```python
import torch

def _softmax(x, axis=-1):
    return torch.softmax(x, dim=axis)
def _gelu(x):
    return torch.nn.functional.gelu(x, approximate="tanh")
def _silu(x):
    return torch.nn.functional.silu(x)
def _sigmoid(x):
    return torch.sigmoid(x)
def _layernorm(x, axis=-1, eps=1e-5):
    m = x.mean(dim=axis, keepdim=True)
    v = x.var(dim=axis, keepdim=True, unbiased=False)
    return (x - m) / torch.sqrt(v + eps)
def _scatter_add(tgt, idx, src, axis=0):
    return tgt.clone().index_add_(axis, idx, src)
def _segment_sum(src, seg, n):
    out = torch.zeros((n,) + src.shape[1:], dtype=src.dtype)
    return out.index_add_(0, seg, src)
def _pad(x, pw):
    flat = tuple(v for pair in reversed(pw) for v in pair)
    return torch.nn.functional.pad(x, flat)

kernel_name = 'interleave_layers__sliding_local_dilated__softmax_full_mha__prompt'

def setup_inputs():

    _w = (lambda a: (lambda t: t.to(torch.bfloat16) if t.is_floating_point() else t)(torch.as_tensor(a)))
    def _A_setup():
        B, S, D = 1, 2048, 1024
        return {
            "x": _w((lambda *s: torch.randn(*s, dtype=torch.bfloat16) * 0.05)(B, S, D)),
            "wqkv": _w((lambda *s: torch.randn(*s, dtype=torch.bfloat16) * 0.05)(D, 3 * D)),
            "wo": _w((lambda *s: torch.randn(*s, dtype=torch.bfloat16) * 0.05)(D, D)),
        }
    _A_in = _A_setup()

    def _B_setup():
        B, S, D = 1, 2048, 1024
        return {
            "x": _w((lambda *s: torch.randn(*s, dtype=torch.bfloat16) * 0.05)(B, S, D)),
            "wqkv": _w((lambda *s: torch.randn(*s, dtype=torch.bfloat16) * 0.05)(D, 3 * D)),
            "wo": _w((lambda *s: torch.randn(*s, dtype=torch.bfloat16) * 0.05)(D, D)),
        }
    _B_in = _B_setup()

    return {
        "A_x": _A_in["x"],
        "A_wqkv": _A_in["wqkv"],
        "A_wo": _A_in["wo"],
        "B_x": _B_in["x"],
        "B_wqkv": _B_in["wqkv"],
        "B_wo": _B_in["wo"],
    }

def reference(A_x, A_wqkv, A_wo, B_x, B_wqkv, B_wo):
    def _A_ref(x, wqkv, wo):
        B, S, D = x.shape
        H = 32; Dh = D // H
        W, dil = 8, 2
        qkv = (lambda x, *d: x.permute(*d))((x @ wqkv).reshape(B, S, 3, H, Dh), 2, 0, 3, 1, 4)
        q, k, v = qkv[0], qkv[1], qkv[2]
        scale = Dh ** -0.5
        pos = torch.arange(S)
        off = torch.arange(W) * dil
        idx = pos[:, None] - off[None, :]
        mask = idx >= 0
        idx_c = torch.where(mask, idx, 0).reshape(-1)
        kg = k[:, :, idx_c, :].reshape(B, H, S, W, Dh)
        vg = v[:, :, idx_c, :].reshape(B, H, S, W, Dh)
        logits = torch.einsum("bhsd,bhswd->bhsw", q, kg) * scale
        logits = torch.where(mask[None, None, :, :], logits, -1e9)
        attn = _softmax(logits, axis=-1)
        o = torch.einsum("bhsw,bhswd->bhsd", attn, vg)
        return (lambda x, *d: x.permute(*d))(o, 0, 2, 1, 3).reshape(B, S, D) @ wo

    def _B_ref(x, wqkv, wo):
        B, S, D = x.shape
        H = 32; Dh = D // H
        qkv = (lambda x, *d: x.permute(*d))((x @ wqkv).reshape(B, S, 3, H, Dh), 2, 0, 3, 1, 4)
        q, k, v = qkv[0], qkv[1], qkv[2]
        scale = Dh ** -0.5
        scores = torch.einsum("bhqd,bhkd->bhqk", q, k) * scale
        p = _softmax(scores, axis=-1)
        o = torch.einsum("bhqk,bhkd->bhqd", p, v)
        return (lambda x, *d: x.permute(*d))(o, 0, 2, 1, 3).reshape(B, S, D) @ wo

    x = A_x
    x = x + _A_ref(_layernorm(x, axis=-1), A_wqkv, A_wo)
    x = x + _B_ref(_layernorm(x, axis=-1), B_wqkv, B_wo)
    x = x + _A_ref(_layernorm(x, axis=-1), A_wqkv, A_wo)
    x = x + _B_ref(_layernorm(x, axis=-1), B_wqkv, B_wo)
    return x
```

```asm
; @launch grid=(256,1,1) block=(512,1,1) lds=159744
.amdgcn_target "amdgcn-amd-amdhsa--gfx950"
.text
.globl interleave_layers__sliding_local_dilated__softmax_full_mha__prompt_kernel
.type interleave_layers__sliding_local_dilated__softmax_full_mha__prompt_kernel,@function
.p2align 8
interleave_layers__sliding_local_dilated__softmax_full_mha__prompt_kernel:
    s_cmp_ge_u32 s2, 256
    s_cbranch_scc1 k_exit2
    s_load_dwordx16 s[32:47], s[0:1], 0
    s_load_dwordx2 s[4:5], s[0:1], 64
    v_lshrrev_b32 v2, 6, v0
    v_and_b32 v1, 63, v0
    v_readfirstlane_b32 s8, v2
    s_and_b32 s3, s2, 1
    s_lshl_b32 s3, s3, 3
    s_bfe_u32 s6, s2, 0x30003
    s_add_u32 s6, s3, s6
    s_bfe_u32 s3, s2, 0x20001
    s_lshl_b32 s3, s3, 2
    s_lshr_b32 s7, s2, 6
    s_add_u32 s7, s3, s7
    s_lshl_b32 s11, s6, 4
    s_add_u32 s11, s11, s7
    s_mov_b32 s9, -1
    s_mov_b32 s96, 0
    s_mov_b32 s10, 0
    s_waitcnt lgkmcnt(0)
    s_mov_b32 s12, s4
    s_mov_b32 s13, s5
    s_mov_b32 s14, 67108864
    s_mov_b32 s15, 0x00020000
    s_cmp_lt_u32 s8, 4
    s_cbranch_scc1 c_prep
    s_cmp_eq_u32 s8, 4
    s_cbranch_scc1 h_raw
    s_branch l_raw
k_exit:
k_exit2:
    s_endpgm
.p2align 6
c_qkva:
    v_and_b32 v1, 63, v0
    v_lshrrev_b32 v2, 6, v0
    v_lshlrev_b32 v5, 4, v1
    s_lshl_b32 s48, s6, 2
    s_add_u32 s48, s48, s8
    s_lshl_b32 s55, s48, 16
    v_lshrrev_b32 v3, 5, v1
    v_and_b32 v4, 15, v0
    v_bfe_u32 v19, v1, 4, 1
    v_lshl_add_u32 v6, v19, 5, v4
    v_lshlrev_b32 v6, 4, v6
    v_lshl_add_u32 v6, v3, 10, v6
    s_lshl_b32 s56, s9, 22
    s_add_u32 s55, s55, s56
    s_add_u32 s16, s4, s55
    s_addc_u32 s17, s5, 0
    s_mov_b32 s18, 65536
    s_mov_b32 s19, 0x00020000
    s_movk_i32 s54, 4096
    v_lshrrev_b32 v23, 2, v4
    v_lshl_add_u32 v23, v19, 2, v23
    v_lshlrev_b32 v23, 7, v23
    v_and_b32 v22, 3, v4
    v_lshl_add_u32 v23, v22, 3, v23
    v_mul_u32_u24 v22, 6144, v3
    v_add_u32 v23, v23, v22
    v_lshrrev_b32 v22, 3, v4
    v_lshl_add_u32 v22, v22, 1, v19
    v_xor_b32 v24, 0, v22
    v_lshl_add_u32 v11, v24, 5, v23
    v_mov_b32 v7, v11
    v_xor_b32 v24, 1, v22
    v_lshl_add_u32 v12, v24, 5, v23
    v_mov_b32 v8, v12
    v_xor_b32 v24, 2, v22
    v_lshl_add_u32 v13, v24, 5, v23
    v_mov_b32 v9, v13
    v_xor_b32 v24, 3, v22
    v_lshl_add_u32 v14, v24, 5, v23
    v_mov_b32 v10, v14
    v_xor_b32 v24, v2, v22
    v_lshl_add_u32 v16, v24, 5, v23
    v_mov_b32 v15, v16
    v_add_u32 v18, 147456, v5
    v_mov_b32 v17, v18
    v_mov_b32 v32, 0
    v_mov_b32 v33, 0
    v_mov_b32 v34, 0
    v_mov_b32 v35, 0
    v_mov_b32 v36, 0
    v_mov_b32 v37, 0
    v_mov_b32 v38, 0
    v_mov_b32 v39, 0
    v_mov_b32 v40, 0
    v_mov_b32 v41, 0
    v_mov_b32 v42, 0
    v_mov_b32 v43, 0
    v_mov_b32 v44, 0
    v_mov_b32 v45, 0
    v_mov_b32 v46, 0
    v_mov_b32 v47, 0
    v_mov_b32 v48, 0
    v_mov_b32 v49, 0
    v_mov_b32 v50, 0
    v_mov_b32 v51, 0
    v_mov_b32 v52, 0
    v_mov_b32 v53, 0
    v_mov_b32 v54, 0
    v_mov_b32 v55, 0
    v_mov_b32 v56, 0
    v_mov_b32 v57, 0
    v_mov_b32 v58, 0
    v_mov_b32 v59, 0
    v_mov_b32 v60, 0
    v_mov_b32 v61, 0
    v_mov_b32 v62, 0
    v_mov_b32 v63, 0
    v_mov_b32 v64, 0
    v_mov_b32 v65, 0
    v_mov_b32 v66, 0
    v_mov_b32 v67, 0
    v_mov_b32 v68, 0
    v_mov_b32 v69, 0
    v_mov_b32 v70, 0
    v_mov_b32 v71, 0
    v_mov_b32 v72, 0
    v_mov_b32 v73, 0
    v_mov_b32 v74, 0
    v_mov_b32 v75, 0
    v_mov_b32 v76, 0
    v_mov_b32 v77, 0
    v_mov_b32 v78, 0
    v_mov_b32 v79, 0
    v_mov_b32 v80, 0
    v_mov_b32 v81, 0
    v_mov_b32 v82, 0
    v_mov_b32 v83, 0
    v_mov_b32 v84, 0
    v_mov_b32 v85, 0
    v_mov_b32 v86, 0
    v_mov_b32 v87, 0
    v_mov_b32 v88, 0
    v_mov_b32 v89, 0
    v_mov_b32 v90, 0
    v_mov_b32 v91, 0
    v_mov_b32 v92, 0
    v_mov_b32 v93, 0
    v_mov_b32 v94, 0
    v_mov_b32 v95, 0
    v_mov_b32 v96, 0
    v_mov_b32 v97, 0
    v_mov_b32 v98, 0
    v_mov_b32 v99, 0
    v_mov_b32 v100, 0
    v_mov_b32 v101, 0
    v_mov_b32 v102, 0
    v_mov_b32 v103, 0
    v_mov_b32 v104, 0
    v_mov_b32 v105, 0
    v_mov_b32 v106, 0
    v_mov_b32 v107, 0
    v_mov_b32 v108, 0
    v_mov_b32 v109, 0
    v_mov_b32 v110, 0
    v_mov_b32 v111, 0
    v_mov_b32 v112, 0
    v_mov_b32 v113, 0
    v_mov_b32 v114, 0
    v_mov_b32 v115, 0
    v_mov_b32 v116, 0
    v_mov_b32 v117, 0
    v_mov_b32 v118, 0
    v_mov_b32 v119, 0
    v_mov_b32 v120, 0
    v_mov_b32 v121, 0
    v_mov_b32 v122, 0
    v_mov_b32 v123, 0
    v_mov_b32 v124, 0
    v_mov_b32 v125, 0
    v_mov_b32 v126, 0
    v_mov_b32 v127, 0
    v_mov_b32 v128, 0
    v_mov_b32 v129, 0
    v_mov_b32 v130, 0
    v_mov_b32 v131, 0
    v_mov_b32 v132, 0
    v_mov_b32 v133, 0
    v_mov_b32 v134, 0
    v_mov_b32 v135, 0
    v_mov_b32 v184, 0
    v_mov_b32 v185, 0
    v_mov_b32 v186, 0
    v_mov_b32 v187, 0
    v_mov_b32 v188, 0
    v_mov_b32 v189, 0
    v_mov_b32 v190, 0
    v_mov_b32 v191, 0
    v_mov_b32 v192, 0
    v_mov_b32 v193, 0
    v_mov_b32 v194, 0
    v_mov_b32 v195, 0
    v_mov_b32 v196, 0
    v_mov_b32 v197, 0
    v_mov_b32 v198, 0
    v_mov_b32 v199, 0
    s_barrier
    buffer_load_dwordx4 a[0:3], v6, s[16:19], 0 offen offset:0 sc1
    buffer_load_dwordx4 a[4:7], v6, s[16:19], 0 offen offset:256 sc1
    buffer_load_dwordx4 a[8:11], v6, s[16:19], 0 offen offset:2048 sc1
    buffer_load_dwordx4 a[12:15], v6, s[16:19], 0 offen offset:2304 sc1
    buffer_load_dwordx4 a[16:19], v6, s[16:19], s54 offen offset:0 sc1
    buffer_load_dwordx4 a[20:23], v6, s[16:19], s54 offen offset:256 sc1
    s_mov_b32 s50, 6144
    s_mov_b32 s51, 10240
    s_mov_b32 s52, 0
    s_mov_b32 s53, 0
    s_mov_b32 s54, 8
    ds_read_b64_tr_b16 v[136:137], v7 offset:0
    ds_read_b64_tr_b16 v[138:139], v7 offset:3072
    ds_read_b64_tr_b16 v[140:141], v8 offset:0
    ds_read_b64_tr_b16 v[142:143], v8 offset:3072
    ds_read_b64_tr_b16 v[144:145], v9 offset:0
    ds_read_b64_tr_b16 v[146:147], v9 offset:3072
    ds_read_b64_tr_b16 v[148:149], v10 offset:0
    ds_read_b64_tr_b16 v[150:151], v10 offset:3072
    ds_read_b64_tr_b16 v[152:153], v7 offset:1024
    ds_read_b64_tr_b16 v[154:155], v7 offset:4096
    ds_read_b64_tr_b16 v[156:157], v8 offset:1024
    ds_read_b64_tr_b16 v[158:159], v8 offset:4096
    ds_read_b64_tr_b16 v[160:161], v9 offset:1024
    ds_read_b64_tr_b16 v[162:163], v9 offset:4096
    ds_read_b64_tr_b16 v[164:165], v10 offset:1024
    ds_read_b64_tr_b16 v[166:167], v10 offset:4096
    ds_read_b64_tr_b16 v[168:169], v7 offset:2048
    ds_read_b64_tr_b16 v[170:171], v7 offset:5120
    ds_read_b64_tr_b16 v[172:173], v8 offset:2048
    ds_read_b64_tr_b16 v[174:175], v8 offset:5120
    ds_read_b64_tr_b16 v[176:177], v9 offset:2048
    ds_read_b64_tr_b16 v[178:179], v9 offset:5120
    s_waitcnt vmcnt(4)
    s_barrier
.p2align 3
c_qkva_loop:
    s_waitcnt vmcnt(4) lgkmcnt(10)
    v_mfma_f32_16x16x32_bf16 v[128:131], v[184:187], v[196:199], v[128:131]
    v_mfma_f32_16x16x32_bf16 v[132:135], v[196:199], v[188:191], v[132:135]
    v_mfma_f32_16x16x32_bf16 v[32:35], v[136:139], a[0:3], v[32:35]
    ds_read_b64_tr_b16 v[180:181], v10 offset:2048
    v_mfma_f32_16x16x32_bf16 v[36:39], v[136:139], a[4:7], v[36:39]
    ds_read_b64_tr_b16 v[182:183], v10 offset:5120
    v_mfma_f32_16x16x32_bf16 v[40:43], v[140:143], a[0:3], v[40:43]
    ds_read_b64_tr_b16 v[136:137], v7 offset:12288
    buffer_load_dwordx4 a[24:27], v6, s[16:19], s50 offen offset:0 sc1
    v_mfma_f32_16x16x32_bf16 v[44:47], v[140:143], a[4:7], v[44:47]
    ds_read_b64_tr_b16 v[138:139], v7 offset:15360
    v_mfma_f32_16x16x32_bf16 v[48:51], v[144:147], a[0:3], v[48:51]
    ds_read_b64_tr_b16 v[140:141], v8 offset:12288
    v_mfma_f32_16x16x32_bf16 v[52:55], v[144:147], a[4:7], v[52:55]
    ds_read_b64_tr_b16 v[142:143], v8 offset:15360
    ds_read_b64_tr_b16 v[184:185], v15 offset:1024
    ds_read_b64_tr_b16 v[186:187], v15 offset:4096
    v_mfma_f32_16x16x32_bf16 v[56:59], v[148:151], a[0:3], v[56:59]
    ds_read_b64_tr_b16 v[144:145], v9 offset:12288
    buffer_load_dwordx4 a[28:31], v6, s[16:19], s50 offen offset:256 sc1
    v_mfma_f32_16x16x32_bf16 v[60:63], v[148:151], a[4:7], v[60:63]
    ds_read_b64_tr_b16 v[146:147], v9 offset:15360
    v_mfma_f32_16x16x32_bf16 v[64:67], v[152:155], a[0:3], v[64:67]
    ds_read_b64_tr_b16 v[148:149], v10 offset:12288
    v_mfma_f32_16x16x32_bf16 v[68:71], v[152:155], a[4:7], v[68:71]
    ds_read_b64_tr_b16 v[150:151], v10 offset:15360
    ds_read_b64_tr_b16 v[188:189], v15 offset:2048
    ds_read_b64_tr_b16 v[190:191], v15 offset:5120
    v_mfma_f32_16x16x32_bf16 v[72:75], v[156:159], a[0:3], v[72:75]
    ds_read_b64_tr_b16 v[152:153], v7 offset:13312
    v_mfma_f32_16x16x32_bf16 v[76:79], v[156:159], a[4:7], v[76:79]
    ds_read_b64_tr_b16 v[154:155], v7 offset:16384
    v_mfma_f32_16x16x32_bf16 v[80:83], v[160:163], a[0:3], v[80:83]
    ds_read_b64_tr_b16 v[156:157], v8 offset:13312
    v_mfma_f32_16x16x32_bf16 v[84:87], v[160:163], a[4:7], v[84:87]
    ds_read_b64_tr_b16 v[158:159], v8 offset:16384
    ds_read_b128 v[192:195], v17 offset:0
    v_mfma_f32_16x16x32_bf16 v[88:91], v[164:167], a[0:3], v[88:91]
    ds_read_b64_tr_b16 v[160:161], v9 offset:13312
    v_mfma_f32_16x16x32_bf16 v[92:95], v[164:167], a[4:7], v[92:95]
    ds_read_b64_tr_b16 v[162:163], v9 offset:16384
    v_mfma_f32_16x16x32_bf16 v[96:99], a[0:3], v[168:171], v[96:99]
    ds_read_b64_tr_b16 v[164:165], v10 offset:13312
    v_mfma_f32_16x16x32_bf16 v[100:103], a[4:7], v[168:171], v[100:103]
    ds_read_b64_tr_b16 v[166:167], v10 offset:16384
    v_mfma_f32_16x16x32_bf16 v[104:107], a[0:3], v[172:175], v[104:107]
    ds_read_b64_tr_b16 v[168:169], v7 offset:14336
    v_mfma_f32_16x16x32_bf16 v[108:111], a[4:7], v[172:175], v[108:111]
    ds_read_b64_tr_b16 v[170:171], v7 offset:17408
    v_mfma_f32_16x16x32_bf16 v[112:115], a[0:3], v[176:179], v[112:115]
    ds_read_b64_tr_b16 v[172:173], v8 offset:14336
    v_mfma_f32_16x16x32_bf16 v[116:119], a[4:7], v[176:179], v[116:119]
    ds_read_b64_tr_b16 v[174:175], v8 offset:17408
    v_mfma_f32_16x16x32_bf16 v[120:123], a[0:3], v[180:183], v[120:123]
    ds_read_b64_tr_b16 v[176:177], v9 offset:14336
    v_mfma_f32_16x16x32_bf16 v[124:127], a[4:7], v[180:183], v[124:127]
    ds_read_b64_tr_b16 v[178:179], v9 offset:17408
    s_waitcnt vmcnt(4) lgkmcnt(10)
    v_mfma_f32_16x16x32_bf16 v[128:131], v[184:187], v[192:195], v[128:131]
    v_mfma_f32_16x16x32_bf16 v[132:135], v[192:195], v[188:191], v[132:135]
    v_mfma_f32_16x16x32_bf16 v[32:35], v[136:139], a[8:11], v[32:35]
    ds_read_b64_tr_b16 v[180:181], v10 offset:14336
    v_mfma_f32_16x16x32_bf16 v[36:39], v[136:139], a[12:15], v[36:39]
    ds_read_b64_tr_b16 v[182:183], v10 offset:17408
    s_barrier
    v_mfma_f32_16x16x32_bf16 v[40:43], v[140:143], a[8:11], v[40:43]
    ds_read_b64_tr_b16 v[136:137], v7 offset:24576
    buffer_load_dwordx4 a[0:3], v6, s[16:19], s50 offen offset:2048 sc1
    v_mfma_f32_16x16x32_bf16 v[44:47], v[140:143], a[12:15], v[44:47]
    ds_read_b64_tr_b16 v[138:139], v7 offset:27648
    v_mfma_f32_16x16x32_bf16 v[48:51], v[144:147], a[8:11], v[48:51]
    ds_read_b64_tr_b16 v[140:141], v8 offset:24576
    v_mfma_f32_16x16x32_bf16 v[52:55], v[144:147], a[12:15], v[52:55]
    ds_read_b64_tr_b16 v[142:143], v8 offset:27648
    ds_read_b64_tr_b16 v[184:185], v15 offset:13312
    ds_read_b64_tr_b16 v[186:187], v15 offset:16384
    v_mfma_f32_16x16x32_bf16 v[56:59], v[148:151], a[8:11], v[56:59]
    ds_read_b64_tr_b16 v[144:145], v9 offset:24576
    buffer_load_dwordx4 a[4:7], v6, s[16:19], s50 offen offset:2304 sc1
    v_mfma_f32_16x16x32_bf16 v[60:63], v[148:151], a[12:15], v[60:63]
    ds_read_b64_tr_b16 v[146:147], v9 offset:27648
    v_mfma_f32_16x16x32_bf16 v[64:67], v[152:155], a[8:11], v[64:67]
    ds_read_b64_tr_b16 v[148:149], v10 offset:24576
    v_mfma_f32_16x16x32_bf16 v[68:71], v[152:155], a[12:15], v[68:71]
    ds_read_b64_tr_b16 v[150:151], v10 offset:27648
    ds_read_b64_tr_b16 v[188:189], v15 offset:14336
    ds_read_b64_tr_b16 v[190:191], v15 offset:17408
    v_mfma_f32_16x16x32_bf16 v[72:75], v[156:159], a[8:11], v[72:75]
    ds_read_b64_tr_b16 v[152:153], v7 offset:25600
    v_mfma_f32_16x16x32_bf16 v[76:79], v[156:159], a[12:15], v[76:79]
    ds_read_b64_tr_b16 v[154:155], v7 offset:28672
    v_mfma_f32_16x16x32_bf16 v[80:83], v[160:163], a[8:11], v[80:83]
    ds_read_b64_tr_b16 v[156:157], v8 offset:25600
    v_mfma_f32_16x16x32_bf16 v[84:87], v[160:163], a[12:15], v[84:87]
    ds_read_b64_tr_b16 v[158:159], v8 offset:28672
    ds_read_b128 v[196:199], v17 offset:1024
    v_mfma_f32_16x16x32_bf16 v[88:91], v[164:167], a[8:11], v[88:91]
    ds_read_b64_tr_b16 v[160:161], v9 offset:25600
    v_mfma_f32_16x16x32_bf16 v[92:95], v[164:167], a[12:15], v[92:95]
    ds_read_b64_tr_b16 v[162:163], v9 offset:28672
    v_mfma_f32_16x16x32_bf16 v[96:99], a[8:11], v[168:171], v[96:99]
    ds_read_b64_tr_b16 v[164:165], v10 offset:25600
    v_mfma_f32_16x16x32_bf16 v[100:103], a[12:15], v[168:171], v[100:103]
    ds_read_b64_tr_b16 v[166:167], v10 offset:28672
    v_mfma_f32_16x16x32_bf16 v[104:107], a[8:11], v[172:175], v[104:107]
    ds_read_b64_tr_b16 v[168:169], v7 offset:26624
    v_mfma_f32_16x16x32_bf16 v[108:111], a[12:15], v[172:175], v[108:111]
    ds_read_b64_tr_b16 v[170:171], v7 offset:29696
    v_mfma_f32_16x16x32_bf16 v[112:115], a[8:11], v[176:179], v[112:115]
    ds_read_b64_tr_b16 v[172:173], v8 offset:26624
    v_mfma_f32_16x16x32_bf16 v[116:119], a[12:15], v[176:179], v[116:119]
    ds_read_b64_tr_b16 v[174:175], v8 offset:29696
    v_mfma_f32_16x16x32_bf16 v[120:123], a[8:11], v[180:183], v[120:123]
    ds_read_b64_tr_b16 v[176:177], v9 offset:26624
    v_mfma_f32_16x16x32_bf16 v[124:127], a[12:15], v[180:183], v[124:127]
    ds_read_b64_tr_b16 v[178:179], v9 offset:29696
    s_waitcnt vmcnt(4) lgkmcnt(10)
    v_mfma_f32_16x16x32_bf16 v[128:131], v[184:187], v[196:199], v[128:131]
    v_mfma_f32_16x16x32_bf16 v[132:135], v[196:199], v[188:191], v[132:135]
    v_mfma_f32_16x16x32_bf16 v[32:35], v[136:139], a[16:19], v[32:35]
    ds_read_b64_tr_b16 v[180:181], v10 offset:26624
    v_mfma_f32_16x16x32_bf16 v[36:39], v[136:139], a[20:23], v[36:39]
    ds_read_b64_tr_b16 v[182:183], v10 offset:29696
    v_mfma_f32_16x16x32_bf16 v[40:43], v[140:143], a[16:19], v[40:43]
    ds_read_b64_tr_b16 v[136:137], v7 offset:36864
    buffer_load_dwordx4 a[8:11], v6, s[16:19], s51 offen offset:0 sc1
    v_mfma_f32_16x16x32_bf16 v[44:47], v[140:143], a[20:23], v[44:47]
    ds_read_b64_tr_b16 v[138:139], v7 offset:39936
    v_mfma_f32_16x16x32_bf16 v[48:51], v[144:147], a[16:19], v[48:51]
    ds_read_b64_tr_b16 v[140:141], v8 offset:36864
    v_mfma_f32_16x16x32_bf16 v[52:55], v[144:147], a[20:23], v[52:55]
    ds_read_b64_tr_b16 v[142:143], v8 offset:39936
    ds_read_b64_tr_b16 v[184:185], v15 offset:25600
    ds_read_b64_tr_b16 v[186:187], v15 offset:28672
    v_mfma_f32_16x16x32_bf16 v[56:59], v[148:151], a[16:19], v[56:59]
    ds_read_b64_tr_b16 v[144:145], v9 offset:36864
    buffer_load_dwordx4 a[12:15], v6, s[16:19], s51 offen offset:256 sc1
    v_mfma_f32_16x16x32_bf16 v[60:63], v[148:151], a[20:23], v[60:63]
    ds_read_b64_tr_b16 v[146:147], v9 offset:39936
    v_mfma_f32_16x16x32_bf16 v[64:67], v[152:155], a[16:19], v[64:67]
    ds_read_b64_tr_b16 v[148:149], v10 offset:36864
    v_mfma_f32_16x16x32_bf16 v[68:71], v[152:155], a[20:23], v[68:71]
    ds_read_b64_tr_b16 v[150:151], v10 offset:39936
    ds_read_b64_tr_b16 v[188:189], v15 offset:26624
    ds_read_b64_tr_b16 v[190:191], v15 offset:29696
    v_mfma_f32_16x16x32_bf16 v[72:75], v[156:159], a[16:19], v[72:75]
    ds_read_b64_tr_b16 v[152:153], v7 offset:37888
    v_mfma_f32_16x16x32_bf16 v[76:79], v[156:159], a[20:23], v[76:79]
    ds_read_b64_tr_b16 v[154:155], v7 offset:40960
    v_mfma_f32_16x16x32_bf16 v[80:83], v[160:163], a[16:19], v[80:83]
    ds_read_b64_tr_b16 v[156:157], v8 offset:37888
    v_mfma_f32_16x16x32_bf16 v[84:87], v[160:163], a[20:23], v[84:87]
    ds_read_b64_tr_b16 v[158:159], v8 offset:40960
    ds_read_b128 v[192:195], v17 offset:2048
    v_mfma_f32_16x16x32_bf16 v[88:91], v[164:167], a[16:19], v[88:91]
    ds_read_b64_tr_b16 v[160:161], v9 offset:37888
    v_mfma_f32_16x16x32_bf16 v[92:95], v[164:167], a[20:23], v[92:95]
    ds_read_b64_tr_b16 v[162:163], v9 offset:40960
    v_mfma_f32_16x16x32_bf16 v[96:99], a[16:19], v[168:171], v[96:99]
    ds_read_b64_tr_b16 v[164:165], v10 offset:37888
    v_mfma_f32_16x16x32_bf16 v[100:103], a[20:23], v[168:171], v[100:103]
    ds_read_b64_tr_b16 v[166:167], v10 offset:40960
    v_mfma_f32_16x16x32_bf16 v[104:107], a[16:19], v[172:175], v[104:107]
    ds_read_b64_tr_b16 v[168:169], v7 offset:38912
    v_mfma_f32_16x16x32_bf16 v[108:111], a[20:23], v[172:175], v[108:111]
    ds_read_b64_tr_b16 v[170:171], v7 offset:41984
    v_mfma_f32_16x16x32_bf16 v[112:115], a[16:19], v[176:179], v[112:115]
    ds_read_b64_tr_b16 v[172:173], v8 offset:38912
    v_mfma_f32_16x16x32_bf16 v[116:119], a[20:23], v[176:179], v[116:119]
    ds_read_b64_tr_b16 v[174:175], v8 offset:41984
    v_mfma_f32_16x16x32_bf16 v[120:123], a[16:19], v[180:183], v[120:123]
    ds_read_b64_tr_b16 v[176:177], v9 offset:38912
    v_mfma_f32_16x16x32_bf16 v[124:127], a[20:23], v[180:183], v[124:127]
    ds_read_b64_tr_b16 v[178:179], v9 offset:41984
    s_waitcnt vmcnt(4) lgkmcnt(10)
    v_mfma_f32_16x16x32_bf16 v[128:131], v[184:187], v[192:195], v[128:131]
    v_mfma_f32_16x16x32_bf16 v[132:135], v[192:195], v[188:191], v[132:135]
    v_mfma_f32_16x16x32_bf16 v[32:35], v[136:139], a[24:27], v[32:35]
    ds_read_b64_tr_b16 v[180:181], v10 offset:38912
    s_add_u32 s52, s52, 49152
    s_cmp_eq_u32 s52, 147456
    s_cselect_b32 s52, 0, s52
    v_mfma_f32_16x16x32_bf16 v[36:39], v[136:139], a[28:31], v[36:39]
    ds_read_b64_tr_b16 v[182:183], v10 offset:41984
    s_barrier
    v_add_u32 v7, s52, v11
    v_add_u32 v8, s52, v12
    v_add_u32 v9, s52, v13
    v_add_u32 v10, s52, v14
    v_mfma_f32_16x16x32_bf16 v[40:43], v[140:143], a[24:27], v[40:43]
    ds_read_b64_tr_b16 v[136:137], v7 offset:0
    buffer_load_dwordx4 a[16:19], v6, s[16:19], s51 offen offset:2048 sc1
    v_mfma_f32_16x16x32_bf16 v[44:47], v[140:143], a[28:31], v[44:47]
    ds_read_b64_tr_b16 v[138:139], v7 offset:3072
    v_mfma_f32_16x16x32_bf16 v[48:51], v[144:147], a[24:27], v[48:51]
    ds_read_b64_tr_b16 v[140:141], v8 offset:0
    v_mfma_f32_16x16x32_bf16 v[52:55], v[144:147], a[28:31], v[52:55]
    ds_read_b64_tr_b16 v[142:143], v8 offset:3072
    ds_read_b64_tr_b16 v[184:185], v15 offset:37888
    ds_read_b64_tr_b16 v[186:187], v15 offset:40960
    v_mfma_f32_16x16x32_bf16 v[56:59], v[148:151], a[24:27], v[56:59]
    ds_read_b64_tr_b16 v[144:145], v9 offset:0
    buffer_load_dwordx4 a[20:23], v6, s[16:19], s51 offen offset:2304 sc1
    v_mfma_f32_16x16x32_bf16 v[60:63], v[148:151], a[28:31], v[60:63]
    ds_read_b64_tr_b16 v[146:147], v9 offset:3072
    v_mfma_f32_16x16x32_bf16 v[64:67], v[152:155], a[24:27], v[64:67]
    ds_read_b64_tr_b16 v[148:149], v10 offset:0
    v_mfma_f32_16x16x32_bf16 v[68:71], v[152:155], a[28:31], v[68:71]
    ds_read_b64_tr_b16 v[150:151], v10 offset:3072
    ds_read_b64_tr_b16 v[188:189], v15 offset:38912
    ds_read_b64_tr_b16 v[190:191], v15 offset:41984
    v_mfma_f32_16x16x32_bf16 v[72:75], v[156:159], a[24:27], v[72:75]
    ds_read_b64_tr_b16 v[152:153], v7 offset:1024
    v_mfma_f32_16x16x32_bf16 v[76:79], v[156:159], a[28:31], v[76:79]
    ds_read_b64_tr_b16 v[154:155], v7 offset:4096
    v_mfma_f32_16x16x32_bf16 v[80:83], v[160:163], a[24:27], v[80:83]
    ds_read_b64_tr_b16 v[156:157], v8 offset:1024
    v_mfma_f32_16x16x32_bf16 v[84:87], v[160:163], a[28:31], v[84:87]
    ds_read_b64_tr_b16 v[158:159], v8 offset:4096
    ds_read_b128 v[196:199], v17 offset:3072
    v_mfma_f32_16x16x32_bf16 v[88:91], v[164:167], a[24:27], v[88:91]
    ds_read_b64_tr_b16 v[160:161], v9 offset:1024
    v_mfma_f32_16x16x32_bf16 v[92:95], v[164:167], a[28:31], v[92:95]
    ds_read_b64_tr_b16 v[162:163], v9 offset:4096
    v_mfma_f32_16x16x32_bf16 v[96:99], a[24:27], v[168:171], v[96:99]
    ds_read_b64_tr_b16 v[164:165], v10 offset:1024
    s_xor_b32 s53, s53, 4096
    v_mfma_f32_16x16x32_bf16 v[100:103], a[28:31], v[168:171], v[100:103]
    ds_read_b64_tr_b16 v[166:167], v10 offset:4096
    v_mfma_f32_16x16x32_bf16 v[104:107], a[24:27], v[172:175], v[104:107]
    ds_read_b64_tr_b16 v[168:169], v7 offset:2048
    v_add_u32 v15, s52, v16
    v_mfma_f32_16x16x32_bf16 v[108:111], a[28:31], v[172:175], v[108:111]
    ds_read_b64_tr_b16 v[170:171], v7 offset:5120
    v_add_u32 v17, s53, v18
    v_mfma_f32_16x16x32_bf16 v[112:115], a[24:27], v[176:179], v[112:115]
    ds_read_b64_tr_b16 v[172:173], v8 offset:2048
    s_add_u32 s50, s50, 8192
    v_mfma_f32_16x16x32_bf16 v[116:119], a[28:31], v[176:179], v[116:119]
    ds_read_b64_tr_b16 v[174:175], v8 offset:5120
    s_add_u32 s51, s51, 8192
    v_mfma_f32_16x16x32_bf16 v[120:123], a[24:27], v[180:183], v[120:123]
    ds_read_b64_tr_b16 v[176:177], v9 offset:2048
    s_sub_u32 s54, s54, 1
    v_mfma_f32_16x16x32_bf16 v[124:127], a[28:31], v[180:183], v[124:127]
    ds_read_b64_tr_b16 v[178:179], v9 offset:5120
    s_cmp_lg_u32 s54, 0
    s_cbranch_scc1 c_qkva_loop
c_qkva_epi:
    s_waitcnt lgkmcnt(0)
    v_mfma_f32_16x16x32_bf16 v[128:131], v[184:187], v[196:199], v[128:131]
    v_mfma_f32_16x16x32_bf16 v[132:135], v[196:199], v[188:191], v[132:135]
    v_and_b32 v7, 0x30, v1
    v_add_u32 v7, 155648, v7
    v_lshlrev_b32 v8, 2, v4
    v_add_u32 v8, 155648, v8
    v_lshl_add_u32 v9, v2, 7, v8
    v_lshl_add_u32 v10, v2, 7, v7
    ds_read_b32 v20, v9 offset:1536
    ds_read_b32 v24, v9 offset:2560
    ds_read_b32 v22, v9 offset:1600
    ds_read_b32 v26, v9 offset:2624
    ds_read_b128 v[152:155], v7 offset:256
    ds_read_b128 v[156:159], v7 offset:320
    ds_read_b128 v[160:163], v7 offset:384
    ds_read_b128 v[164:167], v7 offset:448
    ds_read_b128 v[136:139], v7 offset:0
    ds_read_b128 v[140:143], v7 offset:64
    ds_read_b128 v[144:147], v7 offset:128
    ds_read_b128 v[148:151], v7 offset:192
    s_waitcnt lgkmcnt(8)
    ds_read_b128 v[168:171], v10 offset:1536
    ds_read_b128 v[176:179], v10 offset:2560
    v_mul_f32 v28, 0x3e8293ee, v24
    ds_read_b128 v[172:175], v10 offset:1600
    ds_read_b128 v[180:183], v10 offset:2624
    v_mul_f32 v30, 0x3e8293ee, v26
    ds_read_b32 v200, v8 offset:512
    ds_read_b32 v202, v8 offset:576
    ds_read_b32 v204, v8 offset:640
    ds_read_b32 v206, v8 offset:704
    v_lshl_add_u32 v11, v2, 12, v5
    v_add_u32 v11, 131072, v11
    s_waitcnt lgkmcnt(14)
    v_pk_fma_f32 v[64:65], v[20:21], v[152:153], v[64:65] op_sel_hi:[0,1,1] neg_lo:[1,0,0] neg_hi:[1,0,0]
    v_pk_fma_f32 v[66:67], v[20:21], v[154:155], v[66:67] op_sel_hi:[0,1,1] neg_lo:[1,0,0] neg_hi:[1,0,0]
    v_pk_mul_f32 v[64:65], v[24:25], v[64:65] op_sel_hi:[0,1]
    v_pk_mul_f32 v[66:67], v[24:25], v[66:67] op_sel_hi:[0,1]
    v_pk_fma_f32 v[72:73], v[20:21], v[156:157], v[72:73] op_sel_hi:[0,1,1] neg_lo:[1,0,0] neg_hi:[1,0,0]
    v_pk_fma_f32 v[74:75], v[20:21], v[158:159], v[74:75] op_sel_hi:[0,1,1] neg_lo:[1,0,0] neg_hi:[1,0,0]
    v_pk_mul_f32 v[72:73], v[24:25], v[72:73] op_sel_hi:[0,1]
    v_pk_mul_f32 v[74:75], v[24:25], v[74:75] op_sel_hi:[0,1]
    v_pk_fma_f32 v[68:69], v[22:23], v[152:153], v[68:69] op_sel_hi:[0,1,1] neg_lo:[1,0,0] neg_hi:[1,0,0]
    v_pk_fma_f32 v[70:71], v[22:23], v[154:155], v[70:71] op_sel_hi:[0,1,1] neg_lo:[1,0,0] neg_hi:[1,0,0]
    v_pk_mul_f32 v[68:69], v[26:27], v[68:69] op_sel_hi:[0,1]
    v_pk_mul_f32 v[70:71], v[26:27], v[70:71] op_sel_hi:[0,1]
    v_pk_fma_f32 v[76:77], v[22:23], v[156:157], v[76:77] op_sel_hi:[0,1,1] neg_lo:[1,0,0] neg_hi:[1,0,0]
    v_pk_fma_f32 v[78:79], v[22:23], v[158:159], v[78:79] op_sel_hi:[0,1,1] neg_lo:[1,0,0] neg_hi:[1,0,0]
    v_pk_mul_f32 v[76:77], v[26:27], v[76:77] op_sel_hi:[0,1]
    v_pk_mul_f32 v[78:79], v[26:27], v[78:79] op_sel_hi:[0,1]
    v_cvt_pk_bf16_f32 v64, v64, v65
    v_cvt_pk_bf16_f32 v65, v66, v67
    v_cvt_pk_bf16_f32 v66, v72, v73
    v_cvt_pk_bf16_f32 v67, v74, v75
    v_cvt_pk_bf16_f32 v68, v68, v69
    v_cvt_pk_bf16_f32 v69, v70, v71
    v_cvt_pk_bf16_f32 v70, v76, v77
    v_cvt_pk_bf16_f32 v71, v78, v79
    ds_write_b128 v11, v[68:71] offset:4096
    s_waitcnt lgkmcnt(13)
    v_pk_fma_f32 v[80:81], v[20:21], v[160:161], v[80:81] op_sel_hi:[0,1,1] neg_lo:[1,0,0] neg_hi:[1,0,0]
    v_pk_fma_f32 v[82:83], v[20:21], v[162:163], v[82:83] op_sel_hi:[0,1,1] neg_lo:[1,0,0] neg_hi:[1,0,0]
    v_pk_mul_f32 v[80:81], v[24:25], v[80:81] op_sel_hi:[0,1]
    v_pk_mul_f32 v[82:83], v[24:25], v[82:83] op_sel_hi:[0,1]
    v_pk_fma_f32 v[88:89], v[20:21], v[164:165], v[88:89] op_sel_hi:[0,1,1] neg_lo:[1,0,0] neg_hi:[1,0,0]
    v_pk_fma_f32 v[90:91], v[20:21], v[166:167], v[90:91] op_sel_hi:[0,1,1] neg_lo:[1,0,0] neg_hi:[1,0,0]
    v_pk_mul_f32 v[88:89], v[24:25], v[88:89] op_sel_hi:[0,1]
    v_pk_mul_f32 v[90:91], v[24:25], v[90:91] op_sel_hi:[0,1]
    v_pk_fma_f32 v[84:85], v[22:23], v[160:161], v[84:85] op_sel_hi:[0,1,1] neg_lo:[1,0,0] neg_hi:[1,0,0]
    v_pk_fma_f32 v[86:87], v[22:23], v[162:163], v[86:87] op_sel_hi:[0,1,1] neg_lo:[1,0,0] neg_hi:[1,0,0]
    v_pk_mul_f32 v[84:85], v[26:27], v[84:85] op_sel_hi:[0,1]
    v_pk_mul_f32 v[86:87], v[26:27], v[86:87] op_sel_hi:[0,1]
    v_pk_fma_f32 v[92:93], v[22:23], v[164:165], v[92:93] op_sel_hi:[0,1,1] neg_lo:[1,0,0] neg_hi:[1,0,0]
    v_pk_fma_f32 v[94:95], v[22:23], v[166:167], v[94:95] op_sel_hi:[0,1,1] neg_lo:[1,0,0] neg_hi:[1,0,0]
    v_pk_mul_f32 v[92:93], v[26:27], v[92:93] op_sel_hi:[0,1]
    v_pk_mul_f32 v[94:95], v[26:27], v[94:95] op_sel_hi:[0,1]
    v_cvt_pk_bf16_f32 v80, v80, v81
    v_cvt_pk_bf16_f32 v81, v82, v83
    v_cvt_pk_bf16_f32 v82, v88, v89
    v_cvt_pk_bf16_f32 v83, v90, v91
    v_cvt_pk_bf16_f32 v84, v84, v85
    v_cvt_pk_bf16_f32 v85, v86, v87
    v_cvt_pk_bf16_f32 v86, v92, v93
    v_cvt_pk_bf16_f32 v87, v94, v95
    ds_write_b128 v11, v[84:87] offset:5120
    v_lshl_add_u32 v12, v2, 6, v7
    v_lshl_add_u32 v13, v2, 6, v8
    ds_read_b128 v[208:211], v12 offset:256
    ds_read_b128 v[212:215], v7 offset:1472
    ds_read_b128 v[216:219], v7 offset:2496
    ds_read_b32 v220, v8 offset:1472
    ds_read_b32 v222, v8 offset:2496
    ds_read_b32 v184, v13 offset:512
    s_waitcnt lgkmcnt(8)
    v_pk_fma_f32 v[96:97], v[168:169], v[200:201], v[96:97] op_sel_hi:[1,0,1] neg_lo:[1,0,0] neg_hi:[1,0,0]
    v_pk_fma_f32 v[98:99], v[170:171], v[200:201], v[98:99] op_sel_hi:[1,0,1] neg_lo:[1,0,0] neg_hi:[1,0,0]
    v_pk_mul_f32 v[96:97], v[176:177], v[96:97]
    v_pk_mul_f32 v[98:99], v[178:179], v[98:99]
    v_pk_fma_f32 v[100:101], v[172:173], v[200:201], v[100:101] op_sel_hi:[1,0,1] neg_lo:[1,0,0] neg_hi:[1,0,0]
    v_pk_fma_f32 v[102:103], v[174:175], v[200:201], v[102:103] op_sel_hi:[1,0,1] neg_lo:[1,0,0] neg_hi:[1,0,0]
    v_pk_mul_f32 v[100:101], v[180:181], v[100:101]
    v_pk_mul_f32 v[102:103], v[182:183], v[102:103]
    v_cvt_pk_bf16_f32 v99, v98, v99
    v_cvt_pk_bf16_f32 v98, v96, v97
    v_cvt_pk_bf16_f32 v100, v100, v101
    v_cvt_pk_bf16_f32 v101, v102, v103
    ds_write_b64 v11, v[100:101] offset:6144
    v_pk_fma_f32 v[104:105], v[168:169], v[202:203], v[104:105] op_sel_hi:[1,0,1] neg_lo:[1,0,0] neg_hi:[1,0,0]
    v_pk_fma_f32 v[106:107], v[170:171], v[202:203], v[106:107] op_sel_hi:[1,0,1] neg_lo:[1,0,0] neg_hi:[1,0,0]
    v_pk_mul_f32 v[104:105], v[176:177], v[104:105]
    v_pk_mul_f32 v[106:107], v[178:179], v[106:107]
    v_pk_fma_f32 v[108:109], v[172:173], v[202:203], v[108:109] op_sel_hi:[1,0,1] neg_lo:[1,0,0] neg_hi:[1,0,0]
    v_pk_fma_f32 v[110:111], v[174:175], v[202:203], v[110:111] op_sel_hi:[1,0,1] neg_lo:[1,0,0] neg_hi:[1,0,0]
    v_pk_mul_f32 v[108:109], v[180:181], v[108:109]
    v_pk_mul_f32 v[110:111], v[182:183], v[110:111]
    v_cvt_pk_bf16_f32 v107, v106, v107
    v_cvt_pk_bf16_f32 v106, v104, v105
    v_cvt_pk_bf16_f32 v108, v108, v109
    v_cvt_pk_bf16_f32 v109, v110, v111
    ds_write_b64 v11, v[108:109] offset:6152
    v_pk_fma_f32 v[112:113], v[168:169], v[204:205], v[112:113] op_sel_hi:[1,0,1] neg_lo:[1,0,0] neg_hi:[1,0,0]
    v_pk_fma_f32 v[114:115], v[170:171], v[204:205], v[114:115] op_sel_hi:[1,0,1] neg_lo:[1,0,0] neg_hi:[1,0,0]
    v_pk_mul_f32 v[112:113], v[176:177], v[112:113]
    v_pk_mul_f32 v[114:115], v[178:179], v[114:115]
    v_pk_fma_f32 v[116:117], v[172:173], v[204:205], v[116:117] op_sel_hi:[1,0,1] neg_lo:[1,0,0] neg_hi:[1,0,0]
    v_pk_fma_f32 v[118:119], v[174:175], v[204:205], v[118:119] op_sel_hi:[1,0,1] neg_lo:[1,0,0] neg_hi:[1,0,0]
    v_pk_mul_f32 v[116:117], v[180:181], v[116:117]
    v_pk_mul_f32 v[118:119], v[182:183], v[118:119]
    v_cvt_pk_bf16_f32 v115, v114, v115
    v_cvt_pk_bf16_f32 v114, v112, v113
    v_cvt_pk_bf16_f32 v116, v116, v117
    v_cvt_pk_bf16_f32 v117, v118, v119
    ds_write_b64 v11, v[116:117] offset:7168
    v_pk_fma_f32 v[120:121], v[168:169], v[206:207], v[120:121] op_sel_hi:[1,0,1] neg_lo:[1,0,0] neg_hi:[1,0,0]
    v_pk_fma_f32 v[122:123], v[170:171], v[206:207], v[122:123] op_sel_hi:[1,0,1] neg_lo:[1,0,0] neg_hi:[1,0,0]
    v_pk_mul_f32 v[120:121], v[176:177], v[120:121]
    v_pk_mul_f32 v[122:123], v[178:179], v[122:123]
    v_pk_fma_f32 v[124:125], v[172:173], v[206:207], v[124:125] op_sel_hi:[1,0,1] neg_lo:[1,0,0] neg_hi:[1,0,0]
    v_pk_fma_f32 v[126:127], v[174:175], v[206:207], v[126:127] op_sel_hi:[1,0,1] neg_lo:[1,0,0] neg_hi:[1,0,0]
    v_pk_mul_f32 v[124:125], v[180:181], v[124:125]
    v_pk_mul_f32 v[126:127], v[182:183], v[126:127]
    v_cvt_pk_bf16_f32 v123, v122, v123
    v_cvt_pk_bf16_f32 v122, v120, v121
    v_cvt_pk_bf16_f32 v124, v124, v125
    v_cvt_pk_bf16_f32 v125, v126, v127
    ds_write_b64 v11, v[124:125] offset:7176
    s_waitcnt lgkmcnt(4)
    v_pk_fma_f32 v[128:129], v[220:221], v[208:209], v[128:129] op_sel_hi:[0,1,1] neg_lo:[1,0,0] neg_hi:[1,0,0]
    v_pk_fma_f32 v[130:131], v[220:221], v[210:211], v[130:131] op_sel_hi:[0,1,1] neg_lo:[1,0,0] neg_hi:[1,0,0]
    v_pk_mul_f32 v[128:129], v[222:223], v[128:129] op_sel_hi:[0,1]
    v_pk_mul_f32 v[130:131], v[222:223], v[130:131] op_sel_hi:[0,1]
    v_pk_fma_f32 v[132:133], v[212:213], v[184:185], v[132:133] op_sel_hi:[1,0,1] neg_lo:[1,0,0] neg_hi:[1,0,0]
    v_pk_fma_f32 v[134:135], v[214:215], v[184:185], v[134:135] op_sel_hi:[1,0,1] neg_lo:[1,0,0] neg_hi:[1,0,0]
    v_pk_mul_f32 v[132:133], v[216:217], v[132:133]
    v_pk_mul_f32 v[134:135], v[218:219], v[134:135]
    v_cvt_pk_bf16_f32 v128, v128, v129
    v_cvt_pk_bf16_f32 v129, v130, v131
    v_cvt_pk_bf16_f32 v130, v132, v133
    v_cvt_pk_bf16_f32 v131, v134, v135
    s_lshr_b32 s3, s8, 1
    s_lshl_b32 s3, s3, 10
    s_and_b32 s55, s8, 1
    s_lshl_b32 s55, s55, 3
    s_add_u32 s3, s3, s55
    s_add_u32 s3, s3, 131072
    v_add_u32 v12, s3, v5
    ds_write_b64 v12, v[128:129]
    ds_write_b64 v12, v[130:131] offset:2048
    v_pk_fma_f32 v[32:33], v[20:21], v[136:137], v[32:33] op_sel_hi:[0,1,1] neg_lo:[1,0,0] neg_hi:[1,0,0]
    v_pk_fma_f32 v[34:35], v[20:21], v[138:139], v[34:35] op_sel_hi:[0,1,1] neg_lo:[1,0,0] neg_hi:[1,0,0]
    v_pk_mul_f32 v[32:33], v[28:29], v[32:33] op_sel_hi:[0,1]
    v_pk_mul_f32 v[34:35], v[28:29], v[34:35] op_sel_hi:[0,1]
    v_pk_fma_f32 v[40:41], v[20:21], v[140:141], v[40:41] op_sel_hi:[0,1,1] neg_lo:[1,0,0] neg_hi:[1,0,0]
    v_pk_fma_f32 v[42:43], v[20:21], v[142:143], v[42:43] op_sel_hi:[0,1,1] neg_lo:[1,0,0] neg_hi:[1,0,0]
    v_pk_mul_f32 v[40:41], v[28:29], v[40:41] op_sel_hi:[0,1]
    v_pk_mul_f32 v[42:43], v[28:29], v[42:43] op_sel_hi:[0,1]
    v_pk_fma_f32 v[36:37], v[22:23], v[136:137], v[36:37] op_sel_hi:[0,1,1] neg_lo:[1,0,0] neg_hi:[1,0,0]
    v_pk_fma_f32 v[38:39], v[22:23], v[138:139], v[38:39] op_sel_hi:[0,1,1] neg_lo:[1,0,0] neg_hi:[1,0,0]
    v_pk_mul_f32 v[36:37], v[30:31], v[36:37] op_sel_hi:[0,1]
    v_pk_mul_f32 v[38:39], v[30:31], v[38:39] op_sel_hi:[0,1]
    v_pk_fma_f32 v[44:45], v[22:23], v[140:141], v[44:45] op_sel_hi:[0,1,1] neg_lo:[1,0,0] neg_hi:[1,0,0]
    v_pk_fma_f32 v[46:47], v[22:23], v[142:143], v[46:47] op_sel_hi:[0,1,1] neg_lo:[1,0,0] neg_hi:[1,0,0]
    v_pk_mul_f32 v[44:45], v[30:31], v[44:45] op_sel_hi:[0,1]
    v_pk_mul_f32 v[46:47], v[30:31], v[46:47] op_sel_hi:[0,1]
    v_cvt_pk_bf16_f32 v32, v32, v33
    v_cvt_pk_bf16_f32 v33, v34, v35
    v_cvt_pk_bf16_f32 v34, v40, v41
    v_cvt_pk_bf16_f32 v35, v42, v43
    v_cvt_pk_bf16_f32 v36, v36, v37
    v_cvt_pk_bf16_f32 v37, v38, v39
    v_cvt_pk_bf16_f32 v38, v44, v45
    v_cvt_pk_bf16_f32 v39, v46, v47
    v_pk_fma_f32 v[48:49], v[20:21], v[144:145], v[48:49] op_sel_hi:[0,1,1] neg_lo:[1,0,0] neg_hi:[1,0,0]
    v_pk_fma_f32 v[50:51], v[20:21], v[146:147], v[50:51] op_sel_hi:[0,1,1] neg_lo:[1,0,0] neg_hi:[1,0,0]
    v_pk_mul_f32 v[48:49], v[28:29], v[48:49] op_sel_hi:[0,1]
    v_pk_mul_f32 v[50:51], v[28:29], v[50:51] op_sel_hi:[0,1]
    v_pk_fma_f32 v[56:57], v[20:21], v[148:149], v[56:57] op_sel_hi:[0,1,1] neg_lo:[1,0,0] neg_hi:[1,0,0]
    v_pk_fma_f32 v[58:59], v[20:21], v[150:151], v[58:59] op_sel_hi:[0,1,1] neg_lo:[1,0,0] neg_hi:[1,0,0]
    v_pk_mul_f32 v[56:57], v[28:29], v[56:57] op_sel_hi:[0,1]
    v_pk_mul_f32 v[58:59], v[28:29], v[58:59] op_sel_hi:[0,1]
    v_pk_fma_f32 v[52:53], v[22:23], v[144:145], v[52:53] op_sel_hi:[0,1,1] neg_lo:[1,0,0] neg_hi:[1,0,0]
    v_pk_fma_f32 v[54:55], v[22:23], v[146:147], v[54:55] op_sel_hi:[0,1,1] neg_lo:[1,0,0] neg_hi:[1,0,0]
    v_pk_mul_f32 v[52:53], v[30:31], v[52:53] op_sel_hi:[0,1]
    v_pk_mul_f32 v[54:55], v[30:31], v[54:55] op_sel_hi:[0,1]
    v_pk_fma_f32 v[60:61], v[22:23], v[148:149], v[60:61] op_sel_hi:[0,1,1] neg_lo:[1,0,0] neg_hi:[1,0,0]
    v_pk_fma_f32 v[62:63], v[22:23], v[150:151], v[62:63] op_sel_hi:[0,1,1] neg_lo:[1,0,0] neg_hi:[1,0,0]
    v_pk_mul_f32 v[60:61], v[30:31], v[60:61] op_sel_hi:[0,1]
    v_pk_mul_f32 v[62:63], v[30:31], v[62:63] op_sel_hi:[0,1]
    v_cvt_pk_bf16_f32 v48, v48, v49
    v_cvt_pk_bf16_f32 v49, v50, v51
    v_cvt_pk_bf16_f32 v50, v56, v57
    v_cvt_pk_bf16_f32 v51, v58, v59
    v_cvt_pk_bf16_f32 v52, v52, v53
    v_cvt_pk_bf16_f32 v53, v54, v55
    v_cvt_pk_bf16_f32 v54, v60, v61
    v_cvt_pk_bf16_f32 v55, v62, v63
    v_lshrrev_b32 v13, 4, v1
    v_lshlrev_b32 v13, 2, v13
    v_sub_u32 v13, v4, v13
    v_mov_b32 v14, 0xf149f2ca
    v_add_u32 v9, 0x0, v13
    v_and_b32 v9, 0xfffffff1, v9
    v_cmp_eq_u32 vcc, 0, v9
    s_nop 1
    v_cndmask_b32 v216, v14, 0, vcc
    v_add_u32 v9, 0xffffffff, v13
    v_and_b32 v9, 0xfffffff1, v9
    v_cmp_eq_u32 vcc, 0, v9
    s_nop 1
    v_cndmask_b32 v217, v14, 0, vcc
    v_add_u32 v9, 0xfffffffe, v13
    v_and_b32 v9, 0xfffffff1, v9
    v_cmp_eq_u32 vcc, 0, v9
    s_nop 1
    v_cndmask_b32 v218, v14, 0, vcc
    v_add_u32 v9, 0xfffffffd, v13
    v_and_b32 v9, 0xfffffff1, v9
    v_cmp_eq_u32 vcc, 0, v9
    s_nop 1
    v_cndmask_b32 v219, v14, 0, vcc
    v_add_u32 v9, 0x10, v13
    v_and_b32 v9, 0xfffffff1, v9
    v_cmp_eq_u32 vcc, 0, v9
    s_nop 1
    v_cndmask_b32 v220, v14, 0, vcc
    v_add_u32 v9, 0xf, v13
    v_and_b32 v9, 0xfffffff1, v9
    v_cmp_eq_u32 vcc, 0, v9
    s_nop 1
    v_cndmask_b32 v221, v14, 0, vcc
    v_add_u32 v9, 0xe, v13
    v_and_b32 v9, 0xfffffff1, v9
    v_cmp_eq_u32 vcc, 0, v9
    s_nop 1
    v_cndmask_b32 v222, v14, 0, vcc
    v_add_u32 v9, 0xd, v13
    v_and_b32 v9, 0xfffffff1, v9
    v_cmp_eq_u32 vcc, 0, v9
    s_nop 1
    v_cndmask_b32 v223, v14, 0, vcc
    v_mfma_f32_16x16x32_bf16 v[140:143], v[64:67], v[32:35], v[216:219]
    v_mfma_f32_16x16x32_bf16 v[148:151], v[68:71], v[36:39], v[216:219]
    v_mfma_f32_16x16x32_bf16 v[144:147], v[64:67], v[36:39], v[220:223]
    v_mfma_f32_16x16x32_bf16 v[156:159], v[80:83], v[48:51], v[216:219]
    v_mfma_f32_16x16x32_bf16 v[164:167], v[84:87], v[52:55], v[216:219]
    v_mfma_f32_16x16x32_bf16 v[160:163], v[80:83], v[52:55], v[220:223]
    s_waitcnt lgkmcnt(0)
    s_barrier
    ds_read_b128 v[168:171], v11 offset:0
    ds_read_b128 v[172:175], v11 offset:1024
    ds_read_b64 v[96:97], v11 offset:2048
    ds_read_b64 v[104:105], v11 offset:2056
    ds_read_b64 v[112:113], v11 offset:3072
    ds_read_b64 v[120:121], v11 offset:3080
    s_cmp_lg_u32 s48, 0
    s_cbranch_scc1 c_qkva_hasprev
    v_mov_b32 v220, 0xf149f2ca
    v_mov_b32 v221, 0xf149f2ca
    v_mov_b32 v222, 0xf149f2ca
    v_mov_b32 v223, 0xf149f2ca
c_qkva_hasprev:
    s_lshl_b32 s3, s48, 16
    s_lshl_b32 s55, s7, 12
    s_add_u32 s3, s3, s55
    s_lshl_b32 s55, s9, 22
    s_add_u32 s3, s3, s55
    s_add_u32 s3, s3, 16777216
    s_waitcnt lgkmcnt(4)
    v_mfma_f32_16x16x32_bf16 v[136:139], v[168:171], v[32:35], v[220:223]
    v_mfma_f32_16x16x32_bf16 v[152:155], v[172:175], v[48:51], v[220:223]
    v_max3_f32 v20, v144, v145, v146
    v_max3_f32 v20, v20, v147, v148
    v_max3_f32 v20, v20, v149, v150
    v_max_f32 v20, v20, v151
    v_max3_f32 v22, v160, v161, v162
    v_max3_f32 v22, v22, v163, v164
    v_max3_f32 v22, v22, v165, v166
    v_max_f32 v22, v22, v167
    v_max3_f32 v24, v136, v137, v138
    v_max3_f32 v24, v24, v139, v140
    v_max3_f32 v24, v24, v141, v142
    v_max_f32 v24, v24, v143
    v_max3_f32 v26, v152, v153, v154
    v_max3_f32 v26, v26, v155, v156
    v_max3_f32 v26, v26, v157, v158
    v_max_f32 v26, v26, v159
    v_mov_b32 v21, v20
    v_mov_b32 v23, v22
    v_mov_b32 v25, v24
    v_mov_b32 v27, v26
    v_permlane32_swap_b32 v20, v21
    v_permlane32_swap_b32 v22, v23
    v_permlane32_swap_b32 v24, v25
    v_permlane32_swap_b32 v26, v27
    v_max_f32 v20, v20, v21
    v_max_f32 v22, v22, v23
    v_max_f32 v24, v24, v25
    v_max_f32 v26, v26, v27
    v_mov_b32 v21, v20
    v_mov_b32 v23, v22
    v_mov_b32 v25, v24
    v_mov_b32 v27, v26
    v_permlane16_swap_b32 v20, v21
    v_permlane16_swap_b32 v22, v23
    v_permlane16_swap_b32 v24, v25
    v_permlane16_swap_b32 v26, v27
    v_max_f32 v20, v20, v21
    v_max_f32 v22, v22, v23
    v_max_f32 v24, v24, v25
    v_max_f32 v26, v26, v27
    s_waitcnt lgkmcnt(0)
    v_pk_add_f32 v[144:145], v[144:145], v[20:21] op_sel_hi:[1,0] neg_lo:[0,1] neg_hi:[0,1]
    v_pk_add_f32 v[146:147], v[146:147], v[20:21] op_sel_hi:[1,0] neg_lo:[0,1] neg_hi:[0,1]
    v_pk_add_f32 v[148:149], v[148:149], v[20:21] op_sel_hi:[1,0] neg_lo:[0,1] neg_hi:[0,1]
    v_pk_add_f32 v[150:151], v[150:151], v[20:21] op_sel_hi:[1,0] neg_lo:[0,1] neg_hi:[0,1]
    v_exp_f32 v144, v144
    v_exp_f32 v145, v145
    v_exp_f32 v146, v146
    v_exp_f32 v147, v147
    v_exp_f32 v148, v148
    v_exp_f32 v149, v149
    v_exp_f32 v150, v150
    v_exp_f32 v151, v151
    v_cvt_pk_bf16_f32 v168, v144, v145
    v_cvt_pk_bf16_f32 v169, v146, v147
    v_cvt_pk_bf16_f32 v170, v148, v149
    v_cvt_pk_bf16_f32 v171, v150, v151
    s_nop 1
    v_mfma_f32_16x16x32_bf16 v[56:59], v[98:101], v[168:171], 0
    v_mfma_f32_16x16x32_bf16 v[60:63], v[106:109], v[168:171], 0
    v_pk_add_f32 v[200:201], v[144:145], v[146:147]
    v_pk_add_f32 v[200:201], v[200:201], v[148:149]
    v_pk_add_f32 v[200:201], v[200:201], v[150:151]
    v_add_f32 v200, v200, v201
    v_pk_add_f32 v[160:161], v[160:161], v[22:23] op_sel_hi:[1,0] neg_lo:[0,1] neg_hi:[0,1]
    v_pk_add_f32 v[162:163], v[162:163], v[22:23] op_sel_hi:[1,0] neg_lo:[0,1] neg_hi:[0,1]
    v_pk_add_f32 v[164:165], v[164:165], v[22:23] op_sel_hi:[1,0] neg_lo:[0,1] neg_hi:[0,1]
    v_pk_add_f32 v[166:167], v[166:167], v[22:23] op_sel_hi:[1,0] neg_lo:[0,1] neg_hi:[0,1]
    v_exp_f32 v160, v160
    v_exp_f32 v161, v161
    v_exp_f32 v162, v162
    v_exp_f32 v163, v163
    v_exp_f32 v164, v164
    v_exp_f32 v165, v165
    v_exp_f32 v166, v166
    v_exp_f32 v167, v167
    v_cvt_pk_bf16_f32 v172, v160, v161
    v_cvt_pk_bf16_f32 v173, v162, v163
    v_cvt_pk_bf16_f32 v174, v164, v165
    v_cvt_pk_bf16_f32 v175, v166, v167
    s_nop 1
    v_mfma_f32_16x16x32_bf16 v[88:91], v[114:117], v[172:175], 0
    v_mfma_f32_16x16x32_bf16 v[92:95], v[122:125], v[172:175], 0
    v_pk_add_f32 v[202:203], v[160:161], v[162:163]
    v_pk_add_f32 v[202:203], v[202:203], v[164:165]
    v_pk_add_f32 v[202:203], v[202:203], v[166:167]
    v_add_f32 v202, v202, v203
    v_pk_add_f32 v[136:137], v[136:137], v[24:25] op_sel_hi:[1,0] neg_lo:[0,1] neg_hi:[0,1]
    v_pk_add_f32 v[138:139], v[138:139], v[24:25] op_sel_hi:[1,0] neg_lo:[0,1] neg_hi:[0,1]
    v_pk_add_f32 v[140:141], v[140:141], v[24:25] op_sel_hi:[1,0] neg_lo:[0,1] neg_hi:[0,1]
    v_pk_add_f32 v[142:143], v[142:143], v[24:25] op_sel_hi:[1,0] neg_lo:[0,1] neg_hi:[0,1]
    v_exp_f32 v136, v136
    v_exp_f32 v137, v137
    v_exp_f32 v138, v138
    v_exp_f32 v139, v139
    v_exp_f32 v140, v140
    v_exp_f32 v141, v141
    v_exp_f32 v142, v142
    v_exp_f32 v143, v143
    v_cvt_pk_bf16_f32 v176, v136, v137
    v_cvt_pk_bf16_f32 v177, v138, v139
    v_cvt_pk_bf16_f32 v178, v140, v141
    v_cvt_pk_bf16_f32 v179, v142, v143
    s_nop 1
    v_mfma_f32_16x16x32_bf16 v[40:43], v[96:99], v[176:179], 0
    v_mfma_f32_16x16x32_bf16 v[44:47], v[104:107], v[176:179], 0
    v_pk_add_f32 v[204:205], v[136:137], v[138:139]
    v_pk_add_f32 v[204:205], v[204:205], v[140:141]
    v_pk_add_f32 v[204:205], v[204:205], v[142:143]
    v_add_f32 v204, v204, v205
    v_pk_add_f32 v[152:153], v[152:153], v[26:27] op_sel_hi:[1,0] neg_lo:[0,1] neg_hi:[0,1]
    v_pk_add_f32 v[154:155], v[154:155], v[26:27] op_sel_hi:[1,0] neg_lo:[0,1] neg_hi:[0,1]
    v_pk_add_f32 v[156:157], v[156:157], v[26:27] op_sel_hi:[1,0] neg_lo:[0,1] neg_hi:[0,1]
    v_pk_add_f32 v[158:159], v[158:159], v[26:27] op_sel_hi:[1,0] neg_lo:[0,1] neg_hi:[0,1]
    v_exp_f32 v152, v152
    v_exp_f32 v153, v153
    v_exp_f32 v154, v154
    v_exp_f32 v155, v155
    v_exp_f32 v156, v156
    v_exp_f32 v157, v157
    v_exp_f32 v158, v158
    v_exp_f32 v159, v159
    v_cvt_pk_bf16_f32 v180, v152, v153
    v_cvt_pk_bf16_f32 v181, v154, v155
    v_cvt_pk_bf16_f32 v182, v156, v157
    v_cvt_pk_bf16_f32 v183, v158, v159
    s_nop 1
    v_mfma_f32_16x16x32_bf16 v[72:75], v[112:115], v[180:183], 0
    v_mfma_f32_16x16x32_bf16 v[76:79], v[120:123], v[180:183], 0
    v_pk_add_f32 v[206:207], v[152:153], v[154:155]
    v_pk_add_f32 v[206:207], v[206:207], v[156:157]
    v_pk_add_f32 v[206:207], v[206:207], v[158:159]
    v_add_f32 v206, v206, v207
    v_mov_b32 v201, v200
    v_mov_b32 v203, v202
    v_mov_b32 v205, v204
    v_mov_b32 v207, v206
    v_permlane32_swap_b32 v200, v201
    v_permlane32_swap_b32 v202, v203
    v_permlane32_swap_b32 v204, v205
    v_permlane32_swap_b32 v206, v207
    v_add_f32 v200, v200, v201
    v_add_f32 v202, v202, v203
    v_add_f32 v204, v204, v205
    v_add_f32 v206, v206, v207
    v_mov_b32 v201, v200
    v_mov_b32 v203, v202
    v_mov_b32 v205, v204
    v_mov_b32 v207, v206
    v_permlane16_swap_b32 v200, v201
    v_permlane16_swap_b32 v202, v203
    v_permlane16_swap_b32 v204, v205
    v_permlane16_swap_b32 v206, v207
    v_add_f32 v200, v200, v201
    v_add_f32 v202, v202, v203
    v_add_f32 v204, v204, v205
    v_add_f32 v206, v206, v207
    v_rcp_f32 v200, v200
    v_rcp_f32 v202, v202
    v_rcp_f32 v204, v204
    v_rcp_f32 v206, v206
    v_pk_mul_f32 v[56:57], v[200:201], v[56:57] op_sel_hi:[0,1]
    v_pk_mul_f32 v[58:59], v[200:201], v[58:59] op_sel_hi:[0,1]
    v_pk_mul_f32 v[60:61], v[200:201], v[60:61] op_sel_hi:[0,1]
    v_pk_mul_f32 v[62:63], v[200:201], v[62:63] op_sel_hi:[0,1]
    v_cvt_pk_bf16_f32 v56, v56, v57
    v_cvt_pk_bf16_f32 v57, v58, v59
    v_cvt_pk_bf16_f32 v58, v60, v61
    v_cvt_pk_bf16_f32 v59, v62, v63
    s_nop 0
    v_permlane32_swap_b32 v56, v58
    v_permlane32_swap_b32 v57, v59
    buffer_store_dwordx4 v[56:59], v6, s[12:15], s3 offen offset:256 sc1
    v_pk_mul_f32 v[88:89], v[202:203], v[88:89] op_sel_hi:[0,1]
    v_pk_mul_f32 v[90:91], v[202:203], v[90:91] op_sel_hi:[0,1]
    v_pk_mul_f32 v[92:93], v[202:203], v[92:93] op_sel_hi:[0,1]
    v_pk_mul_f32 v[94:95], v[202:203], v[94:95] op_sel_hi:[0,1]
    v_cvt_pk_bf16_f32 v88, v88, v89
    v_cvt_pk_bf16_f32 v89, v90, v91
    v_cvt_pk_bf16_f32 v90, v92, v93
    v_cvt_pk_bf16_f32 v91, v94, v95
    s_nop 0
    v_permlane32_swap_b32 v88, v90
    v_permlane32_swap_b32 v89, v91
    buffer_store_dwordx4 v[88:91], v6, s[12:15], s3 offen offset:2304 sc1
    v_pk_mul_f32 v[40:41], v[204:205], v[40:41] op_sel_hi:[0,1]
    v_pk_mul_f32 v[42:43], v[204:205], v[42:43] op_sel_hi:[0,1]
    v_pk_mul_f32 v[44:45], v[204:205], v[44:45] op_sel_hi:[0,1]
    v_pk_mul_f32 v[46:47], v[204:205], v[46:47] op_sel_hi:[0,1]
    v_cvt_pk_bf16_f32 v40, v40, v41
    v_cvt_pk_bf16_f32 v41, v42, v43
    v_cvt_pk_bf16_f32 v42, v44, v45
    v_cvt_pk_bf16_f32 v43, v46, v47
    s_nop 0
    v_permlane32_swap_b32 v40, v42
    v_permlane32_swap_b32 v41, v43
    buffer_store_dwordx4 v[40:43], v6, s[12:15], s3 offen offset:0 sc1
    v_pk_mul_f32 v[72:73], v[206:207], v[72:73] op_sel_hi:[0,1]
    v_pk_mul_f32 v[74:75], v[206:207], v[74:75] op_sel_hi:[0,1]
    v_pk_mul_f32 v[76:77], v[206:207], v[76:77] op_sel_hi:[0,1]
    v_pk_mul_f32 v[78:79], v[206:207], v[78:79] op_sel_hi:[0,1]
    v_cvt_pk_bf16_f32 v72, v72, v73
    v_cvt_pk_bf16_f32 v73, v74, v75
    v_cvt_pk_bf16_f32 v74, v76, v77
    v_cvt_pk_bf16_f32 v75, v78, v79
    s_nop 0
    v_permlane32_swap_b32 v72, v74
    v_permlane32_swap_b32 v73, v75
    buffer_store_dwordx4 v[72:75], v6, s[12:15], s3 offen offset:2048 sc1
    s_mul_i32 s55, s9, 393216
    s_add_u32 s55, s55, 60162048
    v_and_b32 v20, 63, v0
    s_lshl_b32 s56, s6, 13
    s_add_u32 s55, s55, s56
    s_lshr_b32 s56, s7, 2
    s_and_b32 s57, s7, 3
    v_lshlrev_b32 v20, 9, v20
    s_lshl_b32 s56, s56, 7
    s_lshl_b32 s57, s57, 2
    s_add_u32 s55, s55, s56
    s_add_u32 s55, s55, s57
    v_mov_b32 v21, 158976
    v_mov_b32 v22, 1
    v_mov_b32 v23, s10
    s_mov_b64 exec, 1
    s_waitcnt vmcnt(0)
    ds_add_rtn_u32 v22, v21, v22
    s_waitcnt lgkmcnt(0)
    v_readfirstlane_b32 s56, v22
    s_and_b32 s56, s56, 3
    s_cmp_lg_u32 s56, 3
    s_cbranch_scc1 pub_1
    s_mov_b32 exec_lo, 0xffff
    buffer_store_dword v23, v20, s[12:15], s55 offen sc1
pub_1:
    s_mov_b64 exec, -1
    s_branch c_wo
.p2align 6
c_wo:
    v_and_b32 v1, 63, v0
    v_lshrrev_b32 v2, 6, v0
    v_lshlrev_b32 v5, 4, v1
    v_lshrrev_b32 v3, 5, v1
    s_lshl_b32 s48, s6, 2
    s_add_u32 s48, s48, s8
    s_lshl_b32 s55, s48, 16
    s_lshl_b32 s56, s9, 22
    s_add_u32 s55, s55, s56
    s_lshl_b32 s56, s7, 12
    s_add_u32 s58, s55, s56
    buffer_load_dwordx4 v[96:99], v5, s[12:15], s58 offen offset:0 sc1
    buffer_load_dwordx4 v[100:103], v5, s[12:15], s58 offen offset:1024 sc1
    buffer_load_dwordx4 v[104:107], v5, s[12:15], s58 offen offset:2048 sc1
    buffer_load_dwordx4 v[108:111], v5, s[12:15], s58 offen offset:3072 sc1
    s_add_u32 s55, s55, 16777216
    s_add_u32 s16, s4, s55
    s_addc_u32 s17, s5, 0
    s_mov_b32 s18, 65536
    s_mov_b32 s19, 0x00020000
    v_and_b32 v4, 15, v0
    v_lshrrev_b32 v16, 2, v4
    v_lshl_add_u32 v16, v3, 2, v16
    v_lshlrev_b32 v16, 7, v16
    v_bfe_u32 v17, v1, 4, 1
    v_lshl_add_u32 v16, v17, 5, v16
    v_and_b32 v17, 3, v4
    v_lshl_add_u32 v16, v17, 3, v16
    v_lshrrev_b32 v17, 3, v4
    v_lshlrev_b32 v18, 6, v17
    v_add_u32 v12, v16, v18
    v_sub_u32 v13, v16, v18
    v_mov_b32 v32, 0
    v_mov_b32 v33, 0
    v_mov_b32 v34, 0
    v_mov_b32 v35, 0
    v_mov_b32 v36, 0
    v_mov_b32 v37, 0
    v_mov_b32 v38, 0
    v_mov_b32 v39, 0
    v_mov_b32 v40, 0
    v_mov_b32 v41, 0
    v_mov_b32 v42, 0
    v_mov_b32 v43, 0
    v_mov_b32 v44, 0
    v_mov_b32 v45, 0
    v_mov_b32 v46, 0
    v_mov_b32 v47, 0
    v_mov_b32 v48, 0
    v_mov_b32 v49, 0
    v_mov_b32 v50, 0
    v_mov_b32 v51, 0
    v_mov_b32 v52, 0
    v_mov_b32 v53, 0
    v_mov_b32 v54, 0
    v_mov_b32 v55, 0
    v_mov_b32 v56, 0
    v_mov_b32 v57, 0
    v_mov_b32 v58, 0
    v_mov_b32 v59, 0
    v_mov_b32 v60, 0
    v_mov_b32 v61, 0
    v_mov_b32 v62, 0
    v_mov_b32 v63, 0
    s_mov_b32 s50, 0
    s_mov_b32 s51, 4096
    s_mov_b32 s52, 8192
    s_mov_b32 s53, 12288
    s_mov_b32 s54, 4
    s_barrier
    buffer_load_dwordx4 v[112:115], v5, s[16:19], s50 offen offset:0 sc1
    buffer_load_dwordx4 v[116:119], v5, s[16:19], s50 offen offset:1024 sc1
    buffer_load_dwordx4 v[120:123], v5, s[16:19], s50 offen offset:2048 sc1
    buffer_load_dwordx4 v[124:127], v5, s[16:19], s50 offen offset:3072 sc1
    ds_read_b64_tr_b16 v[64:65], v12 offset:0
    ds_read_b64_tr_b16 v[66:67], v12 offset:1024
    ds_read_b64_tr_b16 v[68:69], v13 offset:64
    ds_read_b64_tr_b16 v[70:71], v13 offset:1088
    ds_read_b64_tr_b16 v[72:73], v12 offset:2048
    ds_read_b64_tr_b16 v[74:75], v12 offset:3072
    ds_read_b64_tr_b16 v[76:77], v13 offset:2112
    ds_read_b64_tr_b16 v[78:79], v13 offset:3136
    ds_read_b64_tr_b16 v[80:81], v12 offset:4096
    ds_read_b64_tr_b16 v[82:83], v12 offset:5120
    ds_read_b64_tr_b16 v[84:85], v13 offset:4160
    ds_read_b64_tr_b16 v[86:87], v13 offset:5184
    buffer_load_dwordx4 v[128:131], v5, s[16:19], s51 offen offset:0 sc1
    buffer_load_dwordx4 v[132:135], v5, s[16:19], s51 offen offset:1024 sc1
    buffer_load_dwordx4 v[136:139], v5, s[16:19], s51 offen offset:2048 sc1
    buffer_load_dwordx4 v[140:143], v5, s[16:19], s51 offen offset:3072 sc1
    buffer_load_dwordx4 v[144:147], v5, s[16:19], s52 offen offset:0 sc1
    buffer_load_dwordx4 v[148:151], v5, s[16:19], s52 offen offset:1024 sc1
    buffer_load_dwordx4 v[152:155], v5, s[16:19], s52 offen offset:2048 sc1
    buffer_load_dwordx4 v[156:159], v5, s[16:19], s52 offen offset:3072 sc1
    buffer_load_dwordx4 v[160:163], v5, s[16:19], s53 offen offset:0 sc1
    buffer_load_dwordx4 v[164:167], v5, s[16:19], s53 offen offset:1024 sc1
    buffer_load_dwordx4 v[168:171], v5, s[16:19], s53 offen offset:2048 sc1
    s_add_u32 s50, s50, 15360
    s_add_u32 s51, s51, 15360
    s_add_u32 s52, s52, 15360
    s_add_u32 s53, s53, 15360
.p2align 3
c_wo_loop:
    s_waitcnt vmcnt(14) lgkmcnt(8)
    v_mfma_f32_32x32x16_bf16 v[32:47], v[64:67], v[112:115], v[32:47]
    ds_read_b64_tr_b16 v[88:89], v12 offset:6144
    ds_read_b64_tr_b16 v[90:91], v12 offset:7168
    buffer_load_dwordx4 v[172:175], v5, s[16:19], s50 offen offset:0 sc1
    v_mfma_f32_32x32x16_bf16 v[48:63], v[68:71], v[112:115], v[48:63]
    ds_read_b64_tr_b16 v[92:93], v13 offset:6208
    ds_read_b64_tr_b16 v[94:95], v13 offset:7232
    s_waitcnt vmcnt(14) lgkmcnt(8)
    v_mfma_f32_32x32x16_bf16 v[32:47], v[72:75], v[116:119], v[32:47]
    ds_read_b64_tr_b16 v[64:65], v12 offset:8192
    ds_read_b64_tr_b16 v[66:67], v12 offset:9216
    buffer_load_dwordx4 v[112:115], v5, s[16:19], s50 offen offset:1024 sc1
    v_mfma_f32_32x32x16_bf16 v[48:63], v[76:79], v[116:119], v[48:63]
    ds_read_b64_tr_b16 v[68:69], v13 offset:8256
    ds_read_b64_tr_b16 v[70:71], v13 offset:9280
    s_waitcnt vmcnt(14) lgkmcnt(8)
    v_mfma_f32_32x32x16_bf16 v[32:47], v[80:83], v[120:123], v[32:47]
    ds_read_b64_tr_b16 v[72:73], v12 offset:10240
    ds_read_b64_tr_b16 v[74:75], v12 offset:11264
    buffer_load_dwordx4 v[116:119], v5, s[16:19], s50 offen offset:2048 sc1
    v_mfma_f32_32x32x16_bf16 v[48:63], v[84:87], v[120:123], v[48:63]
    ds_read_b64_tr_b16 v[76:77], v13 offset:10304
    ds_read_b64_tr_b16 v[78:79], v13 offset:11328
    s_waitcnt vmcnt(14) lgkmcnt(8)
    v_mfma_f32_32x32x16_bf16 v[32:47], v[88:91], v[124:127], v[32:47]
    ds_read_b64_tr_b16 v[80:81], v12 offset:12288
    ds_read_b64_tr_b16 v[82:83], v12 offset:13312
    buffer_load_dwordx4 v[120:123], v5, s[16:19], s50 offen offset:3072 sc1
    v_mfma_f32_32x32x16_bf16 v[48:63], v[92:95], v[124:127], v[48:63]
    ds_read_b64_tr_b16 v[84:85], v13 offset:12352
    ds_read_b64_tr_b16 v[86:87], v13 offset:13376
    s_add_u32 s50, s50, 16384
    s_waitcnt vmcnt(14) lgkmcnt(8)
    v_mfma_f32_32x32x16_bf16 v[32:47], v[64:67], v[128:131], v[32:47]
    ds_read_b64_tr_b16 v[88:89], v12 offset:14336
    ds_read_b64_tr_b16 v[90:91], v12 offset:15360
    buffer_load_dwordx4 v[124:127], v5, s[16:19], s51 offen offset:0 sc1
    v_mfma_f32_32x32x16_bf16 v[48:63], v[68:71], v[128:131], v[48:63]
    ds_read_b64_tr_b16 v[92:93], v13 offset:14400
    ds_read_b64_tr_b16 v[94:95], v13 offset:15424
    s_waitcnt vmcnt(14) lgkmcnt(8)
    v_mfma_f32_32x32x16_bf16 v[32:47], v[72:75], v[132:135], v[32:47]
    ds_read_b64_tr_b16 v[64:65], v12 offset:16384
    ds_read_b64_tr_b16 v[66:67], v12 offset:17408
    buffer_load_dwordx4 v[128:131], v5, s[16:19], s51 offen offset:1024 sc1
    v_mfma_f32_32x32x16_bf16 v[48:63], v[76:79], v[132:135], v[48:63]
    ds_read_b64_tr_b16 v[68:69], v13 offset:16448
    ds_read_b64_tr_b16 v[70:71], v13 offset:17472
    s_waitcnt vmcnt(14) lgkmcnt(8)
    v_mfma_f32_32x32x16_bf16 v[32:47], v[80:83], v[136:139], v[32:47]
    ds_read_b64_tr_b16 v[72:73], v12 offset:18432
    ds_read_b64_tr_b16 v[74:75], v12 offset:19456
    buffer_load_dwordx4 v[132:135], v5, s[16:19], s51 offen offset:2048 sc1
    v_mfma_f32_32x32x16_bf16 v[48:63], v[84:87], v[136:139], v[48:63]
    ds_read_b64_tr_b16 v[76:77], v13 offset:18496
    ds_read_b64_tr_b16 v[78:79], v13 offset:19520
    s_waitcnt vmcnt(14) lgkmcnt(8)
    v_mfma_f32_32x32x16_bf16 v[32:47], v[88:91], v[140:143], v[32:47]
    ds_read_b64_tr_b16 v[80:81], v12 offset:20480
    ds_read_b64_tr_b16 v[82:83], v12 offset:21504
    buffer_load_dwordx4 v[136:139], v5, s[16:19], s51 offen offset:3072 sc1
    v_mfma_f32_32x32x16_bf16 v[48:63], v[92:95], v[140:143], v[48:63]
    ds_read_b64_tr_b16 v[84:85], v13 offset:20544
    ds_read_b64_tr_b16 v[86:87], v13 offset:21568
    s_add_u32 s51, s51, 16384
    s_waitcnt vmcnt(14) lgkmcnt(8)
    v_mfma_f32_32x32x16_bf16 v[32:47], v[64:67], v[144:147], v[32:47]
    ds_read_b64_tr_b16 v[88:89], v12 offset:22528
    ds_read_b64_tr_b16 v[90:91], v12 offset:23552
    buffer_load_dwordx4 v[140:143], v5, s[16:19], s52 offen offset:0 sc1
    v_mfma_f32_32x32x16_bf16 v[48:63], v[68:71], v[144:147], v[48:63]
    ds_read_b64_tr_b16 v[92:93], v13 offset:22592
    ds_read_b64_tr_b16 v[94:95], v13 offset:23616
    s_waitcnt vmcnt(14) lgkmcnt(8)
    v_mfma_f32_32x32x16_bf16 v[32:47], v[72:75], v[148:151], v[32:47]
    ds_read_b64_tr_b16 v[64:65], v12 offset:24576
    ds_read_b64_tr_b16 v[66:67], v12 offset:25600
    buffer_load_dwordx4 v[144:147], v5, s[16:19], s52 offen offset:1024 sc1
    v_mfma_f32_32x32x16_bf16 v[48:63], v[76:79], v[148:151], v[48:63]
    ds_read_b64_tr_b16 v[68:69], v13 offset:24640
    ds_read_b64_tr_b16 v[70:71], v13 offset:25664
    s_waitcnt vmcnt(14) lgkmcnt(8)
    v_mfma_f32_32x32x16_bf16 v[32:47], v[80:83], v[152:155], v[32:47]
    ds_read_b64_tr_b16 v[72:73], v12 offset:26624
    ds_read_b64_tr_b16 v[74:75], v12 offset:27648
    buffer_load_dwordx4 v[148:151], v5, s[16:19], s52 offen offset:2048 sc1
    v_mfma_f32_32x32x16_bf16 v[48:63], v[84:87], v[152:155], v[48:63]
    ds_read_b64_tr_b16 v[76:77], v13 offset:26688
    ds_read_b64_tr_b16 v[78:79], v13 offset:27712
    s_waitcnt vmcnt(14) lgkmcnt(8)
    v_mfma_f32_32x32x16_bf16 v[32:47], v[88:91], v[156:159], v[32:47]
    ds_read_b64_tr_b16 v[80:81], v12 offset:28672
    ds_read_b64_tr_b16 v[82:83], v12 offset:29696
    buffer_load_dwordx4 v[152:155], v5, s[16:19], s52 offen offset:3072 sc1
    v_mfma_f32_32x32x16_bf16 v[48:63], v[92:95], v[156:159], v[48:63]
    ds_read_b64_tr_b16 v[84:85], v13 offset:28736
    ds_read_b64_tr_b16 v[86:87], v13 offset:29760
    s_add_u32 s52, s52, 16384
    s_waitcnt vmcnt(14) lgkmcnt(8)
    v_mfma_f32_32x32x16_bf16 v[32:47], v[64:67], v[160:163], v[32:47]
    ds_read_b64_tr_b16 v[88:89], v12 offset:30720
    ds_read_b64_tr_b16 v[90:91], v12 offset:31744
    buffer_load_dwordx4 v[156:159], v5, s[16:19], s53 offen offset:0 sc1
    v_mfma_f32_32x32x16_bf16 v[48:63], v[68:71], v[160:163], v[48:63]
    ds_read_b64_tr_b16 v[92:93], v13 offset:30784
    ds_read_b64_tr_b16 v[94:95], v13 offset:31808
    s_waitcnt vmcnt(14) lgkmcnt(8)
    v_mfma_f32_32x32x16_bf16 v[32:47], v[72:75], v[164:167], v[32:47]
    ds_read_b64_tr_b16 v[64:65], v12 offset:32768
    ds_read_b64_tr_b16 v[66:67], v12 offset:33792
    buffer_load_dwordx4 v[160:163], v5, s[16:19], s53 offen offset:1024 sc1
    v_mfma_f32_32x32x16_bf16 v[48:63], v[76:79], v[164:167], v[48:63]
    ds_read_b64_tr_b16 v[68:69], v13 offset:32832
    ds_read_b64_tr_b16 v[70:71], v13 offset:33856
    s_waitcnt vmcnt(14) lgkmcnt(8)
    v_mfma_f32_32x32x16_bf16 v[32:47], v[80:83], v[168:171], v[32:47]
    ds_read_b64_tr_b16 v[72:73], v12 offset:34816
    ds_read_b64_tr_b16 v[74:75], v12 offset:35840
    buffer_load_dwordx4 v[164:167], v5, s[16:19], s53 offen offset:2048 sc1
    v_mfma_f32_32x32x16_bf16 v[48:63], v[84:87], v[168:171], v[48:63]
    ds_read_b64_tr_b16 v[76:77], v13 offset:34880
    ds_read_b64_tr_b16 v[78:79], v13 offset:35904
    s_waitcnt vmcnt(14) lgkmcnt(8)
    v_mfma_f32_32x32x16_bf16 v[32:47], v[88:91], v[172:175], v[32:47]
    ds_read_b64_tr_b16 v[80:81], v12 offset:36864
    ds_read_b64_tr_b16 v[82:83], v12 offset:37888
    buffer_load_dwordx4 v[168:171], v5, s[16:19], s53 offen offset:3072 sc1
    v_add_u32 v12, 32768, v12
    v_mfma_f32_32x32x16_bf16 v[48:63], v[92:95], v[172:175], v[48:63]
    ds_read_b64_tr_b16 v[84:85], v13 offset:36928
    ds_read_b64_tr_b16 v[86:87], v13 offset:37952
    v_add_u32 v13, 32768, v13
    s_add_u32 s53, s53, 16384
    s_sub_u32 s54, s54, 1
    s_cmp_lg_u32 s54, 0
    s_cbranch_scc1 c_wo_loop
    s_barrier
    s_mov_b32 s57, 0xffff0000
    v_lshlrev_b32 v176, 16, v96
    v_and_b32 v177, s57, v96
    v_lshlrev_b32 v178, 16, v97
    v_and_b32 v179, s57, v97
    v_lshlrev_b32 v180, 16, v98
    v_and_b32 v181, s57, v98
    v_lshlrev_b32 v182, 16, v99
    v_and_b32 v183, s57, v99
    v_lshlrev_b32 v184, 16, v100
    v_and_b32 v185, s57, v100
    v_lshlrev_b32 v186, 16, v101
    v_and_b32 v187, s57, v101
    v_lshlrev_b32 v188, 16, v102
    v_and_b32 v189, s57, v102
    v_lshlrev_b32 v190, 16, v103
    v_and_b32 v191, s57, v103
    v_lshlrev_b32 v192, 16, v104
    v_and_b32 v193, s57, v104
    v_lshlrev_b32 v194, 16, v105
    v_and_b32 v195, s57, v105
    v_lshlrev_b32 v196, 16, v106
    v_and_b32 v197, s57, v106
    v_lshlrev_b32 v198, 16, v107
    v_and_b32 v199, s57, v107
    v_lshlrev_b32 v200, 16, v108
    v_and_b32 v201, s57, v108
    v_lshlrev_b32 v202, 16, v109
    v_and_b32 v203, s57, v109
    v_lshlrev_b32 v204, 16, v110
    v_and_b32 v205, s57, v110
    v_lshlrev_b32 v206, 16, v111
    v_and_b32 v207, s57, v111
    s_cmp_eq_u32 s9, 3
    s_cbranch_scc1 c_wo_fin
    s_add_u32 s58, s58, 4194304
    v_pk_add_f32 v[32:33], v[32:33], v[176:177]
    v_pk_add_f32 v[34:35], v[34:35], v[178:179]
    v_pk_add_f32 v[36:37], v[36:37], v[180:181]
    v_pk_add_f32 v[38:39], v[38:39], v[182:183]
    v_cvt_pk_bf16_f32 v96, v32, v33
    v_cvt_pk_bf16_f32 v97, v34, v35
    v_cvt_pk_bf16_f32 v98, v36, v37
    v_cvt_pk_bf16_f32 v99, v38, v39
    buffer_store_dwordx4 v[96:99], v5, s[12:15], s58 offen offset:0 sc1
    v_pk_add_f32 v[40:41], v[40:41], v[184:185]
    v_pk_add_f32 v[42:43], v[42:43], v[186:187]
    v_pk_add_f32 v[44:45], v[44:45], v[188:189]
    v_pk_add_f32 v[46:47], v[46:47], v[190:191]
    v_cvt_pk_bf16_f32 v100, v40, v41
    v_cvt_pk_bf16_f32 v101, v42, v43
    v_cvt_pk_bf16_f32 v102, v44, v45
    v_cvt_pk_bf16_f32 v103, v46, v47
    buffer_store_dwordx4 v[100:103], v5, s[12:15], s58 offen offset:1024 sc1
    v_pk_add_f32 v[48:49], v[48:49], v[192:193]
    v_pk_add_f32 v[50:51], v[50:51], v[194:195]
    v_pk_add_f32 v[52:53], v[52:53], v[196:197]
    v_pk_add_f32 v[54:55], v[54:55], v[198:199]
    v_cvt_pk_bf16_f32 v104, v48, v49
    v_cvt_pk_bf16_f32 v105, v50, v51
    v_cvt_pk_bf16_f32 v106, v52, v53
    v_cvt_pk_bf16_f32 v107, v54, v55
    buffer_store_dwordx4 v[104:107], v5, s[12:15], s58 offen offset:2048 sc1
    v_pk_add_f32 v[56:57], v[56:57], v[200:201]
    v_pk_add_f32 v[58:59], v[58:59], v[202:203]
    v_pk_add_f32 v[60:61], v[60:61], v[204:205]
    v_pk_add_f32 v[62:63], v[62:63], v[206:207]
    v_cvt_pk_bf16_f32 v108, v56, v57
    v_cvt_pk_bf16_f32 v109, v58, v59
    v_cvt_pk_bf16_f32 v110, v60, v61
    v_cvt_pk_bf16_f32 v111, v62, v63
    buffer_store_dwordx4 v[108:111], v5, s[12:15], s58 offen offset:3072 sc1
c_wo_stat:
    v_mov_b32 v22, 0x3f803f80
    v_mov_b32 v18, 0
    v_mov_b32 v19, 0
    v_dot2_f32_bf16 v18, v96, v22, v18
    v_dot2_f32_bf16 v19, v96, v96, v19
    v_dot2_f32_bf16 v18, v97, v22, v18
    v_dot2_f32_bf16 v19, v97, v97, v19
    v_dot2_f32_bf16 v18, v98, v22, v18
    v_dot2_f32_bf16 v19, v98, v98, v19
    v_dot2_f32_bf16 v18, v99, v22, v18
    v_dot2_f32_bf16 v19, v99, v99, v19
    v_dot2_f32_bf16 v18, v100, v22, v18
    v_dot2_f32_bf16 v19, v100, v100, v19
    v_dot2_f32_bf16 v18, v101, v22, v18
    v_dot2_f32_bf16 v19, v101, v101, v19
    v_dot2_f32_bf16 v18, v102, v22, v18
    v_dot2_f32_bf16 v19, v102, v102, v19
    v_dot2_f32_bf16 v18, v103, v22, v18
    v_dot2_f32_bf16 v19, v103, v103, v19
    v_dot2_f32_bf16 v18, v104, v22, v18
    v_dot2_f32_bf16 v19, v104, v104, v19
    v_dot2_f32_bf16 v18, v105, v22, v18
    v_dot2_f32_bf16 v19, v105, v105, v19
    v_dot2_f32_bf16 v18, v106, v22, v18
    v_dot2_f32_bf16 v19, v106, v106, v19
    v_dot2_f32_bf16 v18, v107, v22, v18
    v_dot2_f32_bf16 v19, v107, v107, v19
    v_dot2_f32_bf16 v18, v108, v22, v18
    v_dot2_f32_bf16 v19, v108, v108, v19
    v_dot2_f32_bf16 v18, v109, v22, v18
    v_dot2_f32_bf16 v19, v109, v109, v19
    v_dot2_f32_bf16 v18, v110, v22, v18
    v_dot2_f32_bf16 v19, v110, v110, v19
    v_dot2_f32_bf16 v18, v111, v22, v18
    v_dot2_f32_bf16 v19, v111, v111, v19
    v_lshlrev_b32 v16, 3, v1
    s_lshl_b32 s3, s48, 12
    s_lshl_b32 s55, s7, 8
    v_mov_b32 v20, v18
    v_mov_b32 v21, v19
    s_add_u32 s3, s3, s55
    s_lshl_b32 s55, s9, 18
    v_permlane32_swap_b32 v18, v20
    v_permlane32_swap_b32 v19, v21
    s_add_u32 s3, s3, s55
    s_add_u32 s3, s3, 57933824
    v_pk_add_f32 v[18:19], v[18:19], v[20:21]
    s_mov_b32 exec_hi, 0
    buffer_store_dwordx2 v[18:19], v16, s[12:15], s3 offen sc1
    s_mov_b64 exec, -1
    s_bitcmp1_b32 s9, 0
    s_cbranch_scc1 c_wo_toA
    s_mul_i32 s55, s9, 393216
    s_add_u32 s55, s55, 60293120
    v_and_b32 v24, 63, v0
    s_lshr_b32 s56, s11, 5
    s_lshl_b32 s56, s56, 14
    s_add_u32 s55, s55, s56
    s_bfe_u32 s56, s11, 0x20003
    s_and_b32 s57, s11, 7
    v_lshlrev_b32 v24, 9, v24
    s_lshl_b32 s56, s56, 7
    s_lshl_b32 s57, s57, 2
    s_add_u32 s55, s55, s56
    s_add_u32 s55, s55, s57
    v_mov_b32 v25, 158976
    v_mov_b32 v26, 1
    v_mov_b32 v27, s10
    s_mov_b64 exec, 1
    s_waitcnt vmcnt(0)
    ds_add_rtn_u32 v26, v25, v26
    s_waitcnt lgkmcnt(0)
    v_readfirstlane_b32 s56, v26
    s_and_b32 s56, s56, 3
    s_cmp_lg_u32 s56, 3
    s_cbranch_scc1 pub_2
    s_mov_b32 exec_lo, -1
    buffer_store_dword v27, v24, s[12:15], s55 offen sc1
pub_2:
    s_mov_b64 exec, -1
    s_add_u32 s9, s9, 1
    s_branch c_qkvb
c_wo_toA:
    s_cmp_lg_u32 s9, -1
    s_cbranch_scc1 c_wo_toA2
    s_barrier
    v_mov_b32 v24, 158980
non_3:
    ds_read_b32 v25, v24
    s_waitcnt lgkmcnt(0)
    v_readfirstlane_b32 s10, v25
    s_cmp_eq_u32 s10, 0
    s_cbranch_scc1 non_3
c_wo_toA2:
    s_mul_i32 s55, s9, 393216
    s_add_u32 s55, s55, 60293120
    v_and_b32 v24, 63, v0
    s_lshl_b32 s56, s6, 4
    v_lshrrev_b32 v25, 4, v24
    v_add_u32 v24, s56, v24
    v_and_b32 v24, 255, v24
    v_lshlrev_b32 v24, 9, v24
    v_lshl_add_u32 v24, v25, 8, v24
    s_lshr_b32 s56, s7, 3
    s_and_b32 s57, s7, 7
    s_lshl_b32 s56, s56, 7
    s_lshl_b32 s57, s57, 2
    s_add_u32 s55, s55, s56
    s_add_u32 s55, s55, s57
    v_mov_b32 v25, 158976
    v_mov_b32 v26, 1
    v_mov_b32 v27, s10
    s_mov_b64 exec, 1
    s_waitcnt vmcnt(0)
    ds_add_rtn_u32 v26, v25, v26
    s_waitcnt lgkmcnt(0)
    v_readfirstlane_b32 s56, v26
    s_and_b32 s56, s56, 3
    s_cmp_lg_u32 s56, 3
    s_cbranch_scc1 pub_4
    s_mov_b32 exec_lo, -1
    buffer_store_dword v27, v24, s[12:15], s55 offen sc1
pub_4:
    s_mov_b64 exec, -1
    s_add_u32 s9, s9, 1
    s_branch c_qkva
c_wo_fin:
    v_pk_add_f32 v[32:33], v[32:33], v[176:177]
    v_pk_add_f32 v[34:35], v[34:35], v[178:179]
    v_pk_add_f32 v[36:37], v[36:37], v[180:181]
    v_pk_add_f32 v[38:39], v[38:39], v[182:183]
    v_pk_add_f32 v[40:41], v[40:41], v[184:185]
    v_pk_add_f32 v[42:43], v[42:43], v[186:187]
    v_pk_add_f32 v[44:45], v[44:45], v[188:189]
    v_pk_add_f32 v[46:47], v[46:47], v[190:191]
    v_pk_add_f32 v[48:49], v[48:49], v[192:193]
    v_pk_add_f32 v[50:51], v[50:51], v[194:195]
    v_pk_add_f32 v[52:53], v[52:53], v[196:197]
    v_pk_add_f32 v[54:55], v[54:55], v[198:199]
    v_pk_add_f32 v[56:57], v[56:57], v[200:201]
    v_pk_add_f32 v[58:59], v[58:59], v[202:203]
    v_pk_add_f32 v[60:61], v[60:61], v[204:205]
    v_pk_add_f32 v[62:63], v[62:63], v[206:207]
    v_cvt_pk_bf16_f32 v96, v32, v33
    v_cvt_pk_bf16_f32 v97, v34, v35
    v_cvt_pk_bf16_f32 v98, v36, v37
    v_cvt_pk_bf16_f32 v99, v38, v39
    v_cvt_pk_bf16_f32 v100, v40, v41
    v_cvt_pk_bf16_f32 v101, v42, v43
    v_cvt_pk_bf16_f32 v102, v44, v45
    v_cvt_pk_bf16_f32 v103, v46, v47
    v_cvt_pk_bf16_f32 v104, v48, v49
    v_cvt_pk_bf16_f32 v105, v50, v51
    v_cvt_pk_bf16_f32 v106, v52, v53
    v_cvt_pk_bf16_f32 v107, v54, v55
    v_cvt_pk_bf16_f32 v108, v56, v57
    v_cvt_pk_bf16_f32 v109, v58, v59
    v_cvt_pk_bf16_f32 v110, v60, v61
    v_cvt_pk_bf16_f32 v111, v62, v63
    s_mov_b32 s28, s44
    s_mov_b32 s29, s45
    s_mov_b32 s30, 4194304
    s_mov_b32 s31, 0x00020000
    v_and_b32 v16, 31, v1
    v_mul_u32_u24 v16, 144, v16
    v_lshl_add_u32 v16, v3, 3, v16
    v_mul_u32_u24 v17, 4608, v2
    v_add_u32 v16, v16, v17
    ds_write_b64 v16, v[96:97] offset:0
    ds_write_b64 v16, v[98:99] offset:16
    ds_write_b64 v16, v[100:101] offset:32
    ds_write_b64 v16, v[102:103] offset:48
    ds_write_b64 v16, v[104:105] offset:64
    ds_write_b64 v16, v[106:107] offset:80
    ds_write_b64 v16, v[108:109] offset:96
    ds_write_b64 v16, v[110:111] offset:112
    v_lshrrev_b32 v18, 3, v1
    v_and_b32 v19, 7, v1
    v_mul_u32_u24 v20, 144, v18
    v_lshl_add_u32 v20, v19, 4, v20
    v_add_u32 v20, v20, v17
    v_lshlrev_b32 v21, 11, v18
    v_lshl_add_u32 v21, v19, 4, v21
    s_lshl_b32 s3, s48, 16
    s_lshl_b32 s55, s7, 7
    s_add_u32 s3, s3, s55
    s_waitcnt lgkmcnt(0)
    ds_read_b128 v[32:35], v20 offset:0
    ds_read_b128 v[36:39], v20 offset:1152
    ds_read_b128 v[40:43], v20 offset:2304
    ds_read_b128 v[44:47], v20 offset:3456
    s_waitcnt lgkmcnt(3)
    buffer_store_dwordx4 v[32:35], v21, s[28:31], s3 offen sc1
    s_add_u32 s3, s3, 16384
    s_waitcnt lgkmcnt(2)
    buffer_store_dwordx4 v[36:39], v21, s[28:31], s3 offen sc1
    s_add_u32 s3, s3, 16384
    s_waitcnt lgkmcnt(1)
    buffer_store_dwordx4 v[40:43], v21, s[28:31], s3 offen sc1
    s_add_u32 s3, s3, 16384
    s_waitcnt lgkmcnt(0)
    buffer_store_dwordx4 v[44:47], v21, s[28:31], s3 offen sc1
    s_add_u32 s3, s3, 16384
    s_branch k_exit
c_prep:
    s_mov_b32 s28, s32
    s_mov_b32 s29, s33
    s_mov_b32 s30, 4194304
    s_mov_b32 s31, 0x00020000
    s_lshl_b32 s48, s6, 2
    s_add_u32 s48, s48, s8
    v_lshrrev_b32 v16, 3, v1
    v_and_b32 v17, 7, v1
    v_lshlrev_b32 v18, 11, v16
    v_lshl_add_u32 v18, v17, 4, v18
    s_lshl_b32 s55, s48, 16
    s_lshl_b32 s56, s7, 7
    s_add_u32 s3, s55, s56
    buffer_load_dwordx4 v[32:35], v18, s[28:31], s3 offen
    s_add_u32 s3, s3, 16384
    buffer_load_dwordx4 v[36:39], v18, s[28:31], s3 offen
    s_add_u32 s3, s3, 16384
    buffer_load_dwordx4 v[40:43], v18, s[28:31], s3 offen
    s_add_u32 s3, s3, 16384
    buffer_load_dwordx4 v[44:47], v18, s[28:31], s3 offen
    s_add_u32 s3, s3, 16384
    s_barrier
    s_lshl_b32 s56, s7, 12
    s_add_u32 s58, s55, s56
    v_lshlrev_b32 v5, 4, v1
    s_lshl_b32 s3, s8, 12
    s_add_u32 s3, s3, 131072
    v_lshrrev_b32 v18, 1, v17
    v_lshlrev_b32 v18, 10, v18
    v_lshl_add_u32 v18, v16, 4, v18
    v_and_b32 v17, 1, v17
    v_lshl_add_u32 v18, v17, 3, v18
    v_add_u32 v18, s3, v18
    v_add_u32 v19, s3, v5
    s_waitcnt vmcnt(3)
    ds_write_b64 v18, v[32:33] offset:0
    ds_write_b64 v18, v[34:35] offset:512
    s_waitcnt vmcnt(2)
    ds_write_b64 v18, v[36:37] offset:128
    ds_write_b64 v18, v[38:39] offset:640
    s_waitcnt vmcnt(1)
    ds_write_b64 v18, v[40:41] offset:256
    ds_write_b64 v18, v[42:43] offset:768
    s_waitcnt vmcnt(0)
    ds_write_b64 v18, v[44:45] offset:384
    ds_write_b64 v18, v[46:47] offset:896
    s_waitcnt lgkmcnt(0)
    ds_read_b128 v[96:99], v19 offset:0
    ds_read_b128 v[100:103], v19 offset:1024
    ds_read_b128 v[104:107], v19 offset:2048
    ds_read_b128 v[108:111], v19 offset:3072
    s_waitcnt lgkmcnt(3)
    buffer_store_dwordx4 v[96:99], v5, s[12:15], s58 offen offset:0 sc1
    s_waitcnt lgkmcnt(2)
    buffer_store_dwordx4 v[100:103], v5, s[12:15], s58 offen offset:1024 sc1
    s_waitcnt lgkmcnt(1)
    buffer_store_dwordx4 v[104:107], v5, s[12:15], s58 offen offset:2048 sc1
    s_waitcnt lgkmcnt(0)
    buffer_store_dwordx4 v[108:111], v5, s[12:15], s58 offen offset:3072 sc1
    s_branch c_wo_stat
.p2align 6
c_qkvb:
    v_and_b32 v1, 63, v0
    v_lshrrev_b32 v2, 6, v0
    v_lshlrev_b32 v5, 4, v1
    v_lshrrev_b32 v3, 5, v1
    v_and_b32 v4, 15, v0
    v_bfe_u32 v7, v1, 4, 1
    v_lshl_add_u32 v6, v7, 5, v4
    v_lshlrev_b32 v6, 4, v6
    v_lshl_add_u32 v6, v3, 10, v6
    s_lshr_b32 s48, s6, 1
    s_lshl_b32 s48, s48, 2
    s_add_u32 s48, s48, s8
    s_lshl_b32 s55, s48, 17
    s_lshl_b32 s56, s9, 22
    s_add_u32 s55, s55, s56
    s_add_u32 s16, s4, s55
    s_addc_u32 s17, s5, 0
    s_mov_b32 s18, 65536
    s_mov_b32 s19, 0x00020000
    s_add_u32 s55, s55, 65536
    s_add_u32 s20, s4, s55
    s_addc_u32 s21, s5, 0
    s_mov_b32 s22, 65536
    s_mov_b32 s23, 0x00020000
    s_movk_i32 s54, 4096
    v_lshrrev_b32 v8, 2, v4
    v_lshl_add_u32 v8, v7, 2, v8
    v_lshl_add_u32 v8, v3, 4, v8
    v_lshlrev_b32 v8, 6, v8
    v_and_b32 v9, 3, v4
    v_lshl_add_u32 v8, v9, 3, v8
    v_lshl_add_u32 v26, v7, 5, v8
    v_xor_b32 v27, 32, v26
    v_mov_b32 v24, v26
    v_mov_b32 v25, v27
    v_mov_b32 v32, 0
    v_mov_b32 v33, 0
    v_mov_b32 v34, 0
    v_mov_b32 v35, 0
    v_mov_b32 v36, 0
    v_mov_b32 v37, 0
    v_mov_b32 v38, 0
    v_mov_b32 v39, 0
    v_mov_b32 v40, 0
    v_mov_b32 v41, 0
    v_mov_b32 v42, 0
    v_mov_b32 v43, 0
    v_mov_b32 v44, 0
    v_mov_b32 v45, 0
    v_mov_b32 v46, 0
    v_mov_b32 v47, 0
    v_mov_b32 v48, 0
    v_mov_b32 v49, 0
    v_mov_b32 v50, 0
    v_mov_b32 v51, 0
    v_mov_b32 v52, 0
    v_mov_b32 v53, 0
    v_mov_b32 v54, 0
    v_mov_b32 v55, 0
    v_mov_b32 v56, 0
    v_mov_b32 v57, 0
    v_mov_b32 v58, 0
    v_mov_b32 v59, 0
    v_mov_b32 v60, 0
    v_mov_b32 v61, 0
    v_mov_b32 v62, 0
    v_mov_b32 v63, 0
    v_mov_b32 v64, 0
    v_mov_b32 v65, 0
    v_mov_b32 v66, 0
    v_mov_b32 v67, 0
    v_mov_b32 v68, 0
    v_mov_b32 v69, 0
    v_mov_b32 v70, 0
    v_mov_b32 v71, 0
    v_mov_b32 v72, 0
    v_mov_b32 v73, 0
    v_mov_b32 v74, 0
    v_mov_b32 v75, 0
    v_mov_b32 v76, 0
    v_mov_b32 v77, 0
    v_mov_b32 v78, 0
    v_mov_b32 v79, 0
    v_mov_b32 v80, 0
    v_mov_b32 v81, 0
    v_mov_b32 v82, 0
    v_mov_b32 v83, 0
    v_mov_b32 v84, 0
    v_mov_b32 v85, 0
    v_mov_b32 v86, 0
    v_mov_b32 v87, 0
    v_mov_b32 v88, 0
    v_mov_b32 v89, 0
    v_mov_b32 v90, 0
    v_mov_b32 v91, 0
    v_mov_b32 v92, 0
    v_mov_b32 v93, 0
    v_mov_b32 v94, 0
    v_mov_b32 v95, 0
    v_mov_b32 v96, 0
    v_mov_b32 v97, 0
    v_mov_b32 v98, 0
    v_mov_b32 v99, 0
    v_mov_b32 v100, 0
    v_mov_b32 v101, 0
    v_mov_b32 v102, 0
    v_mov_b32 v103, 0
    v_mov_b32 v104, 0
    v_mov_b32 v105, 0
    v_mov_b32 v106, 0
    v_mov_b32 v107, 0
    v_mov_b32 v108, 0
    v_mov_b32 v109, 0
    v_mov_b32 v110, 0
    v_mov_b32 v111, 0
    v_mov_b32 v112, 0
    v_mov_b32 v113, 0
    v_mov_b32 v114, 0
    v_mov_b32 v115, 0
    v_mov_b32 v116, 0
    v_mov_b32 v117, 0
    v_mov_b32 v118, 0
    v_mov_b32 v119, 0
    v_mov_b32 v120, 0
    v_mov_b32 v121, 0
    v_mov_b32 v122, 0
    v_mov_b32 v123, 0
    v_mov_b32 v124, 0
    v_mov_b32 v125, 0
    v_mov_b32 v126, 0
    v_mov_b32 v127, 0
    s_mov_b32 s50, 6144
    s_mov_b32 s51, 10240
    s_mov_b32 s52, 0
    s_barrier
    buffer_load_dwordx4 a[0:3], v6, s[16:19], 0 offen offset:0 sc1
    buffer_load_dwordx4 a[4:7], v6, s[16:19], 0 offen offset:256 sc1
    buffer_load_dwordx4 a[8:11], v6, s[20:23], 0 offen offset:0 sc1
    buffer_load_dwordx4 a[12:15], v6, s[20:23], 0 offen offset:256 sc1
    ds_read_b64_tr_b16 v[128:129], v24 offset:0
    ds_read_b64_tr_b16 v[130:131], v24 offset:512
    ds_read_b64_tr_b16 v[132:133], v25 offset:0
    ds_read_b64_tr_b16 v[134:135], v25 offset:512
    ds_read_b64_tr_b16 v[136:137], v24 offset:8192
    ds_read_b64_tr_b16 v[138:139], v24 offset:8704
    ds_read_b64_tr_b16 v[140:141], v25 offset:8192
    ds_read_b64_tr_b16 v[142:143], v25 offset:8704
    ds_read_b64_tr_b16 v[144:145], v24 offset:16384
    ds_read_b64_tr_b16 v[146:147], v24 offset:16896
    buffer_load_dwordx4 a[16:19], v6, s[16:19], 0 offen offset:2048 sc1
    buffer_load_dwordx4 a[20:23], v6, s[16:19], 0 offen offset:2304 sc1
    buffer_load_dwordx4 a[24:27], v6, s[20:23], 0 offen offset:2048 sc1
    buffer_load_dwordx4 a[28:31], v6, s[20:23], 0 offen offset:2304 sc1
    buffer_load_dwordx4 v[152:155], v6, s[16:19], s54 offen offset:0 sc1
    buffer_load_dwordx4 v[156:159], v6, s[16:19], s54 offen offset:256 sc1
    buffer_load_dwordx4 v[160:163], v6, s[20:23], s54 offen offset:0 sc1
    buffer_load_dwordx4 v[164:167], v6, s[20:23], s54 offen offset:256 sc1
    s_mov_b32 s54, 8
.p2align 3
c_qkvb_loop:
    s_waitcnt vmcnt(8) lgkmcnt(8)
    v_mfma_f32_16x16x32_bf16 v[32:35], v[128:131], a[0:3], v[32:35]
    ds_read_b64_tr_b16 v[148:149], v25 offset:16384
    v_mfma_f32_16x16x32_bf16 v[36:39], v[128:131], a[4:7], v[36:39]
    ds_read_b64_tr_b16 v[150:151], v25 offset:16896
    v_mfma_f32_16x16x32_bf16 v[40:43], v[128:131], a[8:11], v[40:43]
    v_mfma_f32_16x16x32_bf16 v[44:47], v[128:131], a[12:15], v[44:47]
    s_waitcnt lgkmcnt(8)
    v_mfma_f32_16x16x32_bf16 v[48:51], v[132:135], a[0:3], v[48:51]
    ds_read_b64_tr_b16 v[128:129], v24 offset:2048
    v_mfma_f32_16x16x32_bf16 v[52:55], v[132:135], a[4:7], v[52:55]
    ds_read_b64_tr_b16 v[130:131], v24 offset:2560
    v_mfma_f32_16x16x32_bf16 v[56:59], v[132:135], a[8:11], v[56:59]
    buffer_load_dwordx4 v[168:171], v6, s[16:19], s50 offen offset:0 sc1
    v_mfma_f32_16x16x32_bf16 v[60:63], v[132:135], a[12:15], v[60:63]
    s_waitcnt lgkmcnt(8)
    v_mfma_f32_16x16x32_bf16 v[64:67], v[136:139], a[0:3], v[64:67]
    ds_read_b64_tr_b16 v[132:133], v25 offset:2048
    v_mfma_f32_16x16x32_bf16 v[68:71], v[136:139], a[4:7], v[68:71]
    ds_read_b64_tr_b16 v[134:135], v25 offset:2560
    v_mfma_f32_16x16x32_bf16 v[72:75], v[136:139], a[8:11], v[72:75]
    buffer_load_dwordx4 v[172:175], v6, s[16:19], s50 offen offset:256 sc1
    v_mfma_f32_16x16x32_bf16 v[76:79], v[136:139], a[12:15], v[76:79]
    s_waitcnt lgkmcnt(8)
    v_mfma_f32_16x16x32_bf16 v[80:83], v[140:143], a[0:3], v[80:83]
    ds_read_b64_tr_b16 v[136:137], v24 offset:10240
    v_mfma_f32_16x16x32_bf16 v[84:87], v[140:143], a[4:7], v[84:87]
    ds_read_b64_tr_b16 v[138:139], v24 offset:10752
    v_mfma_f32_16x16x32_bf16 v[88:91], v[140:143], a[8:11], v[88:91]
    buffer_load_dwordx4 v[176:179], v6, s[20:23], s50 offen offset:0 sc1
    v_mfma_f32_16x16x32_bf16 v[92:95], v[140:143], a[12:15], v[92:95]
    s_waitcnt lgkmcnt(8)
    v_mfma_f32_16x16x32_bf16 v[96:99], a[0:3], v[144:147], v[96:99]
    ds_read_b64_tr_b16 v[140:141], v25 offset:10240
    v_mfma_f32_16x16x32_bf16 v[100:103], a[4:7], v[144:147], v[100:103]
    ds_read_b64_tr_b16 v[142:143], v25 offset:10752
    v_mfma_f32_16x16x32_bf16 v[104:107], a[8:11], v[144:147], v[104:107]
    buffer_load_dwordx4 v[180:183], v6, s[20:23], s50 offen offset:256 sc1
    v_mfma_f32_16x16x32_bf16 v[108:111], a[12:15], v[144:147], v[108:111]
    s_waitcnt lgkmcnt(8)
    v_mfma_f32_16x16x32_bf16 v[112:115], a[0:3], v[148:151], v[112:115]
    ds_read_b64_tr_b16 v[144:145], v24 offset:18432
    v_mfma_f32_16x16x32_bf16 v[116:119], a[4:7], v[148:151], v[116:119]
    ds_read_b64_tr_b16 v[146:147], v24 offset:18944
    v_mfma_f32_16x16x32_bf16 v[120:123], a[8:11], v[148:151], v[120:123]
    v_mfma_f32_16x16x32_bf16 v[124:127], a[12:15], v[148:151], v[124:127]
    s_waitcnt vmcnt(8) lgkmcnt(8)
    v_mfma_f32_16x16x32_bf16 v[32:35], v[128:131], a[16:19], v[32:35]
    ds_read_b64_tr_b16 v[148:149], v25 offset:18432
    v_mfma_f32_16x16x32_bf16 v[36:39], v[128:131], a[20:23], v[36:39]
    ds_read_b64_tr_b16 v[150:151], v25 offset:18944
    v_mfma_f32_16x16x32_bf16 v[40:43], v[128:131], a[24:27], v[40:43]
    v_mfma_f32_16x16x32_bf16 v[44:47], v[128:131], a[28:31], v[44:47]
    s_waitcnt lgkmcnt(8)
    v_mfma_f32_16x16x32_bf16 v[48:51], v[132:135], a[16:19], v[48:51]
    ds_read_b64_tr_b16 v[128:129], v24 offset:4096
    v_mfma_f32_16x16x32_bf16 v[52:55], v[132:135], a[20:23], v[52:55]
    ds_read_b64_tr_b16 v[130:131], v24 offset:4608
    v_mfma_f32_16x16x32_bf16 v[56:59], v[132:135], a[24:27], v[56:59]
    buffer_load_dwordx4 a[0:3], v6, s[16:19], s50 offen offset:2048 sc1
    v_mfma_f32_16x16x32_bf16 v[60:63], v[132:135], a[28:31], v[60:63]
    s_waitcnt lgkmcnt(8)
    v_mfma_f32_16x16x32_bf16 v[64:67], v[136:139], a[16:19], v[64:67]
    ds_read_b64_tr_b16 v[132:133], v25 offset:4096
    v_mfma_f32_16x16x32_bf16 v[68:71], v[136:139], a[20:23], v[68:71]
    ds_read_b64_tr_b16 v[134:135], v25 offset:4608
    v_mfma_f32_16x16x32_bf16 v[72:75], v[136:139], a[24:27], v[72:75]
    buffer_load_dwordx4 a[4:7], v6, s[16:19], s50 offen offset:2304 sc1
    v_mfma_f32_16x16x32_bf16 v[76:79], v[136:139], a[28:31], v[76:79]
    s_waitcnt lgkmcnt(8)
    v_mfma_f32_16x16x32_bf16 v[80:83], v[140:143], a[16:19], v[80:83]
    ds_read_b64_tr_b16 v[136:137], v24 offset:12288
    v_mfma_f32_16x16x32_bf16 v[84:87], v[140:143], a[20:23], v[84:87]
    ds_read_b64_tr_b16 v[138:139], v24 offset:12800
    v_mfma_f32_16x16x32_bf16 v[88:91], v[140:143], a[24:27], v[88:91]
    buffer_load_dwordx4 a[8:11], v6, s[20:23], s50 offen offset:2048 sc1
    v_mfma_f32_16x16x32_bf16 v[92:95], v[140:143], a[28:31], v[92:95]
    s_waitcnt lgkmcnt(8)
    v_mfma_f32_16x16x32_bf16 v[96:99], a[16:19], v[144:147], v[96:99]
    ds_read_b64_tr_b16 v[140:141], v25 offset:12288
    v_mfma_f32_16x16x32_bf16 v[100:103], a[20:23], v[144:147], v[100:103]
    ds_read_b64_tr_b16 v[142:143], v25 offset:12800
    v_mfma_f32_16x16x32_bf16 v[104:107], a[24:27], v[144:147], v[104:107]
    buffer_load_dwordx4 a[12:15], v6, s[20:23], s50 offen offset:2304 sc1
    v_mfma_f32_16x16x32_bf16 v[108:111], a[28:31], v[144:147], v[108:111]
    s_waitcnt lgkmcnt(8)
    v_mfma_f32_16x16x32_bf16 v[112:115], a[16:19], v[148:151], v[112:115]
    ds_read_b64_tr_b16 v[144:145], v24 offset:20480
    v_mfma_f32_16x16x32_bf16 v[116:119], a[20:23], v[148:151], v[116:119]
    ds_read_b64_tr_b16 v[146:147], v24 offset:20992
    v_mfma_f32_16x16x32_bf16 v[120:123], a[24:27], v[148:151], v[120:123]
    v_mfma_f32_16x16x32_bf16 v[124:127], a[28:31], v[148:151], v[124:127]
    s_waitcnt vmcnt(8) lgkmcnt(8)
    v_mfma_f32_16x16x32_bf16 v[32:35], v[128:131], v[152:155], v[32:35]
    ds_read_b64_tr_b16 v[148:149], v25 offset:20480
    v_mfma_f32_16x16x32_bf16 v[36:39], v[128:131], v[156:159], v[36:39]
    ds_read_b64_tr_b16 v[150:151], v25 offset:20992
    v_mfma_f32_16x16x32_bf16 v[40:43], v[128:131], v[160:163], v[40:43]
    v_mfma_f32_16x16x32_bf16 v[44:47], v[128:131], v[164:167], v[44:47]
    s_waitcnt lgkmcnt(8)
    v_mfma_f32_16x16x32_bf16 v[48:51], v[132:135], v[152:155], v[48:51]
    ds_read_b64_tr_b16 v[128:129], v24 offset:6144
    v_mfma_f32_16x16x32_bf16 v[52:55], v[132:135], v[156:159], v[52:55]
    ds_read_b64_tr_b16 v[130:131], v24 offset:6656
    v_mfma_f32_16x16x32_bf16 v[56:59], v[132:135], v[160:163], v[56:59]
    buffer_load_dwordx4 a[16:19], v6, s[16:19], s51 offen offset:0 sc1
    v_mfma_f32_16x16x32_bf16 v[60:63], v[132:135], v[164:167], v[60:63]
    s_waitcnt lgkmcnt(8)
    v_mfma_f32_16x16x32_bf16 v[64:67], v[136:139], v[152:155], v[64:67]
    ds_read_b64_tr_b16 v[132:133], v25 offset:6144
    v_mfma_f32_16x16x32_bf16 v[68:71], v[136:139], v[156:159], v[68:71]
    ds_read_b64_tr_b16 v[134:135], v25 offset:6656
    v_mfma_f32_16x16x32_bf16 v[72:75], v[136:139], v[160:163], v[72:75]
    buffer_load_dwordx4 a[20:23], v6, s[16:19], s51 offen offset:256 sc1
    v_mfma_f32_16x16x32_bf16 v[76:79], v[136:139], v[164:167], v[76:79]
    s_waitcnt lgkmcnt(8)
    v_mfma_f32_16x16x32_bf16 v[80:83], v[140:143], v[152:155], v[80:83]
    ds_read_b64_tr_b16 v[136:137], v24 offset:14336
    v_mfma_f32_16x16x32_bf16 v[84:87], v[140:143], v[156:159], v[84:87]
    ds_read_b64_tr_b16 v[138:139], v24 offset:14848
    v_mfma_f32_16x16x32_bf16 v[88:91], v[140:143], v[160:163], v[88:91]
    buffer_load_dwordx4 a[24:27], v6, s[20:23], s51 offen offset:0 sc1
    v_mfma_f32_16x16x32_bf16 v[92:95], v[140:143], v[164:167], v[92:95]
    s_waitcnt lgkmcnt(8)
    v_mfma_f32_16x16x32_bf16 v[96:99], v[152:155], v[144:147], v[96:99]
    ds_read_b64_tr_b16 v[140:141], v25 offset:14336
    v_mfma_f32_16x16x32_bf16 v[100:103], v[156:159], v[144:147], v[100:103]
    ds_read_b64_tr_b16 v[142:143], v25 offset:14848
    v_mfma_f32_16x16x32_bf16 v[104:107], v[160:163], v[144:147], v[104:107]
    buffer_load_dwordx4 a[28:31], v6, s[20:23], s51 offen offset:256 sc1
    v_mfma_f32_16x16x32_bf16 v[108:111], v[164:167], v[144:147], v[108:111]
    s_waitcnt lgkmcnt(8)
    v_mfma_f32_16x16x32_bf16 v[112:115], v[152:155], v[148:151], v[112:115]
    ds_read_b64_tr_b16 v[144:145], v24 offset:22528
    v_mfma_f32_16x16x32_bf16 v[116:119], v[156:159], v[148:151], v[116:119]
    ds_read_b64_tr_b16 v[146:147], v24 offset:23040
    v_mfma_f32_16x16x32_bf16 v[120:123], v[160:163], v[148:151], v[120:123]
    v_mfma_f32_16x16x32_bf16 v[124:127], v[164:167], v[148:151], v[124:127]
    s_waitcnt vmcnt(8) lgkmcnt(8)
    v_mfma_f32_16x16x32_bf16 v[32:35], v[128:131], v[168:171], v[32:35]
    ds_read_b64_tr_b16 v[148:149], v25 offset:22528
    v_mfma_f32_16x16x32_bf16 v[36:39], v[128:131], v[172:175], v[36:39]
    ds_read_b64_tr_b16 v[150:151], v25 offset:23040
    s_add_u32 s52, s52, 24576
    s_cmp_eq_u32 s52, 147456
    v_mfma_f32_16x16x32_bf16 v[40:43], v[128:131], v[176:179], v[40:43]
    s_cselect_b32 s52, 0, s52
    s_barrier
    v_mfma_f32_16x16x32_bf16 v[44:47], v[128:131], v[180:183], v[44:47]
    v_add_u32 v24, s52, v26
    v_add_u32 v25, s52, v27
    s_waitcnt lgkmcnt(8)
    v_mfma_f32_16x16x32_bf16 v[48:51], v[132:135], v[168:171], v[48:51]
    ds_read_b64_tr_b16 v[128:129], v24 offset:0
    v_mfma_f32_16x16x32_bf16 v[52:55], v[132:135], v[172:175], v[52:55]
    ds_read_b64_tr_b16 v[130:131], v24 offset:512
    v_mfma_f32_16x16x32_bf16 v[56:59], v[132:135], v[176:179], v[56:59]
    buffer_load_dwordx4 v[152:155], v6, s[16:19], s51 offen offset:2048 sc1
    v_mfma_f32_16x16x32_bf16 v[60:63], v[132:135], v[180:183], v[60:63]
    s_waitcnt lgkmcnt(8)
    v_mfma_f32_16x16x32_bf16 v[64:67], v[136:139], v[168:171], v[64:67]
    ds_read_b64_tr_b16 v[132:133], v25 offset:0
    v_mfma_f32_16x16x32_bf16 v[68:71], v[136:139], v[172:175], v[68:71]
    ds_read_b64_tr_b16 v[134:135], v25 offset:512
    v_mfma_f32_16x16x32_bf16 v[72:75], v[136:139], v[176:179], v[72:75]
    buffer_load_dwordx4 v[156:159], v6, s[16:19], s51 offen offset:2304 sc1
    v_mfma_f32_16x16x32_bf16 v[76:79], v[136:139], v[180:183], v[76:79]
    s_waitcnt lgkmcnt(8)
    v_mfma_f32_16x16x32_bf16 v[80:83], v[140:143], v[168:171], v[80:83]
    ds_read_b64_tr_b16 v[136:137], v24 offset:8192
    v_mfma_f32_16x16x32_bf16 v[84:87], v[140:143], v[172:175], v[84:87]
    ds_read_b64_tr_b16 v[138:139], v24 offset:8704
    v_mfma_f32_16x16x32_bf16 v[88:91], v[140:143], v[176:179], v[88:91]
    buffer_load_dwordx4 v[160:163], v6, s[20:23], s51 offen offset:2048 sc1
    v_mfma_f32_16x16x32_bf16 v[92:95], v[140:143], v[180:183], v[92:95]
    s_waitcnt lgkmcnt(8)
    v_mfma_f32_16x16x32_bf16 v[96:99], v[168:171], v[144:147], v[96:99]
    ds_read_b64_tr_b16 v[140:141], v25 offset:8192
    v_mfma_f32_16x16x32_bf16 v[100:103], v[172:175], v[144:147], v[100:103]
    ds_read_b64_tr_b16 v[142:143], v25 offset:8704
    v_mfma_f32_16x16x32_bf16 v[104:107], v[176:179], v[144:147], v[104:107]
    buffer_load_dwordx4 v[164:167], v6, s[20:23], s51 offen offset:2304 sc1
    v_mfma_f32_16x16x32_bf16 v[108:111], v[180:183], v[144:147], v[108:111]
    s_waitcnt lgkmcnt(8)
    v_mfma_f32_16x16x32_bf16 v[112:115], v[168:171], v[148:151], v[112:115]
    ds_read_b64_tr_b16 v[144:145], v24 offset:16384
    s_add_u32 s50, s50, 8192
    v_mfma_f32_16x16x32_bf16 v[116:119], v[172:175], v[148:151], v[116:119]
    ds_read_b64_tr_b16 v[146:147], v24 offset:16896
    s_add_u32 s51, s51, 8192
    v_mfma_f32_16x16x32_bf16 v[120:123], v[176:179], v[148:151], v[120:123]
    s_sub_u32 s54, s54, 1
    v_mfma_f32_16x16x32_bf16 v[124:127], v[180:183], v[148:151], v[124:127]
    s_cmp_lg_u32 s54, 0
    s_cbranch_scc1 c_qkvb_loop
    v_and_b32 v8, 0x30, v1
    v_add_u32 v8, 155648, v8
    v_lshlrev_b32 v9, 2, v4
    v_add_u32 v9, 155648, v9
    v_lshl_add_u32 v12, v2, 8, v9
    v_lshl_add_u32 v13, v2, 8, v8
    ds_read_b32 v200, v12 offset:1280
    ds_read_b32 v208, v12 offset:2304
    ds_read_b32 v202, v12 offset:1344
    ds_read_b32 v210, v12 offset:2368
    ds_read_b32 v204, v12 offset:1408
    ds_read_b32 v212, v12 offset:2432
    ds_read_b32 v206, v12 offset:1472
    ds_read_b32 v214, v12 offset:2496
    ds_read_b128 v[192:195], v8 offset:896
    ds_read_b128 v[196:199], v8 offset:960
    ds_read_b128 v[184:187], v8 offset:768
    ds_read_b128 v[188:191], v8 offset:832
    ds_read_b32 v216, v9 offset:1024
    ds_read_b32 v218, v9 offset:1088
    s_lshr_b32 s3, s8, 1
    s_lshl_b32 s3, s3, 14
    s_and_b32 s55, s8, 1
    s_lshl_b32 s55, s55, 12
    s_add_u32 s3, s3, s55
    s_add_u32 s3, s3, 81920
    v_lshl_add_u32 v10, v3, 5, v4
    v_lshlrev_b32 v10, 4, v10
    v_lshl_add_u32 v10, v7, 10, v10
    v_add_u32 v10, s3, v10
    v_add_u32 v11, s3, v5
    s_waitcnt vmcnt(0) lgkmcnt(4)
    ds_read_b128 v[128:131], v13 offset:1280
    ds_read_b128 v[144:147], v13 offset:2304
    ds_read_b128 v[132:135], v13 offset:1344
    ds_read_b128 v[148:151], v13 offset:2368
    ds_read_b128 v[136:139], v13 offset:1408
    ds_read_b128 v[152:155], v13 offset:2432
    ds_read_b128 v[140:143], v13 offset:1472
    ds_read_b128 v[156:159], v13 offset:2496
    v_pk_fma_f32 v[64:65], v[200:201], v[192:193], v[64:65] op_sel_hi:[0,1,1] neg_lo:[1,0,0] neg_hi:[1,0,0]
    v_pk_fma_f32 v[66:67], v[200:201], v[194:195], v[66:67] op_sel_hi:[0,1,1] neg_lo:[1,0,0] neg_hi:[1,0,0]
    v_pk_mul_f32 v[64:65], v[208:209], v[64:65] op_sel_hi:[0,1]
    v_pk_mul_f32 v[66:67], v[208:209], v[66:67] op_sel_hi:[0,1]
    v_pk_fma_f32 v[80:81], v[200:201], v[196:197], v[80:81] op_sel_hi:[0,1,1] neg_lo:[1,0,0] neg_hi:[1,0,0]
    v_pk_fma_f32 v[82:83], v[200:201], v[198:199], v[82:83] op_sel_hi:[0,1,1] neg_lo:[1,0,0] neg_hi:[1,0,0]
    v_pk_mul_f32 v[80:81], v[208:209], v[80:81] op_sel_hi:[0,1]
    v_pk_mul_f32 v[82:83], v[208:209], v[82:83] op_sel_hi:[0,1]
    v_cvt_pk_bf16_f32 v64, v64, v65
    v_cvt_pk_bf16_f32 v65, v66, v67
    v_cvt_pk_bf16_f32 v66, v80, v81
    v_cvt_pk_bf16_f32 v67, v82, v83
    ds_write_b128 v10, v[64:67] offset:0
    v_pk_fma_f32 v[68:69], v[202:203], v[192:193], v[68:69] op_sel_hi:[0,1,1] neg_lo:[1,0,0] neg_hi:[1,0,0]
    v_pk_fma_f32 v[70:71], v[202:203], v[194:195], v[70:71] op_sel_hi:[0,1,1] neg_lo:[1,0,0] neg_hi:[1,0,0]
    v_pk_mul_f32 v[68:69], v[210:211], v[68:69] op_sel_hi:[0,1]
    v_pk_mul_f32 v[70:71], v[210:211], v[70:71] op_sel_hi:[0,1]
    v_pk_fma_f32 v[84:85], v[202:203], v[196:197], v[84:85] op_sel_hi:[0,1,1] neg_lo:[1,0,0] neg_hi:[1,0,0]
    v_pk_fma_f32 v[86:87], v[202:203], v[198:199], v[86:87] op_sel_hi:[0,1,1] neg_lo:[1,0,0] neg_hi:[1,0,0]
    v_pk_mul_f32 v[84:85], v[210:211], v[84:85] op_sel_hi:[0,1]
    v_pk_mul_f32 v[86:87], v[210:211], v[86:87] op_sel_hi:[0,1]
    v_cvt_pk_bf16_f32 v68, v68, v69
    v_cvt_pk_bf16_f32 v69, v70, v71
    v_cvt_pk_bf16_f32 v70, v84, v85
    v_cvt_pk_bf16_f32 v71, v86, v87
    ds_write_b128 v10, v[68:71] offset:256
    v_pk_fma_f32 v[72:73], v[204:205], v[192:193], v[72:73] op_sel_hi:[0,1,1] neg_lo:[1,0,0] neg_hi:[1,0,0]
    v_pk_fma_f32 v[74:75], v[204:205], v[194:195], v[74:75] op_sel_hi:[0,1,1] neg_lo:[1,0,0] neg_hi:[1,0,0]
    v_pk_mul_f32 v[72:73], v[212:213], v[72:73] op_sel_hi:[0,1]
    v_pk_mul_f32 v[74:75], v[212:213], v[74:75] op_sel_hi:[0,1]
    v_pk_fma_f32 v[88:89], v[204:205], v[196:197], v[88:89] op_sel_hi:[0,1,1] neg_lo:[1,0,0] neg_hi:[1,0,0]
    v_pk_fma_f32 v[90:91], v[204:205], v[198:199], v[90:91] op_sel_hi:[0,1,1] neg_lo:[1,0,0] neg_hi:[1,0,0]
    v_pk_mul_f32 v[88:89], v[212:213], v[88:89] op_sel_hi:[0,1]
    v_pk_mul_f32 v[90:91], v[212:213], v[90:91] op_sel_hi:[0,1]
    v_cvt_pk_bf16_f32 v72, v72, v73
    v_cvt_pk_bf16_f32 v73, v74, v75
    v_cvt_pk_bf16_f32 v74, v88, v89
    v_cvt_pk_bf16_f32 v75, v90, v91
    ds_write_b128 v10, v[72:75] offset:2048
    v_pk_fma_f32 v[76:77], v[206:207], v[192:193], v[76:77] op_sel_hi:[0,1,1] neg_lo:[1,0,0] neg_hi:[1,0,0]
    v_pk_fma_f32 v[78:79], v[206:207], v[194:195], v[78:79] op_sel_hi:[0,1,1] neg_lo:[1,0,0] neg_hi:[1,0,0]
    v_pk_mul_f32 v[76:77], v[214:215], v[76:77] op_sel_hi:[0,1]
    v_pk_mul_f32 v[78:79], v[214:215], v[78:79] op_sel_hi:[0,1]
    v_pk_fma_f32 v[92:93], v[206:207], v[196:197], v[92:93] op_sel_hi:[0,1,1] neg_lo:[1,0,0] neg_hi:[1,0,0]
    v_pk_fma_f32 v[94:95], v[206:207], v[198:199], v[94:95] op_sel_hi:[0,1,1] neg_lo:[1,0,0] neg_hi:[1,0,0]
    v_pk_mul_f32 v[92:93], v[214:215], v[92:93] op_sel_hi:[0,1]
    v_pk_mul_f32 v[94:95], v[214:215], v[94:95] op_sel_hi:[0,1]
    v_cvt_pk_bf16_f32 v76, v76, v77
    v_cvt_pk_bf16_f32 v77, v78, v79
    v_cvt_pk_bf16_f32 v78, v92, v93
    v_cvt_pk_bf16_f32 v79, v94, v95
    ds_write_b128 v10, v[76:79] offset:2304
    s_waitcnt lgkmcnt(4)
    v_pk_fma_f32 v[96:97], v[128:129], v[216:217], v[96:97] op_sel_hi:[1,0,1] neg_lo:[1,0,0] neg_hi:[1,0,0]
    v_pk_fma_f32 v[98:99], v[130:131], v[216:217], v[98:99] op_sel_hi:[1,0,1] neg_lo:[1,0,0] neg_hi:[1,0,0]
    v_pk_mul_f32 v[96:97], v[144:145], v[96:97]
    v_pk_mul_f32 v[98:99], v[146:147], v[98:99]
    v_pk_fma_f32 v[112:113], v[128:129], v[218:219], v[112:113] op_sel_hi:[1,0,1] neg_lo:[1,0,0] neg_hi:[1,0,0]
    v_pk_fma_f32 v[114:115], v[130:131], v[218:219], v[114:115] op_sel_hi:[1,0,1] neg_lo:[1,0,0] neg_hi:[1,0,0]
    v_pk_mul_f32 v[112:113], v[144:145], v[112:113]
    v_pk_mul_f32 v[114:115], v[146:147], v[114:115]
    v_cvt_pk_bf16_f32 v96, v96, v97
    v_cvt_pk_bf16_f32 v97, v98, v99
    v_cvt_pk_bf16_f32 v98, v112, v113
    v_cvt_pk_bf16_f32 v99, v114, v115
    s_nop 0
    v_permlane16_swap_b32 v96, v98
    v_permlane16_swap_b32 v97, v99
    ds_write_b128 v11, v[96:99] offset:8192
    v_pk_fma_f32 v[100:101], v[132:133], v[216:217], v[100:101] op_sel_hi:[1,0,1] neg_lo:[1,0,0] neg_hi:[1,0,0]
    v_pk_fma_f32 v[102:103], v[134:135], v[216:217], v[102:103] op_sel_hi:[1,0,1] neg_lo:[1,0,0] neg_hi:[1,0,0]
    v_pk_mul_f32 v[100:101], v[148:149], v[100:101]
    v_pk_mul_f32 v[102:103], v[150:151], v[102:103]
    v_pk_fma_f32 v[116:117], v[132:133], v[218:219], v[116:117] op_sel_hi:[1,0,1] neg_lo:[1,0,0] neg_hi:[1,0,0]
    v_pk_fma_f32 v[118:119], v[134:135], v[218:219], v[118:119] op_sel_hi:[1,0,1] neg_lo:[1,0,0] neg_hi:[1,0,0]
    v_pk_mul_f32 v[116:117], v[148:149], v[116:117]
    v_pk_mul_f32 v[118:119], v[150:151], v[118:119]
    v_cvt_pk_bf16_f32 v100, v100, v101
    v_cvt_pk_bf16_f32 v101, v102, v103
    v_cvt_pk_bf16_f32 v102, v116, v117
    v_cvt_pk_bf16_f32 v103, v118, v119
    s_nop 0
    v_permlane16_swap_b32 v100, v102
    v_permlane16_swap_b32 v101, v103
    ds_write_b128 v11, v[100:103] offset:9216
    v_pk_fma_f32 v[104:105], v[136:137], v[216:217], v[104:105] op_sel_hi:[1,0,1] neg_lo:[1,0,0] neg_hi:[1,0,0]
    v_pk_fma_f32 v[106:107], v[138:139], v[216:217], v[106:107] op_sel_hi:[1,0,1] neg_lo:[1,0,0] neg_hi:[1,0,0]
    v_pk_mul_f32 v[104:105], v[152:153], v[104:105]
    v_pk_mul_f32 v[106:107], v[154:155], v[106:107]
    v_pk_fma_f32 v[120:121], v[136:137], v[218:219], v[120:121] op_sel_hi:[1,0,1] neg_lo:[1,0,0] neg_hi:[1,0,0]
    v_pk_fma_f32 v[122:123], v[138:139], v[218:219], v[122:123] op_sel_hi:[1,0,1] neg_lo:[1,0,0] neg_hi:[1,0,0]
    v_pk_mul_f32 v[120:121], v[152:153], v[120:121]
    v_pk_mul_f32 v[122:123], v[154:155], v[122:123]
    v_cvt_pk_bf16_f32 v104, v104, v105
    v_cvt_pk_bf16_f32 v105, v106, v107
    v_cvt_pk_bf16_f32 v106, v120, v121
    v_cvt_pk_bf16_f32 v107, v122, v123
    s_nop 0
    v_permlane16_swap_b32 v104, v106
    v_permlane16_swap_b32 v105, v107
    ds_write_b128 v11, v[104:107] offset:10240
    v_pk_fma_f32 v[108:109], v[140:141], v[216:217], v[108:109] op_sel_hi:[1,0,1] neg_lo:[1,0,0] neg_hi:[1,0,0]
    v_pk_fma_f32 v[110:111], v[142:143], v[216:217], v[110:111] op_sel_hi:[1,0,1] neg_lo:[1,0,0] neg_hi:[1,0,0]
    v_pk_mul_f32 v[108:109], v[156:157], v[108:109]
    v_pk_mul_f32 v[110:111], v[158:159], v[110:111]
    v_pk_fma_f32 v[124:125], v[140:141], v[218:219], v[124:125] op_sel_hi:[1,0,1] neg_lo:[1,0,0] neg_hi:[1,0,0]
    v_pk_fma_f32 v[126:127], v[142:143], v[218:219], v[126:127] op_sel_hi:[1,0,1] neg_lo:[1,0,0] neg_hi:[1,0,0]
    v_pk_mul_f32 v[124:125], v[156:157], v[124:125]
    v_pk_mul_f32 v[126:127], v[158:159], v[126:127]
    v_cvt_pk_bf16_f32 v108, v108, v109
    v_cvt_pk_bf16_f32 v109, v110, v111
    v_cvt_pk_bf16_f32 v110, v124, v125
    v_cvt_pk_bf16_f32 v111, v126, v127
    s_nop 0
    v_permlane16_swap_b32 v108, v110
    v_permlane16_swap_b32 v109, v111
    ds_write_b128 v11, v[108:111] offset:11264
    v_mul_f32 v208, 0x3e8293ee, v208
    v_mul_f32 v210, 0x3e8293ee, v210
    v_mul_f32 v212, 0x3e8293ee, v212
    v_mul_f32 v214, 0x3e8293ee, v214
    s_waitcnt lgkmcnt(0)
    s_barrier
    v_add_u32 v24, 81920, v5
    ds_read_b128 v[128:131], v24 offset:0
    ds_read_b128 v[132:135], v24 offset:1024
    ds_read_b128 v[136:139], v24 offset:2048
    ds_read_b128 v[140:143], v24 offset:3072
    v_pk_fma_f32 v[32:33], v[200:201], v[184:185], v[32:33] op_sel_hi:[0,1,1] neg_lo:[1,0,0] neg_hi:[1,0,0]
    v_pk_fma_f32 v[34:35], v[200:201], v[186:187], v[34:35] op_sel_hi:[0,1,1] neg_lo:[1,0,0] neg_hi:[1,0,0]
    v_pk_mul_f32 v[32:33], v[208:209], v[32:33] op_sel_hi:[0,1]
    v_pk_mul_f32 v[34:35], v[208:209], v[34:35] op_sel_hi:[0,1]
    v_pk_fma_f32 v[48:49], v[200:201], v[188:189], v[48:49] op_sel_hi:[0,1,1] neg_lo:[1,0,0] neg_hi:[1,0,0]
    v_pk_fma_f32 v[50:51], v[200:201], v[190:191], v[50:51] op_sel_hi:[0,1,1] neg_lo:[1,0,0] neg_hi:[1,0,0]
    v_pk_mul_f32 v[48:49], v[208:209], v[48:49] op_sel_hi:[0,1]
    v_pk_mul_f32 v[50:51], v[208:209], v[50:51] op_sel_hi:[0,1]
    v_cvt_pk_bf16_f32 v8, v32, v33
    v_cvt_pk_bf16_f32 v9, v34, v35
    v_cvt_pk_bf16_f32 v10, v48, v49
    v_cvt_pk_bf16_f32 v11, v50, v51
    v_pk_fma_f32 v[36:37], v[202:203], v[184:185], v[36:37] op_sel_hi:[0,1,1] neg_lo:[1,0,0] neg_hi:[1,0,0]
    v_pk_fma_f32 v[38:39], v[202:203], v[186:187], v[38:39] op_sel_hi:[0,1,1] neg_lo:[1,0,0] neg_hi:[1,0,0]
    v_pk_mul_f32 v[36:37], v[210:211], v[36:37] op_sel_hi:[0,1]
    v_pk_mul_f32 v[38:39], v[210:211], v[38:39] op_sel_hi:[0,1]
    v_pk_fma_f32 v[52:53], v[202:203], v[188:189], v[52:53] op_sel_hi:[0,1,1] neg_lo:[1,0,0] neg_hi:[1,0,0]
    v_pk_fma_f32 v[54:55], v[202:203], v[190:191], v[54:55] op_sel_hi:[0,1,1] neg_lo:[1,0,0] neg_hi:[1,0,0]
    v_pk_mul_f32 v[52:53], v[210:211], v[52:53] op_sel_hi:[0,1]
    v_pk_mul_f32 v[54:55], v[210:211], v[54:55] op_sel_hi:[0,1]
    v_cvt_pk_bf16_f32 v12, v36, v37
    v_cvt_pk_bf16_f32 v13, v38, v39
    v_cvt_pk_bf16_f32 v14, v52, v53
    v_cvt_pk_bf16_f32 v15, v54, v55
    v_pk_fma_f32 v[40:41], v[204:205], v[184:185], v[40:41] op_sel_hi:[0,1,1] neg_lo:[1,0,0] neg_hi:[1,0,0]
    v_pk_fma_f32 v[42:43], v[204:205], v[186:187], v[42:43] op_sel_hi:[0,1,1] neg_lo:[1,0,0] neg_hi:[1,0,0]
    v_pk_mul_f32 v[40:41], v[212:213], v[40:41] op_sel_hi:[0,1]
    v_pk_mul_f32 v[42:43], v[212:213], v[42:43] op_sel_hi:[0,1]
    v_pk_fma_f32 v[56:57], v[204:205], v[188:189], v[56:57] op_sel_hi:[0,1,1] neg_lo:[1,0,0] neg_hi:[1,0,0]
    v_pk_fma_f32 v[58:59], v[204:205], v[190:191], v[58:59] op_sel_hi:[0,1,1] neg_lo:[1,0,0] neg_hi:[1,0,0]
    v_pk_mul_f32 v[56:57], v[212:213], v[56:57] op_sel_hi:[0,1]
    v_pk_mul_f32 v[58:59], v[212:213], v[58:59] op_sel_hi:[0,1]
    v_cvt_pk_bf16_f32 v16, v40, v41
    v_cvt_pk_bf16_f32 v17, v42, v43
    v_cvt_pk_bf16_f32 v18, v56, v57
    v_cvt_pk_bf16_f32 v19, v58, v59
    v_pk_fma_f32 v[44:45], v[206:207], v[184:185], v[44:45] op_sel_hi:[0,1,1] neg_lo:[1,0,0] neg_hi:[1,0,0]
    v_pk_fma_f32 v[46:47], v[206:207], v[186:187], v[46:47] op_sel_hi:[0,1,1] neg_lo:[1,0,0] neg_hi:[1,0,0]
    v_pk_mul_f32 v[44:45], v[214:215], v[44:45] op_sel_hi:[0,1]
    v_pk_mul_f32 v[46:47], v[214:215], v[46:47] op_sel_hi:[0,1]
    v_pk_fma_f32 v[60:61], v[206:207], v[188:189], v[60:61] op_sel_hi:[0,1,1] neg_lo:[1,0,0] neg_hi:[1,0,0]
    v_pk_fma_f32 v[62:63], v[206:207], v[190:191], v[62:63] op_sel_hi:[0,1,1] neg_lo:[1,0,0] neg_hi:[1,0,0]
    v_pk_mul_f32 v[60:61], v[214:215], v[60:61] op_sel_hi:[0,1]
    v_pk_mul_f32 v[62:63], v[214:215], v[62:63] op_sel_hi:[0,1]
    v_cvt_pk_bf16_f32 v20, v44, v45
    v_cvt_pk_bf16_f32 v21, v46, v47
    v_cvt_pk_bf16_f32 v22, v60, v61
    v_cvt_pk_bf16_f32 v23, v62, v63
    v_permlane16_swap_b32 v8, v12
    v_permlane16_swap_b32 v9, v13
    v_permlane16_swap_b32 v10, v14
    v_permlane16_swap_b32 v11, v15
    v_permlane16_swap_b32 v16, v20
    v_permlane16_swap_b32 v17, v21
    v_permlane16_swap_b32 v18, v22
    v_permlane16_swap_b32 v19, v23
    s_waitcnt lgkmcnt(0)
    v_mfma_f32_32x32x16_bf16 v[64:79], v[128:131], v[8:11], 0
    v_mfma_f32_32x32x16_bf16 v[64:79], v[132:135], v[12:15], v[64:79]
    v_and_b32 v28, 7, v1
    v_mov_b32 v29, 0x3f803f80
    v_cmp_eq_u32 vcc, 0, v28
    s_nop 1
    v_cndmask_b32 v200, 0, v29, vcc
    v_cndmask_b32 v201, 0, v29, vcc
    v_cmp_eq_u32 vcc, 4, v28
    s_nop 1
    v_cndmask_b32 v202, 0, v29, vcc
    v_cndmask_b32 v203, 0, v29, vcc
    v_mov_b32 v204, 0xdddddddd
    v_mov_b32 v160, 0
    v_mov_b32 v161, 0
    v_mov_b32 v162, 0
    v_mov_b32 v163, 0
    v_mov_b32 v164, 0
    v_mov_b32 v165, 0
    v_mov_b32 v166, 0
    v_mov_b32 v167, 0
    v_mov_b32 v168, 0
    v_mov_b32 v169, 0
    v_mov_b32 v170, 0
    v_mov_b32 v171, 0
    v_mov_b32 v172, 0
    v_mov_b32 v173, 0
    v_mov_b32 v174, 0
    v_mov_b32 v175, 0
    v_mov_b32 v192, 0
    v_mov_b32 v193, 0
    v_mov_b32 v194, 0
    v_mov_b32 v195, 0
    v_mov_b32 v176, 0
    v_mov_b32 v177, 0
    v_mov_b32 v178, 0
    v_mov_b32 v179, 0
    v_mov_b32 v180, 0
    v_mov_b32 v181, 0
    v_mov_b32 v182, 0
    v_mov_b32 v183, 0
    v_mov_b32 v184, 0
    v_mov_b32 v185, 0
    v_mov_b32 v186, 0
    v_mov_b32 v187, 0
    v_mov_b32 v188, 0
    v_mov_b32 v189, 0
    v_mov_b32 v190, 0
    v_mov_b32 v191, 0
    v_mov_b32 v196, 0
    v_mov_b32 v197, 0
    v_mov_b32 v198, 0
    v_mov_b32 v199, 0
    v_mov_b32 v112, 0
    v_mov_b32 v113, 0
    v_mov_b32 v114, 0
    v_mov_b32 v115, 0
    v_mov_b32 v116, 0
    v_mov_b32 v117, 0
    v_mov_b32 v118, 0
    v_mov_b32 v119, 0
    v_mov_b32 v120, 0
    v_mov_b32 v121, 0
    v_mov_b32 v122, 0
    v_mov_b32 v123, 0
    v_mov_b32 v124, 0
    v_mov_b32 v125, 0
    v_mov_b32 v126, 0
    v_mov_b32 v127, 0
    v_mov_b32 v152, 0
    v_mov_b32 v153, 0
    v_mov_b32 v154, 0
    v_mov_b32 v155, 0
    v_mov_b32 v156, 0
    v_mov_b32 v157, 0
    v_mov_b32 v158, 0
    v_mov_b32 v159, 0
    s_mov_b32 s54, 4
.p2align 3
c_attn_loop:
    v_mfma_f32_32x32x16_bf16 v[80:95], v[128:131], v[16:19], 0
    v_exp_f32 v64, v64
    v_exp_f32 v65, v65
    v_exp_f32 v66, v66
    v_mfma_f32_32x32x16_bf16 v[80:95], v[132:135], v[20:23], v[80:95]
    v_exp_f32 v67, v67
    v_exp_f32 v68, v68
    v_exp_f32 v69, v69
    v_smfmac_f32_32x32x32_bf16 v[176:191], v[152:155], v[112:119], v204
    s_waitcnt lgkmcnt(0)
    v_exp_f32 v70, v70
    v_exp_f32 v71, v71
    v_exp_f32 v72, v72
    v_smfmac_f32_16x16x64_bf16 v[196:199], v[200:203], v[112:119], v204
    ds_read_b128 v[144:147], v24 offset:8192
    v_exp_f32 v73, v73
    v_exp_f32 v74, v74
    v_smfmac_f32_32x32x32_bf16 v[176:191], v[156:159], v[120:127], v204
    v_exp_f32 v75, v75
    v_exp_f32 v76, v76
    v_exp_f32 v77, v77
    v_smfmac_f32_16x16x64_bf16 v[196:199], v[200:203], v[120:127], v204
    ds_read_b128 v[148:151], v24 offset:9216
    v_exp_f32 v78, v78
    v_exp_f32 v79, v79
    v_mfma_f32_32x32x16_bf16 v[96:111], v[136:139], v[8:11], 0
    v_exp_f32 v80, v80
    v_exp_f32 v81, v81
    v_exp_f32 v82, v82
    v_mfma_f32_32x32x16_bf16 v[96:111], v[140:143], v[12:15], v[96:111]
    s_waitcnt lgkmcnt(1)
    v_exp_f32 v83, v83
    v_exp_f32 v84, v84
    v_exp_f32 v85, v85
    v_smfmac_f32_32x32x32_bf16 v[160:175], v[144:147], v[64:71], v204
    s_waitcnt lgkmcnt(0)
    v_exp_f32 v86, v86
    v_exp_f32 v87, v87
    v_exp_f32 v88, v88
    v_smfmac_f32_16x16x64_bf16 v[192:195], v[200:203], v[64:71], v204
    ds_read_b128 v[128:131], v24 offset:4096
    v_exp_f32 v89, v89
    v_exp_f32 v90, v90
    v_smfmac_f32_32x32x32_bf16 v[160:175], v[148:151], v[72:79], v204
    v_exp_f32 v91, v91
    v_exp_f32 v92, v92
    v_exp_f32 v93, v93
    v_smfmac_f32_16x16x64_bf16 v[192:195], v[200:203], v[72:79], v204
    ds_read_b128 v[132:135], v24 offset:5120
    v_exp_f32 v94, v94
    v_exp_f32 v95, v95
    v_mfma_f32_32x32x16_bf16 v[112:127], v[136:139], v[16:19], 0
    v_exp_f32 v96, v96
    v_exp_f32 v97, v97
    v_exp_f32 v98, v98
    v_mfma_f32_32x32x16_bf16 v[112:127], v[140:143], v[20:23], v[112:127]
    v_exp_f32 v99, v99
    v_exp_f32 v100, v100
    v_exp_f32 v101, v101
    v_smfmac_f32_32x32x32_bf16 v[176:191], v[144:147], v[80:87], v204
    s_waitcnt lgkmcnt(0)
    v_exp_f32 v102, v102
    v_exp_f32 v103, v103
    v_exp_f32 v104, v104
    v_smfmac_f32_16x16x64_bf16 v[196:199], v[200:203], v[80:87], v204
    ds_read_b128 v[152:155], v24 offset:10240
    v_exp_f32 v105, v105
    v_exp_f32 v106, v106
    v_smfmac_f32_32x32x32_bf16 v[176:191], v[148:151], v[88:95], v204
    v_exp_f32 v107, v107
    v_exp_f32 v108, v108
    v_exp_f32 v109, v109
    v_smfmac_f32_16x16x64_bf16 v[196:199], v[200:203], v[88:95], v204
    ds_read_b128 v[156:159], v24 offset:11264
    v_exp_f32 v110, v110
    v_exp_f32 v111, v111
    v_mfma_f32_32x32x16_bf16 v[64:79], v[128:131], v[8:11], 0
    v_exp_f32 v112, v112
    v_exp_f32 v113, v113
    v_exp_f32 v114, v114
    v_mfma_f32_32x32x16_bf16 v[64:79], v[132:135], v[12:15], v[64:79]
    s_waitcnt lgkmcnt(1)
    v_exp_f32 v115, v115
    v_exp_f32 v116, v116
    v_exp_f32 v117, v117
    v_smfmac_f32_32x32x32_bf16 v[160:175], v[152:155], v[96:103], v204
    s_waitcnt lgkmcnt(0)
    v_exp_f32 v118, v118
    v_exp_f32 v119, v119
    v_exp_f32 v120, v120
    v_smfmac_f32_16x16x64_bf16 v[192:195], v[200:203], v[96:103], v204
    ds_read_b128 v[136:139], v24 offset:6144
    v_exp_f32 v121, v121
    v_exp_f32 v122, v122
    v_smfmac_f32_32x32x32_bf16 v[160:175], v[156:159], v[104:111], v204
    v_exp_f32 v123, v123
    v_exp_f32 v124, v124
    v_exp_f32 v125, v125
    v_smfmac_f32_16x16x64_bf16 v[192:195], v[200:203], v[104:111], v204
    ds_read_b128 v[140:143], v24 offset:7168
    v_exp_f32 v126, v126
    v_exp_f32 v127, v127
    v_mfma_f32_32x32x16_bf16 v[80:95], v[128:131], v[16:19], 0
    s_cmp_eq_u32 s54, 4
    v_exp_f32 v64, v64
    v_exp_f32 v65, v65
    v_exp_f32 v66, v66
    v_mfma_f32_32x32x16_bf16 v[80:95], v[132:135], v[20:23], v[80:95]
    v_exp_f32 v67, v67
    v_exp_f32 v68, v68
    v_exp_f32 v69, v69
    v_smfmac_f32_32x32x32_bf16 v[176:191], v[152:155], v[112:119], v204
    s_waitcnt lgkmcnt(0)
    v_exp_f32 v70, v70
    v_exp_f32 v71, v71
    v_exp_f32 v72, v72
    v_smfmac_f32_16x16x64_bf16 v[196:199], v[200:203], v[112:119], v204
    ds_read_b128 v[144:147], v24 offset:12288
    v_exp_f32 v73, v73
    v_exp_f32 v74, v74
    v_smfmac_f32_32x32x32_bf16 v[176:191], v[156:159], v[120:127], v204
    v_exp_f32 v75, v75
    v_exp_f32 v76, v76
    v_exp_f32 v77, v77
    v_smfmac_f32_16x16x64_bf16 v[196:199], v[200:203], v[120:127], v204
    ds_read_b128 v[148:151], v24 offset:13312
    v_exp_f32 v78, v78
    v_exp_f32 v79, v79
    v_mfma_f32_32x32x16_bf16 v[96:111], v[136:139], v[8:11], 0
    s_cbranch_scc1 c_attn_nobar
    s_barrier
c_attn_nobar:
    v_exp_f32 v80, v80
    v_exp_f32 v81, v81
    v_exp_f32 v82, v82
    v_mfma_f32_32x32x16_bf16 v[96:111], v[140:143], v[12:15], v[96:111]
    s_waitcnt lgkmcnt(1)
    v_exp_f32 v83, v83
    v_exp_f32 v84, v84
    v_exp_f32 v85, v85
    v_smfmac_f32_32x32x32_bf16 v[160:175], v[144:147], v[64:71], v204
    s_waitcnt lgkmcnt(0)
    v_exp_f32 v86, v86
    v_exp_f32 v87, v87
    v_exp_f32 v88, v88
    v_smfmac_f32_16x16x64_bf16 v[192:195], v[200:203], v[64:71], v204
    ds_read_b128 v[128:131], v24 offset:16384
    v_exp_f32 v89, v89
    v_exp_f32 v90, v90
    v_smfmac_f32_32x32x32_bf16 v[160:175], v[148:151], v[72:79], v204
    v_exp_f32 v91, v91
    v_exp_f32 v92, v92
    v_exp_f32 v93, v93
    v_smfmac_f32_16x16x64_bf16 v[192:195], v[200:203], v[72:79], v204
    ds_read_b128 v[132:135], v24 offset:17408
    v_exp_f32 v94, v94
    v_exp_f32 v95, v95
    v_mfma_f32_32x32x16_bf16 v[112:127], v[136:139], v[16:19], 0
    v_exp_f32 v96, v96
    v_exp_f32 v97, v97
    v_exp_f32 v98, v98
    v_mfma_f32_32x32x16_bf16 v[112:127], v[140:143], v[20:23], v[112:127]
    v_exp_f32 v99, v99
    v_exp_f32 v100, v100
    v_exp_f32 v101, v101
    v_smfmac_f32_32x32x32_bf16 v[176:191], v[144:147], v[80:87], v204
    s_waitcnt lgkmcnt(0)
    v_exp_f32 v102, v102
    v_exp_f32 v103, v103
    v_exp_f32 v104, v104
    v_smfmac_f32_16x16x64_bf16 v[196:199], v[200:203], v[80:87], v204
    ds_read_b128 v[152:155], v24 offset:14336
    v_exp_f32 v105, v105
    v_exp_f32 v106, v106
    v_smfmac_f32_32x32x32_bf16 v[176:191], v[148:151], v[88:95], v204
    v_exp_f32 v107, v107
    v_exp_f32 v108, v108
    v_exp_f32 v109, v109
    v_smfmac_f32_16x16x64_bf16 v[196:199], v[200:203], v[88:95], v204
    ds_read_b128 v[156:159], v24 offset:15360
    v_exp_f32 v110, v110
    v_exp_f32 v111, v111
    v_mfma_f32_32x32x16_bf16 v[64:79], v[128:131], v[8:11], 0
    v_exp_f32 v112, v112
    v_exp_f32 v113, v113
    v_exp_f32 v114, v114
    v_mfma_f32_32x32x16_bf16 v[64:79], v[132:135], v[12:15], v[64:79]
    s_waitcnt lgkmcnt(1)
    v_exp_f32 v115, v115
    v_exp_f32 v116, v116
    v_exp_f32 v117, v117
    v_smfmac_f32_32x32x32_bf16 v[160:175], v[152:155], v[96:103], v204
    s_waitcnt lgkmcnt(0)
    v_exp_f32 v118, v118
    v_exp_f32 v119, v119
    v_exp_f32 v120, v120
    v_smfmac_f32_16x16x64_bf16 v[192:195], v[200:203], v[96:103], v204
    ds_read_b128 v[136:139], v24 offset:18432
    v_exp_f32 v121, v121
    v_exp_f32 v122, v122
    v_smfmac_f32_32x32x32_bf16 v[160:175], v[156:159], v[104:111], v204
    v_exp_f32 v123, v123
    v_exp_f32 v124, v124
    v_exp_f32 v125, v125
    v_smfmac_f32_16x16x64_bf16 v[192:195], v[200:203], v[104:111], v204
    ds_read_b128 v[140:143], v24 offset:19456
    v_exp_f32 v126, v126
    v_exp_f32 v127, v127
    v_mfma_f32_32x32x16_bf16 v[80:95], v[128:131], v[16:19], 0
    v_exp_f32 v64, v64
    v_exp_f32 v65, v65
    v_exp_f32 v66, v66
    v_mfma_f32_32x32x16_bf16 v[80:95], v[132:135], v[20:23], v[80:95]
    v_exp_f32 v67, v67
    v_exp_f32 v68, v68
    v_exp_f32 v69, v69
    v_smfmac_f32_32x32x32_bf16 v[176:191], v[152:155], v[112:119], v204
    s_waitcnt lgkmcnt(0)
    v_exp_f32 v70, v70
    v_exp_f32 v71, v71
    v_exp_f32 v72, v72
    v_smfmac_f32_16x16x64_bf16 v[196:199], v[200:203], v[112:119], v204
    ds_read_b128 v[144:147], v24 offset:24576
    v_exp_f32 v73, v73
    v_exp_f32 v74, v74
    v_smfmac_f32_32x32x32_bf16 v[176:191], v[156:159], v[120:127], v204
    v_exp_f32 v75, v75
    v_exp_f32 v76, v76
    v_exp_f32 v77, v77
    v_smfmac_f32_16x16x64_bf16 v[196:199], v[200:203], v[120:127], v204
    ds_read_b128 v[148:151], v24 offset:25600
    v_exp_f32 v78, v78
    v_exp_f32 v79, v79
    v_mfma_f32_32x32x16_bf16 v[96:111], v[136:139], v[8:11], 0
    v_exp_f32 v80, v80
    v_exp_f32 v81, v81
    v_exp_f32 v82, v82
    v_mfma_f32_32x32x16_bf16 v[96:111], v[140:143], v[12:15], v[96:111]
    s_waitcnt lgkmcnt(1)
    v_exp_f32 v83, v83
    v_exp_f32 v84, v84
    v_exp_f32 v85, v85
    v_smfmac_f32_32x32x32_bf16 v[160:175], v[144:147], v[64:71], v204
    s_waitcnt lgkmcnt(0)
    v_exp_f32 v86, v86
    v_exp_f32 v87, v87
    v_exp_f32 v88, v88
    v_smfmac_f32_16x16x64_bf16 v[192:195], v[200:203], v[64:71], v204
    ds_read_b128 v[128:131], v24 offset:20480
    v_exp_f32 v89, v89
    v_exp_f32 v90, v90
    v_smfmac_f32_32x32x32_bf16 v[160:175], v[148:151], v[72:79], v204
    v_exp_f32 v91, v91
    v_exp_f32 v92, v92
    v_exp_f32 v93, v93
    v_smfmac_f32_16x16x64_bf16 v[192:195], v[200:203], v[72:79], v204
    ds_read_b128 v[132:135], v24 offset:21504
    v_exp_f32 v94, v94
    v_exp_f32 v95, v95
    v_mfma_f32_32x32x16_bf16 v[112:127], v[136:139], v[16:19], 0
    v_exp_f32 v96, v96
    v_exp_f32 v97, v97
    v_exp_f32 v98, v98
    v_mfma_f32_32x32x16_bf16 v[112:127], v[140:143], v[20:23], v[112:127]
    v_exp_f32 v99, v99
    v_exp_f32 v100, v100
    v_exp_f32 v101, v101
    v_smfmac_f32_32x32x32_bf16 v[176:191], v[144:147], v[80:87], v204
    s_waitcnt lgkmcnt(0)
    v_exp_f32 v102, v102
    v_exp_f32 v103, v103
    v_exp_f32 v104, v104
    v_smfmac_f32_16x16x64_bf16 v[196:199], v[200:203], v[80:87], v204
    ds_read_b128 v[152:155], v24 offset:26624
    v_exp_f32 v105, v105
    v_exp_f32 v106, v106
    v_smfmac_f32_32x32x32_bf16 v[176:191], v[148:151], v[88:95], v204
    v_exp_f32 v107, v107
    v_exp_f32 v108, v108
    v_exp_f32 v109, v109
    v_smfmac_f32_16x16x64_bf16 v[196:199], v[200:203], v[88:95], v204
    ds_read_b128 v[156:159], v24 offset:27648
    v_exp_f32 v110, v110
    v_exp_f32 v111, v111
    v_mfma_f32_32x32x16_bf16 v[64:79], v[128:131], v[8:11], 0
    v_exp_f32 v112, v112
    v_exp_f32 v113, v113
    v_exp_f32 v114, v114
    v_mfma_f32_32x32x16_bf16 v[64:79], v[132:135], v[12:15], v[64:79]
    s_waitcnt lgkmcnt(1)
    v_exp_f32 v115, v115
    v_exp_f32 v116, v116
    v_exp_f32 v117, v117
    v_smfmac_f32_32x32x32_bf16 v[160:175], v[152:155], v[96:103], v204
    s_waitcnt lgkmcnt(0)
    v_exp_f32 v118, v118
    v_exp_f32 v119, v119
    v_exp_f32 v120, v120
    v_smfmac_f32_16x16x64_bf16 v[192:195], v[200:203], v[96:103], v204
    ds_read_b128 v[136:139], v24 offset:22528
    v_exp_f32 v121, v121
    v_exp_f32 v122, v122
    v_smfmac_f32_32x32x32_bf16 v[160:175], v[156:159], v[104:111], v204
    v_exp_f32 v123, v123
    v_exp_f32 v124, v124
    v_exp_f32 v125, v125
    v_smfmac_f32_16x16x64_bf16 v[192:195], v[200:203], v[104:111], v204
    ds_read_b128 v[140:143], v24 offset:23552
    v_exp_f32 v126, v126
    v_exp_f32 v127, v127
    v_mfma_f32_32x32x16_bf16 v[80:95], v[128:131], v[16:19], 0
    v_exp_f32 v64, v64
    v_exp_f32 v65, v65
    v_exp_f32 v66, v66
    v_mfma_f32_32x32x16_bf16 v[80:95], v[132:135], v[20:23], v[80:95]
    v_exp_f32 v67, v67
    v_exp_f32 v68, v68
    v_exp_f32 v69, v69
    v_smfmac_f32_32x32x32_bf16 v[176:191], v[152:155], v[112:119], v204
    s_waitcnt lgkmcnt(0)
    v_exp_f32 v70, v70
    v_exp_f32 v71, v71
    v_exp_f32 v72, v72
    v_smfmac_f32_16x16x64_bf16 v[196:199], v[200:203], v[112:119], v204
    ds_read_b128 v[144:147], v24 offset:28672
    v_exp_f32 v73, v73
    v_exp_f32 v74, v74
    v_smfmac_f32_32x32x32_bf16 v[176:191], v[156:159], v[120:127], v204
    v_exp_f32 v75, v75
    v_exp_f32 v76, v76
    v_exp_f32 v77, v77
    v_smfmac_f32_16x16x64_bf16 v[196:199], v[200:203], v[120:127], v204
    ds_read_b128 v[148:151], v24 offset:29696
    v_exp_f32 v78, v78
    v_exp_f32 v79, v79
    v_mfma_f32_32x32x16_bf16 v[96:111], v[136:139], v[8:11], 0
    s_barrier
    v_exp_f32 v80, v80
    v_exp_f32 v81, v81
    v_exp_f32 v82, v82
    v_mfma_f32_32x32x16_bf16 v[96:111], v[140:143], v[12:15], v[96:111]
    s_waitcnt lgkmcnt(1)
    v_exp_f32 v83, v83
    v_exp_f32 v84, v84
    v_exp_f32 v85, v85
    v_smfmac_f32_32x32x32_bf16 v[160:175], v[144:147], v[64:71], v204
    s_waitcnt lgkmcnt(0)
    v_exp_f32 v86, v86
    v_exp_f32 v87, v87
    v_exp_f32 v88, v88
    v_smfmac_f32_16x16x64_bf16 v[192:195], v[200:203], v[64:71], v204
    ds_read_b128 v[128:131], v24 offset:32768
    v_exp_f32 v89, v89
    v_exp_f32 v90, v90
    v_smfmac_f32_32x32x32_bf16 v[160:175], v[148:151], v[72:79], v204
    v_exp_f32 v91, v91
    v_exp_f32 v92, v92
    v_exp_f32 v93, v93
    v_smfmac_f32_16x16x64_bf16 v[192:195], v[200:203], v[72:79], v204
    ds_read_b128 v[132:135], v24 offset:33792
    v_exp_f32 v94, v94
    v_exp_f32 v95, v95
    v_mfma_f32_32x32x16_bf16 v[112:127], v[136:139], v[16:19], 0
    v_exp_f32 v96, v96
    v_exp_f32 v97, v97
    v_exp_f32 v98, v98
    v_mfma_f32_32x32x16_bf16 v[112:127], v[140:143], v[20:23], v[112:127]
    v_exp_f32 v99, v99
    v_exp_f32 v100, v100
    v_exp_f32 v101, v101
    v_smfmac_f32_32x32x32_bf16 v[176:191], v[144:147], v[80:87], v204
    s_waitcnt lgkmcnt(0)
    v_exp_f32 v102, v102
    v_exp_f32 v103, v103
    v_exp_f32 v104, v104
    v_smfmac_f32_16x16x64_bf16 v[196:199], v[200:203], v[80:87], v204
    ds_read_b128 v[152:155], v24 offset:30720
    v_exp_f32 v105, v105
    v_exp_f32 v106, v106
    v_smfmac_f32_32x32x32_bf16 v[176:191], v[148:151], v[88:95], v204
    v_exp_f32 v107, v107
    v_exp_f32 v108, v108
    v_exp_f32 v109, v109
    v_smfmac_f32_16x16x64_bf16 v[196:199], v[200:203], v[88:95], v204
    ds_read_b128 v[156:159], v24 offset:31744
    v_exp_f32 v110, v110
    v_exp_f32 v111, v111
    v_mfma_f32_32x32x16_bf16 v[64:79], v[128:131], v[8:11], 0
    v_exp_f32 v112, v112
    v_exp_f32 v113, v113
    v_exp_f32 v114, v114
    v_mfma_f32_32x32x16_bf16 v[64:79], v[132:135], v[12:15], v[64:79]
    s_waitcnt lgkmcnt(1)
    v_exp_f32 v115, v115
    v_exp_f32 v116, v116
    v_exp_f32 v117, v117
    v_smfmac_f32_32x32x32_bf16 v[160:175], v[152:155], v[96:103], v204
    s_waitcnt lgkmcnt(0)
    v_exp_f32 v118, v118
    v_exp_f32 v119, v119
    v_exp_f32 v120, v120
    v_smfmac_f32_16x16x64_bf16 v[192:195], v[200:203], v[96:103], v204
    ds_read_b128 v[136:139], v24 offset:34816
    v_exp_f32 v121, v121
    v_exp_f32 v122, v122
    v_smfmac_f32_32x32x32_bf16 v[160:175], v[156:159], v[104:111], v204
    v_exp_f32 v123, v123
    v_exp_f32 v124, v124
    v_exp_f32 v125, v125
    v_smfmac_f32_16x16x64_bf16 v[192:195], v[200:203], v[104:111], v204
    ds_read_b128 v[140:143], v24 offset:35840
    v_exp_f32 v126, v126
    v_exp_f32 v127, v127
    v_mfma_f32_32x32x16_bf16 v[80:95], v[128:131], v[16:19], 0
    v_exp_f32 v64, v64
    v_exp_f32 v65, v65
    v_exp_f32 v66, v66
    v_mfma_f32_32x32x16_bf16 v[80:95], v[132:135], v[20:23], v[80:95]
    v_exp_f32 v67, v67
    v_exp_f32 v68, v68
    v_exp_f32 v69, v69
    v_smfmac_f32_32x32x32_bf16 v[176:191], v[152:155], v[112:119], v204
    s_waitcnt lgkmcnt(0)
    v_exp_f32 v70, v70
    v_exp_f32 v71, v71
    v_exp_f32 v72, v72
    v_smfmac_f32_16x16x64_bf16 v[196:199], v[200:203], v[112:119], v204
    ds_read_b128 v[144:147], v24 offset:40960
    v_exp_f32 v73, v73
    v_exp_f32 v74, v74
    v_smfmac_f32_32x32x32_bf16 v[176:191], v[156:159], v[120:127], v204
    v_exp_f32 v75, v75
    v_exp_f32 v76, v76
    v_exp_f32 v77, v77
    v_smfmac_f32_16x16x64_bf16 v[196:199], v[200:203], v[120:127], v204
    ds_read_b128 v[148:151], v24 offset:41984
    v_exp_f32 v78, v78
    v_exp_f32 v79, v79
    v_mfma_f32_32x32x16_bf16 v[96:111], v[136:139], v[8:11], 0
    v_exp_f32 v80, v80
    v_exp_f32 v81, v81
    v_exp_f32 v82, v82
    v_mfma_f32_32x32x16_bf16 v[96:111], v[140:143], v[12:15], v[96:111]
    s_waitcnt lgkmcnt(1)
    v_exp_f32 v83, v83
    v_exp_f32 v84, v84
    v_exp_f32 v85, v85
    v_smfmac_f32_32x32x32_bf16 v[160:175], v[144:147], v[64:71], v204
    s_waitcnt lgkmcnt(0)
    v_exp_f32 v86, v86
    v_exp_f32 v87, v87
    v_exp_f32 v88, v88
    v_smfmac_f32_16x16x64_bf16 v[192:195], v[200:203], v[64:71], v204
    ds_read_b128 v[128:131], v24 offset:36864
    v_exp_f32 v89, v89
    v_exp_f32 v90, v90
    v_smfmac_f32_32x32x32_bf16 v[160:175], v[148:151], v[72:79], v204
    v_exp_f32 v91, v91
    v_exp_f32 v92, v92
    v_exp_f32 v93, v93
    v_smfmac_f32_16x16x64_bf16 v[192:195], v[200:203], v[72:79], v204
    ds_read_b128 v[132:135], v24 offset:37888
    v_exp_f32 v94, v94
    v_exp_f32 v95, v95
    v_mfma_f32_32x32x16_bf16 v[112:127], v[136:139], v[16:19], 0
    v_exp_f32 v96, v96
    v_exp_f32 v97, v97
    v_exp_f32 v98, v98
    v_mfma_f32_32x32x16_bf16 v[112:127], v[140:143], v[20:23], v[112:127]
    v_exp_f32 v99, v99
    v_exp_f32 v100, v100
    v_exp_f32 v101, v101
    v_smfmac_f32_32x32x32_bf16 v[176:191], v[144:147], v[80:87], v204
    s_waitcnt lgkmcnt(0)
    v_exp_f32 v102, v102
    v_exp_f32 v103, v103
    v_exp_f32 v104, v104
    v_smfmac_f32_16x16x64_bf16 v[196:199], v[200:203], v[80:87], v204
    ds_read_b128 v[152:155], v24 offset:43008
    v_exp_f32 v105, v105
    v_exp_f32 v106, v106
    v_smfmac_f32_32x32x32_bf16 v[176:191], v[148:151], v[88:95], v204
    v_exp_f32 v107, v107
    v_exp_f32 v108, v108
    v_exp_f32 v109, v109
    v_smfmac_f32_16x16x64_bf16 v[196:199], v[200:203], v[88:95], v204
    ds_read_b128 v[156:159], v24 offset:44032
    v_exp_f32 v110, v110
    v_exp_f32 v111, v111
    v_mfma_f32_32x32x16_bf16 v[64:79], v[128:131], v[8:11], 0
    v_exp_f32 v112, v112
    v_exp_f32 v113, v113
    v_exp_f32 v114, v114
    v_mfma_f32_32x32x16_bf16 v[64:79], v[132:135], v[12:15], v[64:79]
    s_waitcnt lgkmcnt(1)
    v_exp_f32 v115, v115
    v_exp_f32 v116, v116
    v_exp_f32 v117, v117
    v_smfmac_f32_32x32x32_bf16 v[160:175], v[152:155], v[96:103], v204
    s_waitcnt lgkmcnt(0)
    v_exp_f32 v118, v118
    v_exp_f32 v119, v119
    v_exp_f32 v120, v120
    v_smfmac_f32_16x16x64_bf16 v[192:195], v[200:203], v[96:103], v204
    ds_read_b128 v[136:139], v24 offset:38912
    v_exp_f32 v121, v121
    v_exp_f32 v122, v122
    v_smfmac_f32_32x32x32_bf16 v[160:175], v[156:159], v[104:111], v204
    v_exp_f32 v123, v123
    v_exp_f32 v124, v124
    v_exp_f32 v125, v125
    v_smfmac_f32_16x16x64_bf16 v[192:195], v[200:203], v[104:111], v204
    ds_read_b128 v[140:143], v24 offset:39936
    v_exp_f32 v126, v126
    v_exp_f32 v127, v127
    v_mfma_f32_32x32x16_bf16 v[80:95], v[128:131], v[16:19], 0
    v_exp_f32 v64, v64
    v_exp_f32 v65, v65
    v_exp_f32 v66, v66
    v_mfma_f32_32x32x16_bf16 v[80:95], v[132:135], v[20:23], v[80:95]
    v_exp_f32 v67, v67
    v_exp_f32 v68, v68
    v_exp_f32 v69, v69
    v_smfmac_f32_32x32x32_bf16 v[176:191], v[152:155], v[112:119], v204
    s_waitcnt lgkmcnt(0)
    v_exp_f32 v70, v70
    v_exp_f32 v71, v71
    v_exp_f32 v72, v72
    v_smfmac_f32_16x16x64_bf16 v[196:199], v[200:203], v[112:119], v204
    ds_read_b128 v[144:147], v24 offset:45056
    v_exp_f32 v73, v73
    v_exp_f32 v74, v74
    v_smfmac_f32_32x32x32_bf16 v[176:191], v[156:159], v[120:127], v204
    v_exp_f32 v75, v75
    v_exp_f32 v76, v76
    v_exp_f32 v77, v77
    v_smfmac_f32_16x16x64_bf16 v[196:199], v[200:203], v[120:127], v204
    ds_read_b128 v[148:151], v24 offset:46080
    v_exp_f32 v78, v78
    v_exp_f32 v79, v79
    v_mfma_f32_32x32x16_bf16 v[96:111], v[136:139], v[8:11], 0
    s_barrier
    v_exp_f32 v80, v80
    v_exp_f32 v81, v81
    v_exp_f32 v82, v82
    v_mfma_f32_32x32x16_bf16 v[96:111], v[140:143], v[12:15], v[96:111]
    s_waitcnt lgkmcnt(1)
    v_exp_f32 v83, v83
    v_exp_f32 v84, v84
    v_exp_f32 v85, v85
    v_smfmac_f32_32x32x32_bf16 v[160:175], v[144:147], v[64:71], v204
    s_waitcnt lgkmcnt(0)
    v_exp_f32 v86, v86
    v_exp_f32 v87, v87
    v_exp_f32 v88, v88
    v_smfmac_f32_16x16x64_bf16 v[192:195], v[200:203], v[64:71], v204
    ds_read_b128 v[128:131], v24 offset:49152
    v_exp_f32 v89, v89
    v_exp_f32 v90, v90
    v_smfmac_f32_32x32x32_bf16 v[160:175], v[148:151], v[72:79], v204
    v_exp_f32 v91, v91
    v_exp_f32 v92, v92
    v_exp_f32 v93, v93
    v_smfmac_f32_16x16x64_bf16 v[192:195], v[200:203], v[72:79], v204
    ds_read_b128 v[132:135], v24 offset:50176
    v_exp_f32 v94, v94
    v_exp_f32 v95, v95
    v_mfma_f32_32x32x16_bf16 v[112:127], v[136:139], v[16:19], 0
    v_exp_f32 v96, v96
    v_exp_f32 v97, v97
    v_exp_f32 v98, v98
    v_mfma_f32_32x32x16_bf16 v[112:127], v[140:143], v[20:23], v[112:127]
    v_exp_f32 v99, v99
    v_exp_f32 v100, v100
    v_exp_f32 v101, v101
    v_smfmac_f32_32x32x32_bf16 v[176:191], v[144:147], v[80:87], v204
    s_waitcnt lgkmcnt(0)
    v_exp_f32 v102, v102
    v_exp_f32 v103, v103
    v_exp_f32 v104, v104
    v_smfmac_f32_16x16x64_bf16 v[196:199], v[200:203], v[80:87], v204
    ds_read_b128 v[152:155], v24 offset:47104
    v_exp_f32 v105, v105
    v_exp_f32 v106, v106
    v_smfmac_f32_32x32x32_bf16 v[176:191], v[148:151], v[88:95], v204
    v_exp_f32 v107, v107
    v_exp_f32 v108, v108
    v_exp_f32 v109, v109
    v_smfmac_f32_16x16x64_bf16 v[196:199], v[200:203], v[88:95], v204
    ds_read_b128 v[156:159], v24 offset:48128
    v_exp_f32 v110, v110
    v_exp_f32 v111, v111
    v_mfma_f32_32x32x16_bf16 v[64:79], v[128:131], v[8:11], 0
    v_exp_f32 v112, v112
    v_exp_f32 v113, v113
    v_exp_f32 v114, v114
    v_mfma_f32_32x32x16_bf16 v[64:79], v[132:135], v[12:15], v[64:79]
    s_waitcnt lgkmcnt(1)
    v_exp_f32 v115, v115
    v_exp_f32 v116, v116
    v_exp_f32 v117, v117
    v_smfmac_f32_32x32x32_bf16 v[160:175], v[152:155], v[96:103], v204
    s_waitcnt lgkmcnt(0)
    v_exp_f32 v118, v118
    v_exp_f32 v119, v119
    v_exp_f32 v120, v120
    v_smfmac_f32_16x16x64_bf16 v[192:195], v[200:203], v[96:103], v204
    ds_read_b128 v[136:139], v24 offset:51200
    v_exp_f32 v121, v121
    v_exp_f32 v122, v122
    v_smfmac_f32_32x32x32_bf16 v[160:175], v[156:159], v[104:111], v204
    v_exp_f32 v123, v123
    v_exp_f32 v124, v124
    v_exp_f32 v125, v125
    v_smfmac_f32_16x16x64_bf16 v[192:195], v[200:203], v[104:111], v204
    ds_read_b128 v[140:143], v24 offset:52224
    v_exp_f32 v126, v126
    v_exp_f32 v127, v127
    v_mfma_f32_32x32x16_bf16 v[80:95], v[128:131], v[16:19], 0
    v_exp_f32 v64, v64
    v_exp_f32 v65, v65
    v_exp_f32 v66, v66
    v_mfma_f32_32x32x16_bf16 v[80:95], v[132:135], v[20:23], v[80:95]
    v_exp_f32 v67, v67
    v_exp_f32 v68, v68
    v_exp_f32 v69, v69
    v_smfmac_f32_32x32x32_bf16 v[176:191], v[152:155], v[112:119], v204
    s_waitcnt lgkmcnt(0)
    v_exp_f32 v70, v70
    v_exp_f32 v71, v71
    v_exp_f32 v72, v72
    v_smfmac_f32_16x16x64_bf16 v[196:199], v[200:203], v[112:119], v204
    ds_read_b128 v[144:147], v24 offset:57344
    v_exp_f32 v73, v73
    v_exp_f32 v74, v74
    v_smfmac_f32_32x32x32_bf16 v[176:191], v[156:159], v[120:127], v204
    v_exp_f32 v75, v75
    v_exp_f32 v76, v76
    v_exp_f32 v77, v77
    v_smfmac_f32_16x16x64_bf16 v[196:199], v[200:203], v[120:127], v204
    ds_read_b128 v[148:151], v24 offset:58368
    v_exp_f32 v78, v78
    v_exp_f32 v79, v79
    v_mfma_f32_32x32x16_bf16 v[96:111], v[136:139], v[8:11], 0
    v_exp_f32 v80, v80
    v_exp_f32 v81, v81
    v_exp_f32 v82, v82
    v_mfma_f32_32x32x16_bf16 v[96:111], v[140:143], v[12:15], v[96:111]
    s_waitcnt lgkmcnt(1)
    v_exp_f32 v83, v83
    v_exp_f32 v84, v84
    v_exp_f32 v85, v85
    v_smfmac_f32_32x32x32_bf16 v[160:175], v[144:147], v[64:71], v204
    s_waitcnt lgkmcnt(0)
    v_exp_f32 v86, v86
    v_exp_f32 v87, v87
    v_exp_f32 v88, v88
    v_smfmac_f32_16x16x64_bf16 v[192:195], v[200:203], v[64:71], v204
    ds_read_b128 v[128:131], v24 offset:53248
    v_exp_f32 v89, v89
    v_exp_f32 v90, v90
    v_smfmac_f32_32x32x32_bf16 v[160:175], v[148:151], v[72:79], v204
    v_exp_f32 v91, v91
    v_exp_f32 v92, v92
    v_exp_f32 v93, v93
    v_smfmac_f32_16x16x64_bf16 v[192:195], v[200:203], v[72:79], v204
    ds_read_b128 v[132:135], v24 offset:54272
    v_exp_f32 v94, v94
    v_exp_f32 v95, v95
    v_mfma_f32_32x32x16_bf16 v[112:127], v[136:139], v[16:19], 0
    v_exp_f32 v96, v96
    v_exp_f32 v97, v97
    v_exp_f32 v98, v98
    v_mfma_f32_32x32x16_bf16 v[112:127], v[140:143], v[20:23], v[112:127]
    v_exp_f32 v99, v99
    v_exp_f32 v100, v100
    v_exp_f32 v101, v101
    v_smfmac_f32_32x32x32_bf16 v[176:191], v[144:147], v[80:87], v204
    s_waitcnt lgkmcnt(0)
    v_exp_f32 v102, v102
    v_exp_f32 v103, v103
    v_exp_f32 v104, v104
    v_smfmac_f32_16x16x64_bf16 v[196:199], v[200:203], v[80:87], v204
    ds_read_b128 v[152:155], v24 offset:59392
    v_exp_f32 v105, v105
    v_exp_f32 v106, v106
    v_smfmac_f32_32x32x32_bf16 v[176:191], v[148:151], v[88:95], v204
    v_exp_f32 v107, v107
    v_exp_f32 v108, v108
    v_exp_f32 v109, v109
    v_smfmac_f32_16x16x64_bf16 v[196:199], v[200:203], v[88:95], v204
    ds_read_b128 v[156:159], v24 offset:60416
    v_exp_f32 v110, v110
    v_exp_f32 v111, v111
    v_mfma_f32_32x32x16_bf16 v[64:79], v[128:131], v[8:11], 0
    v_exp_f32 v112, v112
    v_exp_f32 v113, v113
    v_exp_f32 v114, v114
    v_mfma_f32_32x32x16_bf16 v[64:79], v[132:135], v[12:15], v[64:79]
    s_waitcnt lgkmcnt(1)
    v_exp_f32 v115, v115
    v_exp_f32 v116, v116
    v_exp_f32 v117, v117
    v_smfmac_f32_32x32x32_bf16 v[160:175], v[152:155], v[96:103], v204
    s_waitcnt lgkmcnt(0)
    v_exp_f32 v118, v118
    v_exp_f32 v119, v119
    v_exp_f32 v120, v120
    v_smfmac_f32_16x16x64_bf16 v[192:195], v[200:203], v[96:103], v204
    ds_read_b128 v[136:139], v24 offset:55296
    v_exp_f32 v121, v121
    v_exp_f32 v122, v122
    v_smfmac_f32_32x32x32_bf16 v[160:175], v[156:159], v[104:111], v204
    v_exp_f32 v123, v123
    v_exp_f32 v124, v124
    v_exp_f32 v125, v125
    v_smfmac_f32_16x16x64_bf16 v[192:195], v[200:203], v[104:111], v204
    ds_read_b128 v[140:143], v24 offset:56320
    v_exp_f32 v126, v126
    v_exp_f32 v127, v127
    v_mfma_f32_32x32x16_bf16 v[80:95], v[128:131], v[16:19], 0
    v_exp_f32 v64, v64
    v_exp_f32 v65, v65
    v_exp_f32 v66, v66
    v_mfma_f32_32x32x16_bf16 v[80:95], v[132:135], v[20:23], v[80:95]
    v_exp_f32 v67, v67
    v_exp_f32 v68, v68
    v_exp_f32 v69, v69
    v_smfmac_f32_32x32x32_bf16 v[176:191], v[152:155], v[112:119], v204
    s_waitcnt lgkmcnt(0)
    v_exp_f32 v70, v70
    v_exp_f32 v71, v71
    v_exp_f32 v72, v72
    v_smfmac_f32_16x16x64_bf16 v[196:199], v[200:203], v[112:119], v204
    ds_read_b128 v[144:147], v24 offset:61440
    v_exp_f32 v73, v73
    v_exp_f32 v74, v74
    v_smfmac_f32_32x32x32_bf16 v[176:191], v[156:159], v[120:127], v204
    v_exp_f32 v75, v75
    v_exp_f32 v76, v76
    v_exp_f32 v77, v77
    v_smfmac_f32_16x16x64_bf16 v[196:199], v[200:203], v[120:127], v204
    ds_read_b128 v[148:151], v24 offset:62464
    v_exp_f32 v78, v78
    v_exp_f32 v79, v79
    v_mfma_f32_32x32x16_bf16 v[96:111], v[136:139], v[8:11], 0
    s_barrier
    v_exp_f32 v80, v80
    v_exp_f32 v81, v81
    v_exp_f32 v82, v82
    v_mfma_f32_32x32x16_bf16 v[96:111], v[140:143], v[12:15], v[96:111]
    s_waitcnt lgkmcnt(1)
    v_exp_f32 v83, v83
    v_exp_f32 v84, v84
    v_exp_f32 v85, v85
    v_smfmac_f32_32x32x32_bf16 v[160:175], v[144:147], v[64:71], v204
    s_waitcnt lgkmcnt(0)
    v_exp_f32 v86, v86
    v_exp_f32 v87, v87
    v_exp_f32 v88, v88
    v_smfmac_f32_16x16x64_bf16 v[192:195], v[200:203], v[64:71], v204
    ds_read_b128 v[128:131], v24 offset:0
    v_exp_f32 v89, v89
    v_exp_f32 v90, v90
    v_smfmac_f32_32x32x32_bf16 v[160:175], v[148:151], v[72:79], v204
    v_exp_f32 v91, v91
    v_exp_f32 v92, v92
    v_exp_f32 v93, v93
    v_smfmac_f32_16x16x64_bf16 v[192:195], v[200:203], v[72:79], v204
    ds_read_b128 v[132:135], v24 offset:1024
    v_exp_f32 v94, v94
    v_exp_f32 v95, v95
    v_mfma_f32_32x32x16_bf16 v[112:127], v[136:139], v[16:19], 0
    v_exp_f32 v96, v96
    v_exp_f32 v97, v97
    v_exp_f32 v98, v98
    v_mfma_f32_32x32x16_bf16 v[112:127], v[140:143], v[20:23], v[112:127]
    v_exp_f32 v99, v99
    v_exp_f32 v100, v100
    v_exp_f32 v101, v101
    v_smfmac_f32_32x32x32_bf16 v[176:191], v[144:147], v[80:87], v204
    s_waitcnt lgkmcnt(0)
    v_exp_f32 v102, v102
    v_exp_f32 v103, v103
    v_exp_f32 v104, v104
    v_smfmac_f32_16x16x64_bf16 v[196:199], v[200:203], v[80:87], v204
    ds_read_b128 v[152:155], v24 offset:63488
    v_exp_f32 v105, v105
    v_exp_f32 v106, v106
    v_smfmac_f32_32x32x32_bf16 v[176:191], v[148:151], v[88:95], v204
    v_exp_f32 v107, v107
    v_exp_f32 v108, v108
    v_exp_f32 v109, v109
    v_smfmac_f32_16x16x64_bf16 v[196:199], v[200:203], v[88:95], v204
    ds_read_b128 v[156:159], v24 offset:64512
    v_exp_f32 v110, v110
    v_exp_f32 v111, v111
    v_mfma_f32_32x32x16_bf16 v[64:79], v[128:131], v[8:11], 0
    s_sub_u32 s54, s54, 1
    v_exp_f32 v112, v112
    v_exp_f32 v113, v113
    v_exp_f32 v114, v114
    v_mfma_f32_32x32x16_bf16 v[64:79], v[132:135], v[12:15], v[64:79]
    s_waitcnt lgkmcnt(1)
    v_exp_f32 v115, v115
    v_exp_f32 v116, v116
    v_exp_f32 v117, v117
    v_smfmac_f32_32x32x32_bf16 v[160:175], v[152:155], v[96:103], v204
    s_waitcnt lgkmcnt(0)
    v_exp_f32 v118, v118
    v_exp_f32 v119, v119
    v_exp_f32 v120, v120
    v_smfmac_f32_16x16x64_bf16 v[192:195], v[200:203], v[96:103], v204
    ds_read_b128 v[136:139], v24 offset:2048
    v_exp_f32 v121, v121
    v_exp_f32 v122, v122
    v_smfmac_f32_32x32x32_bf16 v[160:175], v[156:159], v[104:111], v204
    s_cmp_lg_u32 s54, 0
    v_exp_f32 v123, v123
    v_exp_f32 v124, v124
    v_exp_f32 v125, v125
    v_smfmac_f32_16x16x64_bf16 v[192:195], v[200:203], v[104:111], v204
    ds_read_b128 v[140:143], v24 offset:3072
    v_exp_f32 v126, v126
    v_exp_f32 v127, v127
    s_cbranch_scc1 c_attn_loop
    v_smfmac_f32_16x16x64_bf16 v[196:199], v[200:203], v[112:119], v204
    v_smfmac_f32_16x16x64_bf16 v[196:199], v[200:203], v[120:127], v204
    v_smfmac_f32_32x32x32_bf16 v[176:191], v[152:155], v[112:119], v204
    v_smfmac_f32_32x32x32_bf16 v[176:191], v[156:159], v[120:127], v204
    v_mov_b32 v28, 0x5f000000
    v_mov_b32 v29, 0x2b800000
    v_cmp_lt_f32 s[56:57], v192, v28
    v_cmp_gt_f32 vcc, v192, v29
    s_and_b64 s[56:57], s[56:57], vcc
    s_nop 0
    v_cmp_lt_f32 vcc, v196, v28
    s_and_b64 s[56:57], s[56:57], vcc
    v_cmp_gt_f32 vcc, v196, v29
    s_and_b64 s[56:57], s[56:57], vcc
    s_cmp_lg_u64 s[56:57], -1
    s_cbranch_scc1 c_attn_slow
c_attn_fin:
    s_lshl_b32 s3, s48, 17
    s_lshl_b32 s55, s7, 12
    s_add_u32 s3, s3, s55
    s_and_b32 s55, s6, 1
    s_lshl_b32 s55, s55, 11
    s_add_u32 s3, s3, s55
    s_lshl_b32 s55, s9, 22
    s_add_u32 s3, s3, s55
    s_add_u32 s3, s3, 16777216
    v_rcp_f32 v192, v192
    s_nop 0
    v_pk_mul_f32 v[160:161], v[192:193], v[160:161] op_sel_hi:[0,1]
    v_pk_mul_f32 v[162:163], v[192:193], v[162:163] op_sel_hi:[0,1]
    v_pk_mul_f32 v[164:165], v[192:193], v[164:165] op_sel_hi:[0,1]
    v_pk_mul_f32 v[166:167], v[192:193], v[166:167] op_sel_hi:[0,1]
    v_pk_mul_f32 v[168:169], v[192:193], v[168:169] op_sel_hi:[0,1]
    v_pk_mul_f32 v[170:171], v[192:193], v[170:171] op_sel_hi:[0,1]
    v_pk_mul_f32 v[172:173], v[192:193], v[172:173] op_sel_hi:[0,1]
    v_pk_mul_f32 v[174:175], v[192:193], v[174:175] op_sel_hi:[0,1]
    v_cvt_pk_bf16_f32 v160, v160, v161
    v_cvt_pk_bf16_f32 v161, v162, v163
    v_cvt_pk_bf16_f32 v162, v164, v165
    v_cvt_pk_bf16_f32 v163, v166, v167
    v_cvt_pk_bf16_f32 v164, v168, v169
    v_cvt_pk_bf16_f32 v165, v170, v171
    v_cvt_pk_bf16_f32 v166, v172, v173
    v_cvt_pk_bf16_f32 v167, v174, v175
    buffer_store_dwordx4 v[160:163], v5, s[12:15], s3 offen offset:0 sc1
    buffer_store_dwordx4 v[164:167], v5, s[12:15], s3 offen offset:1024 sc1
    s_add_u32 s3, s3, 65536
    v_rcp_f32 v196, v196
    s_nop 0
    v_pk_mul_f32 v[176:177], v[196:197], v[176:177] op_sel_hi:[0,1]
    v_pk_mul_f32 v[178:179], v[196:197], v[178:179] op_sel_hi:[0,1]
    v_pk_mul_f32 v[180:181], v[196:197], v[180:181] op_sel_hi:[0,1]
    v_pk_mul_f32 v[182:183], v[196:197], v[182:183] op_sel_hi:[0,1]
    v_pk_mul_f32 v[184:185], v[196:197], v[184:185] op_sel_hi:[0,1]
    v_pk_mul_f32 v[186:187], v[196:197], v[186:187] op_sel_hi:[0,1]
    v_pk_mul_f32 v[188:189], v[196:197], v[188:189] op_sel_hi:[0,1]
    v_pk_mul_f32 v[190:191], v[196:197], v[190:191] op_sel_hi:[0,1]
    v_cvt_pk_bf16_f32 v176, v176, v177
    v_cvt_pk_bf16_f32 v177, v178, v179
    v_cvt_pk_bf16_f32 v178, v180, v181
    v_cvt_pk_bf16_f32 v179, v182, v183
    v_cvt_pk_bf16_f32 v180, v184, v185
    v_cvt_pk_bf16_f32 v181, v186, v187
    v_cvt_pk_bf16_f32 v182, v188, v189
    v_cvt_pk_bf16_f32 v183, v190, v191
    buffer_store_dwordx4 v[176:179], v5, s[12:15], s3 offen offset:0 sc1
    buffer_store_dwordx4 v[180:183], v5, s[12:15], s3 offen offset:1024 sc1
    s_add_u32 s3, s3, 65536
    s_mul_i32 s55, s9, 393216
    s_add_u32 s55, s55, 60162048
    v_and_b32 v28, 63, v0
    s_lshr_b32 s56, s11, 5
    s_lshl_b32 s56, s56, 14
    s_add_u32 s55, s55, s56
    s_bfe_u32 s56, s11, 0x20003
    s_and_b32 s57, s11, 7
    v_lshlrev_b32 v28, 9, v28
    s_lshl_b32 s56, s56, 7
    s_lshl_b32 s57, s57, 2
    s_add_u32 s55, s55, s56
    s_add_u32 s55, s55, s57
    v_mov_b32 v29, 158976
    v_mov_b32 v30, 1
    v_mov_b32 v31, s10
    s_mov_b64 exec, 1
    s_waitcnt vmcnt(0)
    ds_add_rtn_u32 v30, v29, v30
    s_waitcnt lgkmcnt(0)
    v_readfirstlane_b32 s56, v30
    s_and_b32 s56, s56, 3
    s_cmp_lg_u32 s56, 3
    s_cbranch_scc1 pub_5
    s_mov_b32 exec_lo, -1
    buffer_store_dword v31, v28, s[12:15], s55 offen sc1
pub_5:
    s_mov_b64 exec, -1
    s_branch c_wo
.p2align 6
h_raw:
    v_and_b32 v1, 63, v0
    s_mov_b32 s16, s46
    s_mov_b32 s17, s47
    s_mov_b32 s18, 256
    s_mov_b32 s19, 0x00020000
    v_mov_b32 v8, 0
    v_mov_b32 v9, 0
    s_memrealtime s[50:51]
    s_cmp_lg_u32 s2, 0
    s_cbranch_scc1 h_raw_nonon
    s_waitcnt lgkmcnt(0)
    s_or_b32 s50, s50, 1
    v_mov_b32 v13, s50
    buffer_store_dword v13, v8, s[16:19], 0 offen sc1
h_raw_nonon:
    buffer_load_dword v13, v8, s[16:19], 0 offen sc1
    v_mov_b32 v10, 158976
    ds_write_b64 v10, v[8:9]
    s_waitcnt lgkmcnt(0)
    s_barrier
    v_lshlrev_b32 v11, 7, v1
    v_and_b32 v12, 15, v1
    v_lshlrev_b32 v12, 4, v12
    v_lshrrev_b32 v17, 4, v1
    v_min_u32 v17, 2, v17
    v_lshl_add_u32 v22, v17, 8, v12
    v_add_u32 v22, 155648, v22
    v_lshl_add_u32 v17, v17, 16, v12
    s_sub_u32 s50, s50, 8000
    s_waitcnt vmcnt(0)
    v_readfirstlane_b32 s10, v13
    s_sub_u32 s51, s10, s50
    s_and_b32 s3, s10, 1
    s_cselect_b32 s51, s51, -1
    s_cmp_ge_i32 s51, 0
    s_cbranch_scc1 h_raw_non_ok
    s_load_dword s10, s[46:47], 0
    s_mov_b32 s58, 0
    s_waitcnt lgkmcnt(0)
h_raw_non:
    s_sub_u32 s51, s10, s50
    s_and_b32 s3, s10, 1
    s_cselect_b32 s51, s51, -1
    s_cmp_ge_i32 s51, 0
    s_cbranch_scc1 h_raw_non_ok
    buffer_load_dword v13, v8, s[16:19], 0 offen sc1
    s_waitcnt vmcnt(0)
    v_readfirstlane_b32 s10, v13
    s_add_u32 s58, s58, 1
    s_cmp_gt_u32 s58, 200
    s_cselect_b32 s50, s10, s50
    s_cmp_lt_u32 s58, 0x20000
    s_cbranch_scc1 h_raw_non
    s_mov_b32 s10, 1
h_raw_non_ok:
    v_mov_b32 v13, s10
    ds_write_b32 v10, v13 offset:4
    s_waitcnt lgkmcnt(0)
    s_barrier
    s_lshl_b32 s50, s2, 13
    s_mov_b32 s28, s36
    s_mov_b32 s29, s37
    s_mov_b32 s30, 2097152
    s_mov_b32 s31, 0x00020000
    s_mov_b32 s49, s50
    buffer_load_dword v21, v11, s[28:31], s49 offen
    s_mov_b32 s9, 0
    v_and_b32 v20, 15, v1
    s_lshl_b32 s51, s6, 2
    s_sub_u32 s51, s51, 1
    s_max_i32 s51, s51, 0
    s_lshl_b32 s50, s51, 16
    s_lshl_b32 s52, s9, 22
    s_add_u32 s50, s50, s52
    s_add_u32 s20, s4, s50
    s_addc_u32 s21, s5, 0
    s_mov_b32 s22, 65536
    s_mov_b32 s23, 0x00020000
    v_bfe_u32 v24, v1, 4, 1
    v_lshl_add_u32 v6, v24, 5, v20
    v_lshlrev_b32 v6, 4, v6
    v_lshrrev_b32 v24, 5, v1
    v_lshl_add_u32 v6, v24, 10, v6
    v_add_u32 v6, 256, v6
    s_sub_u32 s9, s9, 1
    s_mul_i32 s54, s9, 393216
    s_add_u32 s54, s54, 60293120
    s_lshl_b32 s55, s11, 9
    s_add_u32 s54, s54, s55
    s_add_u32 s52, s4, s54
    s_addc_u32 s53, s5, 0
    s_mov_b32 s54, s10
    s_mov_b32 s55, s10
    s_add_u32 s9, s9, 1
    s_mov_b32 s58, 0x20000
poll_6:
    s_load_dwordx8 s[64:71], s[52:53], 0 glc
    s_load_dwordx8 s[72:79], s[52:53], 128 glc
    s_load_dwordx8 s[80:87], s[52:53], 256 glc
    s_load_dwordx8 s[88:95], s[52:53], 384 glc
    s_sub_u32 s58, s58, 1
    s_cbranch_scc1 poll_6_ok
    s_waitcnt lgkmcnt(0)
    s_xor_b64 s[56:57], s[64:65], s[54:55]
    s_xor_b64 s[64:65], s[66:67], s[54:55]
    s_or_b64 s[56:57], s[56:57], s[64:65]
    s_xor_b64 s[64:65], s[68:69], s[54:55]
    s_or_b64 s[56:57], s[56:57], s[64:65]
    s_xor_b64 s[64:65], s[70:71], s[54:55]
    s_or_b64 s[56:57], s[56:57], s[64:65]
    s_xor_b64 s[64:65], s[72:73], s[54:55]
    s_or_b64 s[56:57], s[56:57], s[64:65]
    s_xor_b64 s[64:65], s[74:75], s[54:55]
    s_or_b64 s[56:57], s[56:57], s[64:65]
    s_xor_b64 s[64:65], s[76:77], s[54:55]
    s_or_b64 s[56:57], s[56:57], s[64:65]
    s_xor_b64 s[64:65], s[78:79], s[54:55]
    s_or_b64 s[56:57], s[56:57], s[64:65]
    s_xor_b64 s[64:65], s[80:81], s[54:55]
    s_or_b64 s[56:57], s[56:57], s[64:65]
    s_xor_b64 s[64:65], s[82:83], s[54:55]
    s_or_b64 s[56:57], s[56:57], s[64:65]
    s_xor_b64 s[64:65], s[84:85], s[54:55]
    s_or_b64 s[56:57], s[56:57], s[64:65]
    s_xor_b64 s[64:65], s[86:87], s[54:55]
    s_or_b64 s[56:57], s[56:57], s[64:65]
    s_xor_b64 s[64:65], s[88:89], s[54:55]
    s_or_b64 s[56:57], s[56:57], s[64:65]
    s_xor_b64 s[64:65], s[90:91], s[54:55]
    s_or_b64 s[56:57], s[56:57], s[64:65]
    s_xor_b64 s[64:65], s[92:93], s[54:55]
    s_or_b64 s[56:57], s[56:57], s[64:65]
    s_xor_b64 s[64:65], s[94:95], s[54:55]
    s_or_b64 s[56:57], s[56:57], s[64:65]
    s_cbranch_scc1 poll_6
poll_6_ok:
    s_waitcnt lgkmcnt(0)
    s_mov_b32 m0, 147456
    s_mov_b32 s48, 0
    buffer_load_dwordx4 v6, s[20:23], s48 offen sc1 lds
    s_mov_b32 m0, 148480
    s_mov_b32 s48, 2048
    buffer_load_dwordx4 v6, s[20:23], s48 offen sc1 lds
    s_barrier
    s_mov_b32 m0, 149504
    s_mov_b32 s48, 4096
    buffer_load_dwordx4 v6, s[20:23], s48 offen sc1 lds
    s_mov_b32 m0, 150528
    s_mov_b32 s48, 6144
    buffer_load_dwordx4 v6, s[20:23], s48 offen sc1 lds
    s_mov_b32 m0, 151552
    s_mov_b32 s48, 8192
    buffer_load_dwordx4 v6, s[20:23], s48 offen sc1 lds
    s_mov_b32 m0, 152576
    s_mov_b32 s48, 10240
    buffer_load_dwordx4 v6, s[20:23], s48 offen sc1 lds
    s_waitcnt vmcnt(4)
    s_barrier
    s_waitcnt vmcnt(2)
    s_barrier
    s_mov_b32 m0, 153600
    s_mov_b32 s48, 12288
    buffer_load_dwordx4 v6, s[20:23], s48 offen sc1 lds
    s_mov_b32 m0, 154624
    s_mov_b32 s48, 14336
    buffer_load_dwordx4 v6, s[20:23], s48 offen sc1 lds
    s_waitcnt vmcnt(2)
    s_barrier
    s_mov_b32 m0, 147456
    s_mov_b32 s48, 16384
    buffer_load_dwordx4 v6, s[20:23], s48 offen sc1 lds
    s_mov_b32 m0, 148480
    s_mov_b32 s48, 18432
    buffer_load_dwordx4 v6, s[20:23], s48 offen sc1 lds
    s_waitcnt vmcnt(2)
    s_barrier
    s_mov_b32 m0, 149504
    s_mov_b32 s48, 20480
    buffer_load_dwordx4 v6, s[20:23], s48 offen sc1 lds
    s_mov_b32 m0, 150528
    s_mov_b32 s48, 22528
    buffer_load_dwordx4 v6, s[20:23], s48 offen sc1 lds
    s_waitcnt vmcnt(2)
    s_barrier
    s_mov_b32 m0, 151552
    s_mov_b32 s48, 24576
    buffer_load_dwordx4 v6, s[20:23], s48 offen sc1 lds
    s_mov_b32 m0, 152576
    s_mov_b32 s48, 26624
    buffer_load_dwordx4 v6, s[20:23], s48 offen sc1 lds
    s_waitcnt vmcnt(2)
    s_barrier
    s_mov_b32 m0, 153600
    s_mov_b32 s48, 28672
    buffer_load_dwordx4 v6, s[20:23], s48 offen sc1 lds
    s_mov_b32 m0, 154624
    s_mov_b32 s48, 30720
    buffer_load_dwordx4 v6, s[20:23], s48 offen sc1 lds
    s_waitcnt vmcnt(2)
    s_barrier
    s_mov_b32 m0, 147456
    s_mov_b32 s48, 32768
    buffer_load_dwordx4 v6, s[20:23], s48 offen sc1 lds
    s_mov_b32 m0, 148480
    s_mov_b32 s48, 34816
    buffer_load_dwordx4 v6, s[20:23], s48 offen sc1 lds
    s_lshl_b32 s54, s7, 6
    s_add_u32 s54, s54, 58753024
    s_add_u32 s52, s4, s54
    s_addc_u32 s53, s5, 0
    s_mov_b32 s54, s10
    s_mov_b32 s55, s10
    s_mov_b32 s58, 0x20000
uf_7:
    s_load_dwordx16 s[64:79], s[52:53], 0 glc
    s_load_dwordx16 s[80:95], s[52:53], 1024 glc
    s_sub_u32 s58, s58, 1
    s_cbranch_scc1 uf_7_ok
    s_waitcnt lgkmcnt(0)
    s_xor_b64 s[56:57], s[64:65], s[54:55]
    s_xor_b64 s[64:65], s[66:67], s[54:55]
    s_or_b64 s[56:57], s[56:57], s[64:65]
    s_xor_b64 s[64:65], s[68:69], s[54:55]
    s_or_b64 s[56:57], s[56:57], s[64:65]
    s_xor_b64 s[64:65], s[70:71], s[54:55]
    s_or_b64 s[56:57], s[56:57], s[64:65]
    s_xor_b64 s[64:65], s[72:73], s[54:55]
    s_or_b64 s[56:57], s[56:57], s[64:65]
    s_xor_b64 s[64:65], s[74:75], s[54:55]
    s_or_b64 s[56:57], s[56:57], s[64:65]
    s_xor_b64 s[64:65], s[76:77], s[54:55]
    s_or_b64 s[56:57], s[56:57], s[64:65]
    s_xor_b64 s[64:65], s[78:79], s[54:55]
    s_or_b64 s[56:57], s[56:57], s[64:65]
    s_xor_b64 s[64:65], s[80:81], s[54:55]
    s_or_b64 s[56:57], s[56:57], s[64:65]
    s_xor_b64 s[64:65], s[82:83], s[54:55]
    s_or_b64 s[56:57], s[56:57], s[64:65]
    s_xor_b64 s[64:65], s[84:85], s[54:55]
    s_or_b64 s[56:57], s[56:57], s[64:65]
    s_xor_b64 s[64:65], s[86:87], s[54:55]
    s_or_b64 s[56:57], s[56:57], s[64:65]
    s_xor_b64 s[64:65], s[88:89], s[54:55]
    s_or_b64 s[56:57], s[56:57], s[64:65]
    s_xor_b64 s[64:65], s[90:91], s[54:55]
    s_or_b64 s[56:57], s[56:57], s[64:65]
    s_xor_b64 s[64:65], s[92:93], s[54:55]
    s_or_b64 s[56:57], s[56:57], s[64:65]
    s_xor_b64 s[64:65], s[94:95], s[54:55]
    s_or_b64 s[56:57], s[56:57], s[64:65]
    s_cbranch_scc1 uf_7
uf_7_ok:
    s_waitcnt lgkmcnt(0)
    s_mov_b32 s58, 0x20000
uf_8:
    s_load_dwordx16 s[64:79], s[52:53], 2048 glc
    s_sub_u32 s58, s58, 1
    s_cbranch_scc1 uf_8_ok
    s_waitcnt lgkmcnt(0)
    s_xor_b64 s[56:57], s[64:65], s[54:55]
    s_xor_b64 s[64:65], s[66:67], s[54:55]
    s_or_b64 s[56:57], s[56:57], s[64:65]
    s_xor_b64 s[64:65], s[68:69], s[54:55]
    s_or_b64 s[56:57], s[56:57], s[64:65]
    s_xor_b64 s[64:65], s[70:71], s[54:55]
    s_or_b64 s[56:57], s[56:57], s[64:65]
    s_xor_b64 s[64:65], s[72:73], s[54:55]
    s_or_b64 s[56:57], s[56:57], s[64:65]
    s_xor_b64 s[64:65], s[74:75], s[54:55]
    s_or_b64 s[56:57], s[56:57], s[64:65]
    s_xor_b64 s[64:65], s[76:77], s[54:55]
    s_or_b64 s[56:57], s[56:57], s[64:65]
    s_xor_b64 s[64:65], s[78:79], s[54:55]
    s_or_b64 s[56:57], s[56:57], s[64:65]
    s_cbranch_scc1 uf_8
uf_8_ok:
    s_waitcnt lgkmcnt(0)
    s_lshl_b32 s56, s7, 12
    s_add_u32 s56, s56, 58785792
    buffer_load_dwordx4 v[32:35], v17, s[12:15], s56 offen offset:0 sc1
    buffer_load_dwordx4 v[36:39], v17, s[12:15], s56 offen offset:256 sc1
    buffer_load_dwordx4 v[40:43], v17, s[12:15], s56 offen offset:512 sc1
    buffer_load_dwordx4 v[44:47], v17, s[12:15], s56 offen offset:768 sc1
    buffer_load_dwordx4 v[48:51], v17, s[12:15], s56 offen offset:1024 sc1
    buffer_load_dwordx4 v[52:55], v17, s[12:15], s56 offen offset:1280 sc1
    buffer_load_dwordx4 v[56:59], v17, s[12:15], s56 offen offset:1536 sc1
    s_waitcnt vmcnt(9)
    s_barrier
    s_mov_b32 m0, 149504
    s_mov_b32 s48, 36864
    buffer_load_dwordx4 v6, s[20:23], s48 offen sc1 lds
    s_mov_b32 m0, 150528
    s_mov_b32 s48, 38912
    buffer_load_dwordx4 v6, s[20:23], s48 offen sc1 lds
    buffer_load_dwordx4 v[60:63], v17, s[12:15], s56 offen offset:1792 sc1
    buffer_load_dwordx4 v[64:67], v17, s[12:15], s56 offen offset:2048 sc1
    buffer_load_dwordx4 v[68:71], v17, s[12:15], s56 offen offset:2304 sc1
    buffer_load_dwordx4 v[72:75], v17, s[12:15], s56 offen offset:2560 sc1
    buffer_load_dwordx4 v[76:79], v17, s[12:15], s56 offen offset:2816 sc1
    buffer_load_dwordx4 v[80:83], v17, s[12:15], s56 offen offset:3072 sc1
    buffer_load_dwordx4 v[84:87], v17, s[12:15], s56 offen offset:3328 sc1
    buffer_load_dwordx4 v[88:91], v17, s[12:15], s56 offen offset:3584 sc1
    buffer_load_dwordx4 v[92:95], v17, s[12:15], s56 offen offset:3840 sc1
    s_waitcnt vmcnt(18)
    s_barrier
    s_mov_b32 m0, 151552
    s_mov_b32 s48, 40960
    buffer_load_dwordx4 v6, s[20:23], s48 offen sc1 lds
    s_mov_b32 m0, 152576
    s_mov_b32 s48, 43008
    buffer_load_dwordx4 v6, s[20:23], s48 offen sc1 lds
    s_waitcnt vmcnt(11)
    s_barrier
    s_mov_b32 m0, 153600
    s_mov_b32 s48, 45056
    buffer_load_dwordx4 v6, s[20:23], s48 offen sc1 lds
    s_mov_b32 m0, 154624
    s_mov_b32 s48, 47104
    buffer_load_dwordx4 v6, s[20:23], s48 offen sc1 lds
    s_waitcnt vmcnt(4)
    v_add_f32 v32, v32, v64
    v_add_f32 v33, v33, v65
    v_add_f32 v34, v34, v66
    v_add_f32 v35, v35, v67
    v_add_f32 v36, v36, v68
    v_add_f32 v37, v37, v69
    v_add_f32 v38, v38, v70
    v_add_f32 v39, v39, v71
    v_add_f32 v40, v40, v72
    v_add_f32 v41, v41, v73
    v_add_f32 v42, v42, v74
    v_add_f32 v43, v43, v75
    s_waitcnt vmcnt(2)
    s_barrier
    s_mov_b32 m0, 147456
    s_mov_b32 s48, 49152
    buffer_load_dwordx4 v6, s[20:23], s48 offen sc1 lds
    s_mov_b32 m0, 148480
    s_mov_b32 s48, 51200
    buffer_load_dwordx4 v6, s[20:23], s48 offen sc1 lds
    v_add_f32 v44, v44, v76
    v_add_f32 v45, v45, v77
    v_add_f32 v46, v46, v78
    v_add_f32 v47, v47, v79
    v_add_f32 v48, v48, v80
    v_add_f32 v49, v49, v81
    v_add_f32 v50, v50, v82
    v_add_f32 v51, v51, v83
    v_add_f32 v52, v52, v84
    v_add_f32 v53, v53, v85
    v_add_f32 v54, v54, v86
    v_add_f32 v55, v55, v87
    s_waitcnt vmcnt(2)
    s_barrier
    s_mov_b32 m0, 149504
    s_mov_b32 s48, 53248
    buffer_load_dwordx4 v6, s[20:23], s48 offen sc1 lds
    s_mov_b32 m0, 150528
    s_mov_b32 s48, 55296
    buffer_load_dwordx4 v6, s[20:23], s48 offen sc1 lds
    v_add_f32 v56, v56, v88
    v_add_f32 v57, v57, v89
    v_add_f32 v58, v58, v90
    v_add_f32 v59, v59, v91
    v_add_f32 v60, v60, v92
    v_add_f32 v61, v61, v93
    v_add_f32 v62, v62, v94
    v_add_f32 v63, v63, v95
    v_add_f32 v32, v32, v48
    v_add_f32 v33, v33, v49
    v_add_f32 v34, v34, v50
    v_add_f32 v35, v35, v51
    s_waitcnt vmcnt(2)
    s_barrier
    s_mov_b32 m0, 151552
    s_mov_b32 s48, 57344
    buffer_load_dwordx4 v6, s[20:23], s48 offen sc1 lds
    s_mov_b32 m0, 152576
    s_mov_b32 s48, 59392
    buffer_load_dwordx4 v6, s[20:23], s48 offen sc1 lds
    v_add_f32 v36, v36, v52
    v_add_f32 v37, v37, v53
    v_add_f32 v38, v38, v54
    v_add_f32 v39, v39, v55
    v_add_f32 v40, v40, v56
    v_add_f32 v41, v41, v57
    v_add_f32 v42, v42, v58
    v_add_f32 v43, v43, v59
    v_add_f32 v44, v44, v60
    v_add_f32 v45, v45, v61
    v_add_f32 v46, v46, v62
    v_add_f32 v47, v47, v63
    s_waitcnt vmcnt(2)
    s_barrier
    s_mov_b32 m0, 153600
    s_mov_b32 s48, 61440
    buffer_load_dwordx4 v6, s[20:23], s48 offen sc1 lds
    s_mov_b32 m0, 154624
    s_mov_b32 s48, 63488
    buffer_load_dwordx4 v6, s[20:23], s48 offen sc1 lds
    v_add_f32 v32, v32, v40
    v_add_f32 v33, v33, v41
    v_add_f32 v34, v34, v42
    v_add_f32 v35, v35, v43
    v_add_f32 v36, v36, v44
    v_add_f32 v37, v37, v45
    v_add_f32 v38, v38, v46
    v_add_f32 v39, v39, v47
    v_add_f32 v32, v32, v36
    v_add_f32 v33, v33, v37
    v_add_f32 v34, v34, v38
    v_add_f32 v35, v35, v39
    s_waitcnt vmcnt(2)
    s_barrier
    ds_write_b128 v22, v[32:35]
    s_waitcnt lgkmcnt(0)
    s_waitcnt vmcnt(0)
    s_barrier
    s_barrier
    s_barrier
    s_branch h_wo
.p2align 6
h_qkva:
    v_and_b32 v1, 63, v0
    v_and_b32 v20, 15, v1
    s_lshl_b32 s51, s6, 2
    s_sub_u32 s51, s51, 1
    s_max_i32 s51, s51, 0
    s_lshl_b32 s50, s51, 16
    s_lshl_b32 s52, s9, 22
    s_add_u32 s50, s50, s52
    s_add_u32 s20, s4, s50
    s_addc_u32 s21, s5, 0
    s_mov_b32 s22, 65536
    s_mov_b32 s23, 0x00020000
    v_bfe_u32 v24, v1, 4, 1
    v_lshl_add_u32 v6, v24, 5, v20
    v_lshlrev_b32 v6, 4, v6
    v_lshrrev_b32 v24, 5, v1
    v_lshl_add_u32 v6, v24, 10, v6
    v_add_u32 v6, 256, v6
    s_sub_u32 s9, s9, 1
    s_mul_i32 s54, s9, 393216
    s_add_u32 s54, s54, 60293120
    s_lshl_b32 s55, s11, 9
    s_add_u32 s54, s54, s55
    s_add_u32 s52, s4, s54
    s_addc_u32 s53, s5, 0
    s_mov_b32 s54, s10
    s_mov_b32 s55, s10
    s_add_u32 s9, s9, 1
    s_mov_b32 s58, 0x20000
poll_9:
    s_load_dwordx8 s[64:71], s[52:53], 0 glc
    s_load_dwordx8 s[72:79], s[52:53], 128 glc
    s_load_dwordx8 s[80:87], s[52:53], 256 glc
    s_load_dwordx8 s[88:95], s[52:53], 384 glc
    s_sub_u32 s58, s58, 1
    s_cbranch_scc1 poll_9_ok
    s_waitcnt lgkmcnt(0)
    s_xor_b64 s[56:57], s[64:65], s[54:55]
    s_xor_b64 s[64:65], s[66:67], s[54:55]
    s_or_b64 s[56:57], s[56:57], s[64:65]
    s_xor_b64 s[64:65], s[68:69], s[54:55]
    s_or_b64 s[56:57], s[56:57], s[64:65]
    s_xor_b64 s[64:65], s[70:71], s[54:55]
    s_or_b64 s[56:57], s[56:57], s[64:65]
    s_xor_b64 s[64:65], s[72:73], s[54:55]
    s_or_b64 s[56:57], s[56:57], s[64:65]
    s_xor_b64 s[64:65], s[74:75], s[54:55]
    s_or_b64 s[56:57], s[56:57], s[64:65]
    s_xor_b64 s[64:65], s[76:77], s[54:55]
    s_or_b64 s[56:57], s[56:57], s[64:65]
    s_xor_b64 s[64:65], s[78:79], s[54:55]
    s_or_b64 s[56:57], s[56:57], s[64:65]
    s_xor_b64 s[64:65], s[80:81], s[54:55]
    s_or_b64 s[56:57], s[56:57], s[64:65]
    s_xor_b64 s[64:65], s[82:83], s[54:55]
    s_or_b64 s[56:57], s[56:57], s[64:65]
    s_xor_b64 s[64:65], s[84:85], s[54:55]
    s_or_b64 s[56:57], s[56:57], s[64:65]
    s_xor_b64 s[64:65], s[86:87], s[54:55]
    s_or_b64 s[56:57], s[56:57], s[64:65]
    s_xor_b64 s[64:65], s[88:89], s[54:55]
    s_or_b64 s[56:57], s[56:57], s[64:65]
    s_xor_b64 s[64:65], s[90:91], s[54:55]
    s_or_b64 s[56:57], s[56:57], s[64:65]
    s_xor_b64 s[64:65], s[92:93], s[54:55]
    s_or_b64 s[56:57], s[56:57], s[64:65]
    s_xor_b64 s[64:65], s[94:95], s[54:55]
    s_or_b64 s[56:57], s[56:57], s[64:65]
    s_cbranch_scc1 poll_9
poll_9_ok:
    s_waitcnt lgkmcnt(0)
    s_mov_b32 m0, 147456
    s_mov_b32 s48, 0
    buffer_load_dwordx4 v6, s[20:23], s48 offen sc1 lds
    s_mov_b32 m0, 148480
    s_mov_b32 s48, 2048
    buffer_load_dwordx4 v6, s[20:23], s48 offen sc1 lds
    s_barrier
    s_mov_b32 m0, 149504
    s_mov_b32 s48, 4096
    buffer_load_dwordx4 v6, s[20:23], s48 offen sc1 lds
    s_mov_b32 m0, 150528
    s_mov_b32 s48, 6144
    buffer_load_dwordx4 v6, s[20:23], s48 offen sc1 lds
    s_mov_b32 m0, 151552
    s_mov_b32 s48, 8192
    buffer_load_dwordx4 v6, s[20:23], s48 offen sc1 lds
    s_mov_b32 m0, 152576
    s_mov_b32 s48, 10240
    buffer_load_dwordx4 v6, s[20:23], s48 offen sc1 lds
    s_waitcnt vmcnt(4)
    s_barrier
    s_waitcnt vmcnt(2)
    s_barrier
    s_mov_b32 m0, 153600
    s_mov_b32 s48, 12288
    buffer_load_dwordx4 v6, s[20:23], s48 offen sc1 lds
    s_mov_b32 m0, 154624
    s_mov_b32 s48, 14336
    buffer_load_dwordx4 v6, s[20:23], s48 offen sc1 lds
    s_waitcnt vmcnt(2)
    s_barrier
    s_mov_b32 m0, 147456
    s_mov_b32 s48, 16384
    buffer_load_dwordx4 v6, s[20:23], s48 offen sc1 lds
    s_mov_b32 m0, 148480
    s_mov_b32 s48, 18432
    buffer_load_dwordx4 v6, s[20:23], s48 offen sc1 lds
    s_waitcnt vmcnt(2)
    s_barrier
    s_mov_b32 m0, 149504
    s_mov_b32 s48, 20480
    buffer_load_dwordx4 v6, s[20:23], s48 offen sc1 lds
    s_mov_b32 m0, 150528
    s_mov_b32 s48, 22528
    buffer_load_dwordx4 v6, s[20:23], s48 offen sc1 lds
    s_waitcnt vmcnt(2)
    s_barrier
    s_mov_b32 m0, 151552
    s_mov_b32 s48, 24576
    buffer_load_dwordx4 v6, s[20:23], s48 offen sc1 lds
    s_mov_b32 m0, 152576
    s_mov_b32 s48, 26624
    buffer_load_dwordx4 v6, s[20:23], s48 offen sc1 lds
    s_waitcnt vmcnt(2)
    s_barrier
    s_mov_b32 m0, 153600
    s_mov_b32 s48, 28672
    buffer_load_dwordx4 v6, s[20:23], s48 offen sc1 lds
    s_mov_b32 m0, 154624
    s_mov_b32 s48, 30720
    buffer_load_dwordx4 v6, s[20:23], s48 offen sc1 lds
    s_waitcnt vmcnt(2)
    s_barrier
    s_mov_b32 m0, 147456
    s_mov_b32 s48, 32768
    buffer_load_dwordx4 v6, s[20:23], s48 offen sc1 lds
    s_mov_b32 m0, 148480
    s_mov_b32 s48, 34816
    buffer_load_dwordx4 v6, s[20:23], s48 offen sc1 lds
    s_waitcnt vmcnt(2)
    s_barrier
    s_mov_b32 m0, 149504
    s_mov_b32 s48, 36864
    buffer_load_dwordx4 v6, s[20:23], s48 offen sc1 lds
    s_mov_b32 m0, 150528
    s_mov_b32 s48, 38912
    buffer_load_dwordx4 v6, s[20:23], s48 offen sc1 lds
    s_waitcnt vmcnt(2)
    s_barrier
    s_mov_b32 m0, 151552
    s_mov_b32 s48, 40960
    buffer_load_dwordx4 v6, s[20:23], s48 offen sc1 lds
    s_mov_b32 m0, 152576
    s_mov_b32 s48, 43008
    buffer_load_dwordx4 v6, s[20:23], s48 offen sc1 lds
    s_waitcnt vmcnt(2)
    s_barrier
    s_mov_b32 m0, 153600
    s_mov_b32 s48, 45056
    buffer_load_dwordx4 v6, s[20:23], s48 offen sc1 lds
    s_mov_b32 m0, 154624
    s_mov_b32 s48, 47104
    buffer_load_dwordx4 v6, s[20:23], s48 offen sc1 lds
    s_waitcnt vmcnt(2)
    s_barrier
    s_mov_b32 m0, 147456
    s_mov_b32 s48, 49152
    buffer_load_dwordx4 v6, s[20:23], s48 offen sc1 lds
    s_mov_b32 m0, 148480
    s_mov_b32 s48, 51200
    buffer_load_dwordx4 v6, s[20:23], s48 offen sc1 lds
    s_waitcnt vmcnt(2)
    s_barrier
    s_mov_b32 m0, 149504
    s_mov_b32 s48, 53248
    buffer_load_dwordx4 v6, s[20:23], s48 offen sc1 lds
    s_mov_b32 m0, 150528
    s_mov_b32 s48, 55296
    buffer_load_dwordx4 v6, s[20:23], s48 offen sc1 lds
    s_waitcnt vmcnt(2)
    s_barrier
    s_mov_b32 m0, 151552
    s_mov_b32 s48, 57344
    buffer_load_dwordx4 v6, s[20:23], s48 offen sc1 lds
    s_mov_b32 m0, 152576
    s_mov_b32 s48, 59392
    buffer_load_dwordx4 v6, s[20:23], s48 offen sc1 lds
    s_waitcnt vmcnt(2)
    s_barrier
    s_mov_b32 m0, 153600
    s_mov_b32 s48, 61440
    buffer_load_dwordx4 v6, s[20:23], s48 offen sc1 lds
    s_mov_b32 m0, 154624
    s_mov_b32 s48, 63488
    buffer_load_dwordx4 v6, s[20:23], s48 offen sc1 lds
    s_waitcnt vmcnt(2)
    s_barrier
    s_waitcnt vmcnt(0)
    s_barrier
    s_barrier
    s_barrier
    s_branch h_wo
.p2align 6
l_raw:
    v_and_b32 v1, 63, v0
    s_sub_u32 s51, s8, 5
    s_lshl_b32 s48, s51, 10
    v_lshrrev_b32 v20, 3, v1
    v_and_b32 v22, 2, v20
    v_lshrrev_b32 v23, 2, v20
    v_or_b32 v22, v22, v23
    v_bfe_u32 v21, v1, 1, 2
    v_xor_b32 v22, v22, v21
    v_lshlrev_b32 v22, 5, v22
    v_and_b32 v21, 1, v1
    v_lshl_add_u32 v22, v21, 4, v22
    s_lshl_b32 s3, s51, 11
    s_lshl_b32 s52, s7, 7
    s_add_u32 s49, s3, s52
    v_lshl_add_u32 v28, v20, 7, v22
    v_mul_u32_u24 v23, 6144, v20
    v_add_u32 v7, v23, v22
    s_mov_b32 s24, s34
    s_mov_b32 s25, s35
    s_mov_b32 s26, 6291456
    s_mov_b32 s27, 0x00020000
    s_mov_b32 s50, 49152
    s_lshl_b32 s61, s51, 8
    s_add_u32 s61, s61, s2
    s_and_b32 s62, s61, 15
    s_lshr_b32 s63, s61, 4
    v_and_b32 v21, 7, v1
    v_lshl_add_u32 v12, v21, 4, v23
    s_barrier
    s_mov_b32 s20, s34
    s_mov_b32 s21, s35
    s_mov_b32 s22, 6291456
    s_mov_b32 s23, 0x00020000
    s_mul_i32 s55, s62, 393216
    s_lshl_b32 s56, s63, 7
    s_add_u32 s55, s55, s56
    buffer_load_dwordx4 v[32:35], v12, s[20:23], s55 offen
    s_add_u32 s55, s55, 49152
    buffer_load_dwordx4 v[36:39], v12, s[20:23], s55 offen
    s_add_u32 s55, s55, 49152
    buffer_load_dwordx4 v[40:43], v12, s[20:23], s55 offen
    s_add_u32 s55, s55, 49152
    buffer_load_dwordx4 v[44:47], v12, s[20:23], s55 offen
    s_add_u32 s55, s55, 49152
    buffer_load_dwordx4 v[48:51], v12, s[20:23], s55 offen
    s_add_u32 s55, s55, 49152
    buffer_load_dwordx4 v[52:55], v12, s[20:23], s55 offen
    s_add_u32 s55, s55, 49152
    buffer_load_dwordx4 v[56:59], v12, s[20:23], s55 offen
    s_add_u32 s55, s55, 49152
    buffer_load_dwordx4 v[60:63], v12, s[20:23], s55 offen
    s_add_u32 s55, s55, 49152
    s_mov_b32 s9, 0
    v_lshlrev_b32 v13, 4, v1
    v_lshlrev_b32 v14, 6, v20
    v_lshrrev_b32 v22, 5, v1
    v_bfe_u32 v23, v1, 1, 1
    v_xor_b32 v22, v22, v23
    v_lshl_add_u32 v14, v22, 5, v14
    v_and_b32 v22, 1, v1
    v_lshl_add_u32 v14, v22, 4, v14
    v_bfe_u32 v23, v1, 2, 1
    v_mul_u32_u24 v23, 196608, v23
    v_add_u32 v14, v14, v23
    v_lshlrev_b32 v22, 4, v22
    v_mov_b32 v23, 0x3f80
    v_lshlrev_b32 v23, v22, v23
    v_bfe_u32 v22, v1, 1, 3
    v_cmp_eq_u32 vcc, 0, v22
    s_nop 1
    v_cndmask_b32 v24, 0, v23, vcc
    v_cmp_eq_u32 vcc, 1, v22
    s_nop 1
    v_cndmask_b32 v25, 0, v23, vcc
    v_cmp_eq_u32 vcc, 2, v22
    s_nop 1
    v_cndmask_b32 v26, 0, v23, vcc
    v_cmp_eq_u32 vcc, 3, v22
    s_nop 1
    v_cndmask_b32 v27, 0, v23, vcc
    v_lshlrev_b32 v16, 5, v21
    v_and_b32 v22, 16, v1
    v_add_u32 v16, v16, v22
    v_mov_b32 v8, 0
    s_barrier
    s_add_u32 m0, s48, 0
    s_nop 0
    buffer_load_dwordx4 v7, s[24:27], s49 offen lds
    s_add_u32 s49, s49, s50
    s_add_u32 m0, s48, 3072
    s_nop 0
    buffer_load_dwordx4 v7, s[24:27], s49 offen lds
    s_add_u32 s49, s49, s50
    s_add_u32 m0, s48, 6144
    s_nop 0
    buffer_load_dwordx4 v7, s[24:27], s49 offen lds
    s_add_u32 s49, s49, s50
    s_add_u32 m0, s48, 9216
    s_nop 0
    buffer_load_dwordx4 v7, s[24:27], s49 offen lds
    s_add_u32 s49, s49, s50
    s_add_u32 m0, s48, 12288
    s_nop 0
    buffer_load_dwordx4 v7, s[24:27], s49 offen lds
    s_add_u32 s49, s49, s50
    s_add_u32 m0, s48, 15360
    s_nop 0
    buffer_load_dwordx4 v7, s[24:27], s49 offen lds
    s_add_u32 s49, s49, s50
    s_add_u32 m0, s48, 18432
    s_nop 0
    buffer_load_dwordx4 v7, s[24:27], s49 offen lds
    s_add_u32 s49, s49, s50
    s_add_u32 m0, s48, 21504
    s_nop 0
    buffer_load_dwordx4 v7, s[24:27], s49 offen lds
    s_add_u32 s49, s49, s50
    s_add_u32 m0, s48, 24576
    s_nop 0
    buffer_load_dwordx4 v7, s[24:27], s49 offen lds
    s_add_u32 s49, s49, s50
    s_add_u32 m0, s48, 27648
    s_nop 0
    buffer_load_dwordx4 v7, s[24:27], s49 offen lds
    s_add_u32 s49, s49, s50
    s_add_u32 m0, s48, 30720
    s_nop 0
    buffer_load_dwordx4 v7, s[24:27], s49 offen lds
    s_add_u32 s49, s49, s50
    s_add_u32 m0, s48, 33792
    s_nop 0
    buffer_load_dwordx4 v7, s[24:27], s49 offen lds
    s_add_u32 s49, s49, s50
    s_add_u32 m0, s48, 36864
    s_nop 0
    buffer_load_dwordx4 v7, s[24:27], s49 offen lds
    s_add_u32 s49, s49, s50
    s_add_u32 m0, s48, 39936
    s_nop 0
    buffer_load_dwordx4 v7, s[24:27], s49 offen lds
    s_add_u32 s49, s49, s50
    s_add_u32 m0, s48, 43008
    s_nop 0
    buffer_load_dwordx4 v7, s[24:27], s49 offen lds
    s_add_u32 s49, s49, s50
    s_add_u32 m0, s48, 46080
    s_nop 0
    buffer_load_dwordx4 v7, s[24:27], s49 offen lds
    s_add_u32 s49, s49, s50
    s_add_u32 m0, s48, 49152
    s_nop 0
    buffer_load_dwordx4 v7, s[24:27], s49 offen lds
    s_add_u32 s49, s49, s50
    s_add_u32 m0, s48, 52224
    s_nop 0
    buffer_load_dwordx4 v7, s[24:27], s49 offen lds
    s_add_u32 s49, s49, s50
    s_add_u32 m0, s48, 55296
    s_nop 0
    buffer_load_dwordx4 v7, s[24:27], s49 offen lds
    s_add_u32 s49, s49, s50
    s_add_u32 m0, s48, 58368
    s_nop 0
    buffer_load_dwordx4 v7, s[24:27], s49 offen lds
    s_add_u32 s49, s49, s50
    s_add_u32 m0, s48, 61440
    s_nop 0
    buffer_load_dwordx4 v7, s[24:27], s49 offen lds
    s_add_u32 s49, s49, s50
    s_add_u32 m0, s48, 64512
    s_nop 0
    buffer_load_dwordx4 v7, s[24:27], s49 offen lds
    s_add_u32 s49, s49, s50
    s_add_u32 m0, s48, 67584
    s_nop 0
    buffer_load_dwordx4 v7, s[24:27], s49 offen lds
    s_add_u32 s49, s49, s50
    s_add_u32 m0, s48, 70656
    s_nop 0
    buffer_load_dwordx4 v7, s[24:27], s49 offen lds
    s_add_u32 s49, s49, s50
    v_lshrrev_b32 v10, 5, v1
    v_and_b32 v11, 31, v1
    v_lshlrev_b32 v11, 3, v11
    v_lshl_add_u32 v10, v10, 12, v11
    s_lshl_b32 s3, s51, 8
    s_add_u32 s3, s3, 155648
    v_lshl_add_u32 v11, v1, 2, s3
    s_lshl_b32 s59, s6, 1
    s_add_u32 s59, s59, s51
    s_sub_u32 s59, s59, 1
    s_max_i32 s59, s59, 0
    s_lshl_b32 s59, s59, 13
    s_lshl_b32 s53, s9, 18
    s_add_u32 s59, s59, s53
    s_add_u32 s59, s59, 57671680
    s_lshl_b32 s3, s7, 7
    v_lshrrev_b32 v20, 3, v1
    v_lshlrev_b32 v21, 11, v20
    v_lshrrev_b32 v22, 2, v1
    v_lshrrev_b32 v23, 4, v1
    v_xor_b32 v22, v22, v23
    v_and_b32 v22, 1, v22
    v_lshl_add_u32 v21, v22, 6, v21
    v_and_b32 v22, 3, v1
    v_lshl_add_u32 v21, v22, 4, v21
    v_add_u32 v17, s3, v21
    s_waitcnt vmcnt(16)
    s_barrier
    v_mov_b32 v9, 158980
    ds_read_b32 v9, v9
    v_mfma_f32_16x16x32_bf16 v[64:67], v[24:27], v[32:35], 0
    v_mfma_f32_16x16x32_bf16 v[64:67], v[24:27], v[36:39], v[64:67]
    v_mfma_f32_16x16x32_bf16 v[64:67], v[24:27], v[40:43], v[64:67]
    v_mfma_f32_16x16x32_bf16 v[64:67], v[24:27], v[44:47], v[64:67]
    v_mfma_f32_16x16x32_bf16 v[64:67], v[24:27], v[48:51], v[64:67]
    v_mfma_f32_16x16x32_bf16 v[64:67], v[24:27], v[52:55], v[64:67]
    v_mfma_f32_16x16x32_bf16 v[64:67], v[24:27], v[56:59], v[64:67]
    v_mfma_f32_16x16x32_bf16 v[64:67], v[24:27], v[60:63], v[64:67]
    s_lshr_b32 s55, s63, 4
    s_and_b32 s56, s63, 15
    s_lshr_b32 s57, s56, 3
    s_mul_i32 s57, s57, 3
    s_add_u32 s57, s57, s55
    s_lshl_b32 s57, s57, 17
    s_lshl_b32 s58, s62, 13
    s_add_u32 s57, s57, s58
    s_add_u32 s57, s57, 56623104
    s_and_b32 s56, s56, 7
    s_cmp_eq_u32 s56, 3
    s_cselect_b32 s57, s57, 67108864
    buffer_store_dwordx4 v[32:35], v13, s[12:15], s57 offen offset:0 sc1
    buffer_store_dwordx4 v[36:39], v13, s[12:15], s57 offen offset:1024 sc1
    buffer_store_dwordx4 v[40:43], v13, s[12:15], s57 offen offset:2048 sc1
    buffer_store_dwordx4 v[44:47], v13, s[12:15], s57 offen offset:3072 sc1
    s_add_u32 s57, s57, 4096
    buffer_store_dwordx4 v[48:51], v13, s[12:15], s57 offen offset:0 sc1
    buffer_store_dwordx4 v[52:55], v13, s[12:15], s57 offen offset:1024 sc1
    buffer_store_dwordx4 v[56:59], v13, s[12:15], s57 offen offset:2048 sc1
    buffer_store_dwordx4 v[60:63], v13, s[12:15], s57 offen offset:3072 sc1
    v_add_f32_dpp v64, v64, v64 row_ror:8 row_mask:0xf bank_mask:0xf
    v_add_f32_dpp v65, v65, v65 row_ror:8 row_mask:0xf bank_mask:0xf
    v_add_f32_dpp v66, v66, v66 row_ror:8 row_mask:0xf bank_mask:0xf
    v_add_f32_dpp v67, v67, v67 row_ror:8 row_mask:0xf bank_mask:0xf
    s_lshl_b32 s55, s61, 8
    s_add_u32 s55, s55, 58785792
    s_mov_b64 exec, 0x00ff00ff
    buffer_store_dwordx4 v[64:67], v16, s[12:15], s55 offen sc1
    s_mov_b64 exec, -1
    s_waitcnt lgkmcnt(0)
    v_readfirstlane_b32 s10, v9
    s_barrier
    s_add_u32 m0, s48, 73728
    s_nop 0
    buffer_load_dwordx4 v7, s[24:27], s49 offen lds
    s_add_u32 s49, s49, s50
    s_add_u32 m0, s48, 76800
    s_nop 0
    buffer_load_dwordx4 v7, s[24:27], s49 offen lds
    s_add_u32 s49, s49, s50
    s_add_u32 m0, s48, 79872
    s_nop 0
    buffer_load_dwordx4 v7, s[24:27], s49 offen lds
    s_add_u32 s49, s49, s50
    s_add_u32 m0, s48, 82944
    s_nop 0
    buffer_load_dwordx4 v7, s[24:27], s49 offen lds
    s_add_u32 s49, s49, s50
    s_add_u32 m0, s48, 86016
    s_nop 0
    buffer_load_dwordx4 v7, s[24:27], s49 offen lds
    s_add_u32 s49, s49, s50
    s_add_u32 m0, s48, 89088
    s_nop 0
    buffer_load_dwordx4 v7, s[24:27], s49 offen lds
    s_add_u32 s49, s49, s50
    s_add_u32 m0, s48, 92160
    s_nop 0
    buffer_load_dwordx4 v7, s[24:27], s49 offen lds
    s_add_u32 s49, s49, s50
    s_add_u32 m0, s48, 95232
    s_nop 0
    buffer_load_dwordx4 v7, s[24:27], s49 offen lds
    s_add_u32 s49, s49, s50
    s_add_u32 m0, s48, 98304
    s_nop 0
    buffer_load_dwordx4 v7, s[24:27], s49 offen lds
    s_add_u32 s49, s49, s50
    s_add_u32 m0, s48, 101376
    s_nop 0
    buffer_load_dwordx4 v7, s[24:27], s49 offen lds
    s_add_u32 s49, s49, s50
    s_add_u32 m0, s48, 104448
    s_nop 0
    buffer_load_dwordx4 v7, s[24:27], s49 offen lds
    s_add_u32 s49, s49, s50
    s_add_u32 m0, s48, 107520
    s_nop 0
    buffer_load_dwordx4 v7, s[24:27], s49 offen lds
    s_add_u32 s49, s49, s50
    s_add_u32 m0, s48, 110592
    s_nop 0
    buffer_load_dwordx4 v7, s[24:27], s49 offen lds
    s_add_u32 s49, s49, s50
    s_add_u32 m0, s48, 113664
    s_nop 0
    buffer_load_dwordx4 v7, s[24:27], s49 offen lds
    s_add_u32 s49, s49, s50
    s_add_u32 m0, s48, 116736
    s_nop 0
    buffer_load_dwordx4 v7, s[24:27], s49 offen lds
    s_add_u32 s49, s49, s50
    s_add_u32 m0, s48, 119808
    s_nop 0
    buffer_load_dwordx4 v7, s[24:27], s49 offen lds
    s_add_u32 s49, s49, s50
    s_waitcnt vmcnt(33)
    s_barrier
    s_add_u32 m0, s48, 122880
    s_nop 0
    buffer_load_dwordx4 v7, s[24:27], s49 offen lds
    s_add_u32 s49, s49, s50
    s_add_u32 m0, s48, 125952
    s_nop 0
    buffer_load_dwordx4 v7, s[24:27], s49 offen lds
    s_add_u32 s49, s49, s50
    s_add_u32 m0, s48, 129024
    s_nop 0
    buffer_load_dwordx4 v7, s[24:27], s49 offen lds
    s_add_u32 s49, s49, s50
    s_add_u32 m0, s48, 132096
    s_nop 0
    buffer_load_dwordx4 v7, s[24:27], s49 offen lds
    s_add_u32 s49, s49, s50
    s_add_u32 m0, s48, 135168
    s_nop 0
    buffer_load_dwordx4 v7, s[24:27], s49 offen lds
    s_add_u32 s49, s49, s50
    s_add_u32 m0, s48, 138240
    s_nop 0
    buffer_load_dwordx4 v7, s[24:27], s49 offen lds
    s_add_u32 s49, s49, s50
    s_add_u32 m0, s48, 141312
    s_nop 0
    buffer_load_dwordx4 v7, s[24:27], s49 offen lds
    s_add_u32 s49, s49, s50
    s_add_u32 m0, s48, 144384
    s_nop 0
    buffer_load_dwordx4 v7, s[24:27], s49 offen lds
    s_add_u32 s49, s49, s50
    s_lshl_b32 s55, s61, 2
    s_add_u32 s55, s55, 58753024
    s_mov_b64 exec, 1
    s_waitcnt vmcnt(24)
    buffer_store_dword v9, v8, s[12:15], s55 offen sc1
    s_mov_b64 exec, -1
    s_barrier
    s_add_u32 m0, s48, 0
    s_nop 0
    buffer_load_dwordx4 v7, s[24:27], s49 offen lds
    s_add_u32 s49, s49, s50
    s_add_u32 m0, s48, 3072
    s_nop 0
    buffer_load_dwordx4 v7, s[24:27], s49 offen lds
    s_add_u32 s49, s49, s50
    s_add_u32 m0, s48, 6144
    s_nop 0
    buffer_load_dwordx4 v7, s[24:27], s49 offen lds
    s_add_u32 s49, s49, s50
    s_add_u32 m0, s48, 9216
    s_nop 0
    buffer_load_dwordx4 v7, s[24:27], s49 offen lds
    s_add_u32 s49, s49, s50
    s_add_u32 m0, s48, 12288
    s_nop 0
    buffer_load_dwordx4 v7, s[24:27], s49 offen lds
    s_add_u32 s49, s49, s50
    s_add_u32 m0, s48, 15360
    s_nop 0
    buffer_load_dwordx4 v7, s[24:27], s49 offen lds
    s_add_u32 s49, s49, s50
    s_add_u32 m0, s48, 18432
    s_nop 0
    buffer_load_dwordx4 v7, s[24:27], s49 offen lds
    s_add_u32 s49, s49, s50
    s_add_u32 m0, s48, 21504
    s_nop 0
    buffer_load_dwordx4 v7, s[24:27], s49 offen lds
    s_add_u32 s49, s49, s50
    buffer_load_dwordx2 v[72:73], v10, s[12:15], s59 offen offset:0 sc1
    buffer_load_dwordx2 v[74:75], v10, s[12:15], s59 offen offset:256 sc1
    buffer_load_dwordx2 v[76:77], v10, s[12:15], s59 offen offset:512 sc1
    buffer_load_dwordx2 v[78:79], v10, s[12:15], s59 offen offset:768 sc1
    s_waitcnt vmcnt(29)
    s_barrier
    s_add_u32 m0, s48, 24576
    s_nop 0
    buffer_load_dwordx4 v7, s[24:27], s49 offen lds
    s_add_u32 s49, s49, s50
    s_add_u32 m0, s48, 27648
    s_nop 0
    buffer_load_dwordx4 v7, s[24:27], s49 offen lds
    s_add_u32 s49, s49, s50
    s_add_u32 m0, s48, 30720
    s_nop 0
    buffer_load_dwordx4 v7, s[24:27], s49 offen lds
    s_add_u32 s49, s49, s50
    s_add_u32 m0, s48, 33792
    s_nop 0
    buffer_load_dwordx4 v7, s[24:27], s49 offen lds
    s_add_u32 s49, s49, s50
    s_add_u32 m0, s48, 36864
    s_nop 0
    buffer_load_dwordx4 v7, s[24:27], s49 offen lds
    s_add_u32 s49, s49, s50
    s_add_u32 m0, s48, 39936
    s_nop 0
    buffer_load_dwordx4 v7, s[24:27], s49 offen lds
    s_add_u32 s49, s49, s50
    s_add_u32 m0, s48, 43008
    s_nop 0
    buffer_load_dwordx4 v7, s[24:27], s49 offen lds
    s_add_u32 s49, s49, s50
    s_add_u32 m0, s48, 46080
    s_nop 0
    buffer_load_dwordx4 v7, s[24:27], s49 offen lds
    s_add_u32 s49, s49, s50
    buffer_load_dwordx2 v[80:81], v10, s[12:15], s59 offen offset:1024 sc1
    buffer_load_dwordx2 v[82:83], v10, s[12:15], s59 offen offset:1280 sc1
    buffer_load_dwordx2 v[84:85], v10, s[12:15], s59 offen offset:1536 sc1
    buffer_load_dwordx2 v[86:87], v10, s[12:15], s59 offen offset:1792 sc1
    s_waitcnt vmcnt(33)
    s_barrier
    s_add_u32 m0, s48, 49152
    s_nop 0
    buffer_load_dwordx4 v7, s[24:27], s49 offen lds
    s_add_u32 s49, s49, s50
    s_add_u32 m0, s48, 52224
    s_nop 0
    buffer_load_dwordx4 v7, s[24:27], s49 offen lds
    s_add_u32 s49, s49, s50
    s_add_u32 m0, s48, 55296
    s_nop 0
    buffer_load_dwordx4 v7, s[24:27], s49 offen lds
    s_add_u32 s49, s49, s50
    s_add_u32 m0, s48, 58368
    s_nop 0
    buffer_load_dwordx4 v7, s[24:27], s49 offen lds
    s_add_u32 s49, s49, s50
    s_add_u32 m0, s48, 61440
    s_nop 0
    buffer_load_dwordx4 v7, s[24:27], s49 offen lds
    s_add_u32 s49, s49, s50
    s_add_u32 m0, s48, 64512
    s_nop 0
    buffer_load_dwordx4 v7, s[24:27], s49 offen lds
    s_add_u32 s49, s49, s50
    s_add_u32 m0, s48, 67584
    s_nop 0
    buffer_load_dwordx4 v7, s[24:27], s49 offen lds
    s_add_u32 s49, s49, s50
    s_add_u32 m0, s48, 70656
    s_nop 0
    buffer_load_dwordx4 v7, s[24:27], s49 offen lds
    s_add_u32 s49, s49, s50
    buffer_load_dwordx2 v[88:89], v10, s[12:15], s59 offen offset:2048 sc1
    buffer_load_dwordx2 v[90:91], v10, s[12:15], s59 offen offset:2304 sc1
    buffer_load_dwordx2 v[92:93], v10, s[12:15], s59 offen offset:2560 sc1
    buffer_load_dwordx2 v[94:95], v10, s[12:15], s59 offen offset:2816 sc1
    s_waitcnt vmcnt(37)
    s_barrier
    s_add_u32 m0, s48, 73728
    s_nop 0
    buffer_load_dwordx4 v7, s[24:27], s49 offen lds
    s_add_u32 s49, s49, s50
    s_add_u32 m0, s48, 76800
    s_nop 0
    buffer_load_dwordx4 v7, s[24:27], s49 offen lds
    s_add_u32 s49, s49, s50
    s_add_u32 m0, s48, 79872
    s_nop 0
    buffer_load_dwordx4 v7, s[24:27], s49 offen lds
    s_add_u32 s49, s49, s50
    s_add_u32 m0, s48, 82944
    s_nop 0
    buffer_load_dwordx4 v7, s[24:27], s49 offen lds
    s_add_u32 s49, s49, s50
    s_add_u32 m0, s48, 86016
    s_nop 0
    buffer_load_dwordx4 v7, s[24:27], s49 offen lds
    s_add_u32 s49, s49, s50
    s_add_u32 m0, s48, 89088
    s_nop 0
    buffer_load_dwordx4 v7, s[24:27], s49 offen lds
    s_add_u32 s49, s49, s50
    s_add_u32 m0, s48, 92160
    s_nop 0
    buffer_load_dwordx4 v7, s[24:27], s49 offen lds
    s_add_u32 s49, s49, s50
    s_add_u32 m0, s48, 95232
    s_nop 0
    buffer_load_dwordx4 v7, s[24:27], s49 offen lds
    s_add_u32 s49, s49, s50
    buffer_load_dwordx2 v[96:97], v10, s[12:15], s59 offen offset:3072 sc1
    buffer_load_dwordx2 v[98:99], v10, s[12:15], s59 offen offset:3328 sc1
    buffer_load_dwordx2 v[100:101], v10, s[12:15], s59 offen offset:3584 sc1
    buffer_load_dwordx2 v[102:103], v10, s[12:15], s59 offen offset:3840 sc1
    s_waitcnt vmcnt(40)
    s_barrier
    s_add_u32 m0, s48, 98304
    s_nop 0
    buffer_load_dwordx4 v7, s[24:27], s49 offen lds
    s_add_u32 s49, s49, s50
    s_add_u32 m0, s48, 101376
    s_nop 0
    buffer_load_dwordx4 v7, s[24:27], s49 offen lds
    s_add_u32 s49, s49, s50
    s_add_u32 m0, s48, 104448
    s_nop 0
    buffer_load_dwordx4 v7, s[24:27], s49 offen lds
    s_add_u32 s49, s49, s50
    s_add_u32 m0, s48, 107520
    s_nop 0
    buffer_load_dwordx4 v7, s[24:27], s49 offen lds
    s_add_u32 s49, s49, s50
    s_add_u32 m0, s48, 110592
    s_nop 0
    buffer_load_dwordx4 v7, s[24:27], s49 offen lds
    s_add_u32 s49, s49, s50
    s_add_u32 m0, s48, 113664
    s_nop 0
    buffer_load_dwordx4 v7, s[24:27], s49 offen lds
    s_add_u32 s49, s49, s50
    s_add_u32 m0, s48, 116736
    s_nop 0
    buffer_load_dwordx4 v7, s[24:27], s49 offen lds
    s_add_u32 s49, s49, s50
    s_add_u32 m0, s48, 119808
    s_nop 0
    buffer_load_dwordx4 v7, s[24:27], s49 offen lds
    s_add_u32 s49, s49, s50
    s_waitcnt vmcnt(36)
    s_barrier
    s_add_u32 m0, s48, 122880
    s_nop 0
    buffer_load_dwordx4 v7, s[24:27], s49 offen lds
    s_add_u32 s49, s49, s50
    s_add_u32 m0, s48, 125952
    s_nop 0
    buffer_load_dwordx4 v7, s[24:27], s49 offen lds
    s_add_u32 s49, s49, s50
    s_add_u32 m0, s48, 129024
    s_nop 0
    buffer_load_dwordx4 v7, s[24:27], s49 offen lds
    s_add_u32 s49, s49, s50
    s_add_u32 m0, s48, 132096
    s_nop 0
    buffer_load_dwordx4 v7, s[24:27], s49 offen lds
    s_add_u32 s49, s49, s50
    s_add_u32 m0, s48, 135168
    s_nop 0
    buffer_load_dwordx4 v7, s[24:27], s49 offen lds
    s_add_u32 s49, s49, s50
    s_add_u32 m0, s48, 138240
    s_nop 0
    buffer_load_dwordx4 v7, s[24:27], s49 offen lds
    s_add_u32 s49, s49, s50
    s_add_u32 m0, s48, 141312
    s_nop 0
    buffer_load_dwordx4 v7, s[24:27], s49 offen lds
    s_add_u32 s49, s49, s50
    s_add_u32 m0, s48, 144384
    s_nop 0
    buffer_load_dwordx4 v7, s[24:27], s49 offen lds
    s_add_u32 s49, s49, s50
    s_waitcnt vmcnt(16)
    v_add_f32 v72, v72, v88
    v_add_f32 v73, v73, v89
    v_add_f32 v74, v74, v90
    v_add_f32 v75, v75, v91
    v_add_f32 v76, v76, v92
    v_add_f32 v77, v77, v93
    v_add_f32 v78, v78, v94
    v_add_f32 v79, v79, v95
    s_barrier
    s_add_u32 m0, s48, 0
    s_nop 0
    buffer_load_dwordx4 v7, s[24:27], s49 offen lds
    s_add_u32 s49, s49, s50
    s_add_u32 m0, s48, 3072
    s_nop 0
    buffer_load_dwordx4 v7, s[24:27], s49 offen lds
    s_add_u32 s49, s49, s50
    s_add_u32 m0, s48, 6144
    s_nop 0
    buffer_load_dwordx4 v7, s[24:27], s49 offen lds
    s_add_u32 s49, s49, s50
    s_add_u32 m0, s48, 9216
    s_nop 0
    buffer_load_dwordx4 v7, s[24:27], s49 offen lds
    s_add_u32 s49, s49, s50
    s_add_u32 m0, s48, 12288
    s_nop 0
    buffer_load_dwordx4 v7, s[24:27], s49 offen lds
    s_add_u32 s49, s49, s50
    s_add_u32 m0, s48, 15360
    s_nop 0
    buffer_load_dwordx4 v7, s[24:27], s49 offen lds
    s_add_u32 s49, s49, s50
    s_add_u32 m0, s48, 18432
    s_nop 0
    buffer_load_dwordx4 v7, s[24:27], s49 offen lds
    s_add_u32 s49, s49, s50
    s_add_u32 m0, s48, 21504
    s_nop 0
    buffer_load_dwordx4 v7, s[24:27], s49 offen lds
    s_add_u32 s49, s49, s50
    v_add_f32 v80, v80, v96
    v_add_f32 v81, v81, v97
    v_add_f32 v82, v82, v98
    v_add_f32 v83, v83, v99
    v_add_f32 v84, v84, v100
    v_add_f32 v85, v85, v101
    v_add_f32 v86, v86, v102
    v_add_f32 v87, v87, v103
    s_barrier
    s_add_u32 m0, s48, 24576
    s_nop 0
    buffer_load_dwordx4 v7, s[24:27], s49 offen lds
    s_add_u32 s49, s49, s50
    s_add_u32 m0, s48, 27648
    s_nop 0
    buffer_load_dwordx4 v7, s[24:27], s49 offen lds
    s_add_u32 s49, s49, s50
    s_add_u32 m0, s48, 30720
    s_nop 0
    buffer_load_dwordx4 v7, s[24:27], s49 offen lds
    s_add_u32 s49, s49, s50
    s_add_u32 m0, s48, 33792
    s_nop 0
    buffer_load_dwordx4 v7, s[24:27], s49 offen lds
    s_add_u32 s49, s49, s50
    s_add_u32 m0, s48, 36864
    s_nop 0
    buffer_load_dwordx4 v7, s[24:27], s49 offen lds
    s_add_u32 s49, s49, s50
    s_add_u32 m0, s48, 39936
    s_nop 0
    buffer_load_dwordx4 v7, s[24:27], s49 offen lds
    s_add_u32 s49, s49, s50
    s_add_u32 m0, s48, 43008
    s_nop 0
    buffer_load_dwordx4 v7, s[24:27], s49 offen lds
    s_add_u32 s49, s49, s50
    s_add_u32 m0, s48, 46080
    s_nop 0
    buffer_load_dwordx4 v7, s[24:27], s49 offen lds
    s_add_u32 s49, s49, s50
    v_add_f32 v72, v72, v80
    v_add_f32 v73, v73, v81
    v_add_f32 v74, v74, v82
    v_add_f32 v75, v75, v83
    v_add_f32 v76, v76, v84
    v_add_f32 v77, v77, v85
    v_add_f32 v78, v78, v86
    v_add_f32 v79, v79, v87
    s_waitcnt vmcnt(24)
    s_barrier
    s_add_u32 m0, s48, 49152
    s_nop 0
    buffer_load_dwordx4 v7, s[24:27], s49 offen lds
    s_add_u32 s49, s49, s50
    s_add_u32 m0, s48, 52224
    s_nop 0
    buffer_load_dwordx4 v7, s[24:27], s49 offen lds
    s_add_u32 s49, s49, s50
    s_add_u32 m0, s48, 55296
    s_nop 0
    buffer_load_dwordx4 v7, s[24:27], s49 offen lds
    s_add_u32 s49, s49, s50
    s_add_u32 m0, s48, 58368
    s_nop 0
    buffer_load_dwordx4 v7, s[24:27], s49 offen lds
    s_add_u32 s49, s49, s50
    s_add_u32 m0, s48, 61440
    s_nop 0
    buffer_load_dwordx4 v7, s[24:27], s49 offen lds
    s_add_u32 s49, s49, s50
    s_add_u32 m0, s48, 64512
    s_nop 0
    buffer_load_dwordx4 v7, s[24:27], s49 offen lds
    s_add_u32 s49, s49, s50
    s_add_u32 m0, s48, 67584
    s_nop 0
    buffer_load_dwordx4 v7, s[24:27], s49 offen lds
    s_add_u32 s49, s49, s50
    s_add_u32 m0, s48, 70656
    s_nop 0
    buffer_load_dwordx4 v7, s[24:27], s49 offen lds
    s_add_u32 s49, s49, s50
    v_add_f32 v72, v72, v76
    v_add_f32 v73, v73, v77
    v_add_f32 v74, v74, v78
    v_add_f32 v75, v75, v79
    v_add_f32 v72, v72, v74
    v_add_f32 v73, v73, v75
    v_mul_f32 v72, 0x3a800000, v72
    v_mul_f32 v73, 0x3a800000, v73
    s_waitcnt vmcnt(24)
    s_barrier
    s_add_u32 m0, s48, 73728
    s_nop 0
    buffer_load_dwordx4 v7, s[24:27], s49 offen lds
    s_add_u32 s49, s49, s50
    s_add_u32 m0, s48, 76800
    s_nop 0
    buffer_load_dwordx4 v7, s[24:27], s49 offen lds
    s_add_u32 s49, s49, s50
    s_add_u32 m0, s48, 79872
    s_nop 0
    buffer_load_dwordx4 v7, s[24:27], s49 offen lds
    s_add_u32 s49, s49, s50
    s_add_u32 m0, s48, 82944
    s_nop 0
    buffer_load_dwordx4 v7, s[24:27], s49 offen lds
    s_add_u32 s49, s49, s50
    s_add_u32 m0, s48, 86016
    s_nop 0
    buffer_load_dwordx4 v7, s[24:27], s49 offen lds
    s_add_u32 s49, s49, s50
    s_add_u32 m0, s48, 89088
    s_nop 0
    buffer_load_dwordx4 v7, s[24:27], s49 offen lds
    s_add_u32 s49, s49, s50
    s_add_u32 m0, s48, 92160
    s_nop 0
    buffer_load_dwordx4 v7, s[24:27], s49 offen lds
    s_add_u32 s49, s49, s50
    s_add_u32 m0, s48, 95232
    s_nop 0
    buffer_load_dwordx4 v7, s[24:27], s49 offen lds
    s_add_u32 s49, s49, s50
    v_fma_f32 v73, -v72, v72, v73
    v_max_f32 v73, 0, v73
    v_add_f32 v73, 0x3727c5ac, v73
    v_rsq_f32 v73, v73
    ds_write_b32 v11, v72 offset:1280
    ds_write_b32 v11, v73 offset:2304
    s_waitcnt lgkmcnt(0)
    s_waitcnt vmcnt(24)
    s_barrier
    s_waitcnt vmcnt(16)
    s_barrier
    s_waitcnt vmcnt(8)
    s_barrier
    s_waitcnt vmcnt(0)
    s_barrier
    s_mov_b32 s20, s40
    s_mov_b32 s21, s41
    s_mov_b32 s22, 6291456
    s_mov_b32 s23, 0x00020000
    s_mul_i32 s55, s62, 393216
    s_lshl_b32 s56, s63, 7
    s_add_u32 s55, s55, s56
    buffer_load_dwordx4 v[32:35], v12, s[20:23], s55 offen
    s_add_u32 s55, s55, 49152
    buffer_load_dwordx4 v[36:39], v12, s[20:23], s55 offen
    s_add_u32 s55, s55, 49152
    buffer_load_dwordx4 v[40:43], v12, s[20:23], s55 offen
    s_add_u32 s55, s55, 49152
    buffer_load_dwordx4 v[44:47], v12, s[20:23], s55 offen
    s_add_u32 s55, s55, 49152
    buffer_load_dwordx4 v[48:51], v12, s[20:23], s55 offen
    s_add_u32 s55, s55, 49152
    buffer_load_dwordx4 v[52:55], v12, s[20:23], s55 offen
    s_add_u32 s55, s55, 49152
    buffer_load_dwordx4 v[56:59], v12, s[20:23], s55 offen
    s_add_u32 s55, s55, 49152
    buffer_load_dwordx4 v[60:63], v12, s[20:23], s55 offen
    s_add_u32 s55, s55, 49152
    s_barrier
    s_mov_b32 s24, s36
    s_mov_b32 s25, s37
    s_mov_b32 s26, 2097152
    s_mov_b32 s27, 0x00020000
    s_mov_b32 s60, s51
wop_10:
    s_lshl_b32 m0, s60, 10
    s_lshl_b32 s3, s60, 14
    buffer_load_dwordx4 v17, s[24:27], s3 offen lds
    s_add_u32 s60, s60, 3
    s_cmp_lt_u32 s60, 24
    s_cbranch_scc1 wop_10
    s_barrier
    s_waitcnt vmcnt(8)
    v_mfma_f32_16x16x32_bf16 v[64:67], v[24:27], v[32:35], 0
    v_mfma_f32_16x16x32_bf16 v[64:67], v[24:27], v[36:39], v[64:67]
    v_mfma_f32_16x16x32_bf16 v[64:67], v[24:27], v[40:43], v[64:67]
    v_mfma_f32_16x16x32_bf16 v[64:67], v[24:27], v[44:47], v[64:67]
    v_mfma_f32_16x16x32_bf16 v[64:67], v[24:27], v[48:51], v[64:67]
    v_mfma_f32_16x16x32_bf16 v[64:67], v[24:27], v[52:55], v[64:67]
    v_mfma_f32_16x16x32_bf16 v[64:67], v[24:27], v[56:59], v[64:67]
    v_mfma_f32_16x16x32_bf16 v[64:67], v[24:27], v[60:63], v[64:67]
    s_lshr_b32 s55, s63, 4
    s_and_b32 s56, s63, 15
    s_mul_i32 s57, s56, 6
    s_add_u32 s57, s57, s55
    s_lshl_b32 s57, s57, 16
    s_lshl_b32 s58, s62, 12
    s_add_u32 s57, s57, s58
    s_add_u32 s57, s57, 50331648
    buffer_store_dwordx4 v[32:35], v14, s[12:15], s57 offen offset:0 sc1
    buffer_store_dwordx4 v[36:39], v14, s[12:15], s57 offen offset:512 sc1
    buffer_store_dwordx4 v[40:43], v14, s[12:15], s57 offen offset:1024 sc1
    buffer_store_dwordx4 v[44:47], v14, s[12:15], s57 offen offset:1536 sc1
    buffer_store_dwordx4 v[48:51], v14, s[12:15], s57 offen offset:2048 sc1
    buffer_store_dwordx4 v[52:55], v14, s[12:15], s57 offen offset:2560 sc1
    buffer_store_dwordx4 v[56:59], v14, s[12:15], s57 offen offset:3072 sc1
    buffer_store_dwordx4 v[60:63], v14, s[12:15], s57 offen offset:3584 sc1
    v_add_f32_dpp v64, v64, v64 row_ror:8 row_mask:0xf bank_mask:0xf
    v_add_f32_dpp v65, v65, v65 row_ror:8 row_mask:0xf bank_mask:0xf
    v_add_f32_dpp v66, v66, v66 row_ror:8 row_mask:0xf bank_mask:0xf
    v_add_f32_dpp v67, v67, v67 row_ror:8 row_mask:0xf bank_mask:0xf
    s_lshl_b32 s55, s61, 8
    s_add_u32 s55, s55, 58982400
    s_mov_b64 exec, 0x00ff00ff
    buffer_store_dwordx4 v[64:67], v16, s[12:15], s55 offen sc1
    s_mov_b64 exec, -1
wop_11:
    s_lshl_b32 m0, s60, 10
    s_lshl_b32 s3, s60, 14
    buffer_load_dwordx4 v17, s[24:27], s3 offen lds
    s_add_u32 s60, s60, 3
    s_cmp_lt_u32 s60, 128
    s_cbranch_scc1 wop_11
    s_lshl_b32 s55, s61, 2
    s_add_u32 s55, s55, 58756096
    s_mov_b64 exec, 1
    s_waitcnt vmcnt(34)
    buffer_store_dword v9, v8, s[12:15], s55 offen sc1
    s_mov_b64 exec, -1
    s_branch l_wo
.p2align 6
l_qkva:
    v_and_b32 v1, 63, v0
    s_sub_u32 s51, s8, 5
    s_lshl_b32 s48, s51, 10
    v_lshrrev_b32 v20, 3, v1
    v_and_b32 v22, 2, v20
    v_lshrrev_b32 v23, 2, v20
    v_or_b32 v22, v22, v23
    v_bfe_u32 v21, v1, 1, 2
    v_xor_b32 v22, v22, v21
    v_lshlrev_b32 v22, 5, v22
    v_and_b32 v21, 1, v1
    v_lshl_add_u32 v22, v21, 4, v22
    s_lshl_b32 s3, s51, 11
    s_lshl_b32 s52, s7, 7
    s_add_u32 s49, s3, s52
    v_lshl_add_u32 v28, v20, 7, v22
    v_mul_u32_u24 v23, 6144, v20
    v_add_u32 v7, v23, v22
    s_mov_b32 s24, s34
    s_mov_b32 s25, s35
    s_mov_b32 s26, 6291456
    s_mov_b32 s27, 0x00020000
    s_mov_b32 s50, 49152
    s_and_b32 s3, s7, 7
    s_cmp_lg_u32 s3, 3
    s_cbranch_scc1 sw_12
    s_add_u32 s24, s4, 56623104
    s_addc_u32 s25, s5, 0
    s_mov_b32 s26, 1048576
    s_mov_b32 s27, 0x00020000
    s_lshr_b32 s49, s7, 3
    s_mul_i32 s49, s49, 3
    s_add_u32 s49, s49, s51
    s_lshl_b32 s49, s49, 17
    s_add_u32 s49, s49, 0
    s_movk_i32 s50, 1024
    v_mov_b32 v7, v28
sw_12:
    s_add_u32 m0, s48, 0
    s_nop 0
    buffer_load_dwordx4 v7, s[24:27], s49 offen lds
    s_add_u32 s49, s49, s50
    s_add_u32 m0, s48, 3072
    s_nop 0
    buffer_load_dwordx4 v7, s[24:27], s49 offen lds
    s_add_u32 s49, s49, s50
    s_add_u32 m0, s48, 6144
    s_nop 0
    buffer_load_dwordx4 v7, s[24:27], s49 offen lds
    s_add_u32 s49, s49, s50
    s_add_u32 m0, s48, 9216
    s_nop 0
    buffer_load_dwordx4 v7, s[24:27], s49 offen lds
    s_add_u32 s49, s49, s50
    s_add_u32 m0, s48, 12288
    s_nop 0
    buffer_load_dwordx4 v7, s[24:27], s49 offen lds
    s_add_u32 s49, s49, s50
    s_add_u32 m0, s48, 15360
    s_nop 0
    buffer_load_dwordx4 v7, s[24:27], s49 offen lds
    s_add_u32 s49, s49, s50
    s_add_u32 m0, s48, 18432
    s_nop 0
    buffer_load_dwordx4 v7, s[24:27], s49 offen lds
    s_add_u32 s49, s49, s50
    s_add_u32 m0, s48, 21504
    s_nop 0
    buffer_load_dwordx4 v7, s[24:27], s49 offen lds
    s_add_u32 s49, s49, s50
    s_waitcnt vmcnt(7)
    s_add_u32 m0, s48, 24576
    s_nop 0
    buffer_load_dwordx4 v7, s[24:27], s49 offen lds
    s_add_u32 s49, s49, s50
    s_waitcnt vmcnt(7)
    s_add_u32 m0, s48, 27648
    s_nop 0
    buffer_load_dwordx4 v7, s[24:27], s49 offen lds
    s_add_u32 s49, s49, s50
    s_waitcnt vmcnt(7)
    s_add_u32 m0, s48, 30720
    s_nop 0
    buffer_load_dwordx4 v7, s[24:27], s49 offen lds
    s_add_u32 s49, s49, s50
    s_waitcnt vmcnt(7)
    s_add_u32 m0, s48, 33792
    s_nop 0
    buffer_load_dwordx4 v7, s[24:27], s49 offen lds
    s_add_u32 s49, s49, s50
    s_waitcnt vmcnt(7)
    s_add_u32 m0, s48, 36864
    s_nop 0
    buffer_load_dwordx4 v7, s[24:27], s49 offen lds
    s_add_u32 s49, s49, s50
    s_waitcnt vmcnt(7)
    s_add_u32 m0, s48, 39936
    s_nop 0
    buffer_load_dwordx4 v7, s[24:27], s49 offen lds
    s_add_u32 s49, s49, s50
    s_waitcnt vmcnt(7)
    s_add_u32 m0, s48, 43008
    s_nop 0
    buffer_load_dwordx4 v7, s[24:27], s49 offen lds
    s_add_u32 s49, s49, s50
    s_waitcnt vmcnt(7)
    s_add_u32 m0, s48, 46080
    s_nop 0
    buffer_load_dwordx4 v7, s[24:27], s49 offen lds
    s_add_u32 s49, s49, s50
    s_waitcnt vmcnt(7)
    s_add_u32 m0, s48, 49152
    s_nop 0
    buffer_load_dwordx4 v7, s[24:27], s49 offen lds
    s_add_u32 s49, s49, s50
    s_waitcnt vmcnt(7)
    s_add_u32 m0, s48, 52224
    s_nop 0
    buffer_load_dwordx4 v7, s[24:27], s49 offen lds
    s_add_u32 s49, s49, s50
    s_waitcnt vmcnt(7)
    s_add_u32 m0, s48, 55296
    s_nop 0
    buffer_load_dwordx4 v7, s[24:27], s49 offen lds
    s_add_u32 s49, s49, s50
    s_waitcnt vmcnt(7)
    s_add_u32 m0, s48, 58368
    s_nop 0
    buffer_load_dwordx4 v7, s[24:27], s49 offen lds
    s_add_u32 s49, s49, s50
    s_waitcnt vmcnt(7)
    s_add_u32 m0, s48, 61440
    s_nop 0
    buffer_load_dwordx4 v7, s[24:27], s49 offen lds
    s_add_u32 s49, s49, s50
    s_waitcnt vmcnt(7)
    s_add_u32 m0, s48, 64512
    s_nop 0
    buffer_load_dwordx4 v7, s[24:27], s49 offen lds
    s_add_u32 s49, s49, s50
    s_waitcnt vmcnt(7)
    s_add_u32 m0, s48, 67584
    s_nop 0
    buffer_load_dwordx4 v7, s[24:27], s49 offen lds
    s_add_u32 s49, s49, s50
    s_waitcnt vmcnt(7)
    s_add_u32 m0, s48, 70656
    s_nop 0
    buffer_load_dwordx4 v7, s[24:27], s49 offen lds
    s_add_u32 s49, s49, s50
    s_waitcnt vmcnt(7)
    s_add_u32 m0, s48, 73728
    s_nop 0
    buffer_load_dwordx4 v7, s[24:27], s49 offen lds
    s_add_u32 s49, s49, s50
    s_waitcnt vmcnt(7)
    s_add_u32 m0, s48, 76800
    s_nop 0
    buffer_load_dwordx4 v7, s[24:27], s49 offen lds
    s_add_u32 s49, s49, s50
    s_waitcnt vmcnt(7)
    s_add_u32 m0, s48, 79872
    s_nop 0
    buffer_load_dwordx4 v7, s[24:27], s49 offen lds
    s_add_u32 s49, s49, s50
    s_waitcnt vmcnt(7)
    s_add_u32 m0, s48, 82944
    s_nop 0
    buffer_load_dwordx4 v7, s[24:27], s49 offen lds
    s_add_u32 s49, s49, s50
    s_waitcnt vmcnt(7)
    s_add_u32 m0, s48, 86016
    s_nop 0
    buffer_load_dwordx4 v7, s[24:27], s49 offen lds
    s_add_u32 s49, s49, s50
    s_waitcnt vmcnt(7)
    s_add_u32 m0, s48, 89088
    s_nop 0
    buffer_load_dwordx4 v7, s[24:27], s49 offen lds
    s_add_u32 s49, s49, s50
    s_waitcnt vmcnt(7)
    s_add_u32 m0, s48, 92160
    s_nop 0
    buffer_load_dwordx4 v7, s[24:27], s49 offen lds
    s_add_u32 s49, s49, s50
    s_waitcnt vmcnt(7)
    s_add_u32 m0, s48, 95232
    s_nop 0
    buffer_load_dwordx4 v7, s[24:27], s49 offen lds
    s_add_u32 s49, s49, s50
    s_waitcnt vmcnt(7)
    s_add_u32 m0, s48, 98304
    s_nop 0
    buffer_load_dwordx4 v7, s[24:27], s49 offen lds
    s_add_u32 s49, s49, s50
    s_waitcnt vmcnt(7)
    s_add_u32 m0, s48, 101376
    s_nop 0
    buffer_load_dwordx4 v7, s[24:27], s49 offen lds
    s_add_u32 s49, s49, s50
    s_waitcnt vmcnt(7)
    s_add_u32 m0, s48, 104448
    s_nop 0
    buffer_load_dwordx4 v7, s[24:27], s49 offen lds
    s_add_u32 s49, s49, s50
    s_waitcnt vmcnt(7)
    s_add_u32 m0, s48, 107520
    s_nop 0
    buffer_load_dwordx4 v7, s[24:27], s49 offen lds
    s_add_u32 s49, s49, s50
    s_waitcnt vmcnt(7)
    s_add_u32 m0, s48, 110592
    s_nop 0
    buffer_load_dwordx4 v7, s[24:27], s49 offen lds
    s_add_u32 s49, s49, s50
    s_waitcnt vmcnt(7)
    s_add_u32 m0, s48, 113664
    s_nop 0
    buffer_load_dwordx4 v7, s[24:27], s49 offen lds
    s_add_u32 s49, s49, s50
    s_waitcnt vmcnt(7)
    s_add_u32 m0, s48, 116736
    s_nop 0
    buffer_load_dwordx4 v7, s[24:27], s49 offen lds
    s_add_u32 s49, s49, s50
    s_waitcnt vmcnt(7)
    s_add_u32 m0, s48, 119808
    s_nop 0
    buffer_load_dwordx4 v7, s[24:27], s49 offen lds
    s_add_u32 s49, s49, s50
    s_waitcnt vmcnt(7)
    v_lshrrev_b32 v10, 5, v1
    v_and_b32 v11, 31, v1
    v_lshlrev_b32 v11, 3, v11
    v_lshl_add_u32 v10, v10, 12, v11
    s_lshl_b32 s3, s51, 8
    s_add_u32 s3, s3, 155648
    v_lshl_add_u32 v11, v1, 2, s3
    s_lshl_b32 s59, s6, 1
    s_add_u32 s59, s59, s51
    s_sub_u32 s59, s59, 1
    s_max_i32 s59, s59, 0
    s_lshl_b32 s59, s59, 13
    s_lshl_b32 s53, s9, 18
    s_add_u32 s59, s59, s53
    s_add_u32 s59, s59, 57671680
    s_lshl_b32 s3, s7, 7
    v_lshrrev_b32 v20, 3, v1
    v_lshlrev_b32 v21, 11, v20
    v_lshrrev_b32 v22, 2, v1
    v_lshrrev_b32 v23, 4, v1
    v_xor_b32 v22, v22, v23
    v_and_b32 v22, 1, v22
    v_lshl_add_u32 v21, v22, 6, v21
    v_and_b32 v22, 3, v1
    v_lshl_add_u32 v21, v22, 4, v21
    v_add_u32 v17, s3, v21
    s_barrier
    s_barrier
    s_barrier
    s_add_u32 m0, s48, 122880
    s_nop 0
    buffer_load_dwordx4 v7, s[24:27], s49 offen lds
    s_add_u32 s49, s49, s50
    s_add_u32 m0, s48, 125952
    s_nop 0
    buffer_load_dwordx4 v7, s[24:27], s49 offen lds
    s_add_u32 s49, s49, s50
    s_add_u32 m0, s48, 129024
    s_nop 0
    buffer_load_dwordx4 v7, s[24:27], s49 offen lds
    s_add_u32 s49, s49, s50
    s_add_u32 m0, s48, 132096
    s_nop 0
    buffer_load_dwordx4 v7, s[24:27], s49 offen lds
    s_add_u32 s49, s49, s50
    s_add_u32 m0, s48, 135168
    s_nop 0
    buffer_load_dwordx4 v7, s[24:27], s49 offen lds
    s_add_u32 s49, s49, s50
    s_add_u32 m0, s48, 138240
    s_nop 0
    buffer_load_dwordx4 v7, s[24:27], s49 offen lds
    s_add_u32 s49, s49, s50
    s_add_u32 m0, s48, 141312
    s_nop 0
    buffer_load_dwordx4 v7, s[24:27], s49 offen lds
    s_add_u32 s49, s49, s50
    s_add_u32 m0, s48, 144384
    s_nop 0
    buffer_load_dwordx4 v7, s[24:27], s49 offen lds
    s_add_u32 s49, s49, s50
    s_barrier
    s_add_u32 m0, s48, 0
    s_nop 0
    buffer_load_dwordx4 v7, s[24:27], s49 offen lds
    s_add_u32 s49, s49, s50
    s_add_u32 m0, s48, 3072
    s_nop 0
    buffer_load_dwordx4 v7, s[24:27], s49 offen lds
    s_add_u32 s49, s49, s50
    s_add_u32 m0, s48, 6144
    s_nop 0
    buffer_load_dwordx4 v7, s[24:27], s49 offen lds
    s_add_u32 s49, s49, s50
    s_add_u32 m0, s48, 9216
    s_nop 0
    buffer_load_dwordx4 v7, s[24:27], s49 offen lds
    s_add_u32 s49, s49, s50
    s_add_u32 m0, s48, 12288
    s_nop 0
    buffer_load_dwordx4 v7, s[24:27], s49 offen lds
    s_add_u32 s49, s49, s50
    s_add_u32 m0, s48, 15360
    s_nop 0
    buffer_load_dwordx4 v7, s[24:27], s49 offen lds
    s_add_u32 s49, s49, s50
    s_add_u32 m0, s48, 18432
    s_nop 0
    buffer_load_dwordx4 v7, s[24:27], s49 offen lds
    s_add_u32 s49, s49, s50
    s_add_u32 m0, s48, 21504
    s_nop 0
    buffer_load_dwordx4 v7, s[24:27], s49 offen lds
    s_add_u32 s49, s49, s50
    buffer_load_dwordx2 v[72:73], v10, s[12:15], s59 offen offset:0 sc1
    buffer_load_dwordx2 v[74:75], v10, s[12:15], s59 offen offset:256 sc1
    buffer_load_dwordx2 v[76:77], v10, s[12:15], s59 offen offset:512 sc1
    buffer_load_dwordx2 v[78:79], v10, s[12:15], s59 offen offset:768 sc1
    s_barrier
    s_add_u32 m0, s48, 24576
    s_nop 0
    buffer_load_dwordx4 v7, s[24:27], s49 offen lds
    s_add_u32 s49, s49, s50
    s_add_u32 m0, s48, 27648
    s_nop 0
    buffer_load_dwordx4 v7, s[24:27], s49 offen lds
    s_add_u32 s49, s49, s50
    s_add_u32 m0, s48, 30720
    s_nop 0
    buffer_load_dwordx4 v7, s[24:27], s49 offen lds
    s_add_u32 s49, s49, s50
    s_add_u32 m0, s48, 33792
    s_nop 0
    buffer_load_dwordx4 v7, s[24:27], s49 offen lds
    s_add_u32 s49, s49, s50
    s_add_u32 m0, s48, 36864
    s_nop 0
    buffer_load_dwordx4 v7, s[24:27], s49 offen lds
    s_add_u32 s49, s49, s50
    s_add_u32 m0, s48, 39936
    s_nop 0
    buffer_load_dwordx4 v7, s[24:27], s49 offen lds
    s_add_u32 s49, s49, s50
    s_add_u32 m0, s48, 43008
    s_nop 0
    buffer_load_dwordx4 v7, s[24:27], s49 offen lds
    s_add_u32 s49, s49, s50
    s_add_u32 m0, s48, 46080
    s_nop 0
    buffer_load_dwordx4 v7, s[24:27], s49 offen lds
    s_add_u32 s49, s49, s50
    buffer_load_dwordx2 v[80:81], v10, s[12:15], s59 offen offset:1024 sc1
    buffer_load_dwordx2 v[82:83], v10, s[12:15], s59 offen offset:1280 sc1
    buffer_load_dwordx2 v[84:85], v10, s[12:15], s59 offen offset:1536 sc1
    buffer_load_dwordx2 v[86:87], v10, s[12:15], s59 offen offset:1792 sc1
    s_waitcnt vmcnt(32)
    s_barrier
    s_add_u32 m0, s48, 49152
    s_nop 0
    buffer_load_dwordx4 v7, s[24:27], s49 offen lds
    s_add_u32 s49, s49, s50
    s_add_u32 m0, s48, 52224
    s_nop 0
    buffer_load_dwordx4 v7, s[24:27], s49 offen lds
    s_add_u32 s49, s49, s50
    s_add_u32 m0, s48, 55296
    s_nop 0
    buffer_load_dwordx4 v7, s[24:27], s49 offen lds
    s_add_u32 s49, s49, s50
    s_add_u32 m0, s48, 58368
    s_nop 0
    buffer_load_dwordx4 v7, s[24:27], s49 offen lds
    s_add_u32 s49, s49, s50
    s_add_u32 m0, s48, 61440
    s_nop 0
    buffer_load_dwordx4 v7, s[24:27], s49 offen lds
    s_add_u32 s49, s49, s50
    s_add_u32 m0, s48, 64512
    s_nop 0
    buffer_load_dwordx4 v7, s[24:27], s49 offen lds
    s_add_u32 s49, s49, s50
    s_add_u32 m0, s48, 67584
    s_nop 0
    buffer_load_dwordx4 v7, s[24:27], s49 offen lds
    s_add_u32 s49, s49, s50
    s_add_u32 m0, s48, 70656
    s_nop 0
    buffer_load_dwordx4 v7, s[24:27], s49 offen lds
    s_add_u32 s49, s49, s50
    buffer_load_dwordx2 v[88:89], v10, s[12:15], s59 offen offset:2048 sc1
    buffer_load_dwordx2 v[90:91], v10, s[12:15], s59 offen offset:2304 sc1
    buffer_load_dwordx2 v[92:93], v10, s[12:15], s59 offen offset:2560 sc1
    buffer_load_dwordx2 v[94:95], v10, s[12:15], s59 offen offset:2816 sc1
    s_waitcnt vmcnt(36)
    s_barrier
    s_add_u32 m0, s48, 73728
    s_nop 0
    buffer_load_dwordx4 v7, s[24:27], s49 offen lds
    s_add_u32 s49, s49, s50
    s_add_u32 m0, s48, 76800
    s_nop 0
    buffer_load_dwordx4 v7, s[24:27], s49 offen lds
    s_add_u32 s49, s49, s50
    s_add_u32 m0, s48, 79872
    s_nop 0
    buffer_load_dwordx4 v7, s[24:27], s49 offen lds
    s_add_u32 s49, s49, s50
    s_add_u32 m0, s48, 82944
    s_nop 0
    buffer_load_dwordx4 v7, s[24:27], s49 offen lds
    s_add_u32 s49, s49, s50
    s_add_u32 m0, s48, 86016
    s_nop 0
    buffer_load_dwordx4 v7, s[24:27], s49 offen lds
    s_add_u32 s49, s49, s50
    s_add_u32 m0, s48, 89088
    s_nop 0
    buffer_load_dwordx4 v7, s[24:27], s49 offen lds
    s_add_u32 s49, s49, s50
    s_add_u32 m0, s48, 92160
    s_nop 0
    buffer_load_dwordx4 v7, s[24:27], s49 offen lds
    s_add_u32 s49, s49, s50
    s_add_u32 m0, s48, 95232
    s_nop 0
    buffer_load_dwordx4 v7, s[24:27], s49 offen lds
    s_add_u32 s49, s49, s50
    buffer_load_dwordx2 v[96:97], v10, s[12:15], s59 offen offset:3072 sc1
    buffer_load_dwordx2 v[98:99], v10, s[12:15], s59 offen offset:3328 sc1
    buffer_load_dwordx2 v[100:101], v10, s[12:15], s59 offen offset:3584 sc1
    buffer_load_dwordx2 v[102:103], v10, s[12:15], s59 offen offset:3840 sc1
    s_waitcnt vmcnt(40)
    s_barrier
    s_add_u32 m0, s48, 98304
    s_nop 0
    buffer_load_dwordx4 v7, s[24:27], s49 offen lds
    s_add_u32 s49, s49, s50
    s_add_u32 m0, s48, 101376
    s_nop 0
    buffer_load_dwordx4 v7, s[24:27], s49 offen lds
    s_add_u32 s49, s49, s50
    s_add_u32 m0, s48, 104448
    s_nop 0
    buffer_load_dwordx4 v7, s[24:27], s49 offen lds
    s_add_u32 s49, s49, s50
    s_add_u32 m0, s48, 107520
    s_nop 0
    buffer_load_dwordx4 v7, s[24:27], s49 offen lds
    s_add_u32 s49, s49, s50
    s_add_u32 m0, s48, 110592
    s_nop 0
    buffer_load_dwordx4 v7, s[24:27], s49 offen lds
    s_add_u32 s49, s49, s50
    s_add_u32 m0, s48, 113664
    s_nop 0
    buffer_load_dwordx4 v7, s[24:27], s49 offen lds
    s_add_u32 s49, s49, s50
    s_add_u32 m0, s48, 116736
    s_nop 0
    buffer_load_dwordx4 v7, s[24:27], s49 offen lds
    s_add_u32 s49, s49, s50
    s_add_u32 m0, s48, 119808
    s_nop 0
    buffer_load_dwordx4 v7, s[24:27], s49 offen lds
    s_add_u32 s49, s49, s50
    s_waitcnt vmcnt(36)
    s_barrier
    s_add_u32 m0, s48, 122880
    s_nop 0
    buffer_load_dwordx4 v7, s[24:27], s49 offen lds
    s_add_u32 s49, s49, s50
    s_add_u32 m0, s48, 125952
    s_nop 0
    buffer_load_dwordx4 v7, s[24:27], s49 offen lds
    s_add_u32 s49, s49, s50
    s_add_u32 m0, s48, 129024
    s_nop 0
    buffer_load_dwordx4 v7, s[24:27], s49 offen lds
    s_add_u32 s49, s49, s50
    s_add_u32 m0, s48, 132096
    s_nop 0
    buffer_load_dwordx4 v7, s[24:27], s49 offen lds
    s_add_u32 s49, s49, s50
    s_add_u32 m0, s48, 135168
    s_nop 0
    buffer_load_dwordx4 v7, s[24:27], s49 offen lds
    s_add_u32 s49, s49, s50
    s_add_u32 m0, s48, 138240
    s_nop 0
    buffer_load_dwordx4 v7, s[24:27], s49 offen lds
    s_add_u32 s49, s49, s50
    s_add_u32 m0, s48, 141312
    s_nop 0
    buffer_load_dwordx4 v7, s[24:27], s49 offen lds
    s_add_u32 s49, s49, s50
    s_add_u32 m0, s48, 144384
    s_nop 0
    buffer_load_dwordx4 v7, s[24:27], s49 offen lds
    s_add_u32 s49, s49, s50
    s_waitcnt vmcnt(16)
    v_add_f32 v72, v72, v88
    v_add_f32 v73, v73, v89
    v_add_f32 v74, v74, v90
    v_add_f32 v75, v75, v91
    v_add_f32 v76, v76, v92
    v_add_f32 v77, v77, v93
    v_add_f32 v78, v78, v94
    v_add_f32 v79, v79, v95
    s_barrier
    s_add_u32 m0, s48, 0
    s_nop 0
    buffer_load_dwordx4 v7, s[24:27], s49 offen lds
    s_add_u32 s49, s49, s50
    s_add_u32 m0, s48, 3072
    s_nop 0
    buffer_load_dwordx4 v7, s[24:27], s49 offen lds
    s_add_u32 s49, s49, s50
    s_add_u32 m0, s48, 6144
    s_nop 0
    buffer_load_dwordx4 v7, s[24:27], s49 offen lds
    s_add_u32 s49, s49, s50
    s_add_u32 m0, s48, 9216
    s_nop 0
    buffer_load_dwordx4 v7, s[24:27], s49 offen lds
    s_add_u32 s49, s49, s50
    s_add_u32 m0, s48, 12288
    s_nop 0
    buffer_load_dwordx4 v7, s[24:27], s49 offen lds
    s_add_u32 s49, s49, s50
    s_add_u32 m0, s48, 15360
    s_nop 0
    buffer_load_dwordx4 v7, s[24:27], s49 offen lds
    s_add_u32 s49, s49, s50
    s_add_u32 m0, s48, 18432
    s_nop 0
    buffer_load_dwordx4 v7, s[24:27], s49 offen lds
    s_add_u32 s49, s49, s50
    s_add_u32 m0, s48, 21504
    s_nop 0
    buffer_load_dwordx4 v7, s[24:27], s49 offen lds
    s_add_u32 s49, s49, s50
    v_add_f32 v80, v80, v96
    v_add_f32 v81, v81, v97
    v_add_f32 v82, v82, v98
    v_add_f32 v83, v83, v99
    v_add_f32 v84, v84, v100
    v_add_f32 v85, v85, v101
    v_add_f32 v86, v86, v102
    v_add_f32 v87, v87, v103
    s_barrier
    s_add_u32 m0, s48, 24576
    s_nop 0
    buffer_load_dwordx4 v7, s[24:27], s49 offen lds
    s_add_u32 s49, s49, s50
    s_add_u32 m0, s48, 27648
    s_nop 0
    buffer_load_dwordx4 v7, s[24:27], s49 offen lds
    s_add_u32 s49, s49, s50
    s_add_u32 m0, s48, 30720
    s_nop 0
    buffer_load_dwordx4 v7, s[24:27], s49 offen lds
    s_add_u32 s49, s49, s50
    s_add_u32 m0, s48, 33792
    s_nop 0
    buffer_load_dwordx4 v7, s[24:27], s49 offen lds
    s_add_u32 s49, s49, s50
    s_add_u32 m0, s48, 36864
    s_nop 0
    buffer_load_dwordx4 v7, s[24:27], s49 offen lds
    s_add_u32 s49, s49, s50
    s_add_u32 m0, s48, 39936
    s_nop 0
    buffer_load_dwordx4 v7, s[24:27], s49 offen lds
    s_add_u32 s49, s49, s50
    s_add_u32 m0, s48, 43008
    s_nop 0
    buffer_load_dwordx4 v7, s[24:27], s49 offen lds
    s_add_u32 s49, s49, s50
    s_add_u32 m0, s48, 46080
    s_nop 0
    buffer_load_dwordx4 v7, s[24:27], s49 offen lds
    s_add_u32 s49, s49, s50
    v_add_f32 v72, v72, v80
    v_add_f32 v73, v73, v81
    v_add_f32 v74, v74, v82
    v_add_f32 v75, v75, v83
    v_add_f32 v76, v76, v84
    v_add_f32 v77, v77, v85
    v_add_f32 v78, v78, v86
    v_add_f32 v79, v79, v87
    s_waitcnt vmcnt(24)
    s_barrier
    s_add_u32 m0, s48, 49152
    s_nop 0
    buffer_load_dwordx4 v7, s[24:27], s49 offen lds
    s_add_u32 s49, s49, s50
    s_add_u32 m0, s48, 52224
    s_nop 0
    buffer_load_dwordx4 v7, s[24:27], s49 offen lds
    s_add_u32 s49, s49, s50
    s_add_u32 m0, s48, 55296
    s_nop 0
    buffer_load_dwordx4 v7, s[24:27], s49 offen lds
    s_add_u32 s49, s49, s50
    s_add_u32 m0, s48, 58368
    s_nop 0
    buffer_load_dwordx4 v7, s[24:27], s49 offen lds
    s_add_u32 s49, s49, s50
    s_add_u32 m0, s48, 61440
    s_nop 0
    buffer_load_dwordx4 v7, s[24:27], s49 offen lds
    s_add_u32 s49, s49, s50
    s_add_u32 m0, s48, 64512
    s_nop 0
    buffer_load_dwordx4 v7, s[24:27], s49 offen lds
    s_add_u32 s49, s49, s50
    s_add_u32 m0, s48, 67584
    s_nop 0
    buffer_load_dwordx4 v7, s[24:27], s49 offen lds
    s_add_u32 s49, s49, s50
    s_add_u32 m0, s48, 70656
    s_nop 0
    buffer_load_dwordx4 v7, s[24:27], s49 offen lds
    s_add_u32 s49, s49, s50
    v_add_f32 v72, v72, v76
    v_add_f32 v73, v73, v77
    v_add_f32 v74, v74, v78
    v_add_f32 v75, v75, v79
    v_add_f32 v72, v72, v74
    v_add_f32 v73, v73, v75
    v_mul_f32 v72, 0x3a800000, v72
    v_mul_f32 v73, 0x3a800000, v73
    s_waitcnt vmcnt(24)
    s_barrier
    s_add_u32 m0, s48, 73728
    s_nop 0
    buffer_load_dwordx4 v7, s[24:27], s49 offen lds
    s_add_u32 s49, s49, s50
    s_add_u32 m0, s48, 76800
    s_nop 0
    buffer_load_dwordx4 v7, s[24:27], s49 offen lds
    s_add_u32 s49, s49, s50
    s_add_u32 m0, s48, 79872
    s_nop 0
    buffer_load_dwordx4 v7, s[24:27], s49 offen lds
    s_add_u32 s49, s49, s50
    s_add_u32 m0, s48, 82944
    s_nop 0
    buffer_load_dwordx4 v7, s[24:27], s49 offen lds
    s_add_u32 s49, s49, s50
    s_add_u32 m0, s48, 86016
    s_nop 0
    buffer_load_dwordx4 v7, s[24:27], s49 offen lds
    s_add_u32 s49, s49, s50
    s_add_u32 m0, s48, 89088
    s_nop 0
    buffer_load_dwordx4 v7, s[24:27], s49 offen lds
    s_add_u32 s49, s49, s50
    s_add_u32 m0, s48, 92160
    s_nop 0
    buffer_load_dwordx4 v7, s[24:27], s49 offen lds
    s_add_u32 s49, s49, s50
    s_add_u32 m0, s48, 95232
    s_nop 0
    buffer_load_dwordx4 v7, s[24:27], s49 offen lds
    s_add_u32 s49, s49, s50
    v_fma_f32 v73, -v72, v72, v73
    v_max_f32 v73, 0, v73
    v_add_f32 v73, 0x3727c5ac, v73
    v_rsq_f32 v73, v73
    ds_write_b32 v11, v72 offset:1280
    ds_write_b32 v11, v73 offset:2304
    s_waitcnt lgkmcnt(0)
    s_waitcnt vmcnt(24)
    s_barrier
    s_waitcnt vmcnt(16)
    s_barrier
    s_waitcnt vmcnt(8)
    s_barrier
    s_waitcnt vmcnt(0)
    s_barrier
    s_barrier
    s_mov_b32 s24, s36
    s_mov_b32 s25, s37
    s_mov_b32 s26, 2097152
    s_mov_b32 s27, 0x00020000
    s_mov_b32 s60, s51
wop_13:
    s_lshl_b32 m0, s60, 10
    s_lshl_b32 s3, s60, 14
    buffer_load_dwordx4 v17, s[24:27], s3 offen lds
    s_add_u32 s60, s60, 3
    s_cmp_lt_u32 s60, 60
    s_cbranch_scc1 wop_13
    s_barrier
wop_14:
    s_lshl_b32 m0, s60, 10
    s_lshl_b32 s3, s60, 14
    buffer_load_dwordx4 v17, s[24:27], s3 offen lds
    s_add_u32 s60, s60, 3
    s_cmp_lt_u32 s60, 128
    s_cbranch_scc1 wop_14
    s_branch l_wo
.p2align 6
h_wo:
    s_mul_i32 s54, s9, 393216
    s_add_u32 s54, s54, 60162048
    s_lshl_b32 s55, s11, 9
    s_add_u32 s54, s54, s55
    s_add_u32 s52, s4, s54
    s_addc_u32 s53, s5, 0
    s_mov_b32 s54, s10
    s_mov_b32 s55, s10
    s_bitcmp1_b32 s9, 0
    s_cbranch_scc1 h_wo_b
    s_mov_b32 s58, 0x20000
poll_15:
    s_load_dwordx4 s[64:67], s[52:53], 0 glc
    s_load_dwordx4 s[68:71], s[52:53], 128 glc
    s_load_dwordx4 s[72:75], s[52:53], 256 glc
    s_load_dwordx4 s[76:79], s[52:53], 384 glc
    s_sub_u32 s58, s58, 1
    s_cbranch_scc1 poll_15_ok
    s_waitcnt lgkmcnt(0)
    s_xor_b64 s[56:57], s[64:65], s[54:55]
    s_xor_b64 s[64:65], s[66:67], s[54:55]
    s_or_b64 s[56:57], s[56:57], s[64:65]
    s_xor_b64 s[64:65], s[68:69], s[54:55]
    s_or_b64 s[56:57], s[56:57], s[64:65]
    s_xor_b64 s[64:65], s[70:71], s[54:55]
    s_or_b64 s[56:57], s[56:57], s[64:65]
    s_xor_b64 s[64:65], s[72:73], s[54:55]
    s_or_b64 s[56:57], s[56:57], s[64:65]
    s_xor_b64 s[64:65], s[74:75], s[54:55]
    s_or_b64 s[56:57], s[56:57], s[64:65]
    s_xor_b64 s[64:65], s[76:77], s[54:55]
    s_or_b64 s[56:57], s[56:57], s[64:65]
    s_xor_b64 s[64:65], s[78:79], s[54:55]
    s_or_b64 s[56:57], s[56:57], s[64:65]
    s_cbranch_scc1 poll_15
poll_15_ok:
    s_waitcnt lgkmcnt(0)
    s_cmp_lg_u32 s9, 0
    s_cbranch_scc1 l_wo
    s_barrier
    v_and_b32 v1, 63, v0
    v_lshrrev_b32 v10, 4, v1
    v_min_u32 v10, 2, v10
    v_and_b32 v11, 15, v1
    v_lshlrev_b32 v11, 3, v11
    v_lshl_add_u32 v12, v10, 7, v11
    v_add_u32 v12, 156416, v12
    v_lshl_add_u32 v10, v10, 16, v11
    s_lshl_b32 s54, s7, 6
    s_add_u32 s54, s54, 58756096
    s_add_u32 s52, s4, s54
    s_addc_u32 s53, s5, 0
    s_mov_b32 s54, s10
    s_mov_b32 s55, s10
    s_mov_b32 s58, 0x20000
uf_16:
    s_load_dwordx16 s[64:79], s[52:53], 0 glc
    s_load_dwordx16 s[80:95], s[52:53], 1024 glc
    s_sub_u32 s58, s58, 1
    s_cbranch_scc1 uf_16_ok
    s_waitcnt lgkmcnt(0)
    s_xor_b64 s[56:57], s[64:65], s[54:55]
    s_xor_b64 s[64:65], s[66:67], s[54:55]
    s_or_b64 s[56:57], s[56:57], s[64:65]
    s_xor_b64 s[64:65], s[68:69], s[54:55]
    s_or_b64 s[56:57], s[56:57], s[64:65]
    s_xor_b64 s[64:65], s[70:71], s[54:55]
    s_or_b64 s[56:57], s[56:57], s[64:65]
    s_xor_b64 s[64:65], s[72:73], s[54:55]
    s_or_b64 s[56:57], s[56:57], s[64:65]
    s_xor_b64 s[64:65], s[74:75], s[54:55]
    s_or_b64 s[56:57], s[56:57], s[64:65]
    s_xor_b64 s[64:65], s[76:77], s[54:55]
    s_or_b64 s[56:57], s[56:57], s[64:65]
    s_xor_b64 s[64:65], s[78:79], s[54:55]
    s_or_b64 s[56:57], s[56:57], s[64:65]
    s_xor_b64 s[64:65], s[80:81], s[54:55]
    s_or_b64 s[56:57], s[56:57], s[64:65]
    s_xor_b64 s[64:65], s[82:83], s[54:55]
    s_or_b64 s[56:57], s[56:57], s[64:65]
    s_xor_b64 s[64:65], s[84:85], s[54:55]
    s_or_b64 s[56:57], s[56:57], s[64:65]
    s_xor_b64 s[64:65], s[86:87], s[54:55]
    s_or_b64 s[56:57], s[56:57], s[64:65]
    s_xor_b64 s[64:65], s[88:89], s[54:55]
    s_or_b64 s[56:57], s[56:57], s[64:65]
    s_xor_b64 s[64:65], s[90:91], s[54:55]
    s_or_b64 s[56:57], s[56:57], s[64:65]
    s_xor_b64 s[64:65], s[92:93], s[54:55]
    s_or_b64 s[56:57], s[56:57], s[64:65]
    s_xor_b64 s[64:65], s[94:95], s[54:55]
    s_or_b64 s[56:57], s[56:57], s[64:65]
    s_cbranch_scc1 uf_16
uf_16_ok:
    s_waitcnt lgkmcnt(0)
    s_mov_b32 s58, 0x20000
uf_17:
    s_load_dwordx16 s[64:79], s[52:53], 2048 glc
    s_sub_u32 s58, s58, 1
    s_cbranch_scc1 uf_17_ok
    s_waitcnt lgkmcnt(0)
    s_xor_b64 s[56:57], s[64:65], s[54:55]
    s_xor_b64 s[64:65], s[66:67], s[54:55]
    s_or_b64 s[56:57], s[56:57], s[64:65]
    s_xor_b64 s[64:65], s[68:69], s[54:55]
    s_or_b64 s[56:57], s[56:57], s[64:65]
    s_xor_b64 s[64:65], s[70:71], s[54:55]
    s_or_b64 s[56:57], s[56:57], s[64:65]
    s_xor_b64 s[64:65], s[72:73], s[54:55]
    s_or_b64 s[56:57], s[56:57], s[64:65]
    s_xor_b64 s[64:65], s[74:75], s[54:55]
    s_or_b64 s[56:57], s[56:57], s[64:65]
    s_xor_b64 s[64:65], s[76:77], s[54:55]
    s_or_b64 s[56:57], s[56:57], s[64:65]
    s_xor_b64 s[64:65], s[78:79], s[54:55]
    s_or_b64 s[56:57], s[56:57], s[64:65]
    s_cbranch_scc1 uf_17
uf_17_ok:
    s_waitcnt lgkmcnt(0)
    s_lshl_b32 s56, s7, 12
    s_and_b32 s57, s6, 1
    s_lshl_b32 s57, s57, 7
    s_add_u32 s56, s56, s57
    s_add_u32 s56, s56, 58982400
    buffer_load_dwordx2 v[32:33], v10, s[12:15], s56 offen offset:0 sc1
    buffer_load_dwordx2 v[34:35], v10, s[12:15], s56 offen offset:256 sc1
    buffer_load_dwordx2 v[36:37], v10, s[12:15], s56 offen offset:512 sc1
    buffer_load_dwordx2 v[38:39], v10, s[12:15], s56 offen offset:768 sc1
    buffer_load_dwordx2 v[40:41], v10, s[12:15], s56 offen offset:1024 sc1
    buffer_load_dwordx2 v[42:43], v10, s[12:15], s56 offen offset:1280 sc1
    buffer_load_dwordx2 v[44:45], v10, s[12:15], s56 offen offset:1536 sc1
    buffer_load_dwordx2 v[46:47], v10, s[12:15], s56 offen offset:1792 sc1
    buffer_load_dwordx2 v[48:49], v10, s[12:15], s56 offen offset:2048 sc1
    buffer_load_dwordx2 v[50:51], v10, s[12:15], s56 offen offset:2304 sc1
    buffer_load_dwordx2 v[52:53], v10, s[12:15], s56 offen offset:2560 sc1
    buffer_load_dwordx2 v[54:55], v10, s[12:15], s56 offen offset:2816 sc1
    buffer_load_dwordx2 v[56:57], v10, s[12:15], s56 offen offset:3072 sc1
    buffer_load_dwordx2 v[58:59], v10, s[12:15], s56 offen offset:3328 sc1
    buffer_load_dwordx2 v[60:61], v10, s[12:15], s56 offen offset:3584 sc1
    buffer_load_dwordx2 v[62:63], v10, s[12:15], s56 offen offset:3840 sc1
    s_waitcnt vmcnt(0)
    v_add_f32 v32, v32, v48
    v_add_f32 v33, v33, v49
    v_add_f32 v34, v34, v50
    v_add_f32 v35, v35, v51
    v_add_f32 v36, v36, v52
    v_add_f32 v37, v37, v53
    v_add_f32 v38, v38, v54
    v_add_f32 v39, v39, v55
    v_add_f32 v40, v40, v56
    v_add_f32 v41, v41, v57
    v_add_f32 v42, v42, v58
    v_add_f32 v43, v43, v59
    v_add_f32 v44, v44, v60
    v_add_f32 v45, v45, v61
    v_add_f32 v46, v46, v62
    v_add_f32 v47, v47, v63
    v_add_f32 v32, v32, v40
    v_add_f32 v33, v33, v41
    v_add_f32 v34, v34, v42
    v_add_f32 v35, v35, v43
    v_add_f32 v36, v36, v44
    v_add_f32 v37, v37, v45
    v_add_f32 v38, v38, v46
    v_add_f32 v39, v39, v47
    v_add_f32 v32, v32, v36
    v_add_f32 v33, v33, v37
    v_add_f32 v34, v34, v38
    v_add_f32 v35, v35, v39
    v_add_f32 v32, v32, v34
    v_add_f32 v33, v33, v35
    ds_write_b64 v12, v[32:33]
    s_waitcnt lgkmcnt(0)
    s_branch l_wo_end
h_wo_b:
    s_mov_b32 s58, 0x20000
poll_18:
    s_load_dwordx8 s[64:71], s[52:53], 0 glc
    s_load_dwordx8 s[72:79], s[52:53], 128 glc
    s_load_dwordx8 s[80:87], s[52:53], 256 glc
    s_load_dwordx8 s[88:95], s[52:53], 384 glc
    s_sub_u32 s58, s58, 1
    s_cbranch_scc1 poll_18_ok
    s_waitcnt lgkmcnt(0)
    s_xor_b64 s[56:57], s[64:65], s[54:55]
    s_xor_b64 s[64:65], s[66:67], s[54:55]
    s_or_b64 s[56:57], s[56:57], s[64:65]
    s_xor_b64 s[64:65], s[68:69], s[54:55]
    s_or_b64 s[56:57], s[56:57], s[64:65]
    s_xor_b64 s[64:65], s[70:71], s[54:55]
    s_or_b64 s[56:57], s[56:57], s[64:65]
    s_xor_b64 s[64:65], s[72:73], s[54:55]
    s_or_b64 s[56:57], s[56:57], s[64:65]
    s_xor_b64 s[64:65], s[74:75], s[54:55]
    s_or_b64 s[56:57], s[56:57], s[64:65]
    s_xor_b64 s[64:65], s[76:77], s[54:55]
    s_or_b64 s[56:57], s[56:57], s[64:65]
    s_xor_b64 s[64:65], s[78:79], s[54:55]
    s_or_b64 s[56:57], s[56:57], s[64:65]
    s_xor_b64 s[64:65], s[80:81], s[54:55]
    s_or_b64 s[56:57], s[56:57], s[64:65]
    s_xor_b64 s[64:65], s[82:83], s[54:55]
    s_or_b64 s[56:57], s[56:57], s[64:65]
    s_xor_b64 s[64:65], s[84:85], s[54:55]
    s_or_b64 s[56:57], s[56:57], s[64:65]
    s_xor_b64 s[64:65], s[86:87], s[54:55]
    s_or_b64 s[56:57], s[56:57], s[64:65]
    s_xor_b64 s[64:65], s[88:89], s[54:55]
    s_or_b64 s[56:57], s[56:57], s[64:65]
    s_xor_b64 s[64:65], s[90:91], s[54:55]
    s_or_b64 s[56:57], s[56:57], s[64:65]
    s_xor_b64 s[64:65], s[92:93], s[54:55]
    s_or_b64 s[56:57], s[56:57], s[64:65]
    s_xor_b64 s[64:65], s[94:95], s[54:55]
    s_or_b64 s[56:57], s[56:57], s[64:65]
    s_cbranch_scc1 poll_18
poll_18_ok:
    s_waitcnt lgkmcnt(0)
l_wo:
    s_waitcnt vmcnt(0)
    s_barrier
l_wo_end:
    s_barrier
    s_add_u32 s9, s9, 1
    s_cmp_eq_u32 s9, 4
    s_cbranch_scc1 k_exit
    s_cmp_eq_u32 s8, 4
    s_cbranch_scc1 h_next
    s_cmp_eq_u32 s9, 2
    s_cbranch_scc1 l_qkva
    s_branch l_qkvb
h_next:
    s_cmp_eq_u32 s9, 2
    s_cbranch_scc1 h_qkva
    s_branch h_qkvb
.p2align 6
h_qkvb:
    s_sub_u32 s9, s9, 1
    s_mul_i32 s54, s9, 393216
    s_add_u32 s54, s54, 60293120
    s_lshl_b32 s55, s11, 9
    s_add_u32 s54, s54, s55
    s_add_u32 s52, s4, s54
    s_addc_u32 s53, s5, 0
    s_mov_b32 s54, s10
    s_mov_b32 s55, s10
    s_add_u32 s9, s9, 1
    v_and_b32 v1, 63, v0
    v_lshlrev_b32 v5, 4, v1
    s_sub_u32 s50, s8, 4
    v_lshrrev_b32 v10, 5, v1
    v_and_b32 v11, 31, v1
    v_lshlrev_b32 v11, 3, v11
    v_lshl_add_u32 v10, v10, 12, v11
    s_lshl_b32 s3, s50, 8
    s_add_u32 s3, s3, 155648
    v_lshl_add_u32 v11, v1, 2, s3
    s_lshr_b32 s3, s6, 1
    s_lshl_b32 s3, s3, 2
    s_add_u32 s50, s50, s3
    s_lshl_b32 s50, s50, 13
    s_lshl_b32 s3, s9, 18
    s_add_u32 s50, s50, s3
    s_add_u32 s50, s50, 57671680
    s_mov_b32 s58, 0x20000
poll_19:
    s_load_dwordx8 s[64:71], s[52:53], 0 glc
    s_load_dwordx8 s[72:79], s[52:53], 128 glc
    s_load_dwordx8 s[80:87], s[52:53], 256 glc
    s_load_dwordx8 s[88:95], s[52:53], 384 glc
    s_sub_u32 s58, s58, 1
    s_cbranch_scc1 poll_19_ok
    s_waitcnt lgkmcnt(0)
    s_xor_b64 s[56:57], s[64:65], s[54:55]
    s_xor_b64 s[64:65], s[66:67], s[54:55]
    s_or_b64 s[56:57], s[56:57], s[64:65]
    s_xor_b64 s[64:65], s[68:69], s[54:55]
    s_or_b64 s[56:57], s[56:57], s[64:65]
    s_xor_b64 s[64:65], s[70:71], s[54:55]
    s_or_b64 s[56:57], s[56:57], s[64:65]
    s_xor_b64 s[64:65], s[72:73], s[54:55]
    s_or_b64 s[56:57], s[56:57], s[64:65]
    s_xor_b64 s[64:65], s[74:75], s[54:55]
    s_or_b64 s[56:57], s[56:57], s[64:65]
    s_xor_b64 s[64:65], s[76:77], s[54:55]
    s_or_b64 s[56:57], s[56:57], s[64:65]
    s_xor_b64 s[64:65], s[78:79], s[54:55]
    s_or_b64 s[56:57], s[56:57], s[64:65]
    s_xor_b64 s[64:65], s[80:81], s[54:55]
    s_or_b64 s[56:57], s[56:57], s[64:65]
    s_xor_b64 s[64:65], s[82:83], s[54:55]
    s_or_b64 s[56:57], s[56:57], s[64:65]
    s_xor_b64 s[64:65], s[84:85], s[54:55]
    s_or_b64 s[56:57], s[56:57], s[64:65]
    s_xor_b64 s[64:65], s[86:87], s[54:55]
    s_or_b64 s[56:57], s[56:57], s[64:65]
    s_xor_b64 s[64:65], s[88:89], s[54:55]
    s_or_b64 s[56:57], s[56:57], s[64:65]
    s_xor_b64 s[64:65], s[90:91], s[54:55]
    s_or_b64 s[56:57], s[56:57], s[64:65]
    s_xor_b64 s[64:65], s[92:93], s[54:55]
    s_or_b64 s[56:57], s[56:57], s[64:65]
    s_xor_b64 s[64:65], s[94:95], s[54:55]
    s_or_b64 s[56:57], s[56:57], s[64:65]
    s_cbranch_scc1 poll_19
poll_19_ok:
    s_waitcnt lgkmcnt(0)
    s_barrier
    s_barrier
    buffer_load_dwordx2 v[32:33], v10, s[12:15], s50 offen offset:0 sc1
    buffer_load_dwordx2 v[34:35], v10, s[12:15], s50 offen offset:256 sc1
    buffer_load_dwordx2 v[36:37], v10, s[12:15], s50 offen offset:512 sc1
    buffer_load_dwordx2 v[38:39], v10, s[12:15], s50 offen offset:768 sc1
    buffer_load_dwordx2 v[40:41], v10, s[12:15], s50 offen offset:1024 sc1
    buffer_load_dwordx2 v[42:43], v10, s[12:15], s50 offen offset:1280 sc1
    buffer_load_dwordx2 v[44:45], v10, s[12:15], s50 offen offset:1536 sc1
    s_barrier
    buffer_load_dwordx2 v[46:47], v10, s[12:15], s50 offen offset:1792 sc1
    buffer_load_dwordx2 v[48:49], v10, s[12:15], s50 offen offset:2048 sc1
    buffer_load_dwordx2 v[50:51], v10, s[12:15], s50 offen offset:2304 sc1
    buffer_load_dwordx2 v[52:53], v10, s[12:15], s50 offen offset:2560 sc1
    buffer_load_dwordx2 v[54:55], v10, s[12:15], s50 offen offset:2816 sc1
    buffer_load_dwordx2 v[56:57], v10, s[12:15], s50 offen offset:3072 sc1
    buffer_load_dwordx2 v[58:59], v10, s[12:15], s50 offen offset:3328 sc1
    s_barrier
    buffer_load_dwordx2 v[60:61], v10, s[12:15], s50 offen offset:3584 sc1
    buffer_load_dwordx2 v[62:63], v10, s[12:15], s50 offen offset:3840 sc1
    s_barrier
    s_waitcnt vmcnt(0)
    v_add_f32 v32, v32, v48
    v_add_f32 v33, v33, v49
    v_add_f32 v34, v34, v50
    v_add_f32 v35, v35, v51
    v_add_f32 v36, v36, v52
    v_add_f32 v37, v37, v53
    v_add_f32 v38, v38, v54
    v_add_f32 v39, v39, v55
    v_add_f32 v40, v40, v56
    v_add_f32 v41, v41, v57
    v_add_f32 v42, v42, v58
    v_add_f32 v43, v43, v59
    v_add_f32 v44, v44, v60
    s_barrier
    v_add_f32 v45, v45, v61
    v_add_f32 v46, v46, v62
    v_add_f32 v47, v47, v63
    v_add_f32 v32, v32, v40
    v_add_f32 v33, v33, v41
    v_add_f32 v34, v34, v42
    v_add_f32 v35, v35, v43
    v_add_f32 v36, v36, v44
    v_add_f32 v37, v37, v45
    v_add_f32 v38, v38, v46
    v_add_f32 v39, v39, v47
    v_add_f32 v32, v32, v36
    v_add_f32 v33, v33, v37
    s_barrier
    v_add_f32 v34, v34, v38
    v_add_f32 v35, v35, v39
    v_add_f32 v32, v32, v34
    v_add_f32 v33, v33, v35
    v_mul_f32 v32, 0x3a800000, v32
    v_mul_f32 v33, 0x3a800000, v33
    v_fma_f32 v33, -v32, v32, v33
    v_max_f32 v33, 0, v33
    v_add_f32 v33, 0x3727c5ac, v33
    v_rsq_f32 v33, v33
    ds_write_b32 v11, v32 offset:1280
    ds_write_b32 v11, v33 offset:2304
    s_waitcnt lgkmcnt(0)
    s_barrier
    s_barrier
    s_branch s_attn
.p2align 6
l_qkvb:
    v_and_b32 v1, 63, v0
    v_lshlrev_b32 v5, 4, v1
    s_sub_u32 s51, s8, 5
    s_lshl_b32 s48, s51, 13
    s_lshl_b32 s49, s7, 1
    s_and_b32 s52, s6, 1
    s_add_u32 s49, s49, s52
    s_mul_i32 s49, s49, 3
    s_add_u32 s49, s49, s51
    s_lshl_b32 s49, s49, 16
    s_add_u32 s49, s49, 50331648
    s_add_u32 m0, s48, 0
    s_nop 0
    buffer_load_dwordx4 v5, s[12:15], s49 offen offset:0 sc1 lds
    buffer_load_dwordx4 v5, s[12:15], s49 offen offset:1024 sc1 lds
    buffer_load_dwordx4 v5, s[12:15], s49 offen offset:2048 sc1 lds
    buffer_load_dwordx4 v5, s[12:15], s49 offen offset:3072 sc1 lds
    s_add_u32 s49, s49, 4096
    s_add_u32 m0, s48, 4096
    s_nop 0
    buffer_load_dwordx4 v5, s[12:15], s49 offen offset:0 sc1 lds
    buffer_load_dwordx4 v5, s[12:15], s49 offen offset:1024 sc1 lds
    buffer_load_dwordx4 v5, s[12:15], s49 offen offset:2048 sc1 lds
    buffer_load_dwordx4 v5, s[12:15], s49 offen offset:3072 sc1 lds
    s_waitcnt vmcnt(7)
    s_add_u32 s49, s49, 4096
    s_add_u32 m0, s48, 24576
    s_nop 0
    buffer_load_dwordx4 v5, s[12:15], s49 offen offset:0 sc1 lds
    s_waitcnt vmcnt(7)
    buffer_load_dwordx4 v5, s[12:15], s49 offen offset:1024 sc1 lds
    s_waitcnt vmcnt(7)
    buffer_load_dwordx4 v5, s[12:15], s49 offen offset:2048 sc1 lds
    s_waitcnt vmcnt(7)
    buffer_load_dwordx4 v5, s[12:15], s49 offen offset:3072 sc1 lds
    s_waitcnt vmcnt(7)
    s_add_u32 s49, s49, 4096
    s_add_u32 m0, s48, 28672
    s_nop 0
    buffer_load_dwordx4 v5, s[12:15], s49 offen offset:0 sc1 lds
    s_waitcnt vmcnt(7)
    buffer_load_dwordx4 v5, s[12:15], s49 offen offset:1024 sc1 lds
    s_waitcnt vmcnt(7)
    buffer_load_dwordx4 v5, s[12:15], s49 offen offset:2048 sc1 lds
    s_waitcnt vmcnt(7)
    buffer_load_dwordx4 v5, s[12:15], s49 offen offset:3072 sc1 lds
    s_waitcnt vmcnt(7)
    s_add_u32 s49, s49, 4096
    s_add_u32 m0, s48, 49152
    s_nop 0
    buffer_load_dwordx4 v5, s[12:15], s49 offen offset:0 sc1 lds
    s_waitcnt vmcnt(7)
    buffer_load_dwordx4 v5, s[12:15], s49 offen offset:1024 sc1 lds
    s_waitcnt vmcnt(7)
    buffer_load_dwordx4 v5, s[12:15], s49 offen offset:2048 sc1 lds
    s_waitcnt vmcnt(7)
    buffer_load_dwordx4 v5, s[12:15], s49 offen offset:3072 sc1 lds
    s_waitcnt vmcnt(7)
    s_add_u32 s49, s49, 4096
    s_add_u32 m0, s48, 53248
    s_nop 0
    buffer_load_dwordx4 v5, s[12:15], s49 offen offset:0 sc1 lds
    s_waitcnt vmcnt(7)
    buffer_load_dwordx4 v5, s[12:15], s49 offen offset:1024 sc1 lds
    s_waitcnt vmcnt(7)
    buffer_load_dwordx4 v5, s[12:15], s49 offen offset:2048 sc1 lds
    s_waitcnt vmcnt(7)
    buffer_load_dwordx4 v5, s[12:15], s49 offen offset:3072 sc1 lds
    s_waitcnt vmcnt(7)
    s_add_u32 s49, s49, 4096
    s_add_u32 m0, s48, 73728
    s_nop 0
    buffer_load_dwordx4 v5, s[12:15], s49 offen offset:0 sc1 lds
    s_waitcnt vmcnt(7)
    buffer_load_dwordx4 v5, s[12:15], s49 offen offset:1024 sc1 lds
    s_waitcnt vmcnt(7)
    buffer_load_dwordx4 v5, s[12:15], s49 offen offset:2048 sc1 lds
    s_waitcnt vmcnt(7)
    buffer_load_dwordx4 v5, s[12:15], s49 offen offset:3072 sc1 lds
    s_waitcnt vmcnt(7)
    s_add_u32 s49, s49, 4096
    s_add_u32 m0, s48, 77824
    s_nop 0
    buffer_load_dwordx4 v5, s[12:15], s49 offen offset:0 sc1 lds
    s_waitcnt vmcnt(7)
    buffer_load_dwordx4 v5, s[12:15], s49 offen offset:1024 sc1 lds
    s_waitcnt vmcnt(7)
    buffer_load_dwordx4 v5, s[12:15], s49 offen offset:2048 sc1 lds
    s_waitcnt vmcnt(7)
    buffer_load_dwordx4 v5, s[12:15], s49 offen offset:3072 sc1 lds
    s_waitcnt vmcnt(7)
    s_add_u32 s49, s49, 4096
    s_add_u32 m0, s48, 98304
    s_nop 0
    buffer_load_dwordx4 v5, s[12:15], s49 offen offset:0 sc1 lds
    s_waitcnt vmcnt(7)
    buffer_load_dwordx4 v5, s[12:15], s49 offen offset:1024 sc1 lds
    s_waitcnt vmcnt(7)
    buffer_load_dwordx4 v5, s[12:15], s49 offen offset:2048 sc1 lds
    s_waitcnt vmcnt(7)
    buffer_load_dwordx4 v5, s[12:15], s49 offen offset:3072 sc1 lds
    s_waitcnt vmcnt(7)
    s_add_u32 s49, s49, 4096
    s_add_u32 m0, s48, 102400
    s_nop 0
    buffer_load_dwordx4 v5, s[12:15], s49 offen offset:0 sc1 lds
    s_waitcnt vmcnt(7)
    buffer_load_dwordx4 v5, s[12:15], s49 offen offset:1024 sc1 lds
    s_waitcnt vmcnt(7)
    buffer_load_dwordx4 v5, s[12:15], s49 offen offset:2048 sc1 lds
    s_waitcnt vmcnt(7)
    buffer_load_dwordx4 v5, s[12:15], s49 offen offset:3072 sc1 lds
    s_waitcnt vmcnt(7)
    s_add_u32 s49, s49, 4096
    s_add_u32 m0, s48, 122880
    s_nop 0
    buffer_load_dwordx4 v5, s[12:15], s49 offen offset:0 sc1 lds
    s_waitcnt vmcnt(7)
    buffer_load_dwordx4 v5, s[12:15], s49 offen offset:1024 sc1 lds
    s_waitcnt vmcnt(7)
    buffer_load_dwordx4 v5, s[12:15], s49 offen offset:2048 sc1 lds
    s_waitcnt vmcnt(7)
    buffer_load_dwordx4 v5, s[12:15], s49 offen offset:3072 sc1 lds
    s_waitcnt vmcnt(7)
    s_add_u32 s49, s49, 4096
    s_add_u32 m0, s48, 126976
    s_nop 0
    buffer_load_dwordx4 v5, s[12:15], s49 offen offset:0 sc1 lds
    s_waitcnt vmcnt(7)
    buffer_load_dwordx4 v5, s[12:15], s49 offen offset:1024 sc1 lds
    s_waitcnt vmcnt(7)
    buffer_load_dwordx4 v5, s[12:15], s49 offen offset:2048 sc1 lds
    s_waitcnt vmcnt(7)
    buffer_load_dwordx4 v5, s[12:15], s49 offen offset:3072 sc1 lds
    s_waitcnt vmcnt(7)
    s_add_u32 s49, s49, 4096
    s_sub_u32 s50, s8, 4
    v_lshrrev_b32 v10, 5, v1
    v_and_b32 v11, 31, v1
    v_lshlrev_b32 v11, 3, v11
    v_lshl_add_u32 v10, v10, 12, v11
    s_lshl_b32 s3, s50, 8
    s_add_u32 s3, s3, 155648
    v_lshl_add_u32 v11, v1, 2, s3
    s_lshr_b32 s3, s6, 1
    s_lshl_b32 s3, s3, 2
    s_add_u32 s50, s50, s3
    s_lshl_b32 s50, s50, 13
    s_lshl_b32 s3, s9, 18
    s_add_u32 s50, s50, s3
    s_add_u32 s50, s50, 57671680
    s_barrier
    s_barrier
    buffer_load_dwordx2 v[32:33], v10, s[12:15], s50 offen offset:0 sc1
    buffer_load_dwordx2 v[34:35], v10, s[12:15], s50 offen offset:256 sc1
    buffer_load_dwordx2 v[36:37], v10, s[12:15], s50 offen offset:512 sc1
    buffer_load_dwordx2 v[38:39], v10, s[12:15], s50 offen offset:768 sc1
    buffer_load_dwordx2 v[40:41], v10, s[12:15], s50 offen offset:1024 sc1
    buffer_load_dwordx2 v[42:43], v10, s[12:15], s50 offen offset:1280 sc1
    buffer_load_dwordx2 v[44:45], v10, s[12:15], s50 offen offset:1536 sc1
    s_barrier
    s_add_u32 m0, s48, 0
    s_nop 0
    buffer_load_dwordx4 v5, s[12:15], s49 offen offset:0 sc1 lds
    buffer_load_dwordx4 v5, s[12:15], s49 offen offset:1024 sc1 lds
    buffer_load_dwordx4 v5, s[12:15], s49 offen offset:2048 sc1 lds
    buffer_load_dwordx4 v5, s[12:15], s49 offen offset:3072 sc1 lds
    s_add_u32 s49, s49, 4096
    s_add_u32 m0, s48, 4096
    s_nop 0
    buffer_load_dwordx4 v5, s[12:15], s49 offen offset:0 sc1 lds
    buffer_load_dwordx4 v5, s[12:15], s49 offen offset:1024 sc1 lds
    buffer_load_dwordx4 v5, s[12:15], s49 offen offset:2048 sc1 lds
    buffer_load_dwordx4 v5, s[12:15], s49 offen offset:3072 sc1 lds
    s_add_u32 s49, s49, 4096
    buffer_load_dwordx2 v[46:47], v10, s[12:15], s50 offen offset:1792 sc1
    buffer_load_dwordx2 v[48:49], v10, s[12:15], s50 offen offset:2048 sc1
    buffer_load_dwordx2 v[50:51], v10, s[12:15], s50 offen offset:2304 sc1
    buffer_load_dwordx2 v[52:53], v10, s[12:15], s50 offen offset:2560 sc1
    buffer_load_dwordx2 v[54:55], v10, s[12:15], s50 offen offset:2816 sc1
    buffer_load_dwordx2 v[56:57], v10, s[12:15], s50 offen offset:3072 sc1
    buffer_load_dwordx2 v[58:59], v10, s[12:15], s50 offen offset:3328 sc1
    s_barrier
    s_add_u32 m0, s48, 24576
    s_nop 0
    buffer_load_dwordx4 v5, s[12:15], s49 offen offset:0 sc1 lds
    buffer_load_dwordx4 v5, s[12:15], s49 offen offset:1024 sc1 lds
    buffer_load_dwordx4 v5, s[12:15], s49 offen offset:2048 sc1 lds
    buffer_load_dwordx4 v5, s[12:15], s49 offen offset:3072 sc1 lds
    s_add_u32 s49, s49, 4096
    s_add_u32 m0, s48, 28672
    s_nop 0
    buffer_load_dwordx4 v5, s[12:15], s49 offen offset:0 sc1 lds
    buffer_load_dwordx4 v5, s[12:15], s49 offen offset:1024 sc1 lds
    buffer_load_dwordx4 v5, s[12:15], s49 offen offset:2048 sc1 lds
    buffer_load_dwordx4 v5, s[12:15], s49 offen offset:3072 sc1 lds
    s_add_u32 s49, s49, 4096
    buffer_load_dwordx2 v[60:61], v10, s[12:15], s50 offen offset:3584 sc1
    buffer_load_dwordx2 v[62:63], v10, s[12:15], s50 offen offset:3840 sc1
    s_barrier
    s_waitcnt vmcnt(0)
    v_add_f32 v32, v32, v48
    v_add_f32 v33, v33, v49
    v_add_f32 v34, v34, v50
    v_add_f32 v35, v35, v51
    v_add_f32 v36, v36, v52
    v_add_f32 v37, v37, v53
    v_add_f32 v38, v38, v54
    v_add_f32 v39, v39, v55
    v_add_f32 v40, v40, v56
    v_add_f32 v41, v41, v57
    v_add_f32 v42, v42, v58
    v_add_f32 v43, v43, v59
    v_add_f32 v44, v44, v60
    s_barrier
    v_add_f32 v45, v45, v61
    v_add_f32 v46, v46, v62
    v_add_f32 v47, v47, v63
    v_add_f32 v32, v32, v40
    v_add_f32 v33, v33, v41
    v_add_f32 v34, v34, v42
    v_add_f32 v35, v35, v43
    v_add_f32 v36, v36, v44
    v_add_f32 v37, v37, v45
    v_add_f32 v38, v38, v46
    v_add_f32 v39, v39, v47
    v_add_f32 v32, v32, v36
    v_add_f32 v33, v33, v37
    s_barrier
    v_add_f32 v34, v34, v38
    v_add_f32 v35, v35, v39
    v_add_f32 v32, v32, v34
    v_add_f32 v33, v33, v35
    v_mul_f32 v32, 0x3a800000, v32
    v_mul_f32 v33, 0x3a800000, v33
    v_fma_f32 v33, -v32, v32, v33
    v_max_f32 v33, 0, v33
    v_add_f32 v33, 0x3727c5ac, v33
    v_rsq_f32 v33, v33
    ds_write_b32 v11, v32 offset:1280
    ds_write_b32 v11, v33 offset:2304
    s_waitcnt lgkmcnt(0)
    s_barrier
    s_barrier
s_attn:
    s_sub_u32 s48, s8, 4
    s_lshl_b32 s3, s7, 7
    v_lshrrev_b32 v20, 3, v1
    v_lshlrev_b32 v21, 11, v20
    v_lshrrev_b32 v22, 2, v1
    v_lshrrev_b32 v23, 4, v1
    v_xor_b32 v22, v22, v23
    v_and_b32 v22, 1, v22
    v_lshl_add_u32 v21, v22, 6, v21
    v_and_b32 v22, 3, v1
    v_lshl_add_u32 v21, v22, 4, v21
    v_add_u32 v7, s3, v21
    s_mov_b32 s24, s42
    s_mov_b32 s25, s43
    s_mov_b32 s26, 2097152
    s_mov_b32 s27, 0x00020000
    s_lshr_b32 s49, s9, 1
    s_lshl_b32 s49, s49, 23
    s_lshl_b32 s52, s7, 19
    s_add_u32 s49, s49, s52
    s_and_b32 s52, s6, 1
    s_lshl_b32 s52, s52, 18
    s_add_u32 s49, s49, s52
    s_add_u32 s49, s49, 33554432
    s_lshr_b32 s61, s6, 1
    s_lshl_b32 s52, s48, 13
    s_add_u32 s53, s52, 81920
    v_add_u32 v8, s53, v5
    s_lshl_b32 s53, s61, 15
    s_add_u32 s52, s52, s53
    s_add_u32 s62, s52, s49
    s_add_u32 s63, s62, 4096
    s_mul_i32 s59, s9, 393216
    s_add_u32 s59, s59, 60424192
    s_and_b32 s52, s11, 31
    s_lshl_b32 s52, s52, 9
    s_add_u32 s59, s59, s52
    s_lshr_b32 s52, s61, 1
    s_lshl_b32 s52, s52, 7
    s_add_u32 s59, s59, s52
    s_and_b32 s52, s61, 1
    s_lshl_b32 s52, s52, 2
    s_add_u32 s52, s52, s48
    s_lshl_b32 s52, s52, 2
    s_add_u32 s59, s59, s52
    v_lshlrev_b32 v20, 14, v1
    v_mov_b32 v21, s10
    s_mul_i32 s54, s9, 393216
    s_add_u32 s54, s54, 60424192
    s_lshl_b32 s55, s11, 9
    s_add_u32 s54, s54, s55
    s_add_u32 s52, s4, s54
    s_addc_u32 s53, s5, 0
    s_mov_b32 s54, s10
    s_mov_b32 s55, s10
    s_lshl_b32 s51, s48, 12
    s_add_u32 s49, s49, s51
    s_add_u32 s51, s51, 81920
    s_mov_b32 s60, s48
    s_barrier
    ds_read_b128 v[32:35], v8 offset:0
    ds_read_b128 v[36:39], v8 offset:1024
    ds_read_b128 v[40:43], v8 offset:2048
    ds_read_b128 v[44:47], v8 offset:3072
    ds_read_b128 v[48:51], v8 offset:4096
    ds_read_b128 v[52:55], v8 offset:5120
    ds_read_b128 v[56:59], v8 offset:6144
    ds_read_b128 v[60:63], v8 offset:7168
    s_waitcnt lgkmcnt(7)
    buffer_store_dwordx4 v[32:35], v5, s[12:15], s62 offen offset:0 sc1
    s_waitcnt lgkmcnt(6)
    buffer_store_dwordx4 v[36:39], v5, s[12:15], s62 offen offset:1024 sc1
    s_waitcnt lgkmcnt(5)
    buffer_store_dwordx4 v[40:43], v5, s[12:15], s62 offen offset:2048 sc1
    s_waitcnt lgkmcnt(4)
    buffer_store_dwordx4 v[44:47], v5, s[12:15], s62 offen offset:3072 sc1
    s_waitcnt lgkmcnt(3)
    buffer_store_dwordx4 v[48:51], v5, s[12:15], s63 offen offset:0 sc1
    s_waitcnt lgkmcnt(2)
    buffer_store_dwordx4 v[52:55], v5, s[12:15], s63 offen offset:1024 sc1
    s_waitcnt lgkmcnt(1)
    buffer_store_dwordx4 v[56:59], v5, s[12:15], s63 offen offset:2048 sc1
    s_waitcnt lgkmcnt(0)
    buffer_store_dwordx4 v[60:63], v5, s[12:15], s63 offen offset:3072 sc1
    s_mov_b64 exec, 0xff
    s_waitcnt vmcnt(0)
    buffer_store_dword v21, v20, s[12:15], s59 offen sc1
    s_mov_b64 exec, -1
    s_add_u32 s62, s61, 1
    s_and_b32 s62, s62, 7
    s_lshl_b32 s50, s62, 15
    s_add_u32 s50, s50, s49
    s_lshr_b32 s63, s62, 1
    s_lshl_b32 s63, s63, 7
    s_and_b32 s62, s62, 1
    s_lshl_b32 s62, s62, 4
    s_add_u32 s62, s62, s63
    s_mov_b32 s58, 0x20000
need_20:
    s_load_dwordx4 s[64:67], s[52:53], s62 glc
    s_sub_u32 s58, s58, 1
    s_cbranch_scc1 need_20_ok
    s_waitcnt lgkmcnt(0)
    s_xor_b64 s[64:65], s[64:65], s[54:55]
    s_xor_b64 s[66:67], s[66:67], s[54:55]
    s_or_b64 s[64:65], s[64:65], s[66:67]
    s_cbranch_scc1 need_20
need_20_ok:
    s_waitcnt lgkmcnt(0)
    s_add_u32 m0, s51, 32768
    s_nop 0
    buffer_load_dwordx4 v5, s[12:15], s50 offen offset:0 sc1 lds
    buffer_load_dwordx4 v5, s[12:15], s50 offen offset:1024 sc1 lds
    buffer_load_dwordx4 v5, s[12:15], s50 offen offset:2048 sc1 lds
    buffer_load_dwordx4 v5, s[12:15], s50 offen offset:3072 sc1 lds
    s_add_u32 s50, s50, 16384
    s_add_u32 m0, s51, 49152
    s_nop 0
    buffer_load_dwordx4 v5, s[12:15], s50 offen offset:0 sc1 lds
    buffer_load_dwordx4 v5, s[12:15], s50 offen offset:1024 sc1 lds
    buffer_load_dwordx4 v5, s[12:15], s50 offen offset:2048 sc1 lds
    buffer_load_dwordx4 v5, s[12:15], s50 offen offset:3072 sc1 lds
    s_add_u32 s50, s50, 16384
    s_waitcnt vmcnt(4)
    s_barrier
    s_add_u32 s62, s61, 2
    s_and_b32 s62, s62, 7
    s_lshl_b32 s50, s62, 15
    s_add_u32 s50, s50, s49
    s_lshr_b32 s63, s62, 1
    s_lshl_b32 s63, s63, 7
    s_and_b32 s62, s62, 1
    s_lshl_b32 s62, s62, 4
    s_add_u32 s62, s62, s63
    s_mov_b32 s58, 0x20000
need_21:
    s_load_dwordx4 s[64:67], s[52:53], s62 glc
    s_sub_u32 s58, s58, 1
    s_cbranch_scc1 need_21_ok
    s_waitcnt lgkmcnt(0)
    s_xor_b64 s[64:65], s[64:65], s[54:55]
    s_xor_b64 s[66:67], s[66:67], s[54:55]
    s_or_b64 s[64:65], s[64:65], s[66:67]
    s_cbranch_scc1 need_21
need_21_ok:
    s_waitcnt lgkmcnt(0)
    s_add_u32 m0, s51, 0
    s_nop 0
    buffer_load_dwordx4 v5, s[12:15], s50 offen offset:0 sc1 lds
    buffer_load_dwordx4 v5, s[12:15], s50 offen offset:1024 sc1 lds
    buffer_load_dwordx4 v5, s[12:15], s50 offen offset:2048 sc1 lds
    buffer_load_dwordx4 v5, s[12:15], s50 offen offset:3072 sc1 lds
    s_add_u32 s50, s50, 16384
    s_waitcnt vmcnt(4)
    s_barrier
    s_add_u32 m0, s51, 16384
    s_nop 0
    buffer_load_dwordx4 v5, s[12:15], s50 offen offset:0 sc1 lds
    buffer_load_dwordx4 v5, s[12:15], s50 offen offset:1024 sc1 lds
    buffer_load_dwordx4 v5, s[12:15], s50 offen offset:2048 sc1 lds
    buffer_load_dwordx4 v5, s[12:15], s50 offen offset:3072 sc1 lds
    s_add_u32 s50, s50, 16384
    s_waitcnt vmcnt(4)
    s_barrier
    s_add_u32 s62, s61, 3
    s_and_b32 s62, s62, 7
    s_lshl_b32 s50, s62, 15
    s_add_u32 s50, s50, s49
    s_lshr_b32 s63, s62, 1
    s_lshl_b32 s63, s63, 7
    s_and_b32 s62, s62, 1
    s_lshl_b32 s62, s62, 4
    s_add_u32 s62, s62, s63
    s_mov_b32 s58, 0x20000
need_22:
    s_load_dwordx4 s[64:67], s[52:53], s62 glc
    s_sub_u32 s58, s58, 1
    s_cbranch_scc1 need_22_ok
    s_waitcnt lgkmcnt(0)
    s_xor_b64 s[64:65], s[64:65], s[54:55]
    s_xor_b64 s[66:67], s[66:67], s[54:55]
    s_or_b64 s[64:65], s[64:65], s[66:67]
    s_cbranch_scc1 need_22
need_22_ok:
    s_waitcnt lgkmcnt(0)
    s_add_u32 m0, s51, 32768
    s_nop 0
    buffer_load_dwordx4 v5, s[12:15], s50 offen offset:0 sc1 lds
    buffer_load_dwordx4 v5, s[12:15], s50 offen offset:1024 sc1 lds
    buffer_load_dwordx4 v5, s[12:15], s50 offen offset:2048 sc1 lds
    buffer_load_dwordx4 v5, s[12:15], s50 offen offset:3072 sc1 lds
    s_add_u32 s50, s50, 16384
    s_lshl_b32 m0, s60, 10
    s_lshl_b32 s3, s60, 14
    buffer_load_dwordx4 v7, s[24:27], s3 offen lds
    s_add_u32 s60, s60, 4
    s_lshl_b32 m0, s60, 10
    s_lshl_b32 s3, s60, 14
    buffer_load_dwordx4 v7, s[24:27], s3 offen lds
    s_add_u32 s60, s60, 4
    s_waitcnt vmcnt(6)
    s_barrier
    s_add_u32 m0, s51, 49152
    s_nop 0
    buffer_load_dwordx4 v5, s[12:15], s50 offen offset:0 sc1 lds
    buffer_load_dwordx4 v5, s[12:15], s50 offen offset:1024 sc1 lds
    buffer_load_dwordx4 v5, s[12:15], s50 offen offset:2048 sc1 lds
    buffer_load_dwordx4 v5, s[12:15], s50 offen offset:3072 sc1 lds
    s_add_u32 s50, s50, 16384
    s_lshl_b32 m0, s60, 10
    s_lshl_b32 s3, s60, 14
    buffer_load_dwordx4 v7, s[24:27], s3 offen lds
    s_add_u32 s60, s60, 4
    s_lshl_b32 m0, s60, 10
    s_lshl_b32 s3, s60, 14
    buffer_load_dwordx4 v7, s[24:27], s3 offen lds
    s_add_u32 s60, s60, 4
    s_waitcnt vmcnt(8)
    s_barrier
    s_add_u32 s62, s61, 4
    s_and_b32 s62, s62, 7
    s_lshl_b32 s50, s62, 15
    s_add_u32 s50, s50, s49
    s_lshr_b32 s63, s62, 1
    s_lshl_b32 s63, s63, 7
    s_and_b32 s62, s62, 1
    s_lshl_b32 s62, s62, 4
    s_add_u32 s62, s62, s63
    s_mov_b32 s58, 0x20000
need_23:
    s_load_dwordx4 s[64:67], s[52:53], s62 glc
    s_sub_u32 s58, s58, 1
    s_cbranch_scc1 need_23_ok
    s_waitcnt lgkmcnt(0)
    s_xor_b64 s[64:65], s[64:65], s[54:55]
    s_xor_b64 s[66:67], s[66:67], s[54:55]
    s_or_b64 s[64:65], s[64:65], s[66:67]
    s_cbranch_scc1 need_23
need_23_ok:
    s_waitcnt lgkmcnt(0)
    s_add_u32 m0, s51, 0
    s_nop 0
    buffer_load_dwordx4 v5, s[12:15], s50 offen offset:0 sc1 lds
    buffer_load_dwordx4 v5, s[12:15], s50 offen offset:1024 sc1 lds
    buffer_load_dwordx4 v5, s[12:15], s50 offen offset:2048 sc1 lds
    buffer_load_dwordx4 v5, s[12:15], s50 offen offset:3072 sc1 lds
    s_add_u32 s50, s50, 16384
    s_lshl_b32 m0, s60, 10
    s_lshl_b32 s3, s60, 14
    buffer_load_dwordx4 v7, s[24:27], s3 offen lds
    s_add_u32 s60, s60, 4
    s_lshl_b32 m0, s60, 10
    s_lshl_b32 s3, s60, 14
    buffer_load_dwordx4 v7, s[24:27], s3 offen lds
    s_add_u32 s60, s60, 4
    s_waitcnt vmcnt(8)
    s_barrier
    s_add_u32 m0, s51, 16384
    s_nop 0
    buffer_load_dwordx4 v5, s[12:15], s50 offen offset:0 sc1 lds
    buffer_load_dwordx4 v5, s[12:15], s50 offen offset:1024 sc1 lds
    buffer_load_dwordx4 v5, s[12:15], s50 offen offset:2048 sc1 lds
    buffer_load_dwordx4 v5, s[12:15], s50 offen offset:3072 sc1 lds
    s_add_u32 s50, s50, 16384
    s_lshl_b32 m0, s60, 10
    s_lshl_b32 s3, s60, 14
    buffer_load_dwordx4 v7, s[24:27], s3 offen lds
    s_add_u32 s60, s60, 4
    s_lshl_b32 m0, s60, 10
    s_lshl_b32 s3, s60, 14
    buffer_load_dwordx4 v7, s[24:27], s3 offen lds
    s_add_u32 s60, s60, 4
    s_waitcnt vmcnt(8)
    s_barrier
    s_add_u32 s62, s61, 5
    s_and_b32 s62, s62, 7
    s_lshl_b32 s50, s62, 15
    s_add_u32 s50, s50, s49
    s_lshr_b32 s63, s62, 1
    s_lshl_b32 s63, s63, 7
    s_and_b32 s62, s62, 1
    s_lshl_b32 s62, s62, 4
    s_add_u32 s62, s62, s63
    s_mov_b32 s58, 0x20000
need_24:
    s_load_dwordx4 s[64:67], s[52:53], s62 glc
    s_sub_u32 s58, s58, 1
    s_cbranch_scc1 need_24_ok
    s_waitcnt lgkmcnt(0)
    s_xor_b64 s[64:65], s[64:65], s[54:55]
    s_xor_b64 s[66:67], s[66:67], s[54:55]
    s_or_b64 s[64:65], s[64:65], s[66:67]
    s_cbranch_scc1 need_24
need_24_ok:
    s_waitcnt lgkmcnt(0)
    s_add_u32 m0, s51, 32768
    s_nop 0
    buffer_load_dwordx4 v5, s[12:15], s50 offen offset:0 sc1 lds
    buffer_load_dwordx4 v5, s[12:15], s50 offen offset:1024 sc1 lds
    buffer_load_dwordx4 v5, s[12:15], s50 offen offset:2048 sc1 lds
    buffer_load_dwordx4 v5, s[12:15], s50 offen offset:3072 sc1 lds
    s_add_u32 s50, s50, 16384
    s_lshl_b32 m0, s60, 10
    s_lshl_b32 s3, s60, 14
    buffer_load_dwordx4 v7, s[24:27], s3 offen lds
    s_add_u32 s60, s60, 4
    s_lshl_b32 m0, s60, 10
    s_lshl_b32 s3, s60, 14
    buffer_load_dwordx4 v7, s[24:27], s3 offen lds
    s_add_u32 s60, s60, 4
    s_waitcnt vmcnt(8)
    s_barrier
    s_add_u32 m0, s51, 49152
    s_nop 0
    buffer_load_dwordx4 v5, s[12:15], s50 offen offset:0 sc1 lds
    buffer_load_dwordx4 v5, s[12:15], s50 offen offset:1024 sc1 lds
    buffer_load_dwordx4 v5, s[12:15], s50 offen offset:2048 sc1 lds
    buffer_load_dwordx4 v5, s[12:15], s50 offen offset:3072 sc1 lds
    s_add_u32 s50, s50, 16384
    s_lshl_b32 m0, s60, 10
    s_lshl_b32 s3, s60, 14
    buffer_load_dwordx4 v7, s[24:27], s3 offen lds
    s_add_u32 s60, s60, 4
    s_lshl_b32 m0, s60, 10
    s_lshl_b32 s3, s60, 14
    buffer_load_dwordx4 v7, s[24:27], s3 offen lds
    s_add_u32 s60, s60, 4
    s_waitcnt vmcnt(8)
    s_barrier
    s_add_u32 s62, s61, 6
    s_and_b32 s62, s62, 7
    s_lshl_b32 s50, s62, 15
    s_add_u32 s50, s50, s49
    s_lshr_b32 s63, s62, 1
    s_lshl_b32 s63, s63, 7
    s_and_b32 s62, s62, 1
    s_lshl_b32 s62, s62, 4
    s_add_u32 s62, s62, s63
    s_mov_b32 s58, 0x20000
need_25:
    s_load_dwordx4 s[64:67], s[52:53], s62 glc
    s_sub_u32 s58, s58, 1
    s_cbranch_scc1 need_25_ok
    s_waitcnt lgkmcnt(0)
    s_xor_b64 s[64:65], s[64:65], s[54:55]
    s_xor_b64 s[66:67], s[66:67], s[54:55]
    s_or_b64 s[64:65], s[64:65], s[66:67]
    s_cbranch_scc1 need_25
need_25_ok:
    s_waitcnt lgkmcnt(0)
    s_add_u32 m0, s51, 0
    s_nop 0
    buffer_load_dwordx4 v5, s[12:15], s50 offen offset:0 sc1 lds
    buffer_load_dwordx4 v5, s[12:15], s50 offen offset:1024 sc1 lds
    buffer_load_dwordx4 v5, s[12:15], s50 offen offset:2048 sc1 lds
    buffer_load_dwordx4 v5, s[12:15], s50 offen offset:3072 sc1 lds
    s_add_u32 s50, s50, 16384
    s_lshl_b32 m0, s60, 10
    s_lshl_b32 s3, s60, 14
    buffer_load_dwordx4 v7, s[24:27], s3 offen lds
    s_add_u32 s60, s60, 4
    s_lshl_b32 m0, s60, 10
    s_lshl_b32 s3, s60, 14
    buffer_load_dwordx4 v7, s[24:27], s3 offen lds
    s_add_u32 s60, s60, 4
    s_waitcnt vmcnt(8)
    s_barrier
    s_add_u32 m0, s51, 16384
    s_nop 0
    buffer_load_dwordx4 v5, s[12:15], s50 offen offset:0 sc1 lds
    buffer_load_dwordx4 v5, s[12:15], s50 offen offset:1024 sc1 lds
    buffer_load_dwordx4 v5, s[12:15], s50 offen offset:2048 sc1 lds
    buffer_load_dwordx4 v5, s[12:15], s50 offen offset:3072 sc1 lds
    s_add_u32 s50, s50, 16384
    s_lshl_b32 m0, s60, 10
    s_lshl_b32 s3, s60, 14
    buffer_load_dwordx4 v7, s[24:27], s3 offen lds
    s_add_u32 s60, s60, 4
    s_lshl_b32 m0, s60, 10
    s_lshl_b32 s3, s60, 14
    buffer_load_dwordx4 v7, s[24:27], s3 offen lds
    s_add_u32 s60, s60, 4
    s_waitcnt vmcnt(8)
    s_barrier
    s_add_u32 s62, s61, 7
    s_and_b32 s62, s62, 7
    s_lshl_b32 s50, s62, 15
    s_add_u32 s50, s50, s49
    s_lshr_b32 s63, s62, 1
    s_lshl_b32 s63, s63, 7
    s_and_b32 s62, s62, 1
    s_lshl_b32 s62, s62, 4
    s_add_u32 s62, s62, s63
    s_mov_b32 s58, 0x20000
need_26:
    s_load_dwordx4 s[64:67], s[52:53], s62 glc
    s_sub_u32 s58, s58, 1
    s_cbranch_scc1 need_26_ok
    s_waitcnt lgkmcnt(0)
    s_xor_b64 s[64:65], s[64:65], s[54:55]
    s_xor_b64 s[66:67], s[66:67], s[54:55]
    s_or_b64 s[64:65], s[64:65], s[66:67]
    s_cbranch_scc1 need_26
need_26_ok:
    s_waitcnt lgkmcnt(0)
    s_add_u32 m0, s51, 32768
    s_nop 0
    buffer_load_dwordx4 v5, s[12:15], s50 offen offset:0 sc1 lds
    buffer_load_dwordx4 v5, s[12:15], s50 offen offset:1024 sc1 lds
    buffer_load_dwordx4 v5, s[12:15], s50 offen offset:2048 sc1 lds
    buffer_load_dwordx4 v5, s[12:15], s50 offen offset:3072 sc1 lds
    s_add_u32 s50, s50, 16384
    s_lshl_b32 m0, s60, 10
    s_lshl_b32 s3, s60, 14
    buffer_load_dwordx4 v7, s[24:27], s3 offen lds
    s_add_u32 s60, s60, 4
    s_lshl_b32 m0, s60, 10
    s_lshl_b32 s3, s60, 14
    buffer_load_dwordx4 v7, s[24:27], s3 offen lds
    s_add_u32 s60, s60, 4
    s_waitcnt vmcnt(8)
    s_barrier
    s_add_u32 m0, s51, 49152
    s_nop 0
    buffer_load_dwordx4 v5, s[12:15], s50 offen offset:0 sc1 lds
    buffer_load_dwordx4 v5, s[12:15], s50 offen offset:1024 sc1 lds
    buffer_load_dwordx4 v5, s[12:15], s50 offen offset:2048 sc1 lds
    buffer_load_dwordx4 v5, s[12:15], s50 offen offset:3072 sc1 lds
    s_add_u32 s50, s50, 16384
    s_lshl_b32 m0, s60, 10
    s_lshl_b32 s3, s60, 14
    buffer_load_dwordx4 v7, s[24:27], s3 offen lds
    s_add_u32 s60, s60, 4
    s_lshl_b32 m0, s60, 10
    s_lshl_b32 s3, s60, 14
    buffer_load_dwordx4 v7, s[24:27], s3 offen lds
    s_add_u32 s60, s60, 4
    s_waitcnt vmcnt(8)
    s_barrier
    s_lshl_b32 m0, s60, 10
    s_lshl_b32 s3, s60, 14
    buffer_load_dwordx4 v7, s[24:27], s3 offen lds
    s_add_u32 s60, s60, 4
    s_lshl_b32 m0, s60, 10
    s_lshl_b32 s3, s60, 14
    buffer_load_dwordx4 v7, s[24:27], s3 offen lds
    s_add_u32 s60, s60, 4
    s_lshl_b32 m0, s60, 10
    s_lshl_b32 s3, s60, 14
    buffer_load_dwordx4 v7, s[24:27], s3 offen lds
    s_add_u32 s60, s60, 4
    s_lshl_b32 m0, s60, 10
    s_lshl_b32 s3, s60, 14
    buffer_load_dwordx4 v7, s[24:27], s3 offen lds
    s_add_u32 s60, s60, 4
    s_waitcnt vmcnt(6)
    s_barrier
    s_lshl_b32 m0, s60, 10
    s_lshl_b32 s3, s60, 14
    buffer_load_dwordx4 v7, s[24:27], s3 offen lds
    s_add_u32 s60, s60, 4
    s_lshl_b32 m0, s60, 10
    s_lshl_b32 s3, s60, 14
    buffer_load_dwordx4 v7, s[24:27], s3 offen lds
    s_add_u32 s60, s60, 4
    s_lshl_b32 m0, s60, 10
    s_lshl_b32 s3, s60, 14
    buffer_load_dwordx4 v7, s[24:27], s3 offen lds
    s_add_u32 s60, s60, 4
    s_lshl_b32 m0, s60, 10
    s_lshl_b32 s3, s60, 14
    buffer_load_dwordx4 v7, s[24:27], s3 offen lds
    s_add_u32 s60, s60, 4
    s_barrier
    s_lshl_b32 m0, s60, 10
    s_lshl_b32 s3, s60, 14
    buffer_load_dwordx4 v7, s[24:27], s3 offen lds
    s_add_u32 s60, s60, 4
    s_lshl_b32 m0, s60, 10
    s_lshl_b32 s3, s60, 14
    buffer_load_dwordx4 v7, s[24:27], s3 offen lds
    s_add_u32 s60, s60, 4
    s_lshl_b32 m0, s60, 10
    s_lshl_b32 s3, s60, 14
    buffer_load_dwordx4 v7, s[24:27], s3 offen lds
    s_add_u32 s60, s60, 4
    s_lshl_b32 m0, s60, 10
    s_lshl_b32 s3, s60, 14
    buffer_load_dwordx4 v7, s[24:27], s3 offen lds
    s_add_u32 s60, s60, 4
    s_cmp_eq_u32 s8, 4
    s_cbranch_scc1 h_wo
    s_branch l_wo
.p2align 6
c_attn_slow:
    s_waitcnt lgkmcnt(0)
    s_lshr_b32 s56, s9, 1
    s_lshl_b32 s56, s56, 23
    s_lshl_b32 s55, s7, 19
    s_add_u32 s56, s56, s55
    s_and_b32 s55, s6, 1
    s_lshl_b32 s55, s55, 18
    s_add_u32 s56, s56, s55
    s_add_u32 s56, s56, 33554432
    v_mov_b32 v28, 0xff800000
    v_mov_b32 v30, 0xff800000
    s_mov_b32 s57, 0
c_attn_slow1:
    s_lshr_b32 s55, s57, 2
    s_lshl_b32 s55, s55, 14
    s_and_b32 s58, s57, 3
    s_lshl_b32 s58, s58, 11
    s_add_u32 s55, s55, s58
    s_add_u32 s55, s55, s56
    buffer_load_dwordx4 v[128:131], v5, s[12:15], s55 offen offset:0 sc1
    buffer_load_dwordx4 v[132:135], v5, s[12:15], s55 offen offset:1024 sc1
    s_waitcnt vmcnt(0)
    v_mfma_f32_32x32x16_bf16 v[64:79], v[128:131], v[8:11], 0
    v_mfma_f32_32x32x16_bf16 v[80:95], v[128:131], v[16:19], 0
    v_mfma_f32_32x32x16_bf16 v[64:79], v[132:135], v[12:15], v[64:79]
    v_mfma_f32_32x32x16_bf16 v[80:95], v[132:135], v[20:23], v[80:95]
    s_nop 10
    v_max3_f32 v28, v28, v64, v65
    v_max3_f32 v28, v28, v66, v67
    v_max3_f32 v28, v28, v68, v69
    v_max3_f32 v28, v28, v70, v71
    v_max3_f32 v28, v28, v72, v73
    v_max3_f32 v28, v28, v74, v75
    v_max3_f32 v28, v28, v76, v77
    v_max3_f32 v28, v28, v78, v79
    v_max3_f32 v30, v30, v80, v81
    v_max3_f32 v30, v30, v82, v83
    v_max3_f32 v30, v30, v84, v85
    v_max3_f32 v30, v30, v86, v87
    v_max3_f32 v30, v30, v88, v89
    v_max3_f32 v30, v30, v90, v91
    v_max3_f32 v30, v30, v92, v93
    v_max3_f32 v30, v30, v94, v95
    s_add_u32 s57, s57, 1
    s_cmp_lt_u32 s57, 64
    s_cbranch_scc1 c_attn_slow1
    v_mov_b32 v29, v28
    s_nop 1
    v_permlane32_swap_b32 v28, v29
    v_max_f32 v28, v28, v29
    v_sub_f32 v96, 0, v28
    v_sub_f32 v97, 0, v28
    v_sub_f32 v98, 0, v28
    v_sub_f32 v99, 0, v28
    v_sub_f32 v100, 0, v28
    v_sub_f32 v101, 0, v28
    v_sub_f32 v102, 0, v28
    v_sub_f32 v103, 0, v28
    v_sub_f32 v104, 0, v28
    v_sub_f32 v105, 0, v28
    v_sub_f32 v106, 0, v28
    v_sub_f32 v107, 0, v28
    v_sub_f32 v108, 0, v28
    v_sub_f32 v109, 0, v28
    v_sub_f32 v110, 0, v28
    v_sub_f32 v111, 0, v28
    v_mov_b32 v160, 0
    v_mov_b32 v161, 0
    v_mov_b32 v162, 0
    v_mov_b32 v163, 0
    v_mov_b32 v164, 0
    v_mov_b32 v165, 0
    v_mov_b32 v166, 0
    v_mov_b32 v167, 0
    v_mov_b32 v168, 0
    v_mov_b32 v169, 0
    v_mov_b32 v170, 0
    v_mov_b32 v171, 0
    v_mov_b32 v172, 0
    v_mov_b32 v173, 0
    v_mov_b32 v174, 0
    v_mov_b32 v175, 0
    v_mov_b32 v192, 0
    v_mov_b32 v193, 0
    v_mov_b32 v194, 0
    v_mov_b32 v195, 0
    v_mov_b32 v31, v30
    s_nop 1
    v_permlane32_swap_b32 v30, v31
    v_max_f32 v30, v30, v31
    v_sub_f32 v112, 0, v30
    v_sub_f32 v113, 0, v30
    v_sub_f32 v114, 0, v30
    v_sub_f32 v115, 0, v30
    v_sub_f32 v116, 0, v30
    v_sub_f32 v117, 0, v30
    v_sub_f32 v118, 0, v30
    v_sub_f32 v119, 0, v30
    v_sub_f32 v120, 0, v30
    v_sub_f32 v121, 0, v30
    v_sub_f32 v122, 0, v30
    v_sub_f32 v123, 0, v30
    v_sub_f32 v124, 0, v30
    v_sub_f32 v125, 0, v30
    v_sub_f32 v126, 0, v30
    v_sub_f32 v127, 0, v30
    v_mov_b32 v176, 0
    v_mov_b32 v177, 0
    v_mov_b32 v178, 0
    v_mov_b32 v179, 0
    v_mov_b32 v180, 0
    v_mov_b32 v181, 0
    v_mov_b32 v182, 0
    v_mov_b32 v183, 0
    v_mov_b32 v184, 0
    v_mov_b32 v185, 0
    v_mov_b32 v186, 0
    v_mov_b32 v187, 0
    v_mov_b32 v188, 0
    v_mov_b32 v189, 0
    v_mov_b32 v190, 0
    v_mov_b32 v191, 0
    v_mov_b32 v196, 0
    v_mov_b32 v197, 0
    v_mov_b32 v198, 0
    v_mov_b32 v199, 0
    s_mov_b32 s57, 0
c_attn_slow2:
    s_lshr_b32 s55, s57, 2
    s_lshl_b32 s55, s55, 14
    s_and_b32 s58, s57, 3
    s_lshl_b32 s58, s58, 11
    s_add_u32 s55, s55, s58
    s_add_u32 s55, s55, s56
    buffer_load_dwordx4 v[128:131], v5, s[12:15], s55 offen offset:0 sc1
    buffer_load_dwordx4 v[132:135], v5, s[12:15], s55 offen offset:1024 sc1
    s_add_u32 s55, s55, 8192
    buffer_load_dwordx4 v[144:147], v5, s[12:15], s55 offen offset:0 sc1
    buffer_load_dwordx4 v[148:151], v5, s[12:15], s55 offen offset:1024 sc1
    s_waitcnt vmcnt(0)
    v_mfma_f32_32x32x16_bf16 v[64:79], v[128:131], v[8:11], v[96:111]
    v_mfma_f32_32x32x16_bf16 v[80:95], v[128:131], v[16:19], v[112:127]
    v_mfma_f32_32x32x16_bf16 v[64:79], v[132:135], v[12:15], v[64:79]
    v_mfma_f32_32x32x16_bf16 v[80:95], v[132:135], v[20:23], v[80:95]
    s_nop 10
    v_exp_f32 v64, v64
    v_exp_f32 v65, v65
    v_exp_f32 v66, v66
    v_exp_f32 v67, v67
    v_exp_f32 v68, v68
    v_exp_f32 v69, v69
    v_exp_f32 v70, v70
    v_exp_f32 v71, v71
    v_exp_f32 v72, v72
    v_exp_f32 v73, v73
    v_exp_f32 v74, v74
    v_exp_f32 v75, v75
    v_exp_f32 v76, v76
    v_exp_f32 v77, v77
    v_exp_f32 v78, v78
    v_exp_f32 v79, v79
    v_exp_f32 v80, v80
    v_exp_f32 v81, v81
    v_exp_f32 v82, v82
    v_exp_f32 v83, v83
    v_exp_f32 v84, v84
    v_exp_f32 v85, v85
    v_exp_f32 v86, v86
    v_exp_f32 v87, v87
    v_exp_f32 v88, v88
    v_exp_f32 v89, v89
    v_exp_f32 v90, v90
    v_exp_f32 v91, v91
    v_exp_f32 v92, v92
    v_exp_f32 v93, v93
    v_exp_f32 v94, v94
    v_exp_f32 v95, v95
    v_smfmac_f32_32x32x32_bf16 v[160:175], v[144:147], v[64:71], v204
    v_smfmac_f32_16x16x64_bf16 v[192:195], v[200:203], v[64:71], v204
    v_smfmac_f32_32x32x32_bf16 v[160:175], v[148:151], v[72:79], v204
    v_smfmac_f32_16x16x64_bf16 v[192:195], v[200:203], v[72:79], v204
    v_smfmac_f32_32x32x32_bf16 v[176:191], v[144:147], v[80:87], v204
    v_smfmac_f32_16x16x64_bf16 v[196:199], v[200:203], v[80:87], v204
    v_smfmac_f32_32x32x32_bf16 v[176:191], v[148:151], v[88:95], v204
    v_smfmac_f32_16x16x64_bf16 v[196:199], v[200:203], v[88:95], v204
    s_add_u32 s57, s57, 1
    s_cmp_lt_u32 s57, 64
    s_nop 15
    s_cbranch_scc1 c_attn_slow2
    s_branch c_attn_fin
    s_endpgm
.section .rodata,"a"
.p2align 6
.amdhsa_kernel interleave_layers__sliding_local_dilated__softmax_full_mha__prompt_kernel
  .amdhsa_next_free_vgpr 256
  .amdhsa_next_free_sgpr 102
  .amdhsa_accum_offset 224
  .amdhsa_group_segment_fixed_size 0
  .amdhsa_kernarg_size 72
  .amdhsa_user_sgpr_count 2
  .amdhsa_user_sgpr_kernarg_segment_ptr 1
  .amdhsa_system_sgpr_workgroup_id_x 1
.end_amdhsa_kernel
```

```asm
; @launch grid=(256,1,1) block=(512,1,1) lds=159744
.amdgcn_target "amdgcn-amd-amdhsa--gfx950"
.text
.globl interleave_layers__sliding_local_dilated__softmax_full_mha__prompt_kernel
.type interleave_layers__sliding_local_dilated__softmax_full_mha__prompt_kernel,@function
.p2align 8
interleave_layers__sliding_local_dilated__softmax_full_mha__prompt_kernel:
    s_cmp_ge_u32 s2, 256
    s_cbranch_scc1 k_exit2
    s_load_dwordx16 s[32:47], s[0:1], 0
    s_load_dwordx2 s[4:5], s[0:1], 64
    v_lshrrev_b32 v2, 6, v0
    v_and_b32 v1, 63, v0
    v_readfirstlane_b32 s8, v2
    s_and_b32 s3, s2, 1
    s_lshl_b32 s3, s3, 3
    s_bfe_u32 s6, s2, 0x30003
    s_add_u32 s6, s3, s6
    s_bfe_u32 s3, s2, 0x20001
    s_lshl_b32 s3, s3, 2
    s_lshr_b32 s7, s2, 6
    s_add_u32 s7, s3, s7
    s_lshl_b32 s11, s6, 4
    s_add_u32 s11, s11, s7
    s_mov_b32 s9, -1
    s_mov_b32 s96, 0
    s_mov_b32 s10, 0
    s_waitcnt lgkmcnt(0)
    s_mov_b32 s12, s4
    s_mov_b32 s13, s5
    s_mov_b32 s14, 67108864
    s_mov_b32 s15, 0x00020000
    s_cmp_lt_u32 s8, 4
    s_cbranch_scc1 c_prep
    s_cmp_eq_u32 s8, 4
    s_cbranch_scc1 h_raw
    s_branch l_raw
k_exit:
k_exit2:
    s_endpgm
.p2align 6
c_qkva:
    v_and_b32 v1, 63, v0
    v_lshrrev_b32 v2, 6, v0
    v_lshlrev_b32 v5, 4, v1
    s_lshl_b32 s48, s6, 2
    s_add_u32 s48, s48, s8
    s_lshl_b32 s55, s48, 16
    v_lshrrev_b32 v3, 5, v1
    v_and_b32 v4, 15, v0
    v_bfe_u32 v19, v1, 4, 1
    v_lshl_add_u32 v6, v19, 5, v4
    v_lshlrev_b32 v6, 4, v6
    v_lshl_add_u32 v6, v3, 10, v6
    s_lshl_b32 s56, s9, 22
    s_add_u32 s55, s55, s56
    s_add_u32 s16, s4, s55
    s_addc_u32 s17, s5, 0
    s_mov_b32 s18, 65536
    s_mov_b32 s19, 0x00020000
    s_movk_i32 s54, 4096
    v_lshrrev_b32 v23, 2, v4
    v_lshl_add_u32 v23, v19, 2, v23
    v_lshlrev_b32 v23, 7, v23
    v_and_b32 v22, 3, v4
    v_lshl_add_u32 v23, v22, 3, v23
    v_mul_u32_u24 v22, 6144, v3
    v_add_u32 v23, v23, v22
    v_lshrrev_b32 v22, 3, v4
    v_lshl_add_u32 v22, v22, 1, v19
    v_xor_b32 v24, 0, v22
    v_lshl_add_u32 v11, v24, 5, v23
    v_mov_b32 v7, v11
    v_xor_b32 v24, 1, v22
    v_lshl_add_u32 v12, v24, 5, v23
    v_mov_b32 v8, v12
    v_xor_b32 v24, 2, v22
    v_lshl_add_u32 v13, v24, 5, v23
    v_mov_b32 v9, v13
    v_xor_b32 v24, 3, v22
    v_lshl_add_u32 v14, v24, 5, v23
    v_mov_b32 v10, v14
    v_xor_b32 v24, v2, v22
    v_lshl_add_u32 v16, v24, 5, v23
    v_mov_b32 v15, v16
    v_add_u32 v18, 147456, v5
    v_mov_b32 v17, v18
    v_mov_b32 v32, 0
    v_mov_b32 v33, 0
    v_mov_b32 v34, 0
    v_mov_b32 v35, 0
    v_mov_b32 v36, 0
    v_mov_b32 v37, 0
    v_mov_b32 v38, 0
    v_mov_b32 v39, 0
    v_mov_b32 v40, 0
    v_mov_b32 v41, 0
    v_mov_b32 v42, 0
    v_mov_b32 v43, 0
    v_mov_b32 v44, 0
    v_mov_b32 v45, 0
    v_mov_b32 v46, 0
    v_mov_b32 v47, 0
    v_mov_b32 v48, 0
    v_mov_b32 v49, 0
    v_mov_b32 v50, 0
    v_mov_b32 v51, 0
    v_mov_b32 v52, 0
    v_mov_b32 v53, 0
    v_mov_b32 v54, 0
    v_mov_b32 v55, 0
    v_mov_b32 v56, 0
    v_mov_b32 v57, 0
    v_mov_b32 v58, 0
    v_mov_b32 v59, 0
    v_mov_b32 v60, 0
    v_mov_b32 v61, 0
    v_mov_b32 v62, 0
    v_mov_b32 v63, 0
    v_mov_b32 v64, 0
    v_mov_b32 v65, 0
    v_mov_b32 v66, 0
    v_mov_b32 v67, 0
    v_mov_b32 v68, 0
    v_mov_b32 v69, 0
    v_mov_b32 v70, 0
    v_mov_b32 v71, 0
    v_mov_b32 v72, 0
    v_mov_b32 v73, 0
    v_mov_b32 v74, 0
    v_mov_b32 v75, 0
    v_mov_b32 v76, 0
    v_mov_b32 v77, 0
    v_mov_b32 v78, 0
    v_mov_b32 v79, 0
    v_mov_b32 v80, 0
    v_mov_b32 v81, 0
    v_mov_b32 v82, 0
    v_mov_b32 v83, 0
    v_mov_b32 v84, 0
    v_mov_b32 v85, 0
    v_mov_b32 v86, 0
    v_mov_b32 v87, 0
    v_mov_b32 v88, 0
    v_mov_b32 v89, 0
    v_mov_b32 v90, 0
    v_mov_b32 v91, 0
    v_mov_b32 v92, 0
    v_mov_b32 v93, 0
    v_mov_b32 v94, 0
    v_mov_b32 v95, 0
    v_mov_b32 v96, 0
    v_mov_b32 v97, 0
    v_mov_b32 v98, 0
    v_mov_b32 v99, 0
    v_mov_b32 v100, 0
    v_mov_b32 v101, 0
    v_mov_b32 v102, 0
    v_mov_b32 v103, 0
    v_mov_b32 v104, 0
    v_mov_b32 v105, 0
    v_mov_b32 v106, 0
    v_mov_b32 v107, 0
    v_mov_b32 v108, 0
    v_mov_b32 v109, 0
    v_mov_b32 v110, 0
    v_mov_b32 v111, 0
    v_mov_b32 v112, 0
    v_mov_b32 v113, 0
    v_mov_b32 v114, 0
    v_mov_b32 v115, 0
    v_mov_b32 v116, 0
    v_mov_b32 v117, 0
    v_mov_b32 v118, 0
    v_mov_b32 v119, 0
    v_mov_b32 v120, 0
    v_mov_b32 v121, 0
    v_mov_b32 v122, 0
    v_mov_b32 v123, 0
    v_mov_b32 v124, 0
    v_mov_b32 v125, 0
    v_mov_b32 v126, 0
    v_mov_b32 v127, 0
    v_mov_b32 v128, 0
    v_mov_b32 v129, 0
    v_mov_b32 v130, 0
    v_mov_b32 v131, 0
    v_mov_b32 v132, 0
    v_mov_b32 v133, 0
    v_mov_b32 v134, 0
    v_mov_b32 v135, 0
    v_mov_b32 v184, 0
    v_mov_b32 v185, 0
    v_mov_b32 v186, 0
    v_mov_b32 v187, 0
    v_mov_b32 v188, 0
    v_mov_b32 v189, 0
    v_mov_b32 v190, 0
    v_mov_b32 v191, 0
    v_mov_b32 v192, 0
    v_mov_b32 v193, 0
    v_mov_b32 v194, 0
    v_mov_b32 v195, 0
    v_mov_b32 v196, 0
    v_mov_b32 v197, 0
    v_mov_b32 v198, 0
    v_mov_b32 v199, 0
    s_barrier
    buffer_load_dwordx4 a[0:3], v6, s[16:19], 0 offen offset:0 sc1
    buffer_load_dwordx4 a[4:7], v6, s[16:19], 0 offen offset:256 sc1
    buffer_load_dwordx4 a[8:11], v6, s[16:19], 0 offen offset:2048 sc1
    buffer_load_dwordx4 a[12:15], v6, s[16:19], 0 offen offset:2304 sc1
    buffer_load_dwordx4 a[16:19], v6, s[16:19], s54 offen offset:0 sc1
    buffer_load_dwordx4 a[20:23], v6, s[16:19], s54 offen offset:256 sc1
    s_mov_b32 s50, 6144
    s_mov_b32 s51, 10240
    s_mov_b32 s52, 0
    s_mov_b32 s53, 0
    s_mov_b32 s54, 8
    ds_read_b64_tr_b16 v[136:137], v7 offset:0
    ds_read_b64_tr_b16 v[138:139], v7 offset:3072
    ds_read_b64_tr_b16 v[140:141], v8 offset:0
    ds_read_b64_tr_b16 v[142:143], v8 offset:3072
    ds_read_b64_tr_b16 v[144:145], v9 offset:0
    ds_read_b64_tr_b16 v[146:147], v9 offset:3072
    ds_read_b64_tr_b16 v[148:149], v10 offset:0
    ds_read_b64_tr_b16 v[150:151], v10 offset:3072
    ds_read_b64_tr_b16 v[152:153], v7 offset:1024
    ds_read_b64_tr_b16 v[154:155], v7 offset:4096
    ds_read_b64_tr_b16 v[156:157], v8 offset:1024
    ds_read_b64_tr_b16 v[158:159], v8 offset:4096
    ds_read_b64_tr_b16 v[160:161], v9 offset:1024
    ds_read_b64_tr_b16 v[162:163], v9 offset:4096
    ds_read_b64_tr_b16 v[164:165], v10 offset:1024
    ds_read_b64_tr_b16 v[166:167], v10 offset:4096
    ds_read_b64_tr_b16 v[168:169], v7 offset:2048
    ds_read_b64_tr_b16 v[170:171], v7 offset:5120
    ds_read_b64_tr_b16 v[172:173], v8 offset:2048
    ds_read_b64_tr_b16 v[174:175], v8 offset:5120
    ds_read_b64_tr_b16 v[176:177], v9 offset:2048
    ds_read_b64_tr_b16 v[178:179], v9 offset:5120
    s_waitcnt vmcnt(4)
    s_barrier
.p2align 3
c_qkva_loop:
    s_waitcnt vmcnt(4) lgkmcnt(10)
    v_mfma_f32_16x16x32_bf16 v[128:131], v[184:187], v[196:199], v[128:131]
    v_mfma_f32_16x16x32_bf16 v[132:135], v[196:199], v[188:191], v[132:135]
    v_mfma_f32_16x16x32_bf16 v[32:35], v[136:139], a[0:3], v[32:35]
    ds_read_b64_tr_b16 v[180:181], v10 offset:2048
    v_mfma_f32_16x16x32_bf16 v[36:39], v[136:139], a[4:7], v[36:39]
    ds_read_b64_tr_b16 v[182:183], v10 offset:5120
    v_mfma_f32_16x16x32_bf16 v[40:43], v[140:143], a[0:3], v[40:43]
    ds_read_b64_tr_b16 v[136:137], v7 offset:12288
    buffer_load_dwordx4 a[24:27], v6, s[16:19], s50 offen offset:0 sc1
    v_mfma_f32_16x16x32_bf16 v[44:47], v[140:143], a[4:7], v[44:47]
    ds_read_b64_tr_b16 v[138:139], v7 offset:15360
    v_mfma_f32_16x16x32_bf16 v[48:51], v[144:147], a[0:3], v[48:51]
    ds_read_b64_tr_b16 v[140:141], v8 offset:12288
    v_mfma_f32_16x16x32_bf16 v[52:55], v[144:147], a[4:7], v[52:55]
    ds_read_b64_tr_b16 v[142:143], v8 offset:15360
    ds_read_b64_tr_b16 v[184:185], v15 offset:1024
    ds_read_b64_tr_b16 v[186:187], v15 offset:4096
    v_mfma_f32_16x16x32_bf16 v[56:59], v[148:151], a[0:3], v[56:59]
    ds_read_b64_tr_b16 v[144:145], v9 offset:12288
    buffer_load_dwordx4 a[28:31], v6, s[16:19], s50 offen offset:256 sc1
    v_mfma_f32_16x16x32_bf16 v[60:63], v[148:151], a[4:7], v[60:63]
    ds_read_b64_tr_b16 v[146:147], v9 offset:15360
    v_mfma_f32_16x16x32_bf16 v[64:67], v[152:155], a[0:3], v[64:67]
    ds_read_b64_tr_b16 v[148:149], v10 offset:12288
    v_mfma_f32_16x16x32_bf16 v[68:71], v[152:155], a[4:7], v[68:71]
    ds_read_b64_tr_b16 v[150:151], v10 offset:15360
    ds_read_b64_tr_b16 v[188:189], v15 offset:2048
    ds_read_b64_tr_b16 v[190:191], v15 offset:5120
    v_mfma_f32_16x16x32_bf16 v[72:75], v[156:159], a[0:3], v[72:75]
    ds_read_b64_tr_b16 v[152:153], v7 offset:13312
    v_mfma_f32_16x16x32_bf16 v[76:79], v[156:159], a[4:7], v[76:79]
    ds_read_b64_tr_b16 v[154:155], v7 offset:16384
    v_mfma_f32_16x16x32_bf16 v[80:83], v[160:163], a[0:3], v[80:83]
    ds_read_b64_tr_b16 v[156:157], v8 offset:13312
    v_mfma_f32_16x16x32_bf16 v[84:87], v[160:163], a[4:7], v[84:87]
    ds_read_b64_tr_b16 v[158:159], v8 offset:16384
    ds_read_b128 v[192:195], v17 offset:0
    v_mfma_f32_16x16x32_bf16 v[88:91], v[164:167], a[0:3], v[88:91]
    ds_read_b64_tr_b16 v[160:161], v9 offset:13312
    v_mfma_f32_16x16x32_bf16 v[92:95], v[164:167], a[4:7], v[92:95]
    ds_read_b64_tr_b16 v[162:163], v9 offset:16384
    v_mfma_f32_16x16x32_bf16 v[96:99], a[0:3], v[168:171], v[96:99]
    ds_read_b64_tr_b16 v[164:165], v10 offset:13312
    v_mfma_f32_16x16x32_bf16 v[100:103], a[4:7], v[168:171], v[100:103]
    ds_read_b64_tr_b16 v[166:167], v10 offset:16384
    v_mfma_f32_16x16x32_bf16 v[104:107], a[0:3], v[172:175], v[104:107]
    ds_read_b64_tr_b16 v[168:169], v7 offset:14336
    v_mfma_f32_16x16x32_bf16 v[108:111], a[4:7], v[172:175], v[108:111]
    ds_read_b64_tr_b16 v[170:171], v7 offset:17408
    v_mfma_f32_16x16x32_bf16 v[112:115], a[0:3], v[176:179], v[112:115]
    ds_read_b64_tr_b16 v[172:173], v8 offset:14336
    v_mfma_f32_16x16x32_bf16 v[116:119], a[4:7], v[176:179], v[116:119]
    ds_read_b64_tr_b16 v[174:175], v8 offset:17408
    v_mfma_f32_16x16x32_bf16 v[120:123], a[0:3], v[180:183], v[120:123]
    ds_read_b64_tr_b16 v[176:177], v9 offset:14336
    v_mfma_f32_16x16x32_bf16 v[124:127], a[4:7], v[180:183], v[124:127]
    ds_read_b64_tr_b16 v[178:179], v9 offset:17408
    s_waitcnt vmcnt(4) lgkmcnt(10)
    v_mfma_f32_16x16x32_bf16 v[128:131], v[184:187], v[192:195], v[128:131]
    v_mfma_f32_16x16x32_bf16 v[132:135], v[192:195], v[188:191], v[132:135]
    v_mfma_f32_16x16x32_bf16 v[32:35], v[136:139], a[8:11], v[32:35]
    ds_read_b64_tr_b16 v[180:181], v10 offset:14336
    v_mfma_f32_16x16x32_bf16 v[36:39], v[136:139], a[12:15], v[36:39]
    ds_read_b64_tr_b16 v[182:183], v10 offset:17408
    s_barrier
    v_mfma_f32_16x16x32_bf16 v[40:43], v[140:143], a[8:11], v[40:43]
    ds_read_b64_tr_b16 v[136:137], v7 offset:24576
    buffer_load_dwordx4 a[0:3], v6, s[16:19], s50 offen offset:2048 sc1
    v_mfma_f32_16x16x32_bf16 v[44:47], v[140:143], a[12:15], v[44:47]
    ds_read_b64_tr_b16 v[138:139], v7 offset:27648
    v_mfma_f32_16x16x32_bf16 v[48:51], v[144:147], a[8:11], v[48:51]
    ds_read_b64_tr_b16 v[140:141], v8 offset:24576
    v_mfma_f32_16x16x32_bf16 v[52:55], v[144:147], a[12:15], v[52:55]
    ds_read_b64_tr_b16 v[142:143], v8 offset:27648
    ds_read_b64_tr_b16 v[184:185], v15 offset:13312
    ds_read_b64_tr_b16 v[186:187], v15 offset:16384
    v_mfma_f32_16x16x32_bf16 v[56:59], v[148:151], a[8:11], v[56:59]
    ds_read_b64_tr_b16 v[144:145], v9 offset:24576
    buffer_load_dwordx4 a[4:7], v6, s[16:19], s50 offen offset:2304 sc1
    v_mfma_f32_16x16x32_bf16 v[60:63], v[148:151], a[12:15], v[60:63]
    ds_read_b64_tr_b16 v[146:147], v9 offset:27648
    v_mfma_f32_16x16x32_bf16 v[64:67], v[152:155], a[8:11], v[64:67]
    ds_read_b64_tr_b16 v[148:149], v10 offset:24576
    v_mfma_f32_16x16x32_bf16 v[68:71], v[152:155], a[12:15], v[68:71]
    ds_read_b64_tr_b16 v[150:151], v10 offset:27648
    ds_read_b64_tr_b16 v[188:189], v15 offset:14336
    ds_read_b64_tr_b16 v[190:191], v15 offset:17408
    v_mfma_f32_16x16x32_bf16 v[72:75], v[156:159], a[8:11], v[72:75]
    ds_read_b64_tr_b16 v[152:153], v7 offset:25600
    v_mfma_f32_16x16x32_bf16 v[76:79], v[156:159], a[12:15], v[76:79]
    ds_read_b64_tr_b16 v[154:155], v7 offset:28672
    v_mfma_f32_16x16x32_bf16 v[80:83], v[160:163], a[8:11], v[80:83]
    ds_read_b64_tr_b16 v[156:157], v8 offset:25600
    v_mfma_f32_16x16x32_bf16 v[84:87], v[160:163], a[12:15], v[84:87]
    ds_read_b64_tr_b16 v[158:159], v8 offset:28672
    ds_read_b128 v[196:199], v17 offset:1024
    v_mfma_f32_16x16x32_bf16 v[88:91], v[164:167], a[8:11], v[88:91]
    ds_read_b64_tr_b16 v[160:161], v9 offset:25600
    v_mfma_f32_16x16x32_bf16 v[92:95], v[164:167], a[12:15], v[92:95]
    ds_read_b64_tr_b16 v[162:163], v9 offset:28672
    v_mfma_f32_16x16x32_bf16 v[96:99], a[8:11], v[168:171], v[96:99]
    ds_read_b64_tr_b16 v[164:165], v10 offset:25600
    v_mfma_f32_16x16x32_bf16 v[100:103], a[12:15], v[168:171], v[100:103]
    ds_read_b64_tr_b16 v[166:167], v10 offset:28672
    v_mfma_f32_16x16x32_bf16 v[104:107], a[8:11], v[172:175], v[104:107]
    ds_read_b64_tr_b16 v[168:169], v7 offset:26624
    v_mfma_f32_16x16x32_bf16 v[108:111], a[12:15], v[172:175], v[108:111]
    ds_read_b64_tr_b16 v[170:171], v7 offset:29696
    v_mfma_f32_16x16x32_bf16 v[112:115], a[8:11], v[176:179], v[112:115]
    ds_read_b64_tr_b16 v[172:173], v8 offset:26624
    v_mfma_f32_16x16x32_bf16 v[116:119], a[12:15], v[176:179], v[116:119]
    ds_read_b64_tr_b16 v[174:175], v8 offset:29696
    v_mfma_f32_16x16x32_bf16 v[120:123], a[8:11], v[180:183], v[120:123]
    ds_read_b64_tr_b16 v[176:177], v9 offset:26624
    v_mfma_f32_16x16x32_bf16 v[124:127], a[12:15], v[180:183], v[124:127]
    ds_read_b64_tr_b16 v[178:179], v9 offset:29696
    s_waitcnt vmcnt(4) lgkmcnt(10)
    v_mfma_f32_16x16x32_bf16 v[128:131], v[184:187], v[196:199], v[128:131]
    v_mfma_f32_16x16x32_bf16 v[132:135], v[196:199], v[188:191], v[132:135]
    v_mfma_f32_16x16x32_bf16 v[32:35], v[136:139], a[16:19], v[32:35]
    ds_read_b64_tr_b16 v[180:181], v10 offset:26624
    v_mfma_f32_16x16x32_bf16 v[36:39], v[136:139], a[20:23], v[36:39]
    ds_read_b64_tr_b16 v[182:183], v10 offset:29696
    v_mfma_f32_16x16x32_bf16 v[40:43], v[140:143], a[16:19], v[40:43]
    ds_read_b64_tr_b16 v[136:137], v7 offset:36864
    buffer_load_dwordx4 a[8:11], v6, s[16:19], s51 offen offset:0 sc1
    v_mfma_f32_16x16x32_bf16 v[44:47], v[140:143], a[20:23], v[44:47]
    ds_read_b64_tr_b16 v[138:139], v7 offset:39936
    v_mfma_f32_16x16x32_bf16 v[48:51], v[144:147], a[16:19], v[48:51]
    ds_read_b64_tr_b16 v[140:141], v8 offset:36864
    v_mfma_f32_16x16x32_bf16 v[52:55], v[144:147], a[20:23], v[52:55]
    ds_read_b64_tr_b16 v[142:143], v8 offset:39936
    ds_read_b64_tr_b16 v[184:185], v15 offset:25600
    ds_read_b64_tr_b16 v[186:187], v15 offset:28672
    v_mfma_f32_16x16x32_bf16 v[56:59], v[148:151], a[16:19], v[56:59]
    ds_read_b64_tr_b16 v[144:145], v9 offset:36864
    buffer_load_dwordx4 a[12:15], v6, s[16:19], s51 offen offset:256 sc1
    v_mfma_f32_16x16x32_bf16 v[60:63], v[148:151], a[20:23], v[60:63]
    ds_read_b64_tr_b16 v[146:147], v9 offset:39936
    v_mfma_f32_16x16x32_bf16 v[64:67], v[152:155], a[16:19], v[64:67]
    ds_read_b64_tr_b16 v[148:149], v10 offset:36864
    v_mfma_f32_16x16x32_bf16 v[68:71], v[152:155], a[20:23], v[68:71]
    ds_read_b64_tr_b16 v[150:151], v10 offset:39936
    ds_read_b64_tr_b16 v[188:189], v15 offset:26624
    ds_read_b64_tr_b16 v[190:191], v15 offset:29696
    v_mfma_f32_16x16x32_bf16 v[72:75], v[156:159], a[16:19], v[72:75]
    ds_read_b64_tr_b16 v[152:153], v7 offset:37888
    v_mfma_f32_16x16x32_bf16 v[76:79], v[156:159], a[20:23], v[76:79]
    ds_read_b64_tr_b16 v[154:155], v7 offset:40960
    v_mfma_f32_16x16x32_bf16 v[80:83], v[160:163], a[16:19], v[80:83]
    ds_read_b64_tr_b16 v[156:157], v8 offset:37888
    v_mfma_f32_16x16x32_bf16 v[84:87], v[160:163], a[20:23], v[84:87]
    ds_read_b64_tr_b16 v[158:159], v8 offset:40960
    ds_read_b128 v[192:195], v17 offset:2048
    v_mfma_f32_16x16x32_bf16 v[88:91], v[164:167], a[16:19], v[88:91]
    ds_read_b64_tr_b16 v[160:161], v9 offset:37888
    v_mfma_f32_16x16x32_bf16 v[92:95], v[164:167], a[20:23], v[92:95]
    ds_read_b64_tr_b16 v[162:163], v9 offset:40960
    v_mfma_f32_16x16x32_bf16 v[96:99], a[16:19], v[168:171], v[96:99]
    ds_read_b64_tr_b16 v[164:165], v10 offset:37888
    v_mfma_f32_16x16x32_bf16 v[100:103], a[20:23], v[168:171], v[100:103]
    ds_read_b64_tr_b16 v[166:167], v10 offset:40960
    v_mfma_f32_16x16x32_bf16 v[104:107], a[16:19], v[172:175], v[104:107]
    ds_read_b64_tr_b16 v[168:169], v7 offset:38912
    v_mfma_f32_16x16x32_bf16 v[108:111], a[20:23], v[172:175], v[108:111]
    ds_read_b64_tr_b16 v[170:171], v7 offset:41984
    v_mfma_f32_16x16x32_bf16 v[112:115], a[16:19], v[176:179], v[112:115]
    ds_read_b64_tr_b16 v[172:173], v8 offset:38912
    v_mfma_f32_16x16x32_bf16 v[116:119], a[20:23], v[176:179], v[116:119]
    ds_read_b64_tr_b16 v[174:175], v8 offset:41984
    v_mfma_f32_16x16x32_bf16 v[120:123], a[16:19], v[180:183], v[120:123]
    ds_read_b64_tr_b16 v[176:177], v9 offset:38912
    v_mfma_f32_16x16x32_bf16 v[124:127], a[20:23], v[180:183], v[124:127]
    ds_read_b64_tr_b16 v[178:179], v9 offset:41984
    s_waitcnt vmcnt(4) lgkmcnt(10)
    v_mfma_f32_16x16x32_bf16 v[128:131], v[184:187], v[192:195], v[128:131]
    v_mfma_f32_16x16x32_bf16 v[132:135], v[192:195], v[188:191], v[132:135]
    v_mfma_f32_16x16x32_bf16 v[32:35], v[136:139], a[24:27], v[32:35]
    ds_read_b64_tr_b16 v[180:181], v10 offset:38912
    s_add_u32 s52, s52, 49152
    s_cmp_eq_u32 s52, 147456
    s_cselect_b32 s52, 0, s52
    v_mfma_f32_16x16x32_bf16 v[36:39], v[136:139], a[28:31], v[36:39]
    ds_read_b64_tr_b16 v[182:183], v10 offset:41984
    s_barrier
    v_add_u32 v7, s52, v11
    v_add_u32 v8, s52, v12
    v_add_u32 v9, s52, v13
    v_add_u32 v10, s52, v14
    v_mfma_f32_16x16x32_bf16 v[40:43], v[140:143], a[24:27], v[40:43]
    ds_read_b64_tr_b16 v[136:137], v7 offset:0
    buffer_load_dwordx4 a[16:19], v6, s[16:19], s51 offen offset:2048 sc1
    v_mfma_f32_16x16x32_bf16 v[44:47], v[140:143], a[28:31], v[44:47]
    ds_read_b64_tr_b16 v[138:139], v7 offset:3072
    v_mfma_f32_16x16x32_bf16 v[48:51], v[144:147], a[24:27], v[48:51]
    ds_read_b64_tr_b16 v[140:141], v8 offset:0
    v_mfma_f32_16x16x32_bf16 v[52:55], v[144:147], a[28:31], v[52:55]
    ds_read_b64_tr_b16 v[142:143], v8 offset:3072
    ds_read_b64_tr_b16 v[184:185], v15 offset:37888
    ds_read_b64_tr_b16 v[186:187], v15 offset:40960
    v_mfma_f32_16x16x32_bf16 v[56:59], v[148:151], a[24:27], v[56:59]
    ds_read_b64_tr_b16 v[144:145], v9 offset:0
    buffer_load_dwordx4 a[20:23], v6, s[16:19], s51 offen offset:2304 sc1
    v_mfma_f32_16x16x32_bf16 v[60:63], v[148:151], a[28:31], v[60:63]
    ds_read_b64_tr_b16 v[146:147], v9 offset:3072
    v_mfma_f32_16x16x32_bf16 v[64:67], v[152:155], a[24:27], v[64:67]
    ds_read_b64_tr_b16 v[148:149], v10 offset:0
    v_mfma_f32_16x16x32_bf16 v[68:71], v[152:155], a[28:31], v[68:71]
    ds_read_b64_tr_b16 v[150:151], v10 offset:3072
    ds_read_b64_tr_b16 v[188:189], v15 offset:38912
    ds_read_b64_tr_b16 v[190:191], v15 offset:41984
    v_mfma_f32_16x16x32_bf16 v[72:75], v[156:159], a[24:27], v[72:75]
    ds_read_b64_tr_b16 v[152:153], v7 offset:1024
    v_mfma_f32_16x16x32_bf16 v[76:79], v[156:159], a[28:31], v[76:79]
    ds_read_b64_tr_b16 v[154:155], v7 offset:4096
    v_mfma_f32_16x16x32_bf16 v[80:83], v[160:163], a[24:27], v[80:83]
    ds_read_b64_tr_b16 v[156:157], v8 offset:1024
    v_mfma_f32_16x16x32_bf16 v[84:87], v[160:163], a[28:31], v[84:87]
    ds_read_b64_tr_b16 v[158:159], v8 offset:4096
    ds_read_b128 v[196:199], v17 offset:3072
    v_mfma_f32_16x16x32_bf16 v[88:91], v[164:167], a[24:27], v[88:91]
    ds_read_b64_tr_b16 v[160:161], v9 offset:1024
    v_mfma_f32_16x16x32_bf16 v[92:95], v[164:167], a[28:31], v[92:95]
    ds_read_b64_tr_b16 v[162:163], v9 offset:4096
    v_mfma_f32_16x16x32_bf16 v[96:99], a[24:27], v[168:171], v[96:99]
    ds_read_b64_tr_b16 v[164:165], v10 offset:1024
    s_xor_b32 s53, s53, 4096
    v_mfma_f32_16x16x32_bf16 v[100:103], a[28:31], v[168:171], v[100:103]
    ds_read_b64_tr_b16 v[166:167], v10 offset:4096
    v_mfma_f32_16x16x32_bf16 v[104:107], a[24:27], v[172:175], v[104:107]
    ds_read_b64_tr_b16 v[168:169], v7 offset:2048
    v_add_u32 v15, s52, v16
    v_mfma_f32_16x16x32_bf16 v[108:111], a[28:31], v[172:175], v[108:111]
    ds_read_b64_tr_b16 v[170:171], v7 offset:5120
    v_add_u32 v17, s53, v18
    v_mfma_f32_16x16x32_bf16 v[112:115], a[24:27], v[176:179], v[112:115]
    ds_read_b64_tr_b16 v[172:173], v8 offset:2048
    s_add_u32 s50, s50, 8192
    v_mfma_f32_16x16x32_bf16 v[116:119], a[28:31], v[176:179], v[116:119]
    ds_read_b64_tr_b16 v[174:175], v8 offset:5120
    s_add_u32 s51, s51, 8192
    v_mfma_f32_16x16x32_bf16 v[120:123], a[24:27], v[180:183], v[120:123]
    ds_read_b64_tr_b16 v[176:177], v9 offset:2048
    s_sub_u32 s54, s54, 1
    v_mfma_f32_16x16x32_bf16 v[124:127], a[28:31], v[180:183], v[124:127]
    ds_read_b64_tr_b16 v[178:179], v9 offset:5120
    s_cmp_lg_u32 s54, 0
    s_cbranch_scc1 c_qkva_loop
c_qkva_epi:
    s_waitcnt lgkmcnt(0)
    v_mfma_f32_16x16x32_bf16 v[128:131], v[184:187], v[196:199], v[128:131]
    v_mfma_f32_16x16x32_bf16 v[132:135], v[196:199], v[188:191], v[132:135]
    v_and_b32 v7, 0x30, v1
    v_add_u32 v7, 155648, v7
    v_lshlrev_b32 v8, 2, v4
    v_add_u32 v8, 155648, v8
    v_lshl_add_u32 v9, v2, 7, v8
    v_lshl_add_u32 v10, v2, 7, v7
    ds_read_b32 v20, v9 offset:1536
    ds_read_b32 v24, v9 offset:2560
    ds_read_b32 v22, v9 offset:1600
    ds_read_b32 v26, v9 offset:2624
    ds_read_b128 v[152:155], v7 offset:256
    ds_read_b128 v[156:159], v7 offset:320
    ds_read_b128 v[160:163], v7 offset:384
    ds_read_b128 v[164:167], v7 offset:448
    ds_read_b128 v[136:139], v7 offset:0
    ds_read_b128 v[140:143], v7 offset:64
    ds_read_b128 v[144:147], v7 offset:128
    ds_read_b128 v[148:151], v7 offset:192
    s_waitcnt lgkmcnt(8)
    ds_read_b128 v[168:171], v10 offset:1536
    ds_read_b128 v[176:179], v10 offset:2560
    v_mul_f32 v28, 0x3e8293ee, v24
    ds_read_b128 v[172:175], v10 offset:1600
    ds_read_b128 v[180:183], v10 offset:2624
    v_mul_f32 v30, 0x3e8293ee, v26
    ds_read_b32 v200, v8 offset:512
    ds_read_b32 v202, v8 offset:576
    ds_read_b32 v204, v8 offset:640
    ds_read_b32 v206, v8 offset:704
    v_lshl_add_u32 v11, v2, 12, v5
    v_add_u32 v11, 131072, v11
    s_waitcnt lgkmcnt(14)
    v_pk_fma_f32 v[64:65], v[20:21], v[152:153], v[64:65] op_sel_hi:[0,1,1] neg_lo:[1,0,0] neg_hi:[1,0,0]
    v_pk_fma_f32 v[66:67], v[20:21], v[154:155], v[66:67] op_sel_hi:[0,1,1] neg_lo:[1,0,0] neg_hi:[1,0,0]
    v_pk_mul_f32 v[64:65], v[24:25], v[64:65] op_sel_hi:[0,1]
    v_pk_mul_f32 v[66:67], v[24:25], v[66:67] op_sel_hi:[0,1]
    v_pk_fma_f32 v[72:73], v[20:21], v[156:157], v[72:73] op_sel_hi:[0,1,1] neg_lo:[1,0,0] neg_hi:[1,0,0]
    v_pk_fma_f32 v[74:75], v[20:21], v[158:159], v[74:75] op_sel_hi:[0,1,1] neg_lo:[1,0,0] neg_hi:[1,0,0]
    v_pk_mul_f32 v[72:73], v[24:25], v[72:73] op_sel_hi:[0,1]
    v_pk_mul_f32 v[74:75], v[24:25], v[74:75] op_sel_hi:[0,1]
    v_pk_fma_f32 v[68:69], v[22:23], v[152:153], v[68:69] op_sel_hi:[0,1,1] neg_lo:[1,0,0] neg_hi:[1,0,0]
    v_pk_fma_f32 v[70:71], v[22:23], v[154:155], v[70:71] op_sel_hi:[0,1,1] neg_lo:[1,0,0] neg_hi:[1,0,0]
    v_pk_mul_f32 v[68:69], v[26:27], v[68:69] op_sel_hi:[0,1]
    v_pk_mul_f32 v[70:71], v[26:27], v[70:71] op_sel_hi:[0,1]
    v_pk_fma_f32 v[76:77], v[22:23], v[156:157], v[76:77] op_sel_hi:[0,1,1] neg_lo:[1,0,0] neg_hi:[1,0,0]
    v_pk_fma_f32 v[78:79], v[22:23], v[158:159], v[78:79] op_sel_hi:[0,1,1] neg_lo:[1,0,0] neg_hi:[1,0,0]
    v_pk_mul_f32 v[76:77], v[26:27], v[76:77] op_sel_hi:[0,1]
    v_pk_mul_f32 v[78:79], v[26:27], v[78:79] op_sel_hi:[0,1]
    v_cvt_pk_bf16_f32 v64, v64, v65
    v_cvt_pk_bf16_f32 v65, v66, v67
    v_cvt_pk_bf16_f32 v66, v72, v73
    v_cvt_pk_bf16_f32 v67, v74, v75
    v_cvt_pk_bf16_f32 v68, v68, v69
    v_cvt_pk_bf16_f32 v69, v70, v71
    v_cvt_pk_bf16_f32 v70, v76, v77
    v_cvt_pk_bf16_f32 v71, v78, v79
    ds_write_b128 v11, v[68:71] offset:4096
    s_waitcnt lgkmcnt(13)
    v_pk_fma_f32 v[80:81], v[20:21], v[160:161], v[80:81] op_sel_hi:[0,1,1] neg_lo:[1,0,0] neg_hi:[1,0,0]
    v_pk_fma_f32 v[82:83], v[20:21], v[162:163], v[82:83] op_sel_hi:[0,1,1] neg_lo:[1,0,0] neg_hi:[1,0,0]
    v_pk_mul_f32 v[80:81], v[24:25], v[80:81] op_sel_hi:[0,1]
    v_pk_mul_f32 v[82:83], v[24:25], v[82:83] op_sel_hi:[0,1]
    v_pk_fma_f32 v[88:89], v[20:21], v[164:165], v[88:89] op_sel_hi:[0,1,1] neg_lo:[1,0,0] neg_hi:[1,0,0]
    v_pk_fma_f32 v[90:91], v[20:21], v[166:167], v[90:91] op_sel_hi:[0,1,1] neg_lo:[1,0,0] neg_hi:[1,0,0]
    v_pk_mul_f32 v[88:89], v[24:25], v[88:89] op_sel_hi:[0,1]
    v_pk_mul_f32 v[90:91], v[24:25], v[90:91] op_sel_hi:[0,1]
    v_pk_fma_f32 v[84:85], v[22:23], v[160:161], v[84:85] op_sel_hi:[0,1,1] neg_lo:[1,0,0] neg_hi:[1,0,0]
    v_pk_fma_f32 v[86:87], v[22:23], v[162:163], v[86:87] op_sel_hi:[0,1,1] neg_lo:[1,0,0] neg_hi:[1,0,0]
    v_pk_mul_f32 v[84:85], v[26:27], v[84:85] op_sel_hi:[0,1]
    v_pk_mul_f32 v[86:87], v[26:27], v[86:87] op_sel_hi:[0,1]
    v_pk_fma_f32 v[92:93], v[22:23], v[164:165], v[92:93] op_sel_hi:[0,1,1] neg_lo:[1,0,0] neg_hi:[1,0,0]
    v_pk_fma_f32 v[94:95], v[22:23], v[166:167], v[94:95] op_sel_hi:[0,1,1] neg_lo:[1,0,0] neg_hi:[1,0,0]
    v_pk_mul_f32 v[92:93], v[26:27], v[92:93] op_sel_hi:[0,1]
    v_pk_mul_f32 v[94:95], v[26:27], v[94:95] op_sel_hi:[0,1]
    v_cvt_pk_bf16_f32 v80, v80, v81
    v_cvt_pk_bf16_f32 v81, v82, v83
    v_cvt_pk_bf16_f32 v82, v88, v89
    v_cvt_pk_bf16_f32 v83, v90, v91
    v_cvt_pk_bf16_f32 v84, v84, v85
    v_cvt_pk_bf16_f32 v85, v86, v87
    v_cvt_pk_bf16_f32 v86, v92, v93
    v_cvt_pk_bf16_f32 v87, v94, v95
    ds_write_b128 v11, v[84:87] offset:5120
    v_lshl_add_u32 v12, v2, 6, v7
    v_lshl_add_u32 v13, v2, 6, v8
    ds_read_b128 v[208:211], v12 offset:256
    ds_read_b128 v[212:215], v7 offset:1472
    ds_read_b128 v[216:219], v7 offset:2496
    ds_read_b32 v220, v8 offset:1472
    ds_read_b32 v222, v8 offset:2496
    ds_read_b32 v184, v13 offset:512
    s_waitcnt lgkmcnt(8)
    v_pk_fma_f32 v[96:97], v[168:169], v[200:201], v[96:97] op_sel_hi:[1,0,1] neg_lo:[1,0,0] neg_hi:[1,0,0]
    v_pk_fma_f32 v[98:99], v[170:171], v[200:201], v[98:99] op_sel_hi:[1,0,1] neg_lo:[1,0,0] neg_hi:[1,0,0]
    v_pk_mul_f32 v[96:97], v[176:177], v[96:97]
    v_pk_mul_f32 v[98:99], v[178:179], v[98:99]
    v_pk_fma_f32 v[100:101], v[172:173], v[200:201], v[100:101] op_sel_hi:[1,0,1] neg_lo:[1,0,0] neg_hi:[1,0,0]
    v_pk_fma_f32 v[102:103], v[174:175], v[200:201], v[102:103] op_sel_hi:[1,0,1] neg_lo:[1,0,0] neg_hi:[1,0,0]
    v_pk_mul_f32 v[100:101], v[180:181], v[100:101]
    v_pk_mul_f32 v[102:103], v[182:183], v[102:103]
    v_cvt_pk_bf16_f32 v99, v98, v99
    v_cvt_pk_bf16_f32 v98, v96, v97
    v_cvt_pk_bf16_f32 v100, v100, v101
    v_cvt_pk_bf16_f32 v101, v102, v103
    ds_write_b64 v11, v[100:101] offset:6144
    v_pk_fma_f32 v[104:105], v[168:169], v[202:203], v[104:105] op_sel_hi:[1,0,1] neg_lo:[1,0,0] neg_hi:[1,0,0]
    v_pk_fma_f32 v[106:107], v[170:171], v[202:203], v[106:107] op_sel_hi:[1,0,1] neg_lo:[1,0,0] neg_hi:[1,0,0]
    v_pk_mul_f32 v[104:105], v[176:177], v[104:105]
    v_pk_mul_f32 v[106:107], v[178:179], v[106:107]
    v_pk_fma_f32 v[108:109], v[172:173], v[202:203], v[108:109] op_sel_hi:[1,0,1] neg_lo:[1,0,0] neg_hi:[1,0,0]
    v_pk_fma_f32 v[110:111], v[174:175], v[202:203], v[110:111] op_sel_hi:[1,0,1] neg_lo:[1,0,0] neg_hi:[1,0,0]
    v_pk_mul_f32 v[108:109], v[180:181], v[108:109]
    v_pk_mul_f32 v[110:111], v[182:183], v[110:111]
    v_cvt_pk_bf16_f32 v107, v106, v107
    v_cvt_pk_bf16_f32 v106, v104, v105
    v_cvt_pk_bf16_f32 v108, v108, v109
    v_cvt_pk_bf16_f32 v109, v110, v111
    ds_write_b64 v11, v[108:109] offset:6152
    v_pk_fma_f32 v[112:113], v[168:169], v[204:205], v[112:113] op_sel_hi:[1,0,1] neg_lo:[1,0,0] neg_hi:[1,0,0]
    v_pk_fma_f32 v[114:115], v[170:171], v[204:205], v[114:115] op_sel_hi:[1,0,1] neg_lo:[1,0,0] neg_hi:[1,0,0]
    v_pk_mul_f32 v[112:113], v[176:177], v[112:113]
    v_pk_mul_f32 v[114:115], v[178:179], v[114:115]
    v_pk_fma_f32 v[116:117], v[172:173], v[204:205], v[116:117] op_sel_hi:[1,0,1] neg_lo:[1,0,0] neg_hi:[1,0,0]
    v_pk_fma_f32 v[118:119], v[174:175], v[204:205], v[118:119] op_sel_hi:[1,0,1] neg_lo:[1,0,0] neg_hi:[1,0,0]
    v_pk_mul_f32 v[116:117], v[180:181], v[116:117]
    v_pk_mul_f32 v[118:119], v[182:183], v[118:119]
    v_cvt_pk_bf16_f32 v115, v114, v115
    v_cvt_pk_bf16_f32 v114, v112, v113
    v_cvt_pk_bf16_f32 v116, v116, v117
    v_cvt_pk_bf16_f32 v117, v118, v119
    ds_write_b64 v11, v[116:117] offset:7168
    v_pk_fma_f32 v[120:121], v[168:169], v[206:207], v[120:121] op_sel_hi:[1,0,1] neg_lo:[1,0,0] neg_hi:[1,0,0]
    v_pk_fma_f32 v[122:123], v[170:171], v[206:207], v[122:123] op_sel_hi:[1,0,1] neg_lo:[1,0,0] neg_hi:[1,0,0]
    v_pk_mul_f32 v[120:121], v[176:177], v[120:121]
    v_pk_mul_f32 v[122:123], v[178:179], v[122:123]
    v_pk_fma_f32 v[124:125], v[172:173], v[206:207], v[124:125] op_sel_hi:[1,0,1] neg_lo:[1,0,0] neg_hi:[1,0,0]
    v_pk_fma_f32 v[126:127], v[174:175], v[206:207], v[126:127] op_sel_hi:[1,0,1] neg_lo:[1,0,0] neg_hi:[1,0,0]
    v_pk_mul_f32 v[124:125], v[180:181], v[124:125]
    v_pk_mul_f32 v[126:127], v[182:183], v[126:127]
    v_cvt_pk_bf16_f32 v123, v122, v123
    v_cvt_pk_bf16_f32 v122, v120, v121
    v_cvt_pk_bf16_f32 v124, v124, v125
    v_cvt_pk_bf16_f32 v125, v126, v127
    ds_write_b64 v11, v[124:125] offset:7176
    s_waitcnt lgkmcnt(4)
    v_pk_fma_f32 v[128:129], v[220:221], v[208:209], v[128:129] op_sel_hi:[0,1,1] neg_lo:[1,0,0] neg_hi:[1,0,0]
    v_pk_fma_f32 v[130:131], v[220:221], v[210:211], v[130:131] op_sel_hi:[0,1,1] neg_lo:[1,0,0] neg_hi:[1,0,0]
    v_pk_mul_f32 v[128:129], v[222:223], v[128:129] op_sel_hi:[0,1]
    v_pk_mul_f32 v[130:131], v[222:223], v[130:131] op_sel_hi:[0,1]
    v_pk_fma_f32 v[132:133], v[212:213], v[184:185], v[132:133] op_sel_hi:[1,0,1] neg_lo:[1,0,0] neg_hi:[1,0,0]
    v_pk_fma_f32 v[134:135], v[214:215], v[184:185], v[134:135] op_sel_hi:[1,0,1] neg_lo:[1,0,0] neg_hi:[1,0,0]
    v_pk_mul_f32 v[132:133], v[216:217], v[132:133]
    v_pk_mul_f32 v[134:135], v[218:219], v[134:135]
    v_cvt_pk_bf16_f32 v128, v128, v129
    v_cvt_pk_bf16_f32 v129, v130, v131
    v_cvt_pk_bf16_f32 v130, v132, v133
    v_cvt_pk_bf16_f32 v131, v134, v135
    s_lshr_b32 s3, s8, 1
    s_lshl_b32 s3, s3, 10
    s_and_b32 s55, s8, 1
    s_lshl_b32 s55, s55, 3
    s_add_u32 s3, s3, s55
    s_add_u32 s3, s3, 131072
    v_add_u32 v12, s3, v5
    ds_write_b64 v12, v[128:129]
    ds_write_b64 v12, v[130:131] offset:2048
    v_pk_fma_f32 v[32:33], v[20:21], v[136:137], v[32:33] op_sel_hi:[0,1,1] neg_lo:[1,0,0] neg_hi:[1,0,0]
    v_pk_fma_f32 v[34:35], v[20:21], v[138:139], v[34:35] op_sel_hi:[0,1,1] neg_lo:[1,0,0] neg_hi:[1,0,0]
    v_pk_mul_f32 v[32:33], v[28:29], v[32:33] op_sel_hi:[0,1]
    v_pk_mul_f32 v[34:35], v[28:29], v[34:35] op_sel_hi:[0,1]
    v_pk_fma_f32 v[40:41], v[20:21], v[140:141], v[40:41] op_sel_hi:[0,1,1] neg_lo:[1,0,0] neg_hi:[1,0,0]
    v_pk_fma_f32 v[42:43], v[20:21], v[142:143], v[42:43] op_sel_hi:[0,1,1] neg_lo:[1,0,0] neg_hi:[1,0,0]
    v_pk_mul_f32 v[40:41], v[28:29], v[40:41] op_sel_hi:[0,1]
    v_pk_mul_f32 v[42:43], v[28:29], v[42:43] op_sel_hi:[0,1]
    v_pk_fma_f32 v[36:37], v[22:23], v[136:137], v[36:37] op_sel_hi:[0,1,1] neg_lo:[1,0,0] neg_hi:[1,0,0]
    v_pk_fma_f32 v[38:39], v[22:23], v[138:139], v[38:39] op_sel_hi:[0,1,1] neg_lo:[1,0,0] neg_hi:[1,0,0]
    v_pk_mul_f32 v[36:37], v[30:31], v[36:37] op_sel_hi:[0,1]
    v_pk_mul_f32 v[38:39], v[30:31], v[38:39] op_sel_hi:[0,1]
    v_pk_fma_f32 v[44:45], v[22:23], v[140:141], v[44:45] op_sel_hi:[0,1,1] neg_lo:[1,0,0] neg_hi:[1,0,0]
    v_pk_fma_f32 v[46:47], v[22:23], v[142:143], v[46:47] op_sel_hi:[0,1,1] neg_lo:[1,0,0] neg_hi:[1,0,0]
    v_pk_mul_f32 v[44:45], v[30:31], v[44:45] op_sel_hi:[0,1]
    v_pk_mul_f32 v[46:47], v[30:31], v[46:47] op_sel_hi:[0,1]
    v_cvt_pk_bf16_f32 v32, v32, v33
    v_cvt_pk_bf16_f32 v33, v34, v35
    v_cvt_pk_bf16_f32 v34, v40, v41
    v_cvt_pk_bf16_f32 v35, v42, v43
    v_cvt_pk_bf16_f32 v36, v36, v37
    v_cvt_pk_bf16_f32 v37, v38, v39
    v_cvt_pk_bf16_f32 v38, v44, v45
    v_cvt_pk_bf16_f32 v39, v46, v47
    v_pk_fma_f32 v[48:49], v[20:21], v[144:145], v[48:49] op_sel_hi:[0,1,1] neg_lo:[1,0,0] neg_hi:[1,0,0]
    v_pk_fma_f32 v[50:51], v[20:21], v[146:147], v[50:51] op_sel_hi:[0,1,1] neg_lo:[1,0,0] neg_hi:[1,0,0]
    v_pk_mul_f32 v[48:49], v[28:29], v[48:49] op_sel_hi:[0,1]
    v_pk_mul_f32 v[50:51], v[28:29], v[50:51] op_sel_hi:[0,1]
    v_pk_fma_f32 v[56:57], v[20:21], v[148:149], v[56:57] op_sel_hi:[0,1,1] neg_lo:[1,0,0] neg_hi:[1,0,0]
    v_pk_fma_f32 v[58:59], v[20:21], v[150:151], v[58:59] op_sel_hi:[0,1,1] neg_lo:[1,0,0] neg_hi:[1,0,0]
    v_pk_mul_f32 v[56:57], v[28:29], v[56:57] op_sel_hi:[0,1]
    v_pk_mul_f32 v[58:59], v[28:29], v[58:59] op_sel_hi:[0,1]
    v_pk_fma_f32 v[52:53], v[22:23], v[144:145], v[52:53] op_sel_hi:[0,1,1] neg_lo:[1,0,0] neg_hi:[1,0,0]
    v_pk_fma_f32 v[54:55], v[22:23], v[146:147], v[54:55] op_sel_hi:[0,1,1] neg_lo:[1,0,0] neg_hi:[1,0,0]
    v_pk_mul_f32 v[52:53], v[30:31], v[52:53] op_sel_hi:[0,1]
    v_pk_mul_f32 v[54:55], v[30:31], v[54:55] op_sel_hi:[0,1]
    v_pk_fma_f32 v[60:61], v[22:23], v[148:149], v[60:61] op_sel_hi:[0,1,1] neg_lo:[1,0,0] neg_hi:[1,0,0]
    v_pk_fma_f32 v[62:63], v[22:23], v[150:151], v[62:63] op_sel_hi:[0,1,1] neg_lo:[1,0,0] neg_hi:[1,0,0]
    v_pk_mul_f32 v[60:61], v[30:31], v[60:61] op_sel_hi:[0,1]
    v_pk_mul_f32 v[62:63], v[30:31], v[62:63] op_sel_hi:[0,1]
    v_cvt_pk_bf16_f32 v48, v48, v49
    v_cvt_pk_bf16_f32 v49, v50, v51
    v_cvt_pk_bf16_f32 v50, v56, v57
    v_cvt_pk_bf16_f32 v51, v58, v59
    v_cvt_pk_bf16_f32 v52, v52, v53
    v_cvt_pk_bf16_f32 v53, v54, v55
    v_cvt_pk_bf16_f32 v54, v60, v61
    v_cvt_pk_bf16_f32 v55, v62, v63
    v_lshrrev_b32 v13, 4, v1
    v_lshlrev_b32 v13, 2, v13
    v_sub_u32 v13, v4, v13
    v_mov_b32 v14, 0xf149f2ca
    v_add_u32 v9, 0x0, v13
    v_and_b32 v9, 0xfffffff1, v9
    v_cmp_eq_u32 vcc, 0, v9
    s_nop 1
    v_cndmask_b32 v216, v14, 0, vcc
    v_add_u32 v9, 0xffffffff, v13
    v_and_b32 v9, 0xfffffff1, v9
    v_cmp_eq_u32 vcc, 0, v9
    s_nop 1
    v_cndmask_b32 v217, v14, 0, vcc
    v_add_u32 v9, 0xfffffffe, v13
    v_and_b32 v9, 0xfffffff1, v9
    v_cmp_eq_u32 vcc, 0, v9
    s_nop 1
    v_cndmask_b32 v218, v14, 0, vcc
    v_add_u32 v9, 0xfffffffd, v13
    v_and_b32 v9, 0xfffffff1, v9
    v_cmp_eq_u32 vcc, 0, v9
    s_nop 1
    v_cndmask_b32 v219, v14, 0, vcc
    v_add_u32 v9, 0x10, v13
    v_and_b32 v9, 0xfffffff1, v9
    v_cmp_eq_u32 vcc, 0, v9
    s_nop 1
    v_cndmask_b32 v220, v14, 0, vcc
    v_add_u32 v9, 0xf, v13
    v_and_b32 v9, 0xfffffff1, v9
    v_cmp_eq_u32 vcc, 0, v9
    s_nop 1
    v_cndmask_b32 v221, v14, 0, vcc
    v_add_u32 v9, 0xe, v13
    v_and_b32 v9, 0xfffffff1, v9
    v_cmp_eq_u32 vcc, 0, v9
    s_nop 1
    v_cndmask_b32 v222, v14, 0, vcc
    v_add_u32 v9, 0xd, v13
    v_and_b32 v9, 0xfffffff1, v9
    v_cmp_eq_u32 vcc, 0, v9
    s_nop 1
    v_cndmask_b32 v223, v14, 0, vcc
    v_mfma_f32_16x16x32_bf16 v[140:143], v[64:67], v[32:35], v[216:219]
    v_mfma_f32_16x16x32_bf16 v[148:151], v[68:71], v[36:39], v[216:219]
    v_mfma_f32_16x16x32_bf16 v[144:147], v[64:67], v[36:39], v[220:223]
    v_mfma_f32_16x16x32_bf16 v[156:159], v[80:83], v[48:51], v[216:219]
    v_mfma_f32_16x16x32_bf16 v[164:167], v[84:87], v[52:55], v[216:219]
    v_mfma_f32_16x16x32_bf16 v[160:163], v[80:83], v[52:55], v[220:223]
    s_waitcnt lgkmcnt(0)
    s_barrier
    ds_read_b128 v[168:171], v11 offset:0
    ds_read_b128 v[172:175], v11 offset:1024
    ds_read_b64 v[96:97], v11 offset:2048
    ds_read_b64 v[104:105], v11 offset:2056
    ds_read_b64 v[112:113], v11 offset:3072
    ds_read_b64 v[120:121], v11 offset:3080
    s_cmp_lg_u32 s48, 0
    s_cbranch_scc1 c_qkva_hasprev
    v_mov_b32 v220, 0xf149f2ca
    v_mov_b32 v221, 0xf149f2ca
    v_mov_b32 v222, 0xf149f2ca
    v_mov_b32 v223, 0xf149f2ca
c_qkva_hasprev:
    s_lshl_b32 s3, s48, 16
    s_lshl_b32 s55, s7, 12
    s_add_u32 s3, s3, s55
    s_lshl_b32 s55, s9, 22
    s_add_u32 s3, s3, s55
    s_add_u32 s3, s3, 16777216
    s_waitcnt lgkmcnt(4)
    v_mfma_f32_16x16x32_bf16 v[136:139], v[168:171], v[32:35], v[220:223]
    v_mfma_f32_16x16x32_bf16 v[152:155], v[172:175], v[48:51], v[220:223]
    v_max3_f32 v20, v144, v145, v146
    v_max3_f32 v20, v20, v147, v148
    v_max3_f32 v20, v20, v149, v150
    v_max_f32 v20, v20, v151
    v_max3_f32 v22, v160, v161, v162
    v_max3_f32 v22, v22, v163, v164
    v_max3_f32 v22, v22, v165, v166
    v_max_f32 v22, v22, v167
    v_max3_f32 v24, v136, v137, v138
    v_max3_f32 v24, v24, v139, v140
    v_max3_f32 v24, v24, v141, v142
    v_max_f32 v24, v24, v143
    v_max3_f32 v26, v152, v153, v154
    v_max3_f32 v26, v26, v155, v156
    v_max3_f32 v26, v26, v157, v158
    v_max_f32 v26, v26, v159
    v_mov_b32 v21, v20
    v_mov_b32 v23, v22
    v_mov_b32 v25, v24
    v_mov_b32 v27, v26
    v_permlane32_swap_b32 v20, v21
    v_permlane32_swap_b32 v22, v23
    v_permlane32_swap_b32 v24, v25
    v_permlane32_swap_b32 v26, v27
    v_max_f32 v20, v20, v21
    v_max_f32 v22, v22, v23
    v_max_f32 v24, v24, v25
    v_max_f32 v26, v26, v27
    v_mov_b32 v21, v20
    v_mov_b32 v23, v22
    v_mov_b32 v25, v24
    v_mov_b32 v27, v26
    v_permlane16_swap_b32 v20, v21
    v_permlane16_swap_b32 v22, v23
    v_permlane16_swap_b32 v24, v25
    v_permlane16_swap_b32 v26, v27
    v_max_f32 v20, v20, v21
    v_max_f32 v22, v22, v23
    v_max_f32 v24, v24, v25
    v_max_f32 v26, v26, v27
    s_waitcnt lgkmcnt(0)
    v_pk_add_f32 v[144:145], v[144:145], v[20:21] op_sel_hi:[1,0] neg_lo:[0,1] neg_hi:[0,1]
    v_pk_add_f32 v[146:147], v[146:147], v[20:21] op_sel_hi:[1,0] neg_lo:[0,1] neg_hi:[0,1]
    v_pk_add_f32 v[148:149], v[148:149], v[20:21] op_sel_hi:[1,0] neg_lo:[0,1] neg_hi:[0,1]
    v_pk_add_f32 v[150:151], v[150:151], v[20:21] op_sel_hi:[1,0] neg_lo:[0,1] neg_hi:[0,1]
    v_exp_f32 v144, v144
    v_exp_f32 v145, v145
    v_exp_f32 v146, v146
    v_exp_f32 v147, v147
    v_exp_f32 v148, v148
    v_exp_f32 v149, v149
    v_exp_f32 v150, v150
    v_exp_f32 v151, v151
    v_cvt_pk_bf16_f32 v168, v144, v145
    v_cvt_pk_bf16_f32 v169, v146, v147
    v_cvt_pk_bf16_f32 v170, v148, v149
    v_cvt_pk_bf16_f32 v171, v150, v151
    s_nop 1
    v_mfma_f32_16x16x32_bf16 v[56:59], v[98:101], v[168:171], 0
    v_mfma_f32_16x16x32_bf16 v[60:63], v[106:109], v[168:171], 0
    v_pk_add_f32 v[200:201], v[144:145], v[146:147]
    v_pk_add_f32 v[200:201], v[200:201], v[148:149]
    v_pk_add_f32 v[200:201], v[200:201], v[150:151]
    v_add_f32 v200, v200, v201
    v_pk_add_f32 v[160:161], v[160:161], v[22:23] op_sel_hi:[1,0] neg_lo:[0,1] neg_hi:[0,1]
    v_pk_add_f32 v[162:163], v[162:163], v[22:23] op_sel_hi:[1,0] neg_lo:[0,1] neg_hi:[0,1]
    v_pk_add_f32 v[164:165], v[164:165], v[22:23] op_sel_hi:[1,0] neg_lo:[0,1] neg_hi:[0,1]
    v_pk_add_f32 v[166:167], v[166:167], v[22:23] op_sel_hi:[1,0] neg_lo:[0,1] neg_hi:[0,1]
    v_exp_f32 v160, v160
    v_exp_f32 v161, v161
    v_exp_f32 v162, v162
    v_exp_f32 v163, v163
    v_exp_f32 v164, v164
    v_exp_f32 v165, v165
    v_exp_f32 v166, v166
    v_exp_f32 v167, v167
    v_cvt_pk_bf16_f32 v172, v160, v161
    v_cvt_pk_bf16_f32 v173, v162, v163
    v_cvt_pk_bf16_f32 v174, v164, v165
    v_cvt_pk_bf16_f32 v175, v166, v167
    s_nop 1
    v_mfma_f32_16x16x32_bf16 v[88:91], v[114:117], v[172:175], 0
    v_mfma_f32_16x16x32_bf16 v[92:95], v[122:125], v[172:175], 0
    v_pk_add_f32 v[202:203], v[160:161], v[162:163]
    v_pk_add_f32 v[202:203], v[202:203], v[164:165]
    v_pk_add_f32 v[202:203], v[202:203], v[166:167]
    v_add_f32 v202, v202, v203
    v_pk_add_f32 v[136:137], v[136:137], v[24:25] op_sel_hi:[1,0] neg_lo:[0,1] neg_hi:[0,1]
    v_pk_add_f32 v[138:139], v[138:139], v[24:25] op_sel_hi:[1,0] neg_lo:[0,1] neg_hi:[0,1]
    v_pk_add_f32 v[140:141], v[140:141], v[24:25] op_sel_hi:[1,0] neg_lo:[0,1] neg_hi:[0,1]
    v_pk_add_f32 v[142:143], v[142:143], v[24:25] op_sel_hi:[1,0] neg_lo:[0,1] neg_hi:[0,1]
    v_exp_f32 v136, v136
    v_exp_f32 v137, v137
    v_exp_f32 v138, v138
    v_exp_f32 v139, v139
    v_exp_f32 v140, v140
    v_exp_f32 v141, v141
    v_exp_f32 v142, v142
    v_exp_f32 v143, v143
    v_cvt_pk_bf16_f32 v176, v136, v137
    v_cvt_pk_bf16_f32 v177, v138, v139
    v_cvt_pk_bf16_f32 v178, v140, v141
    v_cvt_pk_bf16_f32 v179, v142, v143
    s_nop 1
    v_mfma_f32_16x16x32_bf16 v[40:43], v[96:99], v[176:179], 0
    v_mfma_f32_16x16x32_bf16 v[44:47], v[104:107], v[176:179], 0
    v_pk_add_f32 v[204:205], v[136:137], v[138:139]
    v_pk_add_f32 v[204:205], v[204:205], v[140:141]
    v_pk_add_f32 v[204:205], v[204:205], v[142:143]
    v_add_f32 v204, v204, v205
    v_pk_add_f32 v[152:153], v[152:153], v[26:27] op_sel_hi:[1,0] neg_lo:[0,1] neg_hi:[0,1]
    v_pk_add_f32 v[154:155], v[154:155], v[26:27] op_sel_hi:[1,0] neg_lo:[0,1] neg_hi:[0,1]
    v_pk_add_f32 v[156:157], v[156:157], v[26:27] op_sel_hi:[1,0] neg_lo:[0,1] neg_hi:[0,1]
    v_pk_add_f32 v[158:159], v[158:159], v[26:27] op_sel_hi:[1,0] neg_lo:[0,1] neg_hi:[0,1]
    v_exp_f32 v152, v152
    v_exp_f32 v153, v153
    v_exp_f32 v154, v154
    v_exp_f32 v155, v155
    v_exp_f32 v156, v156
    v_exp_f32 v157, v157
    v_exp_f32 v158, v158
    v_exp_f32 v159, v159
    v_cvt_pk_bf16_f32 v180, v152, v153
    v_cvt_pk_bf16_f32 v181, v154, v155
    v_cvt_pk_bf16_f32 v182, v156, v157
    v_cvt_pk_bf16_f32 v183, v158, v159
    s_nop 1
    v_mfma_f32_16x16x32_bf16 v[72:75], v[112:115], v[180:183], 0
    v_mfma_f32_16x16x32_bf16 v[76:79], v[120:123], v[180:183], 0
    v_pk_add_f32 v[206:207], v[152:153], v[154:155]
    v_pk_add_f32 v[206:207], v[206:207], v[156:157]
    v_pk_add_f32 v[206:207], v[206:207], v[158:159]
    v_add_f32 v206, v206, v207
    v_mov_b32 v201, v200
    v_mov_b32 v203, v202
    v_mov_b32 v205, v204
    v_mov_b32 v207, v206
    v_permlane32_swap_b32 v200, v201
    v_permlane32_swap_b32 v202, v203
    v_permlane32_swap_b32 v204, v205
    v_permlane32_swap_b32 v206, v207
    v_add_f32 v200, v200, v201
    v_add_f32 v202, v202, v203
    v_add_f32 v204, v204, v205
    v_add_f32 v206, v206, v207
    v_mov_b32 v201, v200
    v_mov_b32 v203, v202
    v_mov_b32 v205, v204
    v_mov_b32 v207, v206
    v_permlane16_swap_b32 v200, v201
    v_permlane16_swap_b32 v202, v203
    v_permlane16_swap_b32 v204, v205
    v_permlane16_swap_b32 v206, v207
    v_add_f32 v200, v200, v201
    v_add_f32 v202, v202, v203
    v_add_f32 v204, v204, v205
    v_add_f32 v206, v206, v207
    v_rcp_f32 v200, v200
    v_rcp_f32 v202, v202
    v_rcp_f32 v204, v204
    v_rcp_f32 v206, v206
    v_pk_mul_f32 v[56:57], v[200:201], v[56:57] op_sel_hi:[0,1]
    v_pk_mul_f32 v[58:59], v[200:201], v[58:59] op_sel_hi:[0,1]
    v_pk_mul_f32 v[60:61], v[200:201], v[60:61] op_sel_hi:[0,1]
    v_pk_mul_f32 v[62:63], v[200:201], v[62:63] op_sel_hi:[0,1]
    v_cvt_pk_bf16_f32 v56, v56, v57
    v_cvt_pk_bf16_f32 v57, v58, v59
    v_cvt_pk_bf16_f32 v58, v60, v61
    v_cvt_pk_bf16_f32 v59, v62, v63
    s_nop 0
    v_permlane32_swap_b32 v56, v58
    v_permlane32_swap_b32 v57, v59
    buffer_store_dwordx4 v[56:59], v6, s[12:15], s3 offen offset:256 sc1
    v_pk_mul_f32 v[88:89], v[202:203], v[88:89] op_sel_hi:[0,1]
    v_pk_mul_f32 v[90:91], v[202:203], v[90:91] op_sel_hi:[0,1]
    v_pk_mul_f32 v[92:93], v[202:203], v[92:93] op_sel_hi:[0,1]
    v_pk_mul_f32 v[94:95], v[202:203], v[94:95] op_sel_hi:[0,1]
    v_cvt_pk_bf16_f32 v88, v88, v89
    v_cvt_pk_bf16_f32 v89, v90, v91
    v_cvt_pk_bf16_f32 v90, v92, v93
    v_cvt_pk_bf16_f32 v91, v94, v95
    s_nop 0
    v_permlane32_swap_b32 v88, v90
    v_permlane32_swap_b32 v89, v91
    buffer_store_dwordx4 v[88:91], v6, s[12:15], s3 offen offset:2304 sc1
    v_pk_mul_f32 v[40:41], v[204:205], v[40:41] op_sel_hi:[0,1]
    v_pk_mul_f32 v[42:43], v[204:205], v[42:43] op_sel_hi:[0,1]
    v_pk_mul_f32 v[44:45], v[204:205], v[44:45] op_sel_hi:[0,1]
    v_pk_mul_f32 v[46:47], v[204:205], v[46:47] op_sel_hi:[0,1]
    v_cvt_pk_bf16_f32 v40, v40, v41
    v_cvt_pk_bf16_f32 v41, v42, v43
    v_cvt_pk_bf16_f32 v42, v44, v45
    v_cvt_pk_bf16_f32 v43, v46, v47
    s_nop 0
    v_permlane32_swap_b32 v40, v42
    v_permlane32_swap_b32 v41, v43
    buffer_store_dwordx4 v[40:43], v6, s[12:15], s3 offen offset:0 sc1
    v_pk_mul_f32 v[72:73], v[206:207], v[72:73] op_sel_hi:[0,1]
    v_pk_mul_f32 v[74:75], v[206:207], v[74:75] op_sel_hi:[0,1]
    v_pk_mul_f32 v[76:77], v[206:207], v[76:77] op_sel_hi:[0,1]
    v_pk_mul_f32 v[78:79], v[206:207], v[78:79] op_sel_hi:[0,1]
    v_cvt_pk_bf16_f32 v72, v72, v73
    v_cvt_pk_bf16_f32 v73, v74, v75
    v_cvt_pk_bf16_f32 v74, v76, v77
    v_cvt_pk_bf16_f32 v75, v78, v79
    s_nop 0
    v_permlane32_swap_b32 v72, v74
    v_permlane32_swap_b32 v73, v75
    buffer_store_dwordx4 v[72:75], v6, s[12:15], s3 offen offset:2048 sc1
    s_mul_i32 s55, s9, 393216
    s_add_u32 s55, s55, 60162048
    v_and_b32 v20, 63, v0
    s_lshl_b32 s56, s6, 13
    s_add_u32 s55, s55, s56
    s_lshr_b32 s56, s7, 2
    s_and_b32 s57, s7, 3
    v_lshlrev_b32 v20, 9, v20
    s_lshl_b32 s56, s56, 7
    s_lshl_b32 s57, s57, 2
    s_add_u32 s55, s55, s56
    s_add_u32 s55, s55, s57
    v_mov_b32 v21, 158976
    v_mov_b32 v22, 1
    v_mov_b32 v23, s10
    s_mov_b64 exec, 1
    s_waitcnt vmcnt(0)
    ds_add_rtn_u32 v22, v21, v22
    s_waitcnt lgkmcnt(0)
    v_readfirstlane_b32 s56, v22
    s_and_b32 s56, s56, 3
    s_cmp_lg_u32 s56, 3
    s_cbranch_scc1 pub_1
    s_mov_b32 exec_lo, 0xffff
    buffer_store_dword v23, v20, s[12:15], s55 offen sc1
pub_1:
    s_mov_b64 exec, -1
    s_branch c_wo
.p2align 6
c_wo:
    v_and_b32 v1, 63, v0
    v_lshrrev_b32 v2, 6, v0
    v_lshlrev_b32 v5, 4, v1
    v_lshrrev_b32 v3, 5, v1
    s_lshl_b32 s48, s6, 2
    s_add_u32 s48, s48, s8
    s_lshl_b32 s55, s48, 16
    s_lshl_b32 s56, s9, 22
    s_add_u32 s55, s55, s56
    s_lshl_b32 s56, s7, 12
    s_add_u32 s58, s55, s56
    buffer_load_dwordx4 v[96:99], v5, s[12:15], s58 offen offset:0 sc1
    buffer_load_dwordx4 v[100:103], v5, s[12:15], s58 offen offset:1024 sc1
    buffer_load_dwordx4 v[104:107], v5, s[12:15], s58 offen offset:2048 sc1
    buffer_load_dwordx4 v[108:111], v5, s[12:15], s58 offen offset:3072 sc1
    s_add_u32 s55, s55, 16777216
    s_add_u32 s16, s4, s55
    s_addc_u32 s17, s5, 0
    s_mov_b32 s18, 65536
    s_mov_b32 s19, 0x00020000
    v_and_b32 v4, 15, v0
    v_lshrrev_b32 v16, 2, v4
    v_lshl_add_u32 v16, v3, 2, v16
    v_lshlrev_b32 v16, 7, v16
    v_bfe_u32 v17, v1, 4, 1
    v_lshl_add_u32 v16, v17, 5, v16
    v_and_b32 v17, 3, v4
    v_lshl_add_u32 v16, v17, 3, v16
    v_lshrrev_b32 v17, 3, v4
    v_lshlrev_b32 v18, 6, v17
    v_add_u32 v12, v16, v18
    v_sub_u32 v13, v16, v18
    v_mov_b32 v32, 0
    v_mov_b32 v33, 0
    v_mov_b32 v34, 0
    v_mov_b32 v35, 0
    v_mov_b32 v36, 0
    v_mov_b32 v37, 0
    v_mov_b32 v38, 0
    v_mov_b32 v39, 0
    v_mov_b32 v40, 0
    v_mov_b32 v41, 0
    v_mov_b32 v42, 0
    v_mov_b32 v43, 0
    v_mov_b32 v44, 0
    v_mov_b32 v45, 0
    v_mov_b32 v46, 0
    v_mov_b32 v47, 0
    v_mov_b32 v48, 0
    v_mov_b32 v49, 0
    v_mov_b32 v50, 0
    v_mov_b32 v51, 0
    v_mov_b32 v52, 0
    v_mov_b32 v53, 0
    v_mov_b32 v54, 0
    v_mov_b32 v55, 0
    v_mov_b32 v56, 0
    v_mov_b32 v57, 0
    v_mov_b32 v58, 0
    v_mov_b32 v59, 0
    v_mov_b32 v60, 0
    v_mov_b32 v61, 0
    v_mov_b32 v62, 0
    v_mov_b32 v63, 0
    s_mov_b32 s50, 0
    s_mov_b32 s51, 4096
    s_mov_b32 s52, 8192
    s_mov_b32 s53, 12288
    s_mov_b32 s54, 4
    s_barrier
    buffer_load_dwordx4 v[112:115], v5, s[16:19], s50 offen offset:0 sc1
    buffer_load_dwordx4 v[116:119], v5, s[16:19], s50 offen offset:1024 sc1
    buffer_load_dwordx4 v[120:123], v5, s[16:19], s50 offen offset:2048 sc1
    buffer_load_dwordx4 v[124:127], v5, s[16:19], s50 offen offset:3072 sc1
    ds_read_b64_tr_b16 v[64:65], v12 offset:0
    ds_read_b64_tr_b16 v[66:67], v12 offset:1024
    ds_read_b64_tr_b16 v[68:69], v13 offset:64
    ds_read_b64_tr_b16 v[70:71], v13 offset:1088
    ds_read_b64_tr_b16 v[72:73], v12 offset:2048
    ds_read_b64_tr_b16 v[74:75], v12 offset:3072
    ds_read_b64_tr_b16 v[76:77], v13 offset:2112
    ds_read_b64_tr_b16 v[78:79], v13 offset:3136
    ds_read_b64_tr_b16 v[80:81], v12 offset:4096
    ds_read_b64_tr_b16 v[82:83], v12 offset:5120
    ds_read_b64_tr_b16 v[84:85], v13 offset:4160
    ds_read_b64_tr_b16 v[86:87], v13 offset:5184
    buffer_load_dwordx4 v[128:131], v5, s[16:19], s51 offen offset:0 sc1
    buffer_load_dwordx4 v[132:135], v5, s[16:19], s51 offen offset:1024 sc1
    buffer_load_dwordx4 v[136:139], v5, s[16:19], s51 offen offset:2048 sc1
    buffer_load_dwordx4 v[140:143], v5, s[16:19], s51 offen offset:3072 sc1
    buffer_load_dwordx4 v[144:147], v5, s[16:19], s52 offen offset:0 sc1
    buffer_load_dwordx4 v[148:151], v5, s[16:19], s52 offen offset:1024 sc1
    buffer_load_dwordx4 v[152:155], v5, s[16:19], s52 offen offset:2048 sc1
    buffer_load_dwordx4 v[156:159], v5, s[16:19], s52 offen offset:3072 sc1
    buffer_load_dwordx4 v[160:163], v5, s[16:19], s53 offen offset:0 sc1
    buffer_load_dwordx4 v[164:167], v5, s[16:19], s53 offen offset:1024 sc1
    buffer_load_dwordx4 v[168:171], v5, s[16:19], s53 offen offset:2048 sc1
    s_add_u32 s50, s50, 15360
    s_add_u32 s51, s51, 15360
    s_add_u32 s52, s52, 15360
    s_add_u32 s53, s53, 15360
.p2align 3
c_wo_loop:
    s_waitcnt vmcnt(14) lgkmcnt(8)
    v_mfma_f32_32x32x16_bf16 v[32:47], v[64:67], v[112:115], v[32:47]
    ds_read_b64_tr_b16 v[88:89], v12 offset:6144
    ds_read_b64_tr_b16 v[90:91], v12 offset:7168
    buffer_load_dwordx4 v[172:175], v5, s[16:19], s50 offen offset:0 sc1
    v_mfma_f32_32x32x16_bf16 v[48:63], v[68:71], v[112:115], v[48:63]
    ds_read_b64_tr_b16 v[92:93], v13 offset:6208
    ds_read_b64_tr_b16 v[94:95], v13 offset:7232
    s_waitcnt vmcnt(14) lgkmcnt(8)
    v_mfma_f32_32x32x16_bf16 v[32:47], v[72:75], v[116:119], v[32:47]
    ds_read_b64_tr_b16 v[64:65], v12 offset:8192
    ds_read_b64_tr_b16 v[66:67], v12 offset:9216
    buffer_load_dwordx4 v[112:115], v5, s[16:19], s50 offen offset:1024 sc1
    v_mfma_f32_32x32x16_bf16 v[48:63], v[76:79], v[116:119], v[48:63]
    ds_read_b64_tr_b16 v[68:69], v13 offset:8256
    ds_read_b64_tr_b16 v[70:71], v13 offset:9280
    s_waitcnt vmcnt(14) lgkmcnt(8)
    v_mfma_f32_32x32x16_bf16 v[32:47], v[80:83], v[120:123], v[32:47]
    ds_read_b64_tr_b16 v[72:73], v12 offset:10240
    ds_read_b64_tr_b16 v[74:75], v12 offset:11264
    buffer_load_dwordx4 v[116:119], v5, s[16:19], s50 offen offset:2048 sc1
    v_mfma_f32_32x32x16_bf16 v[48:63], v[84:87], v[120:123], v[48:63]
    ds_read_b64_tr_b16 v[76:77], v13 offset:10304
    ds_read_b64_tr_b16 v[78:79], v13 offset:11328
    s_waitcnt vmcnt(14) lgkmcnt(8)
    v_mfma_f32_32x32x16_bf16 v[32:47], v[88:91], v[124:127], v[32:47]
    ds_read_b64_tr_b16 v[80:81], v12 offset:12288
    ds_read_b64_tr_b16 v[82:83], v12 offset:13312
    buffer_load_dwordx4 v[120:123], v5, s[16:19], s50 offen offset:3072 sc1
    v_mfma_f32_32x32x16_bf16 v[48:63], v[92:95], v[124:127], v[48:63]
    ds_read_b64_tr_b16 v[84:85], v13 offset:12352
    ds_read_b64_tr_b16 v[86:87], v13 offset:13376
    s_add_u32 s50, s50, 16384
    s_waitcnt vmcnt(14) lgkmcnt(8)
    v_mfma_f32_32x32x16_bf16 v[32:47], v[64:67], v[128:131], v[32:47]
    ds_read_b64_tr_b16 v[88:89], v12 offset:14336
    ds_read_b64_tr_b16 v[90:91], v12 offset:15360
    buffer_load_dwordx4 v[124:127], v5, s[16:19], s51 offen offset:0 sc1
    v_mfma_f32_32x32x16_bf16 v[48:63], v[68:71], v[128:131], v[48:63]
    ds_read_b64_tr_b16 v[92:93], v13 offset:14400
    ds_read_b64_tr_b16 v[94:95], v13 offset:15424
    s_waitcnt vmcnt(14) lgkmcnt(8)
    v_mfma_f32_32x32x16_bf16 v[32:47], v[72:75], v[132:135], v[32:47]
    ds_read_b64_tr_b16 v[64:65], v12 offset:16384
    ds_read_b64_tr_b16 v[66:67], v12 offset:17408
    buffer_load_dwordx4 v[128:131], v5, s[16:19], s51 offen offset:1024 sc1
    v_mfma_f32_32x32x16_bf16 v[48:63], v[76:79], v[132:135], v[48:63]
    ds_read_b64_tr_b16 v[68:69], v13 offset:16448
    ds_read_b64_tr_b16 v[70:71], v13 offset:17472
    s_waitcnt vmcnt(14) lgkmcnt(8)
    v_mfma_f32_32x32x16_bf16 v[32:47], v[80:83], v[136:139], v[32:47]
    ds_read_b64_tr_b16 v[72:73], v12 offset:18432
    ds_read_b64_tr_b16 v[74:75], v12 offset:19456
    buffer_load_dwordx4 v[132:135], v5, s[16:19], s51 offen offset:2048 sc1
    v_mfma_f32_32x32x16_bf16 v[48:63], v[84:87], v[136:139], v[48:63]
    ds_read_b64_tr_b16 v[76:77], v13 offset:18496
    ds_read_b64_tr_b16 v[78:79], v13 offset:19520
    s_waitcnt vmcnt(14) lgkmcnt(8)
    v_mfma_f32_32x32x16_bf16 v[32:47], v[88:91], v[140:143], v[32:47]
    ds_read_b64_tr_b16 v[80:81], v12 offset:20480
    ds_read_b64_tr_b16 v[82:83], v12 offset:21504
    buffer_load_dwordx4 v[136:139], v5, s[16:19], s51 offen offset:3072 sc1
    v_mfma_f32_32x32x16_bf16 v[48:63], v[92:95], v[140:143], v[48:63]
    ds_read_b64_tr_b16 v[84:85], v13 offset:20544
    ds_read_b64_tr_b16 v[86:87], v13 offset:21568
    s_add_u32 s51, s51, 16384
    s_waitcnt vmcnt(14) lgkmcnt(8)
    v_mfma_f32_32x32x16_bf16 v[32:47], v[64:67], v[144:147], v[32:47]
    ds_read_b64_tr_b16 v[88:89], v12 offset:22528
    ds_read_b64_tr_b16 v[90:91], v12 offset:23552
    buffer_load_dwordx4 v[140:143], v5, s[16:19], s52 offen offset:0 sc1
    v_mfma_f32_32x32x16_bf16 v[48:63], v[68:71], v[144:147], v[48:63]
    ds_read_b64_tr_b16 v[92:93], v13 offset:22592
    ds_read_b64_tr_b16 v[94:95], v13 offset:23616
    s_waitcnt vmcnt(14) lgkmcnt(8)
    v_mfma_f32_32x32x16_bf16 v[32:47], v[72:75], v[148:151], v[32:47]
    ds_read_b64_tr_b16 v[64:65], v12 offset:24576
    ds_read_b64_tr_b16 v[66:67], v12 offset:25600
    buffer_load_dwordx4 v[144:147], v5, s[16:19], s52 offen offset:1024 sc1
    v_mfma_f32_32x32x16_bf16 v[48:63], v[76:79], v[148:151], v[48:63]
    ds_read_b64_tr_b16 v[68:69], v13 offset:24640
    ds_read_b64_tr_b16 v[70:71], v13 offset:25664
    s_waitcnt vmcnt(14) lgkmcnt(8)
    v_mfma_f32_32x32x16_bf16 v[32:47], v[80:83], v[152:155], v[32:47]
    ds_read_b64_tr_b16 v[72:73], v12 offset:26624
    ds_read_b64_tr_b16 v[74:75], v12 offset:27648
    buffer_load_dwordx4 v[148:151], v5, s[16:19], s52 offen offset:2048 sc1
    v_mfma_f32_32x32x16_bf16 v[48:63], v[84:87], v[152:155], v[48:63]
    ds_read_b64_tr_b16 v[76:77], v13 offset:26688
    ds_read_b64_tr_b16 v[78:79], v13 offset:27712
    s_waitcnt vmcnt(14) lgkmcnt(8)
    v_mfma_f32_32x32x16_bf16 v[32:47], v[88:91], v[156:159], v[32:47]
    ds_read_b64_tr_b16 v[80:81], v12 offset:28672
    ds_read_b64_tr_b16 v[82:83], v12 offset:29696
    buffer_load_dwordx4 v[152:155], v5, s[16:19], s52 offen offset:3072 sc1
    v_mfma_f32_32x32x16_bf16 v[48:63], v[92:95], v[156:159], v[48:63]
    ds_read_b64_tr_b16 v[84:85], v13 offset:28736
    ds_read_b64_tr_b16 v[86:87], v13 offset:29760
    s_add_u32 s52, s52, 16384
    s_waitcnt vmcnt(14) lgkmcnt(8)
    v_mfma_f32_32x32x16_bf16 v[32:47], v[64:67], v[160:163], v[32:47]
    ds_read_b64_tr_b16 v[88:89], v12 offset:30720
    ds_read_b64_tr_b16 v[90:91], v12 offset:31744
    buffer_load_dwordx4 v[156:159], v5, s[16:19], s53 offen offset:0 sc1
    v_mfma_f32_32x32x16_bf16 v[48:63], v[68:71], v[160:163], v[48:63]
    ds_read_b64_tr_b16 v[92:93], v13 offset:30784
    ds_read_b64_tr_b16 v[94:95], v13 offset:31808
    s_waitcnt vmcnt(14) lgkmcnt(8)
    v_mfma_f32_32x32x16_bf16 v[32:47], v[72:75], v[164:167], v[32:47]
    ds_read_b64_tr_b16 v[64:65], v12 offset:32768
    ds_read_b64_tr_b16 v[66:67], v12 offset:33792
    buffer_load_dwordx4 v[160:163], v5, s[16:19], s53 offen offset:1024 sc1
    v_mfma_f32_32x32x16_bf16 v[48:63], v[76:79], v[164:167], v[48:63]
    ds_read_b64_tr_b16 v[68:69], v13 offset:32832
    ds_read_b64_tr_b16 v[70:71], v13 offset:33856
    s_waitcnt vmcnt(14) lgkmcnt(8)
    v_mfma_f32_32x32x16_bf16 v[32:47], v[80:83], v[168:171], v[32:47]
    ds_read_b64_tr_b16 v[72:73], v12 offset:34816
    ds_read_b64_tr_b16 v[74:75], v12 offset:35840
    buffer_load_dwordx4 v[164:167], v5, s[16:19], s53 offen offset:2048 sc1
    v_mfma_f32_32x32x16_bf16 v[48:63], v[84:87], v[168:171], v[48:63]
    ds_read_b64_tr_b16 v[76:77], v13 offset:34880
    ds_read_b64_tr_b16 v[78:79], v13 offset:35904
    s_waitcnt vmcnt(14) lgkmcnt(8)
    v_mfma_f32_32x32x16_bf16 v[32:47], v[88:91], v[172:175], v[32:47]
    ds_read_b64_tr_b16 v[80:81], v12 offset:36864
    ds_read_b64_tr_b16 v[82:83], v12 offset:37888
    buffer_load_dwordx4 v[168:171], v5, s[16:19], s53 offen offset:3072 sc1
    v_add_u32 v12, 32768, v12
    v_mfma_f32_32x32x16_bf16 v[48:63], v[92:95], v[172:175], v[48:63]
    ds_read_b64_tr_b16 v[84:85], v13 offset:36928
    ds_read_b64_tr_b16 v[86:87], v13 offset:37952
    v_add_u32 v13, 32768, v13
    s_add_u32 s53, s53, 16384
    s_sub_u32 s54, s54, 1
    s_cmp_lg_u32 s54, 0
    s_cbranch_scc1 c_wo_loop
    s_mov_b32 s57, 0xffff0000
    v_lshlrev_b32 v176, 16, v96
    v_and_b32 v177, s57, v96
    v_lshlrev_b32 v178, 16, v97
    v_and_b32 v179, s57, v97
    v_lshlrev_b32 v180, 16, v98
    v_and_b32 v181, s57, v98
    v_lshlrev_b32 v182, 16, v99
    v_and_b32 v183, s57, v99
    v_lshlrev_b32 v184, 16, v100
    v_and_b32 v185, s57, v100
    v_lshlrev_b32 v186, 16, v101
    v_and_b32 v187, s57, v101
    v_lshlrev_b32 v188, 16, v102
    v_and_b32 v189, s57, v102
    v_lshlrev_b32 v190, 16, v103
    v_and_b32 v191, s57, v103
    v_lshlrev_b32 v192, 16, v104
    v_and_b32 v193, s57, v104
    v_lshlrev_b32 v194, 16, v105
    v_and_b32 v195, s57, v105
    v_lshlrev_b32 v196, 16, v106
    v_and_b32 v197, s57, v106
    v_lshlrev_b32 v198, 16, v107
    v_and_b32 v199, s57, v107
    v_lshlrev_b32 v200, 16, v108
    v_and_b32 v201, s57, v108
    v_lshlrev_b32 v202, 16, v109
    v_and_b32 v203, s57, v109
    v_lshlrev_b32 v204, 16, v110
    v_and_b32 v205, s57, v110
    v_lshlrev_b32 v206, 16, v111
    v_and_b32 v207, s57, v111
    s_cmp_eq_u32 s9, 3
    s_cbranch_scc1 c_wo_fin
    s_add_u32 s58, s58, 4194304
    v_pk_add_f32 v[32:33], v[32:33], v[176:177]
    v_pk_add_f32 v[34:35], v[34:35], v[178:179]
    v_pk_add_f32 v[36:37], v[36:37], v[180:181]
    v_pk_add_f32 v[38:39], v[38:39], v[182:183]
    v_cvt_pk_bf16_f32 v96, v32, v33
    v_cvt_pk_bf16_f32 v97, v34, v35
    v_cvt_pk_bf16_f32 v98, v36, v37
    v_cvt_pk_bf16_f32 v99, v38, v39
    buffer_store_dwordx4 v[96:99], v5, s[12:15], s58 offen offset:0 sc1
    v_pk_add_f32 v[40:41], v[40:41], v[184:185]
    v_pk_add_f32 v[42:43], v[42:43], v[186:187]
    v_pk_add_f32 v[44:45], v[44:45], v[188:189]
    v_pk_add_f32 v[46:47], v[46:47], v[190:191]
    v_cvt_pk_bf16_f32 v100, v40, v41
    v_cvt_pk_bf16_f32 v101, v42, v43
    v_cvt_pk_bf16_f32 v102, v44, v45
    v_cvt_pk_bf16_f32 v103, v46, v47
    buffer_store_dwordx4 v[100:103], v5, s[12:15], s58 offen offset:1024 sc1
    v_pk_add_f32 v[48:49], v[48:49], v[192:193]
    v_pk_add_f32 v[50:51], v[50:51], v[194:195]
    v_pk_add_f32 v[52:53], v[52:53], v[196:197]
    v_pk_add_f32 v[54:55], v[54:55], v[198:199]
    v_cvt_pk_bf16_f32 v104, v48, v49
    v_cvt_pk_bf16_f32 v105, v50, v51
    v_cvt_pk_bf16_f32 v106, v52, v53
    v_cvt_pk_bf16_f32 v107, v54, v55
    buffer_store_dwordx4 v[104:107], v5, s[12:15], s58 offen offset:2048 sc1
    v_pk_add_f32 v[56:57], v[56:57], v[200:201]
    v_pk_add_f32 v[58:59], v[58:59], v[202:203]
    v_pk_add_f32 v[60:61], v[60:61], v[204:205]
    v_pk_add_f32 v[62:63], v[62:63], v[206:207]
    v_cvt_pk_bf16_f32 v108, v56, v57
    v_cvt_pk_bf16_f32 v109, v58, v59
    v_cvt_pk_bf16_f32 v110, v60, v61
    v_cvt_pk_bf16_f32 v111, v62, v63
    buffer_store_dwordx4 v[108:111], v5, s[12:15], s58 offen offset:3072 sc1
    s_barrier
c_wo_stat:
    v_mov_b32 v22, 0x3f803f80
    v_mov_b32 v18, 0
    v_mov_b32 v19, 0
    v_dot2_f32_bf16 v18, v96, v22, v18
    v_dot2_f32_bf16 v19, v96, v96, v19
    v_dot2_f32_bf16 v18, v97, v22, v18
    v_dot2_f32_bf16 v19, v97, v97, v19
    v_dot2_f32_bf16 v18, v98, v22, v18
    v_dot2_f32_bf16 v19, v98, v98, v19
    v_dot2_f32_bf16 v18, v99, v22, v18
    v_dot2_f32_bf16 v19, v99, v99, v19
    v_dot2_f32_bf16 v18, v100, v22, v18
    v_dot2_f32_bf16 v19, v100, v100, v19
    v_dot2_f32_bf16 v18, v101, v22, v18
    v_dot2_f32_bf16 v19, v101, v101, v19
    v_dot2_f32_bf16 v18, v102, v22, v18
    v_dot2_f32_bf16 v19, v102, v102, v19
    v_dot2_f32_bf16 v18, v103, v22, v18
    v_dot2_f32_bf16 v19, v103, v103, v19
    v_dot2_f32_bf16 v18, v104, v22, v18
    v_dot2_f32_bf16 v19, v104, v104, v19
    v_dot2_f32_bf16 v18, v105, v22, v18
    v_dot2_f32_bf16 v19, v105, v105, v19
    v_dot2_f32_bf16 v18, v106, v22, v18
    v_dot2_f32_bf16 v19, v106, v106, v19
    v_dot2_f32_bf16 v18, v107, v22, v18
    v_dot2_f32_bf16 v19, v107, v107, v19
    v_dot2_f32_bf16 v18, v108, v22, v18
    v_dot2_f32_bf16 v19, v108, v108, v19
    v_dot2_f32_bf16 v18, v109, v22, v18
    v_dot2_f32_bf16 v19, v109, v109, v19
    v_dot2_f32_bf16 v18, v110, v22, v18
    v_dot2_f32_bf16 v19, v110, v110, v19
    v_dot2_f32_bf16 v18, v111, v22, v18
    v_dot2_f32_bf16 v19, v111, v111, v19
    v_lshlrev_b32 v16, 3, v1
    s_lshl_b32 s3, s48, 12
    s_lshl_b32 s55, s7, 8
    v_mov_b32 v20, v18
    v_mov_b32 v21, v19
    s_add_u32 s3, s3, s55
    s_lshl_b32 s55, s9, 18
    v_permlane32_swap_b32 v18, v20
    v_permlane32_swap_b32 v19, v21
    s_add_u32 s3, s3, s55
    s_add_u32 s3, s3, 57933824
    v_pk_add_f32 v[18:19], v[18:19], v[20:21]
    s_mov_b32 exec_hi, 0
    buffer_store_dwordx2 v[18:19], v16, s[12:15], s3 offen sc1
    s_mov_b64 exec, -1
    s_bitcmp1_b32 s9, 0
    s_cbranch_scc1 c_wo_toA
    s_mul_i32 s55, s9, 393216
    s_add_u32 s55, s55, 60293120
    v_and_b32 v24, 63, v0
    s_lshr_b32 s56, s11, 5
    s_lshl_b32 s56, s56, 14
    s_add_u32 s55, s55, s56
    s_bfe_u32 s56, s11, 0x20003
    s_and_b32 s57, s11, 7
    v_lshlrev_b32 v24, 9, v24
    s_lshl_b32 s56, s56, 7
    s_lshl_b32 s57, s57, 2
    s_add_u32 s55, s55, s56
    s_add_u32 s55, s55, s57
    v_mov_b32 v25, 158976
    v_mov_b32 v26, 1
    v_mov_b32 v27, s10
    s_mov_b64 exec, 1
    s_waitcnt vmcnt(0)
    ds_add_rtn_u32 v26, v25, v26
    s_waitcnt lgkmcnt(0)
    v_readfirstlane_b32 s56, v26
    s_and_b32 s56, s56, 3
    s_cmp_lg_u32 s56, 3
    s_cbranch_scc1 pub_2
    s_mov_b32 exec_lo, -1
    buffer_store_dword v27, v24, s[12:15], s55 offen sc1
pub_2:
    s_mov_b64 exec, -1
    s_add_u32 s9, s9, 1
    s_branch c_qkvb
c_wo_toA:
    s_cmp_lg_u32 s9, -1
    s_cbranch_scc1 c_wo_toA2
    s_barrier
    v_mov_b32 v24, 158980
non_3:
    ds_read_b32 v25, v24
    s_waitcnt lgkmcnt(0)
    v_readfirstlane_b32 s10, v25
    s_cmp_eq_u32 s10, 0
    s_cbranch_scc1 non_3
c_wo_toA2:
    s_mul_i32 s55, s9, 393216
    s_add_u32 s55, s55, 60293120
    v_and_b32 v24, 63, v0
    s_lshl_b32 s56, s6, 4
    v_lshrrev_b32 v25, 4, v24
    v_add_u32 v24, s56, v24
    v_and_b32 v24, 255, v24
    v_lshlrev_b32 v24, 9, v24
    v_lshl_add_u32 v24, v25, 8, v24
    s_lshr_b32 s56, s7, 3
    s_and_b32 s57, s7, 7
    s_lshl_b32 s56, s56, 7
    s_lshl_b32 s57, s57, 2
    s_add_u32 s55, s55, s56
    s_add_u32 s55, s55, s57
    v_mov_b32 v25, 158976
    v_mov_b32 v26, 1
    v_mov_b32 v27, s10
    s_mov_b64 exec, 1
    s_waitcnt vmcnt(0)
    ds_add_rtn_u32 v26, v25, v26
    s_waitcnt lgkmcnt(0)
    v_readfirstlane_b32 s56, v26
    s_and_b32 s56, s56, 3
    s_cmp_lg_u32 s56, 3
    s_cbranch_scc1 pub_4
    s_mov_b32 exec_lo, -1
    buffer_store_dword v27, v24, s[12:15], s55 offen sc1
pub_4:
    s_mov_b64 exec, -1
    s_add_u32 s9, s9, 1
    s_branch c_qkva
c_wo_fin:
    s_barrier
    v_pk_add_f32 v[32:33], v[32:33], v[176:177]
    v_pk_add_f32 v[34:35], v[34:35], v[178:179]
    v_pk_add_f32 v[36:37], v[36:37], v[180:181]
    v_pk_add_f32 v[38:39], v[38:39], v[182:183]
    v_pk_add_f32 v[40:41], v[40:41], v[184:185]
    v_pk_add_f32 v[42:43], v[42:43], v[186:187]
    v_pk_add_f32 v[44:45], v[44:45], v[188:189]
    v_pk_add_f32 v[46:47], v[46:47], v[190:191]
    v_pk_add_f32 v[48:49], v[48:49], v[192:193]
    v_pk_add_f32 v[50:51], v[50:51], v[194:195]
    v_pk_add_f32 v[52:53], v[52:53], v[196:197]
    v_pk_add_f32 v[54:55], v[54:55], v[198:199]
    v_pk_add_f32 v[56:57], v[56:57], v[200:201]
    v_pk_add_f32 v[58:59], v[58:59], v[202:203]
    v_pk_add_f32 v[60:61], v[60:61], v[204:205]
    v_pk_add_f32 v[62:63], v[62:63], v[206:207]
    v_cvt_pk_bf16_f32 v96, v32, v33
    v_cvt_pk_bf16_f32 v97, v34, v35
    v_cvt_pk_bf16_f32 v98, v36, v37
    v_cvt_pk_bf16_f32 v99, v38, v39
    v_cvt_pk_bf16_f32 v100, v40, v41
    v_cvt_pk_bf16_f32 v101, v42, v43
    v_cvt_pk_bf16_f32 v102, v44, v45
    v_cvt_pk_bf16_f32 v103, v46, v47
    v_cvt_pk_bf16_f32 v104, v48, v49
    v_cvt_pk_bf16_f32 v105, v50, v51
    v_cvt_pk_bf16_f32 v106, v52, v53
    v_cvt_pk_bf16_f32 v107, v54, v55
    v_cvt_pk_bf16_f32 v108, v56, v57
    v_cvt_pk_bf16_f32 v109, v58, v59
    v_cvt_pk_bf16_f32 v110, v60, v61
    v_cvt_pk_bf16_f32 v111, v62, v63
    s_mov_b32 s28, s44
    s_mov_b32 s29, s45
    s_mov_b32 s30, 4194304
    s_mov_b32 s31, 0x00020000
    v_and_b32 v16, 31, v1
    v_mul_u32_u24 v16, 144, v16
    v_lshl_add_u32 v16, v3, 3, v16
    v_mul_u32_u24 v17, 4608, v2
    v_add_u32 v16, v16, v17
    ds_write_b64 v16, v[96:97] offset:0
    ds_write_b64 v16, v[98:99] offset:16
    ds_write_b64 v16, v[100:101] offset:32
    ds_write_b64 v16, v[102:103] offset:48
    ds_write_b64 v16, v[104:105] offset:64
    ds_write_b64 v16, v[106:107] offset:80
    ds_write_b64 v16, v[108:109] offset:96
    ds_write_b64 v16, v[110:111] offset:112
    v_lshrrev_b32 v18, 3, v1
    v_and_b32 v19, 7, v1
    v_mul_u32_u24 v20, 144, v18
    v_lshl_add_u32 v20, v19, 4, v20
    v_add_u32 v20, v20, v17
    v_lshlrev_b32 v21, 11, v18
    v_lshl_add_u32 v21, v19, 4, v21
    s_lshl_b32 s3, s48, 16
    s_lshl_b32 s55, s7, 7
    s_add_u32 s3, s3, s55
    s_waitcnt lgkmcnt(0)
    ds_read_b128 v[32:35], v20 offset:0
    ds_read_b128 v[36:39], v20 offset:1152
    ds_read_b128 v[40:43], v20 offset:2304
    ds_read_b128 v[44:47], v20 offset:3456
    s_waitcnt lgkmcnt(3)
    buffer_store_dwordx4 v[32:35], v21, s[28:31], s3 offen sc1
    s_add_u32 s3, s3, 16384
    s_waitcnt lgkmcnt(2)
    buffer_store_dwordx4 v[36:39], v21, s[28:31], s3 offen sc1
    s_add_u32 s3, s3, 16384
    s_waitcnt lgkmcnt(1)
    buffer_store_dwordx4 v[40:43], v21, s[28:31], s3 offen sc1
    s_add_u32 s3, s3, 16384
    s_waitcnt lgkmcnt(0)
    buffer_store_dwordx4 v[44:47], v21, s[28:31], s3 offen sc1
    s_add_u32 s3, s3, 16384
    s_branch k_exit
c_prep:
    s_mov_b32 s28, s32
    s_mov_b32 s29, s33
    s_mov_b32 s30, 4194304
    s_mov_b32 s31, 0x00020000
    s_lshl_b32 s48, s6, 2
    s_add_u32 s48, s48, s8
    v_lshrrev_b32 v16, 3, v1
    v_and_b32 v17, 7, v1
    v_lshlrev_b32 v18, 11, v16
    v_lshl_add_u32 v18, v17, 4, v18
    s_lshl_b32 s55, s48, 16
    s_lshl_b32 s56, s7, 7
    s_add_u32 s3, s55, s56
    buffer_load_dwordx4 v[32:35], v18, s[28:31], s3 offen
    s_add_u32 s3, s3, 16384
    buffer_load_dwordx4 v[36:39], v18, s[28:31], s3 offen
    s_add_u32 s3, s3, 16384
    buffer_load_dwordx4 v[40:43], v18, s[28:31], s3 offen
    s_add_u32 s3, s3, 16384
    buffer_load_dwordx4 v[44:47], v18, s[28:31], s3 offen
    s_add_u32 s3, s3, 16384
    s_barrier
    s_lshl_b32 s56, s7, 12
    s_add_u32 s58, s55, s56
    v_lshlrev_b32 v5, 4, v1
    s_lshl_b32 s3, s8, 12
    s_add_u32 s3, s3, 131072
    v_lshrrev_b32 v18, 1, v17
    v_lshlrev_b32 v18, 10, v18
    v_lshl_add_u32 v18, v16, 4, v18
    v_and_b32 v17, 1, v17
    v_lshl_add_u32 v18, v17, 3, v18
    v_add_u32 v18, s3, v18
    v_add_u32 v19, s3, v5
    s_waitcnt vmcnt(3)
    ds_write_b64 v18, v[32:33] offset:0
    ds_write_b64 v18, v[34:35] offset:512
    s_waitcnt vmcnt(2)
    ds_write_b64 v18, v[36:37] offset:128
    ds_write_b64 v18, v[38:39] offset:640
    s_waitcnt vmcnt(1)
    ds_write_b64 v18, v[40:41] offset:256
    ds_write_b64 v18, v[42:43] offset:768
    s_waitcnt vmcnt(0)
    ds_write_b64 v18, v[44:45] offset:384
    ds_write_b64 v18, v[46:47] offset:896
    s_waitcnt lgkmcnt(0)
    ds_read_b128 v[96:99], v19 offset:0
    ds_read_b128 v[100:103], v19 offset:1024
    ds_read_b128 v[104:107], v19 offset:2048
    ds_read_b128 v[108:111], v19 offset:3072
    s_waitcnt lgkmcnt(3)
    buffer_store_dwordx4 v[96:99], v5, s[12:15], s58 offen offset:0 sc1
    s_waitcnt lgkmcnt(2)
    buffer_store_dwordx4 v[100:103], v5, s[12:15], s58 offen offset:1024 sc1
    s_waitcnt lgkmcnt(1)
    buffer_store_dwordx4 v[104:107], v5, s[12:15], s58 offen offset:2048 sc1
    s_waitcnt lgkmcnt(0)
    buffer_store_dwordx4 v[108:111], v5, s[12:15], s58 offen offset:3072 sc1
    s_branch c_wo_stat
.p2align 6
c_qkvb:
    v_and_b32 v1, 63, v0
    v_lshrrev_b32 v2, 6, v0
    v_lshlrev_b32 v5, 4, v1
    v_lshrrev_b32 v3, 5, v1
    v_and_b32 v4, 15, v0
    v_bfe_u32 v7, v1, 4, 1
    v_lshl_add_u32 v6, v7, 5, v4
    v_lshlrev_b32 v6, 4, v6
    v_lshl_add_u32 v6, v3, 10, v6
    s_lshr_b32 s48, s6, 1
    s_lshl_b32 s48, s48, 2
    s_add_u32 s48, s48, s8
    s_lshl_b32 s55, s48, 17
    s_lshl_b32 s56, s9, 22
    s_add_u32 s55, s55, s56
    s_add_u32 s16, s4, s55
    s_addc_u32 s17, s5, 0
    s_mov_b32 s18, 65536
    s_mov_b32 s19, 0x00020000
    s_add_u32 s55, s55, 65536
    s_add_u32 s20, s4, s55
    s_addc_u32 s21, s5, 0
    s_mov_b32 s22, 65536
    s_mov_b32 s23, 0x00020000
    s_movk_i32 s54, 4096
    v_lshrrev_b32 v8, 2, v4
    v_lshl_add_u32 v8, v7, 2, v8
    v_lshl_add_u32 v8, v3, 4, v8
    v_lshlrev_b32 v8, 6, v8
    v_and_b32 v9, 3, v4
    v_lshl_add_u32 v8, v9, 3, v8
    v_lshl_add_u32 v26, v7, 5, v8
    v_xor_b32 v27, 32, v26
    v_mov_b32 v24, v26
    v_mov_b32 v25, v27
    v_mov_b32 v32, 0
    v_mov_b32 v33, 0
    v_mov_b32 v34, 0
    v_mov_b32 v35, 0
    v_mov_b32 v36, 0
    v_mov_b32 v37, 0
    v_mov_b32 v38, 0
    v_mov_b32 v39, 0
    v_mov_b32 v40, 0
    v_mov_b32 v41, 0
    v_mov_b32 v42, 0
    v_mov_b32 v43, 0
    v_mov_b32 v44, 0
    v_mov_b32 v45, 0
    v_mov_b32 v46, 0
    v_mov_b32 v47, 0
    v_mov_b32 v48, 0
    v_mov_b32 v49, 0
    v_mov_b32 v50, 0
    v_mov_b32 v51, 0
    v_mov_b32 v52, 0
    v_mov_b32 v53, 0
    v_mov_b32 v54, 0
    v_mov_b32 v55, 0
    v_mov_b32 v56, 0
    v_mov_b32 v57, 0
    v_mov_b32 v58, 0
    v_mov_b32 v59, 0
    v_mov_b32 v60, 0
    v_mov_b32 v61, 0
    v_mov_b32 v62, 0
    v_mov_b32 v63, 0
    v_mov_b32 v64, 0
    v_mov_b32 v65, 0
    v_mov_b32 v66, 0
    v_mov_b32 v67, 0
    v_mov_b32 v68, 0
    v_mov_b32 v69, 0
    v_mov_b32 v70, 0
    v_mov_b32 v71, 0
    v_mov_b32 v72, 0
    v_mov_b32 v73, 0
    v_mov_b32 v74, 0
    v_mov_b32 v75, 0
    v_mov_b32 v76, 0
    v_mov_b32 v77, 0
    v_mov_b32 v78, 0
    v_mov_b32 v79, 0
    v_mov_b32 v80, 0
    v_mov_b32 v81, 0
    v_mov_b32 v82, 0
    v_mov_b32 v83, 0
    v_mov_b32 v84, 0
    v_mov_b32 v85, 0
    v_mov_b32 v86, 0
    v_mov_b32 v87, 0
    v_mov_b32 v88, 0
    v_mov_b32 v89, 0
    v_mov_b32 v90, 0
    v_mov_b32 v91, 0
    v_mov_b32 v92, 0
    v_mov_b32 v93, 0
    v_mov_b32 v94, 0
    v_mov_b32 v95, 0
    v_mov_b32 v96, 0
    v_mov_b32 v97, 0
    v_mov_b32 v98, 0
    v_mov_b32 v99, 0
    v_mov_b32 v100, 0
    v_mov_b32 v101, 0
    v_mov_b32 v102, 0
    v_mov_b32 v103, 0
    v_mov_b32 v104, 0
    v_mov_b32 v105, 0
    v_mov_b32 v106, 0
    v_mov_b32 v107, 0
    v_mov_b32 v108, 0
    v_mov_b32 v109, 0
    v_mov_b32 v110, 0
    v_mov_b32 v111, 0
    v_mov_b32 v112, 0
    v_mov_b32 v113, 0
    v_mov_b32 v114, 0
    v_mov_b32 v115, 0
    v_mov_b32 v116, 0
    v_mov_b32 v117, 0
    v_mov_b32 v118, 0
    v_mov_b32 v119, 0
    v_mov_b32 v120, 0
    v_mov_b32 v121, 0
    v_mov_b32 v122, 0
    v_mov_b32 v123, 0
    v_mov_b32 v124, 0
    v_mov_b32 v125, 0
    v_mov_b32 v126, 0
    v_mov_b32 v127, 0
    s_mov_b32 s50, 6144
    s_mov_b32 s51, 10240
    s_mov_b32 s52, 0
    s_barrier
    buffer_load_dwordx4 a[0:3], v6, s[16:19], 0 offen offset:0 sc1
    buffer_load_dwordx4 a[4:7], v6, s[16:19], 0 offen offset:256 sc1
    buffer_load_dwordx4 a[8:11], v6, s[20:23], 0 offen offset:0 sc1
    buffer_load_dwordx4 a[12:15], v6, s[20:23], 0 offen offset:256 sc1
    ds_read_b64_tr_b16 v[128:129], v24 offset:0
    ds_read_b64_tr_b16 v[130:131], v24 offset:512
    ds_read_b64_tr_b16 v[132:133], v25 offset:0
    ds_read_b64_tr_b16 v[134:135], v25 offset:512
    ds_read_b64_tr_b16 v[136:137], v24 offset:8192
    ds_read_b64_tr_b16 v[138:139], v24 offset:8704
    ds_read_b64_tr_b16 v[140:141], v25 offset:8192
    ds_read_b64_tr_b16 v[142:143], v25 offset:8704
    ds_read_b64_tr_b16 v[144:145], v24 offset:16384
    ds_read_b64_tr_b16 v[146:147], v24 offset:16896
    buffer_load_dwordx4 a[16:19], v6, s[16:19], 0 offen offset:2048 sc1
    buffer_load_dwordx4 a[20:23], v6, s[16:19], 0 offen offset:2304 sc1
    buffer_load_dwordx4 a[24:27], v6, s[20:23], 0 offen offset:2048 sc1
    buffer_load_dwordx4 a[28:31], v6, s[20:23], 0 offen offset:2304 sc1
    buffer_load_dwordx4 v[152:155], v6, s[16:19], s54 offen offset:0 sc1
    buffer_load_dwordx4 v[156:159], v6, s[16:19], s54 offen offset:256 sc1
    buffer_load_dwordx4 v[160:163], v6, s[20:23], s54 offen offset:0 sc1
    buffer_load_dwordx4 v[164:167], v6, s[20:23], s54 offen offset:256 sc1
    s_mov_b32 s54, 8
.p2align 3
c_qkvb_loop:
    s_waitcnt vmcnt(8) lgkmcnt(8)
    v_mfma_f32_16x16x32_bf16 v[32:35], v[128:131], a[0:3], v[32:35]
    ds_read_b64_tr_b16 v[148:149], v25 offset:16384
    v_mfma_f32_16x16x32_bf16 v[36:39], v[128:131], a[4:7], v[36:39]
    ds_read_b64_tr_b16 v[150:151], v25 offset:16896
    v_mfma_f32_16x16x32_bf16 v[40:43], v[128:131], a[8:11], v[40:43]
    v_mfma_f32_16x16x32_bf16 v[44:47], v[128:131], a[12:15], v[44:47]
    s_waitcnt lgkmcnt(8)
    v_mfma_f32_16x16x32_bf16 v[48:51], v[132:135], a[0:3], v[48:51]
    ds_read_b64_tr_b16 v[128:129], v24 offset:2048
    v_mfma_f32_16x16x32_bf16 v[52:55], v[132:135], a[4:7], v[52:55]
    ds_read_b64_tr_b16 v[130:131], v24 offset:2560
    v_mfma_f32_16x16x32_bf16 v[56:59], v[132:135], a[8:11], v[56:59]
    buffer_load_dwordx4 v[168:171], v6, s[16:19], s50 offen offset:0 sc1
    v_mfma_f32_16x16x32_bf16 v[60:63], v[132:135], a[12:15], v[60:63]
    s_waitcnt lgkmcnt(8)
    v_mfma_f32_16x16x32_bf16 v[64:67], v[136:139], a[0:3], v[64:67]
    ds_read_b64_tr_b16 v[132:133], v25 offset:2048
    v_mfma_f32_16x16x32_bf16 v[68:71], v[136:139], a[4:7], v[68:71]
    ds_read_b64_tr_b16 v[134:135], v25 offset:2560
    v_mfma_f32_16x16x32_bf16 v[72:75], v[136:139], a[8:11], v[72:75]
    buffer_load_dwordx4 v[172:175], v6, s[16:19], s50 offen offset:256 sc1
    v_mfma_f32_16x16x32_bf16 v[76:79], v[136:139], a[12:15], v[76:79]
    s_waitcnt lgkmcnt(8)
    v_mfma_f32_16x16x32_bf16 v[80:83], v[140:143], a[0:3], v[80:83]
    ds_read_b64_tr_b16 v[136:137], v24 offset:10240
    v_mfma_f32_16x16x32_bf16 v[84:87], v[140:143], a[4:7], v[84:87]
    ds_read_b64_tr_b16 v[138:139], v24 offset:10752
    v_mfma_f32_16x16x32_bf16 v[88:91], v[140:143], a[8:11], v[88:91]
    buffer_load_dwordx4 v[176:179], v6, s[20:23], s50 offen offset:0 sc1
    v_mfma_f32_16x16x32_bf16 v[92:95], v[140:143], a[12:15], v[92:95]
    s_waitcnt lgkmcnt(8)
    v_mfma_f32_16x16x32_bf16 v[96:99], a[0:3], v[144:147], v[96:99]
    ds_read_b64_tr_b16 v[140:141], v25 offset:10240
    v_mfma_f32_16x16x32_bf16 v[100:103], a[4:7], v[144:147], v[100:103]
    ds_read_b64_tr_b16 v[142:143], v25 offset:10752
    v_mfma_f32_16x16x32_bf16 v[104:107], a[8:11], v[144:147], v[104:107]
    buffer_load_dwordx4 v[180:183], v6, s[20:23], s50 offen offset:256 sc1
    v_mfma_f32_16x16x32_bf16 v[108:111], a[12:15], v[144:147], v[108:111]
    s_waitcnt lgkmcnt(8)
    v_mfma_f32_16x16x32_bf16 v[112:115], a[0:3], v[148:151], v[112:115]
    ds_read_b64_tr_b16 v[144:145], v24 offset:18432
    v_mfma_f32_16x16x32_bf16 v[116:119], a[4:7], v[148:151], v[116:119]
    ds_read_b64_tr_b16 v[146:147], v24 offset:18944
    v_mfma_f32_16x16x32_bf16 v[120:123], a[8:11], v[148:151], v[120:123]
    v_mfma_f32_16x16x32_bf16 v[124:127], a[12:15], v[148:151], v[124:127]
    s_waitcnt vmcnt(8) lgkmcnt(8)
    v_mfma_f32_16x16x32_bf16 v[32:35], v[128:131], a[16:19], v[32:35]
    ds_read_b64_tr_b16 v[148:149], v25 offset:18432
    v_mfma_f32_16x16x32_bf16 v[36:39], v[128:131], a[20:23], v[36:39]
    ds_read_b64_tr_b16 v[150:151], v25 offset:18944
    v_mfma_f32_16x16x32_bf16 v[40:43], v[128:131], a[24:27], v[40:43]
    v_mfma_f32_16x16x32_bf16 v[44:47], v[128:131], a[28:31], v[44:47]
    s_waitcnt lgkmcnt(8)
    v_mfma_f32_16x16x32_bf16 v[48:51], v[132:135], a[16:19], v[48:51]
    ds_read_b64_tr_b16 v[128:129], v24 offset:4096
    v_mfma_f32_16x16x32_bf16 v[52:55], v[132:135], a[20:23], v[52:55]
    ds_read_b64_tr_b16 v[130:131], v24 offset:4608
    v_mfma_f32_16x16x32_bf16 v[56:59], v[132:135], a[24:27], v[56:59]
    buffer_load_dwordx4 a[0:3], v6, s[16:19], s50 offen offset:2048 sc1
    v_mfma_f32_16x16x32_bf16 v[60:63], v[132:135], a[28:31], v[60:63]
    s_waitcnt lgkmcnt(8)
    v_mfma_f32_16x16x32_bf16 v[64:67], v[136:139], a[16:19], v[64:67]
    ds_read_b64_tr_b16 v[132:133], v25 offset:4096
    v_mfma_f32_16x16x32_bf16 v[68:71], v[136:139], a[20:23], v[68:71]
    ds_read_b64_tr_b16 v[134:135], v25 offset:4608
    v_mfma_f32_16x16x32_bf16 v[72:75], v[136:139], a[24:27], v[72:75]
    buffer_load_dwordx4 a[4:7], v6, s[16:19], s50 offen offset:2304 sc1
    v_mfma_f32_16x16x32_bf16 v[76:79], v[136:139], a[28:31], v[76:79]
    s_waitcnt lgkmcnt(8)
    v_mfma_f32_16x16x32_bf16 v[80:83], v[140:143], a[16:19], v[80:83]
    ds_read_b64_tr_b16 v[136:137], v24 offset:12288
    v_mfma_f32_16x16x32_bf16 v[84:87], v[140:143], a[20:23], v[84:87]
    ds_read_b64_tr_b16 v[138:139], v24 offset:12800
    v_mfma_f32_16x16x32_bf16 v[88:91], v[140:143], a[24:27], v[88:91]
    buffer_load_dwordx4 a[8:11], v6, s[20:23], s50 offen offset:2048 sc1
    v_mfma_f32_16x16x32_bf16 v[92:95], v[140:143], a[28:31], v[92:95]
    s_waitcnt lgkmcnt(8)
    v_mfma_f32_16x16x32_bf16 v[96:99], a[16:19], v[144:147], v[96:99]
    ds_read_b64_tr_b16 v[140:141], v25 offset:12288
    v_mfma_f32_16x16x32_bf16 v[100:103], a[20:23], v[144:147], v[100:103]
    ds_read_b64_tr_b16 v[142:143], v25 offset:12800
    v_mfma_f32_16x16x32_bf16 v[104:107], a[24:27], v[144:147], v[104:107]
    buffer_load_dwordx4 a[12:15], v6, s[20:23], s50 offen offset:2304 sc1
    v_mfma_f32_16x16x32_bf16 v[108:111], a[28:31], v[144:147], v[108:111]
    s_waitcnt lgkmcnt(8)
    v_mfma_f32_16x16x32_bf16 v[112:115], a[16:19], v[148:151], v[112:115]
    ds_read_b64_tr_b16 v[144:145], v24 offset:20480
    v_mfma_f32_16x16x32_bf16 v[116:119], a[20:23], v[148:151], v[116:119]
    ds_read_b64_tr_b16 v[146:147], v24 offset:20992
    v_mfma_f32_16x16x32_bf16 v[120:123], a[24:27], v[148:151], v[120:123]
    v_mfma_f32_16x16x32_bf16 v[124:127], a[28:31], v[148:151], v[124:127]
    s_waitcnt vmcnt(8) lgkmcnt(8)
    v_mfma_f32_16x16x32_bf16 v[32:35], v[128:131], v[152:155], v[32:35]
    ds_read_b64_tr_b16 v[148:149], v25 offset:20480
    v_mfma_f32_16x16x32_bf16 v[36:39], v[128:131], v[156:159], v[36:39]
    ds_read_b64_tr_b16 v[150:151], v25 offset:20992
    v_mfma_f32_16x16x32_bf16 v[40:43], v[128:131], v[160:163], v[40:43]
    v_mfma_f32_16x16x32_bf16 v[44:47], v[128:131], v[164:167], v[44:47]
    s_waitcnt lgkmcnt(8)
    v_mfma_f32_16x16x32_bf16 v[48:51], v[132:135], v[152:155], v[48:51]
    ds_read_b64_tr_b16 v[128:129], v24 offset:6144
    v_mfma_f32_16x16x32_bf16 v[52:55], v[132:135], v[156:159], v[52:55]
    ds_read_b64_tr_b16 v[130:131], v24 offset:6656
    v_mfma_f32_16x16x32_bf16 v[56:59], v[132:135], v[160:163], v[56:59]
    buffer_load_dwordx4 a[16:19], v6, s[16:19], s51 offen offset:0 sc1
    v_mfma_f32_16x16x32_bf16 v[60:63], v[132:135], v[164:167], v[60:63]
    s_waitcnt lgkmcnt(8)
    v_mfma_f32_16x16x32_bf16 v[64:67], v[136:139], v[152:155], v[64:67]
    ds_read_b64_tr_b16 v[132:133], v25 offset:6144
    v_mfma_f32_16x16x32_bf16 v[68:71], v[136:139], v[156:159], v[68:71]
    ds_read_b64_tr_b16 v[134:135], v25 offset:6656
    v_mfma_f32_16x16x32_bf16 v[72:75], v[136:139], v[160:163], v[72:75]
    buffer_load_dwordx4 a[20:23], v6, s[16:19], s51 offen offset:256 sc1
    v_mfma_f32_16x16x32_bf16 v[76:79], v[136:139], v[164:167], v[76:79]
    s_waitcnt lgkmcnt(8)
    v_mfma_f32_16x16x32_bf16 v[80:83], v[140:143], v[152:155], v[80:83]
    ds_read_b64_tr_b16 v[136:137], v24 offset:14336
    v_mfma_f32_16x16x32_bf16 v[84:87], v[140:143], v[156:159], v[84:87]
    ds_read_b64_tr_b16 v[138:139], v24 offset:14848
    v_mfma_f32_16x16x32_bf16 v[88:91], v[140:143], v[160:163], v[88:91]
    buffer_load_dwordx4 a[24:27], v6, s[20:23], s51 offen offset:0 sc1
    v_mfma_f32_16x16x32_bf16 v[92:95], v[140:143], v[164:167], v[92:95]
    s_waitcnt lgkmcnt(8)
    v_mfma_f32_16x16x32_bf16 v[96:99], v[152:155], v[144:147], v[96:99]
    ds_read_b64_tr_b16 v[140:141], v25 offset:14336
    v_mfma_f32_16x16x32_bf16 v[100:103], v[156:159], v[144:147], v[100:103]
    ds_read_b64_tr_b16 v[142:143], v25 offset:14848
    v_mfma_f32_16x16x32_bf16 v[104:107], v[160:163], v[144:147], v[104:107]
    buffer_load_dwordx4 a[28:31], v6, s[20:23], s51 offen offset:256 sc1
    v_mfma_f32_16x16x32_bf16 v[108:111], v[164:167], v[144:147], v[108:111]
    s_waitcnt lgkmcnt(8)
    v_mfma_f32_16x16x32_bf16 v[112:115], v[152:155], v[148:151], v[112:115]
    ds_read_b64_tr_b16 v[144:145], v24 offset:22528
    v_mfma_f32_16x16x32_bf16 v[116:119], v[156:159], v[148:151], v[116:119]
    ds_read_b64_tr_b16 v[146:147], v24 offset:23040
    v_mfma_f32_16x16x32_bf16 v[120:123], v[160:163], v[148:151], v[120:123]
    v_mfma_f32_16x16x32_bf16 v[124:127], v[164:167], v[148:151], v[124:127]
    s_waitcnt vmcnt(8) lgkmcnt(8)
    v_mfma_f32_16x16x32_bf16 v[32:35], v[128:131], v[168:171], v[32:35]
    ds_read_b64_tr_b16 v[148:149], v25 offset:22528
    v_mfma_f32_16x16x32_bf16 v[36:39], v[128:131], v[172:175], v[36:39]
    ds_read_b64_tr_b16 v[150:151], v25 offset:23040
    s_add_u32 s52, s52, 24576
    s_cmp_eq_u32 s52, 147456
    v_mfma_f32_16x16x32_bf16 v[40:43], v[128:131], v[176:179], v[40:43]
    s_cselect_b32 s52, 0, s52
    s_barrier
    v_mfma_f32_16x16x32_bf16 v[44:47], v[128:131], v[180:183], v[44:47]
    v_add_u32 v24, s52, v26
    v_add_u32 v25, s52, v27
    s_waitcnt lgkmcnt(8)
    v_mfma_f32_16x16x32_bf16 v[48:51], v[132:135], v[168:171], v[48:51]
    ds_read_b64_tr_b16 v[128:129], v24 offset:0
    v_mfma_f32_16x16x32_bf16 v[52:55], v[132:135], v[172:175], v[52:55]
    ds_read_b64_tr_b16 v[130:131], v24 offset:512
    v_mfma_f32_16x16x32_bf16 v[56:59], v[132:135], v[176:179], v[56:59]
    buffer_load_dwordx4 v[152:155], v6, s[16:19], s51 offen offset:2048 sc1
    v_mfma_f32_16x16x32_bf16 v[60:63], v[132:135], v[180:183], v[60:63]
    s_waitcnt lgkmcnt(8)
    v_mfma_f32_16x16x32_bf16 v[64:67], v[136:139], v[168:171], v[64:67]
    ds_read_b64_tr_b16 v[132:133], v25 offset:0
    v_mfma_f32_16x16x32_bf16 v[68:71], v[136:139], v[172:175], v[68:71]
    ds_read_b64_tr_b16 v[134:135], v25 offset:512
    v_mfma_f32_16x16x32_bf16 v[72:75], v[136:139], v[176:179], v[72:75]
    buffer_load_dwordx4 v[156:159], v6, s[16:19], s51 offen offset:2304 sc1
    v_mfma_f32_16x16x32_bf16 v[76:79], v[136:139], v[180:183], v[76:79]
    s_waitcnt lgkmcnt(8)
    v_mfma_f32_16x16x32_bf16 v[80:83], v[140:143], v[168:171], v[80:83]
    ds_read_b64_tr_b16 v[136:137], v24 offset:8192
    v_mfma_f32_16x16x32_bf16 v[84:87], v[140:143], v[172:175], v[84:87]
    ds_read_b64_tr_b16 v[138:139], v24 offset:8704
    v_mfma_f32_16x16x32_bf16 v[88:91], v[140:143], v[176:179], v[88:91]
    buffer_load_dwordx4 v[160:163], v6, s[20:23], s51 offen offset:2048 sc1
    v_mfma_f32_16x16x32_bf16 v[92:95], v[140:143], v[180:183], v[92:95]
    s_waitcnt lgkmcnt(8)
    v_mfma_f32_16x16x32_bf16 v[96:99], v[168:171], v[144:147], v[96:99]
    ds_read_b64_tr_b16 v[140:141], v25 offset:8192
    v_mfma_f32_16x16x32_bf16 v[100:103], v[172:175], v[144:147], v[100:103]
    ds_read_b64_tr_b16 v[142:143], v25 offset:8704
    v_mfma_f32_16x16x32_bf16 v[104:107], v[176:179], v[144:147], v[104:107]
    buffer_load_dwordx4 v[164:167], v6, s[20:23], s51 offen offset:2304 sc1
    v_mfma_f32_16x16x32_bf16 v[108:111], v[180:183], v[144:147], v[108:111]
    s_waitcnt lgkmcnt(8)
    v_mfma_f32_16x16x32_bf16 v[112:115], v[168:171], v[148:151], v[112:115]
    ds_read_b64_tr_b16 v[144:145], v24 offset:16384
    s_add_u32 s50, s50, 8192
    v_mfma_f32_16x16x32_bf16 v[116:119], v[172:175], v[148:151], v[116:119]
    ds_read_b64_tr_b16 v[146:147], v24 offset:16896
    s_add_u32 s51, s51, 8192
    v_mfma_f32_16x16x32_bf16 v[120:123], v[176:179], v[148:151], v[120:123]
    s_sub_u32 s54, s54, 1
    v_mfma_f32_16x16x32_bf16 v[124:127], v[180:183], v[148:151], v[124:127]
    s_cmp_lg_u32 s54, 0
    s_cbranch_scc1 c_qkvb_loop
    v_and_b32 v8, 0x30, v1
    v_add_u32 v8, 155648, v8
    v_lshlrev_b32 v9, 2, v4
    v_add_u32 v9, 155648, v9
    v_lshl_add_u32 v12, v2, 8, v9
    v_lshl_add_u32 v13, v2, 8, v8
    ds_read_b32 v200, v12 offset:1280
    ds_read_b32 v208, v12 offset:2304
    ds_read_b32 v202, v12 offset:1344
    ds_read_b32 v210, v12 offset:2368
    ds_read_b32 v204, v12 offset:1408
    ds_read_b32 v212, v12 offset:2432
    ds_read_b32 v206, v12 offset:1472
    ds_read_b32 v214, v12 offset:2496
    ds_read_b128 v[192:195], v8 offset:896
    ds_read_b128 v[196:199], v8 offset:960
    ds_read_b128 v[184:187], v8 offset:768
    ds_read_b128 v[188:191], v8 offset:832
    ds_read_b32 v216, v9 offset:1024
    ds_read_b32 v218, v9 offset:1088
    s_lshr_b32 s3, s8, 1
    s_lshl_b32 s3, s3, 14
    s_and_b32 s55, s8, 1
    s_lshl_b32 s55, s55, 12
    s_add_u32 s3, s3, s55
    s_add_u32 s3, s3, 81920
    v_lshl_add_u32 v10, v3, 5, v4
    v_lshlrev_b32 v10, 4, v10
    v_lshl_add_u32 v10, v7, 10, v10
    v_add_u32 v10, s3, v10
    v_add_u32 v11, s3, v5
    s_waitcnt vmcnt(0) lgkmcnt(4)
    ds_read_b128 v[128:131], v13 offset:1280
    ds_read_b128 v[144:147], v13 offset:2304
    ds_read_b128 v[132:135], v13 offset:1344
    ds_read_b128 v[148:151], v13 offset:2368
    ds_read_b128 v[136:139], v13 offset:1408
    ds_read_b128 v[152:155], v13 offset:2432
    ds_read_b128 v[140:143], v13 offset:1472
    ds_read_b128 v[156:159], v13 offset:2496
    v_pk_fma_f32 v[64:65], v[200:201], v[192:193], v[64:65] op_sel_hi:[0,1,1] neg_lo:[1,0,0] neg_hi:[1,0,0]
    v_pk_fma_f32 v[66:67], v[200:201], v[194:195], v[66:67] op_sel_hi:[0,1,1] neg_lo:[1,0,0] neg_hi:[1,0,0]
    v_pk_mul_f32 v[64:65], v[208:209], v[64:65] op_sel_hi:[0,1]
    v_pk_mul_f32 v[66:67], v[208:209], v[66:67] op_sel_hi:[0,1]
    v_pk_fma_f32 v[80:81], v[200:201], v[196:197], v[80:81] op_sel_hi:[0,1,1] neg_lo:[1,0,0] neg_hi:[1,0,0]
    v_pk_fma_f32 v[82:83], v[200:201], v[198:199], v[82:83] op_sel_hi:[0,1,1] neg_lo:[1,0,0] neg_hi:[1,0,0]
    v_pk_mul_f32 v[80:81], v[208:209], v[80:81] op_sel_hi:[0,1]
    v_pk_mul_f32 v[82:83], v[208:209], v[82:83] op_sel_hi:[0,1]
    v_cvt_pk_bf16_f32 v64, v64, v65
    v_cvt_pk_bf16_f32 v65, v66, v67
    v_cvt_pk_bf16_f32 v66, v80, v81
    v_cvt_pk_bf16_f32 v67, v82, v83
    ds_write_b128 v10, v[64:67] offset:0
    v_pk_fma_f32 v[68:69], v[202:203], v[192:193], v[68:69] op_sel_hi:[0,1,1] neg_lo:[1,0,0] neg_hi:[1,0,0]
    v_pk_fma_f32 v[70:71], v[202:203], v[194:195], v[70:71] op_sel_hi:[0,1,1] neg_lo:[1,0,0] neg_hi:[1,0,0]
    v_pk_mul_f32 v[68:69], v[210:211], v[68:69] op_sel_hi:[0,1]
    v_pk_mul_f32 v[70:71], v[210:211], v[70:71] op_sel_hi:[0,1]
    v_pk_fma_f32 v[84:85], v[202:203], v[196:197], v[84:85] op_sel_hi:[0,1,1] neg_lo:[1,0,0] neg_hi:[1,0,0]
    v_pk_fma_f32 v[86:87], v[202:203], v[198:199], v[86:87] op_sel_hi:[0,1,1] neg_lo:[1,0,0] neg_hi:[1,0,0]
    v_pk_mul_f32 v[84:85], v[210:211], v[84:85] op_sel_hi:[0,1]
    v_pk_mul_f32 v[86:87], v[210:211], v[86:87] op_sel_hi:[0,1]
    v_cvt_pk_bf16_f32 v68, v68, v69
    v_cvt_pk_bf16_f32 v69, v70, v71
    v_cvt_pk_bf16_f32 v70, v84, v85
    v_cvt_pk_bf16_f32 v71, v86, v87
    ds_write_b128 v10, v[68:71] offset:256
    v_pk_fma_f32 v[72:73], v[204:205], v[192:193], v[72:73] op_sel_hi:[0,1,1] neg_lo:[1,0,0] neg_hi:[1,0,0]
    v_pk_fma_f32 v[74:75], v[204:205], v[194:195], v[74:75] op_sel_hi:[0,1,1] neg_lo:[1,0,0] neg_hi:[1,0,0]
    v_pk_mul_f32 v[72:73], v[212:213], v[72:73] op_sel_hi:[0,1]
    v_pk_mul_f32 v[74:75], v[212:213], v[74:75] op_sel_hi:[0,1]
    v_pk_fma_f32 v[88:89], v[204:205], v[196:197], v[88:89] op_sel_hi:[0,1,1] neg_lo:[1,0,0] neg_hi:[1,0,0]
    v_pk_fma_f32 v[90:91], v[204:205], v[198:199], v[90:91] op_sel_hi:[0,1,1] neg_lo:[1,0,0] neg_hi:[1,0,0]
    v_pk_mul_f32 v[88:89], v[212:213], v[88:89] op_sel_hi:[0,1]
    v_pk_mul_f32 v[90:91], v[212:213], v[90:91] op_sel_hi:[0,1]
    v_cvt_pk_bf16_f32 v72, v72, v73
    v_cvt_pk_bf16_f32 v73, v74, v75
    v_cvt_pk_bf16_f32 v74, v88, v89
    v_cvt_pk_bf16_f32 v75, v90, v91
    ds_write_b128 v10, v[72:75] offset:2048
    v_pk_fma_f32 v[76:77], v[206:207], v[192:193], v[76:77] op_sel_hi:[0,1,1] neg_lo:[1,0,0] neg_hi:[1,0,0]
    v_pk_fma_f32 v[78:79], v[206:207], v[194:195], v[78:79] op_sel_hi:[0,1,1] neg_lo:[1,0,0] neg_hi:[1,0,0]
    v_pk_mul_f32 v[76:77], v[214:215], v[76:77] op_sel_hi:[0,1]
    v_pk_mul_f32 v[78:79], v[214:215], v[78:79] op_sel_hi:[0,1]
    v_pk_fma_f32 v[92:93], v[206:207], v[196:197], v[92:93] op_sel_hi:[0,1,1] neg_lo:[1,0,0] neg_hi:[1,0,0]
    v_pk_fma_f32 v[94:95], v[206:207], v[198:199], v[94:95] op_sel_hi:[0,1,1] neg_lo:[1,0,0] neg_hi:[1,0,0]
    v_pk_mul_f32 v[92:93], v[214:215], v[92:93] op_sel_hi:[0,1]
    v_pk_mul_f32 v[94:95], v[214:215], v[94:95] op_sel_hi:[0,1]
    v_cvt_pk_bf16_f32 v76, v76, v77
    v_cvt_pk_bf16_f32 v77, v78, v79
    v_cvt_pk_bf16_f32 v78, v92, v93
    v_cvt_pk_bf16_f32 v79, v94, v95
    ds_write_b128 v10, v[76:79] offset:2304
    s_waitcnt lgkmcnt(4)
    v_pk_fma_f32 v[96:97], v[128:129], v[216:217], v[96:97] op_sel_hi:[1,0,1] neg_lo:[1,0,0] neg_hi:[1,0,0]
    v_pk_fma_f32 v[98:99], v[130:131], v[216:217], v[98:99] op_sel_hi:[1,0,1] neg_lo:[1,0,0] neg_hi:[1,0,0]
    v_pk_mul_f32 v[96:97], v[144:145], v[96:97]
    v_pk_mul_f32 v[98:99], v[146:147], v[98:99]
    v_pk_fma_f32 v[112:113], v[128:129], v[218:219], v[112:113] op_sel_hi:[1,0,1] neg_lo:[1,0,0] neg_hi:[1,0,0]
    v_pk_fma_f32 v[114:115], v[130:131], v[218:219], v[114:115] op_sel_hi:[1,0,1] neg_lo:[1,0,0] neg_hi:[1,0,0]
    v_pk_mul_f32 v[112:113], v[144:145], v[112:113]
    v_pk_mul_f32 v[114:115], v[146:147], v[114:115]
    v_cvt_pk_bf16_f32 v96, v96, v97
    v_cvt_pk_bf16_f32 v97, v98, v99
    v_cvt_pk_bf16_f32 v98, v112, v113
    v_cvt_pk_bf16_f32 v99, v114, v115
    s_nop 0
    v_permlane16_swap_b32 v96, v98
    v_permlane16_swap_b32 v97, v99
    ds_write_b128 v11, v[96:99] offset:8192
    v_pk_fma_f32 v[100:101], v[132:133], v[216:217], v[100:101] op_sel_hi:[1,0,1] neg_lo:[1,0,0] neg_hi:[1,0,0]
    v_pk_fma_f32 v[102:103], v[134:135], v[216:217], v[102:103] op_sel_hi:[1,0,1] neg_lo:[1,0,0] neg_hi:[1,0,0]
    v_pk_mul_f32 v[100:101], v[148:149], v[100:101]
    v_pk_mul_f32 v[102:103], v[150:151], v[102:103]
    v_pk_fma_f32 v[116:117], v[132:133], v[218:219], v[116:117] op_sel_hi:[1,0,1] neg_lo:[1,0,0] neg_hi:[1,0,0]
    v_pk_fma_f32 v[118:119], v[134:135], v[218:219], v[118:119] op_sel_hi:[1,0,1] neg_lo:[1,0,0] neg_hi:[1,0,0]
    v_pk_mul_f32 v[116:117], v[148:149], v[116:117]
    v_pk_mul_f32 v[118:119], v[150:151], v[118:119]
    v_cvt_pk_bf16_f32 v100, v100, v101
    v_cvt_pk_bf16_f32 v101, v102, v103
    v_cvt_pk_bf16_f32 v102, v116, v117
    v_cvt_pk_bf16_f32 v103, v118, v119
    s_nop 0
    v_permlane16_swap_b32 v100, v102
    v_permlane16_swap_b32 v101, v103
    ds_write_b128 v11, v[100:103] offset:9216
    v_pk_fma_f32 v[104:105], v[136:137], v[216:217], v[104:105] op_sel_hi:[1,0,1] neg_lo:[1,0,0] neg_hi:[1,0,0]
    v_pk_fma_f32 v[106:107], v[138:139], v[216:217], v[106:107] op_sel_hi:[1,0,1] neg_lo:[1,0,0] neg_hi:[1,0,0]
    v_pk_mul_f32 v[104:105], v[152:153], v[104:105]
    v_pk_mul_f32 v[106:107], v[154:155], v[106:107]
    v_pk_fma_f32 v[120:121], v[136:137], v[218:219], v[120:121] op_sel_hi:[1,0,1] neg_lo:[1,0,0] neg_hi:[1,0,0]
    v_pk_fma_f32 v[122:123], v[138:139], v[218:219], v[122:123] op_sel_hi:[1,0,1] neg_lo:[1,0,0] neg_hi:[1,0,0]
    v_pk_mul_f32 v[120:121], v[152:153], v[120:121]
    v_pk_mul_f32 v[122:123], v[154:155], v[122:123]
    v_cvt_pk_bf16_f32 v104, v104, v105
    v_cvt_pk_bf16_f32 v105, v106, v107
    v_cvt_pk_bf16_f32 v106, v120, v121
    v_cvt_pk_bf16_f32 v107, v122, v123
    s_nop 0
    v_permlane16_swap_b32 v104, v106
    v_permlane16_swap_b32 v105, v107
    ds_write_b128 v11, v[104:107] offset:10240
    v_pk_fma_f32 v[108:109], v[140:141], v[216:217], v[108:109] op_sel_hi:[1,0,1] neg_lo:[1,0,0] neg_hi:[1,0,0]
    v_pk_fma_f32 v[110:111], v[142:143], v[216:217], v[110:111] op_sel_hi:[1,0,1] neg_lo:[1,0,0] neg_hi:[1,0,0]
    v_pk_mul_f32 v[108:109], v[156:157], v[108:109]
    v_pk_mul_f32 v[110:111], v[158:159], v[110:111]
    v_pk_fma_f32 v[124:125], v[140:141], v[218:219], v[124:125] op_sel_hi:[1,0,1] neg_lo:[1,0,0] neg_hi:[1,0,0]
    v_pk_fma_f32 v[126:127], v[142:143], v[218:219], v[126:127] op_sel_hi:[1,0,1] neg_lo:[1,0,0] neg_hi:[1,0,0]
    v_pk_mul_f32 v[124:125], v[156:157], v[124:125]
    v_pk_mul_f32 v[126:127], v[158:159], v[126:127]
    v_cvt_pk_bf16_f32 v108, v108, v109
    v_cvt_pk_bf16_f32 v109, v110, v111
    v_cvt_pk_bf16_f32 v110, v124, v125
    v_cvt_pk_bf16_f32 v111, v126, v127
    s_nop 0
    v_permlane16_swap_b32 v108, v110
    v_permlane16_swap_b32 v109, v111
    ds_write_b128 v11, v[108:111] offset:11264
    v_mul_f32 v208, 0x3e8293ee, v208
    v_mul_f32 v210, 0x3e8293ee, v210
    v_mul_f32 v212, 0x3e8293ee, v212
    v_mul_f32 v214, 0x3e8293ee, v214
    s_waitcnt lgkmcnt(0)
    s_barrier
    v_add_u32 v24, 81920, v5
    ds_read_b128 v[128:131], v24 offset:0
    ds_read_b128 v[132:135], v24 offset:1024
    ds_read_b128 v[136:139], v24 offset:2048
    ds_read_b128 v[140:143], v24 offset:3072
    v_pk_fma_f32 v[32:33], v[200:201], v[184:185], v[32:33] op_sel_hi:[0,1,1] neg_lo:[1,0,0] neg_hi:[1,0,0]
    v_pk_fma_f32 v[34:35], v[200:201], v[186:187], v[34:35] op_sel_hi:[0,1,1] neg_lo:[1,0,0] neg_hi:[1,0,0]
    v_pk_mul_f32 v[32:33], v[208:209], v[32:33] op_sel_hi:[0,1]
    v_pk_mul_f32 v[34:35], v[208:209], v[34:35] op_sel_hi:[0,1]
    v_pk_fma_f32 v[48:49], v[200:201], v[188:189], v[48:49] op_sel_hi:[0,1,1] neg_lo:[1,0,0] neg_hi:[1,0,0]
    v_pk_fma_f32 v[50:51], v[200:201], v[190:191], v[50:51] op_sel_hi:[0,1,1] neg_lo:[1,0,0] neg_hi:[1,0,0]
    v_pk_mul_f32 v[48:49], v[208:209], v[48:49] op_sel_hi:[0,1]
    v_pk_mul_f32 v[50:51], v[208:209], v[50:51] op_sel_hi:[0,1]
    v_cvt_pk_bf16_f32 v8, v32, v33
    v_cvt_pk_bf16_f32 v9, v34, v35
    v_cvt_pk_bf16_f32 v10, v48, v49
    v_cvt_pk_bf16_f32 v11, v50, v51
    v_pk_fma_f32 v[36:37], v[202:203], v[184:185], v[36:37] op_sel_hi:[0,1,1] neg_lo:[1,0,0] neg_hi:[1,0,0]
    v_pk_fma_f32 v[38:39], v[202:203], v[186:187], v[38:39] op_sel_hi:[0,1,1] neg_lo:[1,0,0] neg_hi:[1,0,0]
    v_pk_mul_f32 v[36:37], v[210:211], v[36:37] op_sel_hi:[0,1]
    v_pk_mul_f32 v[38:39], v[210:211], v[38:39] op_sel_hi:[0,1]
    v_pk_fma_f32 v[52:53], v[202:203], v[188:189], v[52:53] op_sel_hi:[0,1,1] neg_lo:[1,0,0] neg_hi:[1,0,0]
    v_pk_fma_f32 v[54:55], v[202:203], v[190:191], v[54:55] op_sel_hi:[0,1,1] neg_lo:[1,0,0] neg_hi:[1,0,0]
    v_pk_mul_f32 v[52:53], v[210:211], v[52:53] op_sel_hi:[0,1]
    v_pk_mul_f32 v[54:55], v[210:211], v[54:55] op_sel_hi:[0,1]
    v_cvt_pk_bf16_f32 v12, v36, v37
    v_cvt_pk_bf16_f32 v13, v38, v39
    v_cvt_pk_bf16_f32 v14, v52, v53
    v_cvt_pk_bf16_f32 v15, v54, v55
    v_pk_fma_f32 v[40:41], v[204:205], v[184:185], v[40:41] op_sel_hi:[0,1,1] neg_lo:[1,0,0] neg_hi:[1,0,0]
    v_pk_fma_f32 v[42:43], v[204:205], v[186:187], v[42:43] op_sel_hi:[0,1,1] neg_lo:[1,0,0] neg_hi:[1,0,0]
    v_pk_mul_f32 v[40:41], v[212:213], v[40:41] op_sel_hi:[0,1]
    v_pk_mul_f32 v[42:43], v[212:213], v[42:43] op_sel_hi:[0,1]
    v_pk_fma_f32 v[56:57], v[204:205], v[188:189], v[56:57] op_sel_hi:[0,1,1] neg_lo:[1,0,0] neg_hi:[1,0,0]
    v_pk_fma_f32 v[58:59], v[204:205], v[190:191], v[58:59] op_sel_hi:[0,1,1] neg_lo:[1,0,0] neg_hi:[1,0,0]
    v_pk_mul_f32 v[56:57], v[212:213], v[56:57] op_sel_hi:[0,1]
    v_pk_mul_f32 v[58:59], v[212:213], v[58:59] op_sel_hi:[0,1]
    v_cvt_pk_bf16_f32 v16, v40, v41
    v_cvt_pk_bf16_f32 v17, v42, v43
    v_cvt_pk_bf16_f32 v18, v56, v57
    v_cvt_pk_bf16_f32 v19, v58, v59
    v_pk_fma_f32 v[44:45], v[206:207], v[184:185], v[44:45] op_sel_hi:[0,1,1] neg_lo:[1,0,0] neg_hi:[1,0,0]
    v_pk_fma_f32 v[46:47], v[206:207], v[186:187], v[46:47] op_sel_hi:[0,1,1] neg_lo:[1,0,0] neg_hi:[1,0,0]
    v_pk_mul_f32 v[44:45], v[214:215], v[44:45] op_sel_hi:[0,1]
    v_pk_mul_f32 v[46:47], v[214:215], v[46:47] op_sel_hi:[0,1]
    v_pk_fma_f32 v[60:61], v[206:207], v[188:189], v[60:61] op_sel_hi:[0,1,1] neg_lo:[1,0,0] neg_hi:[1,0,0]
    v_pk_fma_f32 v[62:63], v[206:207], v[190:191], v[62:63] op_sel_hi:[0,1,1] neg_lo:[1,0,0] neg_hi:[1,0,0]
    v_pk_mul_f32 v[60:61], v[214:215], v[60:61] op_sel_hi:[0,1]
    v_pk_mul_f32 v[62:63], v[214:215], v[62:63] op_sel_hi:[0,1]
    v_cvt_pk_bf16_f32 v20, v44, v45
    v_cvt_pk_bf16_f32 v21, v46, v47
    v_cvt_pk_bf16_f32 v22, v60, v61
    v_cvt_pk_bf16_f32 v23, v62, v63
    v_permlane16_swap_b32 v8, v12
    v_permlane16_swap_b32 v9, v13
    v_permlane16_swap_b32 v10, v14
    v_permlane16_swap_b32 v11, v15
    v_permlane16_swap_b32 v16, v20
    v_permlane16_swap_b32 v17, v21
    v_permlane16_swap_b32 v18, v22
    v_permlane16_swap_b32 v19, v23
    s_waitcnt lgkmcnt(0)
    v_mfma_f32_32x32x16_bf16 v[64:79], v[128:131], v[8:11], 0
    v_mfma_f32_32x32x16_bf16 v[64:79], v[132:135], v[12:15], v[64:79]
    v_and_b32 v28, 7, v1
    v_mov_b32 v29, 0x3f803f80
    v_cmp_eq_u32 vcc, 0, v28
    s_nop 1
    v_cndmask_b32 v200, 0, v29, vcc
    v_cndmask_b32 v201, 0, v29, vcc
    v_cmp_eq_u32 vcc, 4, v28
    s_nop 1
    v_cndmask_b32 v202, 0, v29, vcc
    v_cndmask_b32 v203, 0, v29, vcc
    v_mov_b32 v204, 0xdddddddd
    v_mov_b32 v160, 0
    v_mov_b32 v161, 0
    v_mov_b32 v162, 0
    v_mov_b32 v163, 0
    v_mov_b32 v164, 0
    v_mov_b32 v165, 0
    v_mov_b32 v166, 0
    v_mov_b32 v167, 0
    v_mov_b32 v168, 0
    v_mov_b32 v169, 0
    v_mov_b32 v170, 0
    v_mov_b32 v171, 0
    v_mov_b32 v172, 0
    v_mov_b32 v173, 0
    v_mov_b32 v174, 0
    v_mov_b32 v175, 0
    v_mov_b32 v192, 0
    v_mov_b32 v193, 0
    v_mov_b32 v194, 0
    v_mov_b32 v195, 0
    v_mov_b32 v176, 0
    v_mov_b32 v177, 0
    v_mov_b32 v178, 0
    v_mov_b32 v179, 0
    v_mov_b32 v180, 0
    v_mov_b32 v181, 0
    v_mov_b32 v182, 0
    v_mov_b32 v183, 0
    v_mov_b32 v184, 0
    v_mov_b32 v185, 0
    v_mov_b32 v186, 0
    v_mov_b32 v187, 0
    v_mov_b32 v188, 0
    v_mov_b32 v189, 0
    v_mov_b32 v190, 0
    v_mov_b32 v191, 0
    v_mov_b32 v196, 0
    v_mov_b32 v197, 0
    v_mov_b32 v198, 0
    v_mov_b32 v199, 0
    v_mov_b32 v112, 0
    v_mov_b32 v113, 0
    v_mov_b32 v114, 0
    v_mov_b32 v115, 0
    v_mov_b32 v116, 0
    v_mov_b32 v117, 0
    v_mov_b32 v118, 0
    v_mov_b32 v119, 0
    v_mov_b32 v120, 0
    v_mov_b32 v121, 0
    v_mov_b32 v122, 0
    v_mov_b32 v123, 0
    v_mov_b32 v124, 0
    v_mov_b32 v125, 0
    v_mov_b32 v126, 0
    v_mov_b32 v127, 0
    v_mov_b32 v152, 0
    v_mov_b32 v153, 0
    v_mov_b32 v154, 0
    v_mov_b32 v155, 0
    v_mov_b32 v156, 0
    v_mov_b32 v157, 0
    v_mov_b32 v158, 0
    v_mov_b32 v159, 0
    s_mov_b32 s54, 4
.p2align 3
c_attn_loop:
    v_mfma_f32_32x32x16_bf16 v[80:95], v[128:131], v[16:19], 0
    v_exp_f32 v64, v64
    v_exp_f32 v65, v65
    v_exp_f32 v66, v66
    v_mfma_f32_32x32x16_bf16 v[80:95], v[132:135], v[20:23], v[80:95]
    v_exp_f32 v67, v67
    v_exp_f32 v68, v68
    v_exp_f32 v69, v69
    v_smfmac_f32_32x32x32_bf16 v[176:191], v[152:155], v[112:119], v204
    s_waitcnt lgkmcnt(0)
    v_exp_f32 v70, v70
    v_exp_f32 v71, v71
    v_exp_f32 v72, v72
    v_smfmac_f32_16x16x64_bf16 v[196:199], v[200:203], v[112:119], v204
    ds_read_b128 v[144:147], v24 offset:8192
    v_exp_f32 v73, v73
    v_exp_f32 v74, v74
    v_smfmac_f32_32x32x32_bf16 v[176:191], v[156:159], v[120:127], v204
    v_exp_f32 v75, v75
    v_exp_f32 v76, v76
    v_exp_f32 v77, v77
    v_smfmac_f32_16x16x64_bf16 v[196:199], v[200:203], v[120:127], v204
    ds_read_b128 v[148:151], v24 offset:9216
    v_exp_f32 v78, v78
    v_exp_f32 v79, v79
    v_mfma_f32_32x32x16_bf16 v[96:111], v[136:139], v[8:11], 0
    v_exp_f32 v80, v80
    v_exp_f32 v81, v81
    v_exp_f32 v82, v82
    v_mfma_f32_32x32x16_bf16 v[96:111], v[140:143], v[12:15], v[96:111]
    s_waitcnt lgkmcnt(1)
    v_exp_f32 v83, v83
    v_exp_f32 v84, v84
    v_exp_f32 v85, v85
    v_smfmac_f32_32x32x32_bf16 v[160:175], v[144:147], v[64:71], v204
    s_waitcnt lgkmcnt(0)
    v_exp_f32 v86, v86
    v_exp_f32 v87, v87
    v_exp_f32 v88, v88
    v_smfmac_f32_16x16x64_bf16 v[192:195], v[200:203], v[64:71], v204
    ds_read_b128 v[128:131], v24 offset:4096
    v_exp_f32 v89, v89
    v_exp_f32 v90, v90
    v_smfmac_f32_32x32x32_bf16 v[160:175], v[148:151], v[72:79], v204
    v_exp_f32 v91, v91
    v_exp_f32 v92, v92
    v_exp_f32 v93, v93
    v_smfmac_f32_16x16x64_bf16 v[192:195], v[200:203], v[72:79], v204
    ds_read_b128 v[132:135], v24 offset:5120
    v_exp_f32 v94, v94
    v_exp_f32 v95, v95
    v_mfma_f32_32x32x16_bf16 v[112:127], v[136:139], v[16:19], 0
    v_exp_f32 v96, v96
    v_exp_f32 v97, v97
    v_exp_f32 v98, v98
    v_mfma_f32_32x32x16_bf16 v[112:127], v[140:143], v[20:23], v[112:127]
    v_exp_f32 v99, v99
    v_exp_f32 v100, v100
    v_exp_f32 v101, v101
    v_smfmac_f32_32x32x32_bf16 v[176:191], v[144:147], v[80:87], v204
    s_waitcnt lgkmcnt(0)
    v_exp_f32 v102, v102
    v_exp_f32 v103, v103
    v_exp_f32 v104, v104
    v_smfmac_f32_16x16x64_bf16 v[196:199], v[200:203], v[80:87], v204
    ds_read_b128 v[152:155], v24 offset:10240
    v_exp_f32 v105, v105
    v_exp_f32 v106, v106
    v_smfmac_f32_32x32x32_bf16 v[176:191], v[148:151], v[88:95], v204
    v_exp_f32 v107, v107
    v_exp_f32 v108, v108
    v_exp_f32 v109, v109
    v_smfmac_f32_16x16x64_bf16 v[196:199], v[200:203], v[88:95], v204
    ds_read_b128 v[156:159], v24 offset:11264
    v_exp_f32 v110, v110
    v_exp_f32 v111, v111
    v_mfma_f32_32x32x16_bf16 v[64:79], v[128:131], v[8:11], 0
    v_exp_f32 v112, v112
    v_exp_f32 v113, v113
    v_exp_f32 v114, v114
    v_mfma_f32_32x32x16_bf16 v[64:79], v[132:135], v[12:15], v[64:79]
    s_waitcnt lgkmcnt(1)
    v_exp_f32 v115, v115
    v_exp_f32 v116, v116
    v_exp_f32 v117, v117
    v_smfmac_f32_32x32x32_bf16 v[160:175], v[152:155], v[96:103], v204
    s_waitcnt lgkmcnt(0)
    v_exp_f32 v118, v118
    v_exp_f32 v119, v119
    v_exp_f32 v120, v120
    v_smfmac_f32_16x16x64_bf16 v[192:195], v[200:203], v[96:103], v204
    ds_read_b128 v[136:139], v24 offset:6144
    v_exp_f32 v121, v121
    v_exp_f32 v122, v122
    v_smfmac_f32_32x32x32_bf16 v[160:175], v[156:159], v[104:111], v204
    v_exp_f32 v123, v123
    v_exp_f32 v124, v124
    v_exp_f32 v125, v125
    v_smfmac_f32_16x16x64_bf16 v[192:195], v[200:203], v[104:111], v204
    ds_read_b128 v[140:143], v24 offset:7168
    v_exp_f32 v126, v126
    v_exp_f32 v127, v127
    v_mfma_f32_32x32x16_bf16 v[80:95], v[128:131], v[16:19], 0
    s_cmp_eq_u32 s54, 4
    v_exp_f32 v64, v64
    v_exp_f32 v65, v65
    v_exp_f32 v66, v66
    v_mfma_f32_32x32x16_bf16 v[80:95], v[132:135], v[20:23], v[80:95]
    v_exp_f32 v67, v67
    v_exp_f32 v68, v68
    v_exp_f32 v69, v69
    v_smfmac_f32_32x32x32_bf16 v[176:191], v[152:155], v[112:119], v204
    s_waitcnt lgkmcnt(0)
    v_exp_f32 v70, v70
    v_exp_f32 v71, v71
    v_exp_f32 v72, v72
    v_smfmac_f32_16x16x64_bf16 v[196:199], v[200:203], v[112:119], v204
    ds_read_b128 v[144:147], v24 offset:12288
    v_exp_f32 v73, v73
    v_exp_f32 v74, v74
    v_smfmac_f32_32x32x32_bf16 v[176:191], v[156:159], v[120:127], v204
    v_exp_f32 v75, v75
    v_exp_f32 v76, v76
    v_exp_f32 v77, v77
    v_smfmac_f32_16x16x64_bf16 v[196:199], v[200:203], v[120:127], v204
    ds_read_b128 v[148:151], v24 offset:13312
    v_exp_f32 v78, v78
    v_exp_f32 v79, v79
    v_mfma_f32_32x32x16_bf16 v[96:111], v[136:139], v[8:11], 0
    s_cbranch_scc1 c_attn_nobar
    s_barrier
c_attn_nobar:
    v_exp_f32 v80, v80
    v_exp_f32 v81, v81
    v_exp_f32 v82, v82
    v_mfma_f32_32x32x16_bf16 v[96:111], v[140:143], v[12:15], v[96:111]
    s_waitcnt lgkmcnt(1)
    v_exp_f32 v83, v83
    v_exp_f32 v84, v84
    v_exp_f32 v85, v85
    v_smfmac_f32_32x32x32_bf16 v[160:175], v[144:147], v[64:71], v204
    s_waitcnt lgkmcnt(0)
    v_exp_f32 v86, v86
    v_exp_f32 v87, v87
    v_exp_f32 v88, v88
    v_smfmac_f32_16x16x64_bf16 v[192:195], v[200:203], v[64:71], v204
    ds_read_b128 v[128:131], v24 offset:16384
    v_exp_f32 v89, v89
    v_exp_f32 v90, v90
    v_smfmac_f32_32x32x32_bf16 v[160:175], v[148:151], v[72:79], v204
    v_exp_f32 v91, v91
    v_exp_f32 v92, v92
    v_exp_f32 v93, v93
    v_smfmac_f32_16x16x64_bf16 v[192:195], v[200:203], v[72:79], v204
    ds_read_b128 v[132:135], v24 offset:17408
    v_exp_f32 v94, v94
    v_exp_f32 v95, v95
    v_mfma_f32_32x32x16_bf16 v[112:127], v[136:139], v[16:19], 0
    v_exp_f32 v96, v96
    v_exp_f32 v97, v97
    v_exp_f32 v98, v98
    v_mfma_f32_32x32x16_bf16 v[112:127], v[140:143], v[20:23], v[112:127]
    v_exp_f32 v99, v99
    v_exp_f32 v100, v100
    v_exp_f32 v101, v101
    v_smfmac_f32_32x32x32_bf16 v[176:191], v[144:147], v[80:87], v204
    s_waitcnt lgkmcnt(0)
    v_exp_f32 v102, v102
    v_exp_f32 v103, v103
    v_exp_f32 v104, v104
    v_smfmac_f32_16x16x64_bf16 v[196:199], v[200:203], v[80:87], v204
    ds_read_b128 v[152:155], v24 offset:14336
    v_exp_f32 v105, v105
    v_exp_f32 v106, v106
    v_smfmac_f32_32x32x32_bf16 v[176:191], v[148:151], v[88:95], v204
    v_exp_f32 v107, v107
    v_exp_f32 v108, v108
    v_exp_f32 v109, v109
    v_smfmac_f32_16x16x64_bf16 v[196:199], v[200:203], v[88:95], v204
    ds_read_b128 v[156:159], v24 offset:15360
    v_exp_f32 v110, v110
    v_exp_f32 v111, v111
    v_mfma_f32_32x32x16_bf16 v[64:79], v[128:131], v[8:11], 0
    v_exp_f32 v112, v112
    v_exp_f32 v113, v113
    v_exp_f32 v114, v114
    v_mfma_f32_32x32x16_bf16 v[64:79], v[132:135], v[12:15], v[64:79]
    s_waitcnt lgkmcnt(1)
    v_exp_f32 v115, v115
    v_exp_f32 v116, v116
    v_exp_f32 v117, v117
    v_smfmac_f32_32x32x32_bf16 v[160:175], v[152:155], v[96:103], v204
    s_waitcnt lgkmcnt(0)
    v_exp_f32 v118, v118
    v_exp_f32 v119, v119
    v_exp_f32 v120, v120
    v_smfmac_f32_16x16x64_bf16 v[192:195], v[200:203], v[96:103], v204
    ds_read_b128 v[136:139], v24 offset:18432
    v_exp_f32 v121, v121
    v_exp_f32 v122, v122
    v_smfmac_f32_32x32x32_bf16 v[160:175], v[156:159], v[104:111], v204
    v_exp_f32 v123, v123
    v_exp_f32 v124, v124
    v_exp_f32 v125, v125
    v_smfmac_f32_16x16x64_bf16 v[192:195], v[200:203], v[104:111], v204
    ds_read_b128 v[140:143], v24 offset:19456
    v_exp_f32 v126, v126
    v_exp_f32 v127, v127
    v_mfma_f32_32x32x16_bf16 v[80:95], v[128:131], v[16:19], 0
    v_exp_f32 v64, v64
    v_exp_f32 v65, v65
    v_exp_f32 v66, v66
    v_mfma_f32_32x32x16_bf16 v[80:95], v[132:135], v[20:23], v[80:95]
    v_exp_f32 v67, v67
    v_exp_f32 v68, v68
    v_exp_f32 v69, v69
    v_smfmac_f32_32x32x32_bf16 v[176:191], v[152:155], v[112:119], v204
    s_waitcnt lgkmcnt(0)
    v_exp_f32 v70, v70
    v_exp_f32 v71, v71
    v_exp_f32 v72, v72
    v_smfmac_f32_16x16x64_bf16 v[196:199], v[200:203], v[112:119], v204
    ds_read_b128 v[144:147], v24 offset:24576
    v_exp_f32 v73, v73
    v_exp_f32 v74, v74
    v_smfmac_f32_32x32x32_bf16 v[176:191], v[156:159], v[120:127], v204
    v_exp_f32 v75, v75
    v_exp_f32 v76, v76
    v_exp_f32 v77, v77
    v_smfmac_f32_16x16x64_bf16 v[196:199], v[200:203], v[120:127], v204
    ds_read_b128 v[148:151], v24 offset:25600
    v_exp_f32 v78, v78
    v_exp_f32 v79, v79
    v_mfma_f32_32x32x16_bf16 v[96:111], v[136:139], v[8:11], 0
    v_exp_f32 v80, v80
    v_exp_f32 v81, v81
    v_exp_f32 v82, v82
    v_mfma_f32_32x32x16_bf16 v[96:111], v[140:143], v[12:15], v[96:111]
    s_waitcnt lgkmcnt(1)
    v_exp_f32 v83, v83
    v_exp_f32 v84, v84
    v_exp_f32 v85, v85
    v_smfmac_f32_32x32x32_bf16 v[160:175], v[144:147], v[64:71], v204
    s_waitcnt lgkmcnt(0)
    v_exp_f32 v86, v86
    v_exp_f32 v87, v87
    v_exp_f32 v88, v88
    v_smfmac_f32_16x16x64_bf16 v[192:195], v[200:203], v[64:71], v204
    ds_read_b128 v[128:131], v24 offset:20480
    v_exp_f32 v89, v89
    v_exp_f32 v90, v90
    v_smfmac_f32_32x32x32_bf16 v[160:175], v[148:151], v[72:79], v204
    v_exp_f32 v91, v91
    v_exp_f32 v92, v92
    v_exp_f32 v93, v93
    v_smfmac_f32_16x16x64_bf16 v[192:195], v[200:203], v[72:79], v204
    ds_read_b128 v[132:135], v24 offset:21504
    v_exp_f32 v94, v94
    v_exp_f32 v95, v95
    v_mfma_f32_32x32x16_bf16 v[112:127], v[136:139], v[16:19], 0
    v_exp_f32 v96, v96
    v_exp_f32 v97, v97
    v_exp_f32 v98, v98
    v_mfma_f32_32x32x16_bf16 v[112:127], v[140:143], v[20:23], v[112:127]
    v_exp_f32 v99, v99
    v_exp_f32 v100, v100
    v_exp_f32 v101, v101
    v_smfmac_f32_32x32x32_bf16 v[176:191], v[144:147], v[80:87], v204
    s_waitcnt lgkmcnt(0)
    v_exp_f32 v102, v102
    v_exp_f32 v103, v103
    v_exp_f32 v104, v104
    v_smfmac_f32_16x16x64_bf16 v[196:199], v[200:203], v[80:87], v204
    ds_read_b128 v[152:155], v24 offset:26624
    v_exp_f32 v105, v105
    v_exp_f32 v106, v106
    v_smfmac_f32_32x32x32_bf16 v[176:191], v[148:151], v[88:95], v204
    v_exp_f32 v107, v107
    v_exp_f32 v108, v108
    v_exp_f32 v109, v109
    v_smfmac_f32_16x16x64_bf16 v[196:199], v[200:203], v[88:95], v204
    ds_read_b128 v[156:159], v24 offset:27648
    v_exp_f32 v110, v110
    v_exp_f32 v111, v111
    v_mfma_f32_32x32x16_bf16 v[64:79], v[128:131], v[8:11], 0
    v_exp_f32 v112, v112
    v_exp_f32 v113, v113
    v_exp_f32 v114, v114
    v_mfma_f32_32x32x16_bf16 v[64:79], v[132:135], v[12:15], v[64:79]
    s_waitcnt lgkmcnt(1)
    v_exp_f32 v115, v115
    v_exp_f32 v116, v116
    v_exp_f32 v117, v117
    v_smfmac_f32_32x32x32_bf16 v[160:175], v[152:155], v[96:103], v204
    s_waitcnt lgkmcnt(0)
    v_exp_f32 v118, v118
    v_exp_f32 v119, v119
    v_exp_f32 v120, v120
    v_smfmac_f32_16x16x64_bf16 v[192:195], v[200:203], v[96:103], v204
    ds_read_b128 v[136:139], v24 offset:22528
    v_exp_f32 v121, v121
    v_exp_f32 v122, v122
    v_smfmac_f32_32x32x32_bf16 v[160:175], v[156:159], v[104:111], v204
    v_exp_f32 v123, v123
    v_exp_f32 v124, v124
    v_exp_f32 v125, v125
    v_smfmac_f32_16x16x64_bf16 v[192:195], v[200:203], v[104:111], v204
    ds_read_b128 v[140:143], v24 offset:23552
    v_exp_f32 v126, v126
    v_exp_f32 v127, v127
    v_mfma_f32_32x32x16_bf16 v[80:95], v[128:131], v[16:19], 0
    v_exp_f32 v64, v64
    v_exp_f32 v65, v65
    v_exp_f32 v66, v66
    v_mfma_f32_32x32x16_bf16 v[80:95], v[132:135], v[20:23], v[80:95]
    v_exp_f32 v67, v67
    v_exp_f32 v68, v68
    v_exp_f32 v69, v69
    v_smfmac_f32_32x32x32_bf16 v[176:191], v[152:155], v[112:119], v204
    s_waitcnt lgkmcnt(0)
    v_exp_f32 v70, v70
    v_exp_f32 v71, v71
    v_exp_f32 v72, v72
    v_smfmac_f32_16x16x64_bf16 v[196:199], v[200:203], v[112:119], v204
    ds_read_b128 v[144:147], v24 offset:28672
    v_exp_f32 v73, v73
    v_exp_f32 v74, v74
    v_smfmac_f32_32x32x32_bf16 v[176:191], v[156:159], v[120:127], v204
    v_exp_f32 v75, v75
    v_exp_f32 v76, v76
    v_exp_f32 v77, v77
    v_smfmac_f32_16x16x64_bf16 v[196:199], v[200:203], v[120:127], v204
    ds_read_b128 v[148:151], v24 offset:29696
    v_exp_f32 v78, v78
    v_exp_f32 v79, v79
    v_mfma_f32_32x32x16_bf16 v[96:111], v[136:139], v[8:11], 0
    s_barrier
    v_exp_f32 v80, v80
    v_exp_f32 v81, v81
    v_exp_f32 v82, v82
    v_mfma_f32_32x32x16_bf16 v[96:111], v[140:143], v[12:15], v[96:111]
    s_waitcnt lgkmcnt(1)
    v_exp_f32 v83, v83
    v_exp_f32 v84, v84
    v_exp_f32 v85, v85
    v_smfmac_f32_32x32x32_bf16 v[160:175], v[144:147], v[64:71], v204
    s_waitcnt lgkmcnt(0)
    v_exp_f32 v86, v86
    v_exp_f32 v87, v87
    v_exp_f32 v88, v88
    v_smfmac_f32_16x16x64_bf16 v[192:195], v[200:203], v[64:71], v204
    ds_read_b128 v[128:131], v24 offset:32768
    v_exp_f32 v89, v89
    v_exp_f32 v90, v90
    v_smfmac_f32_32x32x32_bf16 v[160:175], v[148:151], v[72:79], v204
    v_exp_f32 v91, v91
    v_exp_f32 v92, v92
    v_exp_f32 v93, v93
    v_smfmac_f32_16x16x64_bf16 v[192:195], v[200:203], v[72:79], v204
    ds_read_b128 v[132:135], v24 offset:33792
    v_exp_f32 v94, v94
    v_exp_f32 v95, v95
    v_mfma_f32_32x32x16_bf16 v[112:127], v[136:139], v[16:19], 0
    v_exp_f32 v96, v96
    v_exp_f32 v97, v97
    v_exp_f32 v98, v98
    v_mfma_f32_32x32x16_bf16 v[112:127], v[140:143], v[20:23], v[112:127]
    v_exp_f32 v99, v99
    v_exp_f32 v100, v100
    v_exp_f32 v101, v101
    v_smfmac_f32_32x32x32_bf16 v[176:191], v[144:147], v[80:87], v204
    s_waitcnt lgkmcnt(0)
    v_exp_f32 v102, v102
    v_exp_f32 v103, v103
    v_exp_f32 v104, v104
    v_smfmac_f32_16x16x64_bf16 v[196:199], v[200:203], v[80:87], v204
    ds_read_b128 v[152:155], v24 offset:30720
    v_exp_f32 v105, v105
    v_exp_f32 v106, v106
    v_smfmac_f32_32x32x32_bf16 v[176:191], v[148:151], v[88:95], v204
    v_exp_f32 v107, v107
    v_exp_f32 v108, v108
    v_exp_f32 v109, v109
    v_smfmac_f32_16x16x64_bf16 v[196:199], v[200:203], v[88:95], v204
    ds_read_b128 v[156:159], v24 offset:31744
    v_exp_f32 v110, v110
    v_exp_f32 v111, v111
    v_mfma_f32_32x32x16_bf16 v[64:79], v[128:131], v[8:11], 0
    v_exp_f32 v112, v112
    v_exp_f32 v113, v113
    v_exp_f32 v114, v114
    v_mfma_f32_32x32x16_bf16 v[64:79], v[132:135], v[12:15], v[64:79]
    s_waitcnt lgkmcnt(1)
    v_exp_f32 v115, v115
    v_exp_f32 v116, v116
    v_exp_f32 v117, v117
    v_smfmac_f32_32x32x32_bf16 v[160:175], v[152:155], v[96:103], v204
    s_waitcnt lgkmcnt(0)
    v_exp_f32 v118, v118
    v_exp_f32 v119, v119
    v_exp_f32 v120, v120
    v_smfmac_f32_16x16x64_bf16 v[192:195], v[200:203], v[96:103], v204
    ds_read_b128 v[136:139], v24 offset:34816
    v_exp_f32 v121, v121
    v_exp_f32 v122, v122
    v_smfmac_f32_32x32x32_bf16 v[160:175], v[156:159], v[104:111], v204
    v_exp_f32 v123, v123
    v_exp_f32 v124, v124
    v_exp_f32 v125, v125
    v_smfmac_f32_16x16x64_bf16 v[192:195], v[200:203], v[104:111], v204
    ds_read_b128 v[140:143], v24 offset:35840
    v_exp_f32 v126, v126
    v_exp_f32 v127, v127
    v_mfma_f32_32x32x16_bf16 v[80:95], v[128:131], v[16:19], 0
    v_exp_f32 v64, v64
    v_exp_f32 v65, v65
    v_exp_f32 v66, v66
    v_mfma_f32_32x32x16_bf16 v[80:95], v[132:135], v[20:23], v[80:95]
    v_exp_f32 v67, v67
    v_exp_f32 v68, v68
    v_exp_f32 v69, v69
    v_smfmac_f32_32x32x32_bf16 v[176:191], v[152:155], v[112:119], v204
    s_waitcnt lgkmcnt(0)
    v_exp_f32 v70, v70
    v_exp_f32 v71, v71
    v_exp_f32 v72, v72
    v_smfmac_f32_16x16x64_bf16 v[196:199], v[200:203], v[112:119], v204
    ds_read_b128 v[144:147], v24 offset:40960
    v_exp_f32 v73, v73
    v_exp_f32 v74, v74
    v_smfmac_f32_32x32x32_bf16 v[176:191], v[156:159], v[120:127], v204
    v_exp_f32 v75, v75
    v_exp_f32 v76, v76
    v_exp_f32 v77, v77
    v_smfmac_f32_16x16x64_bf16 v[196:199], v[200:203], v[120:127], v204
    ds_read_b128 v[148:151], v24 offset:41984
    v_exp_f32 v78, v78
    v_exp_f32 v79, v79
    v_mfma_f32_32x32x16_bf16 v[96:111], v[136:139], v[8:11], 0
    v_exp_f32 v80, v80
    v_exp_f32 v81, v81
    v_exp_f32 v82, v82
    v_mfma_f32_32x32x16_bf16 v[96:111], v[140:143], v[12:15], v[96:111]
    s_waitcnt lgkmcnt(1)
    v_exp_f32 v83, v83
    v_exp_f32 v84, v84
    v_exp_f32 v85, v85
    v_smfmac_f32_32x32x32_bf16 v[160:175], v[144:147], v[64:71], v204
    s_waitcnt lgkmcnt(0)
    v_exp_f32 v86, v86
    v_exp_f32 v87, v87
    v_exp_f32 v88, v88
    v_smfmac_f32_16x16x64_bf16 v[192:195], v[200:203], v[64:71], v204
    ds_read_b128 v[128:131], v24 offset:36864
    v_exp_f32 v89, v89
    v_exp_f32 v90, v90
    v_smfmac_f32_32x32x32_bf16 v[160:175], v[148:151], v[72:79], v204
    v_exp_f32 v91, v91
    v_exp_f32 v92, v92
    v_exp_f32 v93, v93
    v_smfmac_f32_16x16x64_bf16 v[192:195], v[200:203], v[72:79], v204
    ds_read_b128 v[132:135], v24 offset:37888
    v_exp_f32 v94, v94
    v_exp_f32 v95, v95
    v_mfma_f32_32x32x16_bf16 v[112:127], v[136:139], v[16:19], 0
    v_exp_f32 v96, v96
    v_exp_f32 v97, v97
    v_exp_f32 v98, v98
    v_mfma_f32_32x32x16_bf16 v[112:127], v[140:143], v[20:23], v[112:127]
    v_exp_f32 v99, v99
    v_exp_f32 v100, v100
    v_exp_f32 v101, v101
    v_smfmac_f32_32x32x32_bf16 v[176:191], v[144:147], v[80:87], v204
    s_waitcnt lgkmcnt(0)
    v_exp_f32 v102, v102
    v_exp_f32 v103, v103
    v_exp_f32 v104, v104
    v_smfmac_f32_16x16x64_bf16 v[196:199], v[200:203], v[80:87], v204
    ds_read_b128 v[152:155], v24 offset:43008
    v_exp_f32 v105, v105
    v_exp_f32 v106, v106
    v_smfmac_f32_32x32x32_bf16 v[176:191], v[148:151], v[88:95], v204
    v_exp_f32 v107, v107
    v_exp_f32 v108, v108
    v_exp_f32 v109, v109
    v_smfmac_f32_16x16x64_bf16 v[196:199], v[200:203], v[88:95], v204
    ds_read_b128 v[156:159], v24 offset:44032
    v_exp_f32 v110, v110
    v_exp_f32 v111, v111
    v_mfma_f32_32x32x16_bf16 v[64:79], v[128:131], v[8:11], 0
    v_exp_f32 v112, v112
    v_exp_f32 v113, v113
    v_exp_f32 v114, v114
    v_mfma_f32_32x32x16_bf16 v[64:79], v[132:135], v[12:15], v[64:79]
    s_waitcnt lgkmcnt(1)
    v_exp_f32 v115, v115
    v_exp_f32 v116, v116
    v_exp_f32 v117, v117
    v_smfmac_f32_32x32x32_bf16 v[160:175], v[152:155], v[96:103], v204
    s_waitcnt lgkmcnt(0)
    v_exp_f32 v118, v118
    v_exp_f32 v119, v119
    v_exp_f32 v120, v120
    v_smfmac_f32_16x16x64_bf16 v[192:195], v[200:203], v[96:103], v204
    ds_read_b128 v[136:139], v24 offset:38912
    v_exp_f32 v121, v121
    v_exp_f32 v122, v122
    v_smfmac_f32_32x32x32_bf16 v[160:175], v[156:159], v[104:111], v204
    v_exp_f32 v123, v123
    v_exp_f32 v124, v124
    v_exp_f32 v125, v125
    v_smfmac_f32_16x16x64_bf16 v[192:195], v[200:203], v[104:111], v204
    ds_read_b128 v[140:143], v24 offset:39936
    v_exp_f32 v126, v126
    v_exp_f32 v127, v127
    v_mfma_f32_32x32x16_bf16 v[80:95], v[128:131], v[16:19], 0
    v_exp_f32 v64, v64
    v_exp_f32 v65, v65
    v_exp_f32 v66, v66
    v_mfma_f32_32x32x16_bf16 v[80:95], v[132:135], v[20:23], v[80:95]
    v_exp_f32 v67, v67
    v_exp_f32 v68, v68
    v_exp_f32 v69, v69
    v_smfmac_f32_32x32x32_bf16 v[176:191], v[152:155], v[112:119], v204
    s_waitcnt lgkmcnt(0)
    v_exp_f32 v70, v70
    v_exp_f32 v71, v71
    v_exp_f32 v72, v72
    v_smfmac_f32_16x16x64_bf16 v[196:199], v[200:203], v[112:119], v204
    ds_read_b128 v[144:147], v24 offset:45056
    v_exp_f32 v73, v73
    v_exp_f32 v74, v74
    v_smfmac_f32_32x32x32_bf16 v[176:191], v[156:159], v[120:127], v204
    v_exp_f32 v75, v75
    v_exp_f32 v76, v76
    v_exp_f32 v77, v77
    v_smfmac_f32_16x16x64_bf16 v[196:199], v[200:203], v[120:127], v204
    ds_read_b128 v[148:151], v24 offset:46080
    v_exp_f32 v78, v78
    v_exp_f32 v79, v79
    v_mfma_f32_32x32x16_bf16 v[96:111], v[136:139], v[8:11], 0
    s_barrier
    v_exp_f32 v80, v80
    v_exp_f32 v81, v81
    v_exp_f32 v82, v82
    v_mfma_f32_32x32x16_bf16 v[96:111], v[140:143], v[12:15], v[96:111]
    s_waitcnt lgkmcnt(1)
    v_exp_f32 v83, v83
    v_exp_f32 v84, v84
    v_exp_f32 v85, v85
    v_smfmac_f32_32x32x32_bf16 v[160:175], v[144:147], v[64:71], v204
    s_waitcnt lgkmcnt(0)
    v_exp_f32 v86, v86
    v_exp_f32 v87, v87
    v_exp_f32 v88, v88
    v_smfmac_f32_16x16x64_bf16 v[192:195], v[200:203], v[64:71], v204
    ds_read_b128 v[128:131], v24 offset:49152
    v_exp_f32 v89, v89
    v_exp_f32 v90, v90
    v_smfmac_f32_32x32x32_bf16 v[160:175], v[148:151], v[72:79], v204
    v_exp_f32 v91, v91
    v_exp_f32 v92, v92
    v_exp_f32 v93, v93
    v_smfmac_f32_16x16x64_bf16 v[192:195], v[200:203], v[72:79], v204
    ds_read_b128 v[132:135], v24 offset:50176
    v_exp_f32 v94, v94
    v_exp_f32 v95, v95
    v_mfma_f32_32x32x16_bf16 v[112:127], v[136:139], v[16:19], 0
    v_exp_f32 v96, v96
    v_exp_f32 v97, v97
    v_exp_f32 v98, v98
    v_mfma_f32_32x32x16_bf16 v[112:127], v[140:143], v[20:23], v[112:127]
    v_exp_f32 v99, v99
    v_exp_f32 v100, v100
    v_exp_f32 v101, v101
    v_smfmac_f32_32x32x32_bf16 v[176:191], v[144:147], v[80:87], v204
    s_waitcnt lgkmcnt(0)
    v_exp_f32 v102, v102
    v_exp_f32 v103, v103
    v_exp_f32 v104, v104
    v_smfmac_f32_16x16x64_bf16 v[196:199], v[200:203], v[80:87], v204
    ds_read_b128 v[152:155], v24 offset:47104
    v_exp_f32 v105, v105
    v_exp_f32 v106, v106
    v_smfmac_f32_32x32x32_bf16 v[176:191], v[148:151], v[88:95], v204
    v_exp_f32 v107, v107
    v_exp_f32 v108, v108
    v_exp_f32 v109, v109
    v_smfmac_f32_16x16x64_bf16 v[196:199], v[200:203], v[88:95], v204
    ds_read_b128 v[156:159], v24 offset:48128
    v_exp_f32 v110, v110
    v_exp_f32 v111, v111
    v_mfma_f32_32x32x16_bf16 v[64:79], v[128:131], v[8:11], 0
    v_exp_f32 v112, v112
    v_exp_f32 v113, v113
    v_exp_f32 v114, v114
    v_mfma_f32_32x32x16_bf16 v[64:79], v[132:135], v[12:15], v[64:79]
    s_waitcnt lgkmcnt(1)
    v_exp_f32 v115, v115
    v_exp_f32 v116, v116
    v_exp_f32 v117, v117
    v_smfmac_f32_32x32x32_bf16 v[160:175], v[152:155], v[96:103], v204
    s_waitcnt lgkmcnt(0)
    v_exp_f32 v118, v118
    v_exp_f32 v119, v119
    v_exp_f32 v120, v120
    v_smfmac_f32_16x16x64_bf16 v[192:195], v[200:203], v[96:103], v204
    ds_read_b128 v[136:139], v24 offset:51200
    v_exp_f32 v121, v121
    v_exp_f32 v122, v122
    v_smfmac_f32_32x32x32_bf16 v[160:175], v[156:159], v[104:111], v204
    v_exp_f32 v123, v123
    v_exp_f32 v124, v124
    v_exp_f32 v125, v125
    v_smfmac_f32_16x16x64_bf16 v[192:195], v[200:203], v[104:111], v204
    ds_read_b128 v[140:143], v24 offset:52224
    v_exp_f32 v126, v126
    v_exp_f32 v127, v127
    v_mfma_f32_32x32x16_bf16 v[80:95], v[128:131], v[16:19], 0
    v_exp_f32 v64, v64
    v_exp_f32 v65, v65
    v_exp_f32 v66, v66
    v_mfma_f32_32x32x16_bf16 v[80:95], v[132:135], v[20:23], v[80:95]
    v_exp_f32 v67, v67
    v_exp_f32 v68, v68
    v_exp_f32 v69, v69
    v_smfmac_f32_32x32x32_bf16 v[176:191], v[152:155], v[112:119], v204
    s_waitcnt lgkmcnt(0)
    v_exp_f32 v70, v70
    v_exp_f32 v71, v71
    v_exp_f32 v72, v72
    v_smfmac_f32_16x16x64_bf16 v[196:199], v[200:203], v[112:119], v204
    ds_read_b128 v[144:147], v24 offset:57344
    v_exp_f32 v73, v73
    v_exp_f32 v74, v74
    v_smfmac_f32_32x32x32_bf16 v[176:191], v[156:159], v[120:127], v204
    v_exp_f32 v75, v75
    v_exp_f32 v76, v76
    v_exp_f32 v77, v77
    v_smfmac_f32_16x16x64_bf16 v[196:199], v[200:203], v[120:127], v204
    ds_read_b128 v[148:151], v24 offset:58368
    v_exp_f32 v78, v78
    v_exp_f32 v79, v79
    v_mfma_f32_32x32x16_bf16 v[96:111], v[136:139], v[8:11], 0
    v_exp_f32 v80, v80
    v_exp_f32 v81, v81
    v_exp_f32 v82, v82
    v_mfma_f32_32x32x16_bf16 v[96:111], v[140:143], v[12:15], v[96:111]
    s_waitcnt lgkmcnt(1)
    v_exp_f32 v83, v83
    v_exp_f32 v84, v84
    v_exp_f32 v85, v85
    v_smfmac_f32_32x32x32_bf16 v[160:175], v[144:147], v[64:71], v204
    s_waitcnt lgkmcnt(0)
    v_exp_f32 v86, v86
    v_exp_f32 v87, v87
    v_exp_f32 v88, v88
    v_smfmac_f32_16x16x64_bf16 v[192:195], v[200:203], v[64:71], v204
    ds_read_b128 v[128:131], v24 offset:53248
    v_exp_f32 v89, v89
    v_exp_f32 v90, v90
    v_smfmac_f32_32x32x32_bf16 v[160:175], v[148:151], v[72:79], v204
    v_exp_f32 v91, v91
    v_exp_f32 v92, v92
    v_exp_f32 v93, v93
    v_smfmac_f32_16x16x64_bf16 v[192:195], v[200:203], v[72:79], v204
    ds_read_b128 v[132:135], v24 offset:54272
    v_exp_f32 v94, v94
    v_exp_f32 v95, v95
    v_mfma_f32_32x32x16_bf16 v[112:127], v[136:139], v[16:19], 0
    v_exp_f32 v96, v96
    v_exp_f32 v97, v97
    v_exp_f32 v98, v98
    v_mfma_f32_32x32x16_bf16 v[112:127], v[140:143], v[20:23], v[112:127]
    v_exp_f32 v99, v99
    v_exp_f32 v100, v100
    v_exp_f32 v101, v101
    v_smfmac_f32_32x32x32_bf16 v[176:191], v[144:147], v[80:87], v204
    s_waitcnt lgkmcnt(0)
    v_exp_f32 v102, v102
    v_exp_f32 v103, v103
    v_exp_f32 v104, v104
    v_smfmac_f32_16x16x64_bf16 v[196:199], v[200:203], v[80:87], v204
    ds_read_b128 v[152:155], v24 offset:59392
    v_exp_f32 v105, v105
    v_exp_f32 v106, v106
    v_smfmac_f32_32x32x32_bf16 v[176:191], v[148:151], v[88:95], v204
    v_exp_f32 v107, v107
    v_exp_f32 v108, v108
    v_exp_f32 v109, v109
    v_smfmac_f32_16x16x64_bf16 v[196:199], v[200:203], v[88:95], v204
    ds_read_b128 v[156:159], v24 offset:60416
    v_exp_f32 v110, v110
    v_exp_f32 v111, v111
    v_mfma_f32_32x32x16_bf16 v[64:79], v[128:131], v[8:11], 0
    v_exp_f32 v112, v112
    v_exp_f32 v113, v113
    v_exp_f32 v114, v114
    v_mfma_f32_32x32x16_bf16 v[64:79], v[132:135], v[12:15], v[64:79]
    s_waitcnt lgkmcnt(1)
    v_exp_f32 v115, v115
    v_exp_f32 v116, v116
    v_exp_f32 v117, v117
    v_smfmac_f32_32x32x32_bf16 v[160:175], v[152:155], v[96:103], v204
    s_waitcnt lgkmcnt(0)
    v_exp_f32 v118, v118
    v_exp_f32 v119, v119
    v_exp_f32 v120, v120
    v_smfmac_f32_16x16x64_bf16 v[192:195], v[200:203], v[96:103], v204
    ds_read_b128 v[136:139], v24 offset:55296
    v_exp_f32 v121, v121
    v_exp_f32 v122, v122
    v_smfmac_f32_32x32x32_bf16 v[160:175], v[156:159], v[104:111], v204
    v_exp_f32 v123, v123
    v_exp_f32 v124, v124
    v_exp_f32 v125, v125
    v_smfmac_f32_16x16x64_bf16 v[192:195], v[200:203], v[104:111], v204
    ds_read_b128 v[140:143], v24 offset:56320
    v_exp_f32 v126, v126
    v_exp_f32 v127, v127
    v_mfma_f32_32x32x16_bf16 v[80:95], v[128:131], v[16:19], 0
    v_exp_f32 v64, v64
    v_exp_f32 v65, v65
    v_exp_f32 v66, v66
    v_mfma_f32_32x32x16_bf16 v[80:95], v[132:135], v[20:23], v[80:95]
    v_exp_f32 v67, v67
    v_exp_f32 v68, v68
    v_exp_f32 v69, v69
    v_smfmac_f32_32x32x32_bf16 v[176:191], v[152:155], v[112:119], v204
    s_waitcnt lgkmcnt(0)
    v_exp_f32 v70, v70
    v_exp_f32 v71, v71
    v_exp_f32 v72, v72
    v_smfmac_f32_16x16x64_bf16 v[196:199], v[200:203], v[112:119], v204
    ds_read_b128 v[144:147], v24 offset:61440
    v_exp_f32 v73, v73
    v_exp_f32 v74, v74
    v_smfmac_f32_32x32x32_bf16 v[176:191], v[156:159], v[120:127], v204
    v_exp_f32 v75, v75
    v_exp_f32 v76, v76
    v_exp_f32 v77, v77
    v_smfmac_f32_16x16x64_bf16 v[196:199], v[200:203], v[120:127], v204
    ds_read_b128 v[148:151], v24 offset:62464
    v_exp_f32 v78, v78
    v_exp_f32 v79, v79
    v_mfma_f32_32x32x16_bf16 v[96:111], v[136:139], v[8:11], 0
    s_barrier
    v_exp_f32 v80, v80
    v_exp_f32 v81, v81
    v_exp_f32 v82, v82
    v_mfma_f32_32x32x16_bf16 v[96:111], v[140:143], v[12:15], v[96:111]
    s_waitcnt lgkmcnt(1)
    v_exp_f32 v83, v83
    v_exp_f32 v84, v84
    v_exp_f32 v85, v85
    v_smfmac_f32_32x32x32_bf16 v[160:175], v[144:147], v[64:71], v204
    s_waitcnt lgkmcnt(0)
    v_exp_f32 v86, v86
    v_exp_f32 v87, v87
    v_exp_f32 v88, v88
    v_smfmac_f32_16x16x64_bf16 v[192:195], v[200:203], v[64:71], v204
    ds_read_b128 v[128:131], v24 offset:0
    v_exp_f32 v89, v89
    v_exp_f32 v90, v90
    v_smfmac_f32_32x32x32_bf16 v[160:175], v[148:151], v[72:79], v204
    v_exp_f32 v91, v91
    v_exp_f32 v92, v92
    v_exp_f32 v93, v93
    v_smfmac_f32_16x16x64_bf16 v[192:195], v[200:203], v[72:79], v204
    ds_read_b128 v[132:135], v24 offset:1024
    v_exp_f32 v94, v94
    v_exp_f32 v95, v95
    v_mfma_f32_32x32x16_bf16 v[112:127], v[136:139], v[16:19], 0
    v_exp_f32 v96, v96
    v_exp_f32 v97, v97
    v_exp_f32 v98, v98
    v_mfma_f32_32x32x16_bf16 v[112:127], v[140:143], v[20:23], v[112:127]
    v_exp_f32 v99, v99
    v_exp_f32 v100, v100
    v_exp_f32 v101, v101
    v_smfmac_f32_32x32x32_bf16 v[176:191], v[144:147], v[80:87], v204
    s_waitcnt lgkmcnt(0)
    v_exp_f32 v102, v102
    v_exp_f32 v103, v103
    v_exp_f32 v104, v104
    v_smfmac_f32_16x16x64_bf16 v[196:199], v[200:203], v[80:87], v204
    ds_read_b128 v[152:155], v24 offset:63488
    v_exp_f32 v105, v105
    v_exp_f32 v106, v106
    v_smfmac_f32_32x32x32_bf16 v[176:191], v[148:151], v[88:95], v204
    v_exp_f32 v107, v107
    v_exp_f32 v108, v108
    v_exp_f32 v109, v109
    v_smfmac_f32_16x16x64_bf16 v[196:199], v[200:203], v[88:95], v204
    ds_read_b128 v[156:159], v24 offset:64512
    v_exp_f32 v110, v110
    v_exp_f32 v111, v111
    v_mfma_f32_32x32x16_bf16 v[64:79], v[128:131], v[8:11], 0
    s_sub_u32 s54, s54, 1
    v_exp_f32 v112, v112
    v_exp_f32 v113, v113
    v_exp_f32 v114, v114
    v_mfma_f32_32x32x16_bf16 v[64:79], v[132:135], v[12:15], v[64:79]
    s_waitcnt lgkmcnt(1)
    v_exp_f32 v115, v115
    v_exp_f32 v116, v116
    v_exp_f32 v117, v117
    v_smfmac_f32_32x32x32_bf16 v[160:175], v[152:155], v[96:103], v204
    s_waitcnt lgkmcnt(0)
    v_exp_f32 v118, v118
    v_exp_f32 v119, v119
    v_exp_f32 v120, v120
    v_smfmac_f32_16x16x64_bf16 v[192:195], v[200:203], v[96:103], v204
    ds_read_b128 v[136:139], v24 offset:2048
    v_exp_f32 v121, v121
    v_exp_f32 v122, v122
    v_smfmac_f32_32x32x32_bf16 v[160:175], v[156:159], v[104:111], v204
    s_cmp_lg_u32 s54, 0
    v_exp_f32 v123, v123
    v_exp_f32 v124, v124
    v_exp_f32 v125, v125
    v_smfmac_f32_16x16x64_bf16 v[192:195], v[200:203], v[104:111], v204
    ds_read_b128 v[140:143], v24 offset:3072
    v_exp_f32 v126, v126
    v_exp_f32 v127, v127
    s_cbranch_scc1 c_attn_loop
    v_smfmac_f32_16x16x64_bf16 v[196:199], v[200:203], v[112:119], v204
    v_smfmac_f32_16x16x64_bf16 v[196:199], v[200:203], v[120:127], v204
    v_smfmac_f32_32x32x32_bf16 v[176:191], v[152:155], v[112:119], v204
    v_smfmac_f32_32x32x32_bf16 v[176:191], v[156:159], v[120:127], v204
    v_mov_b32 v28, 0x5f000000
    v_mov_b32 v29, 0x2b800000
    v_cmp_lt_f32 s[56:57], v192, v28
    v_cmp_gt_f32 vcc, v192, v29
    s_and_b64 s[56:57], s[56:57], vcc
    s_nop 0
    v_cmp_lt_f32 vcc, v196, v28
    s_and_b64 s[56:57], s[56:57], vcc
    v_cmp_gt_f32 vcc, v196, v29
    s_and_b64 s[56:57], s[56:57], vcc
    s_cmp_lg_u64 s[56:57], -1
    s_cbranch_scc1 c_attn_slow
c_attn_fin:
    s_lshl_b32 s3, s48, 17
    s_lshl_b32 s55, s7, 12
    s_add_u32 s3, s3, s55
    s_and_b32 s55, s6, 1
    s_lshl_b32 s55, s55, 11
    s_add_u32 s3, s3, s55
    s_lshl_b32 s55, s9, 22
    s_add_u32 s3, s3, s55
    s_add_u32 s3, s3, 16777216
    v_rcp_f32 v192, v192
    s_nop 0
    v_pk_mul_f32 v[160:161], v[192:193], v[160:161] op_sel_hi:[0,1]
    v_pk_mul_f32 v[162:163], v[192:193], v[162:163] op_sel_hi:[0,1]
    v_pk_mul_f32 v[164:165], v[192:193], v[164:165] op_sel_hi:[0,1]
    v_pk_mul_f32 v[166:167], v[192:193], v[166:167] op_sel_hi:[0,1]
    v_pk_mul_f32 v[168:169], v[192:193], v[168:169] op_sel_hi:[0,1]
    v_pk_mul_f32 v[170:171], v[192:193], v[170:171] op_sel_hi:[0,1]
    v_pk_mul_f32 v[172:173], v[192:193], v[172:173] op_sel_hi:[0,1]
    v_pk_mul_f32 v[174:175], v[192:193], v[174:175] op_sel_hi:[0,1]
    v_cvt_pk_bf16_f32 v160, v160, v161
    v_cvt_pk_bf16_f32 v161, v162, v163
    v_cvt_pk_bf16_f32 v162, v164, v165
    v_cvt_pk_bf16_f32 v163, v166, v167
    v_cvt_pk_bf16_f32 v164, v168, v169
    v_cvt_pk_bf16_f32 v165, v170, v171
    v_cvt_pk_bf16_f32 v166, v172, v173
    v_cvt_pk_bf16_f32 v167, v174, v175
    buffer_store_dwordx4 v[160:163], v5, s[12:15], s3 offen offset:0 sc1
    buffer_store_dwordx4 v[164:167], v5, s[12:15], s3 offen offset:1024 sc1
    s_add_u32 s3, s3, 65536
    v_rcp_f32 v196, v196
    s_nop 0
    v_pk_mul_f32 v[176:177], v[196:197], v[176:177] op_sel_hi:[0,1]
    v_pk_mul_f32 v[178:179], v[196:197], v[178:179] op_sel_hi:[0,1]
    v_pk_mul_f32 v[180:181], v[196:197], v[180:181] op_sel_hi:[0,1]
    v_pk_mul_f32 v[182:183], v[196:197], v[182:183] op_sel_hi:[0,1]
    v_pk_mul_f32 v[184:185], v[196:197], v[184:185] op_sel_hi:[0,1]
    v_pk_mul_f32 v[186:187], v[196:197], v[186:187] op_sel_hi:[0,1]
    v_pk_mul_f32 v[188:189], v[196:197], v[188:189] op_sel_hi:[0,1]
    v_pk_mul_f32 v[190:191], v[196:197], v[190:191] op_sel_hi:[0,1]
    v_cvt_pk_bf16_f32 v176, v176, v177
    v_cvt_pk_bf16_f32 v177, v178, v179
    v_cvt_pk_bf16_f32 v178, v180, v181
    v_cvt_pk_bf16_f32 v179, v182, v183
    v_cvt_pk_bf16_f32 v180, v184, v185
    v_cvt_pk_bf16_f32 v181, v186, v187
    v_cvt_pk_bf16_f32 v182, v188, v189
    v_cvt_pk_bf16_f32 v183, v190, v191
    buffer_store_dwordx4 v[176:179], v5, s[12:15], s3 offen offset:0 sc1
    buffer_store_dwordx4 v[180:183], v5, s[12:15], s3 offen offset:1024 sc1
    s_add_u32 s3, s3, 65536
    s_mul_i32 s55, s9, 393216
    s_add_u32 s55, s55, 60162048
    v_and_b32 v28, 63, v0
    s_lshr_b32 s56, s11, 5
    s_lshl_b32 s56, s56, 14
    s_add_u32 s55, s55, s56
    s_bfe_u32 s56, s11, 0x20003
    s_and_b32 s57, s11, 7
    v_lshlrev_b32 v28, 9, v28
    s_lshl_b32 s56, s56, 7
    s_lshl_b32 s57, s57, 2
    s_add_u32 s55, s55, s56
    s_add_u32 s55, s55, s57
    v_mov_b32 v29, 158976
    v_mov_b32 v30, 1
    v_mov_b32 v31, s10
    s_mov_b64 exec, 1
    s_waitcnt vmcnt(0)
    ds_add_rtn_u32 v30, v29, v30
    s_waitcnt lgkmcnt(0)
    v_readfirstlane_b32 s56, v30
    s_and_b32 s56, s56, 3
    s_cmp_lg_u32 s56, 3
    s_cbranch_scc1 pub_5
    s_mov_b32 exec_lo, -1
    buffer_store_dword v31, v28, s[12:15], s55 offen sc1
pub_5:
    s_mov_b64 exec, -1
    s_branch c_wo
.p2align 6
h_raw:
    v_and_b32 v1, 63, v0
    s_mov_b32 s16, s46
    s_mov_b32 s17, s47
    s_mov_b32 s18, 256
    s_mov_b32 s19, 0x00020000
    v_mov_b32 v8, 0
    v_mov_b32 v9, 0
    s_memrealtime s[50:51]
    s_cmp_lg_u32 s2, 0
    s_cbranch_scc1 h_raw_nonon
    s_waitcnt lgkmcnt(0)
    s_or_b32 s50, s50, 1
    v_mov_b32 v13, s50
    buffer_store_dword v13, v8, s[16:19], 0 offen sc1
h_raw_nonon:
    buffer_load_dword v13, v8, s[16:19], 0 offen sc1
    v_mov_b32 v10, 158976
    ds_write_b64 v10, v[8:9]
    s_waitcnt lgkmcnt(0)
    s_barrier
    v_lshlrev_b32 v11, 7, v1
    v_and_b32 v12, 15, v1
    v_lshlrev_b32 v12, 4, v12
    v_lshrrev_b32 v17, 4, v1
    v_min_u32 v17, 2, v17
    v_lshl_add_u32 v22, v17, 8, v12
    v_add_u32 v22, 155648, v22
    v_lshl_add_u32 v17, v17, 16, v12
    s_sub_u32 s50, s50, 8000
    s_waitcnt vmcnt(0)
    v_readfirstlane_b32 s10, v13
    s_sub_u32 s51, s10, s50
    s_and_b32 s3, s10, 1
    s_cselect_b32 s51, s51, -1
    s_cmp_ge_i32 s51, 0
    s_cbranch_scc1 h_raw_non_ok
    s_load_dword s10, s[46:47], 0
    s_mov_b32 s58, 0
    s_waitcnt lgkmcnt(0)
h_raw_non:
    s_sub_u32 s51, s10, s50
    s_and_b32 s3, s10, 1
    s_cselect_b32 s51, s51, -1
    s_cmp_ge_i32 s51, 0
    s_cbranch_scc1 h_raw_non_ok
    buffer_load_dword v13, v8, s[16:19], 0 offen sc1
    s_waitcnt vmcnt(0)
    v_readfirstlane_b32 s10, v13
    s_add_u32 s58, s58, 1
    s_cmp_gt_u32 s58, 200
    s_cselect_b32 s50, s10, s50
    s_cmp_lt_u32 s58, 0x20000
    s_cbranch_scc1 h_raw_non
    s_mov_b32 s10, 1
h_raw_non_ok:
    v_mov_b32 v13, s10
    ds_write_b32 v10, v13 offset:4
    s_waitcnt lgkmcnt(0)
    s_barrier
    s_lshl_b32 s50, s2, 13
    s_mov_b32 s28, s36
    s_mov_b32 s29, s37
    s_mov_b32 s30, 2097152
    s_mov_b32 s31, 0x00020000
    s_mov_b32 s49, s50
    buffer_load_dword v21, v11, s[28:31], s49 offen
    s_mov_b32 s9, 0
    v_and_b32 v20, 15, v1
    s_lshl_b32 s51, s6, 2
    s_sub_u32 s51, s51, 1
    s_max_i32 s51, s51, 0
    s_lshl_b32 s50, s51, 16
    s_lshl_b32 s52, s9, 22
    s_add_u32 s50, s50, s52
    s_add_u32 s20, s4, s50
    s_addc_u32 s21, s5, 0
    s_mov_b32 s22, 65536
    s_mov_b32 s23, 0x00020000
    v_bfe_u32 v24, v1, 4, 1
    v_lshl_add_u32 v6, v24, 5, v20
    v_lshlrev_b32 v6, 4, v6
    v_lshrrev_b32 v24, 5, v1
    v_lshl_add_u32 v6, v24, 10, v6
    v_add_u32 v6, 256, v6
    s_sub_u32 s9, s9, 1
    s_mul_i32 s54, s9, 393216
    s_add_u32 s54, s54, 60293120
    s_lshl_b32 s55, s11, 9
    s_add_u32 s54, s54, s55
    s_add_u32 s52, s4, s54
    s_addc_u32 s53, s5, 0
    s_mov_b32 s54, s10
    s_mov_b32 s55, s10
    s_add_u32 s9, s9, 1
    s_mov_b32 s58, 0x20000
poll_6:
    s_load_dwordx8 s[64:71], s[52:53], 0 glc
    s_load_dwordx8 s[72:79], s[52:53], 128 glc
    s_load_dwordx8 s[80:87], s[52:53], 256 glc
    s_load_dwordx8 s[88:95], s[52:53], 384 glc
    s_sub_u32 s58, s58, 1
    s_cbranch_scc1 poll_6_ok
    s_waitcnt lgkmcnt(0)
    s_xor_b64 s[56:57], s[64:65], s[54:55]
    s_xor_b64 s[64:65], s[66:67], s[54:55]
    s_or_b64 s[56:57], s[56:57], s[64:65]
    s_xor_b64 s[64:65], s[68:69], s[54:55]
    s_or_b64 s[56:57], s[56:57], s[64:65]
    s_xor_b64 s[64:65], s[70:71], s[54:55]
    s_or_b64 s[56:57], s[56:57], s[64:65]
    s_xor_b64 s[64:65], s[72:73], s[54:55]
    s_or_b64 s[56:57], s[56:57], s[64:65]
    s_xor_b64 s[64:65], s[74:75], s[54:55]
    s_or_b64 s[56:57], s[56:57], s[64:65]
    s_xor_b64 s[64:65], s[76:77], s[54:55]
    s_or_b64 s[56:57], s[56:57], s[64:65]
    s_xor_b64 s[64:65], s[78:79], s[54:55]
    s_or_b64 s[56:57], s[56:57], s[64:65]
    s_xor_b64 s[64:65], s[80:81], s[54:55]
    s_or_b64 s[56:57], s[56:57], s[64:65]
    s_xor_b64 s[64:65], s[82:83], s[54:55]
    s_or_b64 s[56:57], s[56:57], s[64:65]
    s_xor_b64 s[64:65], s[84:85], s[54:55]
    s_or_b64 s[56:57], s[56:57], s[64:65]
    s_xor_b64 s[64:65], s[86:87], s[54:55]
    s_or_b64 s[56:57], s[56:57], s[64:65]
    s_xor_b64 s[64:65], s[88:89], s[54:55]
    s_or_b64 s[56:57], s[56:57], s[64:65]
    s_xor_b64 s[64:65], s[90:91], s[54:55]
    s_or_b64 s[56:57], s[56:57], s[64:65]
    s_xor_b64 s[64:65], s[92:93], s[54:55]
    s_or_b64 s[56:57], s[56:57], s[64:65]
    s_xor_b64 s[64:65], s[94:95], s[54:55]
    s_or_b64 s[56:57], s[56:57], s[64:65]
    s_cbranch_scc1 poll_6
poll_6_ok:
    s_waitcnt lgkmcnt(0)
    s_mov_b32 m0, 147456
    s_mov_b32 s48, 0
    buffer_load_dwordx4 v6, s[20:23], s48 offen sc1 lds
    s_mov_b32 m0, 148480
    s_mov_b32 s48, 2048
    buffer_load_dwordx4 v6, s[20:23], s48 offen sc1 lds
    s_barrier
    s_mov_b32 m0, 149504
    s_mov_b32 s48, 4096
    buffer_load_dwordx4 v6, s[20:23], s48 offen sc1 lds
    s_mov_b32 m0, 150528
    s_mov_b32 s48, 6144
    buffer_load_dwordx4 v6, s[20:23], s48 offen sc1 lds
    s_mov_b32 m0, 151552
    s_mov_b32 s48, 8192
    buffer_load_dwordx4 v6, s[20:23], s48 offen sc1 lds
    s_mov_b32 m0, 152576
    s_mov_b32 s48, 10240
    buffer_load_dwordx4 v6, s[20:23], s48 offen sc1 lds
    s_waitcnt vmcnt(4)
    s_barrier
    s_waitcnt vmcnt(2)
    s_barrier
    s_mov_b32 m0, 153600
    s_mov_b32 s48, 12288
    buffer_load_dwordx4 v6, s[20:23], s48 offen sc1 lds
    s_mov_b32 m0, 154624
    s_mov_b32 s48, 14336
    buffer_load_dwordx4 v6, s[20:23], s48 offen sc1 lds
    s_waitcnt vmcnt(2)
    s_barrier
    s_mov_b32 m0, 147456
    s_mov_b32 s48, 16384
    buffer_load_dwordx4 v6, s[20:23], s48 offen sc1 lds
    s_mov_b32 m0, 148480
    s_mov_b32 s48, 18432
    buffer_load_dwordx4 v6, s[20:23], s48 offen sc1 lds
    s_waitcnt vmcnt(2)
    s_barrier
    s_mov_b32 m0, 149504
    s_mov_b32 s48, 20480
    buffer_load_dwordx4 v6, s[20:23], s48 offen sc1 lds
    s_mov_b32 m0, 150528
    s_mov_b32 s48, 22528
    buffer_load_dwordx4 v6, s[20:23], s48 offen sc1 lds
    s_waitcnt vmcnt(2)
    s_barrier
    s_mov_b32 m0, 151552
    s_mov_b32 s48, 24576
    buffer_load_dwordx4 v6, s[20:23], s48 offen sc1 lds
    s_mov_b32 m0, 152576
    s_mov_b32 s48, 26624
    buffer_load_dwordx4 v6, s[20:23], s48 offen sc1 lds
    s_waitcnt vmcnt(2)
    s_barrier
    s_mov_b32 m0, 153600
    s_mov_b32 s48, 28672
    buffer_load_dwordx4 v6, s[20:23], s48 offen sc1 lds
    s_mov_b32 m0, 154624
    s_mov_b32 s48, 30720
    buffer_load_dwordx4 v6, s[20:23], s48 offen sc1 lds
    s_waitcnt vmcnt(2)
    s_barrier
    s_mov_b32 m0, 147456
    s_mov_b32 s48, 32768
    buffer_load_dwordx4 v6, s[20:23], s48 offen sc1 lds
    s_mov_b32 m0, 148480
    s_mov_b32 s48, 34816
    buffer_load_dwordx4 v6, s[20:23], s48 offen sc1 lds
    s_lshl_b32 s54, s7, 6
    s_add_u32 s54, s54, 58753024
    s_add_u32 s52, s4, s54
    s_addc_u32 s53, s5, 0
    s_mov_b32 s54, s10
    s_mov_b32 s55, s10
    s_mov_b32 s58, 0x20000
uf_7:
    s_load_dwordx16 s[64:79], s[52:53], 0 glc
    s_load_dwordx16 s[80:95], s[52:53], 1024 glc
    s_sub_u32 s58, s58, 1
    s_cbranch_scc1 uf_7_ok
    s_waitcnt lgkmcnt(0)
    s_xor_b64 s[56:57], s[64:65], s[54:55]
    s_xor_b64 s[64:65], s[66:67], s[54:55]
    s_or_b64 s[56:57], s[56:57], s[64:65]
    s_xor_b64 s[64:65], s[68:69], s[54:55]
    s_or_b64 s[56:57], s[56:57], s[64:65]
    s_xor_b64 s[64:65], s[70:71], s[54:55]
    s_or_b64 s[56:57], s[56:57], s[64:65]
    s_xor_b64 s[64:65], s[72:73], s[54:55]
    s_or_b64 s[56:57], s[56:57], s[64:65]
    s_xor_b64 s[64:65], s[74:75], s[54:55]
    s_or_b64 s[56:57], s[56:57], s[64:65]
    s_xor_b64 s[64:65], s[76:77], s[54:55]
    s_or_b64 s[56:57], s[56:57], s[64:65]
    s_xor_b64 s[64:65], s[78:79], s[54:55]
    s_or_b64 s[56:57], s[56:57], s[64:65]
    s_xor_b64 s[64:65], s[80:81], s[54:55]
    s_or_b64 s[56:57], s[56:57], s[64:65]
    s_xor_b64 s[64:65], s[82:83], s[54:55]
    s_or_b64 s[56:57], s[56:57], s[64:65]
    s_xor_b64 s[64:65], s[84:85], s[54:55]
    s_or_b64 s[56:57], s[56:57], s[64:65]
    s_xor_b64 s[64:65], s[86:87], s[54:55]
    s_or_b64 s[56:57], s[56:57], s[64:65]
    s_xor_b64 s[64:65], s[88:89], s[54:55]
    s_or_b64 s[56:57], s[56:57], s[64:65]
    s_xor_b64 s[64:65], s[90:91], s[54:55]
    s_or_b64 s[56:57], s[56:57], s[64:65]
    s_xor_b64 s[64:65], s[92:93], s[54:55]
    s_or_b64 s[56:57], s[56:57], s[64:65]
    s_xor_b64 s[64:65], s[94:95], s[54:55]
    s_or_b64 s[56:57], s[56:57], s[64:65]
    s_cbranch_scc1 uf_7
uf_7_ok:
    s_waitcnt lgkmcnt(0)
    s_mov_b32 s58, 0x20000
uf_8:
    s_load_dwordx16 s[64:79], s[52:53], 2048 glc
    s_sub_u32 s58, s58, 1
    s_cbranch_scc1 uf_8_ok
    s_waitcnt lgkmcnt(0)
    s_xor_b64 s[56:57], s[64:65], s[54:55]
    s_xor_b64 s[64:65], s[66:67], s[54:55]
    s_or_b64 s[56:57], s[56:57], s[64:65]
    s_xor_b64 s[64:65], s[68:69], s[54:55]
    s_or_b64 s[56:57], s[56:57], s[64:65]
    s_xor_b64 s[64:65], s[70:71], s[54:55]
    s_or_b64 s[56:57], s[56:57], s[64:65]
    s_xor_b64 s[64:65], s[72:73], s[54:55]
    s_or_b64 s[56:57], s[56:57], s[64:65]
    s_xor_b64 s[64:65], s[74:75], s[54:55]
    s_or_b64 s[56:57], s[56:57], s[64:65]
    s_xor_b64 s[64:65], s[76:77], s[54:55]
    s_or_b64 s[56:57], s[56:57], s[64:65]
    s_xor_b64 s[64:65], s[78:79], s[54:55]
    s_or_b64 s[56:57], s[56:57], s[64:65]
    s_cbranch_scc1 uf_8
uf_8_ok:
    s_waitcnt lgkmcnt(0)
    s_lshl_b32 s56, s7, 12
    s_add_u32 s56, s56, 58785792
    buffer_load_dwordx4 v[32:35], v17, s[12:15], s56 offen offset:0 sc1
    buffer_load_dwordx4 v[36:39], v17, s[12:15], s56 offen offset:256 sc1
    buffer_load_dwordx4 v[40:43], v17, s[12:15], s56 offen offset:512 sc1
    buffer_load_dwordx4 v[44:47], v17, s[12:15], s56 offen offset:768 sc1
    buffer_load_dwordx4 v[48:51], v17, s[12:15], s56 offen offset:1024 sc1
    buffer_load_dwordx4 v[52:55], v17, s[12:15], s56 offen offset:1280 sc1
    buffer_load_dwordx4 v[56:59], v17, s[12:15], s56 offen offset:1536 sc1
    s_waitcnt vmcnt(9)
    s_barrier
    s_mov_b32 m0, 149504
    s_mov_b32 s48, 36864
    buffer_load_dwordx4 v6, s[20:23], s48 offen sc1 lds
    s_mov_b32 m0, 150528
    s_mov_b32 s48, 38912
    buffer_load_dwordx4 v6, s[20:23], s48 offen sc1 lds
    buffer_load_dwordx4 v[60:63], v17, s[12:15], s56 offen offset:1792 sc1
    buffer_load_dwordx4 v[64:67], v17, s[12:15], s56 offen offset:2048 sc1
    buffer_load_dwordx4 v[68:71], v17, s[12:15], s56 offen offset:2304 sc1
    buffer_load_dwordx4 v[72:75], v17, s[12:15], s56 offen offset:2560 sc1
    buffer_load_dwordx4 v[76:79], v17, s[12:15], s56 offen offset:2816 sc1
    buffer_load_dwordx4 v[80:83], v17, s[12:15], s56 offen offset:3072 sc1
    buffer_load_dwordx4 v[84:87], v17, s[12:15], s56 offen offset:3328 sc1
    buffer_load_dwordx4 v[88:91], v17, s[12:15], s56 offen offset:3584 sc1
    buffer_load_dwordx4 v[92:95], v17, s[12:15], s56 offen offset:3840 sc1
    s_waitcnt vmcnt(18)
    s_barrier
    s_mov_b32 m0, 151552
    s_mov_b32 s48, 40960
    buffer_load_dwordx4 v6, s[20:23], s48 offen sc1 lds
    s_mov_b32 m0, 152576
    s_mov_b32 s48, 43008
    buffer_load_dwordx4 v6, s[20:23], s48 offen sc1 lds
    s_waitcnt vmcnt(11)
    s_barrier
    s_mov_b32 m0, 153600
    s_mov_b32 s48, 45056
    buffer_load_dwordx4 v6, s[20:23], s48 offen sc1 lds
    s_mov_b32 m0, 154624
    s_mov_b32 s48, 47104
    buffer_load_dwordx4 v6, s[20:23], s48 offen sc1 lds
    s_waitcnt vmcnt(4)
    v_add_f32 v32, v32, v64
    v_add_f32 v33, v33, v65
    v_add_f32 v34, v34, v66
    v_add_f32 v35, v35, v67
    v_add_f32 v36, v36, v68
    v_add_f32 v37, v37, v69
    v_add_f32 v38, v38, v70
    v_add_f32 v39, v39, v71
    v_add_f32 v40, v40, v72
    v_add_f32 v41, v41, v73
    v_add_f32 v42, v42, v74
    v_add_f32 v43, v43, v75
    s_waitcnt vmcnt(2)
    s_barrier
    s_mov_b32 m0, 147456
    s_mov_b32 s48, 49152
    buffer_load_dwordx4 v6, s[20:23], s48 offen sc1 lds
    s_mov_b32 m0, 148480
    s_mov_b32 s48, 51200
    buffer_load_dwordx4 v6, s[20:23], s48 offen sc1 lds
    v_add_f32 v44, v44, v76
    v_add_f32 v45, v45, v77
    v_add_f32 v46, v46, v78
    v_add_f32 v47, v47, v79
    v_add_f32 v48, v48, v80
    v_add_f32 v49, v49, v81
    v_add_f32 v50, v50, v82
    v_add_f32 v51, v51, v83
    v_add_f32 v52, v52, v84
    v_add_f32 v53, v53, v85
    v_add_f32 v54, v54, v86
    v_add_f32 v55, v55, v87
    s_waitcnt vmcnt(2)
    s_barrier
    s_mov_b32 m0, 149504
    s_mov_b32 s48, 53248
    buffer_load_dwordx4 v6, s[20:23], s48 offen sc1 lds
    s_mov_b32 m0, 150528
    s_mov_b32 s48, 55296
    buffer_load_dwordx4 v6, s[20:23], s48 offen sc1 lds
    v_add_f32 v56, v56, v88
    v_add_f32 v57, v57, v89
    v_add_f32 v58, v58, v90
    v_add_f32 v59, v59, v91
    v_add_f32 v60, v60, v92
    v_add_f32 v61, v61, v93
    v_add_f32 v62, v62, v94
    v_add_f32 v63, v63, v95
    v_add_f32 v32, v32, v48
    v_add_f32 v33, v33, v49
    v_add_f32 v34, v34, v50
    v_add_f32 v35, v35, v51
    s_waitcnt vmcnt(2)
    s_barrier
    s_mov_b32 m0, 151552
    s_mov_b32 s48, 57344
    buffer_load_dwordx4 v6, s[20:23], s48 offen sc1 lds
    s_mov_b32 m0, 152576
    s_mov_b32 s48, 59392
    buffer_load_dwordx4 v6, s[20:23], s48 offen sc1 lds
    v_add_f32 v36, v36, v52
    v_add_f32 v37, v37, v53
    v_add_f32 v38, v38, v54
    v_add_f32 v39, v39, v55
    v_add_f32 v40, v40, v56
    v_add_f32 v41, v41, v57
    v_add_f32 v42, v42, v58
    v_add_f32 v43, v43, v59
    v_add_f32 v44, v44, v60
    v_add_f32 v45, v45, v61
    v_add_f32 v46, v46, v62
    v_add_f32 v47, v47, v63
    s_waitcnt vmcnt(2)
    s_barrier
    s_mov_b32 m0, 153600
    s_mov_b32 s48, 61440
    buffer_load_dwordx4 v6, s[20:23], s48 offen sc1 lds
    s_mov_b32 m0, 154624
    s_mov_b32 s48, 63488
    buffer_load_dwordx4 v6, s[20:23], s48 offen sc1 lds
    v_add_f32 v32, v32, v40
    v_add_f32 v33, v33, v41
    v_add_f32 v34, v34, v42
    v_add_f32 v35, v35, v43
    v_add_f32 v36, v36, v44
    v_add_f32 v37, v37, v45
    v_add_f32 v38, v38, v46
    v_add_f32 v39, v39, v47
    v_add_f32 v32, v32, v36
    v_add_f32 v33, v33, v37
    v_add_f32 v34, v34, v38
    v_add_f32 v35, v35, v39
    s_waitcnt vmcnt(2)
    s_barrier
    ds_write_b128 v22, v[32:35]
    s_waitcnt lgkmcnt(0)
    s_waitcnt vmcnt(0)
    s_barrier
    s_barrier
    s_barrier
    s_branch h_wo
.p2align 6
h_qkva:
    v_and_b32 v1, 63, v0
    v_and_b32 v20, 15, v1
    s_lshl_b32 s51, s6, 2
    s_sub_u32 s51, s51, 1
    s_max_i32 s51, s51, 0
    s_lshl_b32 s50, s51, 16
    s_lshl_b32 s52, s9, 22
    s_add_u32 s50, s50, s52
    s_add_u32 s20, s4, s50
    s_addc_u32 s21, s5, 0
    s_mov_b32 s22, 65536
    s_mov_b32 s23, 0x00020000
    v_bfe_u32 v24, v1, 4, 1
    v_lshl_add_u32 v6, v24, 5, v20
    v_lshlrev_b32 v6, 4, v6
    v_lshrrev_b32 v24, 5, v1
    v_lshl_add_u32 v6, v24, 10, v6
    v_add_u32 v6, 256, v6
    s_sub_u32 s9, s9, 1
    s_mul_i32 s54, s9, 393216
    s_add_u32 s54, s54, 60293120
    s_lshl_b32 s55, s11, 9
    s_add_u32 s54, s54, s55
    s_add_u32 s52, s4, s54
    s_addc_u32 s53, s5, 0
    s_mov_b32 s54, s10
    s_mov_b32 s55, s10
    s_add_u32 s9, s9, 1
    s_mov_b32 s58, 0x20000
poll_9:
    s_load_dwordx8 s[64:71], s[52:53], 0 glc
    s_load_dwordx8 s[72:79], s[52:53], 128 glc
    s_load_dwordx8 s[80:87], s[52:53], 256 glc
    s_load_dwordx8 s[88:95], s[52:53], 384 glc
    s_sub_u32 s58, s58, 1
    s_cbranch_scc1 poll_9_ok
    s_waitcnt lgkmcnt(0)
    s_xor_b64 s[56:57], s[64:65], s[54:55]
    s_xor_b64 s[64:65], s[66:67], s[54:55]
    s_or_b64 s[56:57], s[56:57], s[64:65]
    s_xor_b64 s[64:65], s[68:69], s[54:55]
    s_or_b64 s[56:57], s[56:57], s[64:65]
    s_xor_b64 s[64:65], s[70:71], s[54:55]
    s_or_b64 s[56:57], s[56:57], s[64:65]
    s_xor_b64 s[64:65], s[72:73], s[54:55]
    s_or_b64 s[56:57], s[56:57], s[64:65]
    s_xor_b64 s[64:65], s[74:75], s[54:55]
    s_or_b64 s[56:57], s[56:57], s[64:65]
    s_xor_b64 s[64:65], s[76:77], s[54:55]
    s_or_b64 s[56:57], s[56:57], s[64:65]
    s_xor_b64 s[64:65], s[78:79], s[54:55]
    s_or_b64 s[56:57], s[56:57], s[64:65]
    s_xor_b64 s[64:65], s[80:81], s[54:55]
    s_or_b64 s[56:57], s[56:57], s[64:65]
    s_xor_b64 s[64:65], s[82:83], s[54:55]
    s_or_b64 s[56:57], s[56:57], s[64:65]
    s_xor_b64 s[64:65], s[84:85], s[54:55]
    s_or_b64 s[56:57], s[56:57], s[64:65]
    s_xor_b64 s[64:65], s[86:87], s[54:55]
    s_or_b64 s[56:57], s[56:57], s[64:65]
    s_xor_b64 s[64:65], s[88:89], s[54:55]
    s_or_b64 s[56:57], s[56:57], s[64:65]
    s_xor_b64 s[64:65], s[90:91], s[54:55]
    s_or_b64 s[56:57], s[56:57], s[64:65]
    s_xor_b64 s[64:65], s[92:93], s[54:55]
    s_or_b64 s[56:57], s[56:57], s[64:65]
    s_xor_b64 s[64:65], s[94:95], s[54:55]
    s_or_b64 s[56:57], s[56:57], s[64:65]
    s_cbranch_scc1 poll_9
poll_9_ok:
    s_waitcnt lgkmcnt(0)
    s_mov_b32 m0, 147456
    s_mov_b32 s48, 0
    buffer_load_dwordx4 v6, s[20:23], s48 offen sc1 lds
    s_mov_b32 m0, 148480
    s_mov_b32 s48, 2048
    buffer_load_dwordx4 v6, s[20:23], s48 offen sc1 lds
    s_barrier
    s_mov_b32 m0, 149504
    s_mov_b32 s48, 4096
    buffer_load_dwordx4 v6, s[20:23], s48 offen sc1 lds
    s_mov_b32 m0, 150528
    s_mov_b32 s48, 6144
    buffer_load_dwordx4 v6, s[20:23], s48 offen sc1 lds
    s_mov_b32 m0, 151552
    s_mov_b32 s48, 8192
    buffer_load_dwordx4 v6, s[20:23], s48 offen sc1 lds
    s_mov_b32 m0, 152576
    s_mov_b32 s48, 10240
    buffer_load_dwordx4 v6, s[20:23], s48 offen sc1 lds
    s_waitcnt vmcnt(4)
    s_barrier
    s_waitcnt vmcnt(2)
    s_barrier
    s_mov_b32 m0, 153600
    s_mov_b32 s48, 12288
    buffer_load_dwordx4 v6, s[20:23], s48 offen sc1 lds
    s_mov_b32 m0, 154624
    s_mov_b32 s48, 14336
    buffer_load_dwordx4 v6, s[20:23], s48 offen sc1 lds
    s_waitcnt vmcnt(2)
    s_barrier
    s_mov_b32 m0, 147456
    s_mov_b32 s48, 16384
    buffer_load_dwordx4 v6, s[20:23], s48 offen sc1 lds
    s_mov_b32 m0, 148480
    s_mov_b32 s48, 18432
    buffer_load_dwordx4 v6, s[20:23], s48 offen sc1 lds
    s_waitcnt vmcnt(2)
    s_barrier
    s_mov_b32 m0, 149504
    s_mov_b32 s48, 20480
    buffer_load_dwordx4 v6, s[20:23], s48 offen sc1 lds
    s_mov_b32 m0, 150528
    s_mov_b32 s48, 22528
    buffer_load_dwordx4 v6, s[20:23], s48 offen sc1 lds
    s_waitcnt vmcnt(2)
    s_barrier
    s_mov_b32 m0, 151552
    s_mov_b32 s48, 24576
    buffer_load_dwordx4 v6, s[20:23], s48 offen sc1 lds
    s_mov_b32 m0, 152576
    s_mov_b32 s48, 26624
    buffer_load_dwordx4 v6, s[20:23], s48 offen sc1 lds
    s_waitcnt vmcnt(2)
    s_barrier
    s_mov_b32 m0, 153600
    s_mov_b32 s48, 28672
    buffer_load_dwordx4 v6, s[20:23], s48 offen sc1 lds
    s_mov_b32 m0, 154624
    s_mov_b32 s48, 30720
    buffer_load_dwordx4 v6, s[20:23], s48 offen sc1 lds
    s_waitcnt vmcnt(2)
    s_barrier
    s_mov_b32 m0, 147456
    s_mov_b32 s48, 32768
    buffer_load_dwordx4 v6, s[20:23], s48 offen sc1 lds
    s_mov_b32 m0, 148480
    s_mov_b32 s48, 34816
    buffer_load_dwordx4 v6, s[20:23], s48 offen sc1 lds
    s_waitcnt vmcnt(2)
    s_barrier
    s_mov_b32 m0, 149504
    s_mov_b32 s48, 36864
    buffer_load_dwordx4 v6, s[20:23], s48 offen sc1 lds
    s_mov_b32 m0, 150528
    s_mov_b32 s48, 38912
    buffer_load_dwordx4 v6, s[20:23], s48 offen sc1 lds
    s_waitcnt vmcnt(2)
    s_barrier
    s_mov_b32 m0, 151552
    s_mov_b32 s48, 40960
    buffer_load_dwordx4 v6, s[20:23], s48 offen sc1 lds
    s_mov_b32 m0, 152576
    s_mov_b32 s48, 43008
    buffer_load_dwordx4 v6, s[20:23], s48 offen sc1 lds
    s_waitcnt vmcnt(2)
    s_barrier
    s_mov_b32 m0, 153600
    s_mov_b32 s48, 45056
    buffer_load_dwordx4 v6, s[20:23], s48 offen sc1 lds
    s_mov_b32 m0, 154624
    s_mov_b32 s48, 47104
    buffer_load_dwordx4 v6, s[20:23], s48 offen sc1 lds
    s_waitcnt vmcnt(2)
    s_barrier
    s_mov_b32 m0, 147456
    s_mov_b32 s48, 49152
    buffer_load_dwordx4 v6, s[20:23], s48 offen sc1 lds
    s_mov_b32 m0, 148480
    s_mov_b32 s48, 51200
    buffer_load_dwordx4 v6, s[20:23], s48 offen sc1 lds
    s_waitcnt vmcnt(2)
    s_barrier
    s_mov_b32 m0, 149504
    s_mov_b32 s48, 53248
    buffer_load_dwordx4 v6, s[20:23], s48 offen sc1 lds
    s_mov_b32 m0, 150528
    s_mov_b32 s48, 55296
    buffer_load_dwordx4 v6, s[20:23], s48 offen sc1 lds
    s_waitcnt vmcnt(2)
    s_barrier
    s_mov_b32 m0, 151552
    s_mov_b32 s48, 57344
    buffer_load_dwordx4 v6, s[20:23], s48 offen sc1 lds
    s_mov_b32 m0, 152576
    s_mov_b32 s48, 59392
    buffer_load_dwordx4 v6, s[20:23], s48 offen sc1 lds
    s_waitcnt vmcnt(2)
    s_barrier
    s_mov_b32 m0, 153600
    s_mov_b32 s48, 61440
    buffer_load_dwordx4 v6, s[20:23], s48 offen sc1 lds
    s_mov_b32 m0, 154624
    s_mov_b32 s48, 63488
    buffer_load_dwordx4 v6, s[20:23], s48 offen sc1 lds
    s_waitcnt vmcnt(2)
    s_barrier
    s_waitcnt vmcnt(0)
    s_barrier
    s_barrier
    s_barrier
    s_branch h_wo
.p2align 6
l_raw:
    v_and_b32 v1, 63, v0
    s_sub_u32 s51, s8, 5
    s_lshl_b32 s48, s51, 10
    v_lshrrev_b32 v20, 3, v1
    v_and_b32 v22, 2, v20
    v_lshrrev_b32 v23, 2, v20
    v_or_b32 v22, v22, v23
    v_bfe_u32 v21, v1, 1, 2
    v_xor_b32 v22, v22, v21
    v_lshlrev_b32 v22, 5, v22
    v_and_b32 v21, 1, v1
    v_lshl_add_u32 v22, v21, 4, v22
    s_lshl_b32 s3, s51, 11
    s_lshl_b32 s52, s7, 7
    s_add_u32 s49, s3, s52
    v_lshl_add_u32 v28, v20, 7, v22
    v_mul_u32_u24 v23, 6144, v20
    v_add_u32 v7, v23, v22
    s_mov_b32 s24, s34
    s_mov_b32 s25, s35
    s_mov_b32 s26, 6291456
    s_mov_b32 s27, 0x00020000
    s_mov_b32 s50, 49152
    s_lshl_b32 s61, s51, 8
    s_add_u32 s61, s61, s2
    s_and_b32 s62, s61, 15
    s_lshr_b32 s63, s61, 4
    v_and_b32 v21, 7, v1
    v_lshl_add_u32 v12, v21, 4, v23
    s_barrier
    s_mov_b32 s20, s34
    s_mov_b32 s21, s35
    s_mov_b32 s22, 6291456
    s_mov_b32 s23, 0x00020000
    s_mul_i32 s55, s62, 393216
    s_lshl_b32 s56, s63, 7
    s_add_u32 s55, s55, s56
    buffer_load_dwordx4 v[32:35], v12, s[20:23], s55 offen
    s_add_u32 s55, s55, 49152
    buffer_load_dwordx4 v[36:39], v12, s[20:23], s55 offen
    s_add_u32 s55, s55, 49152
    buffer_load_dwordx4 v[40:43], v12, s[20:23], s55 offen
    s_add_u32 s55, s55, 49152
    buffer_load_dwordx4 v[44:47], v12, s[20:23], s55 offen
    s_add_u32 s55, s55, 49152
    buffer_load_dwordx4 v[48:51], v12, s[20:23], s55 offen
    s_add_u32 s55, s55, 49152
    buffer_load_dwordx4 v[52:55], v12, s[20:23], s55 offen
    s_add_u32 s55, s55, 49152
    buffer_load_dwordx4 v[56:59], v12, s[20:23], s55 offen
    s_add_u32 s55, s55, 49152
    buffer_load_dwordx4 v[60:63], v12, s[20:23], s55 offen
    s_add_u32 s55, s55, 49152
    s_mov_b32 s9, 0
    v_lshlrev_b32 v13, 4, v1
    v_lshlrev_b32 v14, 6, v20
    v_lshrrev_b32 v22, 5, v1
    v_bfe_u32 v23, v1, 1, 1
    v_xor_b32 v22, v22, v23
    v_lshl_add_u32 v14, v22, 5, v14
    v_and_b32 v22, 1, v1
    v_lshl_add_u32 v14, v22, 4, v14
    v_bfe_u32 v23, v1, 2, 1
    v_mul_u32_u24 v23, 196608, v23
    v_add_u32 v14, v14, v23
    v_lshlrev_b32 v22, 4, v22
    v_mov_b32 v23, 0x3f80
    v_lshlrev_b32 v23, v22, v23
    v_bfe_u32 v22, v1, 1, 3
    v_cmp_eq_u32 vcc, 0, v22
    s_nop 1
    v_cndmask_b32 v24, 0, v23, vcc
    v_cmp_eq_u32 vcc, 1, v22
    s_nop 1
    v_cndmask_b32 v25, 0, v23, vcc
    v_cmp_eq_u32 vcc, 2, v22
    s_nop 1
    v_cndmask_b32 v26, 0, v23, vcc
    v_cmp_eq_u32 vcc, 3, v22
    s_nop 1
    v_cndmask_b32 v27, 0, v23, vcc
    v_lshlrev_b32 v16, 5, v21
    v_and_b32 v22, 16, v1
    v_add_u32 v16, v16, v22
    v_mov_b32 v8, 0
    s_barrier
    s_add_u32 m0, s48, 0
    s_nop 0
    buffer_load_dwordx4 v7, s[24:27], s49 offen lds
    s_add_u32 s49, s49, s50
    s_add_u32 m0, s48, 3072
    s_nop 0
    buffer_load_dwordx4 v7, s[24:27], s49 offen lds
    s_add_u32 s49, s49, s50
    s_add_u32 m0, s48, 6144
    s_nop 0
    buffer_load_dwordx4 v7, s[24:27], s49 offen lds
    s_add_u32 s49, s49, s50
    s_add_u32 m0, s48, 9216
    s_nop 0
    buffer_load_dwordx4 v7, s[24:27], s49 offen lds
    s_add_u32 s49, s49, s50
    s_add_u32 m0, s48, 12288
    s_nop 0
    buffer_load_dwordx4 v7, s[24:27], s49 offen lds
    s_add_u32 s49, s49, s50
    s_add_u32 m0, s48, 15360
    s_nop 0
    buffer_load_dwordx4 v7, s[24:27], s49 offen lds
    s_add_u32 s49, s49, s50
    s_add_u32 m0, s48, 18432
    s_nop 0
    buffer_load_dwordx4 v7, s[24:27], s49 offen lds
    s_add_u32 s49, s49, s50
    s_add_u32 m0, s48, 21504
    s_nop 0
    buffer_load_dwordx4 v7, s[24:27], s49 offen lds
    s_add_u32 s49, s49, s50
    s_add_u32 m0, s48, 24576
    s_nop 0
    buffer_load_dwordx4 v7, s[24:27], s49 offen lds
    s_add_u32 s49, s49, s50
    s_add_u32 m0, s48, 27648
    s_nop 0
    buffer_load_dwordx4 v7, s[24:27], s49 offen lds
    s_add_u32 s49, s49, s50
    s_add_u32 m0, s48, 30720
    s_nop 0
    buffer_load_dwordx4 v7, s[24:27], s49 offen lds
    s_add_u32 s49, s49, s50
    s_add_u32 m0, s48, 33792
    s_nop 0
    buffer_load_dwordx4 v7, s[24:27], s49 offen lds
    s_add_u32 s49, s49, s50
    s_add_u32 m0, s48, 36864
    s_nop 0
    buffer_load_dwordx4 v7, s[24:27], s49 offen lds
    s_add_u32 s49, s49, s50
    s_add_u32 m0, s48, 39936
    s_nop 0
    buffer_load_dwordx4 v7, s[24:27], s49 offen lds
    s_add_u32 s49, s49, s50
    s_add_u32 m0, s48, 43008
    s_nop 0
    buffer_load_dwordx4 v7, s[24:27], s49 offen lds
    s_add_u32 s49, s49, s50
    s_add_u32 m0, s48, 46080
    s_nop 0
    buffer_load_dwordx4 v7, s[24:27], s49 offen lds
    s_add_u32 s49, s49, s50
    s_add_u32 m0, s48, 49152
    s_nop 0
    buffer_load_dwordx4 v7, s[24:27], s49 offen lds
    s_add_u32 s49, s49, s50
    s_add_u32 m0, s48, 52224
    s_nop 0
    buffer_load_dwordx4 v7, s[24:27], s49 offen lds
    s_add_u32 s49, s49, s50
    s_add_u32 m0, s48, 55296
    s_nop 0
    buffer_load_dwordx4 v7, s[24:27], s49 offen lds
    s_add_u32 s49, s49, s50
    s_add_u32 m0, s48, 58368
    s_nop 0
    buffer_load_dwordx4 v7, s[24:27], s49 offen lds
    s_add_u32 s49, s49, s50
    s_add_u32 m0, s48, 61440
    s_nop 0
    buffer_load_dwordx4 v7, s[24:27], s49 offen lds
    s_add_u32 s49, s49, s50
    s_add_u32 m0, s48, 64512
    s_nop 0
    buffer_load_dwordx4 v7, s[24:27], s49 offen lds
    s_add_u32 s49, s49, s50
    s_add_u32 m0, s48, 67584
    s_nop 0
    buffer_load_dwordx4 v7, s[24:27], s49 offen lds
    s_add_u32 s49, s49, s50
    s_add_u32 m0, s48, 70656
    s_nop 0
    buffer_load_dwordx4 v7, s[24:27], s49 offen lds
    s_add_u32 s49, s49, s50
    v_lshrrev_b32 v10, 5, v1
    v_and_b32 v11, 31, v1
    v_lshlrev_b32 v11, 3, v11
    v_lshl_add_u32 v10, v10, 12, v11
    s_lshl_b32 s3, s51, 8
    s_add_u32 s3, s3, 155648
    v_lshl_add_u32 v11, v1, 2, s3
    s_lshl_b32 s59, s6, 1
    s_add_u32 s59, s59, s51
    s_sub_u32 s59, s59, 1
    s_max_i32 s59, s59, 0
    s_lshl_b32 s59, s59, 13
    s_lshl_b32 s53, s9, 18
    s_add_u32 s59, s59, s53
    s_add_u32 s59, s59, 57671680
    s_lshl_b32 s3, s7, 7
    v_lshrrev_b32 v20, 3, v1
    v_lshlrev_b32 v21, 11, v20
    v_lshrrev_b32 v22, 2, v1
    v_lshrrev_b32 v23, 4, v1
    v_xor_b32 v22, v22, v23
    v_and_b32 v22, 1, v22
    v_lshl_add_u32 v21, v22, 6, v21
    v_and_b32 v22, 3, v1
    v_lshl_add_u32 v21, v22, 4, v21
    v_add_u32 v17, s3, v21
    s_waitcnt vmcnt(16)
    s_barrier
    v_mov_b32 v9, 158980
    ds_read_b32 v9, v9
    v_mfma_f32_16x16x32_bf16 v[64:67], v[24:27], v[32:35], 0
    v_mfma_f32_16x16x32_bf16 v[64:67], v[24:27], v[36:39], v[64:67]
    v_mfma_f32_16x16x32_bf16 v[64:67], v[24:27], v[40:43], v[64:67]
    v_mfma_f32_16x16x32_bf16 v[64:67], v[24:27], v[44:47], v[64:67]
    v_mfma_f32_16x16x32_bf16 v[64:67], v[24:27], v[48:51], v[64:67]
    v_mfma_f32_16x16x32_bf16 v[64:67], v[24:27], v[52:55], v[64:67]
    v_mfma_f32_16x16x32_bf16 v[64:67], v[24:27], v[56:59], v[64:67]
    v_mfma_f32_16x16x32_bf16 v[64:67], v[24:27], v[60:63], v[64:67]
    s_lshr_b32 s55, s63, 4
    s_and_b32 s56, s63, 15
    s_lshr_b32 s57, s56, 3
    s_mul_i32 s57, s57, 3
    s_add_u32 s57, s57, s55
    s_lshl_b32 s57, s57, 17
    s_lshl_b32 s58, s62, 13
    s_add_u32 s57, s57, s58
    s_add_u32 s57, s57, 56623104
    s_and_b32 s56, s56, 7
    s_cmp_eq_u32 s56, 3
    s_cselect_b32 s57, s57, 67108864
    buffer_store_dwordx4 v[32:35], v13, s[12:15], s57 offen offset:0 sc1
    buffer_store_dwordx4 v[36:39], v13, s[12:15], s57 offen offset:1024 sc1
    buffer_store_dwordx4 v[40:43], v13, s[12:15], s57 offen offset:2048 sc1
    buffer_store_dwordx4 v[44:47], v13, s[12:15], s57 offen offset:3072 sc1
    s_add_u32 s57, s57, 4096
    buffer_store_dwordx4 v[48:51], v13, s[12:15], s57 offen offset:0 sc1
    buffer_store_dwordx4 v[52:55], v13, s[12:15], s57 offen offset:1024 sc1
    buffer_store_dwordx4 v[56:59], v13, s[12:15], s57 offen offset:2048 sc1
    buffer_store_dwordx4 v[60:63], v13, s[12:15], s57 offen offset:3072 sc1
    v_add_f32_dpp v64, v64, v64 row_ror:8 row_mask:0xf bank_mask:0xf
    v_add_f32_dpp v65, v65, v65 row_ror:8 row_mask:0xf bank_mask:0xf
    v_add_f32_dpp v66, v66, v66 row_ror:8 row_mask:0xf bank_mask:0xf
    v_add_f32_dpp v67, v67, v67 row_ror:8 row_mask:0xf bank_mask:0xf
    s_lshl_b32 s55, s61, 8
    s_add_u32 s55, s55, 58785792
    s_mov_b64 exec, 0x00ff00ff
    buffer_store_dwordx4 v[64:67], v16, s[12:15], s55 offen sc1
    s_mov_b64 exec, -1
    s_waitcnt lgkmcnt(0)
    v_readfirstlane_b32 s10, v9
    s_barrier
    s_add_u32 m0, s48, 73728
    s_nop 0
    buffer_load_dwordx4 v7, s[24:27], s49 offen lds
    s_add_u32 s49, s49, s50
    s_add_u32 m0, s48, 76800
    s_nop 0
    buffer_load_dwordx4 v7, s[24:27], s49 offen lds
    s_add_u32 s49, s49, s50
    s_add_u32 m0, s48, 79872
    s_nop 0
    buffer_load_dwordx4 v7, s[24:27], s49 offen lds
    s_add_u32 s49, s49, s50
    s_add_u32 m0, s48, 82944
    s_nop 0
    buffer_load_dwordx4 v7, s[24:27], s49 offen lds
    s_add_u32 s49, s49, s50
    s_add_u32 m0, s48, 86016
    s_nop 0
    buffer_load_dwordx4 v7, s[24:27], s49 offen lds
    s_add_u32 s49, s49, s50
    s_add_u32 m0, s48, 89088
    s_nop 0
    buffer_load_dwordx4 v7, s[24:27], s49 offen lds
    s_add_u32 s49, s49, s50
    s_add_u32 m0, s48, 92160
    s_nop 0
    buffer_load_dwordx4 v7, s[24:27], s49 offen lds
    s_add_u32 s49, s49, s50
    s_add_u32 m0, s48, 95232
    s_nop 0
    buffer_load_dwordx4 v7, s[24:27], s49 offen lds
    s_add_u32 s49, s49, s50
    s_add_u32 m0, s48, 98304
    s_nop 0
    buffer_load_dwordx4 v7, s[24:27], s49 offen lds
    s_add_u32 s49, s49, s50
    s_add_u32 m0, s48, 101376
    s_nop 0
    buffer_load_dwordx4 v7, s[24:27], s49 offen lds
    s_add_u32 s49, s49, s50
    s_add_u32 m0, s48, 104448
    s_nop 0
    buffer_load_dwordx4 v7, s[24:27], s49 offen lds
    s_add_u32 s49, s49, s50
    s_add_u32 m0, s48, 107520
    s_nop 0
    buffer_load_dwordx4 v7, s[24:27], s49 offen lds
    s_add_u32 s49, s49, s50
    s_add_u32 m0, s48, 110592
    s_nop 0
    buffer_load_dwordx4 v7, s[24:27], s49 offen lds
    s_add_u32 s49, s49, s50
    s_add_u32 m0, s48, 113664
    s_nop 0
    buffer_load_dwordx4 v7, s[24:27], s49 offen lds
    s_add_u32 s49, s49, s50
    s_add_u32 m0, s48, 116736
    s_nop 0
    buffer_load_dwordx4 v7, s[24:27], s49 offen lds
    s_add_u32 s49, s49, s50
    s_add_u32 m0, s48, 119808
    s_nop 0
    buffer_load_dwordx4 v7, s[24:27], s49 offen lds
    s_add_u32 s49, s49, s50
    s_waitcnt vmcnt(33)
    s_barrier
    s_add_u32 m0, s48, 122880
    s_nop 0
    buffer_load_dwordx4 v7, s[24:27], s49 offen lds
    s_add_u32 s49, s49, s50
    s_add_u32 m0, s48, 125952
    s_nop 0
    buffer_load_dwordx4 v7, s[24:27], s49 offen lds
    s_add_u32 s49, s49, s50
    s_add_u32 m0, s48, 129024
    s_nop 0
    buffer_load_dwordx4 v7, s[24:27], s49 offen lds
    s_add_u32 s49, s49, s50
    s_add_u32 m0, s48, 132096
    s_nop 0
    buffer_load_dwordx4 v7, s[24:27], s49 offen lds
    s_add_u32 s49, s49, s50
    s_add_u32 m0, s48, 135168
    s_nop 0
    buffer_load_dwordx4 v7, s[24:27], s49 offen lds
    s_add_u32 s49, s49, s50
    s_add_u32 m0, s48, 138240
    s_nop 0
    buffer_load_dwordx4 v7, s[24:27], s49 offen lds
    s_add_u32 s49, s49, s50
    s_add_u32 m0, s48, 141312
    s_nop 0
    buffer_load_dwordx4 v7, s[24:27], s49 offen lds
    s_add_u32 s49, s49, s50
    s_add_u32 m0, s48, 144384
    s_nop 0
    buffer_load_dwordx4 v7, s[24:27], s49 offen lds
    s_add_u32 s49, s49, s50
    s_lshl_b32 s55, s61, 2
    s_add_u32 s55, s55, 58753024
    s_mov_b64 exec, 1
    s_waitcnt vmcnt(24)
    buffer_store_dword v9, v8, s[12:15], s55 offen sc1
    s_mov_b64 exec, -1
    s_barrier
    s_add_u32 m0, s48, 0
    s_nop 0
    buffer_load_dwordx4 v7, s[24:27], s49 offen lds
    s_add_u32 s49, s49, s50
    s_add_u32 m0, s48, 3072
    s_nop 0
    buffer_load_dwordx4 v7, s[24:27], s49 offen lds
    s_add_u32 s49, s49, s50
    s_add_u32 m0, s48, 6144
    s_nop 0
    buffer_load_dwordx4 v7, s[24:27], s49 offen lds
    s_add_u32 s49, s49, s50
    s_add_u32 m0, s48, 9216
    s_nop 0
    buffer_load_dwordx4 v7, s[24:27], s49 offen lds
    s_add_u32 s49, s49, s50
    s_add_u32 m0, s48, 12288
    s_nop 0
    buffer_load_dwordx4 v7, s[24:27], s49 offen lds
    s_add_u32 s49, s49, s50
    s_add_u32 m0, s48, 15360
    s_nop 0
    buffer_load_dwordx4 v7, s[24:27], s49 offen lds
    s_add_u32 s49, s49, s50
    s_add_u32 m0, s48, 18432
    s_nop 0
    buffer_load_dwordx4 v7, s[24:27], s49 offen lds
    s_add_u32 s49, s49, s50
    s_add_u32 m0, s48, 21504
    s_nop 0
    buffer_load_dwordx4 v7, s[24:27], s49 offen lds
    s_add_u32 s49, s49, s50
    buffer_load_dwordx2 v[72:73], v10, s[12:15], s59 offen offset:0 sc1
    buffer_load_dwordx2 v[74:75], v10, s[12:15], s59 offen offset:256 sc1
    buffer_load_dwordx2 v[76:77], v10, s[12:15], s59 offen offset:512 sc1
    buffer_load_dwordx2 v[78:79], v10, s[12:15], s59 offen offset:768 sc1
    s_waitcnt vmcnt(29)
    s_barrier
    s_add_u32 m0, s48, 24576
    s_nop 0
    buffer_load_dwordx4 v7, s[24:27], s49 offen lds
    s_add_u32 s49, s49, s50
    s_add_u32 m0, s48, 27648
    s_nop 0
    buffer_load_dwordx4 v7, s[24:27], s49 offen lds
    s_add_u32 s49, s49, s50
    s_add_u32 m0, s48, 30720
    s_nop 0
    buffer_load_dwordx4 v7, s[24:27], s49 offen lds
    s_add_u32 s49, s49, s50
    s_add_u32 m0, s48, 33792
    s_nop 0
    buffer_load_dwordx4 v7, s[24:27], s49 offen lds
    s_add_u32 s49, s49, s50
    s_add_u32 m0, s48, 36864
    s_nop 0
    buffer_load_dwordx4 v7, s[24:27], s49 offen lds
    s_add_u32 s49, s49, s50
    s_add_u32 m0, s48, 39936
    s_nop 0
    buffer_load_dwordx4 v7, s[24:27], s49 offen lds
    s_add_u32 s49, s49, s50
    s_add_u32 m0, s48, 43008
    s_nop 0
    buffer_load_dwordx4 v7, s[24:27], s49 offen lds
    s_add_u32 s49, s49, s50
    s_add_u32 m0, s48, 46080
    s_nop 0
    buffer_load_dwordx4 v7, s[24:27], s49 offen lds
    s_add_u32 s49, s49, s50
    buffer_load_dwordx2 v[80:81], v10, s[12:15], s59 offen offset:1024 sc1
    buffer_load_dwordx2 v[82:83], v10, s[12:15], s59 offen offset:1280 sc1
    buffer_load_dwordx2 v[84:85], v10, s[12:15], s59 offen offset:1536 sc1
    buffer_load_dwordx2 v[86:87], v10, s[12:15], s59 offen offset:1792 sc1
    s_waitcnt vmcnt(33)
    s_barrier
    s_add_u32 m0, s48, 49152
    s_nop 0
    buffer_load_dwordx4 v7, s[24:27], s49 offen lds
    s_add_u32 s49, s49, s50
    s_add_u32 m0, s48, 52224
    s_nop 0
    buffer_load_dwordx4 v7, s[24:27], s49 offen lds
    s_add_u32 s49, s49, s50
    s_add_u32 m0, s48, 55296
    s_nop 0
    buffer_load_dwordx4 v7, s[24:27], s49 offen lds
    s_add_u32 s49, s49, s50
    s_add_u32 m0, s48, 58368
    s_nop 0
    buffer_load_dwordx4 v7, s[24:27], s49 offen lds
    s_add_u32 s49, s49, s50
    s_add_u32 m0, s48, 61440
    s_nop 0
    buffer_load_dwordx4 v7, s[24:27], s49 offen lds
    s_add_u32 s49, s49, s50
    s_add_u32 m0, s48, 64512
    s_nop 0
    buffer_load_dwordx4 v7, s[24:27], s49 offen lds
    s_add_u32 s49, s49, s50
    s_add_u32 m0, s48, 67584
    s_nop 0
    buffer_load_dwordx4 v7, s[24:27], s49 offen lds
    s_add_u32 s49, s49, s50
    s_add_u32 m0, s48, 70656
    s_nop 0
    buffer_load_dwordx4 v7, s[24:27], s49 offen lds
    s_add_u32 s49, s49, s50
    buffer_load_dwordx2 v[88:89], v10, s[12:15], s59 offen offset:2048 sc1
    buffer_load_dwordx2 v[90:91], v10, s[12:15], s59 offen offset:2304 sc1
    buffer_load_dwordx2 v[92:93], v10, s[12:15], s59 offen offset:2560 sc1
    buffer_load_dwordx2 v[94:95], v10, s[12:15], s59 offen offset:2816 sc1
    s_waitcnt vmcnt(37)
    s_barrier
    s_add_u32 m0, s48, 73728
    s_nop 0
    buffer_load_dwordx4 v7, s[24:27], s49 offen lds
    s_add_u32 s49, s49, s50
    s_add_u32 m0, s48, 76800
    s_nop 0
    buffer_load_dwordx4 v7, s[24:27], s49 offen lds
    s_add_u32 s49, s49, s50
    s_add_u32 m0, s48, 79872
    s_nop 0
    buffer_load_dwordx4 v7, s[24:27], s49 offen lds
    s_add_u32 s49, s49, s50
    s_add_u32 m0, s48, 82944
    s_nop 0
    buffer_load_dwordx4 v7, s[24:27], s49 offen lds
    s_add_u32 s49, s49, s50
    s_add_u32 m0, s48, 86016
    s_nop 0
    buffer_load_dwordx4 v7, s[24:27], s49 offen lds
    s_add_u32 s49, s49, s50
    s_add_u32 m0, s48, 89088
    s_nop 0
    buffer_load_dwordx4 v7, s[24:27], s49 offen lds
    s_add_u32 s49, s49, s50
    s_add_u32 m0, s48, 92160
    s_nop 0
    buffer_load_dwordx4 v7, s[24:27], s49 offen lds
    s_add_u32 s49, s49, s50
    s_add_u32 m0, s48, 95232
    s_nop 0
    buffer_load_dwordx4 v7, s[24:27], s49 offen lds
    s_add_u32 s49, s49, s50
    buffer_load_dwordx2 v[96:97], v10, s[12:15], s59 offen offset:3072 sc1
    buffer_load_dwordx2 v[98:99], v10, s[12:15], s59 offen offset:3328 sc1
    buffer_load_dwordx2 v[100:101], v10, s[12:15], s59 offen offset:3584 sc1
    buffer_load_dwordx2 v[102:103], v10, s[12:15], s59 offen offset:3840 sc1
    s_waitcnt vmcnt(40)
    s_barrier
    s_add_u32 m0, s48, 98304
    s_nop 0
    buffer_load_dwordx4 v7, s[24:27], s49 offen lds
    s_add_u32 s49, s49, s50
    s_add_u32 m0, s48, 101376
    s_nop 0
    buffer_load_dwordx4 v7, s[24:27], s49 offen lds
    s_add_u32 s49, s49, s50
    s_add_u32 m0, s48, 104448
    s_nop 0
    buffer_load_dwordx4 v7, s[24:27], s49 offen lds
    s_add_u32 s49, s49, s50
    s_add_u32 m0, s48, 107520
    s_nop 0
    buffer_load_dwordx4 v7, s[24:27], s49 offen lds
    s_add_u32 s49, s49, s50
    s_add_u32 m0, s48, 110592
    s_nop 0
    buffer_load_dwordx4 v7, s[24:27], s49 offen lds
    s_add_u32 s49, s49, s50
    s_add_u32 m0, s48, 113664
    s_nop 0
    buffer_load_dwordx4 v7, s[24:27], s49 offen lds
    s_add_u32 s49, s49, s50
    s_add_u32 m0, s48, 116736
    s_nop 0
    buffer_load_dwordx4 v7, s[24:27], s49 offen lds
    s_add_u32 s49, s49, s50
    s_add_u32 m0, s48, 119808
    s_nop 0
    buffer_load_dwordx4 v7, s[24:27], s49 offen lds
    s_add_u32 s49, s49, s50
    s_waitcnt vmcnt(36)
    s_barrier
    s_add_u32 m0, s48, 122880
    s_nop 0
    buffer_load_dwordx4 v7, s[24:27], s49 offen lds
    s_add_u32 s49, s49, s50
    s_add_u32 m0, s48, 125952
    s_nop 0
    buffer_load_dwordx4 v7, s[24:27], s49 offen lds
    s_add_u32 s49, s49, s50
    s_add_u32 m0, s48, 129024
    s_nop 0
    buffer_load_dwordx4 v7, s[24:27], s49 offen lds
    s_add_u32 s49, s49, s50
    s_add_u32 m0, s48, 132096
    s_nop 0
    buffer_load_dwordx4 v7, s[24:27], s49 offen lds
    s_add_u32 s49, s49, s50
    s_add_u32 m0, s48, 135168
    s_nop 0
    buffer_load_dwordx4 v7, s[24:27], s49 offen lds
    s_add_u32 s49, s49, s50
    s_add_u32 m0, s48, 138240
    s_nop 0
    buffer_load_dwordx4 v7, s[24:27], s49 offen lds
    s_add_u32 s49, s49, s50
    s_add_u32 m0, s48, 141312
    s_nop 0
    buffer_load_dwordx4 v7, s[24:27], s49 offen lds
    s_add_u32 s49, s49, s50
    s_add_u32 m0, s48, 144384
    s_nop 0
    buffer_load_dwordx4 v7, s[24:27], s49 offen lds
    s_add_u32 s49, s49, s50
    s_waitcnt vmcnt(16)
    v_add_f32 v72, v72, v88
    v_add_f32 v73, v73, v89
    v_add_f32 v74, v74, v90
    v_add_f32 v75, v75, v91
    v_add_f32 v76, v76, v92
    v_add_f32 v77, v77, v93
    v_add_f32 v78, v78, v94
    v_add_f32 v79, v79, v95
    s_barrier
    s_add_u32 m0, s48, 0
    s_nop 0
    buffer_load_dwordx4 v7, s[24:27], s49 offen lds
    s_add_u32 s49, s49, s50
    s_add_u32 m0, s48, 3072
    s_nop 0
    buffer_load_dwordx4 v7, s[24:27], s49 offen lds
    s_add_u32 s49, s49, s50
    s_add_u32 m0, s48, 6144
    s_nop 0
    buffer_load_dwordx4 v7, s[24:27], s49 offen lds
    s_add_u32 s49, s49, s50
    s_add_u32 m0, s48, 9216
    s_nop 0
    buffer_load_dwordx4 v7, s[24:27], s49 offen lds
    s_add_u32 s49, s49, s50
    s_add_u32 m0, s48, 12288
    s_nop 0
    buffer_load_dwordx4 v7, s[24:27], s49 offen lds
    s_add_u32 s49, s49, s50
    s_add_u32 m0, s48, 15360
    s_nop 0
    buffer_load_dwordx4 v7, s[24:27], s49 offen lds
    s_add_u32 s49, s49, s50
    s_add_u32 m0, s48, 18432
    s_nop 0
    buffer_load_dwordx4 v7, s[24:27], s49 offen lds
    s_add_u32 s49, s49, s50
    s_add_u32 m0, s48, 21504
    s_nop 0
    buffer_load_dwordx4 v7, s[24:27], s49 offen lds
    s_add_u32 s49, s49, s50
    v_add_f32 v80, v80, v96
    v_add_f32 v81, v81, v97
    v_add_f32 v82, v82, v98
    v_add_f32 v83, v83, v99
    v_add_f32 v84, v84, v100
    v_add_f32 v85, v85, v101
    v_add_f32 v86, v86, v102
    v_add_f32 v87, v87, v103
    s_barrier
    s_add_u32 m0, s48, 24576
    s_nop 0
    buffer_load_dwordx4 v7, s[24:27], s49 offen lds
    s_add_u32 s49, s49, s50
    s_add_u32 m0, s48, 27648
    s_nop 0
    buffer_load_dwordx4 v7, s[24:27], s49 offen lds
    s_add_u32 s49, s49, s50
    s_add_u32 m0, s48, 30720
    s_nop 0
    buffer_load_dwordx4 v7, s[24:27], s49 offen lds
    s_add_u32 s49, s49, s50
    s_add_u32 m0, s48, 33792
    s_nop 0
    buffer_load_dwordx4 v7, s[24:27], s49 offen lds
    s_add_u32 s49, s49, s50
    s_add_u32 m0, s48, 36864
    s_nop 0
    buffer_load_dwordx4 v7, s[24:27], s49 offen lds
    s_add_u32 s49, s49, s50
    s_add_u32 m0, s48, 39936
    s_nop 0
    buffer_load_dwordx4 v7, s[24:27], s49 offen lds
    s_add_u32 s49, s49, s50
    s_add_u32 m0, s48, 43008
    s_nop 0
    buffer_load_dwordx4 v7, s[24:27], s49 offen lds
    s_add_u32 s49, s49, s50
    s_add_u32 m0, s48, 46080
    s_nop 0
    buffer_load_dwordx4 v7, s[24:27], s49 offen lds
    s_add_u32 s49, s49, s50
    v_add_f32 v72, v72, v80
    v_add_f32 v73, v73, v81
    v_add_f32 v74, v74, v82
    v_add_f32 v75, v75, v83
    v_add_f32 v76, v76, v84
    v_add_f32 v77, v77, v85
    v_add_f32 v78, v78, v86
    v_add_f32 v79, v79, v87
    s_waitcnt vmcnt(24)
    s_barrier
    s_add_u32 m0, s48, 49152
    s_nop 0
    buffer_load_dwordx4 v7, s[24:27], s49 offen lds
    s_add_u32 s49, s49, s50
    s_add_u32 m0, s48, 52224
    s_nop 0
    buffer_load_dwordx4 v7, s[24:27], s49 offen lds
    s_add_u32 s49, s49, s50
    s_add_u32 m0, s48, 55296
    s_nop 0
    buffer_load_dwordx4 v7, s[24:27], s49 offen lds
    s_add_u32 s49, s49, s50
    s_add_u32 m0, s48, 58368
    s_nop 0
    buffer_load_dwordx4 v7, s[24:27], s49 offen lds
    s_add_u32 s49, s49, s50
    s_add_u32 m0, s48, 61440
    s_nop 0
    buffer_load_dwordx4 v7, s[24:27], s49 offen lds
    s_add_u32 s49, s49, s50
    s_add_u32 m0, s48, 64512
    s_nop 0
    buffer_load_dwordx4 v7, s[24:27], s49 offen lds
    s_add_u32 s49, s49, s50
    s_add_u32 m0, s48, 67584
    s_nop 0
    buffer_load_dwordx4 v7, s[24:27], s49 offen lds
    s_add_u32 s49, s49, s50
    s_add_u32 m0, s48, 70656
    s_nop 0
    buffer_load_dwordx4 v7, s[24:27], s49 offen lds
    s_add_u32 s49, s49, s50
    v_add_f32 v72, v72, v76
    v_add_f32 v73, v73, v77
    v_add_f32 v74, v74, v78
    v_add_f32 v75, v75, v79
    v_add_f32 v72, v72, v74
    v_add_f32 v73, v73, v75
    v_mul_f32 v72, 0x3a800000, v72
    v_mul_f32 v73, 0x3a800000, v73
    s_waitcnt vmcnt(24)
    s_barrier
    s_add_u32 m0, s48, 73728
    s_nop 0
    buffer_load_dwordx4 v7, s[24:27], s49 offen lds
    s_add_u32 s49, s49, s50
    s_add_u32 m0, s48, 76800
    s_nop 0
    buffer_load_dwordx4 v7, s[24:27], s49 offen lds
    s_add_u32 s49, s49, s50
    s_add_u32 m0, s48, 79872
    s_nop 0
    buffer_load_dwordx4 v7, s[24:27], s49 offen lds
    s_add_u32 s49, s49, s50
    s_add_u32 m0, s48, 82944
    s_nop 0
    buffer_load_dwordx4 v7, s[24:27], s49 offen lds
    s_add_u32 s49, s49, s50
    s_add_u32 m0, s48, 86016
    s_nop 0
    buffer_load_dwordx4 v7, s[24:27], s49 offen lds
    s_add_u32 s49, s49, s50
    s_add_u32 m0, s48, 89088
    s_nop 0
    buffer_load_dwordx4 v7, s[24:27], s49 offen lds
    s_add_u32 s49, s49, s50
    s_add_u32 m0, s48, 92160
    s_nop 0
    buffer_load_dwordx4 v7, s[24:27], s49 offen lds
    s_add_u32 s49, s49, s50
    s_add_u32 m0, s48, 95232
    s_nop 0
    buffer_load_dwordx4 v7, s[24:27], s49 offen lds
    s_add_u32 s49, s49, s50
    v_fma_f32 v73, -v72, v72, v73
    v_max_f32 v73, 0, v73
    v_add_f32 v73, 0x3727c5ac, v73
    v_rsq_f32 v73, v73
    ds_write_b32 v11, v72 offset:1280
    ds_write_b32 v11, v73 offset:2304
    s_waitcnt lgkmcnt(0)
    s_waitcnt vmcnt(24)
    s_barrier
    s_waitcnt vmcnt(16)
    s_barrier
    s_waitcnt vmcnt(8)
    s_barrier
    s_waitcnt vmcnt(0)
    s_barrier
    s_mov_b32 s20, s40
    s_mov_b32 s21, s41
    s_mov_b32 s22, 6291456
    s_mov_b32 s23, 0x00020000
    s_mul_i32 s55, s62, 393216
    s_lshl_b32 s56, s63, 7
    s_add_u32 s55, s55, s56
    buffer_load_dwordx4 v[32:35], v12, s[20:23], s55 offen
    s_add_u32 s55, s55, 49152
    buffer_load_dwordx4 v[36:39], v12, s[20:23], s55 offen
    s_add_u32 s55, s55, 49152
    buffer_load_dwordx4 v[40:43], v12, s[20:23], s55 offen
    s_add_u32 s55, s55, 49152
    buffer_load_dwordx4 v[44:47], v12, s[20:23], s55 offen
    s_add_u32 s55, s55, 49152
    buffer_load_dwordx4 v[48:51], v12, s[20:23], s55 offen
    s_add_u32 s55, s55, 49152
    buffer_load_dwordx4 v[52:55], v12, s[20:23], s55 offen
    s_add_u32 s55, s55, 49152
    buffer_load_dwordx4 v[56:59], v12, s[20:23], s55 offen
    s_add_u32 s55, s55, 49152
    buffer_load_dwordx4 v[60:63], v12, s[20:23], s55 offen
    s_add_u32 s55, s55, 49152
    s_barrier
    s_mov_b32 s24, s36
    s_mov_b32 s25, s37
    s_mov_b32 s26, 2097152
    s_mov_b32 s27, 0x00020000
    s_mov_b32 s60, s51
wop_10:
    s_lshl_b32 m0, s60, 10
    s_lshl_b32 s3, s60, 14
    buffer_load_dwordx4 v17, s[24:27], s3 offen lds
    s_add_u32 s60, s60, 3
    s_cmp_lt_u32 s60, 24
    s_cbranch_scc1 wop_10
    s_barrier
    s_waitcnt vmcnt(8)
    v_mfma_f32_16x16x32_bf16 v[64:67], v[24:27], v[32:35], 0
    v_mfma_f32_16x16x32_bf16 v[64:67], v[24:27], v[36:39], v[64:67]
    v_mfma_f32_16x16x32_bf16 v[64:67], v[24:27], v[40:43], v[64:67]
    v_mfma_f32_16x16x32_bf16 v[64:67], v[24:27], v[44:47], v[64:67]
    v_mfma_f32_16x16x32_bf16 v[64:67], v[24:27], v[48:51], v[64:67]
    v_mfma_f32_16x16x32_bf16 v[64:67], v[24:27], v[52:55], v[64:67]
    v_mfma_f32_16x16x32_bf16 v[64:67], v[24:27], v[56:59], v[64:67]
    v_mfma_f32_16x16x32_bf16 v[64:67], v[24:27], v[60:63], v[64:67]
    s_lshr_b32 s55, s63, 4
    s_and_b32 s56, s63, 15
    s_mul_i32 s57, s56, 6
    s_add_u32 s57, s57, s55
    s_lshl_b32 s57, s57, 16
    s_lshl_b32 s58, s62, 12
    s_add_u32 s57, s57, s58
    s_add_u32 s57, s57, 50331648
    buffer_store_dwordx4 v[32:35], v14, s[12:15], s57 offen offset:0 sc1
    buffer_store_dwordx4 v[36:39], v14, s[12:15], s57 offen offset:512 sc1
    buffer_store_dwordx4 v[40:43], v14, s[12:15], s57 offen offset:1024 sc1
    buffer_store_dwordx4 v[44:47], v14, s[12:15], s57 offen offset:1536 sc1
    buffer_store_dwordx4 v[48:51], v14, s[12:15], s57 offen offset:2048 sc1
    buffer_store_dwordx4 v[52:55], v14, s[12:15], s57 offen offset:2560 sc1
    buffer_store_dwordx4 v[56:59], v14, s[12:15], s57 offen offset:3072 sc1
    buffer_store_dwordx4 v[60:63], v14, s[12:15], s57 offen offset:3584 sc1
    v_add_f32_dpp v64, v64, v64 row_ror:8 row_mask:0xf bank_mask:0xf
    v_add_f32_dpp v65, v65, v65 row_ror:8 row_mask:0xf bank_mask:0xf
    v_add_f32_dpp v66, v66, v66 row_ror:8 row_mask:0xf bank_mask:0xf
    v_add_f32_dpp v67, v67, v67 row_ror:8 row_mask:0xf bank_mask:0xf
    s_lshl_b32 s55, s61, 8
    s_add_u32 s55, s55, 58982400
    s_mov_b64 exec, 0x00ff00ff
    buffer_store_dwordx4 v[64:67], v16, s[12:15], s55 offen sc1
    s_mov_b64 exec, -1
wop_11:
    s_lshl_b32 m0, s60, 10
    s_lshl_b32 s3, s60, 14
    buffer_load_dwordx4 v17, s[24:27], s3 offen lds
    s_add_u32 s60, s60, 3
    s_cmp_lt_u32 s60, 128
    s_cbranch_scc1 wop_11
    s_lshl_b32 s55, s61, 2
    s_add_u32 s55, s55, 58756096
    s_mov_b64 exec, 1
    s_waitcnt vmcnt(34)
    buffer_store_dword v9, v8, s[12:15], s55 offen sc1
    s_mov_b64 exec, -1
    s_branch l_wo
.p2align 6
l_qkva:
    v_and_b32 v1, 63, v0
    s_sub_u32 s51, s8, 5
    s_lshl_b32 s48, s51, 10
    v_lshrrev_b32 v20, 3, v1
    v_and_b32 v22, 2, v20
    v_lshrrev_b32 v23, 2, v20
    v_or_b32 v22, v22, v23
    v_bfe_u32 v21, v1, 1, 2
    v_xor_b32 v22, v22, v21
    v_lshlrev_b32 v22, 5, v22
    v_and_b32 v21, 1, v1
    v_lshl_add_u32 v22, v21, 4, v22
    s_lshl_b32 s3, s51, 11
    s_lshl_b32 s52, s7, 7
    s_add_u32 s49, s3, s52
    v_lshl_add_u32 v28, v20, 7, v22
    v_mul_u32_u24 v23, 6144, v20
    v_add_u32 v7, v23, v22
    s_mov_b32 s24, s34
    s_mov_b32 s25, s35
    s_mov_b32 s26, 6291456
    s_mov_b32 s27, 0x00020000
    s_mov_b32 s50, 49152
    s_and_b32 s3, s7, 7
    s_cmp_lg_u32 s3, 3
    s_cbranch_scc1 sw_12
    s_add_u32 s24, s4, 56623104
    s_addc_u32 s25, s5, 0
    s_mov_b32 s26, 1048576
    s_mov_b32 s27, 0x00020000
    s_lshr_b32 s49, s7, 3
    s_mul_i32 s49, s49, 3
    s_add_u32 s49, s49, s51
    s_lshl_b32 s49, s49, 17
    s_add_u32 s49, s49, 0
    s_movk_i32 s50, 1024
    v_mov_b32 v7, v28
sw_12:
    s_add_u32 m0, s48, 0
    s_nop 0
    buffer_load_dwordx4 v7, s[24:27], s49 offen lds
    s_add_u32 s49, s49, s50
    s_add_u32 m0, s48, 3072
    s_nop 0
    buffer_load_dwordx4 v7, s[24:27], s49 offen lds
    s_add_u32 s49, s49, s50
    s_add_u32 m0, s48, 6144
    s_nop 0
    buffer_load_dwordx4 v7, s[24:27], s49 offen lds
    s_add_u32 s49, s49, s50
    s_add_u32 m0, s48, 9216
    s_nop 0
    buffer_load_dwordx4 v7, s[24:27], s49 offen lds
    s_add_u32 s49, s49, s50
    s_add_u32 m0, s48, 12288
    s_nop 0
    buffer_load_dwordx4 v7, s[24:27], s49 offen lds
    s_add_u32 s49, s49, s50
    s_add_u32 m0, s48, 15360
    s_nop 0
    buffer_load_dwordx4 v7, s[24:27], s49 offen lds
    s_add_u32 s49, s49, s50
    s_add_u32 m0, s48, 18432
    s_nop 0
    buffer_load_dwordx4 v7, s[24:27], s49 offen lds
    s_add_u32 s49, s49, s50
    s_add_u32 m0, s48, 21504
    s_nop 0
    buffer_load_dwordx4 v7, s[24:27], s49 offen lds
    s_add_u32 s49, s49, s50
    s_add_u32 m0, s48, 24576
    s_nop 0
    buffer_load_dwordx4 v7, s[24:27], s49 offen lds
    s_add_u32 s49, s49, s50
    s_add_u32 m0, s48, 27648
    s_nop 0
    buffer_load_dwordx4 v7, s[24:27], s49 offen lds
    s_add_u32 s49, s49, s50
    s_add_u32 m0, s48, 30720
    s_nop 0
    buffer_load_dwordx4 v7, s[24:27], s49 offen lds
    s_add_u32 s49, s49, s50
    s_waitcnt vmcnt(10)
    s_add_u32 m0, s48, 33792
    s_nop 0
    buffer_load_dwordx4 v7, s[24:27], s49 offen lds
    s_add_u32 s49, s49, s50
    s_waitcnt vmcnt(10)
    s_add_u32 m0, s48, 36864
    s_nop 0
    buffer_load_dwordx4 v7, s[24:27], s49 offen lds
    s_add_u32 s49, s49, s50
    s_waitcnt vmcnt(10)
    s_add_u32 m0, s48, 39936
    s_nop 0
    buffer_load_dwordx4 v7, s[24:27], s49 offen lds
    s_add_u32 s49, s49, s50
    s_waitcnt vmcnt(10)
    s_add_u32 m0, s48, 43008
    s_nop 0
    buffer_load_dwordx4 v7, s[24:27], s49 offen lds
    s_add_u32 s49, s49, s50
    s_waitcnt vmcnt(10)
    s_add_u32 m0, s48, 46080
    s_nop 0
    buffer_load_dwordx4 v7, s[24:27], s49 offen lds
    s_add_u32 s49, s49, s50
    s_waitcnt vmcnt(10)
    s_add_u32 m0, s48, 49152
    s_nop 0
    buffer_load_dwordx4 v7, s[24:27], s49 offen lds
    s_add_u32 s49, s49, s50
    s_waitcnt vmcnt(10)
    s_add_u32 m0, s48, 52224
    s_nop 0
    buffer_load_dwordx4 v7, s[24:27], s49 offen lds
    s_add_u32 s49, s49, s50
    s_waitcnt vmcnt(10)
    s_add_u32 m0, s48, 55296
    s_nop 0
    buffer_load_dwordx4 v7, s[24:27], s49 offen lds
    s_add_u32 s49, s49, s50
    s_waitcnt vmcnt(10)
    s_add_u32 m0, s48, 58368
    s_nop 0
    buffer_load_dwordx4 v7, s[24:27], s49 offen lds
    s_add_u32 s49, s49, s50
    s_waitcnt vmcnt(10)
    s_add_u32 m0, s48, 61440
    s_nop 0
    buffer_load_dwordx4 v7, s[24:27], s49 offen lds
    s_add_u32 s49, s49, s50
    s_waitcnt vmcnt(10)
    s_add_u32 m0, s48, 64512
    s_nop 0
    buffer_load_dwordx4 v7, s[24:27], s49 offen lds
    s_add_u32 s49, s49, s50
    s_waitcnt vmcnt(10)
    s_add_u32 m0, s48, 67584
    s_nop 0
    buffer_load_dwordx4 v7, s[24:27], s49 offen lds
    s_add_u32 s49, s49, s50
    s_waitcnt vmcnt(10)
    s_add_u32 m0, s48, 70656
    s_nop 0
    buffer_load_dwordx4 v7, s[24:27], s49 offen lds
    s_add_u32 s49, s49, s50
    s_waitcnt vmcnt(10)
    s_add_u32 m0, s48, 73728
    s_nop 0
    buffer_load_dwordx4 v7, s[24:27], s49 offen lds
    s_add_u32 s49, s49, s50
    s_waitcnt vmcnt(10)
    s_add_u32 m0, s48, 76800
    s_nop 0
    buffer_load_dwordx4 v7, s[24:27], s49 offen lds
    s_add_u32 s49, s49, s50
    s_waitcnt vmcnt(10)
    s_add_u32 m0, s48, 79872
    s_nop 0
    buffer_load_dwordx4 v7, s[24:27], s49 offen lds
    s_add_u32 s49, s49, s50
    s_waitcnt vmcnt(10)
    s_add_u32 m0, s48, 82944
    s_nop 0
    buffer_load_dwordx4 v7, s[24:27], s49 offen lds
    s_add_u32 s49, s49, s50
    s_waitcnt vmcnt(10)
    s_add_u32 m0, s48, 86016
    s_nop 0
    buffer_load_dwordx4 v7, s[24:27], s49 offen lds
    s_add_u32 s49, s49, s50
    s_waitcnt vmcnt(10)
    s_add_u32 m0, s48, 89088
    s_nop 0
    buffer_load_dwordx4 v7, s[24:27], s49 offen lds
    s_add_u32 s49, s49, s50
    s_waitcnt vmcnt(10)
    s_add_u32 m0, s48, 92160
    s_nop 0
    buffer_load_dwordx4 v7, s[24:27], s49 offen lds
    s_add_u32 s49, s49, s50
    s_waitcnt vmcnt(10)
    s_add_u32 m0, s48, 95232
    s_nop 0
    buffer_load_dwordx4 v7, s[24:27], s49 offen lds
    s_add_u32 s49, s49, s50
    s_waitcnt vmcnt(10)
    s_add_u32 m0, s48, 98304
    s_nop 0
    buffer_load_dwordx4 v7, s[24:27], s49 offen lds
    s_add_u32 s49, s49, s50
    s_waitcnt vmcnt(10)
    s_add_u32 m0, s48, 101376
    s_nop 0
    buffer_load_dwordx4 v7, s[24:27], s49 offen lds
    s_add_u32 s49, s49, s50
    s_waitcnt vmcnt(10)
    s_add_u32 m0, s48, 104448
    s_nop 0
    buffer_load_dwordx4 v7, s[24:27], s49 offen lds
    s_add_u32 s49, s49, s50
    s_waitcnt vmcnt(10)
    s_add_u32 m0, s48, 107520
    s_nop 0
    buffer_load_dwordx4 v7, s[24:27], s49 offen lds
    s_add_u32 s49, s49, s50
    s_waitcnt vmcnt(10)
    s_add_u32 m0, s48, 110592
    s_nop 0
    buffer_load_dwordx4 v7, s[24:27], s49 offen lds
    s_add_u32 s49, s49, s50
    s_waitcnt vmcnt(10)
    s_add_u32 m0, s48, 113664
    s_nop 0
    buffer_load_dwordx4 v7, s[24:27], s49 offen lds
    s_add_u32 s49, s49, s50
    s_waitcnt vmcnt(10)
    s_add_u32 m0, s48, 116736
    s_nop 0
    buffer_load_dwordx4 v7, s[24:27], s49 offen lds
    s_add_u32 s49, s49, s50
    s_waitcnt vmcnt(10)
    s_add_u32 m0, s48, 119808
    s_nop 0
    buffer_load_dwordx4 v7, s[24:27], s49 offen lds
    s_add_u32 s49, s49, s50
    s_waitcnt vmcnt(10)
    v_lshrrev_b32 v10, 5, v1
    v_and_b32 v11, 31, v1
    v_lshlrev_b32 v11, 3, v11
    v_lshl_add_u32 v10, v10, 12, v11
    s_lshl_b32 s3, s51, 8
    s_add_u32 s3, s3, 155648
    v_lshl_add_u32 v11, v1, 2, s3
    s_lshl_b32 s59, s6, 1
    s_add_u32 s59, s59, s51
    s_sub_u32 s59, s59, 1
    s_max_i32 s59, s59, 0
    s_lshl_b32 s59, s59, 13
    s_lshl_b32 s53, s9, 18
    s_add_u32 s59, s59, s53
    s_add_u32 s59, s59, 57671680
    s_lshl_b32 s3, s7, 7
    v_lshrrev_b32 v20, 3, v1
    v_lshlrev_b32 v21, 11, v20
    v_lshrrev_b32 v22, 2, v1
    v_lshrrev_b32 v23, 4, v1
    v_xor_b32 v22, v22, v23
    v_and_b32 v22, 1, v22
    v_lshl_add_u32 v21, v22, 6, v21
    v_and_b32 v22, 3, v1
    v_lshl_add_u32 v21, v22, 4, v21
    v_add_u32 v17, s3, v21
    s_barrier
    s_barrier
    s_barrier
    s_add_u32 m0, s48, 122880
    s_nop 0
    buffer_load_dwordx4 v7, s[24:27], s49 offen lds
    s_add_u32 s49, s49, s50
    s_add_u32 m0, s48, 125952
    s_nop 0
    buffer_load_dwordx4 v7, s[24:27], s49 offen lds
    s_add_u32 s49, s49, s50
    s_add_u32 m0, s48, 129024
    s_nop 0
    buffer_load_dwordx4 v7, s[24:27], s49 offen lds
    s_add_u32 s49, s49, s50
    s_add_u32 m0, s48, 132096
    s_nop 0
    buffer_load_dwordx4 v7, s[24:27], s49 offen lds
    s_add_u32 s49, s49, s50
    s_add_u32 m0, s48, 135168
    s_nop 0
    buffer_load_dwordx4 v7, s[24:27], s49 offen lds
    s_add_u32 s49, s49, s50
    s_add_u32 m0, s48, 138240
    s_nop 0
    buffer_load_dwordx4 v7, s[24:27], s49 offen lds
    s_add_u32 s49, s49, s50
    s_add_u32 m0, s48, 141312
    s_nop 0
    buffer_load_dwordx4 v7, s[24:27], s49 offen lds
    s_add_u32 s49, s49, s50
    s_add_u32 m0, s48, 144384
    s_nop 0
    buffer_load_dwordx4 v7, s[24:27], s49 offen lds
    s_add_u32 s49, s49, s50
    s_barrier
    s_add_u32 m0, s48, 0
    s_nop 0
    buffer_load_dwordx4 v7, s[24:27], s49 offen lds
    s_add_u32 s49, s49, s50
    s_add_u32 m0, s48, 3072
    s_nop 0
    buffer_load_dwordx4 v7, s[24:27], s49 offen lds
    s_add_u32 s49, s49, s50
    s_add_u32 m0, s48, 6144
    s_nop 0
    buffer_load_dwordx4 v7, s[24:27], s49 offen lds
    s_add_u32 s49, s49, s50
    s_add_u32 m0, s48, 9216
    s_nop 0
    buffer_load_dwordx4 v7, s[24:27], s49 offen lds
    s_add_u32 s49, s49, s50
    s_add_u32 m0, s48, 12288
    s_nop 0
    buffer_load_dwordx4 v7, s[24:27], s49 offen lds
    s_add_u32 s49, s49, s50
    s_add_u32 m0, s48, 15360
    s_nop 0
    buffer_load_dwordx4 v7, s[24:27], s49 offen lds
    s_add_u32 s49, s49, s50
    s_add_u32 m0, s48, 18432
    s_nop 0
    buffer_load_dwordx4 v7, s[24:27], s49 offen lds
    s_add_u32 s49, s49, s50
    s_add_u32 m0, s48, 21504
    s_nop 0
    buffer_load_dwordx4 v7, s[24:27], s49 offen lds
    s_add_u32 s49, s49, s50
    buffer_load_dwordx2 v[72:73], v10, s[12:15], s59 offen offset:0 sc1
    buffer_load_dwordx2 v[74:75], v10, s[12:15], s59 offen offset:256 sc1
    buffer_load_dwordx2 v[76:77], v10, s[12:15], s59 offen offset:512 sc1
    buffer_load_dwordx2 v[78:79], v10, s[12:15], s59 offen offset:768 sc1
    s_waitcnt vmcnt(28)
    s_barrier
    s_add_u32 m0, s48, 24576
    s_nop 0
    buffer_load_dwordx4 v7, s[24:27], s49 offen lds
    s_add_u32 s49, s49, s50
    s_add_u32 m0, s48, 27648
    s_nop 0
    buffer_load_dwordx4 v7, s[24:27], s49 offen lds
    s_add_u32 s49, s49, s50
    s_add_u32 m0, s48, 30720
    s_nop 0
    buffer_load_dwordx4 v7, s[24:27], s49 offen lds
    s_add_u32 s49, s49, s50
    s_add_u32 m0, s48, 33792
    s_nop 0
    buffer_load_dwordx4 v7, s[24:27], s49 offen lds
    s_add_u32 s49, s49, s50
    s_add_u32 m0, s48, 36864
    s_nop 0
    buffer_load_dwordx4 v7, s[24:27], s49 offen lds
    s_add_u32 s49, s49, s50
    s_add_u32 m0, s48, 39936
    s_nop 0
    buffer_load_dwordx4 v7, s[24:27], s49 offen lds
    s_add_u32 s49, s49, s50
    s_add_u32 m0, s48, 43008
    s_nop 0
    buffer_load_dwordx4 v7, s[24:27], s49 offen lds
    s_add_u32 s49, s49, s50
    s_add_u32 m0, s48, 46080
    s_nop 0
    buffer_load_dwordx4 v7, s[24:27], s49 offen lds
    s_add_u32 s49, s49, s50
    buffer_load_dwordx2 v[80:81], v10, s[12:15], s59 offen offset:1024 sc1
    buffer_load_dwordx2 v[82:83], v10, s[12:15], s59 offen offset:1280 sc1
    buffer_load_dwordx2 v[84:85], v10, s[12:15], s59 offen offset:1536 sc1
    buffer_load_dwordx2 v[86:87], v10, s[12:15], s59 offen offset:1792 sc1
    s_waitcnt vmcnt(32)
    s_barrier
    s_add_u32 m0, s48, 49152
    s_nop 0
    buffer_load_dwordx4 v7, s[24:27], s49 offen lds
    s_add_u32 s49, s49, s50
    s_add_u32 m0, s48, 52224
    s_nop 0
    buffer_load_dwordx4 v7, s[24:27], s49 offen lds
    s_add_u32 s49, s49, s50
    s_add_u32 m0, s48, 55296
    s_nop 0
    buffer_load_dwordx4 v7, s[24:27], s49 offen lds
    s_add_u32 s49, s49, s50
    s_add_u32 m0, s48, 58368
    s_nop 0
    buffer_load_dwordx4 v7, s[24:27], s49 offen lds
    s_add_u32 s49, s49, s50
    s_add_u32 m0, s48, 61440
    s_nop 0
    buffer_load_dwordx4 v7, s[24:27], s49 offen lds
    s_add_u32 s49, s49, s50
    s_add_u32 m0, s48, 64512
    s_nop 0
    buffer_load_dwordx4 v7, s[24:27], s49 offen lds
    s_add_u32 s49, s49, s50
    s_add_u32 m0, s48, 67584
    s_nop 0
    buffer_load_dwordx4 v7, s[24:27], s49 offen lds
    s_add_u32 s49, s49, s50
    s_add_u32 m0, s48, 70656
    s_nop 0
    buffer_load_dwordx4 v7, s[24:27], s49 offen lds
    s_add_u32 s49, s49, s50
    buffer_load_dwordx2 v[88:89], v10, s[12:15], s59 offen offset:2048 sc1
    buffer_load_dwordx2 v[90:91], v10, s[12:15], s59 offen offset:2304 sc1
    buffer_load_dwordx2 v[92:93], v10, s[12:15], s59 offen offset:2560 sc1
    buffer_load_dwordx2 v[94:95], v10, s[12:15], s59 offen offset:2816 sc1
    s_waitcnt vmcnt(36)
    s_barrier
    s_add_u32 m0, s48, 73728
    s_nop 0
    buffer_load_dwordx4 v7, s[24:27], s49 offen lds
    s_add_u32 s49, s49, s50
    s_add_u32 m0, s48, 76800
    s_nop 0
    buffer_load_dwordx4 v7, s[24:27], s49 offen lds
    s_add_u32 s49, s49, s50
    s_add_u32 m0, s48, 79872
    s_nop 0
    buffer_load_dwordx4 v7, s[24:27], s49 offen lds
    s_add_u32 s49, s49, s50
    s_add_u32 m0, s48, 82944
    s_nop 0
    buffer_load_dwordx4 v7, s[24:27], s49 offen lds
    s_add_u32 s49, s49, s50
    s_add_u32 m0, s48, 86016
    s_nop 0
    buffer_load_dwordx4 v7, s[24:27], s49 offen lds
    s_add_u32 s49, s49, s50
    s_add_u32 m0, s48, 89088
    s_nop 0
    buffer_load_dwordx4 v7, s[24:27], s49 offen lds
    s_add_u32 s49, s49, s50
    s_add_u32 m0, s48, 92160
    s_nop 0
    buffer_load_dwordx4 v7, s[24:27], s49 offen lds
    s_add_u32 s49, s49, s50
    s_add_u32 m0, s48, 95232
    s_nop 0
    buffer_load_dwordx4 v7, s[24:27], s49 offen lds
    s_add_u32 s49, s49, s50
    buffer_load_dwordx2 v[96:97], v10, s[12:15], s59 offen offset:3072 sc1
    buffer_load_dwordx2 v[98:99], v10, s[12:15], s59 offen offset:3328 sc1
    buffer_load_dwordx2 v[100:101], v10, s[12:15], s59 offen offset:3584 sc1
    buffer_load_dwordx2 v[102:103], v10, s[12:15], s59 offen offset:3840 sc1
    s_waitcnt vmcnt(40)
    s_barrier
    s_add_u32 m0, s48, 98304
    s_nop 0
    buffer_load_dwordx4 v7, s[24:27], s49 offen lds
    s_add_u32 s49, s49, s50
    s_add_u32 m0, s48, 101376
    s_nop 0
    buffer_load_dwordx4 v7, s[24:27], s49 offen lds
    s_add_u32 s49, s49, s50
    s_add_u32 m0, s48, 104448
    s_nop 0
    buffer_load_dwordx4 v7, s[24:27], s49 offen lds
    s_add_u32 s49, s49, s50
    s_add_u32 m0, s48, 107520
    s_nop 0
    buffer_load_dwordx4 v7, s[24:27], s49 offen lds
    s_add_u32 s49, s49, s50
    s_add_u32 m0, s48, 110592
    s_nop 0
    buffer_load_dwordx4 v7, s[24:27], s49 offen lds
    s_add_u32 s49, s49, s50
    s_add_u32 m0, s48, 113664
    s_nop 0
    buffer_load_dwordx4 v7, s[24:27], s49 offen lds
    s_add_u32 s49, s49, s50
    s_add_u32 m0, s48, 116736
    s_nop 0
    buffer_load_dwordx4 v7, s[24:27], s49 offen lds
    s_add_u32 s49, s49, s50
    s_add_u32 m0, s48, 119808
    s_nop 0
    buffer_load_dwordx4 v7, s[24:27], s49 offen lds
    s_add_u32 s49, s49, s50
    s_waitcnt vmcnt(36)
    s_barrier
    s_add_u32 m0, s48, 122880
    s_nop 0
    buffer_load_dwordx4 v7, s[24:27], s49 offen lds
    s_add_u32 s49, s49, s50
    s_add_u32 m0, s48, 125952
    s_nop 0
    buffer_load_dwordx4 v7, s[24:27], s49 offen lds
    s_add_u32 s49, s49, s50
    s_add_u32 m0, s48, 129024
    s_nop 0
    buffer_load_dwordx4 v7, s[24:27], s49 offen lds
    s_add_u32 s49, s49, s50
    s_add_u32 m0, s48, 132096
    s_nop 0
    buffer_load_dwordx4 v7, s[24:27], s49 offen lds
    s_add_u32 s49, s49, s50
    s_add_u32 m0, s48, 135168
    s_nop 0
    buffer_load_dwordx4 v7, s[24:27], s49 offen lds
    s_add_u32 s49, s49, s50
    s_add_u32 m0, s48, 138240
    s_nop 0
    buffer_load_dwordx4 v7, s[24:27], s49 offen lds
    s_add_u32 s49, s49, s50
    s_add_u32 m0, s48, 141312
    s_nop 0
    buffer_load_dwordx4 v7, s[24:27], s49 offen lds
    s_add_u32 s49, s49, s50
    s_add_u32 m0, s48, 144384
    s_nop 0
    buffer_load_dwordx4 v7, s[24:27], s49 offen lds
    s_add_u32 s49, s49, s50
    s_waitcnt vmcnt(16)
    v_add_f32 v72, v72, v88
    v_add_f32 v73, v73, v89
    v_add_f32 v74, v74, v90
    v_add_f32 v75, v75, v91
    v_add_f32 v76, v76, v92
    v_add_f32 v77, v77, v93
    v_add_f32 v78, v78, v94
    v_add_f32 v79, v79, v95
    s_barrier
    s_add_u32 m0, s48, 0
    s_nop 0
    buffer_load_dwordx4 v7, s[24:27], s49 offen lds
    s_add_u32 s49, s49, s50
    s_add_u32 m0, s48, 3072
    s_nop 0
    buffer_load_dwordx4 v7, s[24:27], s49 offen lds
    s_add_u32 s49, s49, s50
    s_add_u32 m0, s48, 6144
    s_nop 0
    buffer_load_dwordx4 v7, s[24:27], s49 offen lds
    s_add_u32 s49, s49, s50
    s_add_u32 m0, s48, 9216
    s_nop 0
    buffer_load_dwordx4 v7, s[24:27], s49 offen lds
    s_add_u32 s49, s49, s50
    s_add_u32 m0, s48, 12288
    s_nop 0
    buffer_load_dwordx4 v7, s[24:27], s49 offen lds
    s_add_u32 s49, s49, s50
    s_add_u32 m0, s48, 15360
    s_nop 0
    buffer_load_dwordx4 v7, s[24:27], s49 offen lds
    s_add_u32 s49, s49, s50
    s_add_u32 m0, s48, 18432
    s_nop 0
    buffer_load_dwordx4 v7, s[24:27], s49 offen lds
    s_add_u32 s49, s49, s50
    s_add_u32 m0, s48, 21504
    s_nop 0
    buffer_load_dwordx4 v7, s[24:27], s49 offen lds
    s_add_u32 s49, s49, s50
    v_add_f32 v80, v80, v96
    v_add_f32 v81, v81, v97
    v_add_f32 v82, v82, v98
    v_add_f32 v83, v83, v99
    v_add_f32 v84, v84, v100
    v_add_f32 v85, v85, v101
    v_add_f32 v86, v86, v102
    v_add_f32 v87, v87, v103
    s_barrier
    s_add_u32 m0, s48, 24576
    s_nop 0
    buffer_load_dwordx4 v7, s[24:27], s49 offen lds
    s_add_u32 s49, s49, s50
    s_add_u32 m0, s48, 27648
    s_nop 0
    buffer_load_dwordx4 v7, s[24:27], s49 offen lds
    s_add_u32 s49, s49, s50
    s_add_u32 m0, s48, 30720
    s_nop 0
    buffer_load_dwordx4 v7, s[24:27], s49 offen lds
    s_add_u32 s49, s49, s50
    s_add_u32 m0, s48, 33792
    s_nop 0
    buffer_load_dwordx4 v7, s[24:27], s49 offen lds
    s_add_u32 s49, s49, s50
    s_add_u32 m0, s48, 36864
    s_nop 0
    buffer_load_dwordx4 v7, s[24:27], s49 offen lds
    s_add_u32 s49, s49, s50
    s_add_u32 m0, s48, 39936
    s_nop 0
    buffer_load_dwordx4 v7, s[24:27], s49 offen lds
    s_add_u32 s49, s49, s50
    s_add_u32 m0, s48, 43008
    s_nop 0
    buffer_load_dwordx4 v7, s[24:27], s49 offen lds
    s_add_u32 s49, s49, s50
    s_add_u32 m0, s48, 46080
    s_nop 0
    buffer_load_dwordx4 v7, s[24:27], s49 offen lds
    s_add_u32 s49, s49, s50
    v_add_f32 v72, v72, v80
    v_add_f32 v73, v73, v81
    v_add_f32 v74, v74, v82
    v_add_f32 v75, v75, v83
    v_add_f32 v76, v76, v84
    v_add_f32 v77, v77, v85
    v_add_f32 v78, v78, v86
    v_add_f32 v79, v79, v87
    s_waitcnt vmcnt(24)
    s_barrier
    s_add_u32 m0, s48, 49152
    s_nop 0
    buffer_load_dwordx4 v7, s[24:27], s49 offen lds
    s_add_u32 s49, s49, s50
    s_add_u32 m0, s48, 52224
    s_nop 0
    buffer_load_dwordx4 v7, s[24:27], s49 offen lds
    s_add_u32 s49, s49, s50
    s_add_u32 m0, s48, 55296
    s_nop 0
    buffer_load_dwordx4 v7, s[24:27], s49 offen lds
    s_add_u32 s49, s49, s50
    s_add_u32 m0, s48, 58368
    s_nop 0
    buffer_load_dwordx4 v7, s[24:27], s49 offen lds
    s_add_u32 s49, s49, s50
    s_add_u32 m0, s48, 61440
    s_nop 0
    buffer_load_dwordx4 v7, s[24:27], s49 offen lds
    s_add_u32 s49, s49, s50
    s_add_u32 m0, s48, 64512
    s_nop 0
    buffer_load_dwordx4 v7, s[24:27], s49 offen lds
    s_add_u32 s49, s49, s50
    s_add_u32 m0, s48, 67584
    s_nop 0
    buffer_load_dwordx4 v7, s[24:27], s49 offen lds
    s_add_u32 s49, s49, s50
    s_add_u32 m0, s48, 70656
    s_nop 0
    buffer_load_dwordx4 v7, s[24:27], s49 offen lds
    s_add_u32 s49, s49, s50
    v_add_f32 v72, v72, v76
    v_add_f32 v73, v73, v77
    v_add_f32 v74, v74, v78
    v_add_f32 v75, v75, v79
    v_add_f32 v72, v72, v74
    v_add_f32 v73, v73, v75
    v_mul_f32 v72, 0x3a800000, v72
    v_mul_f32 v73, 0x3a800000, v73
    s_waitcnt vmcnt(24)
    s_barrier
    s_add_u32 m0, s48, 73728
    s_nop 0
    buffer_load_dwordx4 v7, s[24:27], s49 offen lds
    s_add_u32 s49, s49, s50
    s_add_u32 m0, s48, 76800
    s_nop 0
    buffer_load_dwordx4 v7, s[24:27], s49 offen lds
    s_add_u32 s49, s49, s50
    s_add_u32 m0, s48, 79872
    s_nop 0
    buffer_load_dwordx4 v7, s[24:27], s49 offen lds
    s_add_u32 s49, s49, s50
    s_add_u32 m0, s48, 82944
    s_nop 0
    buffer_load_dwordx4 v7, s[24:27], s49 offen lds
    s_add_u32 s49, s49, s50
    s_add_u32 m0, s48, 86016
    s_nop 0
    buffer_load_dwordx4 v7, s[24:27], s49 offen lds
    s_add_u32 s49, s49, s50
    s_add_u32 m0, s48, 89088
    s_nop 0
    buffer_load_dwordx4 v7, s[24:27], s49 offen lds
    s_add_u32 s49, s49, s50
    s_add_u32 m0, s48, 92160
    s_nop 0
    buffer_load_dwordx4 v7, s[24:27], s49 offen lds
    s_add_u32 s49, s49, s50
    s_add_u32 m0, s48, 95232
    s_nop 0
    buffer_load_dwordx4 v7, s[24:27], s49 offen lds
    s_add_u32 s49, s49, s50
    v_fma_f32 v73, -v72, v72, v73
    v_max_f32 v73, 0, v73
    v_add_f32 v73, 0x3727c5ac, v73
    v_rsq_f32 v73, v73
    ds_write_b32 v11, v72 offset:1280
    ds_write_b32 v11, v73 offset:2304
    s_waitcnt lgkmcnt(0)
    s_waitcnt vmcnt(24)
    s_barrier
    s_waitcnt vmcnt(16)
    s_barrier
    s_waitcnt vmcnt(8)
    s_barrier
    s_waitcnt vmcnt(0)
    s_barrier
    s_barrier
    s_mov_b32 s24, s36
    s_mov_b32 s25, s37
    s_mov_b32 s26, 2097152
    s_mov_b32 s27, 0x00020000
    s_mov_b32 s60, s51
wop_13:
    s_lshl_b32 m0, s60, 10
    s_lshl_b32 s3, s60, 14
    buffer_load_dwordx4 v17, s[24:27], s3 offen lds
    s_add_u32 s60, s60, 3
    s_cmp_lt_u32 s60, 60
    s_cbranch_scc1 wop_13
    s_barrier
wop_14:
    s_lshl_b32 m0, s60, 10
    s_lshl_b32 s3, s60, 14
    buffer_load_dwordx4 v17, s[24:27], s3 offen lds
    s_add_u32 s60, s60, 3
    s_cmp_lt_u32 s60, 128
    s_cbranch_scc1 wop_14
    s_branch l_wo
.p2align 6
h_wo:
    s_mul_i32 s54, s9, 393216
    s_add_u32 s54, s54, 60162048
    s_lshl_b32 s55, s11, 9
    s_add_u32 s54, s54, s55
    s_add_u32 s52, s4, s54
    s_addc_u32 s53, s5, 0
    s_mov_b32 s54, s10
    s_mov_b32 s55, s10
    s_bitcmp1_b32 s9, 0
    s_cbranch_scc1 h_wo_b
    s_mov_b32 s58, 0x20000
poll_15:
    s_load_dwordx4 s[64:67], s[52:53], 0 glc
    s_load_dwordx4 s[68:71], s[52:53], 128 glc
    s_load_dwordx4 s[72:75], s[52:53], 256 glc
    s_load_dwordx4 s[76:79], s[52:53], 384 glc
    s_sub_u32 s58, s58, 1
    s_cbranch_scc1 poll_15_ok
    s_waitcnt lgkmcnt(0)
    s_xor_b64 s[56:57], s[64:65], s[54:55]
    s_xor_b64 s[64:65], s[66:67], s[54:55]
    s_or_b64 s[56:57], s[56:57], s[64:65]
    s_xor_b64 s[64:65], s[68:69], s[54:55]
    s_or_b64 s[56:57], s[56:57], s[64:65]
    s_xor_b64 s[64:65], s[70:71], s[54:55]
    s_or_b64 s[56:57], s[56:57], s[64:65]
    s_xor_b64 s[64:65], s[72:73], s[54:55]
    s_or_b64 s[56:57], s[56:57], s[64:65]
    s_xor_b64 s[64:65], s[74:75], s[54:55]
    s_or_b64 s[56:57], s[56:57], s[64:65]
    s_xor_b64 s[64:65], s[76:77], s[54:55]
    s_or_b64 s[56:57], s[56:57], s[64:65]
    s_xor_b64 s[64:65], s[78:79], s[54:55]
    s_or_b64 s[56:57], s[56:57], s[64:65]
    s_cbranch_scc1 poll_15
poll_15_ok:
    s_waitcnt lgkmcnt(0)
    s_cmp_lg_u32 s9, 0
    s_cbranch_scc1 l_wo
    s_barrier
    v_and_b32 v1, 63, v0
    v_lshrrev_b32 v10, 4, v1
    v_min_u32 v10, 2, v10
    v_and_b32 v11, 15, v1
    v_lshlrev_b32 v11, 3, v11
    v_lshl_add_u32 v12, v10, 7, v11
    v_add_u32 v12, 156416, v12
    v_lshl_add_u32 v10, v10, 16, v11
    s_lshl_b32 s54, s7, 6
    s_add_u32 s54, s54, 58756096
    s_add_u32 s52, s4, s54
    s_addc_u32 s53, s5, 0
    s_mov_b32 s54, s10
    s_mov_b32 s55, s10
    s_mov_b32 s58, 0x20000
uf_16:
    s_load_dwordx16 s[64:79], s[52:53], 0 glc
    s_load_dwordx16 s[80:95], s[52:53], 1024 glc
    s_sub_u32 s58, s58, 1
    s_cbranch_scc1 uf_16_ok
    s_waitcnt lgkmcnt(0)
    s_xor_b64 s[56:57], s[64:65], s[54:55]
    s_xor_b64 s[64:65], s[66:67], s[54:55]
    s_or_b64 s[56:57], s[56:57], s[64:65]
    s_xor_b64 s[64:65], s[68:69], s[54:55]
    s_or_b64 s[56:57], s[56:57], s[64:65]
    s_xor_b64 s[64:65], s[70:71], s[54:55]
    s_or_b64 s[56:57], s[56:57], s[64:65]
    s_xor_b64 s[64:65], s[72:73], s[54:55]
    s_or_b64 s[56:57], s[56:57], s[64:65]
    s_xor_b64 s[64:65], s[74:75], s[54:55]
    s_or_b64 s[56:57], s[56:57], s[64:65]
    s_xor_b64 s[64:65], s[76:77], s[54:55]
    s_or_b64 s[56:57], s[56:57], s[64:65]
    s_xor_b64 s[64:65], s[78:79], s[54:55]
    s_or_b64 s[56:57], s[56:57], s[64:65]
    s_xor_b64 s[64:65], s[80:81], s[54:55]
    s_or_b64 s[56:57], s[56:57], s[64:65]
    s_xor_b64 s[64:65], s[82:83], s[54:55]
    s_or_b64 s[56:57], s[56:57], s[64:65]
    s_xor_b64 s[64:65], s[84:85], s[54:55]
    s_or_b64 s[56:57], s[56:57], s[64:65]
    s_xor_b64 s[64:65], s[86:87], s[54:55]
    s_or_b64 s[56:57], s[56:57], s[64:65]
    s_xor_b64 s[64:65], s[88:89], s[54:55]
    s_or_b64 s[56:57], s[56:57], s[64:65]
    s_xor_b64 s[64:65], s[90:91], s[54:55]
    s_or_b64 s[56:57], s[56:57], s[64:65]
    s_xor_b64 s[64:65], s[92:93], s[54:55]
    s_or_b64 s[56:57], s[56:57], s[64:65]
    s_xor_b64 s[64:65], s[94:95], s[54:55]
    s_or_b64 s[56:57], s[56:57], s[64:65]
    s_cbranch_scc1 uf_16
uf_16_ok:
    s_waitcnt lgkmcnt(0)
    s_mov_b32 s58, 0x20000
uf_17:
    s_load_dwordx16 s[64:79], s[52:53], 2048 glc
    s_sub_u32 s58, s58, 1
    s_cbranch_scc1 uf_17_ok
    s_waitcnt lgkmcnt(0)
    s_xor_b64 s[56:57], s[64:65], s[54:55]
    s_xor_b64 s[64:65], s[66:67], s[54:55]
    s_or_b64 s[56:57], s[56:57], s[64:65]
    s_xor_b64 s[64:65], s[68:69], s[54:55]
    s_or_b64 s[56:57], s[56:57], s[64:65]
    s_xor_b64 s[64:65], s[70:71], s[54:55]
    s_or_b64 s[56:57], s[56:57], s[64:65]
    s_xor_b64 s[64:65], s[72:73], s[54:55]
    s_or_b64 s[56:57], s[56:57], s[64:65]
    s_xor_b64 s[64:65], s[74:75], s[54:55]
    s_or_b64 s[56:57], s[56:57], s[64:65]
    s_xor_b64 s[64:65], s[76:77], s[54:55]
    s_or_b64 s[56:57], s[56:57], s[64:65]
    s_xor_b64 s[64:65], s[78:79], s[54:55]
    s_or_b64 s[56:57], s[56:57], s[64:65]
    s_cbranch_scc1 uf_17
uf_17_ok:
    s_waitcnt lgkmcnt(0)
    s_lshl_b32 s56, s7, 12
    s_and_b32 s57, s6, 1
    s_lshl_b32 s57, s57, 7
    s_add_u32 s56, s56, s57
    s_add_u32 s56, s56, 58982400
    buffer_load_dwordx2 v[32:33], v10, s[12:15], s56 offen offset:0 sc1
    buffer_load_dwordx2 v[34:35], v10, s[12:15], s56 offen offset:256 sc1
    buffer_load_dwordx2 v[36:37], v10, s[12:15], s56 offen offset:512 sc1
    buffer_load_dwordx2 v[38:39], v10, s[12:15], s56 offen offset:768 sc1
    buffer_load_dwordx2 v[40:41], v10, s[12:15], s56 offen offset:1024 sc1
    buffer_load_dwordx2 v[42:43], v10, s[12:15], s56 offen offset:1280 sc1
    buffer_load_dwordx2 v[44:45], v10, s[12:15], s56 offen offset:1536 sc1
    buffer_load_dwordx2 v[46:47], v10, s[12:15], s56 offen offset:1792 sc1
    buffer_load_dwordx2 v[48:49], v10, s[12:15], s56 offen offset:2048 sc1
    buffer_load_dwordx2 v[50:51], v10, s[12:15], s56 offen offset:2304 sc1
    buffer_load_dwordx2 v[52:53], v10, s[12:15], s56 offen offset:2560 sc1
    buffer_load_dwordx2 v[54:55], v10, s[12:15], s56 offen offset:2816 sc1
    buffer_load_dwordx2 v[56:57], v10, s[12:15], s56 offen offset:3072 sc1
    buffer_load_dwordx2 v[58:59], v10, s[12:15], s56 offen offset:3328 sc1
    buffer_load_dwordx2 v[60:61], v10, s[12:15], s56 offen offset:3584 sc1
    buffer_load_dwordx2 v[62:63], v10, s[12:15], s56 offen offset:3840 sc1
    s_waitcnt vmcnt(0)
    v_add_f32 v32, v32, v48
    v_add_f32 v33, v33, v49
    v_add_f32 v34, v34, v50
    v_add_f32 v35, v35, v51
    v_add_f32 v36, v36, v52
    v_add_f32 v37, v37, v53
    v_add_f32 v38, v38, v54
    v_add_f32 v39, v39, v55
    v_add_f32 v40, v40, v56
    v_add_f32 v41, v41, v57
    v_add_f32 v42, v42, v58
    v_add_f32 v43, v43, v59
    v_add_f32 v44, v44, v60
    v_add_f32 v45, v45, v61
    v_add_f32 v46, v46, v62
    v_add_f32 v47, v47, v63
    v_add_f32 v32, v32, v40
    v_add_f32 v33, v33, v41
    v_add_f32 v34, v34, v42
    v_add_f32 v35, v35, v43
    v_add_f32 v36, v36, v44
    v_add_f32 v37, v37, v45
    v_add_f32 v38, v38, v46
    v_add_f32 v39, v39, v47
    v_add_f32 v32, v32, v36
    v_add_f32 v33, v33, v37
    v_add_f32 v34, v34, v38
    v_add_f32 v35, v35, v39
    v_add_f32 v32, v32, v34
    v_add_f32 v33, v33, v35
    ds_write_b64 v12, v[32:33]
    s_waitcnt lgkmcnt(0)
    s_branch l_wo_end
h_wo_b:
    s_mov_b32 s58, 0x20000
poll_18:
    s_load_dwordx8 s[64:71], s[52:53], 0 glc
    s_load_dwordx8 s[72:79], s[52:53], 128 glc
    s_load_dwordx8 s[80:87], s[52:53], 256 glc
    s_load_dwordx8 s[88:95], s[52:53], 384 glc
    s_sub_u32 s58, s58, 1
    s_cbranch_scc1 poll_18_ok
    s_waitcnt lgkmcnt(0)
    s_xor_b64 s[56:57], s[64:65], s[54:55]
    s_xor_b64 s[64:65], s[66:67], s[54:55]
    s_or_b64 s[56:57], s[56:57], s[64:65]
    s_xor_b64 s[64:65], s[68:69], s[54:55]
    s_or_b64 s[56:57], s[56:57], s[64:65]
    s_xor_b64 s[64:65], s[70:71], s[54:55]
    s_or_b64 s[56:57], s[56:57], s[64:65]
    s_xor_b64 s[64:65], s[72:73], s[54:55]
    s_or_b64 s[56:57], s[56:57], s[64:65]
    s_xor_b64 s[64:65], s[74:75], s[54:55]
    s_or_b64 s[56:57], s[56:57], s[64:65]
    s_xor_b64 s[64:65], s[76:77], s[54:55]
    s_or_b64 s[56:57], s[56:57], s[64:65]
    s_xor_b64 s[64:65], s[78:79], s[54:55]
    s_or_b64 s[56:57], s[56:57], s[64:65]
    s_xor_b64 s[64:65], s[80:81], s[54:55]
    s_or_b64 s[56:57], s[56:57], s[64:65]
    s_xor_b64 s[64:65], s[82:83], s[54:55]
    s_or_b64 s[56:57], s[56:57], s[64:65]
    s_xor_b64 s[64:65], s[84:85], s[54:55]
    s_or_b64 s[56:57], s[56:57], s[64:65]
    s_xor_b64 s[64:65], s[86:87], s[54:55]
    s_or_b64 s[56:57], s[56:57], s[64:65]
    s_xor_b64 s[64:65], s[88:89], s[54:55]
    s_or_b64 s[56:57], s[56:57], s[64:65]
    s_xor_b64 s[64:65], s[90:91], s[54:55]
    s_or_b64 s[56:57], s[56:57], s[64:65]
    s_xor_b64 s[64:65], s[92:93], s[54:55]
    s_or_b64 s[56:57], s[56:57], s[64:65]
    s_xor_b64 s[64:65], s[94:95], s[54:55]
    s_or_b64 s[56:57], s[56:57], s[64:65]
    s_cbranch_scc1 poll_18
poll_18_ok:
    s_waitcnt lgkmcnt(0)
l_wo:
    s_waitcnt vmcnt(0)
    s_barrier
l_wo_end:
    s_barrier
    s_add_u32 s9, s9, 1
    s_cmp_eq_u32 s9, 4
    s_cbranch_scc1 k_exit
    s_cmp_eq_u32 s8, 4
    s_cbranch_scc1 h_next
    s_cmp_eq_u32 s9, 2
    s_cbranch_scc1 l_qkva
    s_branch l_qkvb
h_next:
    s_cmp_eq_u32 s9, 2
    s_cbranch_scc1 h_qkva
    s_branch h_qkvb
.p2align 6
h_qkvb:
    s_sub_u32 s9, s9, 1
    s_mul_i32 s54, s9, 393216
    s_add_u32 s54, s54, 60293120
    s_lshl_b32 s55, s11, 9
    s_add_u32 s54, s54, s55
    s_add_u32 s52, s4, s54
    s_addc_u32 s53, s5, 0
    s_mov_b32 s54, s10
    s_mov_b32 s55, s10
    s_add_u32 s9, s9, 1
    v_and_b32 v1, 63, v0
    v_lshlrev_b32 v5, 4, v1
    s_sub_u32 s50, s8, 4
    v_lshrrev_b32 v10, 5, v1
    v_and_b32 v11, 31, v1
    v_lshlrev_b32 v11, 3, v11
    v_lshl_add_u32 v10, v10, 12, v11
    s_lshl_b32 s3, s50, 8
    s_add_u32 s3, s3, 155648
    v_lshl_add_u32 v11, v1, 2, s3
    s_lshr_b32 s3, s6, 1
    s_lshl_b32 s3, s3, 2
    s_add_u32 s50, s50, s3
    s_lshl_b32 s50, s50, 13
    s_lshl_b32 s3, s9, 18
    s_add_u32 s50, s50, s3
    s_add_u32 s50, s50, 57671680
    s_mov_b32 s58, 0x20000
poll_19:
    s_load_dwordx8 s[64:71], s[52:53], 0 glc
    s_load_dwordx8 s[72:79], s[52:53], 128 glc
    s_load_dwordx8 s[80:87], s[52:53], 256 glc
    s_load_dwordx8 s[88:95], s[52:53], 384 glc
    s_sub_u32 s58, s58, 1
    s_cbranch_scc1 poll_19_ok
    s_waitcnt lgkmcnt(0)
    s_xor_b64 s[56:57], s[64:65], s[54:55]
    s_xor_b64 s[64:65], s[66:67], s[54:55]
    s_or_b64 s[56:57], s[56:57], s[64:65]
    s_xor_b64 s[64:65], s[68:69], s[54:55]
    s_or_b64 s[56:57], s[56:57], s[64:65]
    s_xor_b64 s[64:65], s[70:71], s[54:55]
    s_or_b64 s[56:57], s[56:57], s[64:65]
    s_xor_b64 s[64:65], s[72:73], s[54:55]
    s_or_b64 s[56:57], s[56:57], s[64:65]
    s_xor_b64 s[64:65], s[74:75], s[54:55]
    s_or_b64 s[56:57], s[56:57], s[64:65]
    s_xor_b64 s[64:65], s[76:77], s[54:55]
    s_or_b64 s[56:57], s[56:57], s[64:65]
    s_xor_b64 s[64:65], s[78:79], s[54:55]
    s_or_b64 s[56:57], s[56:57], s[64:65]
    s_xor_b64 s[64:65], s[80:81], s[54:55]
    s_or_b64 s[56:57], s[56:57], s[64:65]
    s_xor_b64 s[64:65], s[82:83], s[54:55]
    s_or_b64 s[56:57], s[56:57], s[64:65]
    s_xor_b64 s[64:65], s[84:85], s[54:55]
    s_or_b64 s[56:57], s[56:57], s[64:65]
    s_xor_b64 s[64:65], s[86:87], s[54:55]
    s_or_b64 s[56:57], s[56:57], s[64:65]
    s_xor_b64 s[64:65], s[88:89], s[54:55]
    s_or_b64 s[56:57], s[56:57], s[64:65]
    s_xor_b64 s[64:65], s[90:91], s[54:55]
    s_or_b64 s[56:57], s[56:57], s[64:65]
    s_xor_b64 s[64:65], s[92:93], s[54:55]
    s_or_b64 s[56:57], s[56:57], s[64:65]
    s_xor_b64 s[64:65], s[94:95], s[54:55]
    s_or_b64 s[56:57], s[56:57], s[64:65]
    s_cbranch_scc1 poll_19
poll_19_ok:
    s_waitcnt lgkmcnt(0)
    s_barrier
    s_barrier
    buffer_load_dwordx2 v[32:33], v10, s[12:15], s50 offen offset:0 sc1
    buffer_load_dwordx2 v[34:35], v10, s[12:15], s50 offen offset:256 sc1
    buffer_load_dwordx2 v[36:37], v10, s[12:15], s50 offen offset:512 sc1
    buffer_load_dwordx2 v[38:39], v10, s[12:15], s50 offen offset:768 sc1
    buffer_load_dwordx2 v[40:41], v10, s[12:15], s50 offen offset:1024 sc1
    buffer_load_dwordx2 v[42:43], v10, s[12:15], s50 offen offset:1280 sc1
    buffer_load_dwordx2 v[44:45], v10, s[12:15], s50 offen offset:1536 sc1
    s_barrier
    buffer_load_dwordx2 v[46:47], v10, s[12:15], s50 offen offset:1792 sc1
    buffer_load_dwordx2 v[48:49], v10, s[12:15], s50 offen offset:2048 sc1
    buffer_load_dwordx2 v[50:51], v10, s[12:15], s50 offen offset:2304 sc1
    buffer_load_dwordx2 v[52:53], v10, s[12:15], s50 offen offset:2560 sc1
    buffer_load_dwordx2 v[54:55], v10, s[12:15], s50 offen offset:2816 sc1
    buffer_load_dwordx2 v[56:57], v10, s[12:15], s50 offen offset:3072 sc1
    buffer_load_dwordx2 v[58:59], v10, s[12:15], s50 offen offset:3328 sc1
    s_barrier
    buffer_load_dwordx2 v[60:61], v10, s[12:15], s50 offen offset:3584 sc1
    buffer_load_dwordx2 v[62:63], v10, s[12:15], s50 offen offset:3840 sc1
    s_barrier
    s_waitcnt vmcnt(0)
    v_add_f32 v32, v32, v48
    v_add_f32 v33, v33, v49
    v_add_f32 v34, v34, v50
    v_add_f32 v35, v35, v51
    v_add_f32 v36, v36, v52
    v_add_f32 v37, v37, v53
    v_add_f32 v38, v38, v54
    v_add_f32 v39, v39, v55
    v_add_f32 v40, v40, v56
    v_add_f32 v41, v41, v57
    v_add_f32 v42, v42, v58
    v_add_f32 v43, v43, v59
    v_add_f32 v44, v44, v60
    s_barrier
    v_add_f32 v45, v45, v61
    v_add_f32 v46, v46, v62
    v_add_f32 v47, v47, v63
    v_add_f32 v32, v32, v40
    v_add_f32 v33, v33, v41
    v_add_f32 v34, v34, v42
    v_add_f32 v35, v35, v43
    v_add_f32 v36, v36, v44
    v_add_f32 v37, v37, v45
    v_add_f32 v38, v38, v46
    v_add_f32 v39, v39, v47
    v_add_f32 v32, v32, v36
    v_add_f32 v33, v33, v37
    s_barrier
    v_add_f32 v34, v34, v38
    v_add_f32 v35, v35, v39
    v_add_f32 v32, v32, v34
    v_add_f32 v33, v33, v35
    v_mul_f32 v32, 0x3a800000, v32
    v_mul_f32 v33, 0x3a800000, v33
    v_fma_f32 v33, -v32, v32, v33
    v_max_f32 v33, 0, v33
    v_add_f32 v33, 0x3727c5ac, v33
    v_rsq_f32 v33, v33
    ds_write_b32 v11, v32 offset:1280
    ds_write_b32 v11, v33 offset:2304
    s_waitcnt lgkmcnt(0)
    s_barrier
    s_barrier
    s_branch s_attn
.p2align 6
l_qkvb:
    v_and_b32 v1, 63, v0
    v_lshlrev_b32 v5, 4, v1
    s_sub_u32 s51, s8, 5
    s_lshl_b32 s48, s51, 13
    s_lshl_b32 s49, s7, 1
    s_and_b32 s52, s6, 1
    s_add_u32 s49, s49, s52
    s_mul_i32 s49, s49, 3
    s_add_u32 s49, s49, s51
    s_lshl_b32 s49, s49, 16
    s_add_u32 s49, s49, 50331648
    s_add_u32 m0, s48, 0
    s_nop 0
    buffer_load_dwordx4 v5, s[12:15], s49 offen offset:0 sc1 lds
    buffer_load_dwordx4 v5, s[12:15], s49 offen offset:1024 sc1 lds
    buffer_load_dwordx4 v5, s[12:15], s49 offen offset:2048 sc1 lds
    buffer_load_dwordx4 v5, s[12:15], s49 offen offset:3072 sc1 lds
    s_add_u32 s49, s49, 4096
    s_add_u32 m0, s48, 4096
    s_nop 0
    buffer_load_dwordx4 v5, s[12:15], s49 offen offset:0 sc1 lds
    buffer_load_dwordx4 v5, s[12:15], s49 offen offset:1024 sc1 lds
    buffer_load_dwordx4 v5, s[12:15], s49 offen offset:2048 sc1 lds
    buffer_load_dwordx4 v5, s[12:15], s49 offen offset:3072 sc1 lds
    s_add_u32 s49, s49, 4096
    s_add_u32 m0, s48, 24576
    s_nop 0
    buffer_load_dwordx4 v5, s[12:15], s49 offen offset:0 sc1 lds
    buffer_load_dwordx4 v5, s[12:15], s49 offen offset:1024 sc1 lds
    buffer_load_dwordx4 v5, s[12:15], s49 offen offset:2048 sc1 lds
    s_waitcnt vmcnt(10)
    buffer_load_dwordx4 v5, s[12:15], s49 offen offset:3072 sc1 lds
    s_waitcnt vmcnt(10)
    s_add_u32 s49, s49, 4096
    s_add_u32 m0, s48, 28672
    s_nop 0
    buffer_load_dwordx4 v5, s[12:15], s49 offen offset:0 sc1 lds
    s_waitcnt vmcnt(10)
    buffer_load_dwordx4 v5, s[12:15], s49 offen offset:1024 sc1 lds
    s_waitcnt vmcnt(10)
    buffer_load_dwordx4 v5, s[12:15], s49 offen offset:2048 sc1 lds
    s_waitcnt vmcnt(10)
    buffer_load_dwordx4 v5, s[12:15], s49 offen offset:3072 sc1 lds
    s_waitcnt vmcnt(10)
    s_add_u32 s49, s49, 4096
    s_add_u32 m0, s48, 49152
    s_nop 0
    buffer_load_dwordx4 v5, s[12:15], s49 offen offset:0 sc1 lds
    s_waitcnt vmcnt(10)
    buffer_load_dwordx4 v5, s[12:15], s49 offen offset:1024 sc1 lds
    s_waitcnt vmcnt(10)
    buffer_load_dwordx4 v5, s[12:15], s49 offen offset:2048 sc1 lds
    s_waitcnt vmcnt(10)
    buffer_load_dwordx4 v5, s[12:15], s49 offen offset:3072 sc1 lds
    s_waitcnt vmcnt(10)
    s_add_u32 s49, s49, 4096
    s_add_u32 m0, s48, 53248
    s_nop 0
    buffer_load_dwordx4 v5, s[12:15], s49 offen offset:0 sc1 lds
    s_waitcnt vmcnt(10)
    buffer_load_dwordx4 v5, s[12:15], s49 offen offset:1024 sc1 lds
    s_waitcnt vmcnt(10)
    buffer_load_dwordx4 v5, s[12:15], s49 offen offset:2048 sc1 lds
    s_waitcnt vmcnt(10)
    buffer_load_dwordx4 v5, s[12:15], s49 offen offset:3072 sc1 lds
    s_waitcnt vmcnt(10)
    s_add_u32 s49, s49, 4096
    s_add_u32 m0, s48, 73728
    s_nop 0
    buffer_load_dwordx4 v5, s[12:15], s49 offen offset:0 sc1 lds
    s_waitcnt vmcnt(10)
    buffer_load_dwordx4 v5, s[12:15], s49 offen offset:1024 sc1 lds
    s_waitcnt vmcnt(10)
    buffer_load_dwordx4 v5, s[12:15], s49 offen offset:2048 sc1 lds
    s_waitcnt vmcnt(10)
    buffer_load_dwordx4 v5, s[12:15], s49 offen offset:3072 sc1 lds
    s_waitcnt vmcnt(10)
    s_add_u32 s49, s49, 4096
    s_add_u32 m0, s48, 77824
    s_nop 0
    buffer_load_dwordx4 v5, s[12:15], s49 offen offset:0 sc1 lds
    s_waitcnt vmcnt(10)
    buffer_load_dwordx4 v5, s[12:15], s49 offen offset:1024 sc1 lds
    s_waitcnt vmcnt(10)
    buffer_load_dwordx4 v5, s[12:15], s49 offen offset:2048 sc1 lds
    s_waitcnt vmcnt(10)
    buffer_load_dwordx4 v5, s[12:15], s49 offen offset:3072 sc1 lds
    s_waitcnt vmcnt(10)
    s_add_u32 s49, s49, 4096
    s_add_u32 m0, s48, 98304
    s_nop 0
    buffer_load_dwordx4 v5, s[12:15], s49 offen offset:0 sc1 lds
    s_waitcnt vmcnt(10)
    buffer_load_dwordx4 v5, s[12:15], s49 offen offset:1024 sc1 lds
    s_waitcnt vmcnt(10)
    buffer_load_dwordx4 v5, s[12:15], s49 offen offset:2048 sc1 lds
    s_waitcnt vmcnt(10)
    buffer_load_dwordx4 v5, s[12:15], s49 offen offset:3072 sc1 lds
    s_waitcnt vmcnt(10)
    s_add_u32 s49, s49, 4096
    s_add_u32 m0, s48, 102400
    s_nop 0
    buffer_load_dwordx4 v5, s[12:15], s49 offen offset:0 sc1 lds
    s_waitcnt vmcnt(10)
    buffer_load_dwordx4 v5, s[12:15], s49 offen offset:1024 sc1 lds
    s_waitcnt vmcnt(10)
    buffer_load_dwordx4 v5, s[12:15], s49 offen offset:2048 sc1 lds
    s_waitcnt vmcnt(10)
    buffer_load_dwordx4 v5, s[12:15], s49 offen offset:3072 sc1 lds
    s_waitcnt vmcnt(10)
    s_add_u32 s49, s49, 4096
    s_add_u32 m0, s48, 122880
    s_nop 0
    buffer_load_dwordx4 v5, s[12:15], s49 offen offset:0 sc1 lds
    s_waitcnt vmcnt(10)
    buffer_load_dwordx4 v5, s[12:15], s49 offen offset:1024 sc1 lds
    s_waitcnt vmcnt(10)
    buffer_load_dwordx4 v5, s[12:15], s49 offen offset:2048 sc1 lds
    s_waitcnt vmcnt(10)
    buffer_load_dwordx4 v5, s[12:15], s49 offen offset:3072 sc1 lds
    s_waitcnt vmcnt(10)
    s_add_u32 s49, s49, 4096
    s_add_u32 m0, s48, 126976
    s_nop 0
    buffer_load_dwordx4 v5, s[12:15], s49 offen offset:0 sc1 lds
    s_waitcnt vmcnt(10)
    buffer_load_dwordx4 v5, s[12:15], s49 offen offset:1024 sc1 lds
    s_waitcnt vmcnt(10)
    buffer_load_dwordx4 v5, s[12:15], s49 offen offset:2048 sc1 lds
    s_waitcnt vmcnt(10)
    buffer_load_dwordx4 v5, s[12:15], s49 offen offset:3072 sc1 lds
    s_waitcnt vmcnt(10)
    s_add_u32 s49, s49, 4096
    s_sub_u32 s50, s8, 4
    v_lshrrev_b32 v10, 5, v1
    v_and_b32 v11, 31, v1
    v_lshlrev_b32 v11, 3, v11
    v_lshl_add_u32 v10, v10, 12, v11
    s_lshl_b32 s3, s50, 8
    s_add_u32 s3, s3, 155648
    v_lshl_add_u32 v11, v1, 2, s3
    s_lshr_b32 s3, s6, 1
    s_lshl_b32 s3, s3, 2
    s_add_u32 s50, s50, s3
    s_lshl_b32 s50, s50, 13
    s_lshl_b32 s3, s9, 18
    s_add_u32 s50, s50, s3
    s_add_u32 s50, s50, 57671680
    s_barrier
    s_barrier
    buffer_load_dwordx2 v[32:33], v10, s[12:15], s50 offen offset:0 sc1
    buffer_load_dwordx2 v[34:35], v10, s[12:15], s50 offen offset:256 sc1
    buffer_load_dwordx2 v[36:37], v10, s[12:15], s50 offen offset:512 sc1
    buffer_load_dwordx2 v[38:39], v10, s[12:15], s50 offen offset:768 sc1
    buffer_load_dwordx2 v[40:41], v10, s[12:15], s50 offen offset:1024 sc1
    buffer_load_dwordx2 v[42:43], v10, s[12:15], s50 offen offset:1280 sc1
    buffer_load_dwordx2 v[44:45], v10, s[12:15], s50 offen offset:1536 sc1
    s_barrier
    s_add_u32 m0, s48, 0
    s_nop 0
    buffer_load_dwordx4 v5, s[12:15], s49 offen offset:0 sc1 lds
    buffer_load_dwordx4 v5, s[12:15], s49 offen offset:1024 sc1 lds
    buffer_load_dwordx4 v5, s[12:15], s49 offen offset:2048 sc1 lds
    buffer_load_dwordx4 v5, s[12:15], s49 offen offset:3072 sc1 lds
    s_add_u32 s49, s49, 4096
    s_add_u32 m0, s48, 4096
    s_nop 0
    buffer_load_dwordx4 v5, s[12:15], s49 offen offset:0 sc1 lds
    buffer_load_dwordx4 v5, s[12:15], s49 offen offset:1024 sc1 lds
    buffer_load_dwordx4 v5, s[12:15], s49 offen offset:2048 sc1 lds
    buffer_load_dwordx4 v5, s[12:15], s49 offen offset:3072 sc1 lds
    s_add_u32 s49, s49, 4096
    buffer_load_dwordx2 v[46:47], v10, s[12:15], s50 offen offset:1792 sc1
    buffer_load_dwordx2 v[48:49], v10, s[12:15], s50 offen offset:2048 sc1
    buffer_load_dwordx2 v[50:51], v10, s[12:15], s50 offen offset:2304 sc1
    buffer_load_dwordx2 v[52:53], v10, s[12:15], s50 offen offset:2560 sc1
    buffer_load_dwordx2 v[54:55], v10, s[12:15], s50 offen offset:2816 sc1
    buffer_load_dwordx2 v[56:57], v10, s[12:15], s50 offen offset:3072 sc1
    buffer_load_dwordx2 v[58:59], v10, s[12:15], s50 offen offset:3328 sc1
    s_barrier
    s_add_u32 m0, s48, 24576
    s_nop 0
    buffer_load_dwordx4 v5, s[12:15], s49 offen offset:0 sc1 lds
    buffer_load_dwordx4 v5, s[12:15], s49 offen offset:1024 sc1 lds
    buffer_load_dwordx4 v5, s[12:15], s49 offen offset:2048 sc1 lds
    buffer_load_dwordx4 v5, s[12:15], s49 offen offset:3072 sc1 lds
    s_add_u32 s49, s49, 4096
    s_add_u32 m0, s48, 28672
    s_nop 0
    buffer_load_dwordx4 v5, s[12:15], s49 offen offset:0 sc1 lds
    buffer_load_dwordx4 v5, s[12:15], s49 offen offset:1024 sc1 lds
    buffer_load_dwordx4 v5, s[12:15], s49 offen offset:2048 sc1 lds
    buffer_load_dwordx4 v5, s[12:15], s49 offen offset:3072 sc1 lds
    s_add_u32 s49, s49, 4096
    buffer_load_dwordx2 v[60:61], v10, s[12:15], s50 offen offset:3584 sc1
    buffer_load_dwordx2 v[62:63], v10, s[12:15], s50 offen offset:3840 sc1
    s_waitcnt vmcnt(40)
    s_barrier
    s_waitcnt vmcnt(0)
    v_add_f32 v32, v32, v48
    v_add_f32 v33, v33, v49
    v_add_f32 v34, v34, v50
    v_add_f32 v35, v35, v51
    v_add_f32 v36, v36, v52
    v_add_f32 v37, v37, v53
    v_add_f32 v38, v38, v54
    v_add_f32 v39, v39, v55
    v_add_f32 v40, v40, v56
    v_add_f32 v41, v41, v57
    v_add_f32 v42, v42, v58
    v_add_f32 v43, v43, v59
    v_add_f32 v44, v44, v60
    s_barrier
    v_add_f32 v45, v45, v61
    v_add_f32 v46, v46, v62
    v_add_f32 v47, v47, v63
    v_add_f32 v32, v32, v40
    v_add_f32 v33, v33, v41
    v_add_f32 v34, v34, v42
    v_add_f32 v35, v35, v43
    v_add_f32 v36, v36, v44
    v_add_f32 v37, v37, v45
    v_add_f32 v38, v38, v46
    v_add_f32 v39, v39, v47
    v_add_f32 v32, v32, v36
    v_add_f32 v33, v33, v37
    s_barrier
    v_add_f32 v34, v34, v38
    v_add_f32 v35, v35, v39
    v_add_f32 v32, v32, v34
    v_add_f32 v33, v33, v35
    v_mul_f32 v32, 0x3a800000, v32
    v_mul_f32 v33, 0x3a800000, v33
    v_fma_f32 v33, -v32, v32, v33
    v_max_f32 v33, 0, v33
    v_add_f32 v33, 0x3727c5ac, v33
    v_rsq_f32 v33, v33
    ds_write_b32 v11, v32 offset:1280
    ds_write_b32 v11, v33 offset:2304
    s_waitcnt lgkmcnt(0)
    s_barrier
    s_barrier
s_attn:
    s_sub_u32 s48, s8, 4
    s_lshl_b32 s3, s7, 7
    v_lshrrev_b32 v20, 3, v1
    v_lshlrev_b32 v21, 11, v20
    v_lshrrev_b32 v22, 2, v1
    v_lshrrev_b32 v23, 4, v1
    v_xor_b32 v22, v22, v23
    v_and_b32 v22, 1, v22
    v_lshl_add_u32 v21, v22, 6, v21
    v_and_b32 v22, 3, v1
    v_lshl_add_u32 v21, v22, 4, v21
    v_add_u32 v7, s3, v21
    s_mov_b32 s24, s42
    s_mov_b32 s25, s43
    s_mov_b32 s26, 2097152
    s_mov_b32 s27, 0x00020000
    s_lshr_b32 s49, s9, 1
    s_lshl_b32 s49, s49, 23
    s_lshl_b32 s52, s7, 19
    s_add_u32 s49, s49, s52
    s_and_b32 s52, s6, 1
    s_lshl_b32 s52, s52, 18
    s_add_u32 s49, s49, s52
    s_add_u32 s49, s49, 33554432
    s_lshr_b32 s61, s6, 1
    s_lshl_b32 s52, s48, 13
    s_add_u32 s53, s52, 81920
    v_add_u32 v8, s53, v5
    s_lshl_b32 s53, s61, 15
    s_add_u32 s52, s52, s53
    s_add_u32 s62, s52, s49
    s_add_u32 s63, s62, 4096
    s_mul_i32 s59, s9, 393216
    s_add_u32 s59, s59, 60424192
    s_and_b32 s52, s11, 31
    s_lshl_b32 s52, s52, 9
    s_add_u32 s59, s59, s52
    s_lshr_b32 s52, s61, 1
    s_lshl_b32 s52, s52, 7
    s_add_u32 s59, s59, s52
    s_and_b32 s52, s61, 1
    s_lshl_b32 s52, s52, 2
    s_add_u32 s52, s52, s48
    s_lshl_b32 s52, s52, 2
    s_add_u32 s59, s59, s52
    v_lshlrev_b32 v20, 14, v1
    v_mov_b32 v21, s10
    s_mul_i32 s54, s9, 393216
    s_add_u32 s54, s54, 60424192
    s_lshl_b32 s55, s11, 9
    s_add_u32 s54, s54, s55
    s_add_u32 s52, s4, s54
    s_addc_u32 s53, s5, 0
    s_mov_b32 s54, s10
    s_mov_b32 s55, s10
    s_lshl_b32 s51, s48, 12
    s_add_u32 s49, s49, s51
    s_add_u32 s51, s51, 81920
    s_mov_b32 s60, s48
    s_barrier
    ds_read_b128 v[32:35], v8 offset:0
    ds_read_b128 v[36:39], v8 offset:1024
    ds_read_b128 v[40:43], v8 offset:2048
    ds_read_b128 v[44:47], v8 offset:3072
    ds_read_b128 v[48:51], v8 offset:4096
    ds_read_b128 v[52:55], v8 offset:5120
    ds_read_b128 v[56:59], v8 offset:6144
    ds_read_b128 v[60:63], v8 offset:7168
    s_waitcnt lgkmcnt(7)
    buffer_store_dwordx4 v[32:35], v5, s[12:15], s62 offen offset:0 sc1
    s_waitcnt lgkmcnt(6)
    buffer_store_dwordx4 v[36:39], v5, s[12:15], s62 offen offset:1024 sc1
    s_waitcnt lgkmcnt(5)
    buffer_store_dwordx4 v[40:43], v5, s[12:15], s62 offen offset:2048 sc1
    s_waitcnt lgkmcnt(4)
    buffer_store_dwordx4 v[44:47], v5, s[12:15], s62 offen offset:3072 sc1
    s_waitcnt lgkmcnt(3)
    buffer_store_dwordx4 v[48:51], v5, s[12:15], s63 offen offset:0 sc1
    s_waitcnt lgkmcnt(2)
    buffer_store_dwordx4 v[52:55], v5, s[12:15], s63 offen offset:1024 sc1
    s_waitcnt lgkmcnt(1)
    buffer_store_dwordx4 v[56:59], v5, s[12:15], s63 offen offset:2048 sc1
    s_waitcnt lgkmcnt(0)
    buffer_store_dwordx4 v[60:63], v5, s[12:15], s63 offen offset:3072 sc1
    s_mov_b64 exec, 0xff
    s_waitcnt vmcnt(0)
    buffer_store_dword v21, v20, s[12:15], s59 offen sc1
    s_mov_b64 exec, -1
    s_add_u32 s62, s61, 1
    s_and_b32 s62, s62, 7
    s_lshl_b32 s50, s62, 15
    s_add_u32 s50, s50, s49
    s_lshr_b32 s63, s62, 1
    s_lshl_b32 s63, s63, 7
    s_and_b32 s62, s62, 1
    s_lshl_b32 s62, s62, 4
    s_add_u32 s62, s62, s63
    s_mov_b32 s58, 0x20000
need_20:
    s_load_dwordx4 s[64:67], s[52:53], s62 glc
    s_sub_u32 s58, s58, 1
    s_cbranch_scc1 need_20_ok
    s_waitcnt lgkmcnt(0)
    s_xor_b64 s[64:65], s[64:65], s[54:55]
    s_xor_b64 s[66:67], s[66:67], s[54:55]
    s_or_b64 s[64:65], s[64:65], s[66:67]
    s_cbranch_scc1 need_20
need_20_ok:
    s_waitcnt lgkmcnt(0)
    s_add_u32 m0, s51, 32768
    s_nop 0
    buffer_load_dwordx4 v5, s[12:15], s50 offen offset:0 sc1 lds
    buffer_load_dwordx4 v5, s[12:15], s50 offen offset:1024 sc1 lds
    buffer_load_dwordx4 v5, s[12:15], s50 offen offset:2048 sc1 lds
    buffer_load_dwordx4 v5, s[12:15], s50 offen offset:3072 sc1 lds
    s_add_u32 s50, s50, 16384
    s_add_u32 m0, s51, 49152
    s_nop 0
    buffer_load_dwordx4 v5, s[12:15], s50 offen offset:0 sc1 lds
    buffer_load_dwordx4 v5, s[12:15], s50 offen offset:1024 sc1 lds
    buffer_load_dwordx4 v5, s[12:15], s50 offen offset:2048 sc1 lds
    buffer_load_dwordx4 v5, s[12:15], s50 offen offset:3072 sc1 lds
    s_add_u32 s50, s50, 16384
    s_waitcnt vmcnt(4)
    s_barrier
    s_add_u32 s62, s61, 2
    s_and_b32 s62, s62, 7
    s_lshl_b32 s50, s62, 15
    s_add_u32 s50, s50, s49
    s_lshr_b32 s63, s62, 1
    s_lshl_b32 s63, s63, 7
    s_and_b32 s62, s62, 1
    s_lshl_b32 s62, s62, 4
    s_add_u32 s62, s62, s63
    s_mov_b32 s58, 0x20000
need_21:
    s_load_dwordx4 s[64:67], s[52:53], s62 glc
    s_sub_u32 s58, s58, 1
    s_cbranch_scc1 need_21_ok
    s_waitcnt lgkmcnt(0)
    s_xor_b64 s[64:65], s[64:65], s[54:55]
    s_xor_b64 s[66:67], s[66:67], s[54:55]
    s_or_b64 s[64:65], s[64:65], s[66:67]
    s_cbranch_scc1 need_21
need_21_ok:
    s_waitcnt lgkmcnt(0)
    s_add_u32 m0, s51, 0
    s_nop 0
    buffer_load_dwordx4 v5, s[12:15], s50 offen offset:0 sc1 lds
    buffer_load_dwordx4 v5, s[12:15], s50 offen offset:1024 sc1 lds
    buffer_load_dwordx4 v5, s[12:15], s50 offen offset:2048 sc1 lds
    buffer_load_dwordx4 v5, s[12:15], s50 offen offset:3072 sc1 lds
    s_add_u32 s50, s50, 16384
    s_waitcnt vmcnt(4)
    s_barrier
    s_add_u32 m0, s51, 16384
    s_nop 0
    buffer_load_dwordx4 v5, s[12:15], s50 offen offset:0 sc1 lds
    buffer_load_dwordx4 v5, s[12:15], s50 offen offset:1024 sc1 lds
    buffer_load_dwordx4 v5, s[12:15], s50 offen offset:2048 sc1 lds
    buffer_load_dwordx4 v5, s[12:15], s50 offen offset:3072 sc1 lds
    s_add_u32 s50, s50, 16384
    s_waitcnt vmcnt(4)
    s_barrier
    s_add_u32 s62, s61, 3
    s_and_b32 s62, s62, 7
    s_lshl_b32 s50, s62, 15
    s_add_u32 s50, s50, s49
    s_lshr_b32 s63, s62, 1
    s_lshl_b32 s63, s63, 7
    s_and_b32 s62, s62, 1
    s_lshl_b32 s62, s62, 4
    s_add_u32 s62, s62, s63
    s_mov_b32 s58, 0x20000
need_22:
    s_load_dwordx4 s[64:67], s[52:53], s62 glc
    s_sub_u32 s58, s58, 1
    s_cbranch_scc1 need_22_ok
    s_waitcnt lgkmcnt(0)
    s_xor_b64 s[64:65], s[64:65], s[54:55]
    s_xor_b64 s[66:67], s[66:67], s[54:55]
    s_or_b64 s[64:65], s[64:65], s[66:67]
    s_cbranch_scc1 need_22
need_22_ok:
    s_waitcnt lgkmcnt(0)
    s_add_u32 m0, s51, 32768
    s_nop 0
    buffer_load_dwordx4 v5, s[12:15], s50 offen offset:0 sc1 lds
    buffer_load_dwordx4 v5, s[12:15], s50 offen offset:1024 sc1 lds
    buffer_load_dwordx4 v5, s[12:15], s50 offen offset:2048 sc1 lds
    buffer_load_dwordx4 v5, s[12:15], s50 offen offset:3072 sc1 lds
    s_add_u32 s50, s50, 16384
    s_lshl_b32 m0, s60, 10
    s_lshl_b32 s3, s60, 14
    buffer_load_dwordx4 v7, s[24:27], s3 offen lds
    s_add_u32 s60, s60, 4
    s_lshl_b32 m0, s60, 10
    s_lshl_b32 s3, s60, 14
    buffer_load_dwordx4 v7, s[24:27], s3 offen lds
    s_add_u32 s60, s60, 4
    s_waitcnt vmcnt(6)
    s_barrier
    s_add_u32 m0, s51, 49152
    s_nop 0
    buffer_load_dwordx4 v5, s[12:15], s50 offen offset:0 sc1 lds
    buffer_load_dwordx4 v5, s[12:15], s50 offen offset:1024 sc1 lds
    buffer_load_dwordx4 v5, s[12:15], s50 offen offset:2048 sc1 lds
    buffer_load_dwordx4 v5, s[12:15], s50 offen offset:3072 sc1 lds
    s_add_u32 s50, s50, 16384
    s_lshl_b32 m0, s60, 10
    s_lshl_b32 s3, s60, 14
    buffer_load_dwordx4 v7, s[24:27], s3 offen lds
    s_add_u32 s60, s60, 4
    s_lshl_b32 m0, s60, 10
    s_lshl_b32 s3, s60, 14
    buffer_load_dwordx4 v7, s[24:27], s3 offen lds
    s_add_u32 s60, s60, 4
    s_waitcnt vmcnt(8)
    s_barrier
    s_add_u32 s62, s61, 4
    s_and_b32 s62, s62, 7
    s_lshl_b32 s50, s62, 15
    s_add_u32 s50, s50, s49
    s_lshr_b32 s63, s62, 1
    s_lshl_b32 s63, s63, 7
    s_and_b32 s62, s62, 1
    s_lshl_b32 s62, s62, 4
    s_add_u32 s62, s62, s63
    s_mov_b32 s58, 0x20000
need_23:
    s_load_dwordx4 s[64:67], s[52:53], s62 glc
    s_sub_u32 s58, s58, 1
    s_cbranch_scc1 need_23_ok
    s_waitcnt lgkmcnt(0)
    s_xor_b64 s[64:65], s[64:65], s[54:55]
    s_xor_b64 s[66:67], s[66:67], s[54:55]
    s_or_b64 s[64:65], s[64:65], s[66:67]
    s_cbranch_scc1 need_23
need_23_ok:
    s_waitcnt lgkmcnt(0)
    s_add_u32 m0, s51, 0
    s_nop 0
    buffer_load_dwordx4 v5, s[12:15], s50 offen offset:0 sc1 lds
    buffer_load_dwordx4 v5, s[12:15], s50 offen offset:1024 sc1 lds
    buffer_load_dwordx4 v5, s[12:15], s50 offen offset:2048 sc1 lds
    buffer_load_dwordx4 v5, s[12:15], s50 offen offset:3072 sc1 lds
    s_add_u32 s50, s50, 16384
    s_lshl_b32 m0, s60, 10
    s_lshl_b32 s3, s60, 14
    buffer_load_dwordx4 v7, s[24:27], s3 offen lds
    s_add_u32 s60, s60, 4
    s_lshl_b32 m0, s60, 10
    s_lshl_b32 s3, s60, 14
    buffer_load_dwordx4 v7, s[24:27], s3 offen lds
    s_add_u32 s60, s60, 4
    s_waitcnt vmcnt(8)
    s_barrier
    s_add_u32 m0, s51, 16384
    s_nop 0
    buffer_load_dwordx4 v5, s[12:15], s50 offen offset:0 sc1 lds
    buffer_load_dwordx4 v5, s[12:15], s50 offen offset:1024 sc1 lds
    buffer_load_dwordx4 v5, s[12:15], s50 offen offset:2048 sc1 lds
    buffer_load_dwordx4 v5, s[12:15], s50 offen offset:3072 sc1 lds
    s_add_u32 s50, s50, 16384
    s_lshl_b32 m0, s60, 10
    s_lshl_b32 s3, s60, 14
    buffer_load_dwordx4 v7, s[24:27], s3 offen lds
    s_add_u32 s60, s60, 4
    s_lshl_b32 m0, s60, 10
    s_lshl_b32 s3, s60, 14
    buffer_load_dwordx4 v7, s[24:27], s3 offen lds
    s_add_u32 s60, s60, 4
    s_waitcnt vmcnt(8)
    s_barrier
    s_add_u32 s62, s61, 5
    s_and_b32 s62, s62, 7
    s_lshl_b32 s50, s62, 15
    s_add_u32 s50, s50, s49
    s_lshr_b32 s63, s62, 1
    s_lshl_b32 s63, s63, 7
    s_and_b32 s62, s62, 1
    s_lshl_b32 s62, s62, 4
    s_add_u32 s62, s62, s63
    s_mov_b32 s58, 0x20000
need_24:
    s_load_dwordx4 s[64:67], s[52:53], s62 glc
    s_sub_u32 s58, s58, 1
    s_cbranch_scc1 need_24_ok
    s_waitcnt lgkmcnt(0)
    s_xor_b64 s[64:65], s[64:65], s[54:55]
    s_xor_b64 s[66:67], s[66:67], s[54:55]
    s_or_b64 s[64:65], s[64:65], s[66:67]
    s_cbranch_scc1 need_24
need_24_ok:
    s_waitcnt lgkmcnt(0)
    s_add_u32 m0, s51, 32768
    s_nop 0
    buffer_load_dwordx4 v5, s[12:15], s50 offen offset:0 sc1 lds
    buffer_load_dwordx4 v5, s[12:15], s50 offen offset:1024 sc1 lds
    buffer_load_dwordx4 v5, s[12:15], s50 offen offset:2048 sc1 lds
    buffer_load_dwordx4 v5, s[12:15], s50 offen offset:3072 sc1 lds
    s_add_u32 s50, s50, 16384
    s_lshl_b32 m0, s60, 10
    s_lshl_b32 s3, s60, 14
    buffer_load_dwordx4 v7, s[24:27], s3 offen lds
    s_add_u32 s60, s60, 4
    s_lshl_b32 m0, s60, 10
    s_lshl_b32 s3, s60, 14
    buffer_load_dwordx4 v7, s[24:27], s3 offen lds
    s_add_u32 s60, s60, 4
    s_waitcnt vmcnt(8)
    s_barrier
    s_add_u32 m0, s51, 49152
    s_nop 0
    buffer_load_dwordx4 v5, s[12:15], s50 offen offset:0 sc1 lds
    buffer_load_dwordx4 v5, s[12:15], s50 offen offset:1024 sc1 lds
    buffer_load_dwordx4 v5, s[12:15], s50 offen offset:2048 sc1 lds
    buffer_load_dwordx4 v5, s[12:15], s50 offen offset:3072 sc1 lds
    s_add_u32 s50, s50, 16384
    s_lshl_b32 m0, s60, 10
    s_lshl_b32 s3, s60, 14
    buffer_load_dwordx4 v7, s[24:27], s3 offen lds
    s_add_u32 s60, s60, 4
    s_lshl_b32 m0, s60, 10
    s_lshl_b32 s3, s60, 14
    buffer_load_dwordx4 v7, s[24:27], s3 offen lds
    s_add_u32 s60, s60, 4
    s_waitcnt vmcnt(8)
    s_barrier
    s_add_u32 s62, s61, 6
    s_and_b32 s62, s62, 7
    s_lshl_b32 s50, s62, 15
    s_add_u32 s50, s50, s49
    s_lshr_b32 s63, s62, 1
    s_lshl_b32 s63, s63, 7
    s_and_b32 s62, s62, 1
    s_lshl_b32 s62, s62, 4
    s_add_u32 s62, s62, s63
    s_mov_b32 s58, 0x20000
need_25:
    s_load_dwordx4 s[64:67], s[52:53], s62 glc
    s_sub_u32 s58, s58, 1
    s_cbranch_scc1 need_25_ok
    s_waitcnt lgkmcnt(0)
    s_xor_b64 s[64:65], s[64:65], s[54:55]
    s_xor_b64 s[66:67], s[66:67], s[54:55]
    s_or_b64 s[64:65], s[64:65], s[66:67]
    s_cbranch_scc1 need_25
need_25_ok:
    s_waitcnt lgkmcnt(0)
    s_add_u32 m0, s51, 0
    s_nop 0
    buffer_load_dwordx4 v5, s[12:15], s50 offen offset:0 sc1 lds
    buffer_load_dwordx4 v5, s[12:15], s50 offen offset:1024 sc1 lds
    buffer_load_dwordx4 v5, s[12:15], s50 offen offset:2048 sc1 lds
    buffer_load_dwordx4 v5, s[12:15], s50 offen offset:3072 sc1 lds
    s_add_u32 s50, s50, 16384
    s_lshl_b32 m0, s60, 10
    s_lshl_b32 s3, s60, 14
    buffer_load_dwordx4 v7, s[24:27], s3 offen lds
    s_add_u32 s60, s60, 4
    s_lshl_b32 m0, s60, 10
    s_lshl_b32 s3, s60, 14
    buffer_load_dwordx4 v7, s[24:27], s3 offen lds
    s_add_u32 s60, s60, 4
    s_waitcnt vmcnt(8)
    s_barrier
    s_add_u32 m0, s51, 16384
    s_nop 0
    buffer_load_dwordx4 v5, s[12:15], s50 offen offset:0 sc1 lds
    buffer_load_dwordx4 v5, s[12:15], s50 offen offset:1024 sc1 lds
    buffer_load_dwordx4 v5, s[12:15], s50 offen offset:2048 sc1 lds
    buffer_load_dwordx4 v5, s[12:15], s50 offen offset:3072 sc1 lds
    s_add_u32 s50, s50, 16384
    s_lshl_b32 m0, s60, 10
    s_lshl_b32 s3, s60, 14
    buffer_load_dwordx4 v7, s[24:27], s3 offen lds
    s_add_u32 s60, s60, 4
    s_lshl_b32 m0, s60, 10
    s_lshl_b32 s3, s60, 14
    buffer_load_dwordx4 v7, s[24:27], s3 offen lds
    s_add_u32 s60, s60, 4
    s_waitcnt vmcnt(8)
    s_barrier
    s_add_u32 s62, s61, 7
    s_and_b32 s62, s62, 7
    s_lshl_b32 s50, s62, 15
    s_add_u32 s50, s50, s49
    s_lshr_b32 s63, s62, 1
    s_lshl_b32 s63, s63, 7
    s_and_b32 s62, s62, 1
    s_lshl_b32 s62, s62, 4
    s_add_u32 s62, s62, s63
    s_mov_b32 s58, 0x20000
need_26:
    s_load_dwordx4 s[64:67], s[52:53], s62 glc
    s_sub_u32 s58, s58, 1
    s_cbranch_scc1 need_26_ok
    s_waitcnt lgkmcnt(0)
    s_xor_b64 s[64:65], s[64:65], s[54:55]
    s_xor_b64 s[66:67], s[66:67], s[54:55]
    s_or_b64 s[64:65], s[64:65], s[66:67]
    s_cbranch_scc1 need_26
need_26_ok:
    s_waitcnt lgkmcnt(0)
    s_add_u32 m0, s51, 32768
    s_nop 0
    buffer_load_dwordx4 v5, s[12:15], s50 offen offset:0 sc1 lds
    buffer_load_dwordx4 v5, s[12:15], s50 offen offset:1024 sc1 lds
    buffer_load_dwordx4 v5, s[12:15], s50 offen offset:2048 sc1 lds
    buffer_load_dwordx4 v5, s[12:15], s50 offen offset:3072 sc1 lds
    s_add_u32 s50, s50, 16384
    s_lshl_b32 m0, s60, 10
    s_lshl_b32 s3, s60, 14
    buffer_load_dwordx4 v7, s[24:27], s3 offen lds
    s_add_u32 s60, s60, 4
    s_lshl_b32 m0, s60, 10
    s_lshl_b32 s3, s60, 14
    buffer_load_dwordx4 v7, s[24:27], s3 offen lds
    s_add_u32 s60, s60, 4
    s_waitcnt vmcnt(8)
    s_barrier
    s_add_u32 m0, s51, 49152
    s_nop 0
    buffer_load_dwordx4 v5, s[12:15], s50 offen offset:0 sc1 lds
    buffer_load_dwordx4 v5, s[12:15], s50 offen offset:1024 sc1 lds
    buffer_load_dwordx4 v5, s[12:15], s50 offen offset:2048 sc1 lds
    buffer_load_dwordx4 v5, s[12:15], s50 offen offset:3072 sc1 lds
    s_add_u32 s50, s50, 16384
    s_lshl_b32 m0, s60, 10
    s_lshl_b32 s3, s60, 14
    buffer_load_dwordx4 v7, s[24:27], s3 offen lds
    s_add_u32 s60, s60, 4
    s_lshl_b32 m0, s60, 10
    s_lshl_b32 s3, s60, 14
    buffer_load_dwordx4 v7, s[24:27], s3 offen lds
    s_add_u32 s60, s60, 4
    s_waitcnt vmcnt(8)
    s_barrier
    s_lshl_b32 m0, s60, 10
    s_lshl_b32 s3, s60, 14
    buffer_load_dwordx4 v7, s[24:27], s3 offen lds
    s_add_u32 s60, s60, 4
    s_lshl_b32 m0, s60, 10
    s_lshl_b32 s3, s60, 14
    buffer_load_dwordx4 v7, s[24:27], s3 offen lds
    s_add_u32 s60, s60, 4
    s_lshl_b32 m0, s60, 10
    s_lshl_b32 s3, s60, 14
    buffer_load_dwordx4 v7, s[24:27], s3 offen lds
    s_add_u32 s60, s60, 4
    s_lshl_b32 m0, s60, 10
    s_lshl_b32 s3, s60, 14
    buffer_load_dwordx4 v7, s[24:27], s3 offen lds
    s_add_u32 s60, s60, 4
    s_waitcnt vmcnt(6)
    s_barrier
    s_lshl_b32 m0, s60, 10
    s_lshl_b32 s3, s60, 14
    buffer_load_dwordx4 v7, s[24:27], s3 offen lds
    s_add_u32 s60, s60, 4
    s_lshl_b32 m0, s60, 10
    s_lshl_b32 s3, s60, 14
    buffer_load_dwordx4 v7, s[24:27], s3 offen lds
    s_add_u32 s60, s60, 4
    s_lshl_b32 m0, s60, 10
    s_lshl_b32 s3, s60, 14
    buffer_load_dwordx4 v7, s[24:27], s3 offen lds
    s_add_u32 s60, s60, 4
    s_lshl_b32 m0, s60, 10
    s_lshl_b32 s3, s60, 14
    buffer_load_dwordx4 v7, s[24:27], s3 offen lds
    s_add_u32 s60, s60, 4
    s_barrier
    s_lshl_b32 m0, s60, 10
    s_lshl_b32 s3, s60, 14
    buffer_load_dwordx4 v7, s[24:27], s3 offen lds
    s_add_u32 s60, s60, 4
    s_lshl_b32 m0, s60, 10
    s_lshl_b32 s3, s60, 14
    buffer_load_dwordx4 v7, s[24:27], s3 offen lds
    s_add_u32 s60, s60, 4
    s_lshl_b32 m0, s60, 10
    s_lshl_b32 s3, s60, 14
    buffer_load_dwordx4 v7, s[24:27], s3 offen lds
    s_add_u32 s60, s60, 4
    s_lshl_b32 m0, s60, 10
    s_lshl_b32 s3, s60, 14
    buffer_load_dwordx4 v7, s[24:27], s3 offen lds
    s_add_u32 s60, s60, 4
    s_cmp_eq_u32 s8, 4
    s_cbranch_scc1 h_wo
    s_branch l_wo
.p2align 6
c_attn_slow:
    s_waitcnt lgkmcnt(0)
    s_lshr_b32 s56, s9, 1
    s_lshl_b32 s56, s56, 23
    s_lshl_b32 s55, s7, 19
    s_add_u32 s56, s56, s55
    s_and_b32 s55, s6, 1
    s_lshl_b32 s55, s55, 18
    s_add_u32 s56, s56, s55
    s_add_u32 s56, s56, 33554432
    v_mov_b32 v28, 0xff800000
    v_mov_b32 v30, 0xff800000
    s_mov_b32 s57, 0
c_attn_slow1:
    s_lshr_b32 s55, s57, 2
    s_lshl_b32 s55, s55, 14
    s_and_b32 s58, s57, 3
    s_lshl_b32 s58, s58, 11
    s_add_u32 s55, s55, s58
    s_add_u32 s55, s55, s56
    buffer_load_dwordx4 v[128:131], v5, s[12:15], s55 offen offset:0 sc1
    buffer_load_dwordx4 v[132:135], v5, s[12:15], s55 offen offset:1024 sc1
    s_waitcnt vmcnt(0)
    v_mfma_f32_32x32x16_bf16 v[64:79], v[128:131], v[8:11], 0
    v_mfma_f32_32x32x16_bf16 v[80:95], v[128:131], v[16:19], 0
    v_mfma_f32_32x32x16_bf16 v[64:79], v[132:135], v[12:15], v[64:79]
    v_mfma_f32_32x32x16_bf16 v[80:95], v[132:135], v[20:23], v[80:95]
    s_nop 10
    v_max3_f32 v28, v28, v64, v65
    v_max3_f32 v28, v28, v66, v67
    v_max3_f32 v28, v28, v68, v69
    v_max3_f32 v28, v28, v70, v71
    v_max3_f32 v28, v28, v72, v73
    v_max3_f32 v28, v28, v74, v75
    v_max3_f32 v28, v28, v76, v77
    v_max3_f32 v28, v28, v78, v79
    v_max3_f32 v30, v30, v80, v81
    v_max3_f32 v30, v30, v82, v83
    v_max3_f32 v30, v30, v84, v85
    v_max3_f32 v30, v30, v86, v87
    v_max3_f32 v30, v30, v88, v89
    v_max3_f32 v30, v30, v90, v91
    v_max3_f32 v30, v30, v92, v93
    v_max3_f32 v30, v30, v94, v95
    s_add_u32 s57, s57, 1
    s_cmp_lt_u32 s57, 64
    s_cbranch_scc1 c_attn_slow1
    v_mov_b32 v29, v28
    s_nop 1
    v_permlane32_swap_b32 v28, v29
    v_max_f32 v28, v28, v29
    v_sub_f32 v96, 0, v28
    v_sub_f32 v97, 0, v28
    v_sub_f32 v98, 0, v28
    v_sub_f32 v99, 0, v28
    v_sub_f32 v100, 0, v28
    v_sub_f32 v101, 0, v28
    v_sub_f32 v102, 0, v28
    v_sub_f32 v103, 0, v28
    v_sub_f32 v104, 0, v28
    v_sub_f32 v105, 0, v28
    v_sub_f32 v106, 0, v28
    v_sub_f32 v107, 0, v28
    v_sub_f32 v108, 0, v28
    v_sub_f32 v109, 0, v28
    v_sub_f32 v110, 0, v28
    v_sub_f32 v111, 0, v28
    v_mov_b32 v160, 0
    v_mov_b32 v161, 0
    v_mov_b32 v162, 0
    v_mov_b32 v163, 0
    v_mov_b32 v164, 0
    v_mov_b32 v165, 0
    v_mov_b32 v166, 0
    v_mov_b32 v167, 0
    v_mov_b32 v168, 0
    v_mov_b32 v169, 0
    v_mov_b32 v170, 0
    v_mov_b32 v171, 0
    v_mov_b32 v172, 0
    v_mov_b32 v173, 0
    v_mov_b32 v174, 0
    v_mov_b32 v175, 0
    v_mov_b32 v192, 0
    v_mov_b32 v193, 0
    v_mov_b32 v194, 0
    v_mov_b32 v195, 0
    v_mov_b32 v31, v30
    s_nop 1
    v_permlane32_swap_b32 v30, v31
    v_max_f32 v30, v30, v31
    v_sub_f32 v112, 0, v30
    v_sub_f32 v113, 0, v30
    v_sub_f32 v114, 0, v30
    v_sub_f32 v115, 0, v30
    v_sub_f32 v116, 0, v30
    v_sub_f32 v117, 0, v30
    v_sub_f32 v118, 0, v30
    v_sub_f32 v119, 0, v30
    v_sub_f32 v120, 0, v30
    v_sub_f32 v121, 0, v30
    v_sub_f32 v122, 0, v30
    v_sub_f32 v123, 0, v30
    v_sub_f32 v124, 0, v30
    v_sub_f32 v125, 0, v30
    v_sub_f32 v126, 0, v30
    v_sub_f32 v127, 0, v30
    v_mov_b32 v176, 0
    v_mov_b32 v177, 0
    v_mov_b32 v178, 0
    v_mov_b32 v179, 0
    v_mov_b32 v180, 0
    v_mov_b32 v181, 0
    v_mov_b32 v182, 0
    v_mov_b32 v183, 0
    v_mov_b32 v184, 0
    v_mov_b32 v185, 0
    v_mov_b32 v186, 0
    v_mov_b32 v187, 0
    v_mov_b32 v188, 0
    v_mov_b32 v189, 0
    v_mov_b32 v190, 0
    v_mov_b32 v191, 0
    v_mov_b32 v196, 0
    v_mov_b32 v197, 0
    v_mov_b32 v198, 0
    v_mov_b32 v199, 0
    s_mov_b32 s57, 0
c_attn_slow2:
    s_lshr_b32 s55, s57, 2
    s_lshl_b32 s55, s55, 14
    s_and_b32 s58, s57, 3
    s_lshl_b32 s58, s58, 11
    s_add_u32 s55, s55, s58
    s_add_u32 s55, s55, s56
    buffer_load_dwordx4 v[128:131], v5, s[12:15], s55 offen offset:0 sc1
    buffer_load_dwordx4 v[132:135], v5, s[12:15], s55 offen offset:1024 sc1
    s_add_u32 s55, s55, 8192
    buffer_load_dwordx4 v[144:147], v5, s[12:15], s55 offen offset:0 sc1
    buffer_load_dwordx4 v[148:151], v5, s[12:15], s55 offen offset:1024 sc1
    s_waitcnt vmcnt(0)
    v_mfma_f32_32x32x16_bf16 v[64:79], v[128:131], v[8:11], v[96:111]
    v_mfma_f32_32x32x16_bf16 v[80:95], v[128:131], v[16:19], v[112:127]
    v_mfma_f32_32x32x16_bf16 v[64:79], v[132:135], v[12:15], v[64:79]
    v_mfma_f32_32x32x16_bf16 v[80:95], v[132:135], v[20:23], v[80:95]
    s_nop 10
    v_exp_f32 v64, v64
    v_exp_f32 v65, v65
    v_exp_f32 v66, v66
    v_exp_f32 v67, v67
    v_exp_f32 v68, v68
    v_exp_f32 v69, v69
    v_exp_f32 v70, v70
    v_exp_f32 v71, v71
    v_exp_f32 v72, v72
    v_exp_f32 v73, v73
    v_exp_f32 v74, v74
    v_exp_f32 v75, v75
    v_exp_f32 v76, v76
    v_exp_f32 v77, v77
    v_exp_f32 v78, v78
    v_exp_f32 v79, v79
    v_exp_f32 v80, v80
    v_exp_f32 v81, v81
    v_exp_f32 v82, v82
    v_exp_f32 v83, v83
    v_exp_f32 v84, v84
    v_exp_f32 v85, v85
    v_exp_f32 v86, v86
    v_exp_f32 v87, v87
    v_exp_f32 v88, v88
    v_exp_f32 v89, v89
    v_exp_f32 v90, v90
    v_exp_f32 v91, v91
    v_exp_f32 v92, v92
    v_exp_f32 v93, v93
    v_exp_f32 v94, v94
    v_exp_f32 v95, v95
    v_smfmac_f32_32x32x32_bf16 v[160:175], v[144:147], v[64:71], v204
    v_smfmac_f32_16x16x64_bf16 v[192:195], v[200:203], v[64:71], v204
    v_smfmac_f32_32x32x32_bf16 v[160:175], v[148:151], v[72:79], v204
    v_smfmac_f32_16x16x64_bf16 v[192:195], v[200:203], v[72:79], v204
    v_smfmac_f32_32x32x32_bf16 v[176:191], v[144:147], v[80:87], v204
    v_smfmac_f32_16x16x64_bf16 v[196:199], v[200:203], v[80:87], v204
    v_smfmac_f32_32x32x32_bf16 v[176:191], v[148:151], v[88:95], v204
    v_smfmac_f32_16x16x64_bf16 v[196:199], v[200:203], v[88:95], v204
    s_add_u32 s57, s57, 1
    s_cmp_lt_u32 s57, 64
    s_nop 15
    s_cbranch_scc1 c_attn_slow2
    s_branch c_attn_fin
    s_endpgm
.section .rodata,"a"
.p2align 6
.amdhsa_kernel interleave_layers__sliding_local_dilated__softmax_full_mha__prompt_kernel
  .amdhsa_next_free_vgpr 256
  .amdhsa_next_free_sgpr 102
  .amdhsa_accum_offset 224
  .amdhsa_group_segment_fixed_size 0
  .amdhsa_kernarg_size 72
  .amdhsa_user_sgpr_count 2
  .amdhsa_user_sgpr_kernarg_segment_ptr 1
  .amdhsa_system_sgpr_workgroup_id_x 1
.end_amdhsa_kernel
```

```asm
; @launch grid=(256,1,1) block=(512,1,1) lds=159744
.amdgcn_target "amdgcn-amd-amdhsa--gfx950"
.text
.globl interleave_layers__sliding_local_dilated__softmax_full_mha__prompt_kernel
.type interleave_layers__sliding_local_dilated__softmax_full_mha__prompt_kernel,@function
.p2align 8
interleave_layers__sliding_local_dilated__softmax_full_mha__prompt_kernel:
    s_cmp_ge_u32 s2, 256
    s_cbranch_scc1 k_exit2
    s_load_dwordx16 s[32:47], s[0:1], 0
    s_load_dwordx2 s[4:5], s[0:1], 64
    v_lshrrev_b32 v2, 6, v0
    v_and_b32 v1, 63, v0
    v_mov_b32 v15, 0
    v_mov_b32 v16, 0
    v_readfirstlane_b32 s8, v2
    s_and_b32 s3, s2, 1
    s_lshl_b32 s3, s3, 3
    s_bfe_u32 s6, s2, 0x30003
    s_add_u32 s6, s3, s6
    s_bfe_u32 s3, s2, 0x20001
    s_lshl_b32 s3, s3, 2
    s_lshr_b32 s7, s2, 6
    s_add_u32 s7, s3, s7
    s_lshl_b32 s11, s6, 4
    s_add_u32 s11, s11, s7
    s_mov_b32 s9, -1
    s_mov_b32 s96, 0
    s_mov_b32 s10, 0
    s_waitcnt lgkmcnt(0)
    s_mov_b32 s12, s4
    s_mov_b32 s13, s5
    s_mov_b32 s14, 71303168
    s_mov_b32 s15, 0x00020000
    s_cmp_lt_u32 s8, 4
    s_cbranch_scc1 c_prep
    s_cmp_eq_u32 s8, 4
    s_cbranch_scc1 h_first
    s_branch l_first
k_exit:
k_exit2:
    s_endpgm
.p2align 6
c_qkvA:
    v_and_b32 v1, 63, v0
    v_lshrrev_b32 v2, 6, v0
    v_lshlrev_b32 v5, 4, v1
    v_lshrrev_b32 v3, 5, v1
    v_and_b32 v4, 15, v0
    v_bfe_u32 v7, v1, 4, 1
    v_lshl_add_u32 v6, v7, 5, v4
    v_lshlrev_b32 v6, 4, v6
    v_lshl_add_u32 v6, v3, 10, v6
    s_lshr_b32 s48, s6, 1
    s_lshl_b32 s48, s48, 2
    s_add_u32 s48, s48, s8
    s_lshl_b32 s55, s48, 17
    s_lshl_b32 s56, s9, 22
    s_add_u32 s55, s55, s56
    s_add_u32 s16, s4, s55
    s_addc_u32 s17, s5, 0
    s_mov_b32 s18, 65536
    s_mov_b32 s19, 0x00020000
    s_add_u32 s56, s55, 65536
    s_add_u32 s20, s4, s56
    s_addc_u32 s21, s5, 0
    s_mov_b32 s22, 65536
    s_mov_b32 s23, 0x00020000
    s_lshl_b32 s49, s7, 12
    s_add_u32 s49, s49, s55
    s_and_b32 s56, s6, 1
    s_lshl_b32 s56, s56, 11
    s_add_u32 s49, s49, s56
    s_add_u32 s49, s49, 16777216
    s_movk_i32 s54, 4096
    v_lshrrev_b32 v16, 2, v4
    v_lshl_add_u32 v18, v7, 2, v16
    v_lshl_add_u32 v18, v3, 4, v18
    v_lshlrev_b32 v18, 6, v18
    v_and_b32 v17, 3, v4
    v_lshl_add_u32 v18, v17, 3, v18
    v_lshl_add_u32 v26, v7, 5, v18
    v_xor_b32 v27, 32, v26
    v_mov_b32 v24, v26
    v_mov_b32 v25, v27
    v_and_b32 v18, 0x30, v1
    v_add_u32 v10, 155648, v18
    v_lshlrev_b32 v11, 2, v4
    v_add_u32 v11, 155648, v11
    v_lshl_add_u32 v8, v2, 8, v11
    v_lshl_add_u32 v9, v2, 8, v10
    s_lshr_b32 s3, s8, 1
    s_and_b32 s55, s8, 1
    s_lshl_b32 s56, s55, 5
    v_xor_b32 v29, s56, v26
    s_lshl_b32 s56, s3, 13
    s_add_u32 s56, s56, 8192
    v_add_u32 v29, s56, v29
    v_mov_b32 v28, v29
    v_add_u32 v30, 147456, v5
    v_lshl_add_u32 v14, v2, 6, v10
    v_lshl_add_u32 v12, v2, 11, v5
    v_add_u32 v12, 131072, v12
    v_lshlrev_b32 v16, 8, v16
    v_lshl_add_u32 v16, v18, 2, v16
    v_lshl_add_u32 v16, v17, 1, v16
    v_add_u32 v16, 1024, v16
    v_cmp_gt_u32 vcc, 2, v2
    s_nop 1
    v_cndmask_b32 v13, v16, v5, vcc
    s_lshl_b32 s56, s55, 3
    s_add_u32 s56, s56, 131072
    v_add_u32 v13, s56, v13
    v_lshrrev_b32 v18, 2, v18
    v_sub_u32 v18, v4, v18
    v_mov_b32 v19, 0xf149f2ca
    v_add_u32 v16, 0x0, v18
    v_and_b32 v16, 0xfffffff1, v16
    v_cmp_eq_u32 vcc, 0, v16
    s_nop 1
    v_cndmask_b32 v196, v19, 0, vcc
    v_add_u32 v16, 0xffffffff, v18
    v_and_b32 v16, 0xfffffff1, v16
    v_cmp_eq_u32 vcc, 0, v16
    s_nop 1
    v_cndmask_b32 v197, v19, 0, vcc
    v_add_u32 v16, 0xfffffffe, v18
    v_and_b32 v16, 0xfffffff1, v16
    v_cmp_eq_u32 vcc, 0, v16
    s_nop 1
    v_cndmask_b32 v198, v19, 0, vcc
    v_add_u32 v16, 0xfffffffd, v18
    v_and_b32 v16, 0xfffffff1, v16
    v_cmp_eq_u32 vcc, 0, v16
    s_nop 1
    v_cndmask_b32 v199, v19, 0, vcc
    v_add_u32 v16, 0x10, v18
    v_and_b32 v16, 0xfffffff1, v16
    v_cmp_eq_u32 vcc, 0, v16
    s_nop 1
    v_cndmask_b32 v200, v19, 0, vcc
    v_add_u32 v16, 0xf, v18
    v_and_b32 v16, 0xfffffff1, v16
    v_cmp_eq_u32 vcc, 0, v16
    s_nop 1
    v_cndmask_b32 v201, v19, 0, vcc
    v_add_u32 v16, 0xe, v18
    v_and_b32 v16, 0xfffffff1, v16
    v_cmp_eq_u32 vcc, 0, v16
    s_nop 1
    v_cndmask_b32 v202, v19, 0, vcc
    v_add_u32 v16, 0xd, v18
    v_and_b32 v16, 0xfffffff1, v16
    v_cmp_eq_u32 vcc, 0, v16
    s_nop 1
    v_cndmask_b32 v203, v19, 0, vcc
    s_cmp_eq_u32 s48, 0
    s_cselect_b64 vcc, -1, 0
    v_cndmask_b32 v204, v200, v19, vcc
    v_cndmask_b32 v205, v201, v19, vcc
    v_cndmask_b32 v206, v202, v19, vcc
    v_cndmask_b32 v207, v203, v19, vcc
    v_mov_b32 v208, 0x3f803f80
    v_mov_b32 v209, 0x3f803f80
    v_mov_b32 v210, 0x3f803f80
    v_mov_b32 v211, 0x3f803f80
    v_mov_b32 v184, 0
    v_mov_b32 v185, 0
    v_mov_b32 v186, 0
    v_mov_b32 v187, 0
    v_mov_b32 v188, 0
    v_mov_b32 v189, 0
    v_mov_b32 v190, 0
    v_mov_b32 v191, 0
    v_mov_b32 v192, 0
    v_mov_b32 v193, 0
    v_mov_b32 v194, 0
    v_mov_b32 v195, 0
    v_mov_b32 v32, 0
    v_mov_b32 v33, 0
    v_mov_b32 v34, 0
    v_mov_b32 v35, 0
    v_mov_b32 v36, 0
    v_mov_b32 v37, 0
    v_mov_b32 v38, 0
    v_mov_b32 v39, 0
    v_mov_b32 v40, 0
    v_mov_b32 v41, 0
    v_mov_b32 v42, 0
    v_mov_b32 v43, 0
    v_mov_b32 v44, 0
    v_mov_b32 v45, 0
    v_mov_b32 v46, 0
    v_mov_b32 v47, 0
    v_mov_b32 v48, 0
    v_mov_b32 v49, 0
    v_mov_b32 v50, 0
    v_mov_b32 v51, 0
    v_mov_b32 v52, 0
    v_mov_b32 v53, 0
    v_mov_b32 v54, 0
    v_mov_b32 v55, 0
    v_mov_b32 v56, 0
    v_mov_b32 v57, 0
    v_mov_b32 v58, 0
    v_mov_b32 v59, 0
    v_mov_b32 v60, 0
    v_mov_b32 v61, 0
    v_mov_b32 v62, 0
    v_mov_b32 v63, 0
    v_mov_b32 v64, 0
    v_mov_b32 v65, 0
    v_mov_b32 v66, 0
    v_mov_b32 v67, 0
    v_mov_b32 v68, 0
    v_mov_b32 v69, 0
    v_mov_b32 v70, 0
    v_mov_b32 v71, 0
    v_mov_b32 v72, 0
    v_mov_b32 v73, 0
    v_mov_b32 v74, 0
    v_mov_b32 v75, 0
    v_mov_b32 v76, 0
    v_mov_b32 v77, 0
    v_mov_b32 v78, 0
    v_mov_b32 v79, 0
    v_mov_b32 v80, 0
    v_mov_b32 v81, 0
    v_mov_b32 v82, 0
    v_mov_b32 v83, 0
    v_mov_b32 v84, 0
    v_mov_b32 v85, 0
    v_mov_b32 v86, 0
    v_mov_b32 v87, 0
    v_mov_b32 v88, 0
    v_mov_b32 v89, 0
    v_mov_b32 v90, 0
    v_mov_b32 v91, 0
    v_mov_b32 v92, 0
    v_mov_b32 v93, 0
    v_mov_b32 v94, 0
    v_mov_b32 v95, 0
    v_mov_b32 v96, 0
    v_mov_b32 v97, 0
    v_mov_b32 v98, 0
    v_mov_b32 v99, 0
    v_mov_b32 v100, 0
    v_mov_b32 v101, 0
    v_mov_b32 v102, 0
    v_mov_b32 v103, 0
    v_mov_b32 v104, 0
    v_mov_b32 v105, 0
    v_mov_b32 v106, 0
    v_mov_b32 v107, 0
    v_mov_b32 v108, 0
    v_mov_b32 v109, 0
    v_mov_b32 v110, 0
    v_mov_b32 v111, 0
    v_mov_b32 v112, 0
    v_mov_b32 v113, 0
    v_mov_b32 v114, 0
    v_mov_b32 v115, 0
    v_mov_b32 v116, 0
    v_mov_b32 v117, 0
    v_mov_b32 v118, 0
    v_mov_b32 v119, 0
    v_mov_b32 v120, 0
    v_mov_b32 v121, 0
    v_mov_b32 v122, 0
    v_mov_b32 v123, 0
    v_mov_b32 v124, 0
    v_mov_b32 v125, 0
    v_mov_b32 v126, 0
    v_mov_b32 v127, 0
    s_mov_b32 s50, 6144
    s_mov_b32 s51, 10240
    s_mov_b32 s52, 0
    s_barrier
    buffer_load_dwordx4 a[0:3], v6, s[16:19], 0 offen offset:0 sc1
    buffer_load_dwordx4 a[4:7], v6, s[16:19], 0 offen offset:256 sc1
    buffer_load_dwordx4 a[8:11], v6, s[20:23], 0 offen offset:0 sc1
    buffer_load_dwordx4 a[12:15], v6, s[20:23], 0 offen offset:256 sc1
    ds_read_b64_tr_b16 v[128:129], v24 offset:0
    ds_read_b64_tr_b16 v[130:131], v24 offset:512
    ds_read_b64_tr_b16 v[132:133], v25 offset:0
    ds_read_b64_tr_b16 v[134:135], v25 offset:512
    ds_read_b64_tr_b16 v[136:137], v24 offset:8192
    ds_read_b64_tr_b16 v[138:139], v24 offset:8704
    ds_read_b64_tr_b16 v[140:141], v25 offset:8192
    ds_read_b64_tr_b16 v[142:143], v25 offset:8704
    ds_read_b64_tr_b16 v[144:145], v24 offset:16384
    ds_read_b64_tr_b16 v[146:147], v24 offset:16896
    buffer_load_dwordx4 a[16:19], v6, s[16:19], 0 offen offset:2048 sc1
    buffer_load_dwordx4 a[20:23], v6, s[16:19], 0 offen offset:2304 sc1
    buffer_load_dwordx4 a[24:27], v6, s[20:23], 0 offen offset:2048 sc1
    buffer_load_dwordx4 a[28:31], v6, s[20:23], 0 offen offset:2304 sc1
    buffer_load_dwordx4 v[152:155], v6, s[16:19], s54 offen offset:0 sc1
    buffer_load_dwordx4 v[156:159], v6, s[16:19], s54 offen offset:256 sc1
    buffer_load_dwordx4 v[160:163], v6, s[20:23], s54 offen offset:0 sc1
    buffer_load_dwordx4 v[164:167], v6, s[20:23], s54 offen offset:256 sc1
    s_mov_b32 s54, 8
    s_waitcnt vmcnt(8)
    s_barrier
.p2align 3
c_qkvA_loop:
    s_waitcnt vmcnt(8) lgkmcnt(4)
    v_mfma_f32_16x16x32_bf16 v[184:187], v[188:191], v[192:195], v[184:187]
    v_mfma_f32_16x16x32_bf16 v[32:35], v[128:131], a[0:3], v[32:35]
    ds_read_b64_tr_b16 v[148:149], v25 offset:16384
    v_mfma_f32_16x16x32_bf16 v[36:39], v[128:131], a[4:7], v[36:39]
    ds_read_b64_tr_b16 v[150:151], v25 offset:16896
    v_mfma_f32_16x16x32_bf16 v[40:43], v[128:131], a[8:11], v[40:43]
    v_mfma_f32_16x16x32_bf16 v[44:47], v[128:131], a[12:15], v[44:47]
    s_waitcnt lgkmcnt(8)
    v_mfma_f32_16x16x32_bf16 v[48:51], v[132:135], a[0:3], v[48:51]
    ds_read_b64_tr_b16 v[128:129], v24 offset:2048
    v_mfma_f32_16x16x32_bf16 v[52:55], v[132:135], a[4:7], v[52:55]
    ds_read_b64_tr_b16 v[130:131], v24 offset:2560
    v_mfma_f32_16x16x32_bf16 v[56:59], v[132:135], a[8:11], v[56:59]
    buffer_load_dwordx4 v[168:171], v6, s[16:19], s50 offen offset:0 sc1
    v_mfma_f32_16x16x32_bf16 v[60:63], v[132:135], a[12:15], v[60:63]
    ds_read_b64_tr_b16 v[188:189], v28 offset:0
    s_waitcnt lgkmcnt(9)
    v_mfma_f32_16x16x32_bf16 v[64:67], v[136:139], a[0:3], v[64:67]
    ds_read_b64_tr_b16 v[132:133], v25 offset:2048
    v_mfma_f32_16x16x32_bf16 v[68:71], v[136:139], a[4:7], v[68:71]
    ds_read_b64_tr_b16 v[134:135], v25 offset:2560
    v_mfma_f32_16x16x32_bf16 v[72:75], v[136:139], a[8:11], v[72:75]
    buffer_load_dwordx4 v[172:175], v6, s[16:19], s50 offen offset:256 sc1
    v_mfma_f32_16x16x32_bf16 v[76:79], v[136:139], a[12:15], v[76:79]
    ds_read_b64_tr_b16 v[190:191], v28 offset:512
    s_waitcnt lgkmcnt(10)
    v_mfma_f32_16x16x32_bf16 v[80:83], v[140:143], a[0:3], v[80:83]
    ds_read_b64_tr_b16 v[136:137], v24 offset:10240
    v_mfma_f32_16x16x32_bf16 v[84:87], v[140:143], a[4:7], v[84:87]
    ds_read_b64_tr_b16 v[138:139], v24 offset:10752
    v_mfma_f32_16x16x32_bf16 v[88:91], v[140:143], a[8:11], v[88:91]
    buffer_load_dwordx4 v[176:179], v6, s[20:23], s50 offen offset:0 sc1
    v_mfma_f32_16x16x32_bf16 v[92:95], v[140:143], a[12:15], v[92:95]
    ds_read_b128 v[192:195], v30 offset:0
    s_waitcnt lgkmcnt(11)
    v_mfma_f32_16x16x32_bf16 v[96:99], a[0:3], v[144:147], v[96:99]
    ds_read_b64_tr_b16 v[140:141], v25 offset:10240
    v_mfma_f32_16x16x32_bf16 v[100:103], a[4:7], v[144:147], v[100:103]
    ds_read_b64_tr_b16 v[142:143], v25 offset:10752
    v_mfma_f32_16x16x32_bf16 v[104:107], a[8:11], v[144:147], v[104:107]
    buffer_load_dwordx4 v[180:183], v6, s[20:23], s50 offen offset:256 sc1
    v_mfma_f32_16x16x32_bf16 v[108:111], a[12:15], v[144:147], v[108:111]
    s_waitcnt lgkmcnt(11)
    v_mfma_f32_16x16x32_bf16 v[112:115], a[0:3], v[148:151], v[112:115]
    ds_read_b64_tr_b16 v[144:145], v24 offset:18432
    v_mfma_f32_16x16x32_bf16 v[116:119], a[4:7], v[148:151], v[116:119]
    ds_read_b64_tr_b16 v[146:147], v24 offset:18944
    v_mfma_f32_16x16x32_bf16 v[120:123], a[8:11], v[148:151], v[120:123]
    v_mfma_f32_16x16x32_bf16 v[124:127], a[12:15], v[148:151], v[124:127]
    s_waitcnt vmcnt(8) lgkmcnt(4)
    v_mfma_f32_16x16x32_bf16 v[184:187], v[188:191], v[192:195], v[184:187]
    v_mfma_f32_16x16x32_bf16 v[32:35], v[128:131], a[16:19], v[32:35]
    ds_read_b64_tr_b16 v[148:149], v25 offset:18432
    v_mfma_f32_16x16x32_bf16 v[36:39], v[128:131], a[20:23], v[36:39]
    ds_read_b64_tr_b16 v[150:151], v25 offset:18944
    v_mfma_f32_16x16x32_bf16 v[40:43], v[128:131], a[24:27], v[40:43]
    v_mfma_f32_16x16x32_bf16 v[44:47], v[128:131], a[28:31], v[44:47]
    s_waitcnt lgkmcnt(10)
    v_mfma_f32_16x16x32_bf16 v[48:51], v[132:135], a[16:19], v[48:51]
    ds_read_b64_tr_b16 v[128:129], v24 offset:4096
    v_mfma_f32_16x16x32_bf16 v[52:55], v[132:135], a[20:23], v[52:55]
    ds_read_b64_tr_b16 v[130:131], v24 offset:4608
    v_mfma_f32_16x16x32_bf16 v[56:59], v[132:135], a[24:27], v[56:59]
    buffer_load_dwordx4 a[0:3], v6, s[16:19], s50 offen offset:2048 sc1
    v_mfma_f32_16x16x32_bf16 v[60:63], v[132:135], a[28:31], v[60:63]
    ds_read_b64_tr_b16 v[188:189], v28 offset:2048
    s_waitcnt lgkmcnt(10)
    v_mfma_f32_16x16x32_bf16 v[64:67], v[136:139], a[16:19], v[64:67]
    ds_read_b64_tr_b16 v[132:133], v25 offset:4096
    v_mfma_f32_16x16x32_bf16 v[68:71], v[136:139], a[20:23], v[68:71]
    ds_read_b64_tr_b16 v[134:135], v25 offset:4608
    v_mfma_f32_16x16x32_bf16 v[72:75], v[136:139], a[24:27], v[72:75]
    buffer_load_dwordx4 a[4:7], v6, s[16:19], s50 offen offset:2304 sc1
    v_mfma_f32_16x16x32_bf16 v[76:79], v[136:139], a[28:31], v[76:79]
    ds_read_b64_tr_b16 v[190:191], v28 offset:2560
    s_waitcnt lgkmcnt(10)
    v_mfma_f32_16x16x32_bf16 v[80:83], v[140:143], a[16:19], v[80:83]
    ds_read_b64_tr_b16 v[136:137], v24 offset:12288
    v_mfma_f32_16x16x32_bf16 v[84:87], v[140:143], a[20:23], v[84:87]
    ds_read_b64_tr_b16 v[138:139], v24 offset:12800
    v_mfma_f32_16x16x32_bf16 v[88:91], v[140:143], a[24:27], v[88:91]
    buffer_load_dwordx4 a[8:11], v6, s[20:23], s50 offen offset:2048 sc1
    v_mfma_f32_16x16x32_bf16 v[92:95], v[140:143], a[28:31], v[92:95]
    ds_read_b128 v[192:195], v30 offset:1024
    s_waitcnt lgkmcnt(11)
    v_mfma_f32_16x16x32_bf16 v[96:99], a[16:19], v[144:147], v[96:99]
    ds_read_b64_tr_b16 v[140:141], v25 offset:12288
    v_mfma_f32_16x16x32_bf16 v[100:103], a[20:23], v[144:147], v[100:103]
    ds_read_b64_tr_b16 v[142:143], v25 offset:12800
    v_mfma_f32_16x16x32_bf16 v[104:107], a[24:27], v[144:147], v[104:107]
    buffer_load_dwordx4 a[12:15], v6, s[20:23], s50 offen offset:2304 sc1
    v_mfma_f32_16x16x32_bf16 v[108:111], a[28:31], v[144:147], v[108:111]
    s_waitcnt lgkmcnt(11)
    v_mfma_f32_16x16x32_bf16 v[112:115], a[16:19], v[148:151], v[112:115]
    ds_read_b64_tr_b16 v[144:145], v24 offset:20480
    v_mfma_f32_16x16x32_bf16 v[116:119], a[20:23], v[148:151], v[116:119]
    ds_read_b64_tr_b16 v[146:147], v24 offset:20992
    v_mfma_f32_16x16x32_bf16 v[120:123], a[24:27], v[148:151], v[120:123]
    v_mfma_f32_16x16x32_bf16 v[124:127], a[28:31], v[148:151], v[124:127]
    s_waitcnt vmcnt(8) lgkmcnt(4)
    v_mfma_f32_16x16x32_bf16 v[184:187], v[188:191], v[192:195], v[184:187]
    v_mfma_f32_16x16x32_bf16 v[32:35], v[128:131], v[152:155], v[32:35]
    ds_read_b64_tr_b16 v[148:149], v25 offset:20480
    v_mfma_f32_16x16x32_bf16 v[36:39], v[128:131], v[156:159], v[36:39]
    ds_read_b64_tr_b16 v[150:151], v25 offset:20992
    v_mfma_f32_16x16x32_bf16 v[40:43], v[128:131], v[160:163], v[40:43]
    v_mfma_f32_16x16x32_bf16 v[44:47], v[128:131], v[164:167], v[44:47]
    s_waitcnt lgkmcnt(10)
    v_mfma_f32_16x16x32_bf16 v[48:51], v[132:135], v[152:155], v[48:51]
    ds_read_b64_tr_b16 v[128:129], v24 offset:6144
    v_mfma_f32_16x16x32_bf16 v[52:55], v[132:135], v[156:159], v[52:55]
    ds_read_b64_tr_b16 v[130:131], v24 offset:6656
    v_mfma_f32_16x16x32_bf16 v[56:59], v[132:135], v[160:163], v[56:59]
    buffer_load_dwordx4 a[16:19], v6, s[16:19], s51 offen offset:0 sc1
    v_mfma_f32_16x16x32_bf16 v[60:63], v[132:135], v[164:167], v[60:63]
    ds_read_b64_tr_b16 v[188:189], v28 offset:4096
    s_waitcnt lgkmcnt(10)
    v_mfma_f32_16x16x32_bf16 v[64:67], v[136:139], v[152:155], v[64:67]
    ds_read_b64_tr_b16 v[132:133], v25 offset:6144
    v_mfma_f32_16x16x32_bf16 v[68:71], v[136:139], v[156:159], v[68:71]
    ds_read_b64_tr_b16 v[134:135], v25 offset:6656
    v_mfma_f32_16x16x32_bf16 v[72:75], v[136:139], v[160:163], v[72:75]
    buffer_load_dwordx4 a[20:23], v6, s[16:19], s51 offen offset:256 sc1
    v_mfma_f32_16x16x32_bf16 v[76:79], v[136:139], v[164:167], v[76:79]
    ds_read_b64_tr_b16 v[190:191], v28 offset:4608
    s_waitcnt lgkmcnt(10)
    v_mfma_f32_16x16x32_bf16 v[80:83], v[140:143], v[152:155], v[80:83]
    ds_read_b64_tr_b16 v[136:137], v24 offset:14336
    v_mfma_f32_16x16x32_bf16 v[84:87], v[140:143], v[156:159], v[84:87]
    ds_read_b64_tr_b16 v[138:139], v24 offset:14848
    v_mfma_f32_16x16x32_bf16 v[88:91], v[140:143], v[160:163], v[88:91]
    buffer_load_dwordx4 a[24:27], v6, s[20:23], s51 offen offset:0 sc1
    v_mfma_f32_16x16x32_bf16 v[92:95], v[140:143], v[164:167], v[92:95]
    ds_read_b128 v[192:195], v30 offset:2048
    s_waitcnt lgkmcnt(11)
    v_mfma_f32_16x16x32_bf16 v[96:99], v[152:155], v[144:147], v[96:99]
    ds_read_b64_tr_b16 v[140:141], v25 offset:14336
    v_mfma_f32_16x16x32_bf16 v[100:103], v[156:159], v[144:147], v[100:103]
    ds_read_b64_tr_b16 v[142:143], v25 offset:14848
    v_mfma_f32_16x16x32_bf16 v[104:107], v[160:163], v[144:147], v[104:107]
    buffer_load_dwordx4 a[28:31], v6, s[20:23], s51 offen offset:256 sc1
    v_mfma_f32_16x16x32_bf16 v[108:111], v[164:167], v[144:147], v[108:111]
    s_waitcnt lgkmcnt(11)
    v_mfma_f32_16x16x32_bf16 v[112:115], v[152:155], v[148:151], v[112:115]
    ds_read_b64_tr_b16 v[144:145], v24 offset:22528
    v_mfma_f32_16x16x32_bf16 v[116:119], v[156:159], v[148:151], v[116:119]
    ds_read_b64_tr_b16 v[146:147], v24 offset:23040
    v_mfma_f32_16x16x32_bf16 v[120:123], v[160:163], v[148:151], v[120:123]
    v_mfma_f32_16x16x32_bf16 v[124:127], v[164:167], v[148:151], v[124:127]
    s_waitcnt vmcnt(8) lgkmcnt(4)
    v_mfma_f32_16x16x32_bf16 v[184:187], v[188:191], v[192:195], v[184:187]
    v_mfma_f32_16x16x32_bf16 v[32:35], v[128:131], v[168:171], v[32:35]
    ds_read_b64_tr_b16 v[148:149], v25 offset:22528
    v_mfma_f32_16x16x32_bf16 v[36:39], v[128:131], v[172:175], v[36:39]
    ds_read_b64_tr_b16 v[150:151], v25 offset:23040
    s_add_u32 s52, s52, 24576
    s_cmp_eq_u32 s52, 147456
    v_mfma_f32_16x16x32_bf16 v[40:43], v[128:131], v[176:179], v[40:43]
    s_cselect_b32 s52, 0, s52
    s_barrier
    v_mfma_f32_16x16x32_bf16 v[44:47], v[128:131], v[180:183], v[44:47]
    v_add_u32 v24, s52, v26
    v_add_u32 v25, s52, v27
    s_waitcnt lgkmcnt(10)
    v_mfma_f32_16x16x32_bf16 v[48:51], v[132:135], v[168:171], v[48:51]
    ds_read_b64_tr_b16 v[128:129], v24 offset:0
    v_mfma_f32_16x16x32_bf16 v[52:55], v[132:135], v[172:175], v[52:55]
    ds_read_b64_tr_b16 v[130:131], v24 offset:512
    v_mfma_f32_16x16x32_bf16 v[56:59], v[132:135], v[176:179], v[56:59]
    buffer_load_dwordx4 v[152:155], v6, s[16:19], s51 offen offset:2048 sc1
    v_mfma_f32_16x16x32_bf16 v[60:63], v[132:135], v[180:183], v[60:63]
    ds_read_b64_tr_b16 v[188:189], v28 offset:6144
    s_waitcnt lgkmcnt(10)
    v_mfma_f32_16x16x32_bf16 v[64:67], v[136:139], v[168:171], v[64:67]
    ds_read_b64_tr_b16 v[132:133], v25 offset:0
    v_mfma_f32_16x16x32_bf16 v[68:71], v[136:139], v[172:175], v[68:71]
    ds_read_b64_tr_b16 v[134:135], v25 offset:512
    v_mfma_f32_16x16x32_bf16 v[72:75], v[136:139], v[176:179], v[72:75]
    buffer_load_dwordx4 v[156:159], v6, s[16:19], s51 offen offset:2304 sc1
    v_mfma_f32_16x16x32_bf16 v[76:79], v[136:139], v[180:183], v[76:79]
    ds_read_b64_tr_b16 v[190:191], v28 offset:6656
    s_waitcnt lgkmcnt(10)
    v_mfma_f32_16x16x32_bf16 v[80:83], v[140:143], v[168:171], v[80:83]
    ds_read_b64_tr_b16 v[136:137], v24 offset:8192
    v_mfma_f32_16x16x32_bf16 v[84:87], v[140:143], v[172:175], v[84:87]
    ds_read_b64_tr_b16 v[138:139], v24 offset:8704
    v_mfma_f32_16x16x32_bf16 v[88:91], v[140:143], v[176:179], v[88:91]
    buffer_load_dwordx4 v[160:163], v6, s[20:23], s51 offen offset:2048 sc1
    v_mfma_f32_16x16x32_bf16 v[92:95], v[140:143], v[180:183], v[92:95]
    ds_read_b128 v[192:195], v30 offset:3072
    s_waitcnt lgkmcnt(11)
    v_mfma_f32_16x16x32_bf16 v[96:99], v[168:171], v[144:147], v[96:99]
    ds_read_b64_tr_b16 v[140:141], v25 offset:8192
    v_mfma_f32_16x16x32_bf16 v[100:103], v[172:175], v[144:147], v[100:103]
    ds_read_b64_tr_b16 v[142:143], v25 offset:8704
    v_mfma_f32_16x16x32_bf16 v[104:107], v[176:179], v[144:147], v[104:107]
    buffer_load_dwordx4 v[164:167], v6, s[20:23], s51 offen offset:2304 sc1
    v_mfma_f32_16x16x32_bf16 v[108:111], v[180:183], v[144:147], v[108:111]
    v_add_u32 v28, s52, v29
    v_xor_b32 v30, 4096, v30
    s_waitcnt lgkmcnt(11)
    v_mfma_f32_16x16x32_bf16 v[112:115], v[168:171], v[148:151], v[112:115]
    ds_read_b64_tr_b16 v[144:145], v24 offset:16384
    s_add_u32 s50, s50, 8192
    v_mfma_f32_16x16x32_bf16 v[116:119], v[172:175], v[148:151], v[116:119]
    ds_read_b64_tr_b16 v[146:147], v24 offset:16896
    s_add_u32 s51, s51, 8192
    v_mfma_f32_16x16x32_bf16 v[120:123], v[176:179], v[148:151], v[120:123]
    s_sub_u32 s54, s54, 1
    v_mfma_f32_16x16x32_bf16 v[124:127], v[180:183], v[148:151], v[124:127]
    s_cmp_lg_u32 s54, 0
    s_cbranch_scc1 c_qkvA_loop
    ds_read_b32 v16, v8 offset:1280
    ds_read_b32 v17, v8 offset:2816
    ds_read_b32 v18, v8 offset:1344
    ds_read_b32 v19, v8 offset:2880
    ds_read_b32 v20, v8 offset:1408
    ds_read_b32 v21, v8 offset:2944
    ds_read_b32 v22, v8 offset:1472
    ds_read_b32 v23, v8 offset:3008
    ds_read_b128 v[212:215], v10 offset:128
    ds_read_b128 v[216:219], v10 offset:192
    ds_read2_b32 v[220:221], v11 offset0:64 offset1:80
    s_waitcnt vmcnt(0) lgkmcnt(11)
    v_mfma_f32_16x16x32_bf16 v[184:187], v[188:191], v[192:195], v[184:187]
    ds_read_b128 v[128:131], v9 offset:1280
    ds_read_b128 v[144:147], v9 offset:2816
    ds_read_b128 v[132:135], v9 offset:1344
    ds_read_b128 v[148:151], v9 offset:2880
    ds_read_b128 v[136:139], v9 offset:1408
    ds_read_b128 v[152:155], v9 offset:2944
    ds_read_b128 v[140:143], v9 offset:1472
    ds_read_b128 v[156:159], v9 offset:3008
    s_waitcnt lgkmcnt(9)
    ds_read_b128 v[160:163], v10 offset:0
    ds_read_b128 v[164:167], v10 offset:64
    ds_read_b128 v[168:171], v14 offset:128
    ds_read_b32 v222, v11 offset:1216
    ds_read_b32 v223, v11 offset:2752
    v_pk_fma_f32 v[64:65], v[16:17], v[212:213], v[64:65] op_sel_hi:[0,1,1] neg_lo:[1,0,0] neg_hi:[1,0,0]
    v_pk_fma_f32 v[66:67], v[16:17], v[214:215], v[66:67] op_sel_hi:[0,1,1] neg_lo:[1,0,0] neg_hi:[1,0,0]
    v_pk_fma_f32 v[80:81], v[16:17], v[216:217], v[80:81] op_sel_hi:[0,1,1] neg_lo:[1,0,0] neg_hi:[1,0,0]
    v_pk_fma_f32 v[82:83], v[16:17], v[218:219], v[82:83] op_sel_hi:[0,1,1] neg_lo:[1,0,0] neg_hi:[1,0,0]
    v_pk_mul_f32 v[64:65], v[16:17], v[64:65] op_sel:[1,0] op_sel_hi:[1,1]
    v_pk_mul_f32 v[66:67], v[16:17], v[66:67] op_sel:[1,0] op_sel_hi:[1,1]
    v_pk_mul_f32 v[80:81], v[16:17], v[80:81] op_sel:[1,0] op_sel_hi:[1,1]
    v_pk_mul_f32 v[82:83], v[16:17], v[82:83] op_sel:[1,0] op_sel_hi:[1,1]
    v_cvt_pk_bf16_f32 v64, v64, v65
    v_cvt_pk_bf16_f32 v65, v66, v67
    v_cvt_pk_bf16_f32 v66, v80, v81
    v_cvt_pk_bf16_f32 v67, v82, v83
    v_pk_fma_f32 v[68:69], v[18:19], v[212:213], v[68:69] op_sel_hi:[0,1,1] neg_lo:[1,0,0] neg_hi:[1,0,0]
    v_pk_fma_f32 v[70:71], v[18:19], v[214:215], v[70:71] op_sel_hi:[0,1,1] neg_lo:[1,0,0] neg_hi:[1,0,0]
    v_pk_fma_f32 v[84:85], v[18:19], v[216:217], v[84:85] op_sel_hi:[0,1,1] neg_lo:[1,0,0] neg_hi:[1,0,0]
    v_pk_fma_f32 v[86:87], v[18:19], v[218:219], v[86:87] op_sel_hi:[0,1,1] neg_lo:[1,0,0] neg_hi:[1,0,0]
    v_pk_mul_f32 v[68:69], v[18:19], v[68:69] op_sel:[1,0] op_sel_hi:[1,1]
    v_pk_mul_f32 v[70:71], v[18:19], v[70:71] op_sel:[1,0] op_sel_hi:[1,1]
    v_pk_mul_f32 v[84:85], v[18:19], v[84:85] op_sel:[1,0] op_sel_hi:[1,1]
    v_pk_mul_f32 v[86:87], v[18:19], v[86:87] op_sel:[1,0] op_sel_hi:[1,1]
    v_cvt_pk_bf16_f32 v68, v68, v69
    v_cvt_pk_bf16_f32 v69, v70, v71
    v_cvt_pk_bf16_f32 v70, v84, v85
    v_cvt_pk_bf16_f32 v71, v86, v87
    v_pk_fma_f32 v[72:73], v[20:21], v[212:213], v[72:73] op_sel_hi:[0,1,1] neg_lo:[1,0,0] neg_hi:[1,0,0]
    v_pk_fma_f32 v[74:75], v[20:21], v[214:215], v[74:75] op_sel_hi:[0,1,1] neg_lo:[1,0,0] neg_hi:[1,0,0]
    v_pk_fma_f32 v[88:89], v[20:21], v[216:217], v[88:89] op_sel_hi:[0,1,1] neg_lo:[1,0,0] neg_hi:[1,0,0]
    v_pk_fma_f32 v[90:91], v[20:21], v[218:219], v[90:91] op_sel_hi:[0,1,1] neg_lo:[1,0,0] neg_hi:[1,0,0]
    v_pk_mul_f32 v[72:73], v[20:21], v[72:73] op_sel:[1,0] op_sel_hi:[1,1]
    v_pk_mul_f32 v[74:75], v[20:21], v[74:75] op_sel:[1,0] op_sel_hi:[1,1]
    v_pk_mul_f32 v[88:89], v[20:21], v[88:89] op_sel:[1,0] op_sel_hi:[1,1]
    v_pk_mul_f32 v[90:91], v[20:21], v[90:91] op_sel:[1,0] op_sel_hi:[1,1]
    v_cvt_pk_bf16_f32 v72, v72, v73
    v_cvt_pk_bf16_f32 v73, v74, v75
    v_cvt_pk_bf16_f32 v74, v88, v89
    v_cvt_pk_bf16_f32 v75, v90, v91
    v_pk_fma_f32 v[76:77], v[22:23], v[212:213], v[76:77] op_sel_hi:[0,1,1] neg_lo:[1,0,0] neg_hi:[1,0,0]
    v_pk_fma_f32 v[78:79], v[22:23], v[214:215], v[78:79] op_sel_hi:[0,1,1] neg_lo:[1,0,0] neg_hi:[1,0,0]
    v_pk_fma_f32 v[92:93], v[22:23], v[216:217], v[92:93] op_sel_hi:[0,1,1] neg_lo:[1,0,0] neg_hi:[1,0,0]
    v_pk_fma_f32 v[94:95], v[22:23], v[218:219], v[94:95] op_sel_hi:[0,1,1] neg_lo:[1,0,0] neg_hi:[1,0,0]
    v_pk_mul_f32 v[76:77], v[22:23], v[76:77] op_sel:[1,0] op_sel_hi:[1,1]
    v_pk_mul_f32 v[78:79], v[22:23], v[78:79] op_sel:[1,0] op_sel_hi:[1,1]
    v_pk_mul_f32 v[92:93], v[22:23], v[92:93] op_sel:[1,0] op_sel_hi:[1,1]
    v_pk_mul_f32 v[94:95], v[22:23], v[94:95] op_sel:[1,0] op_sel_hi:[1,1]
    v_cvt_pk_bf16_f32 v76, v76, v77
    v_cvt_pk_bf16_f32 v77, v78, v79
    v_cvt_pk_bf16_f32 v78, v92, v93
    v_cvt_pk_bf16_f32 v79, v94, v95
    ds_write_b128 v12, v[76:79] offset:2048
    s_waitcnt lgkmcnt(1)
    v_pk_fma_f32 v[96:97], v[128:129], v[220:221], v[96:97] op_sel:[0,0,0] op_sel_hi:[1,0,1] neg_lo:[1,0,0] neg_hi:[1,0,0]
    v_pk_fma_f32 v[98:99], v[130:131], v[220:221], v[98:99] op_sel:[0,0,0] op_sel_hi:[1,0,1] neg_lo:[1,0,0] neg_hi:[1,0,0]
    v_pk_mul_f32 v[96:97], v[144:145], v[96:97]
    v_pk_mul_f32 v[98:99], v[146:147], v[98:99]
    v_pk_fma_f32 v[112:113], v[128:129], v[220:221], v[112:113] op_sel:[0,1,0] op_sel_hi:[1,1,1] neg_lo:[1,0,0] neg_hi:[1,0,0]
    v_pk_fma_f32 v[114:115], v[130:131], v[220:221], v[114:115] op_sel:[0,1,0] op_sel_hi:[1,1,1] neg_lo:[1,0,0] neg_hi:[1,0,0]
    v_pk_mul_f32 v[112:113], v[144:145], v[112:113]
    v_pk_mul_f32 v[114:115], v[146:147], v[114:115]
    v_cvt_pk_bf16_f32 v99, v98, v99
    v_cvt_pk_bf16_f32 v98, v96, v97
    v_cvt_pk_bf16_f32 v115, v114, v115
    v_cvt_pk_bf16_f32 v114, v112, v113
    v_pk_fma_f32 v[100:101], v[132:133], v[220:221], v[100:101] op_sel:[0,0,0] op_sel_hi:[1,0,1] neg_lo:[1,0,0] neg_hi:[1,0,0]
    v_pk_fma_f32 v[102:103], v[134:135], v[220:221], v[102:103] op_sel:[0,0,0] op_sel_hi:[1,0,1] neg_lo:[1,0,0] neg_hi:[1,0,0]
    v_pk_mul_f32 v[100:101], v[148:149], v[100:101]
    v_pk_mul_f32 v[102:103], v[150:151], v[102:103]
    v_pk_fma_f32 v[116:117], v[132:133], v[220:221], v[116:117] op_sel:[0,1,0] op_sel_hi:[1,1,1] neg_lo:[1,0,0] neg_hi:[1,0,0]
    v_pk_fma_f32 v[118:119], v[134:135], v[220:221], v[118:119] op_sel:[0,1,0] op_sel_hi:[1,1,1] neg_lo:[1,0,0] neg_hi:[1,0,0]
    v_pk_mul_f32 v[116:117], v[148:149], v[116:117]
    v_pk_mul_f32 v[118:119], v[150:151], v[118:119]
    v_cvt_pk_bf16_f32 v100, v100, v101
    v_cvt_pk_bf16_f32 v101, v102, v103
    v_cvt_pk_bf16_f32 v116, v116, v117
    v_cvt_pk_bf16_f32 v117, v118, v119
    v_pk_fma_f32 v[104:105], v[136:137], v[220:221], v[104:105] op_sel:[0,0,0] op_sel_hi:[1,0,1] neg_lo:[1,0,0] neg_hi:[1,0,0]
    v_pk_fma_f32 v[106:107], v[138:139], v[220:221], v[106:107] op_sel:[0,0,0] op_sel_hi:[1,0,1] neg_lo:[1,0,0] neg_hi:[1,0,0]
    v_pk_mul_f32 v[104:105], v[152:153], v[104:105]
    v_pk_mul_f32 v[106:107], v[154:155], v[106:107]
    v_pk_fma_f32 v[120:121], v[136:137], v[220:221], v[120:121] op_sel:[0,1,0] op_sel_hi:[1,1,1] neg_lo:[1,0,0] neg_hi:[1,0,0]
    v_pk_fma_f32 v[122:123], v[138:139], v[220:221], v[122:123] op_sel:[0,1,0] op_sel_hi:[1,1,1] neg_lo:[1,0,0] neg_hi:[1,0,0]
    v_pk_mul_f32 v[120:121], v[152:153], v[120:121]
    v_pk_mul_f32 v[122:123], v[154:155], v[122:123]
    v_cvt_pk_bf16_f32 v102, v104, v105
    v_cvt_pk_bf16_f32 v103, v106, v107
    v_cvt_pk_bf16_f32 v118, v120, v121
    v_cvt_pk_bf16_f32 v119, v122, v123
    v_pk_fma_f32 v[108:109], v[140:141], v[220:221], v[108:109] op_sel:[0,0,0] op_sel_hi:[1,0,1] neg_lo:[1,0,0] neg_hi:[1,0,0]
    v_pk_fma_f32 v[110:111], v[142:143], v[220:221], v[110:111] op_sel:[0,0,0] op_sel_hi:[1,0,1] neg_lo:[1,0,0] neg_hi:[1,0,0]
    v_pk_mul_f32 v[108:109], v[156:157], v[108:109]
    v_pk_mul_f32 v[110:111], v[158:159], v[110:111]
    v_pk_fma_f32 v[124:125], v[140:141], v[220:221], v[124:125] op_sel:[0,1,0] op_sel_hi:[1,1,1] neg_lo:[1,0,0] neg_hi:[1,0,0]
    v_pk_fma_f32 v[126:127], v[142:143], v[220:221], v[126:127] op_sel:[0,1,0] op_sel_hi:[1,1,1] neg_lo:[1,0,0] neg_hi:[1,0,0]
    v_pk_mul_f32 v[124:125], v[156:157], v[124:125]
    v_pk_mul_f32 v[126:127], v[158:159], v[126:127]
    v_cvt_pk_bf16_f32 v104, v108, v109
    v_cvt_pk_bf16_f32 v105, v110, v111
    v_cvt_pk_bf16_f32 v120, v124, v125
    v_cvt_pk_bf16_f32 v121, v126, v127
    ds_write_b64 v12, v[104:105] offset:3072
    ds_write_b64 v12, v[120:121] offset:3080
    v_pk_fma_f32 v[184:185], v[222:223], v[168:169], v[184:185] op_sel_hi:[0,1,1] neg_lo:[1,0,0] neg_hi:[1,0,0]
    v_pk_fma_f32 v[186:187], v[222:223], v[170:171], v[186:187] op_sel_hi:[0,1,1] neg_lo:[1,0,0] neg_hi:[1,0,0]
    v_pk_mul_f32 v[184:185], v[222:223], v[184:185] op_sel:[1,0] op_sel_hi:[1,1]
    v_pk_mul_f32 v[186:187], v[222:223], v[186:187] op_sel:[1,0] op_sel_hi:[1,1]
    v_cvt_pk_bf16_f32 v184, v184, v185
    v_cvt_pk_bf16_f32 v185, v186, v187
    s_cmp_ge_u32 s8, 2
    s_cbranch_scc1 c_qkvA_hv
    ds_write_b64 v13, v[184:185]
    s_branch c_qkvA_hd
c_qkvA_hv:
    ds_write_b16 v13, v184 offset:0
    ds_write_b16_d16_hi v13, v184 offset:16
    ds_write_b16 v13, v185 offset:32
    ds_write_b16_d16_hi v13, v185 offset:48
c_qkvA_hd:
    v_pk_fma_f32 v[44:45], v[22:23], v[160:161], v[44:45] op_sel_hi:[0,1,1] neg_lo:[1,0,0] neg_hi:[1,0,0]
    v_pk_fma_f32 v[46:47], v[22:23], v[162:163], v[46:47] op_sel_hi:[0,1,1] neg_lo:[1,0,0] neg_hi:[1,0,0]
    v_pk_fma_f32 v[60:61], v[22:23], v[164:165], v[60:61] op_sel_hi:[0,1,1] neg_lo:[1,0,0] neg_hi:[1,0,0]
    v_pk_fma_f32 v[62:63], v[22:23], v[166:167], v[62:63] op_sel_hi:[0,1,1] neg_lo:[1,0,0] neg_hi:[1,0,0]
    v_cvt_pk_bf16_f32 v44, v44, v45
    v_cvt_pk_bf16_f32 v45, v46, v47
    v_cvt_pk_bf16_f32 v46, v60, v61
    v_cvt_pk_bf16_f32 v47, v62, v63
    v_mul_f32 v23, 0x3e8293ee, v23
    v_pk_fma_f32 v[40:41], v[20:21], v[160:161], v[40:41] op_sel_hi:[0,1,1] neg_lo:[1,0,0] neg_hi:[1,0,0]
    v_pk_fma_f32 v[42:43], v[20:21], v[162:163], v[42:43] op_sel_hi:[0,1,1] neg_lo:[1,0,0] neg_hi:[1,0,0]
    v_pk_fma_f32 v[56:57], v[20:21], v[164:165], v[56:57] op_sel_hi:[0,1,1] neg_lo:[1,0,0] neg_hi:[1,0,0]
    v_pk_fma_f32 v[58:59], v[20:21], v[166:167], v[58:59] op_sel_hi:[0,1,1] neg_lo:[1,0,0] neg_hi:[1,0,0]
    v_cvt_pk_bf16_f32 v40, v40, v41
    v_cvt_pk_bf16_f32 v41, v42, v43
    v_cvt_pk_bf16_f32 v42, v56, v57
    v_cvt_pk_bf16_f32 v43, v58, v59
    v_mul_f32 v21, 0x3e8293ee, v21
    s_waitcnt lgkmcnt(0)
    s_barrier
    ds_read_b128 v[172:175], v12
    ds_read_b64 v[96:97], v12 offset:1024
    ds_read_b64 v[112:113], v12 offset:1032
    v_mfma_f32_16x16x32_bf16 v[156:159], v[76:79], v[44:47], v[196:199]
    v_mfma_f32_16x16x32_bf16 v[152:155], v[72:75], v[44:47], v[200:203]
    v_pk_fma_f32 v[36:37], v[18:19], v[160:161], v[36:37] op_sel_hi:[0,1,1] neg_lo:[1,0,0] neg_hi:[1,0,0]
    v_pk_fma_f32 v[38:39], v[18:19], v[162:163], v[38:39] op_sel_hi:[0,1,1] neg_lo:[1,0,0] neg_hi:[1,0,0]
    v_pk_fma_f32 v[52:53], v[18:19], v[164:165], v[52:53] op_sel_hi:[0,1,1] neg_lo:[1,0,0] neg_hi:[1,0,0]
    v_pk_fma_f32 v[54:55], v[18:19], v[166:167], v[54:55] op_sel_hi:[0,1,1] neg_lo:[1,0,0] neg_hi:[1,0,0]
    v_cvt_pk_bf16_f32 v36, v36, v37
    v_cvt_pk_bf16_f32 v37, v38, v39
    v_cvt_pk_bf16_f32 v38, v52, v53
    v_cvt_pk_bf16_f32 v39, v54, v55
    v_mul_f32 v19, 0x3e8293ee, v19
    v_mfma_f32_16x16x32_bf16 v[148:151], v[72:75], v[40:43], v[196:199]
    v_mfma_f32_16x16x32_bf16 v[144:147], v[68:71], v[40:43], v[200:203]
    v_pk_fma_f32 v[32:33], v[16:17], v[160:161], v[32:33] op_sel_hi:[0,1,1] neg_lo:[1,0,0] neg_hi:[1,0,0]
    v_pk_fma_f32 v[34:35], v[16:17], v[162:163], v[34:35] op_sel_hi:[0,1,1] neg_lo:[1,0,0] neg_hi:[1,0,0]
    v_pk_fma_f32 v[48:49], v[16:17], v[164:165], v[48:49] op_sel_hi:[0,1,1] neg_lo:[1,0,0] neg_hi:[1,0,0]
    v_pk_fma_f32 v[50:51], v[16:17], v[166:167], v[50:51] op_sel_hi:[0,1,1] neg_lo:[1,0,0] neg_hi:[1,0,0]
    v_cvt_pk_bf16_f32 v32, v32, v33
    v_cvt_pk_bf16_f32 v33, v34, v35
    v_cvt_pk_bf16_f32 v34, v48, v49
    v_cvt_pk_bf16_f32 v35, v50, v51
    v_mul_f32 v17, 0x3e8293ee, v17
    v_mfma_f32_16x16x32_bf16 v[140:143], v[68:71], v[36:39], v[196:199]
    v_mfma_f32_16x16x32_bf16 v[136:139], v[64:67], v[36:39], v[200:203]
    s_waitcnt lgkmcnt(2)
    v_mfma_f32_16x16x32_bf16 v[132:135], v[64:67], v[32:35], v[196:199]
    v_mfma_f32_16x16x32_bf16 v[128:131], v[172:175], v[32:35], v[204:207]
    v_max3_f32 v179, v152, v153, v154
    v_max3_f32 v183, v155, v156, v157
    v_max3_f32 v179, v179, v158, v159
    v_max_f32 v179, v179, v183
    v_max3_f32 v178, v144, v145, v146
    v_max3_f32 v182, v147, v148, v149
    v_max3_f32 v178, v178, v150, v151
    v_max_f32 v178, v178, v182
    v_max3_f32 v177, v136, v137, v138
    v_max3_f32 v181, v139, v140, v141
    v_max3_f32 v177, v177, v142, v143
    v_max_f32 v177, v177, v181
    v_max3_f32 v176, v128, v129, v130
    v_max3_f32 v180, v131, v132, v133
    v_max3_f32 v176, v176, v134, v135
    v_max_f32 v176, v176, v180
    v_mov_b32 v183, v179
    v_mov_b32 v182, v178
    v_mov_b32 v181, v177
    v_mov_b32 v180, v176
    v_permlane32_swap_b32 v179, v183
    v_permlane32_swap_b32 v178, v182
    v_permlane32_swap_b32 v177, v181
    v_permlane32_swap_b32 v176, v180
    v_max_f32 v179, v179, v183
    v_max_f32 v178, v178, v182
    v_max_f32 v177, v177, v181
    v_max_f32 v176, v176, v180
    v_mov_b32 v183, v179
    v_mov_b32 v182, v178
    v_mov_b32 v181, v177
    v_mov_b32 v180, v176
    v_permlane16_swap_b32 v179, v183
    v_permlane16_swap_b32 v178, v182
    v_permlane16_swap_b32 v177, v181
    v_permlane16_swap_b32 v176, v180
    v_max_f32 v179, v179, v183
    v_max_f32 v178, v178, v182
    v_max_f32 v177, v177, v181
    v_max_f32 v176, v176, v180
    v_mul_f32_e64 v22, -v179, v23
    v_mul_f32_e64 v20, -v178, v21
    v_mul_f32_e64 v18, -v177, v19
    v_mul_f32_e64 v16, -v176, v17
    s_waitcnt lgkmcnt(0)
    s_add_u32 s51, s49, 65536
    v_pk_fma_f32 v[152:153], v[152:153], v[22:23], v[22:23] op_sel:[0,1,0] op_sel_hi:[1,1,0]
    v_pk_fma_f32 v[154:155], v[154:155], v[22:23], v[22:23] op_sel:[0,1,0] op_sel_hi:[1,1,0]
    v_pk_fma_f32 v[156:157], v[156:157], v[22:23], v[22:23] op_sel:[0,1,0] op_sel_hi:[1,1,0]
    v_pk_fma_f32 v[158:159], v[158:159], v[22:23], v[22:23] op_sel:[0,1,0] op_sel_hi:[1,1,0]
    v_exp_f32 v152, v152
    v_exp_f32 v153, v153
    v_exp_f32 v154, v154
    v_exp_f32 v155, v155
    v_exp_f32 v156, v156
    v_exp_f32 v157, v157
    v_exp_f32 v158, v158
    v_exp_f32 v159, v159
    v_cvt_pk_bf16_f32 v172, v152, v153
    v_cvt_pk_bf16_f32 v173, v154, v155
    v_cvt_pk_bf16_f32 v174, v156, v157
    v_cvt_pk_bf16_f32 v175, v158, v159
    s_nop 1
    v_mfma_f32_16x16x32_bf16 v[92:95], v[208:211], v[172:175], 0
    v_mfma_f32_16x16x32_bf16 v[60:63], v[102:105], v[172:175], 0
    v_mfma_f32_16x16x32_bf16 v[76:79], v[118:121], v[172:175], 0
    v_pk_fma_f32 v[144:145], v[144:145], v[20:21], v[20:21] op_sel:[0,1,0] op_sel_hi:[1,1,0]
    v_pk_fma_f32 v[146:147], v[146:147], v[20:21], v[20:21] op_sel:[0,1,0] op_sel_hi:[1,1,0]
    v_pk_fma_f32 v[148:149], v[148:149], v[20:21], v[20:21] op_sel:[0,1,0] op_sel_hi:[1,1,0]
    v_pk_fma_f32 v[150:151], v[150:151], v[20:21], v[20:21] op_sel:[0,1,0] op_sel_hi:[1,1,0]
    v_exp_f32 v144, v144
    v_exp_f32 v145, v145
    v_exp_f32 v146, v146
    v_exp_f32 v147, v147
    v_exp_f32 v148, v148
    v_exp_f32 v149, v149
    v_exp_f32 v150, v150
    v_exp_f32 v151, v151
    v_cvt_pk_bf16_f32 v168, v144, v145
    v_cvt_pk_bf16_f32 v169, v146, v147
    v_cvt_pk_bf16_f32 v170, v148, v149
    v_cvt_pk_bf16_f32 v171, v150, v151
    v_rcp_f32 v92, v92
    s_nop 0
    v_pk_mul_f32 v[60:61], v[92:93], v[60:61] op_sel_hi:[0,1]
    v_pk_mul_f32 v[62:63], v[92:93], v[62:63] op_sel_hi:[0,1]
    v_pk_mul_f32 v[76:77], v[92:93], v[76:77] op_sel_hi:[0,1]
    v_pk_mul_f32 v[78:79], v[92:93], v[78:79] op_sel_hi:[0,1]
    v_cvt_pk_bf16_f32 v60, v60, v61
    v_cvt_pk_bf16_f32 v61, v62, v63
    v_cvt_pk_bf16_f32 v62, v76, v77
    v_cvt_pk_bf16_f32 v63, v78, v79
    s_nop 0
    v_permlane32_swap_b32 v60, v62
    v_permlane32_swap_b32 v61, v63
    buffer_store_dwordx4 v[60:63], v6, s[12:15], s51 offen offset:256 sc1
    v_mfma_f32_16x16x32_bf16 v[88:91], v[208:211], v[168:171], 0
    v_mfma_f32_16x16x32_bf16 v[56:59], v[100:103], v[168:171], 0
    v_mfma_f32_16x16x32_bf16 v[72:75], v[116:119], v[168:171], 0
    v_pk_fma_f32 v[136:137], v[136:137], v[18:19], v[18:19] op_sel:[0,1,0] op_sel_hi:[1,1,0]
    v_pk_fma_f32 v[138:139], v[138:139], v[18:19], v[18:19] op_sel:[0,1,0] op_sel_hi:[1,1,0]
    v_pk_fma_f32 v[140:141], v[140:141], v[18:19], v[18:19] op_sel:[0,1,0] op_sel_hi:[1,1,0]
    v_pk_fma_f32 v[142:143], v[142:143], v[18:19], v[18:19] op_sel:[0,1,0] op_sel_hi:[1,1,0]
    v_exp_f32 v136, v136
    v_exp_f32 v137, v137
    v_exp_f32 v138, v138
    v_exp_f32 v139, v139
    v_exp_f32 v140, v140
    v_exp_f32 v141, v141
    v_exp_f32 v142, v142
    v_exp_f32 v143, v143
    v_cvt_pk_bf16_f32 v164, v136, v137
    v_cvt_pk_bf16_f32 v165, v138, v139
    v_cvt_pk_bf16_f32 v166, v140, v141
    v_cvt_pk_bf16_f32 v167, v142, v143
    v_rcp_f32 v88, v88
    s_nop 0
    v_pk_mul_f32 v[56:57], v[88:89], v[56:57] op_sel_hi:[0,1]
    v_pk_mul_f32 v[58:59], v[88:89], v[58:59] op_sel_hi:[0,1]
    v_pk_mul_f32 v[72:73], v[88:89], v[72:73] op_sel_hi:[0,1]
    v_pk_mul_f32 v[74:75], v[88:89], v[74:75] op_sel_hi:[0,1]
    v_cvt_pk_bf16_f32 v56, v56, v57
    v_cvt_pk_bf16_f32 v57, v58, v59
    v_cvt_pk_bf16_f32 v58, v72, v73
    v_cvt_pk_bf16_f32 v59, v74, v75
    s_nop 0
    v_permlane32_swap_b32 v56, v58
    v_permlane32_swap_b32 v57, v59
    buffer_store_dwordx4 v[56:59], v6, s[12:15], s51 offen offset:0 sc1
    v_mfma_f32_16x16x32_bf16 v[84:87], v[208:211], v[164:167], 0
    v_mfma_f32_16x16x32_bf16 v[52:55], v[98:101], v[164:167], 0
    v_mfma_f32_16x16x32_bf16 v[68:71], v[114:117], v[164:167], 0
    v_pk_fma_f32 v[128:129], v[128:129], v[16:17], v[16:17] op_sel:[0,1,0] op_sel_hi:[1,1,0]
    v_pk_fma_f32 v[130:131], v[130:131], v[16:17], v[16:17] op_sel:[0,1,0] op_sel_hi:[1,1,0]
    v_pk_fma_f32 v[132:133], v[132:133], v[16:17], v[16:17] op_sel:[0,1,0] op_sel_hi:[1,1,0]
    v_pk_fma_f32 v[134:135], v[134:135], v[16:17], v[16:17] op_sel:[0,1,0] op_sel_hi:[1,1,0]
    v_exp_f32 v128, v128
    v_exp_f32 v129, v129
    v_exp_f32 v130, v130
    v_exp_f32 v131, v131
    v_exp_f32 v132, v132
    v_exp_f32 v133, v133
    v_exp_f32 v134, v134
    v_exp_f32 v135, v135
    v_cvt_pk_bf16_f32 v160, v128, v129
    v_cvt_pk_bf16_f32 v161, v130, v131
    v_cvt_pk_bf16_f32 v162, v132, v133
    v_cvt_pk_bf16_f32 v163, v134, v135
    v_rcp_f32 v84, v84
    s_nop 0
    v_pk_mul_f32 v[52:53], v[84:85], v[52:53] op_sel_hi:[0,1]
    v_pk_mul_f32 v[54:55], v[84:85], v[54:55] op_sel_hi:[0,1]
    v_pk_mul_f32 v[68:69], v[84:85], v[68:69] op_sel_hi:[0,1]
    v_pk_mul_f32 v[70:71], v[84:85], v[70:71] op_sel_hi:[0,1]
    v_cvt_pk_bf16_f32 v52, v52, v53
    v_cvt_pk_bf16_f32 v53, v54, v55
    v_cvt_pk_bf16_f32 v54, v68, v69
    v_cvt_pk_bf16_f32 v55, v70, v71
    s_nop 0
    v_permlane32_swap_b32 v52, v54
    v_permlane32_swap_b32 v53, v55
    buffer_store_dwordx4 v[52:55], v6, s[12:15], s49 offen offset:256 sc1
    v_mfma_f32_16x16x32_bf16 v[80:83], v[208:211], v[160:163], 0
    v_mfma_f32_16x16x32_bf16 v[48:51], v[96:99], v[160:163], 0
    v_mfma_f32_16x16x32_bf16 v[64:67], v[112:115], v[160:163], 0
    s_nop 5
    v_rcp_f32 v80, v80
    s_nop 0
    v_pk_mul_f32 v[48:49], v[80:81], v[48:49] op_sel_hi:[0,1]
    v_pk_mul_f32 v[50:51], v[80:81], v[50:51] op_sel_hi:[0,1]
    v_pk_mul_f32 v[64:65], v[80:81], v[64:65] op_sel_hi:[0,1]
    v_pk_mul_f32 v[66:67], v[80:81], v[66:67] op_sel_hi:[0,1]
    v_cvt_pk_bf16_f32 v48, v48, v49
    v_cvt_pk_bf16_f32 v49, v50, v51
    v_cvt_pk_bf16_f32 v50, v64, v65
    v_cvt_pk_bf16_f32 v51, v66, v67
    s_nop 0
    v_permlane32_swap_b32 v48, v50
    v_permlane32_swap_b32 v49, v51
    buffer_store_dwordx4 v[48:51], v6, s[12:15], s49 offen offset:0 sc1
    s_mul_i32 s55, s9, 786432
    s_add_u32 s55, s55, 65798144
    v_and_b32 v16, 63, v0
    s_and_b32 s56, s11, 0xe0
    v_lshrrev_b32 v17, 5, v16
    v_add_u32 v16, s56, v16
    v_and_b32 v16, 255, v16
    v_lshlrev_b32 v16, 10, v16
    v_lshl_add_u32 v16, v17, 8, v16
    s_bfe_u32 s56, s11, 0x20003
    s_and_b32 s57, s11, 7
    s_lshl_b32 s56, s56, 7
    s_lshl_b32 s57, s57, 2
    s_add_u32 s55, s55, s56
    s_add_u32 s55, s55, s57
    v_mov_b32 v17, 159488
    v_mov_b32 v18, 1
    v_mov_b32 v19, s10
    s_mov_b64 exec, 1
    s_waitcnt vmcnt(0)
    ds_add_rtn_u32 v18, v17, v18
    s_waitcnt lgkmcnt(0)
    v_readfirstlane_b32 s56, v18
    s_and_b32 s56, s56, 3
    s_cmp_lg_u32 s56, 3
    s_cbranch_scc1 pub_1
    s_mov_b32 exec_lo, -1
    buffer_store_dword v19, v16, s[12:15], s55 offen sc1
pub_1:
    s_mov_b64 exec, -1
    s_branch c_wo
.p2align 6
c_wo:
    v_and_b32 v1, 63, v0
    v_lshrrev_b32 v2, 6, v0
    v_lshlrev_b32 v5, 4, v1
    v_lshrrev_b32 v3, 5, v1
    s_lshl_b32 s48, s6, 2
    s_add_u32 s48, s48, s8
    s_lshl_b32 s55, s48, 16
    s_lshl_b32 s56, s9, 22
    s_add_u32 s55, s55, s56
    s_lshl_b32 s56, s7, 12
    s_add_u32 s58, s55, s56
    buffer_load_dwordx4 v[96:99], v5, s[12:15], s58 offen offset:0 sc1
    buffer_load_dwordx4 v[100:103], v5, s[12:15], s58 offen offset:1024 sc1
    buffer_load_dwordx4 v[104:107], v5, s[12:15], s58 offen offset:2048 sc1
    buffer_load_dwordx4 v[108:111], v5, s[12:15], s58 offen offset:3072 sc1
    s_add_u32 s55, s55, 16777216
    s_add_u32 s16, s4, s55
    s_addc_u32 s17, s5, 0
    s_mov_b32 s18, 65536
    s_mov_b32 s19, 0x00020000
    v_and_b32 v4, 15, v0
    v_lshrrev_b32 v16, 2, v4
    v_lshl_add_u32 v16, v3, 2, v16
    v_lshlrev_b32 v16, 7, v16
    v_bfe_u32 v17, v1, 4, 1
    v_lshl_add_u32 v16, v17, 5, v16
    v_and_b32 v17, 3, v4
    v_lshl_add_u32 v16, v17, 3, v16
    v_lshrrev_b32 v17, 3, v4
    v_lshlrev_b32 v18, 6, v17
    v_add_u32 v12, v16, v18
    v_sub_u32 v13, v16, v18
    v_mov_b32 v32, 0
    v_mov_b32 v33, 0
    v_mov_b32 v34, 0
    v_mov_b32 v35, 0
    v_mov_b32 v36, 0
    v_mov_b32 v37, 0
    v_mov_b32 v38, 0
    v_mov_b32 v39, 0
    v_mov_b32 v40, 0
    v_mov_b32 v41, 0
    v_mov_b32 v42, 0
    v_mov_b32 v43, 0
    v_mov_b32 v44, 0
    v_mov_b32 v45, 0
    v_mov_b32 v46, 0
    v_mov_b32 v47, 0
    v_mov_b32 v48, 0
    v_mov_b32 v49, 0
    v_mov_b32 v50, 0
    v_mov_b32 v51, 0
    v_mov_b32 v52, 0
    v_mov_b32 v53, 0
    v_mov_b32 v54, 0
    v_mov_b32 v55, 0
    v_mov_b32 v56, 0
    v_mov_b32 v57, 0
    v_mov_b32 v58, 0
    v_mov_b32 v59, 0
    v_mov_b32 v60, 0
    v_mov_b32 v61, 0
    v_mov_b32 v62, 0
    v_mov_b32 v63, 0
    s_mov_b32 s50, 0
    s_mov_b32 s51, 4096
    s_mov_b32 s52, 8192
    s_mov_b32 s53, 12288
    s_mov_b32 s54, 4
    s_barrier
    buffer_load_dwordx4 v[112:115], v5, s[16:19], s50 offen offset:0 sc1
    buffer_load_dwordx4 v[116:119], v5, s[16:19], s50 offen offset:1024 sc1
    buffer_load_dwordx4 v[120:123], v5, s[16:19], s50 offen offset:2048 sc1
    buffer_load_dwordx4 v[124:127], v5, s[16:19], s50 offen offset:3072 sc1
    ds_read_b64_tr_b16 v[64:65], v12 offset:0
    ds_read_b64_tr_b16 v[66:67], v12 offset:1024
    ds_read_b64_tr_b16 v[68:69], v13 offset:64
    ds_read_b64_tr_b16 v[70:71], v13 offset:1088
    ds_read_b64_tr_b16 v[72:73], v12 offset:2048
    ds_read_b64_tr_b16 v[74:75], v12 offset:3072
    ds_read_b64_tr_b16 v[76:77], v13 offset:2112
    ds_read_b64_tr_b16 v[78:79], v13 offset:3136
    ds_read_b64_tr_b16 v[80:81], v12 offset:4096
    ds_read_b64_tr_b16 v[82:83], v12 offset:5120
    ds_read_b64_tr_b16 v[84:85], v13 offset:4160
    ds_read_b64_tr_b16 v[86:87], v13 offset:5184
    buffer_load_dwordx4 v[128:131], v5, s[16:19], s51 offen offset:0 sc1
    buffer_load_dwordx4 v[132:135], v5, s[16:19], s51 offen offset:1024 sc1
    buffer_load_dwordx4 v[136:139], v5, s[16:19], s51 offen offset:2048 sc1
    buffer_load_dwordx4 v[140:143], v5, s[16:19], s51 offen offset:3072 sc1
    buffer_load_dwordx4 v[144:147], v5, s[16:19], s52 offen offset:0 sc1
    buffer_load_dwordx4 v[148:151], v5, s[16:19], s52 offen offset:1024 sc1
    buffer_load_dwordx4 v[152:155], v5, s[16:19], s52 offen offset:2048 sc1
    buffer_load_dwordx4 v[156:159], v5, s[16:19], s52 offen offset:3072 sc1
    buffer_load_dwordx4 v[160:163], v5, s[16:19], s53 offen offset:0 sc1
    buffer_load_dwordx4 v[164:167], v5, s[16:19], s53 offen offset:1024 sc1
    buffer_load_dwordx4 v[168:171], v5, s[16:19], s53 offen offset:2048 sc1
    s_add_u32 s50, s50, 15360
    s_add_u32 s51, s51, 15360
    s_add_u32 s52, s52, 15360
    s_add_u32 s53, s53, 15360
.p2align 3
c_wo_loop:
    s_waitcnt vmcnt(14) lgkmcnt(8)
    v_mfma_f32_32x32x16_bf16 v[32:47], v[64:67], v[112:115], v[32:47]
    ds_read_b64_tr_b16 v[88:89], v12 offset:6144
    ds_read_b64_tr_b16 v[90:91], v12 offset:7168
    buffer_load_dwordx4 v[172:175], v5, s[16:19], s50 offen offset:0 sc1
    v_mfma_f32_32x32x16_bf16 v[48:63], v[68:71], v[112:115], v[48:63]
    ds_read_b64_tr_b16 v[92:93], v13 offset:6208
    ds_read_b64_tr_b16 v[94:95], v13 offset:7232
    s_waitcnt vmcnt(14) lgkmcnt(8)
    v_mfma_f32_32x32x16_bf16 v[32:47], v[72:75], v[116:119], v[32:47]
    ds_read_b64_tr_b16 v[64:65], v12 offset:8192
    ds_read_b64_tr_b16 v[66:67], v12 offset:9216
    buffer_load_dwordx4 v[112:115], v5, s[16:19], s50 offen offset:1024 sc1
    v_mfma_f32_32x32x16_bf16 v[48:63], v[76:79], v[116:119], v[48:63]
    ds_read_b64_tr_b16 v[68:69], v13 offset:8256
    ds_read_b64_tr_b16 v[70:71], v13 offset:9280
    s_waitcnt vmcnt(14) lgkmcnt(8)
    v_mfma_f32_32x32x16_bf16 v[32:47], v[80:83], v[120:123], v[32:47]
    ds_read_b64_tr_b16 v[72:73], v12 offset:10240
    ds_read_b64_tr_b16 v[74:75], v12 offset:11264
    buffer_load_dwordx4 v[116:119], v5, s[16:19], s50 offen offset:2048 sc1
    v_mfma_f32_32x32x16_bf16 v[48:63], v[84:87], v[120:123], v[48:63]
    ds_read_b64_tr_b16 v[76:77], v13 offset:10304
    ds_read_b64_tr_b16 v[78:79], v13 offset:11328
    s_waitcnt vmcnt(14) lgkmcnt(8)
    v_mfma_f32_32x32x16_bf16 v[32:47], v[88:91], v[124:127], v[32:47]
    ds_read_b64_tr_b16 v[80:81], v12 offset:12288
    ds_read_b64_tr_b16 v[82:83], v12 offset:13312
    buffer_load_dwordx4 v[120:123], v5, s[16:19], s50 offen offset:3072 sc1
    v_mfma_f32_32x32x16_bf16 v[48:63], v[92:95], v[124:127], v[48:63]
    ds_read_b64_tr_b16 v[84:85], v13 offset:12352
    ds_read_b64_tr_b16 v[86:87], v13 offset:13376
    s_add_u32 s50, s50, 16384
    s_waitcnt vmcnt(14) lgkmcnt(8)
    v_mfma_f32_32x32x16_bf16 v[32:47], v[64:67], v[128:131], v[32:47]
    ds_read_b64_tr_b16 v[88:89], v12 offset:14336
    ds_read_b64_tr_b16 v[90:91], v12 offset:15360
    buffer_load_dwordx4 v[124:127], v5, s[16:19], s51 offen offset:0 sc1
    v_mfma_f32_32x32x16_bf16 v[48:63], v[68:71], v[128:131], v[48:63]
    ds_read_b64_tr_b16 v[92:93], v13 offset:14400
    ds_read_b64_tr_b16 v[94:95], v13 offset:15424
    s_waitcnt vmcnt(14) lgkmcnt(8)
    v_mfma_f32_32x32x16_bf16 v[32:47], v[72:75], v[132:135], v[32:47]
    ds_read_b64_tr_b16 v[64:65], v12 offset:16384
    ds_read_b64_tr_b16 v[66:67], v12 offset:17408
    buffer_load_dwordx4 v[128:131], v5, s[16:19], s51 offen offset:1024 sc1
    v_mfma_f32_32x32x16_bf16 v[48:63], v[76:79], v[132:135], v[48:63]
    ds_read_b64_tr_b16 v[68:69], v13 offset:16448
    ds_read_b64_tr_b16 v[70:71], v13 offset:17472
    s_waitcnt vmcnt(14) lgkmcnt(8)
    v_mfma_f32_32x32x16_bf16 v[32:47], v[80:83], v[136:139], v[32:47]
    ds_read_b64_tr_b16 v[72:73], v12 offset:18432
    ds_read_b64_tr_b16 v[74:75], v12 offset:19456
    buffer_load_dwordx4 v[132:135], v5, s[16:19], s51 offen offset:2048 sc1
    v_mfma_f32_32x32x16_bf16 v[48:63], v[84:87], v[136:139], v[48:63]
    ds_read_b64_tr_b16 v[76:77], v13 offset:18496
    ds_read_b64_tr_b16 v[78:79], v13 offset:19520
    s_waitcnt vmcnt(14) lgkmcnt(8)
    v_mfma_f32_32x32x16_bf16 v[32:47], v[88:91], v[140:143], v[32:47]
    ds_read_b64_tr_b16 v[80:81], v12 offset:20480
    ds_read_b64_tr_b16 v[82:83], v12 offset:21504
    buffer_load_dwordx4 v[136:139], v5, s[16:19], s51 offen offset:3072 sc1
    v_mfma_f32_32x32x16_bf16 v[48:63], v[92:95], v[140:143], v[48:63]
    ds_read_b64_tr_b16 v[84:85], v13 offset:20544
    ds_read_b64_tr_b16 v[86:87], v13 offset:21568
    s_add_u32 s51, s51, 16384
    s_waitcnt vmcnt(14) lgkmcnt(8)
    v_mfma_f32_32x32x16_bf16 v[32:47], v[64:67], v[144:147], v[32:47]
    ds_read_b64_tr_b16 v[88:89], v12 offset:22528
    ds_read_b64_tr_b16 v[90:91], v12 offset:23552
    buffer_load_dwordx4 v[140:143], v5, s[16:19], s52 offen offset:0 sc1
    v_mfma_f32_32x32x16_bf16 v[48:63], v[68:71], v[144:147], v[48:63]
    ds_read_b64_tr_b16 v[92:93], v13 offset:22592
    ds_read_b64_tr_b16 v[94:95], v13 offset:23616
    s_waitcnt vmcnt(14) lgkmcnt(8)
    v_mfma_f32_32x32x16_bf16 v[32:47], v[72:75], v[148:151], v[32:47]
    ds_read_b64_tr_b16 v[64:65], v12 offset:24576
    ds_read_b64_tr_b16 v[66:67], v12 offset:25600
    buffer_load_dwordx4 v[144:147], v5, s[16:19], s52 offen offset:1024 sc1
    v_mfma_f32_32x32x16_bf16 v[48:63], v[76:79], v[148:151], v[48:63]
    ds_read_b64_tr_b16 v[68:69], v13 offset:24640
    ds_read_b64_tr_b16 v[70:71], v13 offset:25664
    s_waitcnt vmcnt(14) lgkmcnt(8)
    v_mfma_f32_32x32x16_bf16 v[32:47], v[80:83], v[152:155], v[32:47]
    ds_read_b64_tr_b16 v[72:73], v12 offset:26624
    ds_read_b64_tr_b16 v[74:75], v12 offset:27648
    buffer_load_dwordx4 v[148:151], v5, s[16:19], s52 offen offset:2048 sc1
    v_mfma_f32_32x32x16_bf16 v[48:63], v[84:87], v[152:155], v[48:63]
    ds_read_b64_tr_b16 v[76:77], v13 offset:26688
    ds_read_b64_tr_b16 v[78:79], v13 offset:27712
    s_waitcnt vmcnt(14) lgkmcnt(8)
    v_mfma_f32_32x32x16_bf16 v[32:47], v[88:91], v[156:159], v[32:47]
    ds_read_b64_tr_b16 v[80:81], v12 offset:28672
    ds_read_b64_tr_b16 v[82:83], v12 offset:29696
    buffer_load_dwordx4 v[152:155], v5, s[16:19], s52 offen offset:3072 sc1
    v_mfma_f32_32x32x16_bf16 v[48:63], v[92:95], v[156:159], v[48:63]
    ds_read_b64_tr_b16 v[84:85], v13 offset:28736
    ds_read_b64_tr_b16 v[86:87], v13 offset:29760
    s_add_u32 s52, s52, 16384
    s_waitcnt vmcnt(14) lgkmcnt(8)
    v_mfma_f32_32x32x16_bf16 v[32:47], v[64:67], v[160:163], v[32:47]
    ds_read_b64_tr_b16 v[88:89], v12 offset:30720
    ds_read_b64_tr_b16 v[90:91], v12 offset:31744
    buffer_load_dwordx4 v[156:159], v5, s[16:19], s53 offen offset:0 sc1
    v_mfma_f32_32x32x16_bf16 v[48:63], v[68:71], v[160:163], v[48:63]
    ds_read_b64_tr_b16 v[92:93], v13 offset:30784
    ds_read_b64_tr_b16 v[94:95], v13 offset:31808
    s_waitcnt vmcnt(14) lgkmcnt(8)
    v_mfma_f32_32x32x16_bf16 v[32:47], v[72:75], v[164:167], v[32:47]
    ds_read_b64_tr_b16 v[64:65], v12 offset:32768
    ds_read_b64_tr_b16 v[66:67], v12 offset:33792
    buffer_load_dwordx4 v[160:163], v5, s[16:19], s53 offen offset:1024 sc1
    v_mfma_f32_32x32x16_bf16 v[48:63], v[76:79], v[164:167], v[48:63]
    ds_read_b64_tr_b16 v[68:69], v13 offset:32832
    ds_read_b64_tr_b16 v[70:71], v13 offset:33856
    s_waitcnt vmcnt(14) lgkmcnt(8)
    v_mfma_f32_32x32x16_bf16 v[32:47], v[80:83], v[168:171], v[32:47]
    ds_read_b64_tr_b16 v[72:73], v12 offset:34816
    ds_read_b64_tr_b16 v[74:75], v12 offset:35840
    buffer_load_dwordx4 v[164:167], v5, s[16:19], s53 offen offset:2048 sc1
    v_mfma_f32_32x32x16_bf16 v[48:63], v[84:87], v[168:171], v[48:63]
    ds_read_b64_tr_b16 v[76:77], v13 offset:34880
    ds_read_b64_tr_b16 v[78:79], v13 offset:35904
    s_waitcnt vmcnt(14) lgkmcnt(8)
    v_mfma_f32_32x32x16_bf16 v[32:47], v[88:91], v[172:175], v[32:47]
    ds_read_b64_tr_b16 v[80:81], v12 offset:36864
    ds_read_b64_tr_b16 v[82:83], v12 offset:37888
    buffer_load_dwordx4 v[168:171], v5, s[16:19], s53 offen offset:3072 sc1
    v_add_u32 v12, 32768, v12
    v_mfma_f32_32x32x16_bf16 v[48:63], v[92:95], v[172:175], v[48:63]
    ds_read_b64_tr_b16 v[84:85], v13 offset:36928
    ds_read_b64_tr_b16 v[86:87], v13 offset:37952
    v_add_u32 v13, 32768, v13
    s_add_u32 s53, s53, 16384
    s_sub_u32 s54, s54, 1
    s_cmp_lg_u32 s54, 0
    s_cbranch_scc1 c_wo_loop
    s_mov_b32 s57, 0xffff0000
    v_lshlrev_b32 v176, 16, v96
    v_and_b32 v177, s57, v96
    v_lshlrev_b32 v178, 16, v97
    v_and_b32 v179, s57, v97
    v_lshlrev_b32 v180, 16, v98
    v_and_b32 v181, s57, v98
    v_lshlrev_b32 v182, 16, v99
    v_and_b32 v183, s57, v99
    v_lshlrev_b32 v184, 16, v100
    v_and_b32 v185, s57, v100
    v_lshlrev_b32 v186, 16, v101
    v_and_b32 v187, s57, v101
    v_lshlrev_b32 v188, 16, v102
    v_and_b32 v189, s57, v102
    v_lshlrev_b32 v190, 16, v103
    v_and_b32 v191, s57, v103
    v_lshlrev_b32 v192, 16, v104
    v_and_b32 v193, s57, v104
    v_lshlrev_b32 v194, 16, v105
    v_and_b32 v195, s57, v105
    v_lshlrev_b32 v196, 16, v106
    v_and_b32 v197, s57, v106
    v_lshlrev_b32 v198, 16, v107
    v_and_b32 v199, s57, v107
    v_lshlrev_b32 v200, 16, v108
    v_and_b32 v201, s57, v108
    v_lshlrev_b32 v202, 16, v109
    v_and_b32 v203, s57, v109
    v_lshlrev_b32 v204, 16, v110
    v_and_b32 v205, s57, v110
    v_lshlrev_b32 v206, 16, v111
    v_and_b32 v207, s57, v111
    s_cmp_eq_u32 s9, 3
    s_cbranch_scc1 c_wo_fin
    s_add_u32 s58, s58, 4194304
    v_pk_add_f32 v[32:33], v[32:33], v[176:177]
    v_pk_add_f32 v[34:35], v[34:35], v[178:179]
    v_pk_add_f32 v[36:37], v[36:37], v[180:181]
    v_pk_add_f32 v[38:39], v[38:39], v[182:183]
    v_cvt_pk_bf16_f32 v96, v32, v33
    v_cvt_pk_bf16_f32 v97, v34, v35
    v_cvt_pk_bf16_f32 v98, v36, v37
    v_cvt_pk_bf16_f32 v99, v38, v39
    buffer_store_dwordx4 v[96:99], v5, s[12:15], s58 offen offset:0 sc1
    v_pk_add_f32 v[40:41], v[40:41], v[184:185]
    v_pk_add_f32 v[42:43], v[42:43], v[186:187]
    v_pk_add_f32 v[44:45], v[44:45], v[188:189]
    v_pk_add_f32 v[46:47], v[46:47], v[190:191]
    v_cvt_pk_bf16_f32 v100, v40, v41
    v_cvt_pk_bf16_f32 v101, v42, v43
    v_cvt_pk_bf16_f32 v102, v44, v45
    v_cvt_pk_bf16_f32 v103, v46, v47
    buffer_store_dwordx4 v[100:103], v5, s[12:15], s58 offen offset:1024 sc1
    v_pk_add_f32 v[48:49], v[48:49], v[192:193]
    v_pk_add_f32 v[50:51], v[50:51], v[194:195]
    v_pk_add_f32 v[52:53], v[52:53], v[196:197]
    v_pk_add_f32 v[54:55], v[54:55], v[198:199]
    v_cvt_pk_bf16_f32 v104, v48, v49
    v_cvt_pk_bf16_f32 v105, v50, v51
    v_cvt_pk_bf16_f32 v106, v52, v53
    v_cvt_pk_bf16_f32 v107, v54, v55
    buffer_store_dwordx4 v[104:107], v5, s[12:15], s58 offen offset:2048 sc1
    v_pk_add_f32 v[56:57], v[56:57], v[200:201]
    v_pk_add_f32 v[58:59], v[58:59], v[202:203]
    v_pk_add_f32 v[60:61], v[60:61], v[204:205]
    v_pk_add_f32 v[62:63], v[62:63], v[206:207]
    v_cvt_pk_bf16_f32 v108, v56, v57
    v_cvt_pk_bf16_f32 v109, v58, v59
    v_cvt_pk_bf16_f32 v110, v60, v61
    v_cvt_pk_bf16_f32 v111, v62, v63
    buffer_store_dwordx4 v[108:111], v5, s[12:15], s58 offen offset:3072 sc1
    s_barrier
c_wo_stat:
    v_mov_b32 v22, 0x3f803f80
    v_mov_b32 v18, 0
    v_mov_b32 v19, 0
    v_dot2_f32_bf16 v18, v96, v22, v18
    v_dot2_f32_bf16 v19, v96, v96, v19
    v_dot2_f32_bf16 v18, v97, v22, v18
    v_dot2_f32_bf16 v19, v97, v97, v19
    v_dot2_f32_bf16 v18, v98, v22, v18
    v_dot2_f32_bf16 v19, v98, v98, v19
    v_dot2_f32_bf16 v18, v99, v22, v18
    v_dot2_f32_bf16 v19, v99, v99, v19
    v_dot2_f32_bf16 v18, v100, v22, v18
    v_dot2_f32_bf16 v19, v100, v100, v19
    v_dot2_f32_bf16 v18, v101, v22, v18
    v_dot2_f32_bf16 v19, v101, v101, v19
    v_dot2_f32_bf16 v18, v102, v22, v18
    v_dot2_f32_bf16 v19, v102, v102, v19
    v_dot2_f32_bf16 v18, v103, v22, v18
    v_dot2_f32_bf16 v19, v103, v103, v19
    v_dot2_f32_bf16 v18, v104, v22, v18
    v_dot2_f32_bf16 v19, v104, v104, v19
    v_dot2_f32_bf16 v18, v105, v22, v18
    v_dot2_f32_bf16 v19, v105, v105, v19
    v_dot2_f32_bf16 v18, v106, v22, v18
    v_dot2_f32_bf16 v19, v106, v106, v19
    v_dot2_f32_bf16 v18, v107, v22, v18
    v_dot2_f32_bf16 v19, v107, v107, v19
    v_dot2_f32_bf16 v18, v108, v22, v18
    v_dot2_f32_bf16 v19, v108, v108, v19
    v_dot2_f32_bf16 v18, v109, v22, v18
    v_dot2_f32_bf16 v19, v109, v109, v19
    v_dot2_f32_bf16 v18, v110, v22, v18
    v_dot2_f32_bf16 v19, v110, v110, v19
    v_dot2_f32_bf16 v18, v111, v22, v18
    v_dot2_f32_bf16 v19, v111, v111, v19
    v_lshlrev_b32 v16, 3, v1
    s_lshl_b32 s3, s48, 12
    s_lshl_b32 s55, s7, 8
    v_mov_b32 v20, v18
    v_mov_b32 v21, v19
    s_add_u32 s3, s3, s55
    s_lshl_b32 s55, s9, 18
    v_permlane32_swap_b32 v18, v20
    v_permlane32_swap_b32 v19, v21
    s_add_u32 s3, s3, s55
    s_add_u32 s3, s3, 63176704
    v_pk_add_f32 v[18:19], v[18:19], v[20:21]
    s_mov_b32 exec_hi, 0
    buffer_store_dwordx2 v[18:19], v16, s[12:15], s3 offen sc1
    s_mov_b64 exec, -1
    s_cmp_lg_u32 s9, -1
    s_cbranch_scc1 c_wo_pub
    s_barrier
    v_mov_b32 v24, 159492
non_2:
    ds_read_b32 v25, v24
    s_waitcnt lgkmcnt(0)
    v_readfirstlane_b32 s10, v25
    s_cmp_eq_u32 s10, 0
    s_cbranch_scc1 non_2
c_wo_pub:
    s_mul_i32 s55, s9, 786432
    s_add_u32 s55, s55, 66060288
    v_and_b32 v24, 63, v0
    s_and_b32 s56, s11, 0xe0
    v_lshrrev_b32 v25, 5, v24
    v_add_u32 v24, s56, v24
    v_and_b32 v24, 255, v24
    v_lshlrev_b32 v24, 10, v24
    v_lshl_add_u32 v24, v25, 8, v24
    s_bfe_u32 s56, s11, 0x20003
    s_and_b32 s57, s11, 7
    s_lshl_b32 s56, s56, 7
    s_lshl_b32 s57, s57, 2
    s_add_u32 s55, s55, s56
    s_add_u32 s55, s55, s57
    s_and_b32 s57, s6, s9
    s_bfe_i32 s57, s57, 0x10000
    v_mov_b32 v25, 159488
    v_mov_b32 v26, 1
    v_mov_b32 v27, s10
    s_mov_b64 exec, 1
    s_waitcnt vmcnt(0)
    ds_add_rtn_u32 v26, v25, v26
    s_waitcnt lgkmcnt(0)
    v_readfirstlane_b32 s56, v26
    s_and_b32 s56, s56, 3
    s_cmp_lg_u32 s56, 3
    s_cbranch_scc1 pub_3
    s_mov_b32 exec_lo, -1
    s_mov_b32 exec_hi, s57
    buffer_store_dword v27, v24, s[12:15], s55 offen sc1
pub_3:
    s_mov_b64 exec, -1
    s_add_u32 s9, s9, 1
    s_bitcmp1_b32 s9, 0
    s_cbranch_scc1 c_qkvB
    s_branch c_qkvA
c_wo_fin:
    s_barrier
    v_pk_add_f32 v[32:33], v[32:33], v[176:177]
    v_pk_add_f32 v[34:35], v[34:35], v[178:179]
    v_pk_add_f32 v[36:37], v[36:37], v[180:181]
    v_pk_add_f32 v[38:39], v[38:39], v[182:183]
    v_pk_add_f32 v[40:41], v[40:41], v[184:185]
    v_pk_add_f32 v[42:43], v[42:43], v[186:187]
    v_pk_add_f32 v[44:45], v[44:45], v[188:189]
    v_pk_add_f32 v[46:47], v[46:47], v[190:191]
    v_pk_add_f32 v[48:49], v[48:49], v[192:193]
    v_pk_add_f32 v[50:51], v[50:51], v[194:195]
    v_pk_add_f32 v[52:53], v[52:53], v[196:197]
    v_pk_add_f32 v[54:55], v[54:55], v[198:199]
    v_pk_add_f32 v[56:57], v[56:57], v[200:201]
    v_pk_add_f32 v[58:59], v[58:59], v[202:203]
    v_pk_add_f32 v[60:61], v[60:61], v[204:205]
    v_pk_add_f32 v[62:63], v[62:63], v[206:207]
    v_cvt_pk_bf16_f32 v96, v32, v33
    v_cvt_pk_bf16_f32 v97, v34, v35
    v_cvt_pk_bf16_f32 v98, v36, v37
    v_cvt_pk_bf16_f32 v99, v38, v39
    v_cvt_pk_bf16_f32 v100, v40, v41
    v_cvt_pk_bf16_f32 v101, v42, v43
    v_cvt_pk_bf16_f32 v102, v44, v45
    v_cvt_pk_bf16_f32 v103, v46, v47
    v_cvt_pk_bf16_f32 v104, v48, v49
    v_cvt_pk_bf16_f32 v105, v50, v51
    v_cvt_pk_bf16_f32 v106, v52, v53
    v_cvt_pk_bf16_f32 v107, v54, v55
    v_cvt_pk_bf16_f32 v108, v56, v57
    v_cvt_pk_bf16_f32 v109, v58, v59
    v_cvt_pk_bf16_f32 v110, v60, v61
    v_cvt_pk_bf16_f32 v111, v62, v63
    s_mov_b32 s28, s44
    s_mov_b32 s29, s45
    s_mov_b32 s30, 4194304
    s_mov_b32 s31, 0x00020000
    v_and_b32 v16, 31, v1
    v_mul_u32_u24 v16, 144, v16
    v_lshl_add_u32 v16, v3, 3, v16
    v_mul_u32_u24 v17, 4608, v2
    v_add_u32 v16, v16, v17
    ds_write_b64 v16, v[96:97] offset:0
    ds_write_b64 v16, v[98:99] offset:16
    ds_write_b64 v16, v[100:101] offset:32
    ds_write_b64 v16, v[102:103] offset:48
    ds_write_b64 v16, v[104:105] offset:64
    ds_write_b64 v16, v[106:107] offset:80
    ds_write_b64 v16, v[108:109] offset:96
    ds_write_b64 v16, v[110:111] offset:112
    v_lshrrev_b32 v18, 3, v1
    v_and_b32 v19, 7, v1
    v_mul_u32_u24 v20, 144, v18
    v_lshl_add_u32 v20, v19, 4, v20
    v_add_u32 v20, v20, v17
    v_lshlrev_b32 v21, 11, v18
    v_lshl_add_u32 v21, v19, 4, v21
    s_lshl_b32 s3, s48, 16
    s_lshl_b32 s55, s7, 7
    s_add_u32 s3, s3, s55
    s_waitcnt lgkmcnt(0)
    ds_read_b128 v[32:35], v20 offset:0
    ds_read_b128 v[36:39], v20 offset:1152
    ds_read_b128 v[40:43], v20 offset:2304
    ds_read_b128 v[44:47], v20 offset:3456
    s_waitcnt lgkmcnt(3)
    buffer_store_dwordx4 v[32:35], v21, s[28:31], s3 offen sc1
    s_add_u32 s3, s3, 16384
    s_waitcnt lgkmcnt(2)
    buffer_store_dwordx4 v[36:39], v21, s[28:31], s3 offen sc1
    s_add_u32 s3, s3, 16384
    s_waitcnt lgkmcnt(1)
    buffer_store_dwordx4 v[40:43], v21, s[28:31], s3 offen sc1
    s_add_u32 s3, s3, 16384
    s_waitcnt lgkmcnt(0)
    buffer_store_dwordx4 v[44:47], v21, s[28:31], s3 offen sc1
    s_add_u32 s3, s3, 16384
    s_branch k_exit
c_prep:
    s_mov_b32 s28, s32
    s_mov_b32 s29, s33
    s_mov_b32 s30, 4194304
    s_mov_b32 s31, 0x00020000
    s_lshl_b32 s48, s6, 2
    s_add_u32 s48, s48, s8
    v_lshrrev_b32 v16, 3, v1
    v_and_b32 v17, 7, v1
    v_lshlrev_b32 v18, 11, v16
    v_lshl_add_u32 v18, v17, 4, v18
    s_lshl_b32 s55, s48, 16
    s_lshl_b32 s56, s7, 7
    s_add_u32 s3, s55, s56
    buffer_load_dwordx4 v[32:35], v18, s[28:31], s3 offen
    s_add_u32 s3, s3, 16384
    buffer_load_dwordx4 v[36:39], v18, s[28:31], s3 offen
    s_add_u32 s3, s3, 16384
    buffer_load_dwordx4 v[40:43], v18, s[28:31], s3 offen
    s_add_u32 s3, s3, 16384
    buffer_load_dwordx4 v[44:47], v18, s[28:31], s3 offen
    s_add_u32 s3, s3, 16384
    s_barrier
    s_lshl_b32 s56, s7, 12
    s_add_u32 s58, s55, s56
    v_lshlrev_b32 v5, 4, v1
    s_lshl_b32 s3, s8, 12
    s_add_u32 s3, s3, 131072
    v_lshrrev_b32 v18, 1, v17
    v_lshlrev_b32 v18, 10, v18
    v_lshl_add_u32 v18, v16, 4, v18
    v_and_b32 v17, 1, v17
    v_lshl_add_u32 v18, v17, 3, v18
    v_add_u32 v18, s3, v18
    v_add_u32 v19, s3, v5
    s_waitcnt vmcnt(3)
    ds_write_b64 v18, v[32:33] offset:0
    ds_write_b64 v18, v[34:35] offset:512
    s_waitcnt vmcnt(2)
    ds_write_b64 v18, v[36:37] offset:128
    ds_write_b64 v18, v[38:39] offset:640
    s_waitcnt vmcnt(1)
    ds_write_b64 v18, v[40:41] offset:256
    ds_write_b64 v18, v[42:43] offset:768
    s_waitcnt vmcnt(0)
    ds_write_b64 v18, v[44:45] offset:384
    ds_write_b64 v18, v[46:47] offset:896
    s_waitcnt lgkmcnt(0)
    ds_read_b128 v[96:99], v19 offset:0
    ds_read_b128 v[100:103], v19 offset:1024
    ds_read_b128 v[104:107], v19 offset:2048
    ds_read_b128 v[108:111], v19 offset:3072
    s_waitcnt lgkmcnt(3)
    buffer_store_dwordx4 v[96:99], v5, s[12:15], s58 offen offset:0 sc1
    s_waitcnt lgkmcnt(2)
    buffer_store_dwordx4 v[100:103], v5, s[12:15], s58 offen offset:1024 sc1
    s_waitcnt lgkmcnt(1)
    buffer_store_dwordx4 v[104:107], v5, s[12:15], s58 offen offset:2048 sc1
    s_waitcnt lgkmcnt(0)
    buffer_store_dwordx4 v[108:111], v5, s[12:15], s58 offen offset:3072 sc1
    s_branch c_wo_stat
.p2align 6
c_qkvB:
    v_and_b32 v1, 63, v0
    v_lshrrev_b32 v2, 6, v0
    v_lshlrev_b32 v5, 4, v1
    v_lshrrev_b32 v3, 5, v1
    v_and_b32 v4, 15, v0
    v_bfe_u32 v7, v1, 4, 1
    v_lshl_add_u32 v6, v7, 5, v4
    v_lshlrev_b32 v6, 4, v6
    v_lshl_add_u32 v6, v3, 10, v6
    s_lshr_b32 s48, s6, 1
    s_lshl_b32 s48, s48, 2
    s_add_u32 s48, s48, s8
    s_lshl_b32 s55, s48, 17
    s_lshl_b32 s56, s9, 22
    s_add_u32 s55, s55, s56
    s_add_u32 s16, s4, s55
    s_addc_u32 s17, s5, 0
    s_mov_b32 s18, 65536
    s_mov_b32 s19, 0x00020000
    s_add_u32 s56, s55, 65536
    s_add_u32 s20, s4, s56
    s_addc_u32 s21, s5, 0
    s_mov_b32 s22, 65536
    s_mov_b32 s23, 0x00020000
    s_lshl_b32 s49, s7, 12
    s_add_u32 s49, s49, s55
    s_and_b32 s56, s6, 1
    s_lshl_b32 s56, s56, 11
    s_add_u32 s49, s49, s56
    s_add_u32 s49, s49, 16777216
    s_movk_i32 s54, 4096
    v_lshrrev_b32 v16, 2, v4
    v_lshl_add_u32 v18, v7, 2, v16
    v_lshl_add_u32 v18, v3, 4, v18
    v_lshlrev_b32 v18, 6, v18
    v_and_b32 v17, 3, v4
    v_lshl_add_u32 v18, v17, 3, v18
    v_lshl_add_u32 v26, v7, 5, v18
    v_xor_b32 v27, 32, v26
    v_mov_b32 v24, v26
    v_mov_b32 v25, v27
    v_and_b32 v18, 0x30, v1
    v_add_u32 v10, 155648, v18
    v_lshlrev_b32 v11, 2, v4
    v_add_u32 v11, 155648, v11
    v_lshl_add_u32 v8, v2, 8, v11
    v_lshl_add_u32 v9, v2, 8, v10
    s_lshr_b32 s3, s8, 1
    s_and_b32 s55, s8, 1
    s_lshl_b32 s3, s3, 14
    s_lshl_b32 s55, s55, 12
    s_add_u32 s3, s3, s55
    s_add_u32 s3, s3, 81920
    v_lshl_add_u32 v12, v3, 5, v4
    v_lshlrev_b32 v12, 4, v12
    v_lshl_add_u32 v12, v7, 10, v12
    v_add_u32 v12, s3, v12
    v_add_u32 v13, s3, v5
    v_mov_b32 v32, 0
    v_mov_b32 v33, 0
    v_mov_b32 v34, 0
    v_mov_b32 v35, 0
    v_mov_b32 v36, 0
    v_mov_b32 v37, 0
    v_mov_b32 v38, 0
    v_mov_b32 v39, 0
    v_mov_b32 v40, 0
    v_mov_b32 v41, 0
    v_mov_b32 v42, 0
    v_mov_b32 v43, 0
    v_mov_b32 v44, 0
    v_mov_b32 v45, 0
    v_mov_b32 v46, 0
    v_mov_b32 v47, 0
    v_mov_b32 v48, 0
    v_mov_b32 v49, 0
    v_mov_b32 v50, 0
    v_mov_b32 v51, 0
    v_mov_b32 v52, 0
    v_mov_b32 v53, 0
    v_mov_b32 v54, 0
    v_mov_b32 v55, 0
    v_mov_b32 v56, 0
    v_mov_b32 v57, 0
    v_mov_b32 v58, 0
    v_mov_b32 v59, 0
    v_mov_b32 v60, 0
    v_mov_b32 v61, 0
    v_mov_b32 v62, 0
    v_mov_b32 v63, 0
    v_mov_b32 v64, 0
    v_mov_b32 v65, 0
    v_mov_b32 v66, 0
    v_mov_b32 v67, 0
    v_mov_b32 v68, 0
    v_mov_b32 v69, 0
    v_mov_b32 v70, 0
    v_mov_b32 v71, 0
    v_mov_b32 v72, 0
    v_mov_b32 v73, 0
    v_mov_b32 v74, 0
    v_mov_b32 v75, 0
    v_mov_b32 v76, 0
    v_mov_b32 v77, 0
    v_mov_b32 v78, 0
    v_mov_b32 v79, 0
    v_mov_b32 v80, 0
    v_mov_b32 v81, 0
    v_mov_b32 v82, 0
    v_mov_b32 v83, 0
    v_mov_b32 v84, 0
    v_mov_b32 v85, 0
    v_mov_b32 v86, 0
    v_mov_b32 v87, 0
    v_mov_b32 v88, 0
    v_mov_b32 v89, 0
    v_mov_b32 v90, 0
    v_mov_b32 v91, 0
    v_mov_b32 v92, 0
    v_mov_b32 v93, 0
    v_mov_b32 v94, 0
    v_mov_b32 v95, 0
    v_mov_b32 v96, 0
    v_mov_b32 v97, 0
    v_mov_b32 v98, 0
    v_mov_b32 v99, 0
    v_mov_b32 v100, 0
    v_mov_b32 v101, 0
    v_mov_b32 v102, 0
    v_mov_b32 v103, 0
    v_mov_b32 v104, 0
    v_mov_b32 v105, 0
    v_mov_b32 v106, 0
    v_mov_b32 v107, 0
    v_mov_b32 v108, 0
    v_mov_b32 v109, 0
    v_mov_b32 v110, 0
    v_mov_b32 v111, 0
    v_mov_b32 v112, 0
    v_mov_b32 v113, 0
    v_mov_b32 v114, 0
    v_mov_b32 v115, 0
    v_mov_b32 v116, 0
    v_mov_b32 v117, 0
    v_mov_b32 v118, 0
    v_mov_b32 v119, 0
    v_mov_b32 v120, 0
    v_mov_b32 v121, 0
    v_mov_b32 v122, 0
    v_mov_b32 v123, 0
    v_mov_b32 v124, 0
    v_mov_b32 v125, 0
    v_mov_b32 v126, 0
    v_mov_b32 v127, 0
    s_mov_b32 s50, 6144
    s_mov_b32 s51, 10240
    s_mov_b32 s52, 0
    s_barrier
    buffer_load_dwordx4 a[0:3], v6, s[16:19], 0 offen offset:0 sc1
    buffer_load_dwordx4 a[4:7], v6, s[16:19], 0 offen offset:256 sc1
    buffer_load_dwordx4 a[8:11], v6, s[20:23], 0 offen offset:0 sc1
    buffer_load_dwordx4 a[12:15], v6, s[20:23], 0 offen offset:256 sc1
    ds_read_b64_tr_b16 v[128:129], v24 offset:0
    ds_read_b64_tr_b16 v[130:131], v24 offset:512
    ds_read_b64_tr_b16 v[132:133], v25 offset:0
    ds_read_b64_tr_b16 v[134:135], v25 offset:512
    ds_read_b64_tr_b16 v[136:137], v24 offset:8192
    ds_read_b64_tr_b16 v[138:139], v24 offset:8704
    ds_read_b64_tr_b16 v[140:141], v25 offset:8192
    ds_read_b64_tr_b16 v[142:143], v25 offset:8704
    ds_read_b64_tr_b16 v[144:145], v24 offset:16384
    ds_read_b64_tr_b16 v[146:147], v24 offset:16896
    buffer_load_dwordx4 a[16:19], v6, s[16:19], 0 offen offset:2048 sc1
    buffer_load_dwordx4 a[20:23], v6, s[16:19], 0 offen offset:2304 sc1
    buffer_load_dwordx4 a[24:27], v6, s[20:23], 0 offen offset:2048 sc1
    buffer_load_dwordx4 a[28:31], v6, s[20:23], 0 offen offset:2304 sc1
    buffer_load_dwordx4 v[152:155], v6, s[16:19], s54 offen offset:0 sc1
    buffer_load_dwordx4 v[156:159], v6, s[16:19], s54 offen offset:256 sc1
    buffer_load_dwordx4 v[160:163], v6, s[20:23], s54 offen offset:0 sc1
    buffer_load_dwordx4 v[164:167], v6, s[20:23], s54 offen offset:256 sc1
    s_mov_b32 s54, 8
    s_waitcnt vmcnt(8)
    s_barrier
.p2align 3
c_qkvB_loop:
    s_waitcnt vmcnt(8) lgkmcnt(8)
    v_mfma_f32_16x16x32_bf16 v[32:35], v[128:131], a[0:3], v[32:35]
    ds_read_b64_tr_b16 v[148:149], v25 offset:16384
    v_mfma_f32_16x16x32_bf16 v[36:39], v[128:131], a[4:7], v[36:39]
    ds_read_b64_tr_b16 v[150:151], v25 offset:16896
    v_mfma_f32_16x16x32_bf16 v[40:43], v[128:131], a[8:11], v[40:43]
    v_mfma_f32_16x16x32_bf16 v[44:47], v[128:131], a[12:15], v[44:47]
    s_waitcnt lgkmcnt(8)
    v_mfma_f32_16x16x32_bf16 v[48:51], v[132:135], a[0:3], v[48:51]
    ds_read_b64_tr_b16 v[128:129], v24 offset:2048
    v_mfma_f32_16x16x32_bf16 v[52:55], v[132:135], a[4:7], v[52:55]
    ds_read_b64_tr_b16 v[130:131], v24 offset:2560
    v_mfma_f32_16x16x32_bf16 v[56:59], v[132:135], a[8:11], v[56:59]
    buffer_load_dwordx4 v[168:171], v6, s[16:19], s50 offen offset:0 sc1
    v_mfma_f32_16x16x32_bf16 v[60:63], v[132:135], a[12:15], v[60:63]
    s_waitcnt lgkmcnt(8)
    v_mfma_f32_16x16x32_bf16 v[64:67], v[136:139], a[0:3], v[64:67]
    ds_read_b64_tr_b16 v[132:133], v25 offset:2048
    v_mfma_f32_16x16x32_bf16 v[68:71], v[136:139], a[4:7], v[68:71]
    ds_read_b64_tr_b16 v[134:135], v25 offset:2560
    v_mfma_f32_16x16x32_bf16 v[72:75], v[136:139], a[8:11], v[72:75]
    buffer_load_dwordx4 v[172:175], v6, s[16:19], s50 offen offset:256 sc1
    v_mfma_f32_16x16x32_bf16 v[76:79], v[136:139], a[12:15], v[76:79]
    s_waitcnt lgkmcnt(8)
    v_mfma_f32_16x16x32_bf16 v[80:83], v[140:143], a[0:3], v[80:83]
    ds_read_b64_tr_b16 v[136:137], v24 offset:10240
    v_mfma_f32_16x16x32_bf16 v[84:87], v[140:143], a[4:7], v[84:87]
    ds_read_b64_tr_b16 v[138:139], v24 offset:10752
    v_mfma_f32_16x16x32_bf16 v[88:91], v[140:143], a[8:11], v[88:91]
    buffer_load_dwordx4 v[176:179], v6, s[20:23], s50 offen offset:0 sc1
    v_mfma_f32_16x16x32_bf16 v[92:95], v[140:143], a[12:15], v[92:95]
    s_waitcnt lgkmcnt(8)
    v_mfma_f32_16x16x32_bf16 v[96:99], a[0:3], v[144:147], v[96:99]
    ds_read_b64_tr_b16 v[140:141], v25 offset:10240
    v_mfma_f32_16x16x32_bf16 v[100:103], a[4:7], v[144:147], v[100:103]
    ds_read_b64_tr_b16 v[142:143], v25 offset:10752
    v_mfma_f32_16x16x32_bf16 v[104:107], a[8:11], v[144:147], v[104:107]
    buffer_load_dwordx4 v[180:183], v6, s[20:23], s50 offen offset:256 sc1
    v_mfma_f32_16x16x32_bf16 v[108:111], a[12:15], v[144:147], v[108:111]
    s_waitcnt lgkmcnt(8)
    v_mfma_f32_16x16x32_bf16 v[112:115], a[0:3], v[148:151], v[112:115]
    ds_read_b64_tr_b16 v[144:145], v24 offset:18432
    v_mfma_f32_16x16x32_bf16 v[116:119], a[4:7], v[148:151], v[116:119]
    ds_read_b64_tr_b16 v[146:147], v24 offset:18944
    v_mfma_f32_16x16x32_bf16 v[120:123], a[8:11], v[148:151], v[120:123]
    v_mfma_f32_16x16x32_bf16 v[124:127], a[12:15], v[148:151], v[124:127]
    s_waitcnt vmcnt(8) lgkmcnt(8)
    v_mfma_f32_16x16x32_bf16 v[32:35], v[128:131], a[16:19], v[32:35]
    ds_read_b64_tr_b16 v[148:149], v25 offset:18432
    v_mfma_f32_16x16x32_bf16 v[36:39], v[128:131], a[20:23], v[36:39]
    ds_read_b64_tr_b16 v[150:151], v25 offset:18944
    v_mfma_f32_16x16x32_bf16 v[40:43], v[128:131], a[24:27], v[40:43]
    v_mfma_f32_16x16x32_bf16 v[44:47], v[128:131], a[28:31], v[44:47]
    s_waitcnt lgkmcnt(8)
    v_mfma_f32_16x16x32_bf16 v[48:51], v[132:135], a[16:19], v[48:51]
    ds_read_b64_tr_b16 v[128:129], v24 offset:4096
    v_mfma_f32_16x16x32_bf16 v[52:55], v[132:135], a[20:23], v[52:55]
    ds_read_b64_tr_b16 v[130:131], v24 offset:4608
    v_mfma_f32_16x16x32_bf16 v[56:59], v[132:135], a[24:27], v[56:59]
    buffer_load_dwordx4 a[0:3], v6, s[16:19], s50 offen offset:2048 sc1
    v_mfma_f32_16x16x32_bf16 v[60:63], v[132:135], a[28:31], v[60:63]
    s_waitcnt lgkmcnt(8)
    v_mfma_f32_16x16x32_bf16 v[64:67], v[136:139], a[16:19], v[64:67]
    ds_read_b64_tr_b16 v[132:133], v25 offset:4096
    v_mfma_f32_16x16x32_bf16 v[68:71], v[136:139], a[20:23], v[68:71]
    ds_read_b64_tr_b16 v[134:135], v25 offset:4608
    v_mfma_f32_16x16x32_bf16 v[72:75], v[136:139], a[24:27], v[72:75]
    buffer_load_dwordx4 a[4:7], v6, s[16:19], s50 offen offset:2304 sc1
    v_mfma_f32_16x16x32_bf16 v[76:79], v[136:139], a[28:31], v[76:79]
    s_waitcnt lgkmcnt(8)
    v_mfma_f32_16x16x32_bf16 v[80:83], v[140:143], a[16:19], v[80:83]
    ds_read_b64_tr_b16 v[136:137], v24 offset:12288
    v_mfma_f32_16x16x32_bf16 v[84:87], v[140:143], a[20:23], v[84:87]
    ds_read_b64_tr_b16 v[138:139], v24 offset:12800
    v_mfma_f32_16x16x32_bf16 v[88:91], v[140:143], a[24:27], v[88:91]
    buffer_load_dwordx4 a[8:11], v6, s[20:23], s50 offen offset:2048 sc1
    v_mfma_f32_16x16x32_bf16 v[92:95], v[140:143], a[28:31], v[92:95]
    s_waitcnt lgkmcnt(8)
    v_mfma_f32_16x16x32_bf16 v[96:99], a[16:19], v[144:147], v[96:99]
    ds_read_b64_tr_b16 v[140:141], v25 offset:12288
    v_mfma_f32_16x16x32_bf16 v[100:103], a[20:23], v[144:147], v[100:103]
    ds_read_b64_tr_b16 v[142:143], v25 offset:12800
    v_mfma_f32_16x16x32_bf16 v[104:107], a[24:27], v[144:147], v[104:107]
    buffer_load_dwordx4 a[12:15], v6, s[20:23], s50 offen offset:2304 sc1
    v_mfma_f32_16x16x32_bf16 v[108:111], a[28:31], v[144:147], v[108:111]
    s_waitcnt lgkmcnt(8)
    v_mfma_f32_16x16x32_bf16 v[112:115], a[16:19], v[148:151], v[112:115]
    ds_read_b64_tr_b16 v[144:145], v24 offset:20480
    v_mfma_f32_16x16x32_bf16 v[116:119], a[20:23], v[148:151], v[116:119]
    ds_read_b64_tr_b16 v[146:147], v24 offset:20992
    v_mfma_f32_16x16x32_bf16 v[120:123], a[24:27], v[148:151], v[120:123]
    v_mfma_f32_16x16x32_bf16 v[124:127], a[28:31], v[148:151], v[124:127]
    s_waitcnt vmcnt(8) lgkmcnt(8)
    v_mfma_f32_16x16x32_bf16 v[32:35], v[128:131], v[152:155], v[32:35]
    ds_read_b64_tr_b16 v[148:149], v25 offset:20480
    v_mfma_f32_16x16x32_bf16 v[36:39], v[128:131], v[156:159], v[36:39]
    ds_read_b64_tr_b16 v[150:151], v25 offset:20992
    v_mfma_f32_16x16x32_bf16 v[40:43], v[128:131], v[160:163], v[40:43]
    v_mfma_f32_16x16x32_bf16 v[44:47], v[128:131], v[164:167], v[44:47]
    s_waitcnt lgkmcnt(8)
    v_mfma_f32_16x16x32_bf16 v[48:51], v[132:135], v[152:155], v[48:51]
    ds_read_b64_tr_b16 v[128:129], v24 offset:6144
    v_mfma_f32_16x16x32_bf16 v[52:55], v[132:135], v[156:159], v[52:55]
    ds_read_b64_tr_b16 v[130:131], v24 offset:6656
    v_mfma_f32_16x16x32_bf16 v[56:59], v[132:135], v[160:163], v[56:59]
    buffer_load_dwordx4 a[16:19], v6, s[16:19], s51 offen offset:0 sc1
    v_mfma_f32_16x16x32_bf16 v[60:63], v[132:135], v[164:167], v[60:63]
    s_waitcnt lgkmcnt(8)
    v_mfma_f32_16x16x32_bf16 v[64:67], v[136:139], v[152:155], v[64:67]
    ds_read_b64_tr_b16 v[132:133], v25 offset:6144
    v_mfma_f32_16x16x32_bf16 v[68:71], v[136:139], v[156:159], v[68:71]
    ds_read_b64_tr_b16 v[134:135], v25 offset:6656
    v_mfma_f32_16x16x32_bf16 v[72:75], v[136:139], v[160:163], v[72:75]
    buffer_load_dwordx4 a[20:23], v6, s[16:19], s51 offen offset:256 sc1
    v_mfma_f32_16x16x32_bf16 v[76:79], v[136:139], v[164:167], v[76:79]
    s_waitcnt lgkmcnt(8)
    v_mfma_f32_16x16x32_bf16 v[80:83], v[140:143], v[152:155], v[80:83]
    ds_read_b64_tr_b16 v[136:137], v24 offset:14336
    v_mfma_f32_16x16x32_bf16 v[84:87], v[140:143], v[156:159], v[84:87]
    ds_read_b64_tr_b16 v[138:139], v24 offset:14848
    v_mfma_f32_16x16x32_bf16 v[88:91], v[140:143], v[160:163], v[88:91]
    buffer_load_dwordx4 a[24:27], v6, s[20:23], s51 offen offset:0 sc1
    v_mfma_f32_16x16x32_bf16 v[92:95], v[140:143], v[164:167], v[92:95]
    s_waitcnt lgkmcnt(8)
    v_mfma_f32_16x16x32_bf16 v[96:99], v[152:155], v[144:147], v[96:99]
    ds_read_b64_tr_b16 v[140:141], v25 offset:14336
    v_mfma_f32_16x16x32_bf16 v[100:103], v[156:159], v[144:147], v[100:103]
    ds_read_b64_tr_b16 v[142:143], v25 offset:14848
    v_mfma_f32_16x16x32_bf16 v[104:107], v[160:163], v[144:147], v[104:107]
    buffer_load_dwordx4 a[28:31], v6, s[20:23], s51 offen offset:256 sc1
    v_mfma_f32_16x16x32_bf16 v[108:111], v[164:167], v[144:147], v[108:111]
    s_waitcnt lgkmcnt(8)
    v_mfma_f32_16x16x32_bf16 v[112:115], v[152:155], v[148:151], v[112:115]
    ds_read_b64_tr_b16 v[144:145], v24 offset:22528
    v_mfma_f32_16x16x32_bf16 v[116:119], v[156:159], v[148:151], v[116:119]
    ds_read_b64_tr_b16 v[146:147], v24 offset:23040
    v_mfma_f32_16x16x32_bf16 v[120:123], v[160:163], v[148:151], v[120:123]
    v_mfma_f32_16x16x32_bf16 v[124:127], v[164:167], v[148:151], v[124:127]
    s_waitcnt vmcnt(8) lgkmcnt(8)
    v_mfma_f32_16x16x32_bf16 v[32:35], v[128:131], v[168:171], v[32:35]
    ds_read_b64_tr_b16 v[148:149], v25 offset:22528
    v_mfma_f32_16x16x32_bf16 v[36:39], v[128:131], v[172:175], v[36:39]
    ds_read_b64_tr_b16 v[150:151], v25 offset:23040
    s_add_u32 s52, s52, 24576
    s_cmp_eq_u32 s52, 147456
    v_mfma_f32_16x16x32_bf16 v[40:43], v[128:131], v[176:179], v[40:43]
    s_cselect_b32 s52, 0, s52
    s_barrier
    v_mfma_f32_16x16x32_bf16 v[44:47], v[128:131], v[180:183], v[44:47]
    v_add_u32 v24, s52, v26
    v_add_u32 v25, s52, v27
    s_waitcnt lgkmcnt(8)
    v_mfma_f32_16x16x32_bf16 v[48:51], v[132:135], v[168:171], v[48:51]
    ds_read_b64_tr_b16 v[128:129], v24 offset:0
    v_mfma_f32_16x16x32_bf16 v[52:55], v[132:135], v[172:175], v[52:55]
    ds_read_b64_tr_b16 v[130:131], v24 offset:512
    v_mfma_f32_16x16x32_bf16 v[56:59], v[132:135], v[176:179], v[56:59]
    buffer_load_dwordx4 v[152:155], v6, s[16:19], s51 offen offset:2048 sc1
    v_mfma_f32_16x16x32_bf16 v[60:63], v[132:135], v[180:183], v[60:63]
    s_waitcnt lgkmcnt(8)
    v_mfma_f32_16x16x32_bf16 v[64:67], v[136:139], v[168:171], v[64:67]
    ds_read_b64_tr_b16 v[132:133], v25 offset:0
    v_mfma_f32_16x16x32_bf16 v[68:71], v[136:139], v[172:175], v[68:71]
    ds_read_b64_tr_b16 v[134:135], v25 offset:512
    v_mfma_f32_16x16x32_bf16 v[72:75], v[136:139], v[176:179], v[72:75]
    buffer_load_dwordx4 v[156:159], v6, s[16:19], s51 offen offset:2304 sc1
    v_mfma_f32_16x16x32_bf16 v[76:79], v[136:139], v[180:183], v[76:79]
    s_waitcnt lgkmcnt(8)
    v_mfma_f32_16x16x32_bf16 v[80:83], v[140:143], v[168:171], v[80:83]
    ds_read_b64_tr_b16 v[136:137], v24 offset:8192
    v_mfma_f32_16x16x32_bf16 v[84:87], v[140:143], v[172:175], v[84:87]
    ds_read_b64_tr_b16 v[138:139], v24 offset:8704
    v_mfma_f32_16x16x32_bf16 v[88:91], v[140:143], v[176:179], v[88:91]
    buffer_load_dwordx4 v[160:163], v6, s[20:23], s51 offen offset:2048 sc1
    v_mfma_f32_16x16x32_bf16 v[92:95], v[140:143], v[180:183], v[92:95]
    s_waitcnt lgkmcnt(8)
    v_mfma_f32_16x16x32_bf16 v[96:99], v[168:171], v[144:147], v[96:99]
    ds_read_b64_tr_b16 v[140:141], v25 offset:8192
    v_mfma_f32_16x16x32_bf16 v[100:103], v[172:175], v[144:147], v[100:103]
    ds_read_b64_tr_b16 v[142:143], v25 offset:8704
    v_mfma_f32_16x16x32_bf16 v[104:107], v[176:179], v[144:147], v[104:107]
    buffer_load_dwordx4 v[164:167], v6, s[20:23], s51 offen offset:2304 sc1
    v_mfma_f32_16x16x32_bf16 v[108:111], v[180:183], v[144:147], v[108:111]
    s_waitcnt lgkmcnt(8)
    v_mfma_f32_16x16x32_bf16 v[112:115], v[168:171], v[148:151], v[112:115]
    ds_read_b64_tr_b16 v[144:145], v24 offset:16384
    s_add_u32 s50, s50, 8192
    v_mfma_f32_16x16x32_bf16 v[116:119], v[172:175], v[148:151], v[116:119]
    ds_read_b64_tr_b16 v[146:147], v24 offset:16896
    s_add_u32 s51, s51, 8192
    v_mfma_f32_16x16x32_bf16 v[120:123], v[176:179], v[148:151], v[120:123]
    s_sub_u32 s54, s54, 1
    v_mfma_f32_16x16x32_bf16 v[124:127], v[180:183], v[148:151], v[124:127]
    s_cmp_lg_u32 s54, 0
    s_cbranch_scc1 c_qkvB_loop
    ds_read_b32 v184, v8 offset:1280
    ds_read_b32 v185, v8 offset:2816
    ds_read_b32 v186, v8 offset:1344
    ds_read_b32 v187, v8 offset:2880
    ds_read_b32 v188, v8 offset:1408
    ds_read_b32 v189, v8 offset:2944
    ds_read_b32 v190, v8 offset:1472
    ds_read_b32 v191, v8 offset:3008
    ds_read_b128 v[212:215], v10 offset:512
    ds_read_b128 v[216:219], v10 offset:576
    ds_read2_b32 v[220:221], v11 offset0:160 offset1:176
    s_waitcnt vmcnt(0) lgkmcnt(11)
    ds_read_b128 v[128:131], v9 offset:1280
    ds_read_b128 v[144:147], v9 offset:2816
    ds_read_b128 v[132:135], v9 offset:1344
    ds_read_b128 v[148:151], v9 offset:2880
    ds_read_b128 v[136:139], v9 offset:1408
    ds_read_b128 v[152:155], v9 offset:2944
    ds_read_b128 v[140:143], v9 offset:1472
    ds_read_b128 v[156:159], v9 offset:3008
    s_waitcnt lgkmcnt(9)
    ds_read_b128 v[192:195], v10 offset:384
    ds_read_b128 v[196:199], v10 offset:448
    v_pk_fma_f32 v[64:65], v[184:185], v[212:213], v[64:65] op_sel_hi:[0,1,1] neg_lo:[1,0,0] neg_hi:[1,0,0]
    v_pk_fma_f32 v[66:67], v[184:185], v[214:215], v[66:67] op_sel_hi:[0,1,1] neg_lo:[1,0,0] neg_hi:[1,0,0]
    v_pk_fma_f32 v[80:81], v[184:185], v[216:217], v[80:81] op_sel_hi:[0,1,1] neg_lo:[1,0,0] neg_hi:[1,0,0]
    v_pk_fma_f32 v[82:83], v[184:185], v[218:219], v[82:83] op_sel_hi:[0,1,1] neg_lo:[1,0,0] neg_hi:[1,0,0]
    v_pk_mul_f32 v[64:65], v[184:185], v[64:65] op_sel:[1,0] op_sel_hi:[1,1]
    v_pk_mul_f32 v[66:67], v[184:185], v[66:67] op_sel:[1,0] op_sel_hi:[1,1]
    v_pk_mul_f32 v[80:81], v[184:185], v[80:81] op_sel:[1,0] op_sel_hi:[1,1]
    v_pk_mul_f32 v[82:83], v[184:185], v[82:83] op_sel:[1,0] op_sel_hi:[1,1]
    v_cvt_pk_bf16_f32 v64, v64, v65
    v_cvt_pk_bf16_f32 v65, v66, v67
    v_cvt_pk_bf16_f32 v66, v80, v81
    v_cvt_pk_bf16_f32 v67, v82, v83
    ds_write_b128 v12, v[64:67] offset:0
    v_pk_fma_f32 v[68:69], v[186:187], v[212:213], v[68:69] op_sel_hi:[0,1,1] neg_lo:[1,0,0] neg_hi:[1,0,0]
    v_pk_fma_f32 v[70:71], v[186:187], v[214:215], v[70:71] op_sel_hi:[0,1,1] neg_lo:[1,0,0] neg_hi:[1,0,0]
    v_pk_fma_f32 v[84:85], v[186:187], v[216:217], v[84:85] op_sel_hi:[0,1,1] neg_lo:[1,0,0] neg_hi:[1,0,0]
    v_pk_fma_f32 v[86:87], v[186:187], v[218:219], v[86:87] op_sel_hi:[0,1,1] neg_lo:[1,0,0] neg_hi:[1,0,0]
    v_pk_mul_f32 v[68:69], v[186:187], v[68:69] op_sel:[1,0] op_sel_hi:[1,1]
    v_pk_mul_f32 v[70:71], v[186:187], v[70:71] op_sel:[1,0] op_sel_hi:[1,1]
    v_pk_mul_f32 v[84:85], v[186:187], v[84:85] op_sel:[1,0] op_sel_hi:[1,1]
    v_pk_mul_f32 v[86:87], v[186:187], v[86:87] op_sel:[1,0] op_sel_hi:[1,1]
    v_cvt_pk_bf16_f32 v68, v68, v69
    v_cvt_pk_bf16_f32 v69, v70, v71
    v_cvt_pk_bf16_f32 v70, v84, v85
    v_cvt_pk_bf16_f32 v71, v86, v87
    ds_write_b128 v12, v[68:71] offset:256
    v_pk_fma_f32 v[72:73], v[188:189], v[212:213], v[72:73] op_sel_hi:[0,1,1] neg_lo:[1,0,0] neg_hi:[1,0,0]
    v_pk_fma_f32 v[74:75], v[188:189], v[214:215], v[74:75] op_sel_hi:[0,1,1] neg_lo:[1,0,0] neg_hi:[1,0,0]
    v_pk_fma_f32 v[88:89], v[188:189], v[216:217], v[88:89] op_sel_hi:[0,1,1] neg_lo:[1,0,0] neg_hi:[1,0,0]
    v_pk_fma_f32 v[90:91], v[188:189], v[218:219], v[90:91] op_sel_hi:[0,1,1] neg_lo:[1,0,0] neg_hi:[1,0,0]
    v_pk_mul_f32 v[72:73], v[188:189], v[72:73] op_sel:[1,0] op_sel_hi:[1,1]
    v_pk_mul_f32 v[74:75], v[188:189], v[74:75] op_sel:[1,0] op_sel_hi:[1,1]
    v_pk_mul_f32 v[88:89], v[188:189], v[88:89] op_sel:[1,0] op_sel_hi:[1,1]
    v_pk_mul_f32 v[90:91], v[188:189], v[90:91] op_sel:[1,0] op_sel_hi:[1,1]
    v_cvt_pk_bf16_f32 v72, v72, v73
    v_cvt_pk_bf16_f32 v73, v74, v75
    v_cvt_pk_bf16_f32 v74, v88, v89
    v_cvt_pk_bf16_f32 v75, v90, v91
    ds_write_b128 v12, v[72:75] offset:2048
    v_pk_fma_f32 v[76:77], v[190:191], v[212:213], v[76:77] op_sel_hi:[0,1,1] neg_lo:[1,0,0] neg_hi:[1,0,0]
    v_pk_fma_f32 v[78:79], v[190:191], v[214:215], v[78:79] op_sel_hi:[0,1,1] neg_lo:[1,0,0] neg_hi:[1,0,0]
    v_pk_fma_f32 v[92:93], v[190:191], v[216:217], v[92:93] op_sel_hi:[0,1,1] neg_lo:[1,0,0] neg_hi:[1,0,0]
    v_pk_fma_f32 v[94:95], v[190:191], v[218:219], v[94:95] op_sel_hi:[0,1,1] neg_lo:[1,0,0] neg_hi:[1,0,0]
    v_pk_mul_f32 v[76:77], v[190:191], v[76:77] op_sel:[1,0] op_sel_hi:[1,1]
    v_pk_mul_f32 v[78:79], v[190:191], v[78:79] op_sel:[1,0] op_sel_hi:[1,1]
    v_pk_mul_f32 v[92:93], v[190:191], v[92:93] op_sel:[1,0] op_sel_hi:[1,1]
    v_pk_mul_f32 v[94:95], v[190:191], v[94:95] op_sel:[1,0] op_sel_hi:[1,1]
    v_cvt_pk_bf16_f32 v76, v76, v77
    v_cvt_pk_bf16_f32 v77, v78, v79
    v_cvt_pk_bf16_f32 v78, v92, v93
    v_cvt_pk_bf16_f32 v79, v94, v95
    ds_write_b128 v12, v[76:79] offset:2304
    s_waitcnt lgkmcnt(4)
    v_pk_fma_f32 v[96:97], v[128:129], v[220:221], v[96:97] op_sel:[0,0,0] op_sel_hi:[1,0,1] neg_lo:[1,0,0] neg_hi:[1,0,0]
    v_pk_fma_f32 v[98:99], v[130:131], v[220:221], v[98:99] op_sel:[0,0,0] op_sel_hi:[1,0,1] neg_lo:[1,0,0] neg_hi:[1,0,0]
    v_pk_mul_f32 v[96:97], v[144:145], v[96:97]
    v_pk_mul_f32 v[98:99], v[146:147], v[98:99]
    v_pk_fma_f32 v[112:113], v[128:129], v[220:221], v[112:113] op_sel:[0,1,0] op_sel_hi:[1,1,1] neg_lo:[1,0,0] neg_hi:[1,0,0]
    v_pk_fma_f32 v[114:115], v[130:131], v[220:221], v[114:115] op_sel:[0,1,0] op_sel_hi:[1,1,1] neg_lo:[1,0,0] neg_hi:[1,0,0]
    v_pk_mul_f32 v[112:113], v[144:145], v[112:113]
    v_pk_mul_f32 v[114:115], v[146:147], v[114:115]
    v_cvt_pk_bf16_f32 v96, v96, v97
    v_cvt_pk_bf16_f32 v97, v98, v99
    v_cvt_pk_bf16_f32 v98, v112, v113
    v_cvt_pk_bf16_f32 v99, v114, v115
    v_mul_f32 v185, 0x3e8293ee, v185
    v_permlane16_swap_b32 v96, v98
    v_permlane16_swap_b32 v97, v99
    ds_write_b128 v13, v[96:99] offset:8192
    v_pk_fma_f32 v[100:101], v[132:133], v[220:221], v[100:101] op_sel:[0,0,0] op_sel_hi:[1,0,1] neg_lo:[1,0,0] neg_hi:[1,0,0]
    v_pk_fma_f32 v[102:103], v[134:135], v[220:221], v[102:103] op_sel:[0,0,0] op_sel_hi:[1,0,1] neg_lo:[1,0,0] neg_hi:[1,0,0]
    v_pk_mul_f32 v[100:101], v[148:149], v[100:101]
    v_pk_mul_f32 v[102:103], v[150:151], v[102:103]
    v_pk_fma_f32 v[116:117], v[132:133], v[220:221], v[116:117] op_sel:[0,1,0] op_sel_hi:[1,1,1] neg_lo:[1,0,0] neg_hi:[1,0,0]
    v_pk_fma_f32 v[118:119], v[134:135], v[220:221], v[118:119] op_sel:[0,1,0] op_sel_hi:[1,1,1] neg_lo:[1,0,0] neg_hi:[1,0,0]
    v_pk_mul_f32 v[116:117], v[148:149], v[116:117]
    v_pk_mul_f32 v[118:119], v[150:151], v[118:119]
    v_cvt_pk_bf16_f32 v100, v100, v101
    v_cvt_pk_bf16_f32 v101, v102, v103
    v_cvt_pk_bf16_f32 v102, v116, v117
    v_cvt_pk_bf16_f32 v103, v118, v119
    v_mul_f32 v187, 0x3e8293ee, v187
    v_permlane16_swap_b32 v100, v102
    v_permlane16_swap_b32 v101, v103
    ds_write_b128 v13, v[100:103] offset:9216
    v_pk_fma_f32 v[104:105], v[136:137], v[220:221], v[104:105] op_sel:[0,0,0] op_sel_hi:[1,0,1] neg_lo:[1,0,0] neg_hi:[1,0,0]
    v_pk_fma_f32 v[106:107], v[138:139], v[220:221], v[106:107] op_sel:[0,0,0] op_sel_hi:[1,0,1] neg_lo:[1,0,0] neg_hi:[1,0,0]
    v_pk_mul_f32 v[104:105], v[152:153], v[104:105]
    v_pk_mul_f32 v[106:107], v[154:155], v[106:107]
    v_pk_fma_f32 v[120:121], v[136:137], v[220:221], v[120:121] op_sel:[0,1,0] op_sel_hi:[1,1,1] neg_lo:[1,0,0] neg_hi:[1,0,0]
    v_pk_fma_f32 v[122:123], v[138:139], v[220:221], v[122:123] op_sel:[0,1,0] op_sel_hi:[1,1,1] neg_lo:[1,0,0] neg_hi:[1,0,0]
    v_pk_mul_f32 v[120:121], v[152:153], v[120:121]
    v_pk_mul_f32 v[122:123], v[154:155], v[122:123]
    v_cvt_pk_bf16_f32 v104, v104, v105
    v_cvt_pk_bf16_f32 v105, v106, v107
    v_cvt_pk_bf16_f32 v106, v120, v121
    v_cvt_pk_bf16_f32 v107, v122, v123
    v_mul_f32 v189, 0x3e8293ee, v189
    v_permlane16_swap_b32 v104, v106
    v_permlane16_swap_b32 v105, v107
    ds_write_b128 v13, v[104:107] offset:10240
    v_pk_fma_f32 v[108:109], v[140:141], v[220:221], v[108:109] op_sel:[0,0,0] op_sel_hi:[1,0,1] neg_lo:[1,0,0] neg_hi:[1,0,0]
    v_pk_fma_f32 v[110:111], v[142:143], v[220:221], v[110:111] op_sel:[0,0,0] op_sel_hi:[1,0,1] neg_lo:[1,0,0] neg_hi:[1,0,0]
    v_pk_mul_f32 v[108:109], v[156:157], v[108:109]
    v_pk_mul_f32 v[110:111], v[158:159], v[110:111]
    v_pk_fma_f32 v[124:125], v[140:141], v[220:221], v[124:125] op_sel:[0,1,0] op_sel_hi:[1,1,1] neg_lo:[1,0,0] neg_hi:[1,0,0]
    v_pk_fma_f32 v[126:127], v[142:143], v[220:221], v[126:127] op_sel:[0,1,0] op_sel_hi:[1,1,1] neg_lo:[1,0,0] neg_hi:[1,0,0]
    v_pk_mul_f32 v[124:125], v[156:157], v[124:125]
    v_pk_mul_f32 v[126:127], v[158:159], v[126:127]
    v_cvt_pk_bf16_f32 v108, v108, v109
    v_cvt_pk_bf16_f32 v109, v110, v111
    v_cvt_pk_bf16_f32 v110, v124, v125
    v_cvt_pk_bf16_f32 v111, v126, v127
    v_mul_f32 v191, 0x3e8293ee, v191
    v_permlane16_swap_b32 v108, v110
    v_permlane16_swap_b32 v109, v111
    ds_write_b128 v13, v[108:111] offset:11264
    v_add_u32 v24, 81920, v5
    v_pk_fma_f32 v[32:33], v[184:185], v[192:193], v[32:33] op_sel_hi:[0,1,1] neg_lo:[1,0,0] neg_hi:[1,0,0]
    v_pk_fma_f32 v[34:35], v[184:185], v[194:195], v[34:35] op_sel_hi:[0,1,1] neg_lo:[1,0,0] neg_hi:[1,0,0]
    v_pk_fma_f32 v[48:49], v[184:185], v[196:197], v[48:49] op_sel_hi:[0,1,1] neg_lo:[1,0,0] neg_hi:[1,0,0]
    v_pk_fma_f32 v[50:51], v[184:185], v[198:199], v[50:51] op_sel_hi:[0,1,1] neg_lo:[1,0,0] neg_hi:[1,0,0]
    s_waitcnt lgkmcnt(0)
    s_barrier
    ds_read_b128 v[128:131], v24 offset:0
    ds_read_b128 v[132:135], v24 offset:1024
    ds_read_b128 v[136:139], v24 offset:2048
    ds_read_b128 v[140:143], v24 offset:3072
    v_pk_mul_f32 v[32:33], v[184:185], v[32:33] op_sel:[1,0] op_sel_hi:[1,1]
    v_pk_mul_f32 v[34:35], v[184:185], v[34:35] op_sel:[1,0] op_sel_hi:[1,1]
    v_pk_mul_f32 v[48:49], v[184:185], v[48:49] op_sel:[1,0] op_sel_hi:[1,1]
    v_pk_mul_f32 v[50:51], v[184:185], v[50:51] op_sel:[1,0] op_sel_hi:[1,1]
    v_cvt_pk_bf16_f32 v8, v32, v33
    v_cvt_pk_bf16_f32 v9, v34, v35
    v_cvt_pk_bf16_f32 v10, v48, v49
    v_cvt_pk_bf16_f32 v11, v50, v51
    v_pk_fma_f32 v[36:37], v[186:187], v[192:193], v[36:37] op_sel_hi:[0,1,1] neg_lo:[1,0,0] neg_hi:[1,0,0]
    v_pk_fma_f32 v[38:39], v[186:187], v[194:195], v[38:39] op_sel_hi:[0,1,1] neg_lo:[1,0,0] neg_hi:[1,0,0]
    v_pk_fma_f32 v[52:53], v[186:187], v[196:197], v[52:53] op_sel_hi:[0,1,1] neg_lo:[1,0,0] neg_hi:[1,0,0]
    v_pk_fma_f32 v[54:55], v[186:187], v[198:199], v[54:55] op_sel_hi:[0,1,1] neg_lo:[1,0,0] neg_hi:[1,0,0]
    v_pk_mul_f32 v[36:37], v[186:187], v[36:37] op_sel:[1,0] op_sel_hi:[1,1]
    v_pk_mul_f32 v[38:39], v[186:187], v[38:39] op_sel:[1,0] op_sel_hi:[1,1]
    v_pk_mul_f32 v[52:53], v[186:187], v[52:53] op_sel:[1,0] op_sel_hi:[1,1]
    v_pk_mul_f32 v[54:55], v[186:187], v[54:55] op_sel:[1,0] op_sel_hi:[1,1]
    v_cvt_pk_bf16_f32 v12, v36, v37
    v_cvt_pk_bf16_f32 v13, v38, v39
    v_cvt_pk_bf16_f32 v14, v52, v53
    v_cvt_pk_bf16_f32 v15, v54, v55
    v_pk_fma_f32 v[40:41], v[188:189], v[192:193], v[40:41] op_sel_hi:[0,1,1] neg_lo:[1,0,0] neg_hi:[1,0,0]
    v_pk_fma_f32 v[42:43], v[188:189], v[194:195], v[42:43] op_sel_hi:[0,1,1] neg_lo:[1,0,0] neg_hi:[1,0,0]
    v_pk_fma_f32 v[56:57], v[188:189], v[196:197], v[56:57] op_sel_hi:[0,1,1] neg_lo:[1,0,0] neg_hi:[1,0,0]
    v_pk_fma_f32 v[58:59], v[188:189], v[198:199], v[58:59] op_sel_hi:[0,1,1] neg_lo:[1,0,0] neg_hi:[1,0,0]
    v_pk_mul_f32 v[40:41], v[188:189], v[40:41] op_sel:[1,0] op_sel_hi:[1,1]
    v_pk_mul_f32 v[42:43], v[188:189], v[42:43] op_sel:[1,0] op_sel_hi:[1,1]
    v_pk_mul_f32 v[56:57], v[188:189], v[56:57] op_sel:[1,0] op_sel_hi:[1,1]
    v_pk_mul_f32 v[58:59], v[188:189], v[58:59] op_sel:[1,0] op_sel_hi:[1,1]
    v_cvt_pk_bf16_f32 v16, v40, v41
    v_cvt_pk_bf16_f32 v17, v42, v43
    v_cvt_pk_bf16_f32 v18, v56, v57
    v_cvt_pk_bf16_f32 v19, v58, v59
    v_pk_fma_f32 v[44:45], v[190:191], v[192:193], v[44:45] op_sel_hi:[0,1,1] neg_lo:[1,0,0] neg_hi:[1,0,0]
    v_pk_fma_f32 v[46:47], v[190:191], v[194:195], v[46:47] op_sel_hi:[0,1,1] neg_lo:[1,0,0] neg_hi:[1,0,0]
    v_pk_fma_f32 v[60:61], v[190:191], v[196:197], v[60:61] op_sel_hi:[0,1,1] neg_lo:[1,0,0] neg_hi:[1,0,0]
    v_pk_fma_f32 v[62:63], v[190:191], v[198:199], v[62:63] op_sel_hi:[0,1,1] neg_lo:[1,0,0] neg_hi:[1,0,0]
    v_pk_mul_f32 v[44:45], v[190:191], v[44:45] op_sel:[1,0] op_sel_hi:[1,1]
    v_pk_mul_f32 v[46:47], v[190:191], v[46:47] op_sel:[1,0] op_sel_hi:[1,1]
    v_pk_mul_f32 v[60:61], v[190:191], v[60:61] op_sel:[1,0] op_sel_hi:[1,1]
    v_pk_mul_f32 v[62:63], v[190:191], v[62:63] op_sel:[1,0] op_sel_hi:[1,1]
    v_cvt_pk_bf16_f32 v20, v44, v45
    v_cvt_pk_bf16_f32 v21, v46, v47
    v_cvt_pk_bf16_f32 v22, v60, v61
    v_cvt_pk_bf16_f32 v23, v62, v63
    v_permlane16_swap_b32 v8, v12
    v_permlane16_swap_b32 v9, v13
    v_permlane16_swap_b32 v10, v14
    v_permlane16_swap_b32 v11, v15
    v_permlane16_swap_b32 v16, v20
    v_permlane16_swap_b32 v17, v21
    v_permlane16_swap_b32 v18, v22
    v_permlane16_swap_b32 v19, v23
    s_waitcnt lgkmcnt(0)
    v_mfma_f32_32x32x16_bf16 v[64:79], v[128:131], v[8:11], 0
    v_mfma_f32_32x32x16_bf16 v[64:79], v[132:135], v[12:15], v[64:79]
    v_and_b32 v28, 7, v1
    v_mov_b32 v29, 0x3f803f80
    v_cmp_eq_u32 vcc, 0, v28
    s_nop 1
    v_cndmask_b32 v200, 0, v29, vcc
    v_cndmask_b32 v201, 0, v29, vcc
    v_cmp_eq_u32 vcc, 4, v28
    s_nop 1
    v_cndmask_b32 v202, 0, v29, vcc
    v_cndmask_b32 v203, 0, v29, vcc
    v_mov_b32 v204, 0xdddddddd
    v_mov_b32 v160, 0
    v_mov_b32 v161, 0
    v_mov_b32 v162, 0
    v_mov_b32 v163, 0
    v_mov_b32 v164, 0
    v_mov_b32 v165, 0
    v_mov_b32 v166, 0
    v_mov_b32 v167, 0
    v_mov_b32 v168, 0
    v_mov_b32 v169, 0
    v_mov_b32 v170, 0
    v_mov_b32 v171, 0
    v_mov_b32 v172, 0
    v_mov_b32 v173, 0
    v_mov_b32 v174, 0
    v_mov_b32 v175, 0
    v_mov_b32 v192, 0
    v_mov_b32 v193, 0
    v_mov_b32 v194, 0
    v_mov_b32 v195, 0
    v_mov_b32 v176, 0
    v_mov_b32 v177, 0
    v_mov_b32 v178, 0
    v_mov_b32 v179, 0
    v_mov_b32 v180, 0
    v_mov_b32 v181, 0
    v_mov_b32 v182, 0
    v_mov_b32 v183, 0
    v_mov_b32 v184, 0
    v_mov_b32 v185, 0
    v_mov_b32 v186, 0
    v_mov_b32 v187, 0
    v_mov_b32 v188, 0
    v_mov_b32 v189, 0
    v_mov_b32 v190, 0
    v_mov_b32 v191, 0
    v_mov_b32 v196, 0
    v_mov_b32 v197, 0
    v_mov_b32 v198, 0
    v_mov_b32 v199, 0
    v_mov_b32 v112, 0
    v_mov_b32 v113, 0
    v_mov_b32 v114, 0
    v_mov_b32 v115, 0
    v_mov_b32 v116, 0
    v_mov_b32 v117, 0
    v_mov_b32 v118, 0
    v_mov_b32 v119, 0
    v_mov_b32 v120, 0
    v_mov_b32 v121, 0
    v_mov_b32 v122, 0
    v_mov_b32 v123, 0
    v_mov_b32 v124, 0
    v_mov_b32 v125, 0
    v_mov_b32 v126, 0
    v_mov_b32 v127, 0
    v_mov_b32 v152, 0
    v_mov_b32 v153, 0
    v_mov_b32 v154, 0
    v_mov_b32 v155, 0
    v_mov_b32 v156, 0
    v_mov_b32 v157, 0
    v_mov_b32 v158, 0
    v_mov_b32 v159, 0
    s_mov_b32 s54, 4
.p2align 3
c_attn_loop:
    v_mfma_f32_32x32x16_bf16 v[80:95], v[128:131], v[16:19], 0
    v_exp_f32 v64, v64
    v_exp_f32 v65, v65
    v_exp_f32 v66, v66
    v_mfma_f32_32x32x16_bf16 v[80:95], v[132:135], v[20:23], v[80:95]
    v_exp_f32 v67, v67
    v_exp_f32 v68, v68
    v_exp_f32 v69, v69
    v_smfmac_f32_32x32x32_bf16 v[176:191], v[152:155], v[112:119], v204
    s_waitcnt lgkmcnt(0)
    v_exp_f32 v70, v70
    v_exp_f32 v71, v71
    v_exp_f32 v72, v72
    v_smfmac_f32_16x16x64_bf16 v[196:199], v[200:203], v[112:119], v204
    ds_read_b128 v[144:147], v24 offset:8192
    v_exp_f32 v73, v73
    v_exp_f32 v74, v74
    v_smfmac_f32_32x32x32_bf16 v[176:191], v[156:159], v[120:127], v204
    v_exp_f32 v75, v75
    v_exp_f32 v76, v76
    v_exp_f32 v77, v77
    v_smfmac_f32_16x16x64_bf16 v[196:199], v[200:203], v[120:127], v204
    ds_read_b128 v[148:151], v24 offset:9216
    v_exp_f32 v78, v78
    v_exp_f32 v79, v79
    v_mfma_f32_32x32x16_bf16 v[96:111], v[136:139], v[8:11], 0
    v_exp_f32 v80, v80
    v_exp_f32 v81, v81
    v_exp_f32 v82, v82
    v_mfma_f32_32x32x16_bf16 v[96:111], v[140:143], v[12:15], v[96:111]
    s_waitcnt lgkmcnt(1)
    v_exp_f32 v83, v83
    v_exp_f32 v84, v84
    v_exp_f32 v85, v85
    v_smfmac_f32_32x32x32_bf16 v[160:175], v[144:147], v[64:71], v204
    s_waitcnt lgkmcnt(0)
    v_exp_f32 v86, v86
    v_exp_f32 v87, v87
    v_exp_f32 v88, v88
    v_smfmac_f32_16x16x64_bf16 v[192:195], v[200:203], v[64:71], v204
    ds_read_b128 v[128:131], v24 offset:4096
    v_exp_f32 v89, v89
    v_exp_f32 v90, v90
    v_smfmac_f32_32x32x32_bf16 v[160:175], v[148:151], v[72:79], v204
    v_exp_f32 v91, v91
    v_exp_f32 v92, v92
    v_exp_f32 v93, v93
    v_smfmac_f32_16x16x64_bf16 v[192:195], v[200:203], v[72:79], v204
    ds_read_b128 v[132:135], v24 offset:5120
    v_exp_f32 v94, v94
    v_exp_f32 v95, v95
    v_mfma_f32_32x32x16_bf16 v[112:127], v[136:139], v[16:19], 0
    v_exp_f32 v96, v96
    v_exp_f32 v97, v97
    v_exp_f32 v98, v98
    v_mfma_f32_32x32x16_bf16 v[112:127], v[140:143], v[20:23], v[112:127]
    v_exp_f32 v99, v99
    v_exp_f32 v100, v100
    v_exp_f32 v101, v101
    v_smfmac_f32_32x32x32_bf16 v[176:191], v[144:147], v[80:87], v204
    s_waitcnt lgkmcnt(0)
    v_exp_f32 v102, v102
    v_exp_f32 v103, v103
    v_exp_f32 v104, v104
    v_smfmac_f32_16x16x64_bf16 v[196:199], v[200:203], v[80:87], v204
    ds_read_b128 v[152:155], v24 offset:10240
    v_exp_f32 v105, v105
    v_exp_f32 v106, v106
    v_smfmac_f32_32x32x32_bf16 v[176:191], v[148:151], v[88:95], v204
    v_exp_f32 v107, v107
    v_exp_f32 v108, v108
    v_exp_f32 v109, v109
    v_smfmac_f32_16x16x64_bf16 v[196:199], v[200:203], v[88:95], v204
    ds_read_b128 v[156:159], v24 offset:11264
    v_exp_f32 v110, v110
    v_exp_f32 v111, v111
    v_mfma_f32_32x32x16_bf16 v[64:79], v[128:131], v[8:11], 0
    v_exp_f32 v112, v112
    v_exp_f32 v113, v113
    v_exp_f32 v114, v114
    v_mfma_f32_32x32x16_bf16 v[64:79], v[132:135], v[12:15], v[64:79]
    s_waitcnt lgkmcnt(1)
    v_exp_f32 v115, v115
    v_exp_f32 v116, v116
    v_exp_f32 v117, v117
    v_smfmac_f32_32x32x32_bf16 v[160:175], v[152:155], v[96:103], v204
    s_waitcnt lgkmcnt(0)
    v_exp_f32 v118, v118
    v_exp_f32 v119, v119
    v_exp_f32 v120, v120
    v_smfmac_f32_16x16x64_bf16 v[192:195], v[200:203], v[96:103], v204
    ds_read_b128 v[136:139], v24 offset:6144
    v_exp_f32 v121, v121
    v_exp_f32 v122, v122
    v_smfmac_f32_32x32x32_bf16 v[160:175], v[156:159], v[104:111], v204
    v_exp_f32 v123, v123
    v_exp_f32 v124, v124
    v_exp_f32 v125, v125
    v_smfmac_f32_16x16x64_bf16 v[192:195], v[200:203], v[104:111], v204
    ds_read_b128 v[140:143], v24 offset:7168
    v_exp_f32 v126, v126
    v_exp_f32 v127, v127
    v_mfma_f32_32x32x16_bf16 v[80:95], v[128:131], v[16:19], 0
    s_cmp_eq_u32 s54, 4
    v_exp_f32 v64, v64
    v_exp_f32 v65, v65
    v_exp_f32 v66, v66
    v_mfma_f32_32x32x16_bf16 v[80:95], v[132:135], v[20:23], v[80:95]
    v_exp_f32 v67, v67
    v_exp_f32 v68, v68
    v_exp_f32 v69, v69
    v_smfmac_f32_32x32x32_bf16 v[176:191], v[152:155], v[112:119], v204
    s_waitcnt lgkmcnt(0)
    v_exp_f32 v70, v70
    v_exp_f32 v71, v71
    v_exp_f32 v72, v72
    v_smfmac_f32_16x16x64_bf16 v[196:199], v[200:203], v[112:119], v204
    ds_read_b128 v[144:147], v24 offset:12288
    v_exp_f32 v73, v73
    v_exp_f32 v74, v74
    v_smfmac_f32_32x32x32_bf16 v[176:191], v[156:159], v[120:127], v204
    v_exp_f32 v75, v75
    v_exp_f32 v76, v76
    v_exp_f32 v77, v77
    v_smfmac_f32_16x16x64_bf16 v[196:199], v[200:203], v[120:127], v204
    ds_read_b128 v[148:151], v24 offset:13312
    v_exp_f32 v78, v78
    v_exp_f32 v79, v79
    v_mfma_f32_32x32x16_bf16 v[96:111], v[136:139], v[8:11], 0
    s_cbranch_scc1 c_attn_nobar
    s_barrier
c_attn_nobar:
    v_exp_f32 v80, v80
    v_exp_f32 v81, v81
    v_exp_f32 v82, v82
    v_mfma_f32_32x32x16_bf16 v[96:111], v[140:143], v[12:15], v[96:111]
    s_waitcnt lgkmcnt(1)
    v_exp_f32 v83, v83
    v_exp_f32 v84, v84
    v_exp_f32 v85, v85
    v_smfmac_f32_32x32x32_bf16 v[160:175], v[144:147], v[64:71], v204
    s_waitcnt lgkmcnt(0)
    v_exp_f32 v86, v86
    v_exp_f32 v87, v87
    v_exp_f32 v88, v88
    v_smfmac_f32_16x16x64_bf16 v[192:195], v[200:203], v[64:71], v204
    ds_read_b128 v[128:131], v24 offset:16384
    v_exp_f32 v89, v89
    v_exp_f32 v90, v90
    v_smfmac_f32_32x32x32_bf16 v[160:175], v[148:151], v[72:79], v204
    v_exp_f32 v91, v91
    v_exp_f32 v92, v92
    v_exp_f32 v93, v93
    v_smfmac_f32_16x16x64_bf16 v[192:195], v[200:203], v[72:79], v204
    ds_read_b128 v[132:135], v24 offset:17408
    v_exp_f32 v94, v94
    v_exp_f32 v95, v95
    v_mfma_f32_32x32x16_bf16 v[112:127], v[136:139], v[16:19], 0
    v_exp_f32 v96, v96
    v_exp_f32 v97, v97
    v_exp_f32 v98, v98
    v_mfma_f32_32x32x16_bf16 v[112:127], v[140:143], v[20:23], v[112:127]
    v_exp_f32 v99, v99
    v_exp_f32 v100, v100
    v_exp_f32 v101, v101
    v_smfmac_f32_32x32x32_bf16 v[176:191], v[144:147], v[80:87], v204
    s_waitcnt lgkmcnt(0)
    v_exp_f32 v102, v102
    v_exp_f32 v103, v103
    v_exp_f32 v104, v104
    v_smfmac_f32_16x16x64_bf16 v[196:199], v[200:203], v[80:87], v204
    ds_read_b128 v[152:155], v24 offset:14336
    v_exp_f32 v105, v105
    v_exp_f32 v106, v106
    v_smfmac_f32_32x32x32_bf16 v[176:191], v[148:151], v[88:95], v204
    v_exp_f32 v107, v107
    v_exp_f32 v108, v108
    v_exp_f32 v109, v109
    v_smfmac_f32_16x16x64_bf16 v[196:199], v[200:203], v[88:95], v204
    ds_read_b128 v[156:159], v24 offset:15360
    v_exp_f32 v110, v110
    v_exp_f32 v111, v111
    v_mfma_f32_32x32x16_bf16 v[64:79], v[128:131], v[8:11], 0
    v_exp_f32 v112, v112
    v_exp_f32 v113, v113
    v_exp_f32 v114, v114
    v_mfma_f32_32x32x16_bf16 v[64:79], v[132:135], v[12:15], v[64:79]
    s_waitcnt lgkmcnt(1)
    v_exp_f32 v115, v115
    v_exp_f32 v116, v116
    v_exp_f32 v117, v117
    v_smfmac_f32_32x32x32_bf16 v[160:175], v[152:155], v[96:103], v204
    s_waitcnt lgkmcnt(0)
    v_exp_f32 v118, v118
    v_exp_f32 v119, v119
    v_exp_f32 v120, v120
    v_smfmac_f32_16x16x64_bf16 v[192:195], v[200:203], v[96:103], v204
    ds_read_b128 v[136:139], v24 offset:18432
    v_exp_f32 v121, v121
    v_exp_f32 v122, v122
    v_smfmac_f32_32x32x32_bf16 v[160:175], v[156:159], v[104:111], v204
    v_exp_f32 v123, v123
    v_exp_f32 v124, v124
    v_exp_f32 v125, v125
    v_smfmac_f32_16x16x64_bf16 v[192:195], v[200:203], v[104:111], v204
    ds_read_b128 v[140:143], v24 offset:19456
    v_exp_f32 v126, v126
    v_exp_f32 v127, v127
    v_mfma_f32_32x32x16_bf16 v[80:95], v[128:131], v[16:19], 0
    v_exp_f32 v64, v64
    v_exp_f32 v65, v65
    v_exp_f32 v66, v66
    v_mfma_f32_32x32x16_bf16 v[80:95], v[132:135], v[20:23], v[80:95]
    v_exp_f32 v67, v67
    v_exp_f32 v68, v68
    v_exp_f32 v69, v69
    v_smfmac_f32_32x32x32_bf16 v[176:191], v[152:155], v[112:119], v204
    s_waitcnt lgkmcnt(0)
    v_exp_f32 v70, v70
    v_exp_f32 v71, v71
    v_exp_f32 v72, v72
    v_smfmac_f32_16x16x64_bf16 v[196:199], v[200:203], v[112:119], v204
    ds_read_b128 v[144:147], v24 offset:24576
    v_exp_f32 v73, v73
    v_exp_f32 v74, v74
    v_smfmac_f32_32x32x32_bf16 v[176:191], v[156:159], v[120:127], v204
    v_exp_f32 v75, v75
    v_exp_f32 v76, v76
    v_exp_f32 v77, v77
    v_smfmac_f32_16x16x64_bf16 v[196:199], v[200:203], v[120:127], v204
    ds_read_b128 v[148:151], v24 offset:25600
    v_exp_f32 v78, v78
    v_exp_f32 v79, v79
    v_mfma_f32_32x32x16_bf16 v[96:111], v[136:139], v[8:11], 0
    v_exp_f32 v80, v80
    v_exp_f32 v81, v81
    v_exp_f32 v82, v82
    v_mfma_f32_32x32x16_bf16 v[96:111], v[140:143], v[12:15], v[96:111]
    s_waitcnt lgkmcnt(1)
    v_exp_f32 v83, v83
    v_exp_f32 v84, v84
    v_exp_f32 v85, v85
    v_smfmac_f32_32x32x32_bf16 v[160:175], v[144:147], v[64:71], v204
    s_waitcnt lgkmcnt(0)
    v_exp_f32 v86, v86
    v_exp_f32 v87, v87
    v_exp_f32 v88, v88
    v_smfmac_f32_16x16x64_bf16 v[192:195], v[200:203], v[64:71], v204
    ds_read_b128 v[128:131], v24 offset:20480
    v_exp_f32 v89, v89
    v_exp_f32 v90, v90
    v_smfmac_f32_32x32x32_bf16 v[160:175], v[148:151], v[72:79], v204
    v_exp_f32 v91, v91
    v_exp_f32 v92, v92
    v_exp_f32 v93, v93
    v_smfmac_f32_16x16x64_bf16 v[192:195], v[200:203], v[72:79], v204
    ds_read_b128 v[132:135], v24 offset:21504
    v_exp_f32 v94, v94
    v_exp_f32 v95, v95
    v_mfma_f32_32x32x16_bf16 v[112:127], v[136:139], v[16:19], 0
    v_exp_f32 v96, v96
    v_exp_f32 v97, v97
    v_exp_f32 v98, v98
    v_mfma_f32_32x32x16_bf16 v[112:127], v[140:143], v[20:23], v[112:127]
    v_exp_f32 v99, v99
    v_exp_f32 v100, v100
    v_exp_f32 v101, v101
    v_smfmac_f32_32x32x32_bf16 v[176:191], v[144:147], v[80:87], v204
    s_waitcnt lgkmcnt(0)
    v_exp_f32 v102, v102
    v_exp_f32 v103, v103
    v_exp_f32 v104, v104
    v_smfmac_f32_16x16x64_bf16 v[196:199], v[200:203], v[80:87], v204
    ds_read_b128 v[152:155], v24 offset:26624
    v_exp_f32 v105, v105
    v_exp_f32 v106, v106
    v_smfmac_f32_32x32x32_bf16 v[176:191], v[148:151], v[88:95], v204
    v_exp_f32 v107, v107
    v_exp_f32 v108, v108
    v_exp_f32 v109, v109
    v_smfmac_f32_16x16x64_bf16 v[196:199], v[200:203], v[88:95], v204
    ds_read_b128 v[156:159], v24 offset:27648
    v_exp_f32 v110, v110
    v_exp_f32 v111, v111
    v_mfma_f32_32x32x16_bf16 v[64:79], v[128:131], v[8:11], 0
    v_exp_f32 v112, v112
    v_exp_f32 v113, v113
    v_exp_f32 v114, v114
    v_mfma_f32_32x32x16_bf16 v[64:79], v[132:135], v[12:15], v[64:79]
    s_waitcnt lgkmcnt(1)
    v_exp_f32 v115, v115
    v_exp_f32 v116, v116
    v_exp_f32 v117, v117
    v_smfmac_f32_32x32x32_bf16 v[160:175], v[152:155], v[96:103], v204
    s_waitcnt lgkmcnt(0)
    v_exp_f32 v118, v118
    v_exp_f32 v119, v119
    v_exp_f32 v120, v120
    v_smfmac_f32_16x16x64_bf16 v[192:195], v[200:203], v[96:103], v204
    ds_read_b128 v[136:139], v24 offset:22528
    v_exp_f32 v121, v121
    v_exp_f32 v122, v122
    v_smfmac_f32_32x32x32_bf16 v[160:175], v[156:159], v[104:111], v204
    v_exp_f32 v123, v123
    v_exp_f32 v124, v124
    v_exp_f32 v125, v125
    v_smfmac_f32_16x16x64_bf16 v[192:195], v[200:203], v[104:111], v204
    ds_read_b128 v[140:143], v24 offset:23552
    v_exp_f32 v126, v126
    v_exp_f32 v127, v127
    v_mfma_f32_32x32x16_bf16 v[80:95], v[128:131], v[16:19], 0
    v_exp_f32 v64, v64
    v_exp_f32 v65, v65
    v_exp_f32 v66, v66
    v_mfma_f32_32x32x16_bf16 v[80:95], v[132:135], v[20:23], v[80:95]
    v_exp_f32 v67, v67
    v_exp_f32 v68, v68
    v_exp_f32 v69, v69
    v_smfmac_f32_32x32x32_bf16 v[176:191], v[152:155], v[112:119], v204
    s_waitcnt lgkmcnt(0)
    v_exp_f32 v70, v70
    v_exp_f32 v71, v71
    v_exp_f32 v72, v72
    v_smfmac_f32_16x16x64_bf16 v[196:199], v[200:203], v[112:119], v204
    ds_read_b128 v[144:147], v24 offset:28672
    v_exp_f32 v73, v73
    v_exp_f32 v74, v74
    v_smfmac_f32_32x32x32_bf16 v[176:191], v[156:159], v[120:127], v204
    v_exp_f32 v75, v75
    v_exp_f32 v76, v76
    v_exp_f32 v77, v77
    v_smfmac_f32_16x16x64_bf16 v[196:199], v[200:203], v[120:127], v204
    ds_read_b128 v[148:151], v24 offset:29696
    v_exp_f32 v78, v78
    v_exp_f32 v79, v79
    v_mfma_f32_32x32x16_bf16 v[96:111], v[136:139], v[8:11], 0
    s_barrier
    v_exp_f32 v80, v80
    v_exp_f32 v81, v81
    v_exp_f32 v82, v82
    v_mfma_f32_32x32x16_bf16 v[96:111], v[140:143], v[12:15], v[96:111]
    s_waitcnt lgkmcnt(1)
    v_exp_f32 v83, v83
    v_exp_f32 v84, v84
    v_exp_f32 v85, v85
    v_smfmac_f32_32x32x32_bf16 v[160:175], v[144:147], v[64:71], v204
    s_waitcnt lgkmcnt(0)
    v_exp_f32 v86, v86
    v_exp_f32 v87, v87
    v_exp_f32 v88, v88
    v_smfmac_f32_16x16x64_bf16 v[192:195], v[200:203], v[64:71], v204
    ds_read_b128 v[128:131], v24 offset:32768
    v_exp_f32 v89, v89
    v_exp_f32 v90, v90
    v_smfmac_f32_32x32x32_bf16 v[160:175], v[148:151], v[72:79], v204
    v_exp_f32 v91, v91
    v_exp_f32 v92, v92
    v_exp_f32 v93, v93
    v_smfmac_f32_16x16x64_bf16 v[192:195], v[200:203], v[72:79], v204
    ds_read_b128 v[132:135], v24 offset:33792
    v_exp_f32 v94, v94
    v_exp_f32 v95, v95
    v_mfma_f32_32x32x16_bf16 v[112:127], v[136:139], v[16:19], 0
    v_exp_f32 v96, v96
    v_exp_f32 v97, v97
    v_exp_f32 v98, v98
    v_mfma_f32_32x32x16_bf16 v[112:127], v[140:143], v[20:23], v[112:127]
    v_exp_f32 v99, v99
    v_exp_f32 v100, v100
    v_exp_f32 v101, v101
    v_smfmac_f32_32x32x32_bf16 v[176:191], v[144:147], v[80:87], v204
    s_waitcnt lgkmcnt(0)
    v_exp_f32 v102, v102
    v_exp_f32 v103, v103
    v_exp_f32 v104, v104
    v_smfmac_f32_16x16x64_bf16 v[196:199], v[200:203], v[80:87], v204
    ds_read_b128 v[152:155], v24 offset:30720
    v_exp_f32 v105, v105
    v_exp_f32 v106, v106
    v_smfmac_f32_32x32x32_bf16 v[176:191], v[148:151], v[88:95], v204
    v_exp_f32 v107, v107
    v_exp_f32 v108, v108
    v_exp_f32 v109, v109
    v_smfmac_f32_16x16x64_bf16 v[196:199], v[200:203], v[88:95], v204
    ds_read_b128 v[156:159], v24 offset:31744
    v_exp_f32 v110, v110
    v_exp_f32 v111, v111
    v_mfma_f32_32x32x16_bf16 v[64:79], v[128:131], v[8:11], 0
    v_exp_f32 v112, v112
    v_exp_f32 v113, v113
    v_exp_f32 v114, v114
    v_mfma_f32_32x32x16_bf16 v[64:79], v[132:135], v[12:15], v[64:79]
    s_waitcnt lgkmcnt(1)
    v_exp_f32 v115, v115
    v_exp_f32 v116, v116
    v_exp_f32 v117, v117
    v_smfmac_f32_32x32x32_bf16 v[160:175], v[152:155], v[96:103], v204
    s_waitcnt lgkmcnt(0)
    v_exp_f32 v118, v118
    v_exp_f32 v119, v119
    v_exp_f32 v120, v120
    v_smfmac_f32_16x16x64_bf16 v[192:195], v[200:203], v[96:103], v204
    ds_read_b128 v[136:139], v24 offset:34816
    v_exp_f32 v121, v121
    v_exp_f32 v122, v122
    v_smfmac_f32_32x32x32_bf16 v[160:175], v[156:159], v[104:111], v204
    v_exp_f32 v123, v123
    v_exp_f32 v124, v124
    v_exp_f32 v125, v125
    v_smfmac_f32_16x16x64_bf16 v[192:195], v[200:203], v[104:111], v204
    ds_read_b128 v[140:143], v24 offset:35840
    v_exp_f32 v126, v126
    v_exp_f32 v127, v127
    v_mfma_f32_32x32x16_bf16 v[80:95], v[128:131], v[16:19], 0
    v_exp_f32 v64, v64
    v_exp_f32 v65, v65
    v_exp_f32 v66, v66
    v_mfma_f32_32x32x16_bf16 v[80:95], v[132:135], v[20:23], v[80:95]
    v_exp_f32 v67, v67
    v_exp_f32 v68, v68
    v_exp_f32 v69, v69
    v_smfmac_f32_32x32x32_bf16 v[176:191], v[152:155], v[112:119], v204
    s_waitcnt lgkmcnt(0)
    v_exp_f32 v70, v70
    v_exp_f32 v71, v71
    v_exp_f32 v72, v72
    v_smfmac_f32_16x16x64_bf16 v[196:199], v[200:203], v[112:119], v204
    ds_read_b128 v[144:147], v24 offset:40960
    v_exp_f32 v73, v73
    v_exp_f32 v74, v74
    v_smfmac_f32_32x32x32_bf16 v[176:191], v[156:159], v[120:127], v204
    v_exp_f32 v75, v75
    v_exp_f32 v76, v76
    v_exp_f32 v77, v77
    v_smfmac_f32_16x16x64_bf16 v[196:199], v[200:203], v[120:127], v204
    ds_read_b128 v[148:151], v24 offset:41984
    v_exp_f32 v78, v78
    v_exp_f32 v79, v79
    v_mfma_f32_32x32x16_bf16 v[96:111], v[136:139], v[8:11], 0
    v_exp_f32 v80, v80
    v_exp_f32 v81, v81
    v_exp_f32 v82, v82
    v_mfma_f32_32x32x16_bf16 v[96:111], v[140:143], v[12:15], v[96:111]
    s_waitcnt lgkmcnt(1)
    v_exp_f32 v83, v83
    v_exp_f32 v84, v84
    v_exp_f32 v85, v85
    v_smfmac_f32_32x32x32_bf16 v[160:175], v[144:147], v[64:71], v204
    s_waitcnt lgkmcnt(0)
    v_exp_f32 v86, v86
    v_exp_f32 v87, v87
    v_exp_f32 v88, v88
    v_smfmac_f32_16x16x64_bf16 v[192:195], v[200:203], v[64:71], v204
    ds_read_b128 v[128:131], v24 offset:36864
    v_exp_f32 v89, v89
    v_exp_f32 v90, v90
    v_smfmac_f32_32x32x32_bf16 v[160:175], v[148:151], v[72:79], v204
    v_exp_f32 v91, v91
    v_exp_f32 v92, v92
    v_exp_f32 v93, v93
    v_smfmac_f32_16x16x64_bf16 v[192:195], v[200:203], v[72:79], v204
    ds_read_b128 v[132:135], v24 offset:37888
    v_exp_f32 v94, v94
    v_exp_f32 v95, v95
    v_mfma_f32_32x32x16_bf16 v[112:127], v[136:139], v[16:19], 0
    v_exp_f32 v96, v96
    v_exp_f32 v97, v97
    v_exp_f32 v98, v98
    v_mfma_f32_32x32x16_bf16 v[112:127], v[140:143], v[20:23], v[112:127]
    v_exp_f32 v99, v99
    v_exp_f32 v100, v100
    v_exp_f32 v101, v101
    v_smfmac_f32_32x32x32_bf16 v[176:191], v[144:147], v[80:87], v204
    s_waitcnt lgkmcnt(0)
    v_exp_f32 v102, v102
    v_exp_f32 v103, v103
    v_exp_f32 v104, v104
    v_smfmac_f32_16x16x64_bf16 v[196:199], v[200:203], v[80:87], v204
    ds_read_b128 v[152:155], v24 offset:43008
    v_exp_f32 v105, v105
    v_exp_f32 v106, v106
    v_smfmac_f32_32x32x32_bf16 v[176:191], v[148:151], v[88:95], v204
    v_exp_f32 v107, v107
    v_exp_f32 v108, v108
    v_exp_f32 v109, v109
    v_smfmac_f32_16x16x64_bf16 v[196:199], v[200:203], v[88:95], v204
    ds_read_b128 v[156:159], v24 offset:44032
    v_exp_f32 v110, v110
    v_exp_f32 v111, v111
    v_mfma_f32_32x32x16_bf16 v[64:79], v[128:131], v[8:11], 0
    v_exp_f32 v112, v112
    v_exp_f32 v113, v113
    v_exp_f32 v114, v114
    v_mfma_f32_32x32x16_bf16 v[64:79], v[132:135], v[12:15], v[64:79]
    s_waitcnt lgkmcnt(1)
    v_exp_f32 v115, v115
    v_exp_f32 v116, v116
    v_exp_f32 v117, v117
    v_smfmac_f32_32x32x32_bf16 v[160:175], v[152:155], v[96:103], v204
    s_waitcnt lgkmcnt(0)
    v_exp_f32 v118, v118
    v_exp_f32 v119, v119
    v_exp_f32 v120, v120
    v_smfmac_f32_16x16x64_bf16 v[192:195], v[200:203], v[96:103], v204
    ds_read_b128 v[136:139], v24 offset:38912
    v_exp_f32 v121, v121
    v_exp_f32 v122, v122
    v_smfmac_f32_32x32x32_bf16 v[160:175], v[156:159], v[104:111], v204
    v_exp_f32 v123, v123
    v_exp_f32 v124, v124
    v_exp_f32 v125, v125
    v_smfmac_f32_16x16x64_bf16 v[192:195], v[200:203], v[104:111], v204
    ds_read_b128 v[140:143], v24 offset:39936
    v_exp_f32 v126, v126
    v_exp_f32 v127, v127
    v_mfma_f32_32x32x16_bf16 v[80:95], v[128:131], v[16:19], 0
    v_exp_f32 v64, v64
    v_exp_f32 v65, v65
    v_exp_f32 v66, v66
    v_mfma_f32_32x32x16_bf16 v[80:95], v[132:135], v[20:23], v[80:95]
    v_exp_f32 v67, v67
    v_exp_f32 v68, v68
    v_exp_f32 v69, v69
    v_smfmac_f32_32x32x32_bf16 v[176:191], v[152:155], v[112:119], v204
    s_waitcnt lgkmcnt(0)
    v_exp_f32 v70, v70
    v_exp_f32 v71, v71
    v_exp_f32 v72, v72
    v_smfmac_f32_16x16x64_bf16 v[196:199], v[200:203], v[112:119], v204
    ds_read_b128 v[144:147], v24 offset:45056
    v_exp_f32 v73, v73
    v_exp_f32 v74, v74
    v_smfmac_f32_32x32x32_bf16 v[176:191], v[156:159], v[120:127], v204
    v_exp_f32 v75, v75
    v_exp_f32 v76, v76
    v_exp_f32 v77, v77
    v_smfmac_f32_16x16x64_bf16 v[196:199], v[200:203], v[120:127], v204
    ds_read_b128 v[148:151], v24 offset:46080
    v_exp_f32 v78, v78
    v_exp_f32 v79, v79
    v_mfma_f32_32x32x16_bf16 v[96:111], v[136:139], v[8:11], 0
    s_barrier
    v_exp_f32 v80, v80
    v_exp_f32 v81, v81
    v_exp_f32 v82, v82
    v_mfma_f32_32x32x16_bf16 v[96:111], v[140:143], v[12:15], v[96:111]
    s_waitcnt lgkmcnt(1)
    v_exp_f32 v83, v83
    v_exp_f32 v84, v84
    v_exp_f32 v85, v85
    v_smfmac_f32_32x32x32_bf16 v[160:175], v[144:147], v[64:71], v204
    s_waitcnt lgkmcnt(0)
    v_exp_f32 v86, v86
    v_exp_f32 v87, v87
    v_exp_f32 v88, v88
    v_smfmac_f32_16x16x64_bf16 v[192:195], v[200:203], v[64:71], v204
    ds_read_b128 v[128:131], v24 offset:49152
    v_exp_f32 v89, v89
    v_exp_f32 v90, v90
    v_smfmac_f32_32x32x32_bf16 v[160:175], v[148:151], v[72:79], v204
    v_exp_f32 v91, v91
    v_exp_f32 v92, v92
    v_exp_f32 v93, v93
    v_smfmac_f32_16x16x64_bf16 v[192:195], v[200:203], v[72:79], v204
    ds_read_b128 v[132:135], v24 offset:50176
    v_exp_f32 v94, v94
    v_exp_f32 v95, v95
    v_mfma_f32_32x32x16_bf16 v[112:127], v[136:139], v[16:19], 0
    v_exp_f32 v96, v96
    v_exp_f32 v97, v97
    v_exp_f32 v98, v98
    v_mfma_f32_32x32x16_bf16 v[112:127], v[140:143], v[20:23], v[112:127]
    v_exp_f32 v99, v99
    v_exp_f32 v100, v100
    v_exp_f32 v101, v101
    v_smfmac_f32_32x32x32_bf16 v[176:191], v[144:147], v[80:87], v204
    s_waitcnt lgkmcnt(0)
    v_exp_f32 v102, v102
    v_exp_f32 v103, v103
    v_exp_f32 v104, v104
    v_smfmac_f32_16x16x64_bf16 v[196:199], v[200:203], v[80:87], v204
    ds_read_b128 v[152:155], v24 offset:47104
    v_exp_f32 v105, v105
    v_exp_f32 v106, v106
    v_smfmac_f32_32x32x32_bf16 v[176:191], v[148:151], v[88:95], v204
    v_exp_f32 v107, v107
    v_exp_f32 v108, v108
    v_exp_f32 v109, v109
    v_smfmac_f32_16x16x64_bf16 v[196:199], v[200:203], v[88:95], v204
    ds_read_b128 v[156:159], v24 offset:48128
    v_exp_f32 v110, v110
    v_exp_f32 v111, v111
    v_mfma_f32_32x32x16_bf16 v[64:79], v[128:131], v[8:11], 0
    v_exp_f32 v112, v112
    v_exp_f32 v113, v113
    v_exp_f32 v114, v114
    v_mfma_f32_32x32x16_bf16 v[64:79], v[132:135], v[12:15], v[64:79]
    s_waitcnt lgkmcnt(1)
    v_exp_f32 v115, v115
    v_exp_f32 v116, v116
    v_exp_f32 v117, v117
    v_smfmac_f32_32x32x32_bf16 v[160:175], v[152:155], v[96:103], v204
    s_waitcnt lgkmcnt(0)
    v_exp_f32 v118, v118
    v_exp_f32 v119, v119
    v_exp_f32 v120, v120
    v_smfmac_f32_16x16x64_bf16 v[192:195], v[200:203], v[96:103], v204
    ds_read_b128 v[136:139], v24 offset:51200
    v_exp_f32 v121, v121
    v_exp_f32 v122, v122
    v_smfmac_f32_32x32x32_bf16 v[160:175], v[156:159], v[104:111], v204
    v_exp_f32 v123, v123
    v_exp_f32 v124, v124
    v_exp_f32 v125, v125
    v_smfmac_f32_16x16x64_bf16 v[192:195], v[200:203], v[104:111], v204
    ds_read_b128 v[140:143], v24 offset:52224
    v_exp_f32 v126, v126
    v_exp_f32 v127, v127
    v_mfma_f32_32x32x16_bf16 v[80:95], v[128:131], v[16:19], 0
    v_exp_f32 v64, v64
    v_exp_f32 v65, v65
    v_exp_f32 v66, v66
    v_mfma_f32_32x32x16_bf16 v[80:95], v[132:135], v[20:23], v[80:95]
    v_exp_f32 v67, v67
    v_exp_f32 v68, v68
    v_exp_f32 v69, v69
    v_smfmac_f32_32x32x32_bf16 v[176:191], v[152:155], v[112:119], v204
    s_waitcnt lgkmcnt(0)
    v_exp_f32 v70, v70
    v_exp_f32 v71, v71
    v_exp_f32 v72, v72
    v_smfmac_f32_16x16x64_bf16 v[196:199], v[200:203], v[112:119], v204
    ds_read_b128 v[144:147], v24 offset:57344
    v_exp_f32 v73, v73
    v_exp_f32 v74, v74
    v_smfmac_f32_32x32x32_bf16 v[176:191], v[156:159], v[120:127], v204
    v_exp_f32 v75, v75
    v_exp_f32 v76, v76
    v_exp_f32 v77, v77
    v_smfmac_f32_16x16x64_bf16 v[196:199], v[200:203], v[120:127], v204
    ds_read_b128 v[148:151], v24 offset:58368
    v_exp_f32 v78, v78
    v_exp_f32 v79, v79
    v_mfma_f32_32x32x16_bf16 v[96:111], v[136:139], v[8:11], 0
    v_exp_f32 v80, v80
    v_exp_f32 v81, v81
    v_exp_f32 v82, v82
    v_mfma_f32_32x32x16_bf16 v[96:111], v[140:143], v[12:15], v[96:111]
    s_waitcnt lgkmcnt(1)
    v_exp_f32 v83, v83
    v_exp_f32 v84, v84
    v_exp_f32 v85, v85
    v_smfmac_f32_32x32x32_bf16 v[160:175], v[144:147], v[64:71], v204
    s_waitcnt lgkmcnt(0)
    v_exp_f32 v86, v86
    v_exp_f32 v87, v87
    v_exp_f32 v88, v88
    v_smfmac_f32_16x16x64_bf16 v[192:195], v[200:203], v[64:71], v204
    ds_read_b128 v[128:131], v24 offset:53248
    v_exp_f32 v89, v89
    v_exp_f32 v90, v90
    v_smfmac_f32_32x32x32_bf16 v[160:175], v[148:151], v[72:79], v204
    v_exp_f32 v91, v91
    v_exp_f32 v92, v92
    v_exp_f32 v93, v93
    v_smfmac_f32_16x16x64_bf16 v[192:195], v[200:203], v[72:79], v204
    ds_read_b128 v[132:135], v24 offset:54272
    v_exp_f32 v94, v94
    v_exp_f32 v95, v95
    v_mfma_f32_32x32x16_bf16 v[112:127], v[136:139], v[16:19], 0
    v_exp_f32 v96, v96
    v_exp_f32 v97, v97
    v_exp_f32 v98, v98
    v_mfma_f32_32x32x16_bf16 v[112:127], v[140:143], v[20:23], v[112:127]
    v_exp_f32 v99, v99
    v_exp_f32 v100, v100
    v_exp_f32 v101, v101
    v_smfmac_f32_32x32x32_bf16 v[176:191], v[144:147], v[80:87], v204
    s_waitcnt lgkmcnt(0)
    v_exp_f32 v102, v102
    v_exp_f32 v103, v103
    v_exp_f32 v104, v104
    v_smfmac_f32_16x16x64_bf16 v[196:199], v[200:203], v[80:87], v204
    ds_read_b128 v[152:155], v24 offset:59392
    v_exp_f32 v105, v105
    v_exp_f32 v106, v106
    v_smfmac_f32_32x32x32_bf16 v[176:191], v[148:151], v[88:95], v204
    v_exp_f32 v107, v107
    v_exp_f32 v108, v108
    v_exp_f32 v109, v109
    v_smfmac_f32_16x16x64_bf16 v[196:199], v[200:203], v[88:95], v204
    ds_read_b128 v[156:159], v24 offset:60416
    v_exp_f32 v110, v110
    v_exp_f32 v111, v111
    v_mfma_f32_32x32x16_bf16 v[64:79], v[128:131], v[8:11], 0
    v_exp_f32 v112, v112
    v_exp_f32 v113, v113
    v_exp_f32 v114, v114
    v_mfma_f32_32x32x16_bf16 v[64:79], v[132:135], v[12:15], v[64:79]
    s_waitcnt lgkmcnt(1)
    v_exp_f32 v115, v115
    v_exp_f32 v116, v116
    v_exp_f32 v117, v117
    v_smfmac_f32_32x32x32_bf16 v[160:175], v[152:155], v[96:103], v204
    s_waitcnt lgkmcnt(0)
    v_exp_f32 v118, v118
    v_exp_f32 v119, v119
    v_exp_f32 v120, v120
    v_smfmac_f32_16x16x64_bf16 v[192:195], v[200:203], v[96:103], v204
    ds_read_b128 v[136:139], v24 offset:55296
    v_exp_f32 v121, v121
    v_exp_f32 v122, v122
    v_smfmac_f32_32x32x32_bf16 v[160:175], v[156:159], v[104:111], v204
    v_exp_f32 v123, v123
    v_exp_f32 v124, v124
    v_exp_f32 v125, v125
    v_smfmac_f32_16x16x64_bf16 v[192:195], v[200:203], v[104:111], v204
    ds_read_b128 v[140:143], v24 offset:56320
    v_exp_f32 v126, v126
    v_exp_f32 v127, v127
    v_mfma_f32_32x32x16_bf16 v[80:95], v[128:131], v[16:19], 0
    v_exp_f32 v64, v64
    v_exp_f32 v65, v65
    v_exp_f32 v66, v66
    v_mfma_f32_32x32x16_bf16 v[80:95], v[132:135], v[20:23], v[80:95]
    v_exp_f32 v67, v67
    v_exp_f32 v68, v68
    v_exp_f32 v69, v69
    v_smfmac_f32_32x32x32_bf16 v[176:191], v[152:155], v[112:119], v204
    s_waitcnt lgkmcnt(0)
    v_exp_f32 v70, v70
    v_exp_f32 v71, v71
    v_exp_f32 v72, v72
    v_smfmac_f32_16x16x64_bf16 v[196:199], v[200:203], v[112:119], v204
    ds_read_b128 v[144:147], v24 offset:61440
    v_exp_f32 v73, v73
    v_exp_f32 v74, v74
    v_smfmac_f32_32x32x32_bf16 v[176:191], v[156:159], v[120:127], v204
    v_exp_f32 v75, v75
    v_exp_f32 v76, v76
    v_exp_f32 v77, v77
    v_smfmac_f32_16x16x64_bf16 v[196:199], v[200:203], v[120:127], v204
    ds_read_b128 v[148:151], v24 offset:62464
    v_exp_f32 v78, v78
    v_exp_f32 v79, v79
    v_mfma_f32_32x32x16_bf16 v[96:111], v[136:139], v[8:11], 0
    s_barrier
    v_exp_f32 v80, v80
    v_exp_f32 v81, v81
    v_exp_f32 v82, v82
    v_mfma_f32_32x32x16_bf16 v[96:111], v[140:143], v[12:15], v[96:111]
    s_waitcnt lgkmcnt(1)
    v_exp_f32 v83, v83
    v_exp_f32 v84, v84
    v_exp_f32 v85, v85
    v_smfmac_f32_32x32x32_bf16 v[160:175], v[144:147], v[64:71], v204
    s_waitcnt lgkmcnt(0)
    v_exp_f32 v86, v86
    v_exp_f32 v87, v87
    v_exp_f32 v88, v88
    v_smfmac_f32_16x16x64_bf16 v[192:195], v[200:203], v[64:71], v204
    ds_read_b128 v[128:131], v24 offset:0
    v_exp_f32 v89, v89
    v_exp_f32 v90, v90
    v_smfmac_f32_32x32x32_bf16 v[160:175], v[148:151], v[72:79], v204
    v_exp_f32 v91, v91
    v_exp_f32 v92, v92
    v_exp_f32 v93, v93
    v_smfmac_f32_16x16x64_bf16 v[192:195], v[200:203], v[72:79], v204
    ds_read_b128 v[132:135], v24 offset:1024
    v_exp_f32 v94, v94
    v_exp_f32 v95, v95
    v_mfma_f32_32x32x16_bf16 v[112:127], v[136:139], v[16:19], 0
    v_exp_f32 v96, v96
    v_exp_f32 v97, v97
    v_exp_f32 v98, v98
    v_mfma_f32_32x32x16_bf16 v[112:127], v[140:143], v[20:23], v[112:127]
    v_exp_f32 v99, v99
    v_exp_f32 v100, v100
    v_exp_f32 v101, v101
    v_smfmac_f32_32x32x32_bf16 v[176:191], v[144:147], v[80:87], v204
    s_waitcnt lgkmcnt(0)
    v_exp_f32 v102, v102
    v_exp_f32 v103, v103
    v_exp_f32 v104, v104
    v_smfmac_f32_16x16x64_bf16 v[196:199], v[200:203], v[80:87], v204
    ds_read_b128 v[152:155], v24 offset:63488
    v_exp_f32 v105, v105
    v_exp_f32 v106, v106
    v_smfmac_f32_32x32x32_bf16 v[176:191], v[148:151], v[88:95], v204
    v_exp_f32 v107, v107
    v_exp_f32 v108, v108
    v_exp_f32 v109, v109
    v_smfmac_f32_16x16x64_bf16 v[196:199], v[200:203], v[88:95], v204
    ds_read_b128 v[156:159], v24 offset:64512
    v_exp_f32 v110, v110
    v_exp_f32 v111, v111
    v_mfma_f32_32x32x16_bf16 v[64:79], v[128:131], v[8:11], 0
    s_sub_u32 s54, s54, 1
    v_exp_f32 v112, v112
    v_exp_f32 v113, v113
    v_exp_f32 v114, v114
    v_mfma_f32_32x32x16_bf16 v[64:79], v[132:135], v[12:15], v[64:79]
    s_waitcnt lgkmcnt(1)
    v_exp_f32 v115, v115
    v_exp_f32 v116, v116
    v_exp_f32 v117, v117
    v_smfmac_f32_32x32x32_bf16 v[160:175], v[152:155], v[96:103], v204
    s_waitcnt lgkmcnt(0)
    v_exp_f32 v118, v118
    v_exp_f32 v119, v119
    v_exp_f32 v120, v120
    v_smfmac_f32_16x16x64_bf16 v[192:195], v[200:203], v[96:103], v204
    ds_read_b128 v[136:139], v24 offset:2048
    v_exp_f32 v121, v121
    v_exp_f32 v122, v122
    v_smfmac_f32_32x32x32_bf16 v[160:175], v[156:159], v[104:111], v204
    s_cmp_lg_u32 s54, 0
    v_exp_f32 v123, v123
    v_exp_f32 v124, v124
    v_exp_f32 v125, v125
    v_smfmac_f32_16x16x64_bf16 v[192:195], v[200:203], v[104:111], v204
    ds_read_b128 v[140:143], v24 offset:3072
    v_exp_f32 v126, v126
    v_exp_f32 v127, v127
    s_cbranch_scc1 c_attn_loop
    v_smfmac_f32_16x16x64_bf16 v[196:199], v[200:203], v[112:119], v204
    v_smfmac_f32_16x16x64_bf16 v[196:199], v[200:203], v[120:127], v204
    v_smfmac_f32_32x32x32_bf16 v[176:191], v[152:155], v[112:119], v204
    v_smfmac_f32_32x32x32_bf16 v[176:191], v[156:159], v[120:127], v204
    v_mov_b32 v28, 0x5f000000
    v_mov_b32 v29, 0x2b800000
    v_cmp_lt_f32 s[56:57], v192, v28
    v_cmp_gt_f32 vcc, v192, v29
    s_and_b64 s[56:57], s[56:57], vcc
    s_nop 0
    v_cmp_lt_f32 vcc, v196, v28
    s_and_b64 s[56:57], s[56:57], vcc
    v_cmp_gt_f32 vcc, v196, v29
    s_and_b64 s[56:57], s[56:57], vcc
    s_cmp_lg_u64 s[56:57], -1
    s_cbranch_scc1 c_attn_slow
c_attn_fin:
    s_lshl_b32 s3, s48, 17
    s_lshl_b32 s55, s7, 12
    s_add_u32 s3, s3, s55
    s_and_b32 s55, s6, 1
    s_lshl_b32 s55, s55, 11
    s_add_u32 s3, s3, s55
    s_lshl_b32 s55, s9, 22
    s_add_u32 s3, s3, s55
    s_add_u32 s3, s3, 16777216
    v_rcp_f32 v192, v192
    s_nop 0
    v_pk_mul_f32 v[160:161], v[192:193], v[160:161] op_sel_hi:[0,1]
    v_pk_mul_f32 v[162:163], v[192:193], v[162:163] op_sel_hi:[0,1]
    v_pk_mul_f32 v[164:165], v[192:193], v[164:165] op_sel_hi:[0,1]
    v_pk_mul_f32 v[166:167], v[192:193], v[166:167] op_sel_hi:[0,1]
    v_pk_mul_f32 v[168:169], v[192:193], v[168:169] op_sel_hi:[0,1]
    v_pk_mul_f32 v[170:171], v[192:193], v[170:171] op_sel_hi:[0,1]
    v_pk_mul_f32 v[172:173], v[192:193], v[172:173] op_sel_hi:[0,1]
    v_pk_mul_f32 v[174:175], v[192:193], v[174:175] op_sel_hi:[0,1]
    v_cvt_pk_bf16_f32 v160, v160, v161
    v_cvt_pk_bf16_f32 v161, v162, v163
    v_cvt_pk_bf16_f32 v162, v164, v165
    v_cvt_pk_bf16_f32 v163, v166, v167
    v_cvt_pk_bf16_f32 v164, v168, v169
    v_cvt_pk_bf16_f32 v165, v170, v171
    v_cvt_pk_bf16_f32 v166, v172, v173
    v_cvt_pk_bf16_f32 v167, v174, v175
    buffer_store_dwordx4 v[160:163], v5, s[12:15], s3 offen offset:0 sc1
    buffer_store_dwordx4 v[164:167], v5, s[12:15], s3 offen offset:1024 sc1
    s_add_u32 s3, s3, 65536
    v_rcp_f32 v196, v196
    s_nop 0
    v_pk_mul_f32 v[176:177], v[196:197], v[176:177] op_sel_hi:[0,1]
    v_pk_mul_f32 v[178:179], v[196:197], v[178:179] op_sel_hi:[0,1]
    v_pk_mul_f32 v[180:181], v[196:197], v[180:181] op_sel_hi:[0,1]
    v_pk_mul_f32 v[182:183], v[196:197], v[182:183] op_sel_hi:[0,1]
    v_pk_mul_f32 v[184:185], v[196:197], v[184:185] op_sel_hi:[0,1]
    v_pk_mul_f32 v[186:187], v[196:197], v[186:187] op_sel_hi:[0,1]
    v_pk_mul_f32 v[188:189], v[196:197], v[188:189] op_sel_hi:[0,1]
    v_pk_mul_f32 v[190:191], v[196:197], v[190:191] op_sel_hi:[0,1]
    v_cvt_pk_bf16_f32 v176, v176, v177
    v_cvt_pk_bf16_f32 v177, v178, v179
    v_cvt_pk_bf16_f32 v178, v180, v181
    v_cvt_pk_bf16_f32 v179, v182, v183
    v_cvt_pk_bf16_f32 v180, v184, v185
    v_cvt_pk_bf16_f32 v181, v186, v187
    v_cvt_pk_bf16_f32 v182, v188, v189
    v_cvt_pk_bf16_f32 v183, v190, v191
    buffer_store_dwordx4 v[176:179], v5, s[12:15], s3 offen offset:0 sc1
    buffer_store_dwordx4 v[180:183], v5, s[12:15], s3 offen offset:1024 sc1
    s_add_u32 s3, s3, 65536
    s_mul_i32 s55, s9, 786432
    s_add_u32 s55, s55, 65798144
    v_and_b32 v28, 63, v0
    s_and_b32 s56, s11, 0xe0
    v_lshrrev_b32 v29, 5, v28
    v_add_u32 v28, s56, v28
    v_and_b32 v28, 255, v28
    v_lshlrev_b32 v28, 10, v28
    v_lshl_add_u32 v28, v29, 8, v28
    s_bfe_u32 s56, s11, 0x20003
    s_and_b32 s57, s11, 7
    s_lshl_b32 s56, s56, 7
    s_lshl_b32 s57, s57, 2
    s_add_u32 s55, s55, s56
    s_add_u32 s55, s55, s57
    v_mov_b32 v29, 159488
    v_mov_b32 v30, 1
    v_mov_b32 v31, s10
    s_mov_b64 exec, 1
    s_waitcnt vmcnt(0)
    ds_add_rtn_u32 v30, v29, v30
    s_waitcnt lgkmcnt(0)
    v_readfirstlane_b32 s56, v30
    s_and_b32 s56, s56, 3
    s_cmp_lg_u32 s56, 3
    s_cbranch_scc1 pub_4
    s_mov_b32 exec_lo, -1
    buffer_store_dword v31, v28, s[12:15], s55 offen sc1
pub_4:
    s_mov_b64 exec, -1
    s_branch c_wo
.p2align 6
h_first:
    s_mov_b32 s16, s46
    s_mov_b32 s17, s47
    s_mov_b32 s18, 256
    s_mov_b32 s19, 0x00020000
    v_mov_b32 v8, 0
    v_mov_b32 v9, 0
    s_memrealtime s[50:51]
    s_cmp_lg_u32 s2, 0
    s_cbranch_scc1 h_first_nonon
    s_waitcnt lgkmcnt(0)
    s_or_b32 s50, s50, 1
    v_mov_b32 v13, s50
    buffer_store_dword v13, v8, s[16:19], 0 offen sc1
h_first_nonon:
    buffer_load_dword v14, v8, s[16:19], 0 offen sc1
    v_mov_b32 v10, 159488
    ds_write_b64 v10, v[8:9]
    ds_write_b32 v10, v8 offset:8
    s_waitcnt lgkmcnt(0)
    s_barrier
    s_sub_u32 s50, s50, 8000
    s_waitcnt vmcnt(0)
    v_readfirstlane_b32 s10, v14
    s_sub_u32 s51, s10, s50
    s_and_b32 s3, s10, 1
    s_cselect_b32 s51, s51, -1
    s_cmp_ge_i32 s51, 0
    s_cbranch_scc1 h_first_non_ok
    s_load_dword s10, s[46:47], 0
    s_mov_b32 s58, 0
    s_waitcnt lgkmcnt(0)
h_first_non:
    s_sub_u32 s51, s10, s50
    s_and_b32 s3, s10, 1
    s_cselect_b32 s51, s51, -1
    s_cmp_ge_i32 s51, 0
    s_cbranch_scc1 h_first_non_ok
    buffer_load_dword v14, v8, s[16:19], 0 offen sc1
    s_waitcnt vmcnt(0)
    v_readfirstlane_b32 s10, v14
    s_add_u32 s58, s58, 1
    s_cmp_gt_u32 s58, 200
    s_cselect_b32 s50, s10, s50
    s_cmp_lt_u32 s58, 0x20000
    s_cbranch_scc1 h_first_non
    s_mov_b32 s10, 1
h_first_non_ok:
    v_mov_b32 v13, s10
    ds_write_b32 v10, v13 offset:4
    s_waitcnt lgkmcnt(0)
    s_barrier
    v_lshlrev_b32 v13, 7, v1
    s_lshl_b32 s50, s2, 13
    s_mov_b32 s28, s36
    s_mov_b32 s29, s37
    s_mov_b32 s30, 2097152
    s_mov_b32 s31, 0x00020000
    buffer_load_dword v14, v13, s[28:31], s50 offen
    s_mov_b32 s9, 0
h_qkvA:
    s_mul_i32 s98, s9, 786432
    s_add_u32 s98, s98, 65273856
    s_lshl_b32 s99, s11, 10
    s_add_u32 s98, s98, s99
    s_add_u32 s96, s4, s98
    s_addc_u32 s97, s5, 0
    s_mov_b32 s98, s10
    s_mov_b32 s99, s10
    v_and_b32 v1, 63, v0
    v_lshlrev_b32 v5, 4, v1
    v_and_b32 v20, 15, v1
    v_lshrrev_b32 v11, 4, v1
    v_min_u32 v11, 2, v11
    v_lshlrev_b32 v21, 3, v20
    v_lshl_add_u32 v12, v11, 7, v21
    v_add_u32 v12, 155648, v12
    v_lshl_add_u32 v11, v11, 16, v21
    v_mov_b32 v10, 159496
    s_add_u32 s3, s9, 1
    v_mov_b32 v13, s3
    s_and_b32 s3, s6, 14
    s_lshl_b32 s3, s3, 2
    s_sub_u32 s3, s3, 1
    s_max_i32 s3, s3, 0
    s_lshl_b32 s3, s3, 16
    s_lshl_b32 s48, s9, 22
    s_add_u32 s3, s3, s48
    s_add_u32 s20, s4, s3
    s_addc_u32 s21, s5, 0
    s_mov_b32 s22, 65536
    s_mov_b32 s23, 0x00020000
    v_bfe_u32 v21, v1, 4, 1
    v_lshl_add_u32 v6, v21, 5, v20
    v_lshlrev_b32 v6, 4, v6
    v_lshrrev_b32 v21, 5, v1
    v_lshl_add_u32 v6, v21, 10, v6
    v_add_u32 v6, 256, v6
    s_mov_b32 s3, 0x20000
poll_5:
    s_load_dwordx8 s[48:55], s[96:97], 0 glc
    s_load_dwordx8 s[56:63], s[96:97], 128 glc
    s_load_dwordx8 s[64:71], s[96:97], 256 glc
    s_load_dwordx8 s[72:79], s[96:97], 384 glc
    s_load_dwordx8 s[80:87], s[96:97], 512 glc
    s_load_dwordx8 s[88:95], s[96:97], 640 glc
    s_sub_u32 s3, s3, 1
    s_cbranch_scc1 poll_5_ok
    s_waitcnt lgkmcnt(0)
    s_xor_b64 s[100:101], s[48:49], s[98:99]
    s_xor_b64 s[48:49], s[50:51], s[98:99]
    s_or_b64 s[100:101], s[100:101], s[48:49]
    s_xor_b64 s[48:49], s[52:53], s[98:99]
    s_or_b64 s[100:101], s[100:101], s[48:49]
    s_xor_b64 s[48:49], s[54:55], s[98:99]
    s_or_b64 s[100:101], s[100:101], s[48:49]
    s_xor_b64 s[48:49], s[56:57], s[98:99]
    s_or_b64 s[100:101], s[100:101], s[48:49]
    s_xor_b64 s[48:49], s[58:59], s[98:99]
    s_or_b64 s[100:101], s[100:101], s[48:49]
    s_xor_b64 s[48:49], s[60:61], s[98:99]
    s_or_b64 s[100:101], s[100:101], s[48:49]
    s_xor_b64 s[48:49], s[62:63], s[98:99]
    s_or_b64 s[100:101], s[100:101], s[48:49]
    s_xor_b64 s[48:49], s[64:65], s[98:99]
    s_or_b64 s[100:101], s[100:101], s[48:49]
    s_xor_b64 s[48:49], s[66:67], s[98:99]
    s_or_b64 s[100:101], s[100:101], s[48:49]
    s_xor_b64 s[48:49], s[68:69], s[98:99]
    s_or_b64 s[100:101], s[100:101], s[48:49]
    s_xor_b64 s[48:49], s[70:71], s[98:99]
    s_or_b64 s[100:101], s[100:101], s[48:49]
    s_xor_b64 s[48:49], s[72:73], s[98:99]
    s_or_b64 s[100:101], s[100:101], s[48:49]
    s_xor_b64 s[48:49], s[74:75], s[98:99]
    s_or_b64 s[100:101], s[100:101], s[48:49]
    s_xor_b64 s[48:49], s[76:77], s[98:99]
    s_or_b64 s[100:101], s[100:101], s[48:49]
    s_xor_b64 s[48:49], s[78:79], s[98:99]
    s_or_b64 s[100:101], s[100:101], s[48:49]
    s_xor_b64 s[48:49], s[80:81], s[98:99]
    s_or_b64 s[100:101], s[100:101], s[48:49]
    s_xor_b64 s[48:49], s[82:83], s[98:99]
    s_or_b64 s[100:101], s[100:101], s[48:49]
    s_xor_b64 s[48:49], s[84:85], s[98:99]
    s_or_b64 s[100:101], s[100:101], s[48:49]
    s_xor_b64 s[48:49], s[86:87], s[98:99]
    s_or_b64 s[100:101], s[100:101], s[48:49]
    s_xor_b64 s[48:49], s[88:89], s[98:99]
    s_or_b64 s[100:101], s[100:101], s[48:49]
    s_xor_b64 s[48:49], s[90:91], s[98:99]
    s_or_b64 s[100:101], s[100:101], s[48:49]
    s_xor_b64 s[48:49], s[92:93], s[98:99]
    s_or_b64 s[100:101], s[100:101], s[48:49]
    s_xor_b64 s[48:49], s[94:95], s[98:99]
    s_or_b64 s[100:101], s[100:101], s[48:49]
    s_cbranch_scc1 poll_5
poll_5_ok:
    s_waitcnt lgkmcnt(0)
    ds_write_b32 v10, v13
    s_mov_b32 m0, 147456
    s_mov_b32 s48, 0
    buffer_load_dwordx4 v6, s[20:23], s48 offen sc1 lds
    s_mov_b32 m0, 148480
    s_mov_b32 s48, 2048
    buffer_load_dwordx4 v6, s[20:23], s48 offen sc1 lds
    s_mov_b32 m0, 149504
    s_mov_b32 s48, 4096
    buffer_load_dwordx4 v6, s[20:23], s48 offen sc1 lds
    s_barrier
    s_mov_b32 m0, 150528
    s_mov_b32 s48, 6144
    buffer_load_dwordx4 v6, s[20:23], s48 offen sc1 lds
    s_mov_b32 m0, 151552
    s_mov_b32 s48, 8192
    buffer_load_dwordx4 v6, s[20:23], s48 offen sc1 lds
    s_mov_b32 m0, 152576
    s_mov_b32 s48, 10240
    buffer_load_dwordx4 v6, s[20:23], s48 offen sc1 lds
    s_mov_b32 m0, 153600
    s_mov_b32 s48, 12288
    buffer_load_dwordx4 v6, s[20:23], s48 offen sc1 lds
    s_lshl_b32 s56, s7, 12
    s_and_b32 s57, s6, 1
    s_lshl_b32 s57, s57, 7
    s_add_u32 s56, s56, s57
    s_add_u32 s56, s56, 63963136
    s_waitcnt vmcnt(4)
    s_barrier
    s_waitcnt vmcnt(0)
    s_barrier
    s_mov_b32 m0, 154624
    s_mov_b32 s48, 14336
    buffer_load_dwordx4 v6, s[20:23], s48 offen sc1 lds
    s_mov_b32 m0, 147456
    s_mov_b32 s48, 16384
    buffer_load_dwordx4 v6, s[20:23], s48 offen sc1 lds
    s_mov_b32 m0, 148480
    s_mov_b32 s48, 18432
    buffer_load_dwordx4 v6, s[20:23], s48 offen sc1 lds
    s_mov_b32 m0, 149504
    s_mov_b32 s48, 20480
    buffer_load_dwordx4 v6, s[20:23], s48 offen sc1 lds
    s_waitcnt vmcnt(0)
    s_barrier
    s_mov_b32 m0, 150528
    s_mov_b32 s48, 22528
    buffer_load_dwordx4 v6, s[20:23], s48 offen sc1 lds
    s_mov_b32 m0, 151552
    s_mov_b32 s48, 24576
    buffer_load_dwordx4 v6, s[20:23], s48 offen sc1 lds
    s_mov_b32 m0, 152576
    s_mov_b32 s48, 26624
    buffer_load_dwordx4 v6, s[20:23], s48 offen sc1 lds
    s_mov_b32 m0, 153600
    s_mov_b32 s48, 28672
    buffer_load_dwordx4 v6, s[20:23], s48 offen sc1 lds
    buffer_load_dwordx2 v[32:33], v11, s[12:15], s56 offen offset:0 sc1
    buffer_load_dwordx2 v[34:35], v11, s[12:15], s56 offen offset:256 sc1
    buffer_load_dwordx2 v[36:37], v11, s[12:15], s56 offen offset:512 sc1
    buffer_load_dwordx2 v[38:39], v11, s[12:15], s56 offen offset:768 sc1
    buffer_load_dwordx2 v[40:41], v11, s[12:15], s56 offen offset:1024 sc1
    buffer_load_dwordx2 v[42:43], v11, s[12:15], s56 offen offset:1280 sc1
    buffer_load_dwordx2 v[44:45], v11, s[12:15], s56 offen offset:1536 sc1
    buffer_load_dwordx2 v[46:47], v11, s[12:15], s56 offen offset:1792 sc1
    buffer_load_dwordx2 v[48:49], v11, s[12:15], s56 offen offset:2048 sc1
    buffer_load_dwordx2 v[50:51], v11, s[12:15], s56 offen offset:2304 sc1
    buffer_load_dwordx2 v[52:53], v11, s[12:15], s56 offen offset:2560 sc1
    buffer_load_dwordx2 v[54:55], v11, s[12:15], s56 offen offset:2816 sc1
    s_waitcnt vmcnt(12)
    s_barrier
    s_mov_b32 m0, 154624
    s_mov_b32 s48, 30720
    buffer_load_dwordx4 v6, s[20:23], s48 offen sc1 lds
    s_mov_b32 m0, 147456
    s_mov_b32 s48, 32768
    buffer_load_dwordx4 v6, s[20:23], s48 offen sc1 lds
    s_mov_b32 m0, 148480
    s_mov_b32 s48, 34816
    buffer_load_dwordx4 v6, s[20:23], s48 offen sc1 lds
    s_mov_b32 m0, 149504
    s_mov_b32 s48, 36864
    buffer_load_dwordx4 v6, s[20:23], s48 offen sc1 lds
    buffer_load_dwordx2 v[56:57], v11, s[12:15], s56 offen offset:3072 sc1
    buffer_load_dwordx2 v[58:59], v11, s[12:15], s56 offen offset:3328 sc1
    buffer_load_dwordx2 v[60:61], v11, s[12:15], s56 offen offset:3584 sc1
    buffer_load_dwordx2 v[62:63], v11, s[12:15], s56 offen offset:3840 sc1
    s_waitcnt vmcnt(4)
    s_barrier
    s_mov_b32 m0, 150528
    s_mov_b32 s48, 38912
    buffer_load_dwordx4 v6, s[20:23], s48 offen sc1 lds
    s_mov_b32 m0, 151552
    s_mov_b32 s48, 40960
    buffer_load_dwordx4 v6, s[20:23], s48 offen sc1 lds
    s_mov_b32 m0, 152576
    s_mov_b32 s48, 43008
    buffer_load_dwordx4 v6, s[20:23], s48 offen sc1 lds
    s_mov_b32 m0, 153600
    s_mov_b32 s48, 45056
    buffer_load_dwordx4 v6, s[20:23], s48 offen sc1 lds
    s_waitcnt vmcnt(4)
    v_add_f32 v32, v32, v48
    v_add_f32 v33, v33, v49
    v_add_f32 v34, v34, v50
    v_add_f32 v35, v35, v51
    v_add_f32 v36, v36, v52
    v_add_f32 v37, v37, v53
    v_add_f32 v38, v38, v54
    v_add_f32 v39, v39, v55
    v_add_f32 v40, v40, v56
    v_add_f32 v41, v41, v57
    v_add_f32 v42, v42, v58
    v_add_f32 v43, v43, v59
    s_waitcnt vmcnt(0)
    s_barrier
    s_mov_b32 m0, 154624
    s_mov_b32 s48, 47104
    buffer_load_dwordx4 v6, s[20:23], s48 offen sc1 lds
    s_mov_b32 m0, 147456
    s_mov_b32 s48, 49152
    buffer_load_dwordx4 v6, s[20:23], s48 offen sc1 lds
    s_mov_b32 m0, 148480
    s_mov_b32 s48, 51200
    buffer_load_dwordx4 v6, s[20:23], s48 offen sc1 lds
    s_mov_b32 m0, 149504
    s_mov_b32 s48, 53248
    buffer_load_dwordx4 v6, s[20:23], s48 offen sc1 lds
    v_add_f32 v44, v44, v60
    v_add_f32 v45, v45, v61
    v_add_f32 v46, v46, v62
    v_add_f32 v47, v47, v63
    v_add_f32 v32, v32, v40
    v_add_f32 v33, v33, v41
    v_add_f32 v34, v34, v42
    v_add_f32 v35, v35, v43
    v_add_f32 v36, v36, v44
    v_add_f32 v37, v37, v45
    v_add_f32 v38, v38, v46
    v_add_f32 v39, v39, v47
    s_waitcnt vmcnt(0)
    s_barrier
    s_mov_b32 m0, 150528
    s_mov_b32 s48, 55296
    buffer_load_dwordx4 v6, s[20:23], s48 offen sc1 lds
    s_mov_b32 m0, 151552
    s_mov_b32 s48, 57344
    buffer_load_dwordx4 v6, s[20:23], s48 offen sc1 lds
    s_mov_b32 m0, 152576
    s_mov_b32 s48, 59392
    buffer_load_dwordx4 v6, s[20:23], s48 offen sc1 lds
    s_mov_b32 m0, 153600
    s_mov_b32 s48, 61440
    buffer_load_dwordx4 v6, s[20:23], s48 offen sc1 lds
    v_add_f32 v32, v32, v36
    v_add_f32 v33, v33, v37
    v_add_f32 v34, v34, v38
    v_add_f32 v35, v35, v39
    v_add_f32 v32, v32, v34
    v_add_f32 v33, v33, v35
    ds_write_b64 v12, v[32:33]
    s_waitcnt lgkmcnt(0)
    s_waitcnt vmcnt(0)
    s_barrier
    s_mov_b32 m0, 154624
    s_mov_b32 s48, 63488
    buffer_load_dwordx4 v6, s[20:23], s48 offen sc1 lds
    s_waitcnt vmcnt(0)
    s_barrier
    s_barrier
    s_branch h_wo
h_qkvB:
    s_mul_i32 s98, s9, 786432
    s_add_u32 s98, s98, 65273856
    s_lshl_b32 s99, s11, 10
    s_add_u32 s98, s98, s99
    s_add_u32 s96, s4, s98
    s_addc_u32 s97, s5, 0
    s_mov_b32 s98, s10
    s_mov_b32 s99, s10
    v_and_b32 v1, 63, v0
    v_lshlrev_b32 v5, 4, v1
    v_and_b32 v20, 15, v1
    v_lshrrev_b32 v11, 4, v1
    v_min_u32 v11, 2, v11
    v_lshlrev_b32 v21, 3, v20
    v_lshl_add_u32 v12, v11, 7, v21
    v_add_u32 v12, 156032, v12
    v_lshl_add_u32 v11, v11, 16, v21
    v_mov_b32 v10, 159496
    s_add_u32 s3, s9, 1
    v_mov_b32 v13, s3
    s_mov_b32 s3, 0x20000
poll_6:
    s_load_dwordx8 s[64:71], s[96:97], 0 glc
    s_load_dwordx8 s[72:79], s[96:97], 128 glc
    s_load_dwordx8 s[80:87], s[96:97], 256 glc
    s_load_dwordx8 s[88:95], s[96:97], 384 glc
    s_sub_u32 s3, s3, 1
    s_cbranch_scc1 poll_6_ok
    s_waitcnt lgkmcnt(0)
    s_xor_b64 s[100:101], s[64:65], s[98:99]
    s_xor_b64 s[64:65], s[66:67], s[98:99]
    s_or_b64 s[100:101], s[100:101], s[64:65]
    s_xor_b64 s[64:65], s[68:69], s[98:99]
    s_or_b64 s[100:101], s[100:101], s[64:65]
    s_xor_b64 s[64:65], s[70:71], s[98:99]
    s_or_b64 s[100:101], s[100:101], s[64:65]
    s_xor_b64 s[64:65], s[72:73], s[98:99]
    s_or_b64 s[100:101], s[100:101], s[64:65]
    s_xor_b64 s[64:65], s[74:75], s[98:99]
    s_or_b64 s[100:101], s[100:101], s[64:65]
    s_xor_b64 s[64:65], s[76:77], s[98:99]
    s_or_b64 s[100:101], s[100:101], s[64:65]
    s_xor_b64 s[64:65], s[78:79], s[98:99]
    s_or_b64 s[100:101], s[100:101], s[64:65]
    s_xor_b64 s[64:65], s[80:81], s[98:99]
    s_or_b64 s[100:101], s[100:101], s[64:65]
    s_xor_b64 s[64:65], s[82:83], s[98:99]
    s_or_b64 s[100:101], s[100:101], s[64:65]
    s_xor_b64 s[64:65], s[84:85], s[98:99]
    s_or_b64 s[100:101], s[100:101], s[64:65]
    s_xor_b64 s[64:65], s[86:87], s[98:99]
    s_or_b64 s[100:101], s[100:101], s[64:65]
    s_xor_b64 s[64:65], s[88:89], s[98:99]
    s_or_b64 s[100:101], s[100:101], s[64:65]
    s_xor_b64 s[64:65], s[90:91], s[98:99]
    s_or_b64 s[100:101], s[100:101], s[64:65]
    s_xor_b64 s[64:65], s[92:93], s[98:99]
    s_or_b64 s[100:101], s[100:101], s[64:65]
    s_xor_b64 s[64:65], s[94:95], s[98:99]
    s_or_b64 s[100:101], s[100:101], s[64:65]
    s_cbranch_scc1 poll_6
poll_6_ok:
    s_waitcnt lgkmcnt(0)
    ds_write_b32 v10, v13
    s_barrier
    s_lshl_b32 s56, s7, 12
    s_and_b32 s57, s6, 1
    s_lshl_b32 s57, s57, 7
    s_add_u32 s56, s56, s57
    s_add_u32 s56, s56, 64159744
    s_barrier
    s_barrier
    s_barrier
    buffer_load_dwordx2 v[32:33], v11, s[12:15], s56 offen offset:0 sc1
    buffer_load_dwordx2 v[34:35], v11, s[12:15], s56 offen offset:256 sc1
    buffer_load_dwordx2 v[36:37], v11, s[12:15], s56 offen offset:512 sc1
    buffer_load_dwordx2 v[38:39], v11, s[12:15], s56 offen offset:768 sc1
    buffer_load_dwordx2 v[40:41], v11, s[12:15], s56 offen offset:1024 sc1
    buffer_load_dwordx2 v[42:43], v11, s[12:15], s56 offen offset:1280 sc1
    buffer_load_dwordx2 v[44:45], v11, s[12:15], s56 offen offset:1536 sc1
    buffer_load_dwordx2 v[46:47], v11, s[12:15], s56 offen offset:1792 sc1
    buffer_load_dwordx2 v[48:49], v11, s[12:15], s56 offen offset:2048 sc1
    buffer_load_dwordx2 v[50:51], v11, s[12:15], s56 offen offset:2304 sc1
    buffer_load_dwordx2 v[52:53], v11, s[12:15], s56 offen offset:2560 sc1
    buffer_load_dwordx2 v[54:55], v11, s[12:15], s56 offen offset:2816 sc1
    s_barrier
    buffer_load_dwordx2 v[56:57], v11, s[12:15], s56 offen offset:3072 sc1
    buffer_load_dwordx2 v[58:59], v11, s[12:15], s56 offen offset:3328 sc1
    buffer_load_dwordx2 v[60:61], v11, s[12:15], s56 offen offset:3584 sc1
    buffer_load_dwordx2 v[62:63], v11, s[12:15], s56 offen offset:3840 sc1
    s_barrier
    s_waitcnt vmcnt(0)
    v_add_f32 v32, v32, v48
    v_add_f32 v33, v33, v49
    v_add_f32 v34, v34, v50
    v_add_f32 v35, v35, v51
    v_add_f32 v36, v36, v52
    v_add_f32 v37, v37, v53
    v_add_f32 v38, v38, v54
    v_add_f32 v39, v39, v55
    v_add_f32 v40, v40, v56
    v_add_f32 v41, v41, v57
    v_add_f32 v42, v42, v58
    v_add_f32 v43, v43, v59
    s_barrier
    v_add_f32 v44, v44, v60
    v_add_f32 v45, v45, v61
    v_add_f32 v46, v46, v62
    v_add_f32 v47, v47, v63
    v_add_f32 v32, v32, v40
    v_add_f32 v33, v33, v41
    v_add_f32 v34, v34, v42
    v_add_f32 v35, v35, v43
    v_add_f32 v36, v36, v44
    v_add_f32 v37, v37, v45
    v_add_f32 v38, v38, v46
    v_add_f32 v39, v39, v47
    s_barrier
    v_add_f32 v32, v32, v36
    v_add_f32 v33, v33, v37
    v_add_f32 v34, v34, v38
    v_add_f32 v35, v35, v39
    v_add_f32 v32, v32, v34
    v_add_f32 v33, v33, v35
    ds_write_b64 v12, v[32:33]
    s_waitcnt lgkmcnt(0)
    s_barrier
    s_barrier
    s_branch s_attn
.p2align 6
l_first:
    s_sub_u32 s51, s8, 5
    s_lshl_b32 s61, s51, 8
    s_add_u32 s61, s61, s2
    s_and_b32 s62, s61, 15
    s_lshr_b32 s63, s61, 4
    v_lshrrev_b32 v20, 3, v1
    v_mul_u32_u24 v12, 6144, v20
    v_and_b32 v21, 7, v1
    v_lshl_add_u32 v12, v21, 4, v12
    s_mov_b32 s20, s34
    s_mov_b32 s21, s35
    s_mov_b32 s22, 6291456
    s_mov_b32 s23, 0x00020000
    s_mov_b32 s28, s40
    s_mov_b32 s29, s41
    s_mov_b32 s30, 6291456
    s_mov_b32 s31, 0x00020000
    s_mul_i32 s52, s62, 393216
    s_lshl_b32 s56, s63, 7
    s_add_u32 s52, s52, s56
    s_barrier
    s_add_u32 s53, s52, 0
    buffer_load_dwordx4 v[136:139], v12, s[20:23], s53 offen
    s_add_u32 s53, s52, 49152
    buffer_load_dwordx4 v[140:143], v12, s[20:23], s53 offen
    v_lshlrev_b32 v14, 6, v20
    v_lshrrev_b32 v22, 5, v1
    v_bfe_u32 v23, v1, 1, 1
    v_xor_b32 v22, v22, v23
    v_lshl_add_u32 v14, v22, 5, v14
    v_and_b32 v22, 1, v1
    v_lshl_add_u32 v14, v22, 4, v14
    v_bfe_u32 v23, v1, 2, 1
    v_mul_u32_u24 v23, 196608, v23
    v_add_u32 v14, v14, v23
    v_lshlrev_b32 v22, 4, v22
    v_mov_b32 v23, 0x3f80
    v_lshlrev_b32 v23, v22, v23
    v_bfe_u32 v22, v1, 1, 3
    v_cmp_eq_u32 vcc, 0, v22
    s_nop 1
    v_cndmask_b32 v24, 0, v23, vcc
    v_cmp_eq_u32 vcc, 1, v22
    s_nop 1
    v_cndmask_b32 v25, 0, v23, vcc
    v_cmp_eq_u32 vcc, 2, v22
    s_nop 1
    v_cndmask_b32 v26, 0, v23, vcc
    v_cmp_eq_u32 vcc, 3, v22
    s_nop 1
    v_cndmask_b32 v27, 0, v23, vcc
    v_lshlrev_b32 v15, 5, v21
    v_and_b32 v22, 16, v1
    v_add_u32 v15, v15, v22
    v_lshlrev_b32 v16, 14, v1
    v_mov_b32 v9, 159492
    s_mov_b32 s9, 0
    s_lshr_b32 s55, s63, 4
    s_and_b32 s56, s63, 15
    s_mul_i32 s57, s56, 6
    s_add_u32 s57, s57, s55
    s_lshl_b32 s57, s57, 16
    s_lshl_b32 s58, s62, 12
    s_add_u32 s57, s57, s58
    s_add_u32 s57, s57, 50331648
    s_lshl_b32 s54, s61, 8
    s_add_u32 s54, s54, 63963136
    s_lshl_b32 s56, s56, 10
    s_lshl_b32 s55, s55, 7
    s_add_u32 s55, s55, s56
    s_lshl_b32 s56, s62, 2
    s_add_u32 s55, s55, s56
    s_add_u32 s55, s55, 64487424
    s_waitcnt vmcnt(1)
    s_add_u32 s53, s52, 98304
    buffer_load_dwordx4 v[144:147], v12, s[20:23], s53 offen
    s_add_u32 s53, s52, 147456
    buffer_load_dwordx4 v[148:151], v12, s[20:23], s53 offen
    s_add_u32 s53, s52, 196608
    buffer_load_dwordx4 v[152:155], v12, s[20:23], s53 offen
    buffer_store_dwordx4 v[136:139], v14, s[12:15], s57 offen offset:0 sc1
    v_mfma_f32_16x16x32_bf16 v[28:31], v[24:27], v[136:139], 0
    s_barrier
    ds_read_b32 v9, v9
    s_waitcnt lgkmcnt(0)
    v_readfirstlane_b32 s10, v9
    s_waitcnt vmcnt(4)
    s_add_u32 s53, s52, 245760
    buffer_load_dwordx4 v[156:159], v12, s[20:23], s53 offen
    buffer_store_dwordx4 v[140:143], v14, s[12:15], s57 offen offset:512 sc1
    v_mfma_f32_16x16x32_bf16 v[28:31], v[24:27], v[140:143], v[28:31]
    s_waitcnt vmcnt(5)
    s_add_u32 s53, s52, 294912
    buffer_load_dwordx4 v[160:163], v12, s[20:23], s53 offen
    buffer_store_dwordx4 v[144:147], v14, s[12:15], s57 offen offset:1024 sc1
    v_mfma_f32_16x16x32_bf16 v[28:31], v[24:27], v[144:147], v[28:31]
    s_waitcnt vmcnt(6)
    s_add_u32 s53, s52, 344064
    buffer_load_dwordx4 v[164:167], v12, s[20:23], s53 offen
    buffer_store_dwordx4 v[148:151], v14, s[12:15], s57 offen offset:1536 sc1
    v_mfma_f32_16x16x32_bf16 v[28:31], v[24:27], v[148:151], v[28:31]
    s_waitcnt vmcnt(7)
    buffer_store_dwordx4 v[152:155], v14, s[12:15], s57 offen offset:2048 sc1
    v_mfma_f32_16x16x32_bf16 v[28:31], v[24:27], v[152:155], v[28:31]
    s_waitcnt vmcnt(6)
    buffer_store_dwordx4 v[156:159], v14, s[12:15], s57 offen offset:2560 sc1
    v_mfma_f32_16x16x32_bf16 v[28:31], v[24:27], v[156:159], v[28:31]
    s_waitcnt vmcnt(5)
    buffer_store_dwordx4 v[160:163], v14, s[12:15], s57 offen offset:3072 sc1
    v_mfma_f32_16x16x32_bf16 v[28:31], v[24:27], v[160:163], v[28:31]
    s_waitcnt vmcnt(4)
    buffer_store_dwordx4 v[164:167], v14, s[12:15], s57 offen offset:3584 sc1
    v_mfma_f32_16x16x32_bf16 v[28:31], v[24:27], v[164:167], v[28:31]
    s_nop 7
    v_add_f32_dpp v28, v28, v28 row_ror:8 row_mask:0xf bank_mask:0xf
    v_add_f32_dpp v29, v29, v29 row_ror:8 row_mask:0xf bank_mask:0xf
    v_add_f32_dpp v30, v30, v30 row_ror:8 row_mask:0xf bank_mask:0xf
    v_add_f32_dpp v31, v31, v31 row_ror:8 row_mask:0xf bank_mask:0xf
    s_mov_b64 exec, 0x00ff00ff
    buffer_store_dwordx4 v[28:31], v15, s[12:15], s54 offen sc1
    s_mov_b64 exec, -1
    s_add_u32 s57, s57, 6291456
    s_add_u32 s54, s54, 196608
    s_add_u32 s53, s52, 0
    buffer_load_dwordx4 v[168:171], v12, s[28:31], s53 offen
    s_add_u32 s53, s52, 49152
    buffer_load_dwordx4 v[172:175], v12, s[28:31], s53 offen
    s_add_u32 s53, s52, 98304
    buffer_load_dwordx4 v[176:179], v12, s[28:31], s53 offen
    s_add_u32 s53, s52, 147456
    buffer_load_dwordx4 v[180:183], v12, s[28:31], s53 offen
    s_add_u32 s53, s52, 196608
    buffer_load_dwordx4 v[184:187], v12, s[28:31], s53 offen
    s_add_u32 s53, s52, 245760
    buffer_load_dwordx4 v[188:191], v12, s[28:31], s53 offen
    s_add_u32 s53, s52, 294912
    buffer_load_dwordx4 v[192:195], v12, s[28:31], s53 offen
    s_add_u32 s53, s52, 344064
    buffer_load_dwordx4 v[196:199], v12, s[28:31], s53 offen
    s_mov_b64 exec, 0xffff
    s_waitcnt vmcnt(8)
    buffer_store_dword v9, v16, s[12:15], s55 offen offset:0 sc1
    s_mov_b64 exec, -1
    s_mov_b32 s60, 1
    s_branch l_qkv2
l_qkv:
    s_mov_b32 s60, 0
l_qkv2:
    v_and_b32 v1, 63, v0
    v_lshlrev_b32 v5, 4, v1
    s_sub_u32 s51, s8, 5
    s_lshl_b32 s48, s51, 13
    s_and_b32 s53, s9, 1
    s_lshl_b32 s52, s53, 4
    s_add_u32 s49, s7, s52
    s_lshl_b32 s49, s49, 1
    s_and_b32 s52, s6, 1
    s_add_u32 s49, s49, s52
    s_mul_i32 s49, s49, 3
    s_add_u32 s49, s49, s51
    s_lshl_b32 s49, s49, 16
    s_add_u32 s49, s49, 50331648
    v_mov_b32 v13, 159496
    s_cmp_lg_u32 s9, 0
    s_cbranch_scc1 l_qkv_tiled
    s_lshl_b32 s53, s8, 7
    s_lshl_b32 s52, s11, 10
    s_add_u32 s53, s53, s52
    s_add_u32 s53, s53, 64486784
    s_add_u32 s96, s4, s53
    s_addc_u32 s97, s5, 0
    s_mov_b32 s98, s10
    s_mov_b32 s99, s10
    s_mov_b32 s3, 0x20000
poll_7:
    s_load_dwordx16 s[80:95], s[96:97], 0 glc
    s_sub_u32 s3, s3, 1
    s_cbranch_scc1 poll_7_ok
    s_waitcnt lgkmcnt(0)
    s_xor_b64 s[100:101], s[80:81], s[98:99]
    s_xor_b64 s[80:81], s[82:83], s[98:99]
    s_or_b64 s[100:101], s[100:101], s[80:81]
    s_xor_b64 s[80:81], s[84:85], s[98:99]
    s_or_b64 s[100:101], s[100:101], s[80:81]
    s_xor_b64 s[80:81], s[86:87], s[98:99]
    s_or_b64 s[100:101], s[100:101], s[80:81]
    s_xor_b64 s[80:81], s[88:89], s[98:99]
    s_or_b64 s[100:101], s[100:101], s[80:81]
    s_xor_b64 s[80:81], s[90:91], s[98:99]
    s_or_b64 s[100:101], s[100:101], s[80:81]
    s_xor_b64 s[80:81], s[92:93], s[98:99]
    s_or_b64 s[100:101], s[100:101], s[80:81]
    s_xor_b64 s[80:81], s[94:95], s[98:99]
    s_or_b64 s[100:101], s[100:101], s[80:81]
    s_cbranch_scc1 poll_7
poll_7_ok:
    s_waitcnt lgkmcnt(0)
l_qkv_tiled:
    s_mov_b32 s50, 0
    s_add_u32 m0, s48, 0
    s_nop 0
    buffer_load_dwordx4 v5, s[12:15], s49 offen offset:0 sc1 lds
    buffer_load_dwordx4 v5, s[12:15], s49 offen offset:1024 sc1 lds
    buffer_load_dwordx4 v5, s[12:15], s49 offen offset:2048 sc1 lds
    buffer_load_dwordx4 v5, s[12:15], s49 offen offset:3072 sc1 lds
    s_add_u32 s49, s49, 4096
    s_add_u32 m0, s48, 4096
    s_nop 0
    buffer_load_dwordx4 v5, s[12:15], s49 offen offset:0 sc1 lds
    buffer_load_dwordx4 v5, s[12:15], s49 offen offset:1024 sc1 lds
    buffer_load_dwordx4 v5, s[12:15], s49 offen offset:2048 sc1 lds
    buffer_load_dwordx4 v5, s[12:15], s49 offen offset:3072 sc1 lds
    s_add_u32 s49, s49, 4096
    s_add_u32 s50, s50, 1
    s_cmp_eq_u32 s50, 6
    s_cselect_b32 s3, 4294819840, 0
    s_add_u32 s48, s48, 24576
    s_add_u32 s48, s48, s3
    v_lshrrev_b32 v10, 4, v1
    v_and_b32 v11, 0xff, v5
    v_lshl_add_u32 v10, v10, 12, v11
    s_lshl_b32 s3, s51, 9
    s_add_u32 s3, s3, 155648
    v_lshl_add_u32 v11, v1, 3, s3
    s_and_b32 s59, s6, 14
    s_add_u32 s59, s59, s51
    s_sub_u32 s59, s59, 1
    s_max_i32 s59, s59, 0
    s_lshl_b32 s59, s59, 14
    s_lshl_b32 s3, s9, 18
    s_add_u32 s59, s59, s3
    s_add_u32 s59, s59, 62914560
    s_and_b32 s3, s9, 1
    s_lshl_b32 s3, s3, 3
    s_add_u32 s3, s3, 56
    s_cmp_eq_u32 s51, 0
    s_cselect_b32 s3, s3, 0
    v_cmp_gt_u32 vcc, s3, v1
    v_mov_b32 v20, 0x7ff00000
    s_nop 0
    v_cndmask_b32 v10, v10, v20, vcc
    s_lshl_b32 s3, s7, 7
    v_lshrrev_b32 v20, 3, v1
    v_lshlrev_b32 v21, 11, v20
    v_lshrrev_b32 v22, 2, v1
    v_lshrrev_b32 v23, 4, v1
    v_xor_b32 v22, v22, v23
    v_and_b32 v22, 1, v22
    v_lshl_add_u32 v21, v22, 6, v21
    v_and_b32 v22, 3, v1
    v_lshl_add_u32 v21, v22, 4, v21
    v_add_u32 v17, s3, v21
    s_add_u32 s52, s9, 1
l_qkv_pre:
    s_add_u32 m0, s48, 0
    s_nop 0
    buffer_load_dwordx4 v5, s[12:15], s49 offen offset:0 sc1 lds
    s_waitcnt vmcnt(10)
    buffer_load_dwordx4 v5, s[12:15], s49 offen offset:1024 sc1 lds
    s_waitcnt vmcnt(10)
    buffer_load_dwordx4 v5, s[12:15], s49 offen offset:2048 sc1 lds
    s_waitcnt vmcnt(10)
    buffer_load_dwordx4 v5, s[12:15], s49 offen offset:3072 sc1 lds
    s_waitcnt vmcnt(10)
    s_add_u32 s49, s49, 4096
    s_add_u32 m0, s48, 4096
    s_nop 0
    buffer_load_dwordx4 v5, s[12:15], s49 offen offset:0 sc1 lds
    s_waitcnt vmcnt(10)
    buffer_load_dwordx4 v5, s[12:15], s49 offen offset:1024 sc1 lds
    s_waitcnt vmcnt(10)
    buffer_load_dwordx4 v5, s[12:15], s49 offen offset:2048 sc1 lds
    s_waitcnt vmcnt(10)
    buffer_load_dwordx4 v5, s[12:15], s49 offen offset:3072 sc1 lds
    s_waitcnt vmcnt(10)
    s_add_u32 s49, s49, 4096
    s_add_u32 s50, s50, 1
    s_cmp_eq_u32 s50, 6
    s_cselect_b32 s3, 4294819840, 0
    s_add_u32 s48, s48, 24576
    s_add_u32 s48, s48, s3
    ds_read_b32 v8, v13
    s_cmp_ge_u32 s50, 6
    s_cbranch_scc1 l_qkv_go
    s_waitcnt lgkmcnt(0)
    v_readfirstlane_b32 s3, v8
    s_cmp_lg_u32 s3, s52
    s_cbranch_scc1 l_qkv_pre
l_qkv_go:
    s_waitcnt vmcnt(8) lgkmcnt(0)
    s_barrier
    s_barrier
    s_cmp_gt_u32 s50, 5
    s_cbranch_scc1 stg_8
    s_add_u32 m0, s48, 0
    s_nop 0
    buffer_load_dwordx4 v5, s[12:15], s49 offen offset:0 sc1 lds
    buffer_load_dwordx4 v5, s[12:15], s49 offen offset:1024 sc1 lds
    buffer_load_dwordx4 v5, s[12:15], s49 offen offset:2048 sc1 lds
    buffer_load_dwordx4 v5, s[12:15], s49 offen offset:3072 sc1 lds
    s_add_u32 s49, s49, 4096
    s_add_u32 m0, s48, 4096
    s_nop 0
    buffer_load_dwordx4 v5, s[12:15], s49 offen offset:0 sc1 lds
    buffer_load_dwordx4 v5, s[12:15], s49 offen offset:1024 sc1 lds
    buffer_load_dwordx4 v5, s[12:15], s49 offen offset:2048 sc1 lds
    buffer_load_dwordx4 v5, s[12:15], s49 offen offset:3072 sc1 lds
    s_add_u32 s49, s49, 4096
    s_add_u32 s50, s50, 1
    s_cmp_eq_u32 s50, 6
    s_cselect_b32 s3, 4294819840, 0
    s_add_u32 s48, s48, 24576
    s_add_u32 s48, s48, s3
stg_8:
    s_waitcnt vmcnt(8)
    s_barrier
    s_cmp_gt_u32 s50, 5
    s_cbranch_scc1 stg_9
    s_add_u32 m0, s48, 0
    s_nop 0
    buffer_load_dwordx4 v5, s[12:15], s49 offen offset:0 sc1 lds
    buffer_load_dwordx4 v5, s[12:15], s49 offen offset:1024 sc1 lds
    buffer_load_dwordx4 v5, s[12:15], s49 offen offset:2048 sc1 lds
    buffer_load_dwordx4 v5, s[12:15], s49 offen offset:3072 sc1 lds
    s_add_u32 s49, s49, 4096
    s_add_u32 m0, s48, 4096
    s_nop 0
    buffer_load_dwordx4 v5, s[12:15], s49 offen offset:0 sc1 lds
    buffer_load_dwordx4 v5, s[12:15], s49 offen offset:1024 sc1 lds
    buffer_load_dwordx4 v5, s[12:15], s49 offen offset:2048 sc1 lds
    buffer_load_dwordx4 v5, s[12:15], s49 offen offset:3072 sc1 lds
    s_add_u32 s49, s49, 4096
    s_add_u32 s50, s50, 1
    s_cmp_eq_u32 s50, 6
    s_cselect_b32 s3, 4294819840, 0
    s_add_u32 s48, s48, 24576
    s_add_u32 s48, s48, s3
stg_9:
    s_cmp_eq_u32 s60, 0
    s_cbranch_scc1 ub_10
    buffer_store_dwordx4 v[168:171], v14, s[12:15], s57 offen offset:0 sc1
    v_mfma_f32_16x16x32_bf16 v[28:31], v[24:27], v[168:171], 0
    buffer_store_dwordx4 v[172:175], v14, s[12:15], s57 offen offset:512 sc1
    v_mfma_f32_16x16x32_bf16 v[28:31], v[24:27], v[172:175], v[28:31]
ub_10:
    buffer_load_dwordx4 v[72:75], v10, s[12:15], s59 offen offset:0 sc1
    buffer_load_dwordx4 v[76:79], v10, s[12:15], s59 offen offset:256 sc1
    buffer_load_dwordx4 v[80:83], v10, s[12:15], s59 offen offset:512 sc1
    buffer_load_dwordx4 v[84:87], v10, s[12:15], s59 offen offset:768 sc1
    buffer_load_dwordx4 v[88:91], v10, s[12:15], s59 offen offset:1024 sc1
    buffer_load_dwordx4 v[92:95], v10, s[12:15], s59 offen offset:1280 sc1
    buffer_load_dwordx4 v[96:99], v10, s[12:15], s59 offen offset:1536 sc1
    buffer_load_dwordx4 v[100:103], v10, s[12:15], s59 offen offset:1792 sc1
    s_waitcnt vmcnt(8)
    s_barrier
    s_cmp_gt_u32 s50, 6
    s_cbranch_scc1 stg_11
    s_add_u32 m0, s48, 0
    s_nop 0
    buffer_load_dwordx4 v5, s[12:15], s49 offen offset:0 sc1 lds
    buffer_load_dwordx4 v5, s[12:15], s49 offen offset:1024 sc1 lds
    buffer_load_dwordx4 v5, s[12:15], s49 offen offset:2048 sc1 lds
    buffer_load_dwordx4 v5, s[12:15], s49 offen offset:3072 sc1 lds
    s_add_u32 s49, s49, 4096
    s_add_u32 m0, s48, 4096
    s_nop 0
    buffer_load_dwordx4 v5, s[12:15], s49 offen offset:0 sc1 lds
    buffer_load_dwordx4 v5, s[12:15], s49 offen offset:1024 sc1 lds
    buffer_load_dwordx4 v5, s[12:15], s49 offen offset:2048 sc1 lds
    buffer_load_dwordx4 v5, s[12:15], s49 offen offset:3072 sc1 lds
    s_add_u32 s49, s49, 4096
    s_add_u32 s50, s50, 1
    s_cmp_eq_u32 s50, 6
    s_cselect_b32 s3, 4294819840, 0
    s_add_u32 s48, s48, 24576
    s_add_u32 s48, s48, s3
stg_11:
    s_cmp_eq_u32 s60, 0
    s_cbranch_scc1 ub_12
    buffer_store_dwordx4 v[176:179], v14, s[12:15], s57 offen offset:1024 sc1
    v_mfma_f32_16x16x32_bf16 v[28:31], v[24:27], v[176:179], v[28:31]
    buffer_store_dwordx4 v[180:183], v14, s[12:15], s57 offen offset:1536 sc1
    v_mfma_f32_16x16x32_bf16 v[28:31], v[24:27], v[180:183], v[28:31]
ub_12:
    buffer_load_dwordx4 v[104:107], v10, s[12:15], s59 offen offset:2048 sc1
    buffer_load_dwordx4 v[108:111], v10, s[12:15], s59 offen offset:2304 sc1
    buffer_load_dwordx4 v[112:115], v10, s[12:15], s59 offen offset:2560 sc1
    buffer_load_dwordx4 v[116:119], v10, s[12:15], s59 offen offset:2816 sc1
    buffer_load_dwordx4 v[120:123], v10, s[12:15], s59 offen offset:3072 sc1
    buffer_load_dwordx4 v[124:127], v10, s[12:15], s59 offen offset:3328 sc1
    buffer_load_dwordx4 v[128:131], v10, s[12:15], s59 offen offset:3584 sc1
    buffer_load_dwordx4 v[132:135], v10, s[12:15], s59 offen offset:3840 sc1
    s_waitcnt vmcnt(8)
    s_barrier
    s_waitcnt vmcnt(0)
    s_cmp_gt_u32 s50, 7
    s_cbranch_scc1 stg_13
    s_add_u32 m0, s48, 0
    s_nop 0
    buffer_load_dwordx4 v5, s[12:15], s49 offen offset:0 sc1 lds
    buffer_load_dwordx4 v5, s[12:15], s49 offen offset:1024 sc1 lds
    buffer_load_dwordx4 v5, s[12:15], s49 offen offset:2048 sc1 lds
    buffer_load_dwordx4 v5, s[12:15], s49 offen offset:3072 sc1 lds
    s_add_u32 s49, s49, 4096
    s_add_u32 m0, s48, 4096
    s_nop 0
    buffer_load_dwordx4 v5, s[12:15], s49 offen offset:0 sc1 lds
    buffer_load_dwordx4 v5, s[12:15], s49 offen offset:1024 sc1 lds
    buffer_load_dwordx4 v5, s[12:15], s49 offen offset:2048 sc1 lds
    buffer_load_dwordx4 v5, s[12:15], s49 offen offset:3072 sc1 lds
    s_add_u32 s49, s49, 4096
    s_add_u32 s50, s50, 1
    s_cmp_eq_u32 s50, 6
    s_cselect_b32 s3, 4294819840, 0
    s_add_u32 s48, s48, 24576
    s_add_u32 s48, s48, s3
stg_13:
    s_cmp_eq_u32 s60, 0
    s_cbranch_scc1 ub_14
    buffer_store_dwordx4 v[184:187], v14, s[12:15], s57 offen offset:2048 sc1
    v_mfma_f32_16x16x32_bf16 v[28:31], v[24:27], v[184:187], v[28:31]
    buffer_store_dwordx4 v[188:191], v14, s[12:15], s57 offen offset:2560 sc1
    v_mfma_f32_16x16x32_bf16 v[28:31], v[24:27], v[188:191], v[28:31]
ub_14:
    v_add_f32 v72, v72, v104
    v_add_f32 v73, v73, v105
    v_add_f32 v74, v74, v106
    v_add_f32 v75, v75, v107
    v_add_f32 v76, v76, v108
    v_add_f32 v77, v77, v109
    v_add_f32 v78, v78, v110
    v_add_f32 v79, v79, v111
    v_add_f32 v80, v80, v112
    v_add_f32 v81, v81, v113
    v_add_f32 v82, v82, v114
    v_add_f32 v83, v83, v115
    v_add_f32 v84, v84, v116
    v_add_f32 v85, v85, v117
    v_add_f32 v86, v86, v118
    v_add_f32 v87, v87, v119
    s_waitcnt vmcnt(8)
    s_barrier
    s_cmp_gt_u32 s50, 7
    s_cbranch_scc1 stg_15
    s_add_u32 m0, s48, 0
    s_nop 0
    buffer_load_dwordx4 v5, s[12:15], s49 offen offset:0 sc1 lds
    buffer_load_dwordx4 v5, s[12:15], s49 offen offset:1024 sc1 lds
    buffer_load_dwordx4 v5, s[12:15], s49 offen offset:2048 sc1 lds
    buffer_load_dwordx4 v5, s[12:15], s49 offen offset:3072 sc1 lds
    s_add_u32 s49, s49, 4096
    s_add_u32 m0, s48, 4096
    s_nop 0
    buffer_load_dwordx4 v5, s[12:15], s49 offen offset:0 sc1 lds
    buffer_load_dwordx4 v5, s[12:15], s49 offen offset:1024 sc1 lds
    buffer_load_dwordx4 v5, s[12:15], s49 offen offset:2048 sc1 lds
    buffer_load_dwordx4 v5, s[12:15], s49 offen offset:3072 sc1 lds
    s_add_u32 s49, s49, 4096
    s_add_u32 s50, s50, 1
    s_cmp_eq_u32 s50, 6
    s_cselect_b32 s3, 4294819840, 0
    s_add_u32 s48, s48, 24576
    s_add_u32 s48, s48, s3
stg_15:
    s_cmp_eq_u32 s60, 0
    s_cbranch_scc1 ub_16
    buffer_store_dwordx4 v[192:195], v14, s[12:15], s57 offen offset:3072 sc1
    v_mfma_f32_16x16x32_bf16 v[28:31], v[24:27], v[192:195], v[28:31]
    buffer_store_dwordx4 v[196:199], v14, s[12:15], s57 offen offset:3584 sc1
    v_mfma_f32_16x16x32_bf16 v[28:31], v[24:27], v[196:199], v[28:31]
ub_16:
    v_add_f32 v88, v88, v120
    v_add_f32 v89, v89, v121
    v_add_f32 v90, v90, v122
    v_add_f32 v91, v91, v123
    v_add_f32 v92, v92, v124
    v_add_f32 v93, v93, v125
    v_add_f32 v94, v94, v126
    v_add_f32 v95, v95, v127
    v_add_f32 v96, v96, v128
    v_add_f32 v97, v97, v129
    v_add_f32 v98, v98, v130
    v_add_f32 v99, v99, v131
    v_add_f32 v100, v100, v132
    v_add_f32 v101, v101, v133
    v_add_f32 v102, v102, v134
    v_add_f32 v103, v103, v135
    s_waitcnt vmcnt(8)
    s_barrier
    s_cmp_gt_u32 s50, 7
    s_cbranch_scc1 stg_17
    s_add_u32 m0, s48, 0
    s_nop 0
    buffer_load_dwordx4 v5, s[12:15], s49 offen offset:0 sc1 lds
    buffer_load_dwordx4 v5, s[12:15], s49 offen offset:1024 sc1 lds
    buffer_load_dwordx4 v5, s[12:15], s49 offen offset:2048 sc1 lds
    buffer_load_dwordx4 v5, s[12:15], s49 offen offset:3072 sc1 lds
    s_add_u32 s49, s49, 4096
    s_add_u32 m0, s48, 4096
    s_nop 0
    buffer_load_dwordx4 v5, s[12:15], s49 offen offset:0 sc1 lds
    buffer_load_dwordx4 v5, s[12:15], s49 offen offset:1024 sc1 lds
    buffer_load_dwordx4 v5, s[12:15], s49 offen offset:2048 sc1 lds
    buffer_load_dwordx4 v5, s[12:15], s49 offen offset:3072 sc1 lds
    s_add_u32 s49, s49, 4096
    s_add_u32 s50, s50, 1
    s_cmp_eq_u32 s50, 6
    s_cselect_b32 s3, 4294819840, 0
    s_add_u32 s48, s48, 24576
    s_add_u32 s48, s48, s3
stg_17:
    s_cmp_eq_u32 s60, 0
    s_cbranch_scc1 ub_18
    v_add_f32_dpp v28, v28, v28 row_ror:8 row_mask:0xf bank_mask:0xf
    v_add_f32_dpp v29, v29, v29 row_ror:8 row_mask:0xf bank_mask:0xf
    v_add_f32_dpp v30, v30, v30 row_ror:8 row_mask:0xf bank_mask:0xf
    v_add_f32_dpp v31, v31, v31 row_ror:8 row_mask:0xf bank_mask:0xf
    s_mov_b64 exec, 0x00ff00ff
    buffer_store_dwordx4 v[28:31], v15, s[12:15], s54 offen sc1
    s_mov_b64 exec, -1
ub_18:
    v_add_f32 v72, v72, v88
    v_add_f32 v73, v73, v89
    v_add_f32 v74, v74, v90
    v_add_f32 v75, v75, v91
    v_add_f32 v76, v76, v92
    v_add_f32 v77, v77, v93
    v_add_f32 v78, v78, v94
    v_add_f32 v79, v79, v95
    v_add_f32 v80, v80, v96
    v_add_f32 v81, v81, v97
    v_add_f32 v82, v82, v98
    v_add_f32 v83, v83, v99
    v_add_f32 v84, v84, v100
    v_add_f32 v85, v85, v101
    v_add_f32 v86, v86, v102
    v_add_f32 v87, v87, v103
    s_waitcnt vmcnt(8)
    s_barrier
    v_add_f32 v72, v72, v80
    v_add_f32 v73, v73, v81
    v_add_f32 v74, v74, v82
    v_add_f32 v75, v75, v83
    v_add_f32 v76, v76, v84
    v_add_f32 v77, v77, v85
    v_add_f32 v78, v78, v86
    v_add_f32 v79, v79, v87
    v_add_f32 v72, v72, v76
    v_add_f32 v73, v73, v77
    v_add_f32 v74, v74, v78
    v_add_f32 v75, v75, v79
    v_mul_f32 v72, 0x3a800000, v72
    v_mul_f32 v74, 0x3a800000, v74
    v_mul_f32 v73, 0x3a800000, v73
    v_mul_f32 v75, 0x3a800000, v75
    s_waitcnt vmcnt(0)
    s_barrier
    s_cmp_eq_u32 s60, 0
    s_cbranch_scc1 ub_19
    s_mov_b64 exec, 0xffff
    buffer_store_dword v9, v16, s[12:15], s55 offen offset:384 sc1
    s_mov_b64 exec, -1
ub_19:
    v_fma_f32 v73, -v72, v72, v73
    v_fma_f32 v75, -v74, v74, v75
    v_max_f32 v73, 0, v73
    v_max_f32 v75, 0, v75
    v_add_f32 v73, 0x3727c5ac, v73
    v_add_f32 v75, 0x3727c5ac, v75
    v_rsq_f32 v73, v73
    v_rsq_f32 v75, v75
    v_swap_b32 v73, v74
    ds_write_b64 v11, v[72:73] offset:768
    ds_write_b64 v11, v[74:75] offset:2304
    s_waitcnt lgkmcnt(0)
    s_barrier
    s_bitcmp1_b32 s9, 0
    s_cbranch_scc1 s_attn
    s_mov_b32 s24, s36
    s_mov_b32 s25, s37
    s_mov_b32 s26, 2097152
    s_mov_b32 s27, 0x00020000
    s_add_u32 s60, s51, 48
wop_20:
    s_lshl_b32 m0, s60, 10
    s_lshl_b32 s3, s60, 14
    buffer_load_dwordx4 v17, s[24:27], s3 offen lds
    s_add_u32 s60, s60, 3
    s_waitcnt vmcnt(7)
    s_cmp_lt_u32 s60, 84
    s_cbranch_scc1 wop_20
    s_barrier
wop_21:
    s_lshl_b32 m0, s60, 10
    s_lshl_b32 s3, s60, 14
    buffer_load_dwordx4 v17, s[24:27], s3 offen lds
    s_add_u32 s60, s60, 3
    s_waitcnt vmcnt(7)
    s_cmp_lt_u32 s60, 128
    s_cbranch_scc1 wop_21
    s_mov_b32 s60, s51
wop_22:
    s_lshl_b32 m0, s60, 10
    s_lshl_b32 s3, s60, 14
    buffer_load_dwordx4 v17, s[24:27], s3 offen lds
    s_add_u32 s60, s60, 3
    s_waitcnt vmcnt(7)
    s_cmp_lt_u32 s60, 48
    s_cbranch_scc1 wop_22
    s_branch l_wo
.p2align 6
h_wo:
    s_mul_i32 s98, s9, 786432
    s_add_u32 s98, s98, 65798144
    s_lshl_b32 s99, s11, 10
    s_add_u32 s98, s98, s99
    s_add_u32 s96, s4, s98
    s_addc_u32 s97, s5, 0
    s_mov_b32 s98, s10
    s_mov_b32 s99, s10
    s_mov_b32 s3, 0x20000
poll_23:
    s_load_dwordx8 s[64:71], s[96:97], 0 glc
    s_load_dwordx8 s[72:79], s[96:97], 128 glc
    s_load_dwordx8 s[80:87], s[96:97], 256 glc
    s_load_dwordx8 s[88:95], s[96:97], 384 glc
    s_sub_u32 s3, s3, 1
    s_cbranch_scc1 poll_23_ok
    s_waitcnt lgkmcnt(0)
    s_xor_b64 s[100:101], s[64:65], s[98:99]
    s_xor_b64 s[64:65], s[66:67], s[98:99]
    s_or_b64 s[100:101], s[100:101], s[64:65]
    s_xor_b64 s[64:65], s[68:69], s[98:99]
    s_or_b64 s[100:101], s[100:101], s[64:65]
    s_xor_b64 s[64:65], s[70:71], s[98:99]
    s_or_b64 s[100:101], s[100:101], s[64:65]
    s_xor_b64 s[64:65], s[72:73], s[98:99]
    s_or_b64 s[100:101], s[100:101], s[64:65]
    s_xor_b64 s[64:65], s[74:75], s[98:99]
    s_or_b64 s[100:101], s[100:101], s[64:65]
    s_xor_b64 s[64:65], s[76:77], s[98:99]
    s_or_b64 s[100:101], s[100:101], s[64:65]
    s_xor_b64 s[64:65], s[78:79], s[98:99]
    s_or_b64 s[100:101], s[100:101], s[64:65]
    s_xor_b64 s[64:65], s[80:81], s[98:99]
    s_or_b64 s[100:101], s[100:101], s[64:65]
    s_xor_b64 s[64:65], s[82:83], s[98:99]
    s_or_b64 s[100:101], s[100:101], s[64:65]
    s_xor_b64 s[64:65], s[84:85], s[98:99]
    s_or_b64 s[100:101], s[100:101], s[64:65]
    s_xor_b64 s[64:65], s[86:87], s[98:99]
    s_or_b64 s[100:101], s[100:101], s[64:65]
    s_xor_b64 s[64:65], s[88:89], s[98:99]
    s_or_b64 s[100:101], s[100:101], s[64:65]
    s_xor_b64 s[64:65], s[90:91], s[98:99]
    s_or_b64 s[100:101], s[100:101], s[64:65]
    s_xor_b64 s[64:65], s[92:93], s[98:99]
    s_or_b64 s[100:101], s[100:101], s[64:65]
    s_xor_b64 s[64:65], s[94:95], s[98:99]
    s_or_b64 s[100:101], s[100:101], s[64:65]
    s_cbranch_scc1 poll_23
poll_23_ok:
    s_waitcnt lgkmcnt(0)
l_wo:
    s_waitcnt vmcnt(0)
    s_barrier
    s_cmp_eq_u32 s8, 4
    s_cbranch_scc1 l_wo_end
    s_cmp_lg_u32 s9, 0
    s_cbranch_scc1 l_wo_end
    s_lshl_b32 s53, s8, 7
    s_lshl_b32 s52, s11, 10
    s_add_u32 s53, s53, s52
    s_add_u32 s53, s53, 64487168
    s_add_u32 s96, s4, s53
    s_addc_u32 s97, s5, 0
    s_mov_b32 s98, s10
    s_mov_b32 s99, s10
    s_mov_b32 s3, 0x20000
poll_24:
    s_load_dwordx16 s[80:95], s[96:97], 0 glc
    s_sub_u32 s3, s3, 1
    s_cbranch_scc1 poll_24_ok
    s_waitcnt lgkmcnt(0)
    s_xor_b64 s[100:101], s[80:81], s[98:99]
    s_xor_b64 s[80:81], s[82:83], s[98:99]
    s_or_b64 s[100:101], s[100:101], s[80:81]
    s_xor_b64 s[80:81], s[84:85], s[98:99]
    s_or_b64 s[100:101], s[100:101], s[80:81]
    s_xor_b64 s[80:81], s[86:87], s[98:99]
    s_or_b64 s[100:101], s[100:101], s[80:81]
    s_xor_b64 s[80:81], s[88:89], s[98:99]
    s_or_b64 s[100:101], s[100:101], s[80:81]
    s_xor_b64 s[80:81], s[90:91], s[98:99]
    s_or_b64 s[100:101], s[100:101], s[80:81]
    s_xor_b64 s[80:81], s[92:93], s[98:99]
    s_or_b64 s[100:101], s[100:101], s[80:81]
    s_xor_b64 s[80:81], s[94:95], s[98:99]
    s_or_b64 s[100:101], s[100:101], s[80:81]
    s_cbranch_scc1 poll_24
poll_24_ok:
    s_waitcnt lgkmcnt(0)
l_wo_end:
    s_barrier
    s_add_u32 s9, s9, 1
    s_cmp_eq_u32 s9, 4
    s_cbranch_scc1 k_exit
    s_cmp_lg_u32 s8, 4
    s_cbranch_scc1 l_qkv
    s_cmp_eq_u32 s9, 2
    s_cbranch_scc1 h_qkvA
    s_branch h_qkvB
.p2align 6
s_attn:
    s_sub_u32 s48, s8, 4
    s_lshl_b32 s3, s7, 7
    v_lshrrev_b32 v20, 3, v1
    v_lshlrev_b32 v21, 11, v20
    v_lshrrev_b32 v22, 2, v1
    v_lshrrev_b32 v23, 4, v1
    v_xor_b32 v22, v22, v23
    v_and_b32 v22, 1, v22
    v_lshl_add_u32 v21, v22, 6, v21
    v_and_b32 v22, 3, v1
    v_lshl_add_u32 v21, v22, 4, v21
    v_add_u32 v7, s3, v21
    s_mov_b32 s24, s42
    s_mov_b32 s25, s43
    s_mov_b32 s26, 2097152
    s_mov_b32 s27, 0x00020000
    s_lshr_b32 s49, s9, 1
    s_lshl_b32 s49, s49, 23
    s_lshl_b32 s52, s7, 19
    s_add_u32 s49, s49, s52
    s_and_b32 s52, s6, 1
    s_lshl_b32 s52, s52, 18
    s_add_u32 s49, s49, s52
    s_add_u32 s49, s49, 33554432
    s_lshr_b32 s61, s6, 1
    s_lshl_b32 s52, s48, 13
    s_add_u32 s53, s52, 81920
    v_add_u32 v8, s53, v5
    s_lshl_b32 s53, s61, 15
    s_add_u32 s52, s52, s53
    s_add_u32 s62, s52, s49
    s_add_u32 s63, s62, 4096
    s_mul_i32 s59, s9, 786432
    s_add_u32 s59, s59, 66322432
    s_and_b32 s52, s11, 31
    s_lshl_b32 s52, s52, 10
    s_add_u32 s59, s59, s52
    s_lshr_b32 s52, s61, 1
    s_lshl_b32 s52, s52, 7
    s_add_u32 s59, s59, s52
    s_and_b32 s52, s61, 1
    s_lshl_b32 s52, s52, 2
    s_add_u32 s52, s52, s48
    s_lshl_b32 s52, s52, 2
    s_add_u32 s59, s59, s52
    v_lshlrev_b32 v20, 15, v1
    v_mov_b32 v21, s10
    s_mul_i32 s54, s9, 786432
    s_add_u32 s54, s54, 66322432
    s_lshl_b32 s55, s11, 10
    s_add_u32 s54, s54, s55
    s_add_u32 s52, s4, s54
    s_addc_u32 s53, s5, 0
    s_mov_b32 s54, s10
    s_mov_b32 s55, s10
    s_lshl_b32 s51, s48, 12
    s_add_u32 s49, s49, s51
    s_add_u32 s51, s51, 81920
    s_mov_b32 s60, s48
    s_barrier
    ds_read_b128 v[32:35], v8 offset:0
    ds_read_b128 v[36:39], v8 offset:1024
    ds_read_b128 v[40:43], v8 offset:2048
    ds_read_b128 v[44:47], v8 offset:3072
    ds_read_b128 v[48:51], v8 offset:4096
    ds_read_b128 v[52:55], v8 offset:5120
    ds_read_b128 v[56:59], v8 offset:6144
    ds_read_b128 v[60:63], v8 offset:7168
    s_waitcnt lgkmcnt(7)
    buffer_store_dwordx4 v[32:35], v5, s[12:15], s62 offen offset:0 sc1
    s_waitcnt lgkmcnt(6)
    buffer_store_dwordx4 v[36:39], v5, s[12:15], s62 offen offset:1024 sc1
    s_waitcnt lgkmcnt(5)
    buffer_store_dwordx4 v[40:43], v5, s[12:15], s62 offen offset:2048 sc1
    s_waitcnt lgkmcnt(4)
    buffer_store_dwordx4 v[44:47], v5, s[12:15], s62 offen offset:3072 sc1
    s_waitcnt lgkmcnt(3)
    buffer_store_dwordx4 v[48:51], v5, s[12:15], s63 offen offset:0 sc1
    s_waitcnt lgkmcnt(2)
    buffer_store_dwordx4 v[52:55], v5, s[12:15], s63 offen offset:1024 sc1
    s_waitcnt lgkmcnt(1)
    buffer_store_dwordx4 v[56:59], v5, s[12:15], s63 offen offset:2048 sc1
    s_waitcnt lgkmcnt(0)
    buffer_store_dwordx4 v[60:63], v5, s[12:15], s63 offen offset:3072 sc1
    s_mov_b64 exec, 0xff
    s_waitcnt vmcnt(0)
    buffer_store_dword v21, v20, s[12:15], s59 offen sc1
    s_mov_b64 exec, -1
    s_add_u32 s62, s61, 1
    s_and_b32 s62, s62, 7
    s_lshl_b32 s50, s62, 15
    s_add_u32 s50, s50, s49
    s_lshr_b32 s63, s62, 1
    s_lshl_b32 s63, s63, 7
    s_and_b32 s62, s62, 1
    s_lshl_b32 s62, s62, 4
    s_add_u32 s62, s62, s63
    s_mov_b32 s58, 0x20000
need_25:
    s_load_dwordx4 s[64:67], s[52:53], s62 glc
    s_sub_u32 s58, s58, 1
    s_cbranch_scc1 need_25_ok
    s_waitcnt lgkmcnt(0)
    s_xor_b64 s[64:65], s[64:65], s[54:55]
    s_xor_b64 s[66:67], s[66:67], s[54:55]
    s_or_b64 s[64:65], s[64:65], s[66:67]
    s_cbranch_scc1 need_25
need_25_ok:
    s_waitcnt lgkmcnt(0)
    s_add_u32 m0, s51, 32768
    s_nop 0
    buffer_load_dwordx4 v5, s[12:15], s50 offen offset:0 sc1 lds
    buffer_load_dwordx4 v5, s[12:15], s50 offen offset:1024 sc1 lds
    buffer_load_dwordx4 v5, s[12:15], s50 offen offset:2048 sc1 lds
    buffer_load_dwordx4 v5, s[12:15], s50 offen offset:3072 sc1 lds
    s_add_u32 s50, s50, 16384
    s_add_u32 m0, s51, 49152
    s_nop 0
    buffer_load_dwordx4 v5, s[12:15], s50 offen offset:0 sc1 lds
    buffer_load_dwordx4 v5, s[12:15], s50 offen offset:1024 sc1 lds
    buffer_load_dwordx4 v5, s[12:15], s50 offen offset:2048 sc1 lds
    buffer_load_dwordx4 v5, s[12:15], s50 offen offset:3072 sc1 lds
    s_add_u32 s50, s50, 16384
    s_waitcnt vmcnt(4)
    s_barrier
    s_add_u32 s62, s61, 2
    s_and_b32 s62, s62, 7
    s_lshl_b32 s50, s62, 15
    s_add_u32 s50, s50, s49
    s_lshr_b32 s63, s62, 1
    s_lshl_b32 s63, s63, 7
    s_and_b32 s62, s62, 1
    s_lshl_b32 s62, s62, 4
    s_add_u32 s62, s62, s63
    s_mov_b32 s58, 0x20000
need_26:
    s_load_dwordx4 s[64:67], s[52:53], s62 glc
    s_sub_u32 s58, s58, 1
    s_cbranch_scc1 need_26_ok
    s_waitcnt lgkmcnt(0)
    s_xor_b64 s[64:65], s[64:65], s[54:55]
    s_xor_b64 s[66:67], s[66:67], s[54:55]
    s_or_b64 s[64:65], s[64:65], s[66:67]
    s_cbranch_scc1 need_26
need_26_ok:
    s_waitcnt lgkmcnt(0)
    s_add_u32 m0, s51, 0
    s_nop 0
    buffer_load_dwordx4 v5, s[12:15], s50 offen offset:0 sc1 lds
    buffer_load_dwordx4 v5, s[12:15], s50 offen offset:1024 sc1 lds
    buffer_load_dwordx4 v5, s[12:15], s50 offen offset:2048 sc1 lds
    buffer_load_dwordx4 v5, s[12:15], s50 offen offset:3072 sc1 lds
    s_add_u32 s50, s50, 16384
    s_waitcnt vmcnt(4)
    s_barrier
    s_add_u32 m0, s51, 16384
    s_nop 0
    buffer_load_dwordx4 v5, s[12:15], s50 offen offset:0 sc1 lds
    buffer_load_dwordx4 v5, s[12:15], s50 offen offset:1024 sc1 lds
    buffer_load_dwordx4 v5, s[12:15], s50 offen offset:2048 sc1 lds
    buffer_load_dwordx4 v5, s[12:15], s50 offen offset:3072 sc1 lds
    s_add_u32 s50, s50, 16384
    s_waitcnt vmcnt(4)
    s_barrier
    s_add_u32 s62, s61, 3
    s_and_b32 s62, s62, 7
    s_lshl_b32 s50, s62, 15
    s_add_u32 s50, s50, s49
    s_lshr_b32 s63, s62, 1
    s_lshl_b32 s63, s63, 7
    s_and_b32 s62, s62, 1
    s_lshl_b32 s62, s62, 4
    s_add_u32 s62, s62, s63
    s_mov_b32 s58, 0x20000
need_27:
    s_load_dwordx4 s[64:67], s[52:53], s62 glc
    s_sub_u32 s58, s58, 1
    s_cbranch_scc1 need_27_ok
    s_waitcnt lgkmcnt(0)
    s_xor_b64 s[64:65], s[64:65], s[54:55]
    s_xor_b64 s[66:67], s[66:67], s[54:55]
    s_or_b64 s[64:65], s[64:65], s[66:67]
    s_cbranch_scc1 need_27
need_27_ok:
    s_waitcnt lgkmcnt(0)
    s_add_u32 m0, s51, 32768
    s_nop 0
    buffer_load_dwordx4 v5, s[12:15], s50 offen offset:0 sc1 lds
    buffer_load_dwordx4 v5, s[12:15], s50 offen offset:1024 sc1 lds
    buffer_load_dwordx4 v5, s[12:15], s50 offen offset:2048 sc1 lds
    buffer_load_dwordx4 v5, s[12:15], s50 offen offset:3072 sc1 lds
    s_add_u32 s50, s50, 16384
    s_lshl_b32 m0, s60, 10
    s_lshl_b32 s3, s60, 14
    buffer_load_dwordx4 v7, s[24:27], s3 offen lds
    s_add_u32 s60, s60, 4
    s_lshl_b32 m0, s60, 10
    s_lshl_b32 s3, s60, 14
    buffer_load_dwordx4 v7, s[24:27], s3 offen lds
    s_add_u32 s60, s60, 4
    s_waitcnt vmcnt(6)
    s_barrier
    s_add_u32 m0, s51, 49152
    s_nop 0
    buffer_load_dwordx4 v5, s[12:15], s50 offen offset:0 sc1 lds
    buffer_load_dwordx4 v5, s[12:15], s50 offen offset:1024 sc1 lds
    buffer_load_dwordx4 v5, s[12:15], s50 offen offset:2048 sc1 lds
    buffer_load_dwordx4 v5, s[12:15], s50 offen offset:3072 sc1 lds
    s_add_u32 s50, s50, 16384
    s_lshl_b32 m0, s60, 10
    s_lshl_b32 s3, s60, 14
    buffer_load_dwordx4 v7, s[24:27], s3 offen lds
    s_add_u32 s60, s60, 4
    s_lshl_b32 m0, s60, 10
    s_lshl_b32 s3, s60, 14
    buffer_load_dwordx4 v7, s[24:27], s3 offen lds
    s_add_u32 s60, s60, 4
    s_waitcnt vmcnt(8)
    s_barrier
    s_add_u32 s62, s61, 4
    s_and_b32 s62, s62, 7
    s_lshl_b32 s50, s62, 15
    s_add_u32 s50, s50, s49
    s_lshr_b32 s63, s62, 1
    s_lshl_b32 s63, s63, 7
    s_and_b32 s62, s62, 1
    s_lshl_b32 s62, s62, 4
    s_add_u32 s62, s62, s63
    s_mov_b32 s58, 0x20000
need_28:
    s_load_dwordx4 s[64:67], s[52:53], s62 glc
    s_sub_u32 s58, s58, 1
    s_cbranch_scc1 need_28_ok
    s_waitcnt lgkmcnt(0)
    s_xor_b64 s[64:65], s[64:65], s[54:55]
    s_xor_b64 s[66:67], s[66:67], s[54:55]
    s_or_b64 s[64:65], s[64:65], s[66:67]
    s_cbranch_scc1 need_28
need_28_ok:
    s_waitcnt lgkmcnt(0)
    s_add_u32 m0, s51, 0
    s_nop 0
    buffer_load_dwordx4 v5, s[12:15], s50 offen offset:0 sc1 lds
    buffer_load_dwordx4 v5, s[12:15], s50 offen offset:1024 sc1 lds
    buffer_load_dwordx4 v5, s[12:15], s50 offen offset:2048 sc1 lds
    buffer_load_dwordx4 v5, s[12:15], s50 offen offset:3072 sc1 lds
    s_add_u32 s50, s50, 16384
    s_lshl_b32 m0, s60, 10
    s_lshl_b32 s3, s60, 14
    buffer_load_dwordx4 v7, s[24:27], s3 offen lds
    s_add_u32 s60, s60, 4
    s_lshl_b32 m0, s60, 10
    s_lshl_b32 s3, s60, 14
    buffer_load_dwordx4 v7, s[24:27], s3 offen lds
    s_add_u32 s60, s60, 4
    s_waitcnt vmcnt(8)
    s_barrier
    s_add_u32 m0, s51, 16384
    s_nop 0
    buffer_load_dwordx4 v5, s[12:15], s50 offen offset:0 sc1 lds
    buffer_load_dwordx4 v5, s[12:15], s50 offen offset:1024 sc1 lds
    buffer_load_dwordx4 v5, s[12:15], s50 offen offset:2048 sc1 lds
    buffer_load_dwordx4 v5, s[12:15], s50 offen offset:3072 sc1 lds
    s_add_u32 s50, s50, 16384
    s_lshl_b32 m0, s60, 10
    s_lshl_b32 s3, s60, 14
    buffer_load_dwordx4 v7, s[24:27], s3 offen lds
    s_add_u32 s60, s60, 4
    s_lshl_b32 m0, s60, 10
    s_lshl_b32 s3, s60, 14
    buffer_load_dwordx4 v7, s[24:27], s3 offen lds
    s_add_u32 s60, s60, 4
    s_waitcnt vmcnt(8)
    s_barrier
    s_add_u32 s62, s61, 5
    s_and_b32 s62, s62, 7
    s_lshl_b32 s50, s62, 15
    s_add_u32 s50, s50, s49
    s_lshr_b32 s63, s62, 1
    s_lshl_b32 s63, s63, 7
    s_and_b32 s62, s62, 1
    s_lshl_b32 s62, s62, 4
    s_add_u32 s62, s62, s63
    s_mov_b32 s58, 0x20000
need_29:
    s_load_dwordx4 s[64:67], s[52:53], s62 glc
    s_sub_u32 s58, s58, 1
    s_cbranch_scc1 need_29_ok
    s_waitcnt lgkmcnt(0)
    s_xor_b64 s[64:65], s[64:65], s[54:55]
    s_xor_b64 s[66:67], s[66:67], s[54:55]
    s_or_b64 s[64:65], s[64:65], s[66:67]
    s_cbranch_scc1 need_29
need_29_ok:
    s_waitcnt lgkmcnt(0)
    s_add_u32 m0, s51, 32768
    s_nop 0
    buffer_load_dwordx4 v5, s[12:15], s50 offen offset:0 sc1 lds
    buffer_load_dwordx4 v5, s[12:15], s50 offen offset:1024 sc1 lds
    buffer_load_dwordx4 v5, s[12:15], s50 offen offset:2048 sc1 lds
    buffer_load_dwordx4 v5, s[12:15], s50 offen offset:3072 sc1 lds
    s_add_u32 s50, s50, 16384
    s_lshl_b32 m0, s60, 10
    s_lshl_b32 s3, s60, 14
    buffer_load_dwordx4 v7, s[24:27], s3 offen lds
    s_add_u32 s60, s60, 4
    s_lshl_b32 m0, s60, 10
    s_lshl_b32 s3, s60, 14
    buffer_load_dwordx4 v7, s[24:27], s3 offen lds
    s_add_u32 s60, s60, 4
    s_waitcnt vmcnt(8)
    s_barrier
    s_add_u32 m0, s51, 49152
    s_nop 0
    buffer_load_dwordx4 v5, s[12:15], s50 offen offset:0 sc1 lds
    buffer_load_dwordx4 v5, s[12:15], s50 offen offset:1024 sc1 lds
    buffer_load_dwordx4 v5, s[12:15], s50 offen offset:2048 sc1 lds
    buffer_load_dwordx4 v5, s[12:15], s50 offen offset:3072 sc1 lds
    s_add_u32 s50, s50, 16384
    s_lshl_b32 m0, s60, 10
    s_lshl_b32 s3, s60, 14
    buffer_load_dwordx4 v7, s[24:27], s3 offen lds
    s_add_u32 s60, s60, 4
    s_lshl_b32 m0, s60, 10
    s_lshl_b32 s3, s60, 14
    buffer_load_dwordx4 v7, s[24:27], s3 offen lds
    s_add_u32 s60, s60, 4
    s_waitcnt vmcnt(8)
    s_barrier
    s_add_u32 s62, s61, 6
    s_and_b32 s62, s62, 7
    s_lshl_b32 s50, s62, 15
    s_add_u32 s50, s50, s49
    s_lshr_b32 s63, s62, 1
    s_lshl_b32 s63, s63, 7
    s_and_b32 s62, s62, 1
    s_lshl_b32 s62, s62, 4
    s_add_u32 s62, s62, s63
    s_mov_b32 s58, 0x20000
need_30:
    s_load_dwordx4 s[64:67], s[52:53], s62 glc
    s_sub_u32 s58, s58, 1
    s_cbranch_scc1 need_30_ok
    s_waitcnt lgkmcnt(0)
    s_xor_b64 s[64:65], s[64:65], s[54:55]
    s_xor_b64 s[66:67], s[66:67], s[54:55]
    s_or_b64 s[64:65], s[64:65], s[66:67]
    s_cbranch_scc1 need_30
need_30_ok:
    s_waitcnt lgkmcnt(0)
    s_add_u32 m0, s51, 0
    s_nop 0
    buffer_load_dwordx4 v5, s[12:15], s50 offen offset:0 sc1 lds
    buffer_load_dwordx4 v5, s[12:15], s50 offen offset:1024 sc1 lds
    buffer_load_dwordx4 v5, s[12:15], s50 offen offset:2048 sc1 lds
    buffer_load_dwordx4 v5, s[12:15], s50 offen offset:3072 sc1 lds
    s_add_u32 s50, s50, 16384
    s_lshl_b32 m0, s60, 10
    s_lshl_b32 s3, s60, 14
    buffer_load_dwordx4 v7, s[24:27], s3 offen lds
    s_add_u32 s60, s60, 4
    s_lshl_b32 m0, s60, 10
    s_lshl_b32 s3, s60, 14
    buffer_load_dwordx4 v7, s[24:27], s3 offen lds
    s_add_u32 s60, s60, 4
    s_waitcnt vmcnt(8)
    s_barrier
    s_add_u32 m0, s51, 16384
    s_nop 0
    buffer_load_dwordx4 v5, s[12:15], s50 offen offset:0 sc1 lds
    buffer_load_dwordx4 v5, s[12:15], s50 offen offset:1024 sc1 lds
    buffer_load_dwordx4 v5, s[12:15], s50 offen offset:2048 sc1 lds
    buffer_load_dwordx4 v5, s[12:15], s50 offen offset:3072 sc1 lds
    s_add_u32 s50, s50, 16384
    s_lshl_b32 m0, s60, 10
    s_lshl_b32 s3, s60, 14
    buffer_load_dwordx4 v7, s[24:27], s3 offen lds
    s_add_u32 s60, s60, 4
    s_lshl_b32 m0, s60, 10
    s_lshl_b32 s3, s60, 14
    buffer_load_dwordx4 v7, s[24:27], s3 offen lds
    s_add_u32 s60, s60, 4
    s_waitcnt vmcnt(8)
    s_barrier
    s_add_u32 s62, s61, 7
    s_and_b32 s62, s62, 7
    s_lshl_b32 s50, s62, 15
    s_add_u32 s50, s50, s49
    s_lshr_b32 s63, s62, 1
    s_lshl_b32 s63, s63, 7
    s_and_b32 s62, s62, 1
    s_lshl_b32 s62, s62, 4
    s_add_u32 s62, s62, s63
    s_mov_b32 s58, 0x20000
need_31:
    s_load_dwordx4 s[64:67], s[52:53], s62 glc
    s_sub_u32 s58, s58, 1
    s_cbranch_scc1 need_31_ok
    s_waitcnt lgkmcnt(0)
    s_xor_b64 s[64:65], s[64:65], s[54:55]
    s_xor_b64 s[66:67], s[66:67], s[54:55]
    s_or_b64 s[64:65], s[64:65], s[66:67]
    s_cbranch_scc1 need_31
need_31_ok:
    s_waitcnt lgkmcnt(0)
    s_add_u32 m0, s51, 32768
    s_nop 0
    buffer_load_dwordx4 v5, s[12:15], s50 offen offset:0 sc1 lds
    buffer_load_dwordx4 v5, s[12:15], s50 offen offset:1024 sc1 lds
    buffer_load_dwordx4 v5, s[12:15], s50 offen offset:2048 sc1 lds
    buffer_load_dwordx4 v5, s[12:15], s50 offen offset:3072 sc1 lds
    s_add_u32 s50, s50, 16384
    s_lshl_b32 m0, s60, 10
    s_lshl_b32 s3, s60, 14
    buffer_load_dwordx4 v7, s[24:27], s3 offen lds
    s_add_u32 s60, s60, 4
    s_lshl_b32 m0, s60, 10
    s_lshl_b32 s3, s60, 14
    buffer_load_dwordx4 v7, s[24:27], s3 offen lds
    s_add_u32 s60, s60, 4
    s_waitcnt vmcnt(8)
    s_barrier
    s_add_u32 m0, s51, 49152
    s_nop 0
    buffer_load_dwordx4 v5, s[12:15], s50 offen offset:0 sc1 lds
    buffer_load_dwordx4 v5, s[12:15], s50 offen offset:1024 sc1 lds
    buffer_load_dwordx4 v5, s[12:15], s50 offen offset:2048 sc1 lds
    buffer_load_dwordx4 v5, s[12:15], s50 offen offset:3072 sc1 lds
    s_add_u32 s50, s50, 16384
    s_lshl_b32 m0, s60, 10
    s_lshl_b32 s3, s60, 14
    buffer_load_dwordx4 v7, s[24:27], s3 offen lds
    s_add_u32 s60, s60, 4
    s_lshl_b32 m0, s60, 10
    s_lshl_b32 s3, s60, 14
    buffer_load_dwordx4 v7, s[24:27], s3 offen lds
    s_add_u32 s60, s60, 4
    s_waitcnt vmcnt(8)
    s_barrier
    s_lshl_b32 m0, s60, 10
    s_lshl_b32 s3, s60, 14
    buffer_load_dwordx4 v7, s[24:27], s3 offen lds
    s_add_u32 s60, s60, 4
    s_lshl_b32 m0, s60, 10
    s_lshl_b32 s3, s60, 14
    buffer_load_dwordx4 v7, s[24:27], s3 offen lds
    s_add_u32 s60, s60, 4
    s_lshl_b32 m0, s60, 10
    s_lshl_b32 s3, s60, 14
    buffer_load_dwordx4 v7, s[24:27], s3 offen lds
    s_add_u32 s60, s60, 4
    s_lshl_b32 m0, s60, 10
    s_lshl_b32 s3, s60, 14
    buffer_load_dwordx4 v7, s[24:27], s3 offen lds
    s_add_u32 s60, s60, 4
    s_waitcnt vmcnt(6)
    s_barrier
    s_lshl_b32 m0, s60, 10
    s_lshl_b32 s3, s60, 14
    buffer_load_dwordx4 v7, s[24:27], s3 offen lds
    s_add_u32 s60, s60, 4
    s_lshl_b32 m0, s60, 10
    s_lshl_b32 s3, s60, 14
    buffer_load_dwordx4 v7, s[24:27], s3 offen lds
    s_add_u32 s60, s60, 4
    s_lshl_b32 m0, s60, 10
    s_lshl_b32 s3, s60, 14
    buffer_load_dwordx4 v7, s[24:27], s3 offen lds
    s_add_u32 s60, s60, 4
    s_lshl_b32 m0, s60, 10
    s_lshl_b32 s3, s60, 14
    buffer_load_dwordx4 v7, s[24:27], s3 offen lds
    s_add_u32 s60, s60, 4
    s_barrier
    s_lshl_b32 m0, s60, 10
    s_lshl_b32 s3, s60, 14
    buffer_load_dwordx4 v7, s[24:27], s3 offen lds
    s_add_u32 s60, s60, 4
    s_lshl_b32 m0, s60, 10
    s_lshl_b32 s3, s60, 14
    buffer_load_dwordx4 v7, s[24:27], s3 offen lds
    s_add_u32 s60, s60, 4
    s_lshl_b32 m0, s60, 10
    s_lshl_b32 s3, s60, 14
    buffer_load_dwordx4 v7, s[24:27], s3 offen lds
    s_add_u32 s60, s60, 4
    s_lshl_b32 m0, s60, 10
    s_lshl_b32 s3, s60, 14
    buffer_load_dwordx4 v7, s[24:27], s3 offen lds
    s_add_u32 s60, s60, 4
    s_cmp_eq_u32 s8, 4
    s_cbranch_scc1 h_wo
    s_branch l_wo
.p2align 6
c_attn_slow:
    s_waitcnt lgkmcnt(0)
    s_lshr_b32 s56, s9, 1
    s_lshl_b32 s56, s56, 23
    s_lshl_b32 s55, s7, 19
    s_add_u32 s56, s56, s55
    s_and_b32 s55, s6, 1
    s_lshl_b32 s55, s55, 18
    s_add_u32 s56, s56, s55
    s_add_u32 s56, s56, 33554432
    v_mov_b32 v28, 0xff800000
    v_mov_b32 v30, 0xff800000
    s_mov_b32 s57, 0
c_attn_slow1:
    s_lshr_b32 s55, s57, 2
    s_lshl_b32 s55, s55, 14
    s_and_b32 s58, s57, 3
    s_lshl_b32 s58, s58, 11
    s_add_u32 s55, s55, s58
    s_add_u32 s55, s55, s56
    buffer_load_dwordx4 v[128:131], v5, s[12:15], s55 offen offset:0 sc1
    buffer_load_dwordx4 v[132:135], v5, s[12:15], s55 offen offset:1024 sc1
    s_waitcnt vmcnt(0)
    v_mfma_f32_32x32x16_bf16 v[64:79], v[128:131], v[8:11], 0
    v_mfma_f32_32x32x16_bf16 v[80:95], v[128:131], v[16:19], 0
    v_mfma_f32_32x32x16_bf16 v[64:79], v[132:135], v[12:15], v[64:79]
    v_mfma_f32_32x32x16_bf16 v[80:95], v[132:135], v[20:23], v[80:95]
    s_nop 10
    v_max3_f32 v28, v28, v64, v65
    v_max3_f32 v28, v28, v66, v67
    v_max3_f32 v28, v28, v68, v69
    v_max3_f32 v28, v28, v70, v71
    v_max3_f32 v28, v28, v72, v73
    v_max3_f32 v28, v28, v74, v75
    v_max3_f32 v28, v28, v76, v77
    v_max3_f32 v28, v28, v78, v79
    v_max3_f32 v30, v30, v80, v81
    v_max3_f32 v30, v30, v82, v83
    v_max3_f32 v30, v30, v84, v85
    v_max3_f32 v30, v30, v86, v87
    v_max3_f32 v30, v30, v88, v89
    v_max3_f32 v30, v30, v90, v91
    v_max3_f32 v30, v30, v92, v93
    v_max3_f32 v30, v30, v94, v95
    s_add_u32 s57, s57, 1
    s_cmp_lt_u32 s57, 64
    s_cbranch_scc1 c_attn_slow1
    v_mov_b32 v29, v28
    s_nop 1
    v_permlane32_swap_b32 v28, v29
    v_max_f32 v28, v28, v29
    v_sub_f32 v96, 0, v28
    v_sub_f32 v97, 0, v28
    v_sub_f32 v98, 0, v28
    v_sub_f32 v99, 0, v28
    v_sub_f32 v100, 0, v28
    v_sub_f32 v101, 0, v28
    v_sub_f32 v102, 0, v28
    v_sub_f32 v103, 0, v28
    v_sub_f32 v104, 0, v28
    v_sub_f32 v105, 0, v28
    v_sub_f32 v106, 0, v28
    v_sub_f32 v107, 0, v28
    v_sub_f32 v108, 0, v28
    v_sub_f32 v109, 0, v28
    v_sub_f32 v110, 0, v28
    v_sub_f32 v111, 0, v28
    v_mov_b32 v160, 0
    v_mov_b32 v161, 0
    v_mov_b32 v162, 0
    v_mov_b32 v163, 0
    v_mov_b32 v164, 0
    v_mov_b32 v165, 0
    v_mov_b32 v166, 0
    v_mov_b32 v167, 0
    v_mov_b32 v168, 0
    v_mov_b32 v169, 0
    v_mov_b32 v170, 0
    v_mov_b32 v171, 0
    v_mov_b32 v172, 0
    v_mov_b32 v173, 0
    v_mov_b32 v174, 0
    v_mov_b32 v175, 0
    v_mov_b32 v192, 0
    v_mov_b32 v193, 0
    v_mov_b32 v194, 0
    v_mov_b32 v195, 0
    v_mov_b32 v31, v30
    s_nop 1
    v_permlane32_swap_b32 v30, v31
    v_max_f32 v30, v30, v31
    v_sub_f32 v112, 0, v30
    v_sub_f32 v113, 0, v30
    v_sub_f32 v114, 0, v30
    v_sub_f32 v115, 0, v30
    v_sub_f32 v116, 0, v30
    v_sub_f32 v117, 0, v30
    v_sub_f32 v118, 0, v30
    v_sub_f32 v119, 0, v30
    v_sub_f32 v120, 0, v30
    v_sub_f32 v121, 0, v30
    v_sub_f32 v122, 0, v30
    v_sub_f32 v123, 0, v30
    v_sub_f32 v124, 0, v30
    v_sub_f32 v125, 0, v30
    v_sub_f32 v126, 0, v30
    v_sub_f32 v127, 0, v30
    v_mov_b32 v176, 0
    v_mov_b32 v177, 0
    v_mov_b32 v178, 0
    v_mov_b32 v179, 0
    v_mov_b32 v180, 0
    v_mov_b32 v181, 0
    v_mov_b32 v182, 0
    v_mov_b32 v183, 0
    v_mov_b32 v184, 0
    v_mov_b32 v185, 0
    v_mov_b32 v186, 0
    v_mov_b32 v187, 0
    v_mov_b32 v188, 0
    v_mov_b32 v189, 0
    v_mov_b32 v190, 0
    v_mov_b32 v191, 0
    v_mov_b32 v196, 0
    v_mov_b32 v197, 0
    v_mov_b32 v198, 0
    v_mov_b32 v199, 0
    s_mov_b32 s57, 0
c_attn_slow2:
    s_lshr_b32 s55, s57, 2
    s_lshl_b32 s55, s55, 14
    s_and_b32 s58, s57, 3
    s_lshl_b32 s58, s58, 11
    s_add_u32 s55, s55, s58
    s_add_u32 s55, s55, s56
    buffer_load_dwordx4 v[128:131], v5, s[12:15], s55 offen offset:0 sc1
    buffer_load_dwordx4 v[132:135], v5, s[12:15], s55 offen offset:1024 sc1
    s_add_u32 s55, s55, 8192
    buffer_load_dwordx4 v[144:147], v5, s[12:15], s55 offen offset:0 sc1
    buffer_load_dwordx4 v[148:151], v5, s[12:15], s55 offen offset:1024 sc1
    s_waitcnt vmcnt(0)
    v_mfma_f32_32x32x16_bf16 v[64:79], v[128:131], v[8:11], v[96:111]
    v_mfma_f32_32x32x16_bf16 v[80:95], v[128:131], v[16:19], v[112:127]
    v_mfma_f32_32x32x16_bf16 v[64:79], v[132:135], v[12:15], v[64:79]
    v_mfma_f32_32x32x16_bf16 v[80:95], v[132:135], v[20:23], v[80:95]
    s_nop 10
    v_exp_f32 v64, v64
    v_exp_f32 v65, v65
    v_exp_f32 v66, v66
    v_exp_f32 v67, v67
    v_exp_f32 v68, v68
    v_exp_f32 v69, v69
    v_exp_f32 v70, v70
    v_exp_f32 v71, v71
    v_exp_f32 v72, v72
    v_exp_f32 v73, v73
    v_exp_f32 v74, v74
    v_exp_f32 v75, v75
    v_exp_f32 v76, v76
    v_exp_f32 v77, v77
    v_exp_f32 v78, v78
    v_exp_f32 v79, v79
    v_exp_f32 v80, v80
    v_exp_f32 v81, v81
    v_exp_f32 v82, v82
    v_exp_f32 v83, v83
    v_exp_f32 v84, v84
    v_exp_f32 v85, v85
    v_exp_f32 v86, v86
    v_exp_f32 v87, v87
    v_exp_f32 v88, v88
    v_exp_f32 v89, v89
    v_exp_f32 v90, v90
    v_exp_f32 v91, v91
    v_exp_f32 v92, v92
    v_exp_f32 v93, v93
    v_exp_f32 v94, v94
    v_exp_f32 v95, v95
    v_smfmac_f32_32x32x32_bf16 v[160:175], v[144:147], v[64:71], v204
    v_smfmac_f32_16x16x64_bf16 v[192:195], v[200:203], v[64:71], v204
    v_smfmac_f32_32x32x32_bf16 v[160:175], v[148:151], v[72:79], v204
    v_smfmac_f32_16x16x64_bf16 v[192:195], v[200:203], v[72:79], v204
    v_smfmac_f32_32x32x32_bf16 v[176:191], v[144:147], v[80:87], v204
    v_smfmac_f32_16x16x64_bf16 v[196:199], v[200:203], v[80:87], v204
    v_smfmac_f32_32x32x32_bf16 v[176:191], v[148:151], v[88:95], v204
    v_smfmac_f32_16x16x64_bf16 v[196:199], v[200:203], v[88:95], v204
    s_add_u32 s57, s57, 1
    s_cmp_lt_u32 s57, 64
    s_nop 15
    s_cbranch_scc1 c_attn_slow2
    s_branch c_attn_fin
    s_endpgm
.section .rodata,"a"
.p2align 6
.amdhsa_kernel interleave_layers__sliding_local_dilated__softmax_full_mha__prompt_kernel
  .amdhsa_next_free_vgpr 256
  .amdhsa_next_free_sgpr 102
  .amdhsa_accum_offset 224
  .amdhsa_group_segment_fixed_size 0
  .amdhsa_kernarg_size 72
  .amdhsa_user_sgpr_count 2
  .amdhsa_user_sgpr_kernarg_segment_ptr 1
  .amdhsa_system_sgpr_workgroup_id_x 1
.end_amdhsa_kernel
```

```asm
; @launch grid=(256,1,1) block=(512,1,1) lds=159744
.amdgcn_target "amdgcn-amd-amdhsa--gfx950"
.text
.globl interleave_layers__sliding_local_dilated__softmax_full_mha__prompt_kernel
.type interleave_layers__sliding_local_dilated__softmax_full_mha__prompt_kernel,@function
.p2align 8
interleave_layers__sliding_local_dilated__softmax_full_mha__prompt_kernel:
    s_cmp_ge_u32 s2, 256
    s_cbranch_scc1 k_exit2
    s_load_dwordx16 s[32:47], s[0:1], 0
    s_load_dwordx2 s[4:5], s[0:1], 64
    v_lshrrev_b32 v2, 6, v0
    v_and_b32 v1, 63, v0
    v_mov_b32 v12, 0
    v_mov_b32 v14, 0
    v_mov_b32 v15, 0
    v_mov_b32 v16, 0
    v_readfirstlane_b32 s8, v2
    s_and_b32 s3, s2, 1
    s_lshl_b32 s3, s3, 3
    s_bfe_u32 s6, s2, 0x30003
    s_add_u32 s6, s3, s6
    s_bfe_u32 s3, s2, 0x20001
    s_lshl_b32 s3, s3, 2
    s_lshr_b32 s7, s2, 6
    s_add_u32 s7, s3, s7
    s_lshl_b32 s11, s6, 4
    s_add_u32 s11, s11, s7
    s_mov_b32 s9, -1
    s_mov_b32 s96, 0
    s_mov_b32 s10, 0
    s_waitcnt lgkmcnt(0)
    s_mov_b32 s12, s4
    s_mov_b32 s13, s5
    s_mov_b32 s14, 71303168
    s_mov_b32 s15, 0x00020000
    s_cmp_lt_u32 s8, 4
    s_cbranch_scc1 c_prep
    s_cmp_eq_u32 s8, 4
    s_cbranch_scc1 h_first
    s_branch l_first
k_exit:
k_exit2:
    s_endpgm
.p2align 6
c_qkvA:
    v_and_b32 v1, 63, v0
    v_lshrrev_b32 v2, 6, v0
    v_lshlrev_b32 v5, 4, v1
    v_lshrrev_b32 v3, 5, v1
    v_and_b32 v4, 15, v0
    v_bfe_u32 v7, v1, 4, 1
    v_lshl_add_u32 v6, v7, 5, v4
    v_lshlrev_b32 v6, 4, v6
    v_lshl_add_u32 v6, v3, 10, v6
    s_lshr_b32 s48, s6, 1
    s_lshl_b32 s48, s48, 2
    s_add_u32 s48, s48, s8
    s_lshl_b32 s55, s48, 17
    s_lshl_b32 s56, s9, 22
    s_add_u32 s55, s55, s56
    s_add_u32 s16, s4, s55
    s_addc_u32 s17, s5, 0
    s_mov_b32 s18, 65536
    s_mov_b32 s19, 0x00020000
    s_add_u32 s56, s55, 65536
    s_add_u32 s20, s4, s56
    s_addc_u32 s21, s5, 0
    s_mov_b32 s22, 65536
    s_mov_b32 s23, 0x00020000
    s_lshl_b32 s49, s7, 12
    s_add_u32 s49, s49, s55
    s_and_b32 s56, s6, 1
    s_lshl_b32 s56, s56, 11
    s_add_u32 s49, s49, s56
    s_add_u32 s49, s49, 16777216
    s_movk_i32 s54, 4096
    v_lshrrev_b32 v16, 2, v4
    v_lshl_add_u32 v18, v7, 2, v16
    v_lshl_add_u32 v18, v3, 4, v18
    v_lshlrev_b32 v18, 6, v18
    v_and_b32 v17, 3, v4
    v_lshl_add_u32 v18, v17, 3, v18
    v_lshl_add_u32 v26, v7, 5, v18
    v_xor_b32 v27, 32, v26
    v_mov_b32 v24, v26
    v_mov_b32 v25, v27
    v_and_b32 v18, 0x30, v1
    v_add_u32 v10, 155648, v18
    v_lshlrev_b32 v11, 2, v4
    v_add_u32 v11, 155648, v11
    v_lshl_add_u32 v8, v2, 8, v11
    v_lshl_add_u32 v9, v2, 8, v10
    s_lshr_b32 s3, s8, 1
    s_and_b32 s55, s8, 1
    s_lshl_b32 s56, s55, 5
    v_xor_b32 v29, s56, v26
    s_lshl_b32 s56, s3, 13
    s_add_u32 s56, s56, 8192
    v_add_u32 v29, s56, v29
    v_mov_b32 v28, v29
    v_add_u32 v30, 147456, v5
    v_lshl_add_u32 v14, v2, 6, v10
    v_lshl_add_u32 v12, v2, 11, v5
    v_add_u32 v12, 131072, v12
    v_lshlrev_b32 v16, 8, v16
    v_lshl_add_u32 v16, v18, 2, v16
    v_lshl_add_u32 v16, v17, 1, v16
    v_add_u32 v16, 1024, v16
    v_cmp_gt_u32 vcc, 2, v2
    s_nop 1
    v_cndmask_b32 v13, v16, v5, vcc
    s_lshl_b32 s56, s55, 3
    s_add_u32 s56, s56, 131072
    v_add_u32 v13, s56, v13
    v_lshrrev_b32 v18, 2, v18
    v_sub_u32 v18, v4, v18
    v_mov_b32 v19, 0xf149f2ca
    v_add_u32 v16, 0x0, v18
    v_and_b32 v16, 0xfffffff1, v16
    v_cmp_eq_u32 vcc, 0, v16
    s_nop 1
    v_cndmask_b32 v196, v19, 0, vcc
    v_add_u32 v16, 0xffffffff, v18
    v_and_b32 v16, 0xfffffff1, v16
    v_cmp_eq_u32 vcc, 0, v16
    s_nop 1
    v_cndmask_b32 v197, v19, 0, vcc
    v_add_u32 v16, 0xfffffffe, v18
    v_and_b32 v16, 0xfffffff1, v16
    v_cmp_eq_u32 vcc, 0, v16
    s_nop 1
    v_cndmask_b32 v198, v19, 0, vcc
    v_add_u32 v16, 0xfffffffd, v18
    v_and_b32 v16, 0xfffffff1, v16
    v_cmp_eq_u32 vcc, 0, v16
    s_nop 1
    v_cndmask_b32 v199, v19, 0, vcc
    v_add_u32 v16, 0x10, v18
    v_and_b32 v16, 0xfffffff1, v16
    v_cmp_eq_u32 vcc, 0, v16
    s_nop 1
    v_cndmask_b32 v200, v19, 0, vcc
    v_add_u32 v16, 0xf, v18
    v_and_b32 v16, 0xfffffff1, v16
    v_cmp_eq_u32 vcc, 0, v16
    s_nop 1
    v_cndmask_b32 v201, v19, 0, vcc
    v_add_u32 v16, 0xe, v18
    v_and_b32 v16, 0xfffffff1, v16
    v_cmp_eq_u32 vcc, 0, v16
    s_nop 1
    v_cndmask_b32 v202, v19, 0, vcc
    v_add_u32 v16, 0xd, v18
    v_and_b32 v16, 0xfffffff1, v16
    v_cmp_eq_u32 vcc, 0, v16
    s_nop 1
    v_cndmask_b32 v203, v19, 0, vcc
    s_cmp_eq_u32 s48, 0
    s_cselect_b64 vcc, -1, 0
    v_cndmask_b32 v204, v200, v19, vcc
    v_cndmask_b32 v205, v201, v19, vcc
    v_cndmask_b32 v206, v202, v19, vcc
    v_cndmask_b32 v207, v203, v19, vcc
    v_mov_b32 v208, 0x3f803f80
    v_mov_b32 v209, 0x3f803f80
    v_mov_b32 v210, 0x3f803f80
    v_mov_b32 v211, 0x3f803f80
    v_mov_b32 v184, 0
    v_mov_b32 v185, 0
    v_mov_b32 v186, 0
    v_mov_b32 v187, 0
    v_mov_b32 v188, 0
    v_mov_b32 v189, 0
    v_mov_b32 v190, 0
    v_mov_b32 v191, 0
    v_mov_b32 v192, 0
    v_mov_b32 v193, 0
    v_mov_b32 v194, 0
    v_mov_b32 v195, 0
    v_mov_b32 v32, 0
    v_mov_b32 v33, 0
    v_mov_b32 v34, 0
    v_mov_b32 v35, 0
    v_mov_b32 v36, 0
    v_mov_b32 v37, 0
    v_mov_b32 v38, 0
    v_mov_b32 v39, 0
    v_mov_b32 v40, 0
    v_mov_b32 v41, 0
    v_mov_b32 v42, 0
    v_mov_b32 v43, 0
    v_mov_b32 v44, 0
    v_mov_b32 v45, 0
    v_mov_b32 v46, 0
    v_mov_b32 v47, 0
    v_mov_b32 v48, 0
    v_mov_b32 v49, 0
    v_mov_b32 v50, 0
    v_mov_b32 v51, 0
    v_mov_b32 v52, 0
    v_mov_b32 v53, 0
    v_mov_b32 v54, 0
    v_mov_b32 v55, 0
    v_mov_b32 v56, 0
    v_mov_b32 v57, 0
    v_mov_b32 v58, 0
    v_mov_b32 v59, 0
    v_mov_b32 v60, 0
    v_mov_b32 v61, 0
    v_mov_b32 v62, 0
    v_mov_b32 v63, 0
    v_mov_b32 v64, 0
    v_mov_b32 v65, 0
    v_mov_b32 v66, 0
    v_mov_b32 v67, 0
    v_mov_b32 v68, 0
    v_mov_b32 v69, 0
    v_mov_b32 v70, 0
    v_mov_b32 v71, 0
    v_mov_b32 v72, 0
    v_mov_b32 v73, 0
    v_mov_b32 v74, 0
    v_mov_b32 v75, 0
    v_mov_b32 v76, 0
    v_mov_b32 v77, 0
    v_mov_b32 v78, 0
    v_mov_b32 v79, 0
    v_mov_b32 v80, 0
    v_mov_b32 v81, 0
    v_mov_b32 v82, 0
    v_mov_b32 v83, 0
    v_mov_b32 v84, 0
    v_mov_b32 v85, 0
    v_mov_b32 v86, 0
    v_mov_b32 v87, 0
    v_mov_b32 v88, 0
    v_mov_b32 v89, 0
    v_mov_b32 v90, 0
    v_mov_b32 v91, 0
    v_mov_b32 v92, 0
    v_mov_b32 v93, 0
    v_mov_b32 v94, 0
    v_mov_b32 v95, 0
    v_mov_b32 v96, 0
    v_mov_b32 v97, 0
    v_mov_b32 v98, 0
    v_mov_b32 v99, 0
    v_mov_b32 v100, 0
    v_mov_b32 v101, 0
    v_mov_b32 v102, 0
    v_mov_b32 v103, 0
    v_mov_b32 v104, 0
    v_mov_b32 v105, 0
    v_mov_b32 v106, 0
    v_mov_b32 v107, 0
    v_mov_b32 v108, 0
    v_mov_b32 v109, 0
    v_mov_b32 v110, 0
    v_mov_b32 v111, 0
    v_mov_b32 v112, 0
    v_mov_b32 v113, 0
    v_mov_b32 v114, 0
    v_mov_b32 v115, 0
    v_mov_b32 v116, 0
    v_mov_b32 v117, 0
    v_mov_b32 v118, 0
    v_mov_b32 v119, 0
    v_mov_b32 v120, 0
    v_mov_b32 v121, 0
    v_mov_b32 v122, 0
    v_mov_b32 v123, 0
    v_mov_b32 v124, 0
    v_mov_b32 v125, 0
    v_mov_b32 v126, 0
    v_mov_b32 v127, 0
    s_mov_b32 s50, 8192
    s_mov_b32 s58, 6144
    s_mov_b32 s51, 12288
    s_mov_b32 s59, 10240
    s_mov_b32 s52, 0
    s_barrier
    buffer_load_dwordx4 a[0:3], v6, s[16:19], 0 offen offset:0 sc1
    buffer_load_dwordx4 a[4:7], v6, s[16:19], 0 offen offset:256 sc1
    buffer_load_dwordx4 a[8:11], v6, s[20:23], 0 offen offset:0 sc1
    buffer_load_dwordx4 a[12:15], v6, s[20:23], 0 offen offset:256 sc1
    ds_read_b64_tr_b16 v[128:129], v24 offset:0
    ds_read_b64_tr_b16 v[130:131], v24 offset:512
    ds_read_b64_tr_b16 v[132:133], v25 offset:0
    ds_read_b64_tr_b16 v[134:135], v25 offset:512
    ds_read_b64_tr_b16 v[136:137], v24 offset:8192
    ds_read_b64_tr_b16 v[138:139], v24 offset:8704
    ds_read_b64_tr_b16 v[140:141], v25 offset:8192
    ds_read_b64_tr_b16 v[142:143], v25 offset:8704
    ds_read_b64_tr_b16 v[144:145], v24 offset:16384
    ds_read_b64_tr_b16 v[146:147], v24 offset:16896
    buffer_load_dwordx4 a[16:19], v6, s[16:19], 0 offen offset:2048 sc1
    buffer_load_dwordx4 a[20:23], v6, s[16:19], 0 offen offset:2304 sc1
    buffer_load_dwordx4 a[24:27], v6, s[20:23], 0 offen offset:2048 sc1
    buffer_load_dwordx4 a[28:31], v6, s[20:23], 0 offen offset:2304 sc1
    buffer_load_dwordx4 v[152:155], v6, s[16:19], s54 offen offset:0 sc1
    buffer_load_dwordx4 v[156:159], v6, s[16:19], s54 offen offset:256 sc1
    buffer_load_dwordx4 v[160:163], v6, s[20:23], s54 offen offset:0 sc1
    buffer_load_dwordx4 v[164:167], v6, s[20:23], s54 offen offset:256 sc1
    buffer_load_dwordx4 v[168:171], v6, s[16:19], s54 offen offset:2048 sc1
    buffer_load_dwordx4 v[172:175], v6, s[16:19], s54 offen offset:2304 sc1
    s_mov_b32 s54, 8
    s_waitcnt vmcnt(12)
    s_barrier
.p2align 3
c_qkvA_loop:
    s_waitcnt vmcnt(12) lgkmcnt(8)
    v_mfma_f32_16x16x32_bf16 v[184:187], v[188:191], v[192:195], v[184:187]
    v_mfma_f32_16x16x32_bf16 v[32:35], v[128:131], a[0:3], v[32:35]
    ds_read_b64_tr_b16 v[148:149], v25 offset:16384
    buffer_load_dwordx4 v[176:179], v6, s[20:23], s58 offen offset:0 sc1
    v_mfma_f32_16x16x32_bf16 v[36:39], v[128:131], a[4:7], v[36:39]
    ds_read_b64_tr_b16 v[150:151], v25 offset:16896
    s_waitcnt lgkmcnt(8)
    v_mfma_f32_16x16x32_bf16 v[52:55], v[132:135], a[4:7], v[52:55]
    v_mfma_f32_16x16x32_bf16 v[48:51], v[132:135], a[0:3], v[48:51]
    ds_read_b64_tr_b16 v[188:189], v28 offset:0
    s_waitcnt lgkmcnt(7)
    v_mfma_f32_16x16x32_bf16 v[64:67], v[136:139], a[0:3], v[64:67]
    v_mfma_f32_16x16x32_bf16 v[68:71], v[136:139], a[4:7], v[68:71]
    ds_read_b64_tr_b16 v[190:191], v28 offset:512
    s_waitcnt lgkmcnt(6)
    v_mfma_f32_16x16x32_bf16 v[84:87], v[140:143], a[4:7], v[84:87]
    buffer_load_dwordx4 v[180:183], v6, s[20:23], s58 offen offset:256 sc1
    v_mfma_f32_16x16x32_bf16 v[80:83], v[140:143], a[0:3], v[80:83]
    ds_read_b128 v[192:195], v30 offset:0
    s_waitcnt lgkmcnt(5)
    v_mfma_f32_16x16x32_bf16 v[96:99], a[0:3], v[144:147], v[96:99]
    v_mfma_f32_16x16x32_bf16 v[100:103], a[4:7], v[144:147], v[100:103]
    s_waitcnt lgkmcnt(3)
    v_mfma_f32_16x16x32_bf16 v[116:119], a[4:7], v[148:151], v[116:119]
    v_mfma_f32_16x16x32_bf16 v[112:115], a[0:3], v[148:151], v[112:115]
    s_waitcnt vmcnt(12)
    v_mfma_f32_16x16x32_bf16 v[40:43], v[128:131], a[8:11], v[40:43]
    buffer_load_dwordx4 a[0:3], v6, s[16:19], s50 offen offset:0 sc1
    v_mfma_f32_16x16x32_bf16 v[44:47], v[128:131], a[12:15], v[44:47]
    v_mfma_f32_16x16x32_bf16 v[60:63], v[132:135], a[12:15], v[60:63]
    ds_read_b64_tr_b16 v[128:129], v24 offset:2048
    v_mfma_f32_16x16x32_bf16 v[56:59], v[132:135], a[8:11], v[56:59]
    ds_read_b64_tr_b16 v[130:131], v24 offset:2560
    v_mfma_f32_16x16x32_bf16 v[72:75], v[136:139], a[8:11], v[72:75]
    ds_read_b64_tr_b16 v[132:133], v25 offset:2048
    v_mfma_f32_16x16x32_bf16 v[76:79], v[136:139], a[12:15], v[76:79]
    ds_read_b64_tr_b16 v[134:135], v25 offset:2560
    v_mfma_f32_16x16x32_bf16 v[92:95], v[140:143], a[12:15], v[92:95]
    ds_read_b64_tr_b16 v[136:137], v24 offset:10240
    buffer_load_dwordx4 a[4:7], v6, s[16:19], s50 offen offset:256 sc1
    v_mfma_f32_16x16x32_bf16 v[88:91], v[140:143], a[8:11], v[88:91]
    ds_read_b64_tr_b16 v[138:139], v24 offset:10752
    v_mfma_f32_16x16x32_bf16 v[104:107], a[8:11], v[144:147], v[104:107]
    ds_read_b64_tr_b16 v[140:141], v25 offset:10240
    v_mfma_f32_16x16x32_bf16 v[108:111], a[12:15], v[144:147], v[108:111]
    ds_read_b64_tr_b16 v[142:143], v25 offset:10752
    v_mfma_f32_16x16x32_bf16 v[124:127], a[12:15], v[148:151], v[124:127]
    ds_read_b64_tr_b16 v[144:145], v24 offset:18432
    v_mfma_f32_16x16x32_bf16 v[120:123], a[8:11], v[148:151], v[120:123]
    ds_read_b64_tr_b16 v[146:147], v24 offset:18944
    s_waitcnt vmcnt(12) lgkmcnt(8)
    v_mfma_f32_16x16x32_bf16 v[184:187], v[188:191], v[192:195], v[184:187]
    v_mfma_f32_16x16x32_bf16 v[32:35], v[128:131], a[16:19], v[32:35]
    ds_read_b64_tr_b16 v[148:149], v25 offset:18432
    buffer_load_dwordx4 a[8:11], v6, s[20:23], s58 offen offset:2048 sc1
    v_mfma_f32_16x16x32_bf16 v[36:39], v[128:131], a[20:23], v[36:39]
    ds_read_b64_tr_b16 v[150:151], v25 offset:18944
    s_waitcnt lgkmcnt(8)
    v_mfma_f32_16x16x32_bf16 v[52:55], v[132:135], a[20:23], v[52:55]
    v_mfma_f32_16x16x32_bf16 v[48:51], v[132:135], a[16:19], v[48:51]
    ds_read_b64_tr_b16 v[188:189], v28 offset:2048
    s_waitcnt lgkmcnt(7)
    v_mfma_f32_16x16x32_bf16 v[64:67], v[136:139], a[16:19], v[64:67]
    v_mfma_f32_16x16x32_bf16 v[68:71], v[136:139], a[20:23], v[68:71]
    ds_read_b64_tr_b16 v[190:191], v28 offset:2560
    s_waitcnt lgkmcnt(6)
    v_mfma_f32_16x16x32_bf16 v[84:87], v[140:143], a[20:23], v[84:87]
    buffer_load_dwordx4 a[12:15], v6, s[20:23], s58 offen offset:2304 sc1
    v_mfma_f32_16x16x32_bf16 v[80:83], v[140:143], a[16:19], v[80:83]
    ds_read_b128 v[192:195], v30 offset:1024
    s_waitcnt lgkmcnt(5)
    v_mfma_f32_16x16x32_bf16 v[96:99], a[16:19], v[144:147], v[96:99]
    v_mfma_f32_16x16x32_bf16 v[100:103], a[20:23], v[144:147], v[100:103]
    s_waitcnt lgkmcnt(3)
    v_mfma_f32_16x16x32_bf16 v[116:119], a[20:23], v[148:151], v[116:119]
    v_mfma_f32_16x16x32_bf16 v[112:115], a[16:19], v[148:151], v[112:115]
    s_waitcnt vmcnt(12)
    v_mfma_f32_16x16x32_bf16 v[40:43], v[128:131], a[24:27], v[40:43]
    buffer_load_dwordx4 a[16:19], v6, s[16:19], s50 offen offset:2048 sc1
    v_mfma_f32_16x16x32_bf16 v[44:47], v[128:131], a[28:31], v[44:47]
    v_mfma_f32_16x16x32_bf16 v[60:63], v[132:135], a[28:31], v[60:63]
    ds_read_b64_tr_b16 v[128:129], v24 offset:4096
    v_mfma_f32_16x16x32_bf16 v[56:59], v[132:135], a[24:27], v[56:59]
    ds_read_b64_tr_b16 v[130:131], v24 offset:4608
    v_mfma_f32_16x16x32_bf16 v[72:75], v[136:139], a[24:27], v[72:75]
    ds_read_b64_tr_b16 v[132:133], v25 offset:4096
    v_mfma_f32_16x16x32_bf16 v[76:79], v[136:139], a[28:31], v[76:79]
    ds_read_b64_tr_b16 v[134:135], v25 offset:4608
    v_mfma_f32_16x16x32_bf16 v[92:95], v[140:143], a[28:31], v[92:95]
    ds_read_b64_tr_b16 v[136:137], v24 offset:12288
    buffer_load_dwordx4 a[20:23], v6, s[16:19], s50 offen offset:2304 sc1
    v_mfma_f32_16x16x32_bf16 v[88:91], v[140:143], a[24:27], v[88:91]
    ds_read_b64_tr_b16 v[138:139], v24 offset:12800
    v_mfma_f32_16x16x32_bf16 v[104:107], a[24:27], v[144:147], v[104:107]
    ds_read_b64_tr_b16 v[140:141], v25 offset:12288
    v_mfma_f32_16x16x32_bf16 v[108:111], a[28:31], v[144:147], v[108:111]
    ds_read_b64_tr_b16 v[142:143], v25 offset:12800
    v_mfma_f32_16x16x32_bf16 v[124:127], a[28:31], v[148:151], v[124:127]
    ds_read_b64_tr_b16 v[144:145], v24 offset:20480
    v_mfma_f32_16x16x32_bf16 v[120:123], a[24:27], v[148:151], v[120:123]
    ds_read_b64_tr_b16 v[146:147], v24 offset:20992
    s_waitcnt vmcnt(12) lgkmcnt(8)
    v_mfma_f32_16x16x32_bf16 v[184:187], v[188:191], v[192:195], v[184:187]
    v_mfma_f32_16x16x32_bf16 v[32:35], v[128:131], v[152:155], v[32:35]
    ds_read_b64_tr_b16 v[148:149], v25 offset:20480
    buffer_load_dwordx4 a[24:27], v6, s[20:23], s59 offen offset:0 sc1
    v_mfma_f32_16x16x32_bf16 v[36:39], v[128:131], v[156:159], v[36:39]
    ds_read_b64_tr_b16 v[150:151], v25 offset:20992
    s_waitcnt lgkmcnt(8)
    v_mfma_f32_16x16x32_bf16 v[52:55], v[132:135], v[156:159], v[52:55]
    v_mfma_f32_16x16x32_bf16 v[48:51], v[132:135], v[152:155], v[48:51]
    ds_read_b64_tr_b16 v[188:189], v28 offset:4096
    s_waitcnt lgkmcnt(7)
    v_mfma_f32_16x16x32_bf16 v[64:67], v[136:139], v[152:155], v[64:67]
    v_mfma_f32_16x16x32_bf16 v[68:71], v[136:139], v[156:159], v[68:71]
    ds_read_b64_tr_b16 v[190:191], v28 offset:4608
    s_waitcnt lgkmcnt(6)
    v_mfma_f32_16x16x32_bf16 v[84:87], v[140:143], v[156:159], v[84:87]
    buffer_load_dwordx4 a[28:31], v6, s[20:23], s59 offen offset:256 sc1
    v_mfma_f32_16x16x32_bf16 v[80:83], v[140:143], v[152:155], v[80:83]
    ds_read_b128 v[192:195], v30 offset:2048
    s_waitcnt lgkmcnt(5)
    v_mfma_f32_16x16x32_bf16 v[96:99], v[152:155], v[144:147], v[96:99]
    v_mfma_f32_16x16x32_bf16 v[100:103], v[156:159], v[144:147], v[100:103]
    s_waitcnt lgkmcnt(3)
    v_mfma_f32_16x16x32_bf16 v[116:119], v[156:159], v[148:151], v[116:119]
    v_mfma_f32_16x16x32_bf16 v[112:115], v[152:155], v[148:151], v[112:115]
    s_waitcnt vmcnt(12)
    v_mfma_f32_16x16x32_bf16 v[40:43], v[128:131], v[160:163], v[40:43]
    buffer_load_dwordx4 v[152:155], v6, s[16:19], s51 offen offset:0 sc1
    v_mfma_f32_16x16x32_bf16 v[44:47], v[128:131], v[164:167], v[44:47]
    v_mfma_f32_16x16x32_bf16 v[60:63], v[132:135], v[164:167], v[60:63]
    ds_read_b64_tr_b16 v[128:129], v24 offset:6144
    v_mfma_f32_16x16x32_bf16 v[56:59], v[132:135], v[160:163], v[56:59]
    ds_read_b64_tr_b16 v[130:131], v24 offset:6656
    v_mfma_f32_16x16x32_bf16 v[72:75], v[136:139], v[160:163], v[72:75]
    ds_read_b64_tr_b16 v[132:133], v25 offset:6144
    v_mfma_f32_16x16x32_bf16 v[76:79], v[136:139], v[164:167], v[76:79]
    ds_read_b64_tr_b16 v[134:135], v25 offset:6656
    v_mfma_f32_16x16x32_bf16 v[92:95], v[140:143], v[164:167], v[92:95]
    ds_read_b64_tr_b16 v[136:137], v24 offset:14336
    buffer_load_dwordx4 v[156:159], v6, s[16:19], s51 offen offset:256 sc1
    v_mfma_f32_16x16x32_bf16 v[88:91], v[140:143], v[160:163], v[88:91]
    ds_read_b64_tr_b16 v[138:139], v24 offset:14848
    v_mfma_f32_16x16x32_bf16 v[104:107], v[160:163], v[144:147], v[104:107]
    ds_read_b64_tr_b16 v[140:141], v25 offset:14336
    v_mfma_f32_16x16x32_bf16 v[108:111], v[164:167], v[144:147], v[108:111]
    ds_read_b64_tr_b16 v[142:143], v25 offset:14848
    v_mfma_f32_16x16x32_bf16 v[124:127], v[164:167], v[148:151], v[124:127]
    ds_read_b64_tr_b16 v[144:145], v24 offset:22528
    v_mfma_f32_16x16x32_bf16 v[120:123], v[160:163], v[148:151], v[120:123]
    ds_read_b64_tr_b16 v[146:147], v24 offset:23040
    s_waitcnt vmcnt(12) lgkmcnt(8)
    v_mfma_f32_16x16x32_bf16 v[184:187], v[188:191], v[192:195], v[184:187]
    v_mfma_f32_16x16x32_bf16 v[32:35], v[128:131], v[168:171], v[32:35]
    ds_read_b64_tr_b16 v[148:149], v25 offset:22528
    buffer_load_dwordx4 v[160:163], v6, s[20:23], s59 offen offset:2048 sc1
    v_mfma_f32_16x16x32_bf16 v[36:39], v[128:131], v[172:175], v[36:39]
    ds_read_b64_tr_b16 v[150:151], v25 offset:23040
    s_waitcnt lgkmcnt(8)
    v_mfma_f32_16x16x32_bf16 v[52:55], v[132:135], v[172:175], v[52:55]
    v_mfma_f32_16x16x32_bf16 v[48:51], v[132:135], v[168:171], v[48:51]
    ds_read_b64_tr_b16 v[188:189], v28 offset:6144
    s_waitcnt lgkmcnt(7)
    v_mfma_f32_16x16x32_bf16 v[64:67], v[136:139], v[168:171], v[64:67]
    v_mfma_f32_16x16x32_bf16 v[68:71], v[136:139], v[172:175], v[68:71]
    ds_read_b64_tr_b16 v[190:191], v28 offset:6656
    s_waitcnt lgkmcnt(6)
    v_mfma_f32_16x16x32_bf16 v[84:87], v[140:143], v[172:175], v[84:87]
    buffer_load_dwordx4 v[164:167], v6, s[20:23], s59 offen offset:2304 sc1
    v_mfma_f32_16x16x32_bf16 v[80:83], v[140:143], v[168:171], v[80:83]
    ds_read_b128 v[192:195], v30 offset:3072
    s_waitcnt lgkmcnt(5)
    v_mfma_f32_16x16x32_bf16 v[96:99], v[168:171], v[144:147], v[96:99]
    s_add_u32 s52, s52, 24576
    v_mfma_f32_16x16x32_bf16 v[100:103], v[172:175], v[144:147], v[100:103]
    s_cmp_eq_u32 s52, 147456
    s_waitcnt lgkmcnt(3)
    v_mfma_f32_16x16x32_bf16 v[116:119], v[172:175], v[148:151], v[116:119]
    s_cselect_b32 s52, 0, s52
    v_mfma_f32_16x16x32_bf16 v[112:115], v[168:171], v[148:151], v[112:115]
    s_add_u32 s58, s58, 8192
    s_add_u32 s59, s59, 8192
    s_waitcnt vmcnt(12) lgkmcnt(0)
    v_mfma_f32_16x16x32_bf16 v[40:43], v[128:131], v[176:179], v[40:43]
    buffer_load_dwordx4 v[168:171], v6, s[16:19], s51 offen offset:2048 sc1
    s_barrier
    v_add_u32 v24, s52, v26
    v_mfma_f32_16x16x32_bf16 v[44:47], v[128:131], v[180:183], v[44:47]
    v_add_u32 v25, s52, v27
    v_add_u32 v28, s52, v29
    v_mfma_f32_16x16x32_bf16 v[60:63], v[132:135], v[180:183], v[60:63]
    ds_read_b64_tr_b16 v[128:129], v24 offset:0
    v_mfma_f32_16x16x32_bf16 v[56:59], v[132:135], v[176:179], v[56:59]
    ds_read_b64_tr_b16 v[130:131], v24 offset:512
    v_mfma_f32_16x16x32_bf16 v[72:75], v[136:139], v[176:179], v[72:75]
    ds_read_b64_tr_b16 v[132:133], v25 offset:0
    v_mfma_f32_16x16x32_bf16 v[76:79], v[136:139], v[180:183], v[76:79]
    ds_read_b64_tr_b16 v[134:135], v25 offset:512
    v_xor_b32 v30, 4096, v30
    v_mfma_f32_16x16x32_bf16 v[92:95], v[140:143], v[180:183], v[92:95]
    ds_read_b64_tr_b16 v[136:137], v24 offset:8192
    buffer_load_dwordx4 v[172:175], v6, s[16:19], s51 offen offset:2304 sc1
    v_mfma_f32_16x16x32_bf16 v[88:91], v[140:143], v[176:179], v[88:91]
    ds_read_b64_tr_b16 v[138:139], v24 offset:8704
    v_mfma_f32_16x16x32_bf16 v[104:107], v[176:179], v[144:147], v[104:107]
    ds_read_b64_tr_b16 v[140:141], v25 offset:8192
    s_add_u32 s50, s50, 8192
    v_mfma_f32_16x16x32_bf16 v[108:111], v[180:183], v[144:147], v[108:111]
    ds_read_b64_tr_b16 v[142:143], v25 offset:8704
    s_add_u32 s51, s51, 8192
    v_mfma_f32_16x16x32_bf16 v[124:127], v[180:183], v[148:151], v[124:127]
    ds_read_b64_tr_b16 v[144:145], v24 offset:16384
    s_sub_u32 s54, s54, 1
    v_mfma_f32_16x16x32_bf16 v[120:123], v[176:179], v[148:151], v[120:123]
    ds_read_b64_tr_b16 v[146:147], v24 offset:16896
    s_cmp_lg_u32 s54, 0
    s_cbranch_scc1 c_qkvA_loop
    ds_read_b32 v16, v8 offset:1280
    ds_read_b32 v17, v8 offset:2816
    ds_read_b32 v18, v8 offset:1344
    ds_read_b32 v19, v8 offset:2880
    ds_read_b32 v20, v8 offset:1408
    ds_read_b32 v21, v8 offset:2944
    ds_read_b32 v22, v8 offset:1472
    ds_read_b32 v23, v8 offset:3008
    ds_read_b128 v[212:215], v10 offset:128
    ds_read_b128 v[216:219], v10 offset:192
    ds_read2_b32 v[220:221], v11 offset0:64 offset1:80
    s_waitcnt vmcnt(0) lgkmcnt(11)
    v_mfma_f32_16x16x32_bf16 v[184:187], v[188:191], v[192:195], v[184:187]
    ds_read_b128 v[128:131], v9 offset:1280
    ds_read_b128 v[144:147], v9 offset:2816
    ds_read_b128 v[132:135], v9 offset:1344
    ds_read_b128 v[148:151], v9 offset:2880
    ds_read_b128 v[136:139], v9 offset:1408
    ds_read_b128 v[152:155], v9 offset:2944
    ds_read_b128 v[140:143], v9 offset:1472
    ds_read_b128 v[156:159], v9 offset:3008
    s_waitcnt lgkmcnt(9)
    ds_read_b128 v[160:163], v10 offset:0
    ds_read_b128 v[164:167], v10 offset:64
    ds_read_b128 v[168:171], v14 offset:128
    ds_read_b32 v222, v11 offset:1216
    ds_read_b32 v223, v11 offset:2752
    v_pk_fma_f32 v[64:65], v[16:17], v[212:213], v[64:65] op_sel_hi:[0,1,1] neg_lo:[1,0,0] neg_hi:[1,0,0]
    v_pk_fma_f32 v[66:67], v[16:17], v[214:215], v[66:67] op_sel_hi:[0,1,1] neg_lo:[1,0,0] neg_hi:[1,0,0]
    v_pk_fma_f32 v[80:81], v[16:17], v[216:217], v[80:81] op_sel_hi:[0,1,1] neg_lo:[1,0,0] neg_hi:[1,0,0]
    v_pk_fma_f32 v[82:83], v[16:17], v[218:219], v[82:83] op_sel_hi:[0,1,1] neg_lo:[1,0,0] neg_hi:[1,0,0]
    v_pk_mul_f32 v[64:65], v[16:17], v[64:65] op_sel:[1,0] op_sel_hi:[1,1]
    v_pk_mul_f32 v[66:67], v[16:17], v[66:67] op_sel:[1,0] op_sel_hi:[1,1]
    v_pk_mul_f32 v[80:81], v[16:17], v[80:81] op_sel:[1,0] op_sel_hi:[1,1]
    v_pk_mul_f32 v[82:83], v[16:17], v[82:83] op_sel:[1,0] op_sel_hi:[1,1]
    v_cvt_pk_bf16_f32 v64, v64, v65
    v_cvt_pk_bf16_f32 v65, v66, v67
    v_cvt_pk_bf16_f32 v66, v80, v81
    v_cvt_pk_bf16_f32 v67, v82, v83
    v_pk_fma_f32 v[68:69], v[18:19], v[212:213], v[68:69] op_sel_hi:[0,1,1] neg_lo:[1,0,0] neg_hi:[1,0,0]
    v_pk_fma_f32 v[70:71], v[18:19], v[214:215], v[70:71] op_sel_hi:[0,1,1] neg_lo:[1,0,0] neg_hi:[1,0,0]
    v_pk_fma_f32 v[84:85], v[18:19], v[216:217], v[84:85] op_sel_hi:[0,1,1] neg_lo:[1,0,0] neg_hi:[1,0,0]
    v_pk_fma_f32 v[86:87], v[18:19], v[218:219], v[86:87] op_sel_hi:[0,1,1] neg_lo:[1,0,0] neg_hi:[1,0,0]
    v_pk_mul_f32 v[68:69], v[18:19], v[68:69] op_sel:[1,0] op_sel_hi:[1,1]
    v_pk_mul_f32 v[70:71], v[18:19], v[70:71] op_sel:[1,0] op_sel_hi:[1,1]
    v_pk_mul_f32 v[84:85], v[18:19], v[84:85] op_sel:[1,0] op_sel_hi:[1,1]
    v_pk_mul_f32 v[86:87], v[18:19], v[86:87] op_sel:[1,0] op_sel_hi:[1,1]
    v_cvt_pk_bf16_f32 v68, v68, v69
    v_cvt_pk_bf16_f32 v69, v70, v71
    v_cvt_pk_bf16_f32 v70, v84, v85
    v_cvt_pk_bf16_f32 v71, v86, v87
    v_pk_fma_f32 v[72:73], v[20:21], v[212:213], v[72:73] op_sel_hi:[0,1,1] neg_lo:[1,0,0] neg_hi:[1,0,0]
    v_pk_fma_f32 v[74:75], v[20:21], v[214:215], v[74:75] op_sel_hi:[0,1,1] neg_lo:[1,0,0] neg_hi:[1,0,0]
    v_pk_fma_f32 v[88:89], v[20:21], v[216:217], v[88:89] op_sel_hi:[0,1,1] neg_lo:[1,0,0] neg_hi:[1,0,0]
    v_pk_fma_f32 v[90:91], v[20:21], v[218:219], v[90:91] op_sel_hi:[0,1,1] neg_lo:[1,0,0] neg_hi:[1,0,0]
    v_pk_mul_f32 v[72:73], v[20:21], v[72:73] op_sel:[1,0] op_sel_hi:[1,1]
    v_pk_mul_f32 v[74:75], v[20:21], v[74:75] op_sel:[1,0] op_sel_hi:[1,1]
    v_pk_mul_f32 v[88:89], v[20:21], v[88:89] op_sel:[1,0] op_sel_hi:[1,1]
    v_pk_mul_f32 v[90:91], v[20:21], v[90:91] op_sel:[1,0] op_sel_hi:[1,1]
    v_cvt_pk_bf16_f32 v72, v72, v73
    v_cvt_pk_bf16_f32 v73, v74, v75
    v_cvt_pk_bf16_f32 v74, v88, v89
    v_cvt_pk_bf16_f32 v75, v90, v91
    v_pk_fma_f32 v[76:77], v[22:23], v[212:213], v[76:77] op_sel_hi:[0,1,1] neg_lo:[1,0,0] neg_hi:[1,0,0]
    v_pk_fma_f32 v[78:79], v[22:23], v[214:215], v[78:79] op_sel_hi:[0,1,1] neg_lo:[1,0,0] neg_hi:[1,0,0]
    v_pk_fma_f32 v[92:93], v[22:23], v[216:217], v[92:93] op_sel_hi:[0,1,1] neg_lo:[1,0,0] neg_hi:[1,0,0]
    v_pk_fma_f32 v[94:95], v[22:23], v[218:219], v[94:95] op_sel_hi:[0,1,1] neg_lo:[1,0,0] neg_hi:[1,0,0]
    v_pk_mul_f32 v[76:77], v[22:23], v[76:77] op_sel:[1,0] op_sel_hi:[1,1]
    v_pk_mul_f32 v[78:79], v[22:23], v[78:79] op_sel:[1,0] op_sel_hi:[1,1]
    v_pk_mul_f32 v[92:93], v[22:23], v[92:93] op_sel:[1,0] op_sel_hi:[1,1]
    v_pk_mul_f32 v[94:95], v[22:23], v[94:95] op_sel:[1,0] op_sel_hi:[1,1]
    v_cvt_pk_bf16_f32 v76, v76, v77
    v_cvt_pk_bf16_f32 v77, v78, v79
    v_cvt_pk_bf16_f32 v78, v92, v93
    v_cvt_pk_bf16_f32 v79, v94, v95
    ds_write_b128 v12, v[76:79] offset:2048
    s_waitcnt lgkmcnt(1)
    v_pk_fma_f32 v[96:97], v[128:129], v[220:221], v[96:97] op_sel:[0,0,0] op_sel_hi:[1,0,1] neg_lo:[1,0,0] neg_hi:[1,0,0]
    v_pk_fma_f32 v[98:99], v[130:131], v[220:221], v[98:99] op_sel:[0,0,0] op_sel_hi:[1,0,1] neg_lo:[1,0,0] neg_hi:[1,0,0]
    v_pk_mul_f32 v[96:97], v[144:145], v[96:97]
    v_pk_mul_f32 v[98:99], v[146:147], v[98:99]
    v_pk_fma_f32 v[112:113], v[128:129], v[220:221], v[112:113] op_sel:[0,1,0] op_sel_hi:[1,1,1] neg_lo:[1,0,0] neg_hi:[1,0,0]
    v_pk_fma_f32 v[114:115], v[130:131], v[220:221], v[114:115] op_sel:[0,1,0] op_sel_hi:[1,1,1] neg_lo:[1,0,0] neg_hi:[1,0,0]
    v_pk_mul_f32 v[112:113], v[144:145], v[112:113]
    v_pk_mul_f32 v[114:115], v[146:147], v[114:115]
    v_cvt_pk_bf16_f32 v99, v98, v99
    v_cvt_pk_bf16_f32 v98, v96, v97
    v_cvt_pk_bf16_f32 v115, v114, v115
    v_cvt_pk_bf16_f32 v114, v112, v113
    v_pk_fma_f32 v[100:101], v[132:133], v[220:221], v[100:101] op_sel:[0,0,0] op_sel_hi:[1,0,1] neg_lo:[1,0,0] neg_hi:[1,0,0]
    v_pk_fma_f32 v[102:103], v[134:135], v[220:221], v[102:103] op_sel:[0,0,0] op_sel_hi:[1,0,1] neg_lo:[1,0,0] neg_hi:[1,0,0]
    v_pk_mul_f32 v[100:101], v[148:149], v[100:101]
    v_pk_mul_f32 v[102:103], v[150:151], v[102:103]
    v_pk_fma_f32 v[116:117], v[132:133], v[220:221], v[116:117] op_sel:[0,1,0] op_sel_hi:[1,1,1] neg_lo:[1,0,0] neg_hi:[1,0,0]
    v_pk_fma_f32 v[118:119], v[134:135], v[220:221], v[118:119] op_sel:[0,1,0] op_sel_hi:[1,1,1] neg_lo:[1,0,0] neg_hi:[1,0,0]
    v_pk_mul_f32 v[116:117], v[148:149], v[116:117]
    v_pk_mul_f32 v[118:119], v[150:151], v[118:119]
    v_cvt_pk_bf16_f32 v100, v100, v101
    v_cvt_pk_bf16_f32 v101, v102, v103
    v_cvt_pk_bf16_f32 v116, v116, v117
    v_cvt_pk_bf16_f32 v117, v118, v119
    v_pk_fma_f32 v[104:105], v[136:137], v[220:221], v[104:105] op_sel:[0,0,0] op_sel_hi:[1,0,1] neg_lo:[1,0,0] neg_hi:[1,0,0]
    v_pk_fma_f32 v[106:107], v[138:139], v[220:221], v[106:107] op_sel:[0,0,0] op_sel_hi:[1,0,1] neg_lo:[1,0,0] neg_hi:[1,0,0]
    v_pk_mul_f32 v[104:105], v[152:153], v[104:105]
    v_pk_mul_f32 v[106:107], v[154:155], v[106:107]
    v_pk_fma_f32 v[120:121], v[136:137], v[220:221], v[120:121] op_sel:[0,1,0] op_sel_hi:[1,1,1] neg_lo:[1,0,0] neg_hi:[1,0,0]
    v_pk_fma_f32 v[122:123], v[138:139], v[220:221], v[122:123] op_sel:[0,1,0] op_sel_hi:[1,1,1] neg_lo:[1,0,0] neg_hi:[1,0,0]
    v_pk_mul_f32 v[120:121], v[152:153], v[120:121]
    v_pk_mul_f32 v[122:123], v[154:155], v[122:123]
    v_cvt_pk_bf16_f32 v102, v104, v105
    v_cvt_pk_bf16_f32 v103, v106, v107
    v_cvt_pk_bf16_f32 v118, v120, v121
    v_cvt_pk_bf16_f32 v119, v122, v123
    v_pk_fma_f32 v[108:109], v[140:141], v[220:221], v[108:109] op_sel:[0,0,0] op_sel_hi:[1,0,1] neg_lo:[1,0,0] neg_hi:[1,0,0]
    v_pk_fma_f32 v[110:111], v[142:143], v[220:221], v[110:111] op_sel:[0,0,0] op_sel_hi:[1,0,1] neg_lo:[1,0,0] neg_hi:[1,0,0]
    v_pk_mul_f32 v[108:109], v[156:157], v[108:109]
    v_pk_mul_f32 v[110:111], v[158:159], v[110:111]
    v_pk_fma_f32 v[124:125], v[140:141], v[220:221], v[124:125] op_sel:[0,1,0] op_sel_hi:[1,1,1] neg_lo:[1,0,0] neg_hi:[1,0,0]
    v_pk_fma_f32 v[126:127], v[142:143], v[220:221], v[126:127] op_sel:[0,1,0] op_sel_hi:[1,1,1] neg_lo:[1,0,0] neg_hi:[1,0,0]
    v_pk_mul_f32 v[124:125], v[156:157], v[124:125]
    v_pk_mul_f32 v[126:127], v[158:159], v[126:127]
    v_cvt_pk_bf16_f32 v104, v108, v109
    v_cvt_pk_bf16_f32 v105, v110, v111
    v_cvt_pk_bf16_f32 v120, v124, v125
    v_cvt_pk_bf16_f32 v121, v126, v127
    ds_write_b64 v12, v[104:105] offset:3072
    ds_write_b64 v12, v[120:121] offset:3080
    v_pk_fma_f32 v[184:185], v[222:223], v[168:169], v[184:185] op_sel_hi:[0,1,1] neg_lo:[1,0,0] neg_hi:[1,0,0]
    v_pk_fma_f32 v[186:187], v[222:223], v[170:171], v[186:187] op_sel_hi:[0,1,1] neg_lo:[1,0,0] neg_hi:[1,0,0]
    v_pk_mul_f32 v[184:185], v[222:223], v[184:185] op_sel:[1,0] op_sel_hi:[1,1]
    v_pk_mul_f32 v[186:187], v[222:223], v[186:187] op_sel:[1,0] op_sel_hi:[1,1]
    v_cvt_pk_bf16_f32 v184, v184, v185
    v_cvt_pk_bf16_f32 v185, v186, v187
    s_cmp_ge_u32 s8, 2
    s_cbranch_scc1 c_qkvA_hv
    ds_write_b64 v13, v[184:185]
    s_branch c_qkvA_hd
c_qkvA_hv:
    ds_write_b16 v13, v184 offset:0
    ds_write_b16_d16_hi v13, v184 offset:16
    ds_write_b16 v13, v185 offset:32
    ds_write_b16_d16_hi v13, v185 offset:48
c_qkvA_hd:
    v_pk_fma_f32 v[44:45], v[22:23], v[160:161], v[44:45] op_sel_hi:[0,1,1] neg_lo:[1,0,0] neg_hi:[1,0,0]
    v_pk_fma_f32 v[46:47], v[22:23], v[162:163], v[46:47] op_sel_hi:[0,1,1] neg_lo:[1,0,0] neg_hi:[1,0,0]
    v_pk_fma_f32 v[60:61], v[22:23], v[164:165], v[60:61] op_sel_hi:[0,1,1] neg_lo:[1,0,0] neg_hi:[1,0,0]
    v_pk_fma_f32 v[62:63], v[22:23], v[166:167], v[62:63] op_sel_hi:[0,1,1] neg_lo:[1,0,0] neg_hi:[1,0,0]
    v_cvt_pk_bf16_f32 v44, v44, v45
    v_cvt_pk_bf16_f32 v45, v46, v47
    v_cvt_pk_bf16_f32 v46, v60, v61
    v_cvt_pk_bf16_f32 v47, v62, v63
    v_mul_f32 v23, 0x3e8293ee, v23
    v_pk_fma_f32 v[40:41], v[20:21], v[160:161], v[40:41] op_sel_hi:[0,1,1] neg_lo:[1,0,0] neg_hi:[1,0,0]
    v_pk_fma_f32 v[42:43], v[20:21], v[162:163], v[42:43] op_sel_hi:[0,1,1] neg_lo:[1,0,0] neg_hi:[1,0,0]
    v_pk_fma_f32 v[56:57], v[20:21], v[164:165], v[56:57] op_sel_hi:[0,1,1] neg_lo:[1,0,0] neg_hi:[1,0,0]
    v_pk_fma_f32 v[58:59], v[20:21], v[166:167], v[58:59] op_sel_hi:[0,1,1] neg_lo:[1,0,0] neg_hi:[1,0,0]
    v_cvt_pk_bf16_f32 v40, v40, v41
    v_cvt_pk_bf16_f32 v41, v42, v43
    v_cvt_pk_bf16_f32 v42, v56, v57
    v_cvt_pk_bf16_f32 v43, v58, v59
    v_mul_f32 v21, 0x3e8293ee, v21
    s_waitcnt lgkmcnt(0)
    s_barrier
    ds_read_b128 v[172:175], v12
    ds_read_b64 v[96:97], v12 offset:1024
    ds_read_b64 v[112:113], v12 offset:1032
    v_mfma_f32_16x16x32_bf16 v[156:159], v[76:79], v[44:47], v[196:199]
    v_mfma_f32_16x16x32_bf16 v[152:155], v[72:75], v[44:47], v[200:203]
    v_pk_fma_f32 v[36:37], v[18:19], v[160:161], v[36:37] op_sel_hi:[0,1,1] neg_lo:[1,0,0] neg_hi:[1,0,0]
    v_pk_fma_f32 v[38:39], v[18:19], v[162:163], v[38:39] op_sel_hi:[0,1,1] neg_lo:[1,0,0] neg_hi:[1,0,0]
    v_pk_fma_f32 v[52:53], v[18:19], v[164:165], v[52:53] op_sel_hi:[0,1,1] neg_lo:[1,0,0] neg_hi:[1,0,0]
    v_pk_fma_f32 v[54:55], v[18:19], v[166:167], v[54:55] op_sel_hi:[0,1,1] neg_lo:[1,0,0] neg_hi:[1,0,0]
    v_cvt_pk_bf16_f32 v36, v36, v37
    v_cvt_pk_bf16_f32 v37, v38, v39
    v_cvt_pk_bf16_f32 v38, v52, v53
    v_cvt_pk_bf16_f32 v39, v54, v55
    v_mul_f32 v19, 0x3e8293ee, v19
    v_mfma_f32_16x16x32_bf16 v[148:151], v[72:75], v[40:43], v[196:199]
    v_mfma_f32_16x16x32_bf16 v[144:147], v[68:71], v[40:43], v[200:203]
    v_pk_fma_f32 v[32:33], v[16:17], v[160:161], v[32:33] op_sel_hi:[0,1,1] neg_lo:[1,0,0] neg_hi:[1,0,0]
    v_pk_fma_f32 v[34:35], v[16:17], v[162:163], v[34:35] op_sel_hi:[0,1,1] neg_lo:[1,0,0] neg_hi:[1,0,0]
    v_pk_fma_f32 v[48:49], v[16:17], v[164:165], v[48:49] op_sel_hi:[0,1,1] neg_lo:[1,0,0] neg_hi:[1,0,0]
    v_pk_fma_f32 v[50:51], v[16:17], v[166:167], v[50:51] op_sel_hi:[0,1,1] neg_lo:[1,0,0] neg_hi:[1,0,0]
    v_cvt_pk_bf16_f32 v32, v32, v33
    v_cvt_pk_bf16_f32 v33, v34, v35
    v_cvt_pk_bf16_f32 v34, v48, v49
    v_cvt_pk_bf16_f32 v35, v50, v51
    v_mul_f32 v17, 0x3e8293ee, v17
    v_mfma_f32_16x16x32_bf16 v[140:143], v[68:71], v[36:39], v[196:199]
    v_mfma_f32_16x16x32_bf16 v[136:139], v[64:67], v[36:39], v[200:203]
    s_waitcnt lgkmcnt(2)
    v_mfma_f32_16x16x32_bf16 v[132:135], v[64:67], v[32:35], v[196:199]
    v_mfma_f32_16x16x32_bf16 v[128:131], v[172:175], v[32:35], v[204:207]
    v_max3_f32 v179, v152, v153, v154
    v_max3_f32 v183, v155, v156, v157
    v_max3_f32 v179, v179, v158, v159
    v_max_f32 v179, v179, v183
    v_max3_f32 v178, v144, v145, v146
    v_max3_f32 v182, v147, v148, v149
    v_max3_f32 v178, v178, v150, v151
    v_max_f32 v178, v178, v182
    v_max3_f32 v177, v136, v137, v138
    v_max3_f32 v181, v139, v140, v141
    v_max3_f32 v177, v177, v142, v143
    v_max_f32 v177, v177, v181
    v_max3_f32 v176, v128, v129, v130
    v_max3_f32 v180, v131, v132, v133
    v_max3_f32 v176, v176, v134, v135
    v_max_f32 v176, v176, v180
    v_mov_b32 v183, v179
    v_mov_b32 v182, v178
    v_mov_b32 v181, v177
    v_mov_b32 v180, v176
    v_permlane32_swap_b32 v179, v183
    v_permlane32_swap_b32 v178, v182
    v_permlane32_swap_b32 v177, v181
    v_permlane32_swap_b32 v176, v180
    v_max_f32 v179, v179, v183
    v_max_f32 v178, v178, v182
    v_max_f32 v177, v177, v181
    v_max_f32 v176, v176, v180
    v_mov_b32 v183, v179
    v_mov_b32 v182, v178
    v_mov_b32 v181, v177
    v_mov_b32 v180, v176
    v_permlane16_swap_b32 v179, v183
    v_permlane16_swap_b32 v178, v182
    v_permlane16_swap_b32 v177, v181
    v_permlane16_swap_b32 v176, v180
    v_max_f32 v179, v179, v183
    v_max_f32 v178, v178, v182
    v_max_f32 v177, v177, v181
    v_max_f32 v176, v176, v180
    v_mul_f32_e64 v22, -v179, v23
    v_mul_f32_e64 v20, -v178, v21
    v_mul_f32_e64 v18, -v177, v19
    v_mul_f32_e64 v16, -v176, v17
    s_waitcnt lgkmcnt(0)
    s_add_u32 s51, s49, 65536
    v_pk_fma_f32 v[152:153], v[152:153], v[22:23], v[22:23] op_sel:[0,1,0] op_sel_hi:[1,1,0]
    v_pk_fma_f32 v[154:155], v[154:155], v[22:23], v[22:23] op_sel:[0,1,0] op_sel_hi:[1,1,0]
    v_pk_fma_f32 v[156:157], v[156:157], v[22:23], v[22:23] op_sel:[0,1,0] op_sel_hi:[1,1,0]
    v_pk_fma_f32 v[158:159], v[158:159], v[22:23], v[22:23] op_sel:[0,1,0] op_sel_hi:[1,1,0]
    v_exp_f32 v152, v152
    v_exp_f32 v153, v153
    v_exp_f32 v154, v154
    v_exp_f32 v155, v155
    v_exp_f32 v156, v156
    v_exp_f32 v157, v157
    v_exp_f32 v158, v158
    v_exp_f32 v159, v159
    v_cvt_pk_bf16_f32 v172, v152, v153
    v_cvt_pk_bf16_f32 v173, v154, v155
    v_cvt_pk_bf16_f32 v174, v156, v157
    v_cvt_pk_bf16_f32 v175, v158, v159
    s_nop 1
    v_mfma_f32_16x16x32_bf16 v[92:95], v[208:211], v[172:175], 0
    v_mfma_f32_16x16x32_bf16 v[60:63], v[102:105], v[172:175], 0
    v_mfma_f32_16x16x32_bf16 v[76:79], v[118:121], v[172:175], 0
    v_pk_fma_f32 v[144:145], v[144:145], v[20:21], v[20:21] op_sel:[0,1,0] op_sel_hi:[1,1,0]
    v_pk_fma_f32 v[146:147], v[146:147], v[20:21], v[20:21] op_sel:[0,1,0] op_sel_hi:[1,1,0]
    v_pk_fma_f32 v[148:149], v[148:149], v[20:21], v[20:21] op_sel:[0,1,0] op_sel_hi:[1,1,0]
    v_pk_fma_f32 v[150:151], v[150:151], v[20:21], v[20:21] op_sel:[0,1,0] op_sel_hi:[1,1,0]
    v_exp_f32 v144, v144
    v_exp_f32 v145, v145
    v_exp_f32 v146, v146
    v_exp_f32 v147, v147
    v_exp_f32 v148, v148
    v_exp_f32 v149, v149
    v_exp_f32 v150, v150
    v_exp_f32 v151, v151
    v_cvt_pk_bf16_f32 v168, v144, v145
    v_cvt_pk_bf16_f32 v169, v146, v147
    v_cvt_pk_bf16_f32 v170, v148, v149
    v_cvt_pk_bf16_f32 v171, v150, v151
    v_rcp_f32 v92, v92
    s_nop 0
    v_pk_mul_f32 v[60:61], v[92:93], v[60:61] op_sel_hi:[0,1]
    v_pk_mul_f32 v[62:63], v[92:93], v[62:63] op_sel_hi:[0,1]
    v_pk_mul_f32 v[76:77], v[92:93], v[76:77] op_sel_hi:[0,1]
    v_pk_mul_f32 v[78:79], v[92:93], v[78:79] op_sel_hi:[0,1]
    v_cvt_pk_bf16_f32 v60, v60, v61
    v_cvt_pk_bf16_f32 v61, v62, v63
    v_cvt_pk_bf16_f32 v62, v76, v77
    v_cvt_pk_bf16_f32 v63, v78, v79
    s_nop 0
    v_permlane32_swap_b32 v60, v62
    v_permlane32_swap_b32 v61, v63
    buffer_store_dwordx4 v[60:63], v6, s[12:15], s51 offen offset:256 sc1
    v_mfma_f32_16x16x32_bf16 v[88:91], v[208:211], v[168:171], 0
    v_mfma_f32_16x16x32_bf16 v[56:59], v[100:103], v[168:171], 0
    v_mfma_f32_16x16x32_bf16 v[72:75], v[116:119], v[168:171], 0
    v_pk_fma_f32 v[136:137], v[136:137], v[18:19], v[18:19] op_sel:[0,1,0] op_sel_hi:[1,1,0]
    v_pk_fma_f32 v[138:139], v[138:139], v[18:19], v[18:19] op_sel:[0,1,0] op_sel_hi:[1,1,0]
    v_pk_fma_f32 v[140:141], v[140:141], v[18:19], v[18:19] op_sel:[0,1,0] op_sel_hi:[1,1,0]
    v_pk_fma_f32 v[142:143], v[142:143], v[18:19], v[18:19] op_sel:[0,1,0] op_sel_hi:[1,1,0]
    v_exp_f32 v136, v136
    v_exp_f32 v137, v137
    v_exp_f32 v138, v138
    v_exp_f32 v139, v139
    v_exp_f32 v140, v140
    v_exp_f32 v141, v141
    v_exp_f32 v142, v142
    v_exp_f32 v143, v143
    v_cvt_pk_bf16_f32 v164, v136, v137
    v_cvt_pk_bf16_f32 v165, v138, v139
    v_cvt_pk_bf16_f32 v166, v140, v141
    v_cvt_pk_bf16_f32 v167, v142, v143
    v_rcp_f32 v88, v88
    s_nop 0
    v_pk_mul_f32 v[56:57], v[88:89], v[56:57] op_sel_hi:[0,1]
    v_pk_mul_f32 v[58:59], v[88:89], v[58:59] op_sel_hi:[0,1]
    v_pk_mul_f32 v[72:73], v[88:89], v[72:73] op_sel_hi:[0,1]
    v_pk_mul_f32 v[74:75], v[88:89], v[74:75] op_sel_hi:[0,1]
    v_cvt_pk_bf16_f32 v56, v56, v57
    v_cvt_pk_bf16_f32 v57, v58, v59
    v_cvt_pk_bf16_f32 v58, v72, v73
    v_cvt_pk_bf16_f32 v59, v74, v75
    s_nop 0
    v_permlane32_swap_b32 v56, v58
    v_permlane32_swap_b32 v57, v59
    buffer_store_dwordx4 v[56:59], v6, s[12:15], s51 offen offset:0 sc1
    v_mfma_f32_16x16x32_bf16 v[84:87], v[208:211], v[164:167], 0
    v_mfma_f32_16x16x32_bf16 v[52:55], v[98:101], v[164:167], 0
    v_mfma_f32_16x16x32_bf16 v[68:71], v[114:117], v[164:167], 0
    v_pk_fma_f32 v[128:129], v[128:129], v[16:17], v[16:17] op_sel:[0,1,0] op_sel_hi:[1,1,0]
    v_pk_fma_f32 v[130:131], v[130:131], v[16:17], v[16:17] op_sel:[0,1,0] op_sel_hi:[1,1,0]
    v_pk_fma_f32 v[132:133], v[132:133], v[16:17], v[16:17] op_sel:[0,1,0] op_sel_hi:[1,1,0]
    v_pk_fma_f32 v[134:135], v[134:135], v[16:17], v[16:17] op_sel:[0,1,0] op_sel_hi:[1,1,0]
    v_exp_f32 v128, v128
    v_exp_f32 v129, v129
    v_exp_f32 v130, v130
    v_exp_f32 v131, v131
    v_exp_f32 v132, v132
    v_exp_f32 v133, v133
    v_exp_f32 v134, v134
    v_exp_f32 v135, v135
    v_cvt_pk_bf16_f32 v160, v128, v129
    v_cvt_pk_bf16_f32 v161, v130, v131
    v_cvt_pk_bf16_f32 v162, v132, v133
    v_cvt_pk_bf16_f32 v163, v134, v135
    v_rcp_f32 v84, v84
    s_nop 0
    v_pk_mul_f32 v[52:53], v[84:85], v[52:53] op_sel_hi:[0,1]
    v_pk_mul_f32 v[54:55], v[84:85], v[54:55] op_sel_hi:[0,1]
    v_pk_mul_f32 v[68:69], v[84:85], v[68:69] op_sel_hi:[0,1]
    v_pk_mul_f32 v[70:71], v[84:85], v[70:71] op_sel_hi:[0,1]
    v_cvt_pk_bf16_f32 v52, v52, v53
    v_cvt_pk_bf16_f32 v53, v54, v55
    v_cvt_pk_bf16_f32 v54, v68, v69
    v_cvt_pk_bf16_f32 v55, v70, v71
    s_nop 0
    v_permlane32_swap_b32 v52, v54
    v_permlane32_swap_b32 v53, v55
    buffer_store_dwordx4 v[52:55], v6, s[12:15], s49 offen offset:256 sc1
    v_mfma_f32_16x16x32_bf16 v[80:83], v[208:211], v[160:163], 0
    v_mfma_f32_16x16x32_bf16 v[48:51], v[96:99], v[160:163], 0
    v_mfma_f32_16x16x32_bf16 v[64:67], v[112:115], v[160:163], 0
    s_nop 5
    v_rcp_f32 v80, v80
    s_nop 0
    v_pk_mul_f32 v[48:49], v[80:81], v[48:49] op_sel_hi:[0,1]
    v_pk_mul_f32 v[50:51], v[80:81], v[50:51] op_sel_hi:[0,1]
    v_pk_mul_f32 v[64:65], v[80:81], v[64:65] op_sel_hi:[0,1]
    v_pk_mul_f32 v[66:67], v[80:81], v[66:67] op_sel_hi:[0,1]
    v_cvt_pk_bf16_f32 v48, v48, v49
    v_cvt_pk_bf16_f32 v49, v50, v51
    v_cvt_pk_bf16_f32 v50, v64, v65
    v_cvt_pk_bf16_f32 v51, v66, v67
    s_nop 0
    v_permlane32_swap_b32 v48, v50
    v_permlane32_swap_b32 v49, v51
    buffer_store_dwordx4 v[48:51], v6, s[12:15], s49 offen offset:0 sc1
    s_mul_i32 s55, s9, 786432
    s_add_u32 s55, s55, 65798144
    v_and_b32 v16, 63, v0
    s_and_b32 s56, s11, 0xe0
    v_lshrrev_b32 v17, 5, v16
    v_add_u32 v16, s56, v16
    v_and_b32 v16, 255, v16
    v_lshlrev_b32 v16, 10, v16
    v_lshl_add_u32 v16, v17, 8, v16
    s_bfe_u32 s56, s11, 0x20003
    s_and_b32 s57, s11, 7
    s_lshl_b32 s56, s56, 7
    s_lshl_b32 s57, s57, 2
    s_add_u32 s55, s55, s56
    s_add_u32 s55, s55, s57
    v_mov_b32 v17, 159488
    v_mov_b32 v18, 1
    v_mov_b32 v19, s10
    s_mov_b64 exec, 1
    s_waitcnt vmcnt(0)
    ds_add_rtn_u32 v18, v17, v18
    s_waitcnt lgkmcnt(0)
    v_readfirstlane_b32 s56, v18
    s_and_b32 s56, s56, 3
    s_cmp_lg_u32 s56, 3
    s_cbranch_scc1 pub_1
    s_mov_b32 exec_lo, -1
    buffer_store_dword v19, v16, s[12:15], s55 offen sc1
pub_1:
    s_mov_b64 exec, -1
    s_branch c_wo
.p2align 6
c_wo:
    v_and_b32 v1, 63, v0
    v_lshrrev_b32 v2, 6, v0
    v_lshlrev_b32 v5, 4, v1
    v_lshrrev_b32 v3, 5, v1
    s_lshl_b32 s48, s6, 2
    s_add_u32 s48, s48, s8
    s_lshl_b32 s55, s48, 16
    s_lshl_b32 s56, s9, 22
    s_add_u32 s55, s55, s56
    s_lshl_b32 s56, s7, 12
    s_add_u32 s58, s55, s56
    buffer_load_dwordx4 v[96:99], v5, s[12:15], s58 offen offset:0 sc1
    buffer_load_dwordx4 v[100:103], v5, s[12:15], s58 offen offset:1024 sc1
    buffer_load_dwordx4 v[104:107], v5, s[12:15], s58 offen offset:2048 sc1
    buffer_load_dwordx4 v[108:111], v5, s[12:15], s58 offen offset:3072 sc1
    s_add_u32 s55, s55, 16777216
    s_add_u32 s16, s4, s55
    s_addc_u32 s17, s5, 0
    s_mov_b32 s18, 65536
    s_mov_b32 s19, 0x00020000
    v_and_b32 v4, 15, v0
    v_lshrrev_b32 v16, 2, v4
    v_lshl_add_u32 v16, v3, 2, v16
    v_lshlrev_b32 v16, 7, v16
    v_bfe_u32 v17, v1, 4, 1
    v_lshl_add_u32 v16, v17, 5, v16
    v_and_b32 v17, 3, v4
    v_lshl_add_u32 v16, v17, 3, v16
    v_lshrrev_b32 v17, 3, v4
    v_lshlrev_b32 v18, 6, v17
    v_add_u32 v12, v16, v18
    v_sub_u32 v13, v16, v18
    s_mov_b32 s57, 0xffff0000
    s_waitcnt vmcnt(0)
    v_lshlrev_b32 v32, 16, v96
    v_and_b32 v33, s57, v96
    v_lshlrev_b32 v34, 16, v97
    v_and_b32 v35, s57, v97
    v_lshlrev_b32 v36, 16, v98
    v_and_b32 v37, s57, v98
    v_lshlrev_b32 v38, 16, v99
    v_and_b32 v39, s57, v99
    v_lshlrev_b32 v40, 16, v100
    v_and_b32 v41, s57, v100
    v_lshlrev_b32 v42, 16, v101
    v_and_b32 v43, s57, v101
    v_lshlrev_b32 v44, 16, v102
    v_and_b32 v45, s57, v102
    v_lshlrev_b32 v46, 16, v103
    v_and_b32 v47, s57, v103
    v_lshlrev_b32 v48, 16, v104
    v_and_b32 v49, s57, v104
    v_lshlrev_b32 v50, 16, v105
    v_and_b32 v51, s57, v105
    v_lshlrev_b32 v52, 16, v106
    v_and_b32 v53, s57, v106
    v_lshlrev_b32 v54, 16, v107
    v_and_b32 v55, s57, v107
    v_lshlrev_b32 v56, 16, v108
    v_and_b32 v57, s57, v108
    v_lshlrev_b32 v58, 16, v109
    v_and_b32 v59, s57, v109
    v_lshlrev_b32 v60, 16, v110
    v_and_b32 v61, s57, v110
    v_lshlrev_b32 v62, 16, v111
    v_and_b32 v63, s57, v111
    s_mov_b32 s50, 0
    s_mov_b32 s51, 4096
    s_mov_b32 s52, 8192
    s_mov_b32 s53, 12288
    s_mov_b32 s54, 4
    s_barrier
    buffer_load_dwordx4 v[112:115], v5, s[16:19], s50 offen offset:0 sc1
    buffer_load_dwordx4 v[116:119], v5, s[16:19], s50 offen offset:1024 sc1
    buffer_load_dwordx4 v[120:123], v5, s[16:19], s50 offen offset:2048 sc1
    buffer_load_dwordx4 v[124:127], v5, s[16:19], s50 offen offset:3072 sc1
    ds_read_b64_tr_b16 v[64:65], v12 offset:0
    ds_read_b64_tr_b16 v[66:67], v12 offset:1024
    ds_read_b64_tr_b16 v[68:69], v13 offset:64
    ds_read_b64_tr_b16 v[70:71], v13 offset:1088
    ds_read_b64_tr_b16 v[72:73], v12 offset:2048
    ds_read_b64_tr_b16 v[74:75], v12 offset:3072
    ds_read_b64_tr_b16 v[76:77], v13 offset:2112
    ds_read_b64_tr_b16 v[78:79], v13 offset:3136
    ds_read_b64_tr_b16 v[80:81], v12 offset:4096
    ds_read_b64_tr_b16 v[82:83], v12 offset:5120
    ds_read_b64_tr_b16 v[84:85], v13 offset:4160
    ds_read_b64_tr_b16 v[86:87], v13 offset:5184
    buffer_load_dwordx4 v[128:131], v5, s[16:19], s51 offen offset:0 sc1
    buffer_load_dwordx4 v[132:135], v5, s[16:19], s51 offen offset:1024 sc1
    buffer_load_dwordx4 v[136:139], v5, s[16:19], s51 offen offset:2048 sc1
    buffer_load_dwordx4 v[140:143], v5, s[16:19], s51 offen offset:3072 sc1
    buffer_load_dwordx4 v[144:147], v5, s[16:19], s52 offen offset:0 sc1
    buffer_load_dwordx4 v[148:151], v5, s[16:19], s52 offen offset:1024 sc1
    buffer_load_dwordx4 v[152:155], v5, s[16:19], s52 offen offset:2048 sc1
    buffer_load_dwordx4 v[156:159], v5, s[16:19], s52 offen offset:3072 sc1
    buffer_load_dwordx4 v[160:163], v5, s[16:19], s53 offen offset:0 sc1
    buffer_load_dwordx4 v[164:167], v5, s[16:19], s53 offen offset:1024 sc1
    buffer_load_dwordx4 v[168:171], v5, s[16:19], s53 offen offset:2048 sc1
    s_add_u32 s50, s50, 15360
    s_add_u32 s51, s51, 15360
    s_add_u32 s52, s52, 15360
    s_add_u32 s53, s53, 15360
.p2align 3
c_wo_loop:
    s_waitcnt vmcnt(14) lgkmcnt(8)
    v_mfma_f32_32x32x16_bf16 v[32:47], v[64:67], v[112:115], v[32:47]
    ds_read_b64_tr_b16 v[88:89], v12 offset:6144
    ds_read_b64_tr_b16 v[90:91], v12 offset:7168
    buffer_load_dwordx4 v[172:175], v5, s[16:19], s50 offen offset:0 sc1
    v_mfma_f32_32x32x16_bf16 v[48:63], v[68:71], v[112:115], v[48:63]
    ds_read_b64_tr_b16 v[92:93], v13 offset:6208
    ds_read_b64_tr_b16 v[94:95], v13 offset:7232
    s_waitcnt vmcnt(14) lgkmcnt(8)
    v_mfma_f32_32x32x16_bf16 v[32:47], v[72:75], v[116:119], v[32:47]
    ds_read_b64_tr_b16 v[64:65], v12 offset:8192
    ds_read_b64_tr_b16 v[66:67], v12 offset:9216
    buffer_load_dwordx4 v[112:115], v5, s[16:19], s50 offen offset:1024 sc1
    v_mfma_f32_32x32x16_bf16 v[48:63], v[76:79], v[116:119], v[48:63]
    ds_read_b64_tr_b16 v[68:69], v13 offset:8256
    ds_read_b64_tr_b16 v[70:71], v13 offset:9280
    s_waitcnt vmcnt(14) lgkmcnt(8)
    v_mfma_f32_32x32x16_bf16 v[32:47], v[80:83], v[120:123], v[32:47]
    ds_read_b64_tr_b16 v[72:73], v12 offset:10240
    ds_read_b64_tr_b16 v[74:75], v12 offset:11264
    buffer_load_dwordx4 v[116:119], v5, s[16:19], s50 offen offset:2048 sc1
    v_mfma_f32_32x32x16_bf16 v[48:63], v[84:87], v[120:123], v[48:63]
    ds_read_b64_tr_b16 v[76:77], v13 offset:10304
    ds_read_b64_tr_b16 v[78:79], v13 offset:11328
    s_waitcnt vmcnt(14) lgkmcnt(8)
    v_mfma_f32_32x32x16_bf16 v[32:47], v[88:91], v[124:127], v[32:47]
    ds_read_b64_tr_b16 v[80:81], v12 offset:12288
    ds_read_b64_tr_b16 v[82:83], v12 offset:13312
    buffer_load_dwordx4 v[120:123], v5, s[16:19], s50 offen offset:3072 sc1
    v_mfma_f32_32x32x16_bf16 v[48:63], v[92:95], v[124:127], v[48:63]
    ds_read_b64_tr_b16 v[84:85], v13 offset:12352
    ds_read_b64_tr_b16 v[86:87], v13 offset:13376
    s_add_u32 s50, s50, 16384
    s_waitcnt vmcnt(14) lgkmcnt(8)
    v_mfma_f32_32x32x16_bf16 v[32:47], v[64:67], v[128:131], v[32:47]
    ds_read_b64_tr_b16 v[88:89], v12 offset:14336
    ds_read_b64_tr_b16 v[90:91], v12 offset:15360
    buffer_load_dwordx4 v[124:127], v5, s[16:19], s51 offen offset:0 sc1
    v_mfma_f32_32x32x16_bf16 v[48:63], v[68:71], v[128:131], v[48:63]
    ds_read_b64_tr_b16 v[92:93], v13 offset:14400
    ds_read_b64_tr_b16 v[94:95], v13 offset:15424
    s_waitcnt vmcnt(14) lgkmcnt(8)
    v_mfma_f32_32x32x16_bf16 v[32:47], v[72:75], v[132:135], v[32:47]
    ds_read_b64_tr_b16 v[64:65], v12 offset:16384
    ds_read_b64_tr_b16 v[66:67], v12 offset:17408
    buffer_load_dwordx4 v[128:131], v5, s[16:19], s51 offen offset:1024 sc1
    v_mfma_f32_32x32x16_bf16 v[48:63], v[76:79], v[132:135], v[48:63]
    ds_read_b64_tr_b16 v[68:69], v13 offset:16448
    ds_read_b64_tr_b16 v[70:71], v13 offset:17472
    s_waitcnt vmcnt(14) lgkmcnt(8)
    v_mfma_f32_32x32x16_bf16 v[32:47], v[80:83], v[136:139], v[32:47]
    ds_read_b64_tr_b16 v[72:73], v12 offset:18432
    ds_read_b64_tr_b16 v[74:75], v12 offset:19456
    buffer_load_dwordx4 v[132:135], v5, s[16:19], s51 offen offset:2048 sc1
    v_mfma_f32_32x32x16_bf16 v[48:63], v[84:87], v[136:139], v[48:63]
    ds_read_b64_tr_b16 v[76:77], v13 offset:18496
    ds_read_b64_tr_b16 v[78:79], v13 offset:19520
    s_waitcnt vmcnt(14) lgkmcnt(8)
    v_mfma_f32_32x32x16_bf16 v[32:47], v[88:91], v[140:143], v[32:47]
    ds_read_b64_tr_b16 v[80:81], v12 offset:20480
    ds_read_b64_tr_b16 v[82:83], v12 offset:21504
    buffer_load_dwordx4 v[136:139], v5, s[16:19], s51 offen offset:3072 sc1
    v_mfma_f32_32x32x16_bf16 v[48:63], v[92:95], v[140:143], v[48:63]
    ds_read_b64_tr_b16 v[84:85], v13 offset:20544
    ds_read_b64_tr_b16 v[86:87], v13 offset:21568
    s_add_u32 s51, s51, 16384
    s_waitcnt vmcnt(14) lgkmcnt(8)
    v_mfma_f32_32x32x16_bf16 v[32:47], v[64:67], v[144:147], v[32:47]
    ds_read_b64_tr_b16 v[88:89], v12 offset:22528
    ds_read_b64_tr_b16 v[90:91], v12 offset:23552
    buffer_load_dwordx4 v[140:143], v5, s[16:19], s52 offen offset:0 sc1
    v_mfma_f32_32x32x16_bf16 v[48:63], v[68:71], v[144:147], v[48:63]
    ds_read_b64_tr_b16 v[92:93], v13 offset:22592
    ds_read_b64_tr_b16 v[94:95], v13 offset:23616
    s_waitcnt vmcnt(14) lgkmcnt(8)
    v_mfma_f32_32x32x16_bf16 v[32:47], v[72:75], v[148:151], v[32:47]
    ds_read_b64_tr_b16 v[64:65], v12 offset:24576
    ds_read_b64_tr_b16 v[66:67], v12 offset:25600
    buffer_load_dwordx4 v[144:147], v5, s[16:19], s52 offen offset:1024 sc1
    v_mfma_f32_32x32x16_bf16 v[48:63], v[76:79], v[148:151], v[48:63]
    ds_read_b64_tr_b16 v[68:69], v13 offset:24640
    ds_read_b64_tr_b16 v[70:71], v13 offset:25664
    s_waitcnt vmcnt(14) lgkmcnt(8)
    v_mfma_f32_32x32x16_bf16 v[32:47], v[80:83], v[152:155], v[32:47]
    ds_read_b64_tr_b16 v[72:73], v12 offset:26624
    ds_read_b64_tr_b16 v[74:75], v12 offset:27648
    buffer_load_dwordx4 v[148:151], v5, s[16:19], s52 offen offset:2048 sc1
    v_mfma_f32_32x32x16_bf16 v[48:63], v[84:87], v[152:155], v[48:63]
    ds_read_b64_tr_b16 v[76:77], v13 offset:26688
    ds_read_b64_tr_b16 v[78:79], v13 offset:27712
    s_waitcnt vmcnt(14) lgkmcnt(8)
    v_mfma_f32_32x32x16_bf16 v[32:47], v[88:91], v[156:159], v[32:47]
    ds_read_b64_tr_b16 v[80:81], v12 offset:28672
    ds_read_b64_tr_b16 v[82:83], v12 offset:29696
    buffer_load_dwordx4 v[152:155], v5, s[16:19], s52 offen offset:3072 sc1
    v_mfma_f32_32x32x16_bf16 v[48:63], v[92:95], v[156:159], v[48:63]
    ds_read_b64_tr_b16 v[84:85], v13 offset:28736
    ds_read_b64_tr_b16 v[86:87], v13 offset:29760
    s_add_u32 s52, s52, 16384
    s_waitcnt vmcnt(14) lgkmcnt(8)
    v_mfma_f32_32x32x16_bf16 v[32:47], v[64:67], v[160:163], v[32:47]
    ds_read_b64_tr_b16 v[88:89], v12 offset:30720
    ds_read_b64_tr_b16 v[90:91], v12 offset:31744
    buffer_load_dwordx4 v[156:159], v5, s[16:19], s53 offen offset:0 sc1
    v_mfma_f32_32x32x16_bf16 v[48:63], v[68:71], v[160:163], v[48:63]
    ds_read_b64_tr_b16 v[92:93], v13 offset:30784
    ds_read_b64_tr_b16 v[94:95], v13 offset:31808
    s_waitcnt vmcnt(14) lgkmcnt(8)
    v_mfma_f32_32x32x16_bf16 v[32:47], v[72:75], v[164:167], v[32:47]
    ds_read_b64_tr_b16 v[64:65], v12 offset:32768
    ds_read_b64_tr_b16 v[66:67], v12 offset:33792
    buffer_load_dwordx4 v[160:163], v5, s[16:19], s53 offen offset:1024 sc1
    v_mfma_f32_32x32x16_bf16 v[48:63], v[76:79], v[164:167], v[48:63]
    ds_read_b64_tr_b16 v[68:69], v13 offset:32832
    ds_read_b64_tr_b16 v[70:71], v13 offset:33856
    s_waitcnt vmcnt(14) lgkmcnt(8)
    v_mfma_f32_32x32x16_bf16 v[32:47], v[80:83], v[168:171], v[32:47]
    ds_read_b64_tr_b16 v[72:73], v12 offset:34816
    ds_read_b64_tr_b16 v[74:75], v12 offset:35840
    buffer_load_dwordx4 v[164:167], v5, s[16:19], s53 offen offset:2048 sc1
    v_mfma_f32_32x32x16_bf16 v[48:63], v[84:87], v[168:171], v[48:63]
    ds_read_b64_tr_b16 v[76:77], v13 offset:34880
    ds_read_b64_tr_b16 v[78:79], v13 offset:35904
    s_waitcnt vmcnt(14) lgkmcnt(8)
    v_mfma_f32_32x32x16_bf16 v[32:47], v[88:91], v[172:175], v[32:47]
    ds_read_b64_tr_b16 v[80:81], v12 offset:36864
    ds_read_b64_tr_b16 v[82:83], v12 offset:37888
    buffer_load_dwordx4 v[168:171], v5, s[16:19], s53 offen offset:3072 sc1
    v_add_u32 v12, 32768, v12
    v_mfma_f32_32x32x16_bf16 v[48:63], v[92:95], v[172:175], v[48:63]
    ds_read_b64_tr_b16 v[84:85], v13 offset:36928
    ds_read_b64_tr_b16 v[86:87], v13 offset:37952
    v_add_u32 v13, 32768, v13
    s_add_u32 s53, s53, 16384
    s_sub_u32 s54, s54, 1
    s_cmp_lg_u32 s54, 0
    s_cbranch_scc1 c_wo_loop
    s_cmp_eq_u32 s9, 3
    s_cbranch_scc1 c_wo_fin
    s_add_u32 s58, s58, 4194304
    v_cvt_pk_bf16_f32 v96, v32, v33
    v_cvt_pk_bf16_f32 v97, v34, v35
    v_cvt_pk_bf16_f32 v98, v36, v37
    v_cvt_pk_bf16_f32 v99, v38, v39
    buffer_store_dwordx4 v[96:99], v5, s[12:15], s58 offen offset:0 sc1
    v_cvt_pk_bf16_f32 v100, v40, v41
    v_cvt_pk_bf16_f32 v101, v42, v43
    v_cvt_pk_bf16_f32 v102, v44, v45
    v_cvt_pk_bf16_f32 v103, v46, v47
    buffer_store_dwordx4 v[100:103], v5, s[12:15], s58 offen offset:1024 sc1
    v_cvt_pk_bf16_f32 v104, v48, v49
    v_cvt_pk_bf16_f32 v105, v50, v51
    v_cvt_pk_bf16_f32 v106, v52, v53
    v_cvt_pk_bf16_f32 v107, v54, v55
    buffer_store_dwordx4 v[104:107], v5, s[12:15], s58 offen offset:2048 sc1
    v_cvt_pk_bf16_f32 v108, v56, v57
    v_cvt_pk_bf16_f32 v109, v58, v59
    v_cvt_pk_bf16_f32 v110, v60, v61
    v_cvt_pk_bf16_f32 v111, v62, v63
    buffer_store_dwordx4 v[108:111], v5, s[12:15], s58 offen offset:3072 sc1
    s_barrier
c_wo_stat:
    v_mov_b32 v22, 0x3f803f80
    v_mov_b32 v18, 0
    v_mov_b32 v19, 0
    v_dot2_f32_bf16 v18, v96, v22, v18
    v_dot2_f32_bf16 v19, v96, v96, v19
    v_dot2_f32_bf16 v18, v97, v22, v18
    v_dot2_f32_bf16 v19, v97, v97, v19
    v_dot2_f32_bf16 v18, v98, v22, v18
    v_dot2_f32_bf16 v19, v98, v98, v19
    v_dot2_f32_bf16 v18, v99, v22, v18
    v_dot2_f32_bf16 v19, v99, v99, v19
    v_dot2_f32_bf16 v18, v100, v22, v18
    v_dot2_f32_bf16 v19, v100, v100, v19
    v_dot2_f32_bf16 v18, v101, v22, v18
    v_dot2_f32_bf16 v19, v101, v101, v19
    v_dot2_f32_bf16 v18, v102, v22, v18
    v_dot2_f32_bf16 v19, v102, v102, v19
    v_dot2_f32_bf16 v18, v103, v22, v18
    v_dot2_f32_bf16 v19, v103, v103, v19
    v_dot2_f32_bf16 v18, v104, v22, v18
    v_dot2_f32_bf16 v19, v104, v104, v19
    v_dot2_f32_bf16 v18, v105, v22, v18
    v_dot2_f32_bf16 v19, v105, v105, v19
    v_dot2_f32_bf16 v18, v106, v22, v18
    v_dot2_f32_bf16 v19, v106, v106, v19
    v_dot2_f32_bf16 v18, v107, v22, v18
    v_dot2_f32_bf16 v19, v107, v107, v19
    v_dot2_f32_bf16 v18, v108, v22, v18
    v_dot2_f32_bf16 v19, v108, v108, v19
    v_dot2_f32_bf16 v18, v109, v22, v18
    v_dot2_f32_bf16 v19, v109, v109, v19
    v_dot2_f32_bf16 v18, v110, v22, v18
    v_dot2_f32_bf16 v19, v110, v110, v19
    v_dot2_f32_bf16 v18, v111, v22, v18
    v_dot2_f32_bf16 v19, v111, v111, v19
    v_lshlrev_b32 v16, 3, v1
    s_lshl_b32 s3, s48, 12
    s_lshl_b32 s55, s7, 8
    v_mov_b32 v20, v18
    v_mov_b32 v21, v19
    s_add_u32 s3, s3, s55
    s_lshl_b32 s55, s9, 18
    v_permlane32_swap_b32 v18, v20
    v_permlane32_swap_b32 v19, v21
    s_add_u32 s3, s3, s55
    s_add_u32 s3, s3, 63176704
    v_pk_add_f32 v[18:19], v[18:19], v[20:21]
    s_mov_b32 exec_hi, 0
    buffer_store_dwordx2 v[18:19], v16, s[12:15], s3 offen sc1
    s_mov_b64 exec, -1
    s_cmp_lg_u32 s9, -1
    s_cbranch_scc1 c_wo_pub
    s_barrier
    v_mov_b32 v24, 159492
non_2:
    ds_read_b32 v25, v24
    s_waitcnt lgkmcnt(0)
    v_readfirstlane_b32 s10, v25
    s_cmp_eq_u32 s10, 0
    s_cbranch_scc1 non_2
c_wo_pub:
    s_mul_i32 s55, s9, 786432
    s_add_u32 s55, s55, 66060288
    v_and_b32 v24, 63, v0
    s_and_b32 s56, s11, 0xe0
    v_lshrrev_b32 v25, 5, v24
    v_add_u32 v24, s56, v24
    v_and_b32 v24, 255, v24
    v_lshlrev_b32 v24, 10, v24
    v_lshl_add_u32 v24, v25, 8, v24
    s_bfe_u32 s56, s11, 0x20003
    s_and_b32 s57, s11, 7
    s_lshl_b32 s56, s56, 7
    s_lshl_b32 s57, s57, 2
    s_add_u32 s55, s55, s56
    s_add_u32 s55, s55, s57
    s_and_b32 s57, s6, s9
    s_bfe_i32 s57, s57, 0x10000
    v_mov_b32 v25, 159488
    v_mov_b32 v26, 1
    v_mov_b32 v27, s10
    s_mov_b64 exec, 1
    s_waitcnt vmcnt(0)
    ds_add_rtn_u32 v26, v25, v26
    s_waitcnt lgkmcnt(0)
    v_readfirstlane_b32 s56, v26
    s_and_b32 s56, s56, 3
    s_cmp_lg_u32 s56, 3
    s_cbranch_scc1 pub_3
    s_mov_b32 exec_lo, -1
    s_mov_b32 exec_hi, s57
    buffer_store_dword v27, v24, s[12:15], s55 offen sc1
pub_3:
    s_mov_b64 exec, -1
    s_add_u32 s9, s9, 1
    s_bitcmp1_b32 s9, 0
    s_cbranch_scc1 c_qkvB
    s_branch c_qkvA
c_wo_fin:
    s_barrier
    v_cvt_pk_bf16_f32 v96, v32, v33
    v_cvt_pk_bf16_f32 v97, v34, v35
    v_cvt_pk_bf16_f32 v98, v36, v37
    v_cvt_pk_bf16_f32 v99, v38, v39
    v_cvt_pk_bf16_f32 v100, v40, v41
    v_cvt_pk_bf16_f32 v101, v42, v43
    v_cvt_pk_bf16_f32 v102, v44, v45
    v_cvt_pk_bf16_f32 v103, v46, v47
    v_cvt_pk_bf16_f32 v104, v48, v49
    v_cvt_pk_bf16_f32 v105, v50, v51
    v_cvt_pk_bf16_f32 v106, v52, v53
    v_cvt_pk_bf16_f32 v107, v54, v55
    v_cvt_pk_bf16_f32 v108, v56, v57
    v_cvt_pk_bf16_f32 v109, v58, v59
    v_cvt_pk_bf16_f32 v110, v60, v61
    v_cvt_pk_bf16_f32 v111, v62, v63
    s_mov_b32 s28, s44
    s_mov_b32 s29, s45
    s_mov_b32 s30, 4194304
    s_mov_b32 s31, 0x00020000
    v_and_b32 v16, 31, v1
    v_mul_u32_u24 v16, 144, v16
    v_lshl_add_u32 v16, v3, 3, v16
    v_mul_u32_u24 v17, 4608, v2
    v_add_u32 v16, v16, v17
    ds_write_b64 v16, v[96:97] offset:0
    ds_write_b64 v16, v[98:99] offset:16
    ds_write_b64 v16, v[100:101] offset:32
    ds_write_b64 v16, v[102:103] offset:48
    ds_write_b64 v16, v[104:105] offset:64
    ds_write_b64 v16, v[106:107] offset:80
    ds_write_b64 v16, v[108:109] offset:96
    ds_write_b64 v16, v[110:111] offset:112
    v_lshrrev_b32 v18, 3, v1
    v_and_b32 v19, 7, v1
    v_mul_u32_u24 v20, 144, v18
    v_lshl_add_u32 v20, v19, 4, v20
    v_add_u32 v20, v20, v17
    v_lshlrev_b32 v21, 11, v18
    v_lshl_add_u32 v21, v19, 4, v21
    s_lshl_b32 s3, s48, 16
    s_lshl_b32 s55, s7, 7
    s_add_u32 s3, s3, s55
    s_waitcnt lgkmcnt(0)
    ds_read_b128 v[32:35], v20 offset:0
    ds_read_b128 v[36:39], v20 offset:1152
    ds_read_b128 v[40:43], v20 offset:2304
    ds_read_b128 v[44:47], v20 offset:3456
    s_waitcnt lgkmcnt(3)
    buffer_store_dwordx4 v[32:35], v21, s[28:31], s3 offen sc1
    s_add_u32 s3, s3, 16384
    s_waitcnt lgkmcnt(2)
    buffer_store_dwordx4 v[36:39], v21, s[28:31], s3 offen sc1
    s_add_u32 s3, s3, 16384
    s_waitcnt lgkmcnt(1)
    buffer_store_dwordx4 v[40:43], v21, s[28:31], s3 offen sc1
    s_add_u32 s3, s3, 16384
    s_waitcnt lgkmcnt(0)
    buffer_store_dwordx4 v[44:47], v21, s[28:31], s3 offen sc1
    s_add_u32 s3, s3, 16384
    s_branch k_exit
c_prep:
    s_mov_b32 s28, s32
    s_mov_b32 s29, s33
    s_mov_b32 s30, 4194304
    s_mov_b32 s31, 0x00020000
    s_lshl_b32 s48, s6, 2
    s_add_u32 s48, s48, s8
    v_lshrrev_b32 v16, 3, v1
    v_and_b32 v17, 7, v1
    v_lshlrev_b32 v18, 11, v16
    v_lshl_add_u32 v18, v17, 4, v18
    s_lshl_b32 s55, s48, 16
    s_lshl_b32 s56, s7, 7
    s_add_u32 s3, s55, s56
    buffer_load_dwordx4 v[32:35], v18, s[28:31], s3 offen nt
    s_add_u32 s3, s3, 16384
    buffer_load_dwordx4 v[36:39], v18, s[28:31], s3 offen nt
    s_add_u32 s3, s3, 16384
    buffer_load_dwordx4 v[40:43], v18, s[28:31], s3 offen nt
    s_add_u32 s3, s3, 16384
    buffer_load_dwordx4 v[44:47], v18, s[28:31], s3 offen nt
    s_add_u32 s3, s3, 16384
    s_barrier
    s_lshl_b32 s56, s7, 12
    s_add_u32 s58, s55, s56
    v_lshlrev_b32 v5, 4, v1
    s_lshl_b32 s3, s8, 12
    s_add_u32 s3, s3, 131072
    v_lshrrev_b32 v18, 1, v17
    v_lshlrev_b32 v18, 10, v18
    v_lshl_add_u32 v18, v16, 4, v18
    v_and_b32 v17, 1, v17
    v_lshl_add_u32 v18, v17, 3, v18
    v_add_u32 v18, s3, v18
    v_add_u32 v19, s3, v5
    s_waitcnt vmcnt(3)
    ds_write_b64 v18, v[32:33] offset:0
    ds_write_b64 v18, v[34:35] offset:512
    s_waitcnt vmcnt(2)
    ds_write_b64 v18, v[36:37] offset:128
    ds_write_b64 v18, v[38:39] offset:640
    s_waitcnt vmcnt(1)
    ds_write_b64 v18, v[40:41] offset:256
    ds_write_b64 v18, v[42:43] offset:768
    s_waitcnt vmcnt(0)
    ds_write_b64 v18, v[44:45] offset:384
    ds_write_b64 v18, v[46:47] offset:896
    s_waitcnt lgkmcnt(0)
    ds_read_b128 v[96:99], v19 offset:0
    ds_read_b128 v[100:103], v19 offset:1024
    ds_read_b128 v[104:107], v19 offset:2048
    ds_read_b128 v[108:111], v19 offset:3072
    s_waitcnt lgkmcnt(3)
    buffer_store_dwordx4 v[96:99], v5, s[12:15], s58 offen offset:0 sc1
    s_waitcnt lgkmcnt(2)
    buffer_store_dwordx4 v[100:103], v5, s[12:15], s58 offen offset:1024 sc1
    s_waitcnt lgkmcnt(1)
    buffer_store_dwordx4 v[104:107], v5, s[12:15], s58 offen offset:2048 sc1
    s_waitcnt lgkmcnt(0)
    buffer_store_dwordx4 v[108:111], v5, s[12:15], s58 offen offset:3072 sc1
    s_branch c_wo_stat
.p2align 6
c_qkvB:
    v_and_b32 v1, 63, v0
    v_lshrrev_b32 v2, 6, v0
    v_lshlrev_b32 v5, 4, v1
    v_lshrrev_b32 v3, 5, v1
    v_and_b32 v4, 15, v0
    v_bfe_u32 v7, v1, 4, 1
    v_lshl_add_u32 v6, v7, 5, v4
    v_lshlrev_b32 v6, 4, v6
    v_lshl_add_u32 v6, v3, 10, v6
    s_lshr_b32 s48, s6, 1
    s_lshl_b32 s48, s48, 2
    s_add_u32 s48, s48, s8
    s_lshl_b32 s55, s48, 17
    s_lshl_b32 s56, s9, 22
    s_add_u32 s55, s55, s56
    s_add_u32 s16, s4, s55
    s_addc_u32 s17, s5, 0
    s_mov_b32 s18, 65536
    s_mov_b32 s19, 0x00020000
    s_add_u32 s56, s55, 65536
    s_add_u32 s20, s4, s56
    s_addc_u32 s21, s5, 0
    s_mov_b32 s22, 65536
    s_mov_b32 s23, 0x00020000
    s_lshl_b32 s49, s7, 12
    s_add_u32 s49, s49, s55
    s_and_b32 s56, s6, 1
    s_lshl_b32 s56, s56, 11
    s_add_u32 s49, s49, s56
    s_add_u32 s49, s49, 16777216
    s_movk_i32 s54, 4096
    v_lshrrev_b32 v16, 2, v4
    v_lshl_add_u32 v18, v7, 2, v16
    v_lshl_add_u32 v18, v3, 4, v18
    v_lshlrev_b32 v18, 6, v18
    v_and_b32 v17, 3, v4
    v_lshl_add_u32 v18, v17, 3, v18
    v_lshl_add_u32 v26, v7, 5, v18
    v_xor_b32 v27, 32, v26
    v_mov_b32 v24, v26
    v_mov_b32 v25, v27
    v_and_b32 v18, 0x30, v1
    v_add_u32 v10, 155648, v18
    v_lshlrev_b32 v11, 2, v4
    v_add_u32 v11, 155648, v11
    v_lshl_add_u32 v8, v2, 8, v11
    v_lshl_add_u32 v9, v2, 8, v10
    s_lshr_b32 s3, s8, 1
    s_and_b32 s55, s8, 1
    s_lshl_b32 s3, s3, 14
    s_lshl_b32 s55, s55, 12
    s_add_u32 s3, s3, s55
    s_add_u32 s3, s3, 81920
    v_lshl_add_u32 v12, v3, 5, v4
    v_lshlrev_b32 v12, 4, v12
    v_lshl_add_u32 v12, v7, 10, v12
    v_add_u32 v12, s3, v12
    v_add_u32 v13, s3, v5
    v_mov_b32 v32, 0
    v_mov_b32 v33, 0
    v_mov_b32 v34, 0
    v_mov_b32 v35, 0
    v_mov_b32 v36, 0
    v_mov_b32 v37, 0
    v_mov_b32 v38, 0
    v_mov_b32 v39, 0
    v_mov_b32 v40, 0
    v_mov_b32 v41, 0
    v_mov_b32 v42, 0
    v_mov_b32 v43, 0
    v_mov_b32 v44, 0
    v_mov_b32 v45, 0
    v_mov_b32 v46, 0
    v_mov_b32 v47, 0
    v_mov_b32 v48, 0
    v_mov_b32 v49, 0
    v_mov_b32 v50, 0
    v_mov_b32 v51, 0
    v_mov_b32 v52, 0
    v_mov_b32 v53, 0
    v_mov_b32 v54, 0
    v_mov_b32 v55, 0
    v_mov_b32 v56, 0
    v_mov_b32 v57, 0
    v_mov_b32 v58, 0
    v_mov_b32 v59, 0
    v_mov_b32 v60, 0
    v_mov_b32 v61, 0
    v_mov_b32 v62, 0
    v_mov_b32 v63, 0
    v_mov_b32 v64, 0
    v_mov_b32 v65, 0
    v_mov_b32 v66, 0
    v_mov_b32 v67, 0
    v_mov_b32 v68, 0
    v_mov_b32 v69, 0
    v_mov_b32 v70, 0
    v_mov_b32 v71, 0
    v_mov_b32 v72, 0
    v_mov_b32 v73, 0
    v_mov_b32 v74, 0
    v_mov_b32 v75, 0
    v_mov_b32 v76, 0
    v_mov_b32 v77, 0
    v_mov_b32 v78, 0
    v_mov_b32 v79, 0
    v_mov_b32 v80, 0
    v_mov_b32 v81, 0
    v_mov_b32 v82, 0
    v_mov_b32 v83, 0
    v_mov_b32 v84, 0
    v_mov_b32 v85, 0
    v_mov_b32 v86, 0
    v_mov_b32 v87, 0
    v_mov_b32 v88, 0
    v_mov_b32 v89, 0
    v_mov_b32 v90, 0
    v_mov_b32 v91, 0
    v_mov_b32 v92, 0
    v_mov_b32 v93, 0
    v_mov_b32 v94, 0
    v_mov_b32 v95, 0
    v_mov_b32 v96, 0
    v_mov_b32 v97, 0
    v_mov_b32 v98, 0
    v_mov_b32 v99, 0
    v_mov_b32 v100, 0
    v_mov_b32 v101, 0
    v_mov_b32 v102, 0
    v_mov_b32 v103, 0
    v_mov_b32 v104, 0
    v_mov_b32 v105, 0
    v_mov_b32 v106, 0
    v_mov_b32 v107, 0
    v_mov_b32 v108, 0
    v_mov_b32 v109, 0
    v_mov_b32 v110, 0
    v_mov_b32 v111, 0
    v_mov_b32 v112, 0
    v_mov_b32 v113, 0
    v_mov_b32 v114, 0
    v_mov_b32 v115, 0
    v_mov_b32 v116, 0
    v_mov_b32 v117, 0
    v_mov_b32 v118, 0
    v_mov_b32 v119, 0
    v_mov_b32 v120, 0
    v_mov_b32 v121, 0
    v_mov_b32 v122, 0
    v_mov_b32 v123, 0
    v_mov_b32 v124, 0
    v_mov_b32 v125, 0
    v_mov_b32 v126, 0
    v_mov_b32 v127, 0
    s_mov_b32 s50, 8192
    s_mov_b32 s58, 6144
    s_mov_b32 s51, 12288
    s_mov_b32 s59, 10240
    s_mov_b32 s52, 0
    s_barrier
    buffer_load_dwordx4 a[0:3], v6, s[16:19], 0 offen offset:0 sc1
    buffer_load_dwordx4 a[4:7], v6, s[16:19], 0 offen offset:256 sc1
    buffer_load_dwordx4 a[8:11], v6, s[20:23], 0 offen offset:0 sc1
    buffer_load_dwordx4 a[12:15], v6, s[20:23], 0 offen offset:256 sc1
    ds_read_b64_tr_b16 v[128:129], v24 offset:0
    ds_read_b64_tr_b16 v[130:131], v24 offset:512
    ds_read_b64_tr_b16 v[132:133], v25 offset:0
    ds_read_b64_tr_b16 v[134:135], v25 offset:512
    ds_read_b64_tr_b16 v[136:137], v24 offset:8192
    ds_read_b64_tr_b16 v[138:139], v24 offset:8704
    ds_read_b64_tr_b16 v[140:141], v25 offset:8192
    ds_read_b64_tr_b16 v[142:143], v25 offset:8704
    ds_read_b64_tr_b16 v[144:145], v24 offset:16384
    ds_read_b64_tr_b16 v[146:147], v24 offset:16896
    buffer_load_dwordx4 a[16:19], v6, s[16:19], 0 offen offset:2048 sc1
    buffer_load_dwordx4 a[20:23], v6, s[16:19], 0 offen offset:2304 sc1
    buffer_load_dwordx4 a[24:27], v6, s[20:23], 0 offen offset:2048 sc1
    buffer_load_dwordx4 a[28:31], v6, s[20:23], 0 offen offset:2304 sc1
    buffer_load_dwordx4 v[152:155], v6, s[16:19], s54 offen offset:0 sc1
    buffer_load_dwordx4 v[156:159], v6, s[16:19], s54 offen offset:256 sc1
    buffer_load_dwordx4 v[160:163], v6, s[20:23], s54 offen offset:0 sc1
    buffer_load_dwordx4 v[164:167], v6, s[20:23], s54 offen offset:256 sc1
    buffer_load_dwordx4 v[168:171], v6, s[16:19], s54 offen offset:2048 sc1
    buffer_load_dwordx4 v[172:175], v6, s[16:19], s54 offen offset:2304 sc1
    s_mov_b32 s54, 8
    s_waitcnt vmcnt(12)
    s_barrier
.p2align 3
c_qkvB_loop:
    s_waitcnt vmcnt(12) lgkmcnt(8)
    v_mfma_f32_16x16x32_bf16 v[32:35], v[128:131], a[0:3], v[32:35]
    ds_read_b64_tr_b16 v[148:149], v25 offset:16384
    buffer_load_dwordx4 v[176:179], v6, s[20:23], s58 offen offset:0 sc1
    v_mfma_f32_16x16x32_bf16 v[36:39], v[128:131], a[4:7], v[36:39]
    ds_read_b64_tr_b16 v[150:151], v25 offset:16896
    s_waitcnt lgkmcnt(8)
    v_mfma_f32_16x16x32_bf16 v[52:55], v[132:135], a[4:7], v[52:55]
    v_mfma_f32_16x16x32_bf16 v[48:51], v[132:135], a[0:3], v[48:51]
    s_waitcnt lgkmcnt(6)
    v_mfma_f32_16x16x32_bf16 v[64:67], v[136:139], a[0:3], v[64:67]
    v_mfma_f32_16x16x32_bf16 v[68:71], v[136:139], a[4:7], v[68:71]
    s_waitcnt lgkmcnt(4)
    v_mfma_f32_16x16x32_bf16 v[84:87], v[140:143], a[4:7], v[84:87]
    buffer_load_dwordx4 v[180:183], v6, s[20:23], s58 offen offset:256 sc1
    v_mfma_f32_16x16x32_bf16 v[80:83], v[140:143], a[0:3], v[80:83]
    s_waitcnt lgkmcnt(2)
    v_mfma_f32_16x16x32_bf16 v[96:99], a[0:3], v[144:147], v[96:99]
    v_mfma_f32_16x16x32_bf16 v[100:103], a[4:7], v[144:147], v[100:103]
    s_waitcnt lgkmcnt(0)
    v_mfma_f32_16x16x32_bf16 v[116:119], a[4:7], v[148:151], v[116:119]
    v_mfma_f32_16x16x32_bf16 v[112:115], a[0:3], v[148:151], v[112:115]
    s_waitcnt vmcnt(12)
    v_mfma_f32_16x16x32_bf16 v[40:43], v[128:131], a[8:11], v[40:43]
    buffer_load_dwordx4 a[0:3], v6, s[16:19], s50 offen offset:0 sc1
    v_mfma_f32_16x16x32_bf16 v[44:47], v[128:131], a[12:15], v[44:47]
    v_mfma_f32_16x16x32_bf16 v[60:63], v[132:135], a[12:15], v[60:63]
    ds_read_b64_tr_b16 v[128:129], v24 offset:2048
    v_mfma_f32_16x16x32_bf16 v[56:59], v[132:135], a[8:11], v[56:59]
    ds_read_b64_tr_b16 v[130:131], v24 offset:2560
    v_mfma_f32_16x16x32_bf16 v[72:75], v[136:139], a[8:11], v[72:75]
    ds_read_b64_tr_b16 v[132:133], v25 offset:2048
    v_mfma_f32_16x16x32_bf16 v[76:79], v[136:139], a[12:15], v[76:79]
    ds_read_b64_tr_b16 v[134:135], v25 offset:2560
    v_mfma_f32_16x16x32_bf16 v[92:95], v[140:143], a[12:15], v[92:95]
    ds_read_b64_tr_b16 v[136:137], v24 offset:10240
    buffer_load_dwordx4 a[4:7], v6, s[16:19], s50 offen offset:256 sc1
    v_mfma_f32_16x16x32_bf16 v[88:91], v[140:143], a[8:11], v[88:91]
    ds_read_b64_tr_b16 v[138:139], v24 offset:10752
    v_mfma_f32_16x16x32_bf16 v[104:107], a[8:11], v[144:147], v[104:107]
    ds_read_b64_tr_b16 v[140:141], v25 offset:10240
    v_mfma_f32_16x16x32_bf16 v[108:111], a[12:15], v[144:147], v[108:111]
    ds_read_b64_tr_b16 v[142:143], v25 offset:10752
    v_mfma_f32_16x16x32_bf16 v[124:127], a[12:15], v[148:151], v[124:127]
    ds_read_b64_tr_b16 v[144:145], v24 offset:18432
    v_mfma_f32_16x16x32_bf16 v[120:123], a[8:11], v[148:151], v[120:123]
    ds_read_b64_tr_b16 v[146:147], v24 offset:18944
    s_waitcnt vmcnt(12) lgkmcnt(8)
    v_mfma_f32_16x16x32_bf16 v[32:35], v[128:131], a[16:19], v[32:35]
    ds_read_b64_tr_b16 v[148:149], v25 offset:18432
    buffer_load_dwordx4 a[8:11], v6, s[20:23], s58 offen offset:2048 sc1
    v_mfma_f32_16x16x32_bf16 v[36:39], v[128:131], a[20:23], v[36:39]
    ds_read_b64_tr_b16 v[150:151], v25 offset:18944
    s_waitcnt lgkmcnt(8)
    v_mfma_f32_16x16x32_bf16 v[52:55], v[132:135], a[20:23], v[52:55]
    v_mfma_f32_16x16x32_bf16 v[48:51], v[132:135], a[16:19], v[48:51]
    s_waitcnt lgkmcnt(6)
    v_mfma_f32_16x16x32_bf16 v[64:67], v[136:139], a[16:19], v[64:67]
    v_mfma_f32_16x16x32_bf16 v[68:71], v[136:139], a[20:23], v[68:71]
    s_waitcnt lgkmcnt(4)
    v_mfma_f32_16x16x32_bf16 v[84:87], v[140:143], a[20:23], v[84:87]
    buffer_load_dwordx4 a[12:15], v6, s[20:23], s58 offen offset:2304 sc1
    v_mfma_f32_16x16x32_bf16 v[80:83], v[140:143], a[16:19], v[80:83]
    s_waitcnt lgkmcnt(2)
    v_mfma_f32_16x16x32_bf16 v[96:99], a[16:19], v[144:147], v[96:99]
    v_mfma_f32_16x16x32_bf16 v[100:103], a[20:23], v[144:147], v[100:103]
    s_waitcnt lgkmcnt(0)
    v_mfma_f32_16x16x32_bf16 v[116:119], a[20:23], v[148:151], v[116:119]
    v_mfma_f32_16x16x32_bf16 v[112:115], a[16:19], v[148:151], v[112:115]
    s_waitcnt vmcnt(12)
    v_mfma_f32_16x16x32_bf16 v[40:43], v[128:131], a[24:27], v[40:43]
    buffer_load_dwordx4 a[16:19], v6, s[16:19], s50 offen offset:2048 sc1
    v_mfma_f32_16x16x32_bf16 v[44:47], v[128:131], a[28:31], v[44:47]
    v_mfma_f32_16x16x32_bf16 v[60:63], v[132:135], a[28:31], v[60:63]
    ds_read_b64_tr_b16 v[128:129], v24 offset:4096
    v_mfma_f32_16x16x32_bf16 v[56:59], v[132:135], a[24:27], v[56:59]
    ds_read_b64_tr_b16 v[130:131], v24 offset:4608
    v_mfma_f32_16x16x32_bf16 v[72:75], v[136:139], a[24:27], v[72:75]
    ds_read_b64_tr_b16 v[132:133], v25 offset:4096
    v_mfma_f32_16x16x32_bf16 v[76:79], v[136:139], a[28:31], v[76:79]
    ds_read_b64_tr_b16 v[134:135], v25 offset:4608
    v_mfma_f32_16x16x32_bf16 v[92:95], v[140:143], a[28:31], v[92:95]
    ds_read_b64_tr_b16 v[136:137], v24 offset:12288
    buffer_load_dwordx4 a[20:23], v6, s[16:19], s50 offen offset:2304 sc1
    v_mfma_f32_16x16x32_bf16 v[88:91], v[140:143], a[24:27], v[88:91]
    ds_read_b64_tr_b16 v[138:139], v24 offset:12800
    v_mfma_f32_16x16x32_bf16 v[104:107], a[24:27], v[144:147], v[104:107]
    ds_read_b64_tr_b16 v[140:141], v25 offset:12288
    v_mfma_f32_16x16x32_bf16 v[108:111], a[28:31], v[144:147], v[108:111]
    ds_read_b64_tr_b16 v[142:143], v25 offset:12800
    v_mfma_f32_16x16x32_bf16 v[124:127], a[28:31], v[148:151], v[124:127]
    ds_read_b64_tr_b16 v[144:145], v24 offset:20480
    v_mfma_f32_16x16x32_bf16 v[120:123], a[24:27], v[148:151], v[120:123]
    ds_read_b64_tr_b16 v[146:147], v24 offset:20992
    s_waitcnt vmcnt(12) lgkmcnt(8)
    v_mfma_f32_16x16x32_bf16 v[32:35], v[128:131], v[152:155], v[32:35]
    ds_read_b64_tr_b16 v[148:149], v25 offset:20480
    buffer_load_dwordx4 a[24:27], v6, s[20:23], s59 offen offset:0 sc1
    v_mfma_f32_16x16x32_bf16 v[36:39], v[128:131], v[156:159], v[36:39]
    ds_read_b64_tr_b16 v[150:151], v25 offset:20992
    s_waitcnt lgkmcnt(8)
    v_mfma_f32_16x16x32_bf16 v[52:55], v[132:135], v[156:159], v[52:55]
    v_mfma_f32_16x16x32_bf16 v[48:51], v[132:135], v[152:155], v[48:51]
    s_waitcnt lgkmcnt(6)
    v_mfma_f32_16x16x32_bf16 v[64:67], v[136:139], v[152:155], v[64:67]
    v_mfma_f32_16x16x32_bf16 v[68:71], v[136:139], v[156:159], v[68:71]
    s_waitcnt lgkmcnt(4)
    v_mfma_f32_16x16x32_bf16 v[84:87], v[140:143], v[156:159], v[84:87]
    buffer_load_dwordx4 a[28:31], v6, s[20:23], s59 offen offset:256 sc1
    v_mfma_f32_16x16x32_bf16 v[80:83], v[140:143], v[152:155], v[80:83]
    s_waitcnt lgkmcnt(2)
    v_mfma_f32_16x16x32_bf16 v[96:99], v[152:155], v[144:147], v[96:99]
    v_mfma_f32_16x16x32_bf16 v[100:103], v[156:159], v[144:147], v[100:103]
    s_waitcnt lgkmcnt(0)
    v_mfma_f32_16x16x32_bf16 v[116:119], v[156:159], v[148:151], v[116:119]
    v_mfma_f32_16x16x32_bf16 v[112:115], v[152:155], v[148:151], v[112:115]
    s_waitcnt vmcnt(12)
    v_mfma_f32_16x16x32_bf16 v[40:43], v[128:131], v[160:163], v[40:43]
    buffer_load_dwordx4 v[152:155], v6, s[16:19], s51 offen offset:0 sc1
    v_mfma_f32_16x16x32_bf16 v[44:47], v[128:131], v[164:167], v[44:47]
    v_mfma_f32_16x16x32_bf16 v[60:63], v[132:135], v[164:167], v[60:63]
    ds_read_b64_tr_b16 v[128:129], v24 offset:6144
    v_mfma_f32_16x16x32_bf16 v[56:59], v[132:135], v[160:163], v[56:59]
    ds_read_b64_tr_b16 v[130:131], v24 offset:6656
    v_mfma_f32_16x16x32_bf16 v[72:75], v[136:139], v[160:163], v[72:75]
    ds_read_b64_tr_b16 v[132:133], v25 offset:6144
    v_mfma_f32_16x16x32_bf16 v[76:79], v[136:139], v[164:167], v[76:79]
    ds_read_b64_tr_b16 v[134:135], v25 offset:6656
    v_mfma_f32_16x16x32_bf16 v[92:95], v[140:143], v[164:167], v[92:95]
    ds_read_b64_tr_b16 v[136:137], v24 offset:14336
    buffer_load_dwordx4 v[156:159], v6, s[16:19], s51 offen offset:256 sc1
    v_mfma_f32_16x16x32_bf16 v[88:91], v[140:143], v[160:163], v[88:91]
    ds_read_b64_tr_b16 v[138:139], v24 offset:14848
    v_mfma_f32_16x16x32_bf16 v[104:107], v[160:163], v[144:147], v[104:107]
    ds_read_b64_tr_b16 v[140:141], v25 offset:14336
    v_mfma_f32_16x16x32_bf16 v[108:111], v[164:167], v[144:147], v[108:111]
    ds_read_b64_tr_b16 v[142:143], v25 offset:14848
    v_mfma_f32_16x16x32_bf16 v[124:127], v[164:167], v[148:151], v[124:127]
    ds_read_b64_tr_b16 v[144:145], v24 offset:22528
    v_mfma_f32_16x16x32_bf16 v[120:123], v[160:163], v[148:151], v[120:123]
    ds_read_b64_tr_b16 v[146:147], v24 offset:23040
    s_waitcnt vmcnt(12) lgkmcnt(8)
    v_mfma_f32_16x16x32_bf16 v[32:35], v[128:131], v[168:171], v[32:35]
    ds_read_b64_tr_b16 v[148:149], v25 offset:22528
    buffer_load_dwordx4 v[160:163], v6, s[20:23], s59 offen offset:2048 sc1
    v_mfma_f32_16x16x32_bf16 v[36:39], v[128:131], v[172:175], v[36:39]
    ds_read_b64_tr_b16 v[150:151], v25 offset:23040
    s_waitcnt lgkmcnt(8)
    v_mfma_f32_16x16x32_bf16 v[52:55], v[132:135], v[172:175], v[52:55]
    v_mfma_f32_16x16x32_bf16 v[48:51], v[132:135], v[168:171], v[48:51]
    s_waitcnt lgkmcnt(6)
    v_mfma_f32_16x16x32_bf16 v[64:67], v[136:139], v[168:171], v[64:67]
    v_mfma_f32_16x16x32_bf16 v[68:71], v[136:139], v[172:175], v[68:71]
    s_waitcnt lgkmcnt(4)
    v_mfma_f32_16x16x32_bf16 v[84:87], v[140:143], v[172:175], v[84:87]
    buffer_load_dwordx4 v[164:167], v6, s[20:23], s59 offen offset:2304 sc1
    v_mfma_f32_16x16x32_bf16 v[80:83], v[140:143], v[168:171], v[80:83]
    s_waitcnt lgkmcnt(2)
    v_mfma_f32_16x16x32_bf16 v[96:99], v[168:171], v[144:147], v[96:99]
    s_add_u32 s52, s52, 24576
    v_mfma_f32_16x16x32_bf16 v[100:103], v[172:175], v[144:147], v[100:103]
    s_cmp_eq_u32 s52, 147456
    s_waitcnt lgkmcnt(0)
    v_mfma_f32_16x16x32_bf16 v[116:119], v[172:175], v[148:151], v[116:119]
    s_cselect_b32 s52, 0, s52
    v_mfma_f32_16x16x32_bf16 v[112:115], v[168:171], v[148:151], v[112:115]
    s_add_u32 s58, s58, 8192
    s_add_u32 s59, s59, 8192
    s_waitcnt vmcnt(12)
    v_mfma_f32_16x16x32_bf16 v[40:43], v[128:131], v[176:179], v[40:43]
    buffer_load_dwordx4 v[168:171], v6, s[16:19], s51 offen offset:2048 sc1
    s_barrier
    v_add_u32 v24, s52, v26
    v_mfma_f32_16x16x32_bf16 v[44:47], v[128:131], v[180:183], v[44:47]
    v_add_u32 v25, s52, v27
    v_mfma_f32_16x16x32_bf16 v[60:63], v[132:135], v[180:183], v[60:63]
    ds_read_b64_tr_b16 v[128:129], v24 offset:0
    v_mfma_f32_16x16x32_bf16 v[56:59], v[132:135], v[176:179], v[56:59]
    ds_read_b64_tr_b16 v[130:131], v24 offset:512
    v_mfma_f32_16x16x32_bf16 v[72:75], v[136:139], v[176:179], v[72:75]
    ds_read_b64_tr_b16 v[132:133], v25 offset:0
    v_mfma_f32_16x16x32_bf16 v[76:79], v[136:139], v[180:183], v[76:79]
    ds_read_b64_tr_b16 v[134:135], v25 offset:512
    v_mfma_f32_16x16x32_bf16 v[92:95], v[140:143], v[180:183], v[92:95]
    ds_read_b64_tr_b16 v[136:137], v24 offset:8192
    buffer_load_dwordx4 v[172:175], v6, s[16:19], s51 offen offset:2304 sc1
    v_mfma_f32_16x16x32_bf16 v[88:91], v[140:143], v[176:179], v[88:91]
    ds_read_b64_tr_b16 v[138:139], v24 offset:8704
    v_mfma_f32_16x16x32_bf16 v[104:107], v[176:179], v[144:147], v[104:107]
    ds_read_b64_tr_b16 v[140:141], v25 offset:8192
    s_add_u32 s50, s50, 8192
    v_mfma_f32_16x16x32_bf16 v[108:111], v[180:183], v[144:147], v[108:111]
    ds_read_b64_tr_b16 v[142:143], v25 offset:8704
    s_add_u32 s51, s51, 8192
    v_mfma_f32_16x16x32_bf16 v[124:127], v[180:183], v[148:151], v[124:127]
    ds_read_b64_tr_b16 v[144:145], v24 offset:16384
    s_sub_u32 s54, s54, 1
    v_mfma_f32_16x16x32_bf16 v[120:123], v[176:179], v[148:151], v[120:123]
    ds_read_b64_tr_b16 v[146:147], v24 offset:16896
    s_cmp_lg_u32 s54, 0
    s_cbranch_scc1 c_qkvB_loop
    ds_read_b32 v184, v8 offset:1280
    ds_read_b32 v185, v8 offset:2816
    ds_read_b32 v186, v8 offset:1344
    ds_read_b32 v187, v8 offset:2880
    ds_read_b32 v188, v8 offset:1408
    ds_read_b32 v189, v8 offset:2944
    ds_read_b32 v190, v8 offset:1472
    ds_read_b32 v191, v8 offset:3008
    ds_read_b128 v[212:215], v10 offset:512
    ds_read_b128 v[216:219], v10 offset:576
    ds_read2_b32 v[220:221], v11 offset0:160 offset1:176
    s_waitcnt vmcnt(0) lgkmcnt(11)
    ds_read_b128 v[128:131], v9 offset:1280
    ds_read_b128 v[144:147], v9 offset:2816
    ds_read_b128 v[132:135], v9 offset:1344
    ds_read_b128 v[148:151], v9 offset:2880
    ds_read_b128 v[136:139], v9 offset:1408
    ds_read_b128 v[152:155], v9 offset:2944
    ds_read_b128 v[140:143], v9 offset:1472
    ds_read_b128 v[156:159], v9 offset:3008
    s_waitcnt lgkmcnt(9)
    ds_read_b128 v[192:195], v10 offset:384
    ds_read_b128 v[196:199], v10 offset:448
    v_pk_fma_f32 v[64:65], v[184:185], v[212:213], v[64:65] op_sel_hi:[0,1,1] neg_lo:[1,0,0] neg_hi:[1,0,0]
    v_pk_fma_f32 v[66:67], v[184:185], v[214:215], v[66:67] op_sel_hi:[0,1,1] neg_lo:[1,0,0] neg_hi:[1,0,0]
    v_pk_fma_f32 v[80:81], v[184:185], v[216:217], v[80:81] op_sel_hi:[0,1,1] neg_lo:[1,0,0] neg_hi:[1,0,0]
    v_pk_fma_f32 v[82:83], v[184:185], v[218:219], v[82:83] op_sel_hi:[0,1,1] neg_lo:[1,0,0] neg_hi:[1,0,0]
    v_pk_mul_f32 v[64:65], v[184:185], v[64:65] op_sel:[1,0] op_sel_hi:[1,1]
    v_pk_mul_f32 v[66:67], v[184:185], v[66:67] op_sel:[1,0] op_sel_hi:[1,1]
    v_pk_mul_f32 v[80:81], v[184:185], v[80:81] op_sel:[1,0] op_sel_hi:[1,1]
    v_pk_mul_f32 v[82:83], v[184:185], v[82:83] op_sel:[1,0] op_sel_hi:[1,1]
    v_cvt_pk_bf16_f32 v64, v64, v65
    v_cvt_pk_bf16_f32 v65, v66, v67
    v_cvt_pk_bf16_f32 v66, v80, v81
    v_cvt_pk_bf16_f32 v67, v82, v83
    ds_write_b128 v12, v[64:67] offset:0
    v_pk_fma_f32 v[68:69], v[186:187], v[212:213], v[68:69] op_sel_hi:[0,1,1] neg_lo:[1,0,0] neg_hi:[1,0,0]
    v_pk_fma_f32 v[70:71], v[186:187], v[214:215], v[70:71] op_sel_hi:[0,1,1] neg_lo:[1,0,0] neg_hi:[1,0,0]
    v_pk_fma_f32 v[84:85], v[186:187], v[216:217], v[84:85] op_sel_hi:[0,1,1] neg_lo:[1,0,0] neg_hi:[1,0,0]
    v_pk_fma_f32 v[86:87], v[186:187], v[218:219], v[86:87] op_sel_hi:[0,1,1] neg_lo:[1,0,0] neg_hi:[1,0,0]
    v_pk_mul_f32 v[68:69], v[186:187], v[68:69] op_sel:[1,0] op_sel_hi:[1,1]
    v_pk_mul_f32 v[70:71], v[186:187], v[70:71] op_sel:[1,0] op_sel_hi:[1,1]
    v_pk_mul_f32 v[84:85], v[186:187], v[84:85] op_sel:[1,0] op_sel_hi:[1,1]
    v_pk_mul_f32 v[86:87], v[186:187], v[86:87] op_sel:[1,0] op_sel_hi:[1,1]
    v_cvt_pk_bf16_f32 v68, v68, v69
    v_cvt_pk_bf16_f32 v69, v70, v71
    v_cvt_pk_bf16_f32 v70, v84, v85
    v_cvt_pk_bf16_f32 v71, v86, v87
    ds_write_b128 v12, v[68:71] offset:256
    v_pk_fma_f32 v[72:73], v[188:189], v[212:213], v[72:73] op_sel_hi:[0,1,1] neg_lo:[1,0,0] neg_hi:[1,0,0]
    v_pk_fma_f32 v[74:75], v[188:189], v[214:215], v[74:75] op_sel_hi:[0,1,1] neg_lo:[1,0,0] neg_hi:[1,0,0]
    v_pk_fma_f32 v[88:89], v[188:189], v[216:217], v[88:89] op_sel_hi:[0,1,1] neg_lo:[1,0,0] neg_hi:[1,0,0]
    v_pk_fma_f32 v[90:91], v[188:189], v[218:219], v[90:91] op_sel_hi:[0,1,1] neg_lo:[1,0,0] neg_hi:[1,0,0]
    v_pk_mul_f32 v[72:73], v[188:189], v[72:73] op_sel:[1,0] op_sel_hi:[1,1]
    v_pk_mul_f32 v[74:75], v[188:189], v[74:75] op_sel:[1,0] op_sel_hi:[1,1]
    v_pk_mul_f32 v[88:89], v[188:189], v[88:89] op_sel:[1,0] op_sel_hi:[1,1]
    v_pk_mul_f32 v[90:91], v[188:189], v[90:91] op_sel:[1,0] op_sel_hi:[1,1]
    v_cvt_pk_bf16_f32 v72, v72, v73
    v_cvt_pk_bf16_f32 v73, v74, v75
    v_cvt_pk_bf16_f32 v74, v88, v89
    v_cvt_pk_bf16_f32 v75, v90, v91
    ds_write_b128 v12, v[72:75] offset:2048
    v_pk_fma_f32 v[76:77], v[190:191], v[212:213], v[76:77] op_sel_hi:[0,1,1] neg_lo:[1,0,0] neg_hi:[1,0,0]
    v_pk_fma_f32 v[78:79], v[190:191], v[214:215], v[78:79] op_sel_hi:[0,1,1] neg_lo:[1,0,0] neg_hi:[1,0,0]
    v_pk_fma_f32 v[92:93], v[190:191], v[216:217], v[92:93] op_sel_hi:[0,1,1] neg_lo:[1,0,0] neg_hi:[1,0,0]
    v_pk_fma_f32 v[94:95], v[190:191], v[218:219], v[94:95] op_sel_hi:[0,1,1] neg_lo:[1,0,0] neg_hi:[1,0,0]
    v_pk_mul_f32 v[76:77], v[190:191], v[76:77] op_sel:[1,0] op_sel_hi:[1,1]
    v_pk_mul_f32 v[78:79], v[190:191], v[78:79] op_sel:[1,0] op_sel_hi:[1,1]
    v_pk_mul_f32 v[92:93], v[190:191], v[92:93] op_sel:[1,0] op_sel_hi:[1,1]
    v_pk_mul_f32 v[94:95], v[190:191], v[94:95] op_sel:[1,0] op_sel_hi:[1,1]
    v_cvt_pk_bf16_f32 v76, v76, v77
    v_cvt_pk_bf16_f32 v77, v78, v79
    v_cvt_pk_bf16_f32 v78, v92, v93
    v_cvt_pk_bf16_f32 v79, v94, v95
    ds_write_b128 v12, v[76:79] offset:2304
    s_waitcnt lgkmcnt(4)
    v_pk_fma_f32 v[96:97], v[128:129], v[220:221], v[96:97] op_sel:[0,0,0] op_sel_hi:[1,0,1] neg_lo:[1,0,0] neg_hi:[1,0,0]
    v_pk_fma_f32 v[98:99], v[130:131], v[220:221], v[98:99] op_sel:[0,0,0] op_sel_hi:[1,0,1] neg_lo:[1,0,0] neg_hi:[1,0,0]
    v_pk_mul_f32 v[96:97], v[144:145], v[96:97]
    v_pk_mul_f32 v[98:99], v[146:147], v[98:99]
    v_pk_fma_f32 v[112:113], v[128:129], v[220:221], v[112:113] op_sel:[0,1,0] op_sel_hi:[1,1,1] neg_lo:[1,0,0] neg_hi:[1,0,0]
    v_pk_fma_f32 v[114:115], v[130:131], v[220:221], v[114:115] op_sel:[0,1,0] op_sel_hi:[1,1,1] neg_lo:[1,0,0] neg_hi:[1,0,0]
    v_pk_mul_f32 v[112:113], v[144:145], v[112:113]
    v_pk_mul_f32 v[114:115], v[146:147], v[114:115]
    v_cvt_pk_bf16_f32 v96, v96, v97
    v_cvt_pk_bf16_f32 v97, v98, v99
    v_cvt_pk_bf16_f32 v98, v112, v113
    v_cvt_pk_bf16_f32 v99, v114, v115
    v_mul_f32 v185, 0x3e8293ee, v185
    v_permlane16_swap_b32 v96, v98
    v_permlane16_swap_b32 v97, v99
    ds_write_b128 v13, v[96:99] offset:8192
    v_pk_fma_f32 v[100:101], v[132:133], v[220:221], v[100:101] op_sel:[0,0,0] op_sel_hi:[1,0,1] neg_lo:[1,0,0] neg_hi:[1,0,0]
    v_pk_fma_f32 v[102:103], v[134:135], v[220:221], v[102:103] op_sel:[0,0,0] op_sel_hi:[1,0,1] neg_lo:[1,0,0] neg_hi:[1,0,0]
    v_pk_mul_f32 v[100:101], v[148:149], v[100:101]
    v_pk_mul_f32 v[102:103], v[150:151], v[102:103]
    v_pk_fma_f32 v[116:117], v[132:133], v[220:221], v[116:117] op_sel:[0,1,0] op_sel_hi:[1,1,1] neg_lo:[1,0,0] neg_hi:[1,0,0]
    v_pk_fma_f32 v[118:119], v[134:135], v[220:221], v[118:119] op_sel:[0,1,0] op_sel_hi:[1,1,1] neg_lo:[1,0,0] neg_hi:[1,0,0]
    v_pk_mul_f32 v[116:117], v[148:149], v[116:117]
    v_pk_mul_f32 v[118:119], v[150:151], v[118:119]
    v_cvt_pk_bf16_f32 v100, v100, v101
    v_cvt_pk_bf16_f32 v101, v102, v103
    v_cvt_pk_bf16_f32 v102, v116, v117
    v_cvt_pk_bf16_f32 v103, v118, v119
    v_mul_f32 v187, 0x3e8293ee, v187
    v_permlane16_swap_b32 v100, v102
    v_permlane16_swap_b32 v101, v103
    ds_write_b128 v13, v[100:103] offset:9216
    v_pk_fma_f32 v[104:105], v[136:137], v[220:221], v[104:105] op_sel:[0,0,0] op_sel_hi:[1,0,1] neg_lo:[1,0,0] neg_hi:[1,0,0]
    v_pk_fma_f32 v[106:107], v[138:139], v[220:221], v[106:107] op_sel:[0,0,0] op_sel_hi:[1,0,1] neg_lo:[1,0,0] neg_hi:[1,0,0]
    v_pk_mul_f32 v[104:105], v[152:153], v[104:105]
    v_pk_mul_f32 v[106:107], v[154:155], v[106:107]
    v_pk_fma_f32 v[120:121], v[136:137], v[220:221], v[120:121] op_sel:[0,1,0] op_sel_hi:[1,1,1] neg_lo:[1,0,0] neg_hi:[1,0,0]
    v_pk_fma_f32 v[122:123], v[138:139], v[220:221], v[122:123] op_sel:[0,1,0] op_sel_hi:[1,1,1] neg_lo:[1,0,0] neg_hi:[1,0,0]
    v_pk_mul_f32 v[120:121], v[152:153], v[120:121]
    v_pk_mul_f32 v[122:123], v[154:155], v[122:123]
    v_cvt_pk_bf16_f32 v104, v104, v105
    v_cvt_pk_bf16_f32 v105, v106, v107
    v_cvt_pk_bf16_f32 v106, v120, v121
    v_cvt_pk_bf16_f32 v107, v122, v123
    v_mul_f32 v189, 0x3e8293ee, v189
    v_permlane16_swap_b32 v104, v106
    v_permlane16_swap_b32 v105, v107
    ds_write_b128 v13, v[104:107] offset:10240
    v_pk_fma_f32 v[108:109], v[140:141], v[220:221], v[108:109] op_sel:[0,0,0] op_sel_hi:[1,0,1] neg_lo:[1,0,0] neg_hi:[1,0,0]
    v_pk_fma_f32 v[110:111], v[142:143], v[220:221], v[110:111] op_sel:[0,0,0] op_sel_hi:[1,0,1] neg_lo:[1,0,0] neg_hi:[1,0,0]
    v_pk_mul_f32 v[108:109], v[156:157], v[108:109]
    v_pk_mul_f32 v[110:111], v[158:159], v[110:111]
    v_pk_fma_f32 v[124:125], v[140:141], v[220:221], v[124:125] op_sel:[0,1,0] op_sel_hi:[1,1,1] neg_lo:[1,0,0] neg_hi:[1,0,0]
    v_pk_fma_f32 v[126:127], v[142:143], v[220:221], v[126:127] op_sel:[0,1,0] op_sel_hi:[1,1,1] neg_lo:[1,0,0] neg_hi:[1,0,0]
    v_pk_mul_f32 v[124:125], v[156:157], v[124:125]
    v_pk_mul_f32 v[126:127], v[158:159], v[126:127]
    v_cvt_pk_bf16_f32 v108, v108, v109
    v_cvt_pk_bf16_f32 v109, v110, v111
    v_cvt_pk_bf16_f32 v110, v124, v125
    v_cvt_pk_bf16_f32 v111, v126, v127
    v_mul_f32 v191, 0x3e8293ee, v191
    v_permlane16_swap_b32 v108, v110
    v_permlane16_swap_b32 v109, v111
    ds_write_b128 v13, v[108:111] offset:11264
    v_add_u32 v24, 81920, v5
    v_pk_fma_f32 v[32:33], v[184:185], v[192:193], v[32:33] op_sel_hi:[0,1,1] neg_lo:[1,0,0] neg_hi:[1,0,0]
    v_pk_fma_f32 v[34:35], v[184:185], v[194:195], v[34:35] op_sel_hi:[0,1,1] neg_lo:[1,0,0] neg_hi:[1,0,0]
    v_pk_fma_f32 v[48:49], v[184:185], v[196:197], v[48:49] op_sel_hi:[0,1,1] neg_lo:[1,0,0] neg_hi:[1,0,0]
    v_pk_fma_f32 v[50:51], v[184:185], v[198:199], v[50:51] op_sel_hi:[0,1,1] neg_lo:[1,0,0] neg_hi:[1,0,0]
    s_waitcnt lgkmcnt(0)
    s_barrier
    ds_read_b128 v[128:131], v24 offset:0
    ds_read_b128 v[132:135], v24 offset:1024
    ds_read_b128 v[136:139], v24 offset:2048
    ds_read_b128 v[140:143], v24 offset:3072
    v_pk_mul_f32 v[32:33], v[184:185], v[32:33] op_sel:[1,0] op_sel_hi:[1,1]
    v_pk_mul_f32 v[34:35], v[184:185], v[34:35] op_sel:[1,0] op_sel_hi:[1,1]
    v_pk_mul_f32 v[48:49], v[184:185], v[48:49] op_sel:[1,0] op_sel_hi:[1,1]
    v_pk_mul_f32 v[50:51], v[184:185], v[50:51] op_sel:[1,0] op_sel_hi:[1,1]
    v_cvt_pk_bf16_f32 v8, v32, v33
    v_cvt_pk_bf16_f32 v9, v34, v35
    v_cvt_pk_bf16_f32 v10, v48, v49
    v_cvt_pk_bf16_f32 v11, v50, v51
    v_pk_fma_f32 v[36:37], v[186:187], v[192:193], v[36:37] op_sel_hi:[0,1,1] neg_lo:[1,0,0] neg_hi:[1,0,0]
    v_pk_fma_f32 v[38:39], v[186:187], v[194:195], v[38:39] op_sel_hi:[0,1,1] neg_lo:[1,0,0] neg_hi:[1,0,0]
    v_pk_fma_f32 v[52:53], v[186:187], v[196:197], v[52:53] op_sel_hi:[0,1,1] neg_lo:[1,0,0] neg_hi:[1,0,0]
    v_pk_fma_f32 v[54:55], v[186:187], v[198:199], v[54:55] op_sel_hi:[0,1,1] neg_lo:[1,0,0] neg_hi:[1,0,0]
    v_pk_mul_f32 v[36:37], v[186:187], v[36:37] op_sel:[1,0] op_sel_hi:[1,1]
    v_pk_mul_f32 v[38:39], v[186:187], v[38:39] op_sel:[1,0] op_sel_hi:[1,1]
    v_pk_mul_f32 v[52:53], v[186:187], v[52:53] op_sel:[1,0] op_sel_hi:[1,1]
    v_pk_mul_f32 v[54:55], v[186:187], v[54:55] op_sel:[1,0] op_sel_hi:[1,1]
    v_cvt_pk_bf16_f32 v12, v36, v37
    v_cvt_pk_bf16_f32 v13, v38, v39
    v_cvt_pk_bf16_f32 v14, v52, v53
    v_cvt_pk_bf16_f32 v15, v54, v55
    v_pk_fma_f32 v[40:41], v[188:189], v[192:193], v[40:41] op_sel_hi:[0,1,1] neg_lo:[1,0,0] neg_hi:[1,0,0]
    v_pk_fma_f32 v[42:43], v[188:189], v[194:195], v[42:43] op_sel_hi:[0,1,1] neg_lo:[1,0,0] neg_hi:[1,0,0]
    v_pk_fma_f32 v[56:57], v[188:189], v[196:197], v[56:57] op_sel_hi:[0,1,1] neg_lo:[1,0,0] neg_hi:[1,0,0]
    v_pk_fma_f32 v[58:59], v[188:189], v[198:199], v[58:59] op_sel_hi:[0,1,1] neg_lo:[1,0,0] neg_hi:[1,0,0]
    v_pk_mul_f32 v[40:41], v[188:189], v[40:41] op_sel:[1,0] op_sel_hi:[1,1]
    v_pk_mul_f32 v[42:43], v[188:189], v[42:43] op_sel:[1,0] op_sel_hi:[1,1]
    v_pk_mul_f32 v[56:57], v[188:189], v[56:57] op_sel:[1,0] op_sel_hi:[1,1]
    v_pk_mul_f32 v[58:59], v[188:189], v[58:59] op_sel:[1,0] op_sel_hi:[1,1]
    v_cvt_pk_bf16_f32 v16, v40, v41
    v_cvt_pk_bf16_f32 v17, v42, v43
    v_cvt_pk_bf16_f32 v18, v56, v57
    v_cvt_pk_bf16_f32 v19, v58, v59
    v_pk_fma_f32 v[44:45], v[190:191], v[192:193], v[44:45] op_sel_hi:[0,1,1] neg_lo:[1,0,0] neg_hi:[1,0,0]
    v_pk_fma_f32 v[46:47], v[190:191], v[194:195], v[46:47] op_sel_hi:[0,1,1] neg_lo:[1,0,0] neg_hi:[1,0,0]
    v_pk_fma_f32 v[60:61], v[190:191], v[196:197], v[60:61] op_sel_hi:[0,1,1] neg_lo:[1,0,0] neg_hi:[1,0,0]
    v_pk_fma_f32 v[62:63], v[190:191], v[198:199], v[62:63] op_sel_hi:[0,1,1] neg_lo:[1,0,0] neg_hi:[1,0,0]
    v_pk_mul_f32 v[44:45], v[190:191], v[44:45] op_sel:[1,0] op_sel_hi:[1,1]
    v_pk_mul_f32 v[46:47], v[190:191], v[46:47] op_sel:[1,0] op_sel_hi:[1,1]
    v_pk_mul_f32 v[60:61], v[190:191], v[60:61] op_sel:[1,0] op_sel_hi:[1,1]
    v_pk_mul_f32 v[62:63], v[190:191], v[62:63] op_sel:[1,0] op_sel_hi:[1,1]
    v_cvt_pk_bf16_f32 v20, v44, v45
    v_cvt_pk_bf16_f32 v21, v46, v47
    v_cvt_pk_bf16_f32 v22, v60, v61
    v_cvt_pk_bf16_f32 v23, v62, v63
    v_permlane16_swap_b32 v8, v12
    v_permlane16_swap_b32 v9, v13
    v_permlane16_swap_b32 v10, v14
    v_permlane16_swap_b32 v11, v15
    v_permlane16_swap_b32 v16, v20
    v_permlane16_swap_b32 v17, v21
    v_permlane16_swap_b32 v18, v22
    v_permlane16_swap_b32 v19, v23
    s_waitcnt lgkmcnt(0)
    v_mfma_f32_32x32x16_bf16 v[64:79], v[128:131], v[8:11], 0
    v_mfma_f32_32x32x16_bf16 v[64:79], v[132:135], v[12:15], v[64:79]
    v_and_b32 v28, 7, v1
    v_mov_b32 v29, 0x3f803f80
    v_cmp_eq_u32 vcc, 0, v28
    s_nop 1
    v_cndmask_b32 v200, 0, v29, vcc
    v_cndmask_b32 v201, 0, v29, vcc
    v_cmp_eq_u32 vcc, 4, v28
    s_nop 1
    v_cndmask_b32 v202, 0, v29, vcc
    v_cndmask_b32 v203, 0, v29, vcc
    v_mov_b32 v204, 0xdddddddd
    v_mov_b32 v160, 0
    v_mov_b32 v161, 0
    v_mov_b32 v162, 0
    v_mov_b32 v163, 0
    v_mov_b32 v164, 0
    v_mov_b32 v165, 0
    v_mov_b32 v166, 0
    v_mov_b32 v167, 0
    v_mov_b32 v168, 0
    v_mov_b32 v169, 0
    v_mov_b32 v170, 0
    v_mov_b32 v171, 0
    v_mov_b32 v172, 0
    v_mov_b32 v173, 0
    v_mov_b32 v174, 0
    v_mov_b32 v175, 0
    v_mov_b32 v192, 0
    v_mov_b32 v193, 0
    v_mov_b32 v194, 0
    v_mov_b32 v195, 0
    v_mov_b32 v176, 0
    v_mov_b32 v177, 0
    v_mov_b32 v178, 0
    v_mov_b32 v179, 0
    v_mov_b32 v180, 0
    v_mov_b32 v181, 0
    v_mov_b32 v182, 0
    v_mov_b32 v183, 0
    v_mov_b32 v184, 0
    v_mov_b32 v185, 0
    v_mov_b32 v186, 0
    v_mov_b32 v187, 0
    v_mov_b32 v188, 0
    v_mov_b32 v189, 0
    v_mov_b32 v190, 0
    v_mov_b32 v191, 0
    v_mov_b32 v196, 0
    v_mov_b32 v197, 0
    v_mov_b32 v198, 0
    v_mov_b32 v199, 0
    v_mov_b32 v112, 0
    v_mov_b32 v113, 0
    v_mov_b32 v114, 0
    v_mov_b32 v115, 0
    v_mov_b32 v116, 0
    v_mov_b32 v117, 0
    v_mov_b32 v118, 0
    v_mov_b32 v119, 0
    v_mov_b32 v120, 0
    v_mov_b32 v121, 0
    v_mov_b32 v122, 0
    v_mov_b32 v123, 0
    v_mov_b32 v124, 0
    v_mov_b32 v125, 0
    v_mov_b32 v126, 0
    v_mov_b32 v127, 0
    v_mov_b32 v152, 0
    v_mov_b32 v153, 0
    v_mov_b32 v154, 0
    v_mov_b32 v155, 0
    v_mov_b32 v156, 0
    v_mov_b32 v157, 0
    v_mov_b32 v158, 0
    v_mov_b32 v159, 0
    s_mov_b32 s54, 4
.p2align 3
c_attn_loop:
    v_mfma_f32_32x32x16_bf16 v[80:95], v[128:131], v[16:19], 0
    v_exp_f32 v64, v64
    v_exp_f32 v65, v65
    v_exp_f32 v66, v66
    v_mfma_f32_32x32x16_bf16 v[80:95], v[132:135], v[20:23], v[80:95]
    v_exp_f32 v67, v67
    v_exp_f32 v68, v68
    v_exp_f32 v69, v69
    v_smfmac_f32_32x32x32_bf16 v[176:191], v[152:155], v[112:119], v204
    s_waitcnt lgkmcnt(0)
    v_exp_f32 v70, v70
    v_exp_f32 v71, v71
    v_exp_f32 v72, v72
    v_smfmac_f32_16x16x64_bf16 v[196:199], v[200:203], v[112:119], v204
    ds_read_b128 v[144:147], v24 offset:8192
    v_exp_f32 v73, v73
    v_exp_f32 v74, v74
    v_smfmac_f32_32x32x32_bf16 v[176:191], v[156:159], v[120:127], v204
    v_exp_f32 v75, v75
    v_exp_f32 v76, v76
    v_exp_f32 v77, v77
    v_smfmac_f32_16x16x64_bf16 v[196:199], v[200:203], v[120:127], v204
    ds_read_b128 v[148:151], v24 offset:9216
    v_exp_f32 v78, v78
    v_exp_f32 v79, v79
    v_mfma_f32_32x32x16_bf16 v[96:111], v[136:139], v[8:11], 0
    v_exp_f32 v80, v80
    v_exp_f32 v81, v81
    v_exp_f32 v82, v82
    v_mfma_f32_32x32x16_bf16 v[96:111], v[140:143], v[12:15], v[96:111]
    s_waitcnt lgkmcnt(1)
    v_exp_f32 v83, v83
    v_exp_f32 v84, v84
    v_exp_f32 v85, v85
    v_smfmac_f32_32x32x32_bf16 v[160:175], v[144:147], v[64:71], v204
    s_waitcnt lgkmcnt(0)
    v_exp_f32 v86, v86
    v_exp_f32 v87, v87
    v_exp_f32 v88, v88
    v_smfmac_f32_16x16x64_bf16 v[192:195], v[200:203], v[64:71], v204
    ds_read_b128 v[128:131], v24 offset:4096
    v_exp_f32 v89, v89
    v_exp_f32 v90, v90
    v_smfmac_f32_32x32x32_bf16 v[160:175], v[148:151], v[72:79], v204
    v_exp_f32 v91, v91
    v_exp_f32 v92, v92
    v_exp_f32 v93, v93
    v_smfmac_f32_16x16x64_bf16 v[192:195], v[200:203], v[72:79], v204
    ds_read_b128 v[132:135], v24 offset:5120
    v_exp_f32 v94, v94
    v_exp_f32 v95, v95
    v_mfma_f32_32x32x16_bf16 v[112:127], v[136:139], v[16:19], 0
    v_exp_f32 v96, v96
    v_exp_f32 v97, v97
    v_exp_f32 v98, v98
    v_mfma_f32_32x32x16_bf16 v[112:127], v[140:143], v[20:23], v[112:127]
    v_exp_f32 v99, v99
    v_exp_f32 v100, v100
    v_exp_f32 v101, v101
    v_smfmac_f32_32x32x32_bf16 v[176:191], v[144:147], v[80:87], v204
    s_waitcnt lgkmcnt(0)
    v_exp_f32 v102, v102
    v_exp_f32 v103, v103
    v_exp_f32 v104, v104
    v_smfmac_f32_16x16x64_bf16 v[196:199], v[200:203], v[80:87], v204
    ds_read_b128 v[152:155], v24 offset:10240
    v_exp_f32 v105, v105
    v_exp_f32 v106, v106
    v_smfmac_f32_32x32x32_bf16 v[176:191], v[148:151], v[88:95], v204
    v_exp_f32 v107, v107
    v_exp_f32 v108, v108
    v_exp_f32 v109, v109
    v_smfmac_f32_16x16x64_bf16 v[196:199], v[200:203], v[88:95], v204
    ds_read_b128 v[156:159], v24 offset:11264
    v_exp_f32 v110, v110
    v_exp_f32 v111, v111
    v_mfma_f32_32x32x16_bf16 v[64:79], v[128:131], v[8:11], 0
    v_exp_f32 v112, v112
    v_exp_f32 v113, v113
    v_exp_f32 v114, v114
    v_mfma_f32_32x32x16_bf16 v[64:79], v[132:135], v[12:15], v[64:79]
    s_waitcnt lgkmcnt(1)
    v_exp_f32 v115, v115
    v_exp_f32 v116, v116
    v_exp_f32 v117, v117
    v_smfmac_f32_32x32x32_bf16 v[160:175], v[152:155], v[96:103], v204
    s_waitcnt lgkmcnt(0)
    v_exp_f32 v118, v118
    v_exp_f32 v119, v119
    v_exp_f32 v120, v120
    v_smfmac_f32_16x16x64_bf16 v[192:195], v[200:203], v[96:103], v204
    ds_read_b128 v[136:139], v24 offset:6144
    v_exp_f32 v121, v121
    v_exp_f32 v122, v122
    v_smfmac_f32_32x32x32_bf16 v[160:175], v[156:159], v[104:111], v204
    v_exp_f32 v123, v123
    v_exp_f32 v124, v124
    v_exp_f32 v125, v125
    v_smfmac_f32_16x16x64_bf16 v[192:195], v[200:203], v[104:111], v204
    ds_read_b128 v[140:143], v24 offset:7168
    v_exp_f32 v126, v126
    v_exp_f32 v127, v127
    v_mfma_f32_32x32x16_bf16 v[80:95], v[128:131], v[16:19], 0
    s_cmp_eq_u32 s54, 4
    v_exp_f32 v64, v64
    v_exp_f32 v65, v65
    v_exp_f32 v66, v66
    v_mfma_f32_32x32x16_bf16 v[80:95], v[132:135], v[20:23], v[80:95]
    v_exp_f32 v67, v67
    v_exp_f32 v68, v68
    v_exp_f32 v69, v69
    v_smfmac_f32_32x32x32_bf16 v[176:191], v[152:155], v[112:119], v204
    s_waitcnt lgkmcnt(0)
    v_exp_f32 v70, v70
    v_exp_f32 v71, v71
    v_exp_f32 v72, v72
    v_smfmac_f32_16x16x64_bf16 v[196:199], v[200:203], v[112:119], v204
    ds_read_b128 v[144:147], v24 offset:12288
    v_exp_f32 v73, v73
    v_exp_f32 v74, v74
    v_smfmac_f32_32x32x32_bf16 v[176:191], v[156:159], v[120:127], v204
    v_exp_f32 v75, v75
    v_exp_f32 v76, v76
    v_exp_f32 v77, v77
    v_smfmac_f32_16x16x64_bf16 v[196:199], v[200:203], v[120:127], v204
    ds_read_b128 v[148:151], v24 offset:13312
    v_exp_f32 v78, v78
    v_exp_f32 v79, v79
    v_mfma_f32_32x32x16_bf16 v[96:111], v[136:139], v[8:11], 0
    s_cbranch_scc1 c_attn_nobar
    s_barrier
c_attn_nobar:
    v_exp_f32 v80, v80
    v_exp_f32 v81, v81
    v_exp_f32 v82, v82
    v_mfma_f32_32x32x16_bf16 v[96:111], v[140:143], v[12:15], v[96:111]
    s_waitcnt lgkmcnt(1)
    v_exp_f32 v83, v83
    v_exp_f32 v84, v84
    v_exp_f32 v85, v85
    v_smfmac_f32_32x32x32_bf16 v[160:175], v[144:147], v[64:71], v204
    s_waitcnt lgkmcnt(0)
    v_exp_f32 v86, v86
    v_exp_f32 v87, v87
    v_exp_f32 v88, v88
    v_smfmac_f32_16x16x64_bf16 v[192:195], v[200:203], v[64:71], v204
    ds_read_b128 v[128:131], v24 offset:16384
    v_exp_f32 v89, v89
    v_exp_f32 v90, v90
    v_smfmac_f32_32x32x32_bf16 v[160:175], v[148:151], v[72:79], v204
    v_exp_f32 v91, v91
    v_exp_f32 v92, v92
    v_exp_f32 v93, v93
    v_smfmac_f32_16x16x64_bf16 v[192:195], v[200:203], v[72:79], v204
    ds_read_b128 v[132:135], v24 offset:17408
    v_exp_f32 v94, v94
    v_exp_f32 v95, v95
    v_mfma_f32_32x32x16_bf16 v[112:127], v[136:139], v[16:19], 0
    v_exp_f32 v96, v96
    v_exp_f32 v97, v97
    v_exp_f32 v98, v98
    v_mfma_f32_32x32x16_bf16 v[112:127], v[140:143], v[20:23], v[112:127]
    v_exp_f32 v99, v99
    v_exp_f32 v100, v100
    v_exp_f32 v101, v101
    v_smfmac_f32_32x32x32_bf16 v[176:191], v[144:147], v[80:87], v204
    s_waitcnt lgkmcnt(0)
    v_exp_f32 v102, v102
    v_exp_f32 v103, v103
    v_exp_f32 v104, v104
    v_smfmac_f32_16x16x64_bf16 v[196:199], v[200:203], v[80:87], v204
    ds_read_b128 v[152:155], v24 offset:14336
    v_exp_f32 v105, v105
    v_exp_f32 v106, v106
    v_smfmac_f32_32x32x32_bf16 v[176:191], v[148:151], v[88:95], v204
    v_exp_f32 v107, v107
    v_exp_f32 v108, v108
    v_exp_f32 v109, v109
    v_smfmac_f32_16x16x64_bf16 v[196:199], v[200:203], v[88:95], v204
    ds_read_b128 v[156:159], v24 offset:15360
    v_exp_f32 v110, v110
    v_exp_f32 v111, v111
    v_mfma_f32_32x32x16_bf16 v[64:79], v[128:131], v[8:11], 0
    v_exp_f32 v112, v112
    v_exp_f32 v113, v113
    v_exp_f32 v114, v114
    v_mfma_f32_32x32x16_bf16 v[64:79], v[132:135], v[12:15], v[64:79]
    s_waitcnt lgkmcnt(1)
    v_exp_f32 v115, v115
    v_exp_f32 v116, v116
    v_exp_f32 v117, v117
    v_smfmac_f32_32x32x32_bf16 v[160:175], v[152:155], v[96:103], v204
    s_waitcnt lgkmcnt(0)
    v_exp_f32 v118, v118
    v_exp_f32 v119, v119
    v_exp_f32 v120, v120
    v_smfmac_f32_16x16x64_bf16 v[192:195], v[200:203], v[96:103], v204
    ds_read_b128 v[136:139], v24 offset:18432
    v_exp_f32 v121, v121
    v_exp_f32 v122, v122
    v_smfmac_f32_32x32x32_bf16 v[160:175], v[156:159], v[104:111], v204
    v_exp_f32 v123, v123
    v_exp_f32 v124, v124
    v_exp_f32 v125, v125
    v_smfmac_f32_16x16x64_bf16 v[192:195], v[200:203], v[104:111], v204
    ds_read_b128 v[140:143], v24 offset:19456
    v_exp_f32 v126, v126
    v_exp_f32 v127, v127
    v_mfma_f32_32x32x16_bf16 v[80:95], v[128:131], v[16:19], 0
    v_exp_f32 v64, v64
    v_exp_f32 v65, v65
    v_exp_f32 v66, v66
    v_mfma_f32_32x32x16_bf16 v[80:95], v[132:135], v[20:23], v[80:95]
    v_exp_f32 v67, v67
    v_exp_f32 v68, v68
    v_exp_f32 v69, v69
    v_smfmac_f32_32x32x32_bf16 v[176:191], v[152:155], v[112:119], v204
    s_waitcnt lgkmcnt(0)
    v_exp_f32 v70, v70
    v_exp_f32 v71, v71
    v_exp_f32 v72, v72
    v_smfmac_f32_16x16x64_bf16 v[196:199], v[200:203], v[112:119], v204
    ds_read_b128 v[144:147], v24 offset:24576
    v_exp_f32 v73, v73
    v_exp_f32 v74, v74
    v_smfmac_f32_32x32x32_bf16 v[176:191], v[156:159], v[120:127], v204
    v_exp_f32 v75, v75
    v_exp_f32 v76, v76
    v_exp_f32 v77, v77
    v_smfmac_f32_16x16x64_bf16 v[196:199], v[200:203], v[120:127], v204
    ds_read_b128 v[148:151], v24 offset:25600
    v_exp_f32 v78, v78
    v_exp_f32 v79, v79
    v_mfma_f32_32x32x16_bf16 v[96:111], v[136:139], v[8:11], 0
    v_exp_f32 v80, v80
    v_exp_f32 v81, v81
    v_exp_f32 v82, v82
    v_mfma_f32_32x32x16_bf16 v[96:111], v[140:143], v[12:15], v[96:111]
    s_waitcnt lgkmcnt(1)
    v_exp_f32 v83, v83
    v_exp_f32 v84, v84
    v_exp_f32 v85, v85
    v_smfmac_f32_32x32x32_bf16 v[160:175], v[144:147], v[64:71], v204
    s_waitcnt lgkmcnt(0)
    v_exp_f32 v86, v86
    v_exp_f32 v87, v87
    v_exp_f32 v88, v88
    v_smfmac_f32_16x16x64_bf16 v[192:195], v[200:203], v[64:71], v204
    ds_read_b128 v[128:131], v24 offset:20480
    v_exp_f32 v89, v89
    v_exp_f32 v90, v90
    v_smfmac_f32_32x32x32_bf16 v[160:175], v[148:151], v[72:79], v204
    v_exp_f32 v91, v91
    v_exp_f32 v92, v92
    v_exp_f32 v93, v93
    v_smfmac_f32_16x16x64_bf16 v[192:195], v[200:203], v[72:79], v204
    ds_read_b128 v[132:135], v24 offset:21504
    v_exp_f32 v94, v94
    v_exp_f32 v95, v95
    v_mfma_f32_32x32x16_bf16 v[112:127], v[136:139], v[16:19], 0
    v_exp_f32 v96, v96
    v_exp_f32 v97, v97
    v_exp_f32 v98, v98
    v_mfma_f32_32x32x16_bf16 v[112:127], v[140:143], v[20:23], v[112:127]
    v_exp_f32 v99, v99
    v_exp_f32 v100, v100
    v_exp_f32 v101, v101
    v_smfmac_f32_32x32x32_bf16 v[176:191], v[144:147], v[80:87], v204
    s_waitcnt lgkmcnt(0)
    v_exp_f32 v102, v102
    v_exp_f32 v103, v103
    v_exp_f32 v104, v104
    v_smfmac_f32_16x16x64_bf16 v[196:199], v[200:203], v[80:87], v204
    ds_read_b128 v[152:155], v24 offset:26624
    v_exp_f32 v105, v105
    v_exp_f32 v106, v106
    v_smfmac_f32_32x32x32_bf16 v[176:191], v[148:151], v[88:95], v204
    v_exp_f32 v107, v107
    v_exp_f32 v108, v108
    v_exp_f32 v109, v109
    v_smfmac_f32_16x16x64_bf16 v[196:199], v[200:203], v[88:95], v204
    ds_read_b128 v[156:159], v24 offset:27648
    v_exp_f32 v110, v110
    v_exp_f32 v111, v111
    v_mfma_f32_32x32x16_bf16 v[64:79], v[128:131], v[8:11], 0
    v_exp_f32 v112, v112
    v_exp_f32 v113, v113
    v_exp_f32 v114, v114
    v_mfma_f32_32x32x16_bf16 v[64:79], v[132:135], v[12:15], v[64:79]
    s_waitcnt lgkmcnt(1)
    v_exp_f32 v115, v115
    v_exp_f32 v116, v116
    v_exp_f32 v117, v117
    v_smfmac_f32_32x32x32_bf16 v[160:175], v[152:155], v[96:103], v204
    s_waitcnt lgkmcnt(0)
    v_exp_f32 v118, v118
    v_exp_f32 v119, v119
    v_exp_f32 v120, v120
    v_smfmac_f32_16x16x64_bf16 v[192:195], v[200:203], v[96:103], v204
    ds_read_b128 v[136:139], v24 offset:22528
    v_exp_f32 v121, v121
    v_exp_f32 v122, v122
    v_smfmac_f32_32x32x32_bf16 v[160:175], v[156:159], v[104:111], v204
    v_exp_f32 v123, v123
    v_exp_f32 v124, v124
    v_exp_f32 v125, v125
    v_smfmac_f32_16x16x64_bf16 v[192:195], v[200:203], v[104:111], v204
    ds_read_b128 v[140:143], v24 offset:23552
    v_exp_f32 v126, v126
    v_exp_f32 v127, v127
    v_mfma_f32_32x32x16_bf16 v[80:95], v[128:131], v[16:19], 0
    v_exp_f32 v64, v64
    v_exp_f32 v65, v65
    v_exp_f32 v66, v66
    v_mfma_f32_32x32x16_bf16 v[80:95], v[132:135], v[20:23], v[80:95]
    v_exp_f32 v67, v67
    v_exp_f32 v68, v68
    v_exp_f32 v69, v69
    v_smfmac_f32_32x32x32_bf16 v[176:191], v[152:155], v[112:119], v204
    s_waitcnt lgkmcnt(0)
    v_exp_f32 v70, v70
    v_exp_f32 v71, v71
    v_exp_f32 v72, v72
    v_smfmac_f32_16x16x64_bf16 v[196:199], v[200:203], v[112:119], v204
    ds_read_b128 v[144:147], v24 offset:28672
    v_exp_f32 v73, v73
    v_exp_f32 v74, v74
    v_smfmac_f32_32x32x32_bf16 v[176:191], v[156:159], v[120:127], v204
    v_exp_f32 v75, v75
    v_exp_f32 v76, v76
    v_exp_f32 v77, v77
    v_smfmac_f32_16x16x64_bf16 v[196:199], v[200:203], v[120:127], v204
    ds_read_b128 v[148:151], v24 offset:29696
    v_exp_f32 v78, v78
    v_exp_f32 v79, v79
    v_mfma_f32_32x32x16_bf16 v[96:111], v[136:139], v[8:11], 0
    s_barrier
    v_exp_f32 v80, v80
    v_exp_f32 v81, v81
    v_exp_f32 v82, v82
    v_mfma_f32_32x32x16_bf16 v[96:111], v[140:143], v[12:15], v[96:111]
    s_waitcnt lgkmcnt(1)
    v_exp_f32 v83, v83
    v_exp_f32 v84, v84
    v_exp_f32 v85, v85
    v_smfmac_f32_32x32x32_bf16 v[160:175], v[144:147], v[64:71], v204
    s_waitcnt lgkmcnt(0)
    v_exp_f32 v86, v86
    v_exp_f32 v87, v87
    v_exp_f32 v88, v88
    v_smfmac_f32_16x16x64_bf16 v[192:195], v[200:203], v[64:71], v204
    ds_read_b128 v[128:131], v24 offset:32768
    v_exp_f32 v89, v89
    v_exp_f32 v90, v90
    v_smfmac_f32_32x32x32_bf16 v[160:175], v[148:151], v[72:79], v204
    v_exp_f32 v91, v91
    v_exp_f32 v92, v92
    v_exp_f32 v93, v93
    v_smfmac_f32_16x16x64_bf16 v[192:195], v[200:203], v[72:79], v204
    ds_read_b128 v[132:135], v24 offset:33792
    v_exp_f32 v94, v94
    v_exp_f32 v95, v95
    v_mfma_f32_32x32x16_bf16 v[112:127], v[136:139], v[16:19], 0
    v_exp_f32 v96, v96
    v_exp_f32 v97, v97
    v_exp_f32 v98, v98
    v_mfma_f32_32x32x16_bf16 v[112:127], v[140:143], v[20:23], v[112:127]
    v_exp_f32 v99, v99
    v_exp_f32 v100, v100
    v_exp_f32 v101, v101
    v_smfmac_f32_32x32x32_bf16 v[176:191], v[144:147], v[80:87], v204
    s_waitcnt lgkmcnt(0)
    v_exp_f32 v102, v102
    v_exp_f32 v103, v103
    v_exp_f32 v104, v104
    v_smfmac_f32_16x16x64_bf16 v[196:199], v[200:203], v[80:87], v204
    ds_read_b128 v[152:155], v24 offset:30720
    v_exp_f32 v105, v105
    v_exp_f32 v106, v106
    v_smfmac_f32_32x32x32_bf16 v[176:191], v[148:151], v[88:95], v204
    v_exp_f32 v107, v107
    v_exp_f32 v108, v108
    v_exp_f32 v109, v109
    v_smfmac_f32_16x16x64_bf16 v[196:199], v[200:203], v[88:95], v204
    ds_read_b128 v[156:159], v24 offset:31744
    v_exp_f32 v110, v110
    v_exp_f32 v111, v111
    v_mfma_f32_32x32x16_bf16 v[64:79], v[128:131], v[8:11], 0
    v_exp_f32 v112, v112
    v_exp_f32 v113, v113
    v_exp_f32 v114, v114
    v_mfma_f32_32x32x16_bf16 v[64:79], v[132:135], v[12:15], v[64:79]
    s_waitcnt lgkmcnt(1)
    v_exp_f32 v115, v115
    v_exp_f32 v116, v116
    v_exp_f32 v117, v117
    v_smfmac_f32_32x32x32_bf16 v[160:175], v[152:155], v[96:103], v204
    s_waitcnt lgkmcnt(0)
    v_exp_f32 v118, v118
    v_exp_f32 v119, v119
    v_exp_f32 v120, v120
    v_smfmac_f32_16x16x64_bf16 v[192:195], v[200:203], v[96:103], v204
    ds_read_b128 v[136:139], v24 offset:34816
    v_exp_f32 v121, v121
    v_exp_f32 v122, v122
    v_smfmac_f32_32x32x32_bf16 v[160:175], v[156:159], v[104:111], v204
    v_exp_f32 v123, v123
    v_exp_f32 v124, v124
    v_exp_f32 v125, v125
    v_smfmac_f32_16x16x64_bf16 v[192:195], v[200:203], v[104:111], v204
    ds_read_b128 v[140:143], v24 offset:35840
    v_exp_f32 v126, v126
    v_exp_f32 v127, v127
    v_mfma_f32_32x32x16_bf16 v[80:95], v[128:131], v[16:19], 0
    v_exp_f32 v64, v64
    v_exp_f32 v65, v65
    v_exp_f32 v66, v66
    v_mfma_f32_32x32x16_bf16 v[80:95], v[132:135], v[20:23], v[80:95]
    v_exp_f32 v67, v67
    v_exp_f32 v68, v68
    v_exp_f32 v69, v69
    v_smfmac_f32_32x32x32_bf16 v[176:191], v[152:155], v[112:119], v204
    s_waitcnt lgkmcnt(0)
    v_exp_f32 v70, v70
    v_exp_f32 v71, v71
    v_exp_f32 v72, v72
    v_smfmac_f32_16x16x64_bf16 v[196:199], v[200:203], v[112:119], v204
    ds_read_b128 v[144:147], v24 offset:40960
    v_exp_f32 v73, v73
    v_exp_f32 v74, v74
    v_smfmac_f32_32x32x32_bf16 v[176:191], v[156:159], v[120:127], v204
    v_exp_f32 v75, v75
    v_exp_f32 v76, v76
    v_exp_f32 v77, v77
    v_smfmac_f32_16x16x64_bf16 v[196:199], v[200:203], v[120:127], v204
    ds_read_b128 v[148:151], v24 offset:41984
    v_exp_f32 v78, v78
    v_exp_f32 v79, v79
    v_mfma_f32_32x32x16_bf16 v[96:111], v[136:139], v[8:11], 0
    v_exp_f32 v80, v80
    v_exp_f32 v81, v81
    v_exp_f32 v82, v82
    v_mfma_f32_32x32x16_bf16 v[96:111], v[140:143], v[12:15], v[96:111]
    s_waitcnt lgkmcnt(1)
    v_exp_f32 v83, v83
    v_exp_f32 v84, v84
    v_exp_f32 v85, v85
    v_smfmac_f32_32x32x32_bf16 v[160:175], v[144:147], v[64:71], v204
    s_waitcnt lgkmcnt(0)
    v_exp_f32 v86, v86
    v_exp_f32 v87, v87
    v_exp_f32 v88, v88
    v_smfmac_f32_16x16x64_bf16 v[192:195], v[200:203], v[64:71], v204
    ds_read_b128 v[128:131], v24 offset:36864
    v_exp_f32 v89, v89
    v_exp_f32 v90, v90
    v_smfmac_f32_32x32x32_bf16 v[160:175], v[148:151], v[72:79], v204
    v_exp_f32 v91, v91
    v_exp_f32 v92, v92
    v_exp_f32 v93, v93
    v_smfmac_f32_16x16x64_bf16 v[192:195], v[200:203], v[72:79], v204
    ds_read_b128 v[132:135], v24 offset:37888
    v_exp_f32 v94, v94
    v_exp_f32 v95, v95
    v_mfma_f32_32x32x16_bf16 v[112:127], v[136:139], v[16:19], 0
    v_exp_f32 v96, v96
    v_exp_f32 v97, v97
    v_exp_f32 v98, v98
    v_mfma_f32_32x32x16_bf16 v[112:127], v[140:143], v[20:23], v[112:127]
    v_exp_f32 v99, v99
    v_exp_f32 v100, v100
    v_exp_f32 v101, v101
    v_smfmac_f32_32x32x32_bf16 v[176:191], v[144:147], v[80:87], v204
    s_waitcnt lgkmcnt(0)
    v_exp_f32 v102, v102
    v_exp_f32 v103, v103
    v_exp_f32 v104, v104
    v_smfmac_f32_16x16x64_bf16 v[196:199], v[200:203], v[80:87], v204
    ds_read_b128 v[152:155], v24 offset:43008
    v_exp_f32 v105, v105
    v_exp_f32 v106, v106
    v_smfmac_f32_32x32x32_bf16 v[176:191], v[148:151], v[88:95], v204
    v_exp_f32 v107, v107
    v_exp_f32 v108, v108
    v_exp_f32 v109, v109
    v_smfmac_f32_16x16x64_bf16 v[196:199], v[200:203], v[88:95], v204
    ds_read_b128 v[156:159], v24 offset:44032
    v_exp_f32 v110, v110
    v_exp_f32 v111, v111
    v_mfma_f32_32x32x16_bf16 v[64:79], v[128:131], v[8:11], 0
    v_exp_f32 v112, v112
    v_exp_f32 v113, v113
    v_exp_f32 v114, v114
    v_mfma_f32_32x32x16_bf16 v[64:79], v[132:135], v[12:15], v[64:79]
    s_waitcnt lgkmcnt(1)
    v_exp_f32 v115, v115
    v_exp_f32 v116, v116
    v_exp_f32 v117, v117
    v_smfmac_f32_32x32x32_bf16 v[160:175], v[152:155], v[96:103], v204
    s_waitcnt lgkmcnt(0)
    v_exp_f32 v118, v118
    v_exp_f32 v119, v119
    v_exp_f32 v120, v120
    v_smfmac_f32_16x16x64_bf16 v[192:195], v[200:203], v[96:103], v204
    ds_read_b128 v[136:139], v24 offset:38912
    v_exp_f32 v121, v121
    v_exp_f32 v122, v122
    v_smfmac_f32_32x32x32_bf16 v[160:175], v[156:159], v[104:111], v204
    v_exp_f32 v123, v123
    v_exp_f32 v124, v124
    v_exp_f32 v125, v125
    v_smfmac_f32_16x16x64_bf16 v[192:195], v[200:203], v[104:111], v204
    ds_read_b128 v[140:143], v24 offset:39936
    v_exp_f32 v126, v126
    v_exp_f32 v127, v127
    v_mfma_f32_32x32x16_bf16 v[80:95], v[128:131], v[16:19], 0
    v_exp_f32 v64, v64
    v_exp_f32 v65, v65
    v_exp_f32 v66, v66
    v_mfma_f32_32x32x16_bf16 v[80:95], v[132:135], v[20:23], v[80:95]
    v_exp_f32 v67, v67
    v_exp_f32 v68, v68
    v_exp_f32 v69, v69
    v_smfmac_f32_32x32x32_bf16 v[176:191], v[152:155], v[112:119], v204
    s_waitcnt lgkmcnt(0)
    v_exp_f32 v70, v70
    v_exp_f32 v71, v71
    v_exp_f32 v72, v72
    v_smfmac_f32_16x16x64_bf16 v[196:199], v[200:203], v[112:119], v204
    ds_read_b128 v[144:147], v24 offset:45056
    v_exp_f32 v73, v73
    v_exp_f32 v74, v74
    v_smfmac_f32_32x32x32_bf16 v[176:191], v[156:159], v[120:127], v204
    v_exp_f32 v75, v75
    v_exp_f32 v76, v76
    v_exp_f32 v77, v77
    v_smfmac_f32_16x16x64_bf16 v[196:199], v[200:203], v[120:127], v204
    ds_read_b128 v[148:151], v24 offset:46080
    v_exp_f32 v78, v78
    v_exp_f32 v79, v79
    v_mfma_f32_32x32x16_bf16 v[96:111], v[136:139], v[8:11], 0
    s_barrier
    v_exp_f32 v80, v80
    v_exp_f32 v81, v81
    v_exp_f32 v82, v82
    v_mfma_f32_32x32x16_bf16 v[96:111], v[140:143], v[12:15], v[96:111]
    s_waitcnt lgkmcnt(1)
    v_exp_f32 v83, v83
    v_exp_f32 v84, v84
    v_exp_f32 v85, v85
    v_smfmac_f32_32x32x32_bf16 v[160:175], v[144:147], v[64:71], v204
    s_waitcnt lgkmcnt(0)
    v_exp_f32 v86, v86
    v_exp_f32 v87, v87
    v_exp_f32 v88, v88
    v_smfmac_f32_16x16x64_bf16 v[192:195], v[200:203], v[64:71], v204
    ds_read_b128 v[128:131], v24 offset:49152
    v_exp_f32 v89, v89
    v_exp_f32 v90, v90
    v_smfmac_f32_32x32x32_bf16 v[160:175], v[148:151], v[72:79], v204
    v_exp_f32 v91, v91
    v_exp_f32 v92, v92
    v_exp_f32 v93, v93
    v_smfmac_f32_16x16x64_bf16 v[192:195], v[200:203], v[72:79], v204
    ds_read_b128 v[132:135], v24 offset:50176
    v_exp_f32 v94, v94
    v_exp_f32 v95, v95
    v_mfma_f32_32x32x16_bf16 v[112:127], v[136:139], v[16:19], 0
    v_exp_f32 v96, v96
    v_exp_f32 v97, v97
    v_exp_f32 v98, v98
    v_mfma_f32_32x32x16_bf16 v[112:127], v[140:143], v[20:23], v[112:127]
    v_exp_f32 v99, v99
    v_exp_f32 v100, v100
    v_exp_f32 v101, v101
    v_smfmac_f32_32x32x32_bf16 v[176:191], v[144:147], v[80:87], v204
    s_waitcnt lgkmcnt(0)
    v_exp_f32 v102, v102
    v_exp_f32 v103, v103
    v_exp_f32 v104, v104
    v_smfmac_f32_16x16x64_bf16 v[196:199], v[200:203], v[80:87], v204
    ds_read_b128 v[152:155], v24 offset:47104
    v_exp_f32 v105, v105
    v_exp_f32 v106, v106
    v_smfmac_f32_32x32x32_bf16 v[176:191], v[148:151], v[88:95], v204
    v_exp_f32 v107, v107
    v_exp_f32 v108, v108
    v_exp_f32 v109, v109
    v_smfmac_f32_16x16x64_bf16 v[196:199], v[200:203], v[88:95], v204
    ds_read_b128 v[156:159], v24 offset:48128
    v_exp_f32 v110, v110
    v_exp_f32 v111, v111
    v_mfma_f32_32x32x16_bf16 v[64:79], v[128:131], v[8:11], 0
    v_exp_f32 v112, v112
    v_exp_f32 v113, v113
    v_exp_f32 v114, v114
    v_mfma_f32_32x32x16_bf16 v[64:79], v[132:135], v[12:15], v[64:79]
    s_waitcnt lgkmcnt(1)
    v_exp_f32 v115, v115
    v_exp_f32 v116, v116
    v_exp_f32 v117, v117
    v_smfmac_f32_32x32x32_bf16 v[160:175], v[152:155], v[96:103], v204
    s_waitcnt lgkmcnt(0)
    v_exp_f32 v118, v118
    v_exp_f32 v119, v119
    v_exp_f32 v120, v120
    v_smfmac_f32_16x16x64_bf16 v[192:195], v[200:203], v[96:103], v204
    ds_read_b128 v[136:139], v24 offset:51200
    v_exp_f32 v121, v121
    v_exp_f32 v122, v122
    v_smfmac_f32_32x32x32_bf16 v[160:175], v[156:159], v[104:111], v204
    v_exp_f32 v123, v123
    v_exp_f32 v124, v124
    v_exp_f32 v125, v125
    v_smfmac_f32_16x16x64_bf16 v[192:195], v[200:203], v[104:111], v204
    ds_read_b128 v[140:143], v24 offset:52224
    v_exp_f32 v126, v126
    v_exp_f32 v127, v127
    v_mfma_f32_32x32x16_bf16 v[80:95], v[128:131], v[16:19], 0
    v_exp_f32 v64, v64
    v_exp_f32 v65, v65
    v_exp_f32 v66, v66
    v_mfma_f32_32x32x16_bf16 v[80:95], v[132:135], v[20:23], v[80:95]
    v_exp_f32 v67, v67
    v_exp_f32 v68, v68
    v_exp_f32 v69, v69
    v_smfmac_f32_32x32x32_bf16 v[176:191], v[152:155], v[112:119], v204
    s_waitcnt lgkmcnt(0)
    v_exp_f32 v70, v70
    v_exp_f32 v71, v71
    v_exp_f32 v72, v72
    v_smfmac_f32_16x16x64_bf16 v[196:199], v[200:203], v[112:119], v204
    ds_read_b128 v[144:147], v24 offset:57344
    v_exp_f32 v73, v73
    v_exp_f32 v74, v74
    v_smfmac_f32_32x32x32_bf16 v[176:191], v[156:159], v[120:127], v204
    v_exp_f32 v75, v75
    v_exp_f32 v76, v76
    v_exp_f32 v77, v77
    v_smfmac_f32_16x16x64_bf16 v[196:199], v[200:203], v[120:127], v204
    ds_read_b128 v[148:151], v24 offset:58368
    v_exp_f32 v78, v78
    v_exp_f32 v79, v79
    v_mfma_f32_32x32x16_bf16 v[96:111], v[136:139], v[8:11], 0
    v_exp_f32 v80, v80
    v_exp_f32 v81, v81
    v_exp_f32 v82, v82
    v_mfma_f32_32x32x16_bf16 v[96:111], v[140:143], v[12:15], v[96:111]
    s_waitcnt lgkmcnt(1)
    v_exp_f32 v83, v83
    v_exp_f32 v84, v84
    v_exp_f32 v85, v85
    v_smfmac_f32_32x32x32_bf16 v[160:175], v[144:147], v[64:71], v204
    s_waitcnt lgkmcnt(0)
    v_exp_f32 v86, v86
    v_exp_f32 v87, v87
    v_exp_f32 v88, v88
    v_smfmac_f32_16x16x64_bf16 v[192:195], v[200:203], v[64:71], v204
    ds_read_b128 v[128:131], v24 offset:53248
    v_exp_f32 v89, v89
    v_exp_f32 v90, v90
    v_smfmac_f32_32x32x32_bf16 v[160:175], v[148:151], v[72:79], v204
    v_exp_f32 v91, v91
    v_exp_f32 v92, v92
    v_exp_f32 v93, v93
    v_smfmac_f32_16x16x64_bf16 v[192:195], v[200:203], v[72:79], v204
    ds_read_b128 v[132:135], v24 offset:54272
    v_exp_f32 v94, v94
    v_exp_f32 v95, v95
    v_mfma_f32_32x32x16_bf16 v[112:127], v[136:139], v[16:19], 0
    v_exp_f32 v96, v96
    v_exp_f32 v97, v97
    v_exp_f32 v98, v98
    v_mfma_f32_32x32x16_bf16 v[112:127], v[140:143], v[20:23], v[112:127]
    v_exp_f32 v99, v99
    v_exp_f32 v100, v100
    v_exp_f32 v101, v101
    v_smfmac_f32_32x32x32_bf16 v[176:191], v[144:147], v[80:87], v204
    s_waitcnt lgkmcnt(0)
    v_exp_f32 v102, v102
    v_exp_f32 v103, v103
    v_exp_f32 v104, v104
    v_smfmac_f32_16x16x64_bf16 v[196:199], v[200:203], v[80:87], v204
    ds_read_b128 v[152:155], v24 offset:59392
    v_exp_f32 v105, v105
    v_exp_f32 v106, v106
    v_smfmac_f32_32x32x32_bf16 v[176:191], v[148:151], v[88:95], v204
    v_exp_f32 v107, v107
    v_exp_f32 v108, v108
    v_exp_f32 v109, v109
    v_smfmac_f32_16x16x64_bf16 v[196:199], v[200:203], v[88:95], v204
    ds_read_b128 v[156:159], v24 offset:60416
    v_exp_f32 v110, v110
    v_exp_f32 v111, v111
    v_mfma_f32_32x32x16_bf16 v[64:79], v[128:131], v[8:11], 0
    v_exp_f32 v112, v112
    v_exp_f32 v113, v113
    v_exp_f32 v114, v114
    v_mfma_f32_32x32x16_bf16 v[64:79], v[132:135], v[12:15], v[64:79]
    s_waitcnt lgkmcnt(1)
    v_exp_f32 v115, v115
    v_exp_f32 v116, v116
    v_exp_f32 v117, v117
    v_smfmac_f32_32x32x32_bf16 v[160:175], v[152:155], v[96:103], v204
    s_waitcnt lgkmcnt(0)
    v_exp_f32 v118, v118
    v_exp_f32 v119, v119
    v_exp_f32 v120, v120
    v_smfmac_f32_16x16x64_bf16 v[192:195], v[200:203], v[96:103], v204
    ds_read_b128 v[136:139], v24 offset:55296
    v_exp_f32 v121, v121
    v_exp_f32 v122, v122
    v_smfmac_f32_32x32x32_bf16 v[160:175], v[156:159], v[104:111], v204
    v_exp_f32 v123, v123
    v_exp_f32 v124, v124
    v_exp_f32 v125, v125
    v_smfmac_f32_16x16x64_bf16 v[192:195], v[200:203], v[104:111], v204
    ds_read_b128 v[140:143], v24 offset:56320
    v_exp_f32 v126, v126
    v_exp_f32 v127, v127
    v_mfma_f32_32x32x16_bf16 v[80:95], v[128:131], v[16:19], 0
    v_exp_f32 v64, v64
    v_exp_f32 v65, v65
    v_exp_f32 v66, v66
    v_mfma_f32_32x32x16_bf16 v[80:95], v[132:135], v[20:23], v[80:95]
    v_exp_f32 v67, v67
    v_exp_f32 v68, v68
    v_exp_f32 v69, v69
    v_smfmac_f32_32x32x32_bf16 v[176:191], v[152:155], v[112:119], v204
    s_waitcnt lgkmcnt(0)
    v_exp_f32 v70, v70
    v_exp_f32 v71, v71
    v_exp_f32 v72, v72
    v_smfmac_f32_16x16x64_bf16 v[196:199], v[200:203], v[112:119], v204
    ds_read_b128 v[144:147], v24 offset:61440
    v_exp_f32 v73, v73
    v_exp_f32 v74, v74
    v_smfmac_f32_32x32x32_bf16 v[176:191], v[156:159], v[120:127], v204
    v_exp_f32 v75, v75
    v_exp_f32 v76, v76
    v_exp_f32 v77, v77
    v_smfmac_f32_16x16x64_bf16 v[196:199], v[200:203], v[120:127], v204
    ds_read_b128 v[148:151], v24 offset:62464
    v_exp_f32 v78, v78
    v_exp_f32 v79, v79
    v_mfma_f32_32x32x16_bf16 v[96:111], v[136:139], v[8:11], 0
    s_barrier
    v_exp_f32 v80, v80
    v_exp_f32 v81, v81
    v_exp_f32 v82, v82
    v_mfma_f32_32x32x16_bf16 v[96:111], v[140:143], v[12:15], v[96:111]
    s_waitcnt lgkmcnt(1)
    v_exp_f32 v83, v83
    v_exp_f32 v84, v84
    v_exp_f32 v85, v85
    v_smfmac_f32_32x32x32_bf16 v[160:175], v[144:147], v[64:71], v204
    s_waitcnt lgkmcnt(0)
    v_exp_f32 v86, v86
    v_exp_f32 v87, v87
    v_exp_f32 v88, v88
    v_smfmac_f32_16x16x64_bf16 v[192:195], v[200:203], v[64:71], v204
    ds_read_b128 v[128:131], v24 offset:0
    v_exp_f32 v89, v89
    v_exp_f32 v90, v90
    v_smfmac_f32_32x32x32_bf16 v[160:175], v[148:151], v[72:79], v204
    v_exp_f32 v91, v91
    v_exp_f32 v92, v92
    v_exp_f32 v93, v93
    v_smfmac_f32_16x16x64_bf16 v[192:195], v[200:203], v[72:79], v204
    ds_read_b128 v[132:135], v24 offset:1024
    v_exp_f32 v94, v94
    v_exp_f32 v95, v95
    v_mfma_f32_32x32x16_bf16 v[112:127], v[136:139], v[16:19], 0
    v_exp_f32 v96, v96
    v_exp_f32 v97, v97
    v_exp_f32 v98, v98
    v_mfma_f32_32x32x16_bf16 v[112:127], v[140:143], v[20:23], v[112:127]
    v_exp_f32 v99, v99
    v_exp_f32 v100, v100
    v_exp_f32 v101, v101
    v_smfmac_f32_32x32x32_bf16 v[176:191], v[144:147], v[80:87], v204
    s_waitcnt lgkmcnt(0)
    v_exp_f32 v102, v102
    v_exp_f32 v103, v103
    v_exp_f32 v104, v104
    v_smfmac_f32_16x16x64_bf16 v[196:199], v[200:203], v[80:87], v204
    ds_read_b128 v[152:155], v24 offset:63488
    v_exp_f32 v105, v105
    v_exp_f32 v106, v106
    v_smfmac_f32_32x32x32_bf16 v[176:191], v[148:151], v[88:95], v204
    v_exp_f32 v107, v107
    v_exp_f32 v108, v108
    v_exp_f32 v109, v109
    v_smfmac_f32_16x16x64_bf16 v[196:199], v[200:203], v[88:95], v204
    ds_read_b128 v[156:159], v24 offset:64512
    v_exp_f32 v110, v110
    v_exp_f32 v111, v111
    v_mfma_f32_32x32x16_bf16 v[64:79], v[128:131], v[8:11], 0
    s_sub_u32 s54, s54, 1
    v_exp_f32 v112, v112
    v_exp_f32 v113, v113
    v_exp_f32 v114, v114
    v_mfma_f32_32x32x16_bf16 v[64:79], v[132:135], v[12:15], v[64:79]
    s_waitcnt lgkmcnt(1)
    v_exp_f32 v115, v115
    v_exp_f32 v116, v116
    v_exp_f32 v117, v117
    v_smfmac_f32_32x32x32_bf16 v[160:175], v[152:155], v[96:103], v204
    s_waitcnt lgkmcnt(0)
    v_exp_f32 v118, v118
    v_exp_f32 v119, v119
    v_exp_f32 v120, v120
    v_smfmac_f32_16x16x64_bf16 v[192:195], v[200:203], v[96:103], v204
    ds_read_b128 v[136:139], v24 offset:2048
    v_exp_f32 v121, v121
    v_exp_f32 v122, v122
    v_smfmac_f32_32x32x32_bf16 v[160:175], v[156:159], v[104:111], v204
    s_cmp_lg_u32 s54, 0
    v_exp_f32 v123, v123
    v_exp_f32 v124, v124
    v_exp_f32 v125, v125
    v_smfmac_f32_16x16x64_bf16 v[192:195], v[200:203], v[104:111], v204
    ds_read_b128 v[140:143], v24 offset:3072
    v_exp_f32 v126, v126
    v_exp_f32 v127, v127
    s_cbranch_scc1 c_attn_loop
    v_smfmac_f32_16x16x64_bf16 v[196:199], v[200:203], v[112:119], v204
    v_smfmac_f32_16x16x64_bf16 v[196:199], v[200:203], v[120:127], v204
    v_smfmac_f32_32x32x32_bf16 v[176:191], v[152:155], v[112:119], v204
    v_smfmac_f32_32x32x32_bf16 v[176:191], v[156:159], v[120:127], v204
    v_mov_b32 v28, 0x5f000000
    v_mov_b32 v29, 0x2b800000
    v_cmp_lt_f32 s[56:57], v192, v28
    v_cmp_gt_f32 vcc, v192, v29
    s_and_b64 s[56:57], s[56:57], vcc
    s_nop 0
    v_cmp_lt_f32 vcc, v196, v28
    s_and_b64 s[56:57], s[56:57], vcc
    v_cmp_gt_f32 vcc, v196, v29
    s_and_b64 s[56:57], s[56:57], vcc
    s_cmp_lg_u64 s[56:57], -1
    s_cbranch_scc1 c_attn_slow
c_attn_fin:
    s_lshl_b32 s3, s48, 17
    s_lshl_b32 s55, s7, 12
    s_add_u32 s3, s3, s55
    s_and_b32 s55, s6, 1
    s_lshl_b32 s55, s55, 11
    s_add_u32 s3, s3, s55
    s_lshl_b32 s55, s9, 22
    s_add_u32 s3, s3, s55
    s_add_u32 s3, s3, 16777216
    v_rcp_f32 v192, v192
    s_nop 0
    v_pk_mul_f32 v[160:161], v[192:193], v[160:161] op_sel_hi:[0,1]
    v_pk_mul_f32 v[162:163], v[192:193], v[162:163] op_sel_hi:[0,1]
    v_pk_mul_f32 v[164:165], v[192:193], v[164:165] op_sel_hi:[0,1]
    v_pk_mul_f32 v[166:167], v[192:193], v[166:167] op_sel_hi:[0,1]
    v_pk_mul_f32 v[168:169], v[192:193], v[168:169] op_sel_hi:[0,1]
    v_pk_mul_f32 v[170:171], v[192:193], v[170:171] op_sel_hi:[0,1]
    v_pk_mul_f32 v[172:173], v[192:193], v[172:173] op_sel_hi:[0,1]
    v_pk_mul_f32 v[174:175], v[192:193], v[174:175] op_sel_hi:[0,1]
    v_cvt_pk_bf16_f32 v160, v160, v161
    v_cvt_pk_bf16_f32 v161, v162, v163
    v_cvt_pk_bf16_f32 v162, v164, v165
    v_cvt_pk_bf16_f32 v163, v166, v167
    v_cvt_pk_bf16_f32 v164, v168, v169
    v_cvt_pk_bf16_f32 v165, v170, v171
    v_cvt_pk_bf16_f32 v166, v172, v173
    v_cvt_pk_bf16_f32 v167, v174, v175
    buffer_store_dwordx4 v[160:163], v5, s[12:15], s3 offen offset:0 sc1
    buffer_store_dwordx4 v[164:167], v5, s[12:15], s3 offen offset:1024 sc1
    s_add_u32 s3, s3, 65536
    v_rcp_f32 v196, v196
    s_nop 0
    v_pk_mul_f32 v[176:177], v[196:197], v[176:177] op_sel_hi:[0,1]
    v_pk_mul_f32 v[178:179], v[196:197], v[178:179] op_sel_hi:[0,1]
    v_pk_mul_f32 v[180:181], v[196:197], v[180:181] op_sel_hi:[0,1]
    v_pk_mul_f32 v[182:183], v[196:197], v[182:183] op_sel_hi:[0,1]
    v_pk_mul_f32 v[184:185], v[196:197], v[184:185] op_sel_hi:[0,1]
    v_pk_mul_f32 v[186:187], v[196:197], v[186:187] op_sel_hi:[0,1]
    v_pk_mul_f32 v[188:189], v[196:197], v[188:189] op_sel_hi:[0,1]
    v_pk_mul_f32 v[190:191], v[196:197], v[190:191] op_sel_hi:[0,1]
    v_cvt_pk_bf16_f32 v176, v176, v177
    v_cvt_pk_bf16_f32 v177, v178, v179
    v_cvt_pk_bf16_f32 v178, v180, v181
    v_cvt_pk_bf16_f32 v179, v182, v183
    v_cvt_pk_bf16_f32 v180, v184, v185
    v_cvt_pk_bf16_f32 v181, v186, v187
    v_cvt_pk_bf16_f32 v182, v188, v189
    v_cvt_pk_bf16_f32 v183, v190, v191
    buffer_store_dwordx4 v[176:179], v5, s[12:15], s3 offen offset:0 sc1
    buffer_store_dwordx4 v[180:183], v5, s[12:15], s3 offen offset:1024 sc1
    s_add_u32 s3, s3, 65536
    s_mul_i32 s55, s9, 786432
    s_add_u32 s55, s55, 65798144
    v_and_b32 v28, 63, v0
    s_and_b32 s56, s11, 0xe0
    v_lshrrev_b32 v29, 5, v28
    v_add_u32 v28, s56, v28
    v_and_b32 v28, 255, v28
    v_lshlrev_b32 v28, 10, v28
    v_lshl_add_u32 v28, v29, 8, v28
    s_bfe_u32 s56, s11, 0x20003
    s_and_b32 s57, s11, 7
    s_lshl_b32 s56, s56, 7
    s_lshl_b32 s57, s57, 2
    s_add_u32 s55, s55, s56
    s_add_u32 s55, s55, s57
    v_mov_b32 v29, 159488
    v_mov_b32 v30, 1
    v_mov_b32 v31, s10
    s_mov_b64 exec, 1
    s_waitcnt vmcnt(0)
    ds_add_rtn_u32 v30, v29, v30
    s_waitcnt lgkmcnt(0)
    v_readfirstlane_b32 s56, v30
    s_and_b32 s56, s56, 3
    s_cmp_lg_u32 s56, 3
    s_cbranch_scc1 pub_4
    s_mov_b32 exec_lo, -1
    buffer_store_dword v31, v28, s[12:15], s55 offen sc1
pub_4:
    s_mov_b64 exec, -1
    s_branch c_wo
.p2align 6
h_first:
    s_memrealtime s[50:51]
    s_cmp_lg_u32 s2, 0
    s_cbranch_scc1 h_first_nonon
    s_mov_b32 s16, s46
    s_mov_b32 s17, s47
    s_mov_b32 s18, 256
    s_mov_b32 s19, 0x00020000
    v_lshlrev_b32 v14, 6, v1
    s_waitcnt lgkmcnt(0)
    s_or_b32 s50, s50, 1
    v_mov_b32 v13, s50
    buffer_store_dword v13, v14, s[16:19], 0 offen sc1
h_first_nonon:
    v_mov_b32 v8, 0
    v_mov_b32 v9, 0
    v_mov_b32 v10, 159488
    ds_write_b64 v10, v[8:9]
    ds_write_b32 v10, v8 offset:8
    s_waitcnt lgkmcnt(0)
    s_barrier
    s_barrier
    s_sub_u32 s50, s50, 8000
    s_load_dword s10, s[46:47], 0
    s_waitcnt lgkmcnt(0)
    s_sub_u32 s51, s10, s50
    s_and_b32 s3, s10, 1
    s_cselect_b32 s51, s51, -1
    s_cmp_ge_i32 s51, 0
    s_cbranch_scc1 h_first_non_ok
    s_load_dword s10, s[46:47], 128
    s_waitcnt lgkmcnt(0)
    s_sub_u32 s51, s10, s50
    s_and_b32 s3, s10, 1
    s_cselect_b32 s51, s51, -1
    s_cmp_ge_i32 s51, 0
    s_cbranch_scc1 h_first_non_ok
    s_load_dword s10, s[46:47], 64
    s_waitcnt lgkmcnt(0)
    s_sub_u32 s51, s10, s50
    s_and_b32 s3, s10, 1
    s_cselect_b32 s51, s51, -1
    s_cmp_ge_i32 s51, 0
    s_cbranch_scc1 h_first_non_ok
    s_load_dword s10, s[46:47], 192
    s_waitcnt lgkmcnt(0)
    s_sub_u32 s51, s10, s50
    s_and_b32 s3, s10, 1
    s_cselect_b32 s51, s51, -1
    s_cmp_ge_i32 s51, 0
    s_cbranch_scc1 h_first_non_ok
    s_mov_b32 s58, 0
    s_and_b32 s57, s2, 0xc0
h_first_non:
    s_load_dword s10, s[46:47], s57 glc
    s_waitcnt lgkmcnt(0)
    s_sub_u32 s51, s10, s50
    s_and_b32 s3, s10, 1
    s_cselect_b32 s51, s51, -1
    s_cmp_ge_i32 s51, 0
    s_cbranch_scc1 h_first_non_ok
    s_add_u32 s58, s58, 1
    s_cmp_gt_u32 s58, 100
    s_cselect_b32 s50, s10, s50
    s_cmp_lt_u32 s58, 0x8000
    s_cbranch_scc1 h_first_non
    s_mov_b32 s10, 1
h_first_non_ok:
    v_mov_b32 v12, s10
    ds_write_b32 v10, v12 offset:4
    s_waitcnt vmcnt(0)
    v_lshlrev_b32 v13, 7, v1
    s_lshl_b32 s50, s2, 13
    s_mov_b32 s28, s36
    s_mov_b32 s29, s37
    s_mov_b32 s30, 2097152
    s_mov_b32 s31, 0x00020000
    buffer_load_dword v14, v13, s[28:31], s50 offen
    s_mov_b32 s9, 0
h_qkvA:
    s_mul_i32 s98, s9, 786432
    s_add_u32 s98, s98, 65273856
    s_lshl_b32 s99, s11, 10
    s_add_u32 s98, s98, s99
    s_add_u32 s96, s4, s98
    s_addc_u32 s97, s5, 0
    s_mov_b32 s98, s10
    s_mov_b32 s99, s10
    v_and_b32 v1, 63, v0
    v_lshlrev_b32 v5, 4, v1
    v_and_b32 v20, 15, v1
    v_lshrrev_b32 v11, 4, v1
    v_min_u32 v11, 2, v11
    v_lshlrev_b32 v21, 3, v20
    v_lshl_add_u32 v12, v11, 7, v21
    v_add_u32 v12, 155648, v12
    v_lshl_add_u32 v11, v11, 16, v21
    v_mov_b32 v10, 159496
    s_add_u32 s3, s9, 1
    v_mov_b32 v13, s3
    s_and_b32 s3, s6, 14
    s_lshl_b32 s3, s3, 2
    s_sub_u32 s3, s3, 1
    s_max_i32 s3, s3, 0
    s_lshl_b32 s3, s3, 16
    s_lshl_b32 s48, s9, 22
    s_add_u32 s3, s3, s48
    s_add_u32 s20, s4, s3
    s_addc_u32 s21, s5, 0
    s_mov_b32 s22, 65536
    s_mov_b32 s23, 0x00020000
    v_bfe_u32 v21, v1, 4, 1
    v_lshl_add_u32 v6, v21, 5, v20
    v_lshlrev_b32 v6, 4, v6
    v_lshrrev_b32 v21, 5, v1
    v_lshl_add_u32 v6, v21, 10, v6
    v_add_u32 v6, 256, v6
    s_mov_b32 s3, 0x20000
poll_5:
    s_load_dwordx8 s[48:55], s[96:97], 0 glc
    s_load_dwordx8 s[56:63], s[96:97], 128 glc
    s_load_dwordx8 s[64:71], s[96:97], 256 glc
    s_load_dwordx8 s[72:79], s[96:97], 384 glc
    s_load_dwordx8 s[80:87], s[96:97], 512 glc
    s_load_dwordx8 s[88:95], s[96:97], 640 glc
    s_sub_u32 s3, s3, 1
    s_cbranch_scc1 poll_5_ok
    s_waitcnt lgkmcnt(0)
    s_xor_b64 s[100:101], s[48:49], s[98:99]
    s_xor_b64 s[48:49], s[50:51], s[98:99]
    s_or_b64 s[100:101], s[100:101], s[48:49]
    s_xor_b64 s[48:49], s[52:53], s[98:99]
    s_or_b64 s[100:101], s[100:101], s[48:49]
    s_xor_b64 s[48:49], s[54:55], s[98:99]
    s_or_b64 s[100:101], s[100:101], s[48:49]
    s_xor_b64 s[48:49], s[56:57], s[98:99]
    s_or_b64 s[100:101], s[100:101], s[48:49]
    s_xor_b64 s[48:49], s[58:59], s[98:99]
    s_or_b64 s[100:101], s[100:101], s[48:49]
    s_xor_b64 s[48:49], s[60:61], s[98:99]
    s_or_b64 s[100:101], s[100:101], s[48:49]
    s_xor_b64 s[48:49], s[62:63], s[98:99]
    s_or_b64 s[100:101], s[100:101], s[48:49]
    s_xor_b64 s[48:49], s[64:65], s[98:99]
    s_or_b64 s[100:101], s[100:101], s[48:49]
    s_xor_b64 s[48:49], s[66:67], s[98:99]
    s_or_b64 s[100:101], s[100:101], s[48:49]
    s_xor_b64 s[48:49], s[68:69], s[98:99]
    s_or_b64 s[100:101], s[100:101], s[48:49]
    s_xor_b64 s[48:49], s[70:71], s[98:99]
    s_or_b64 s[100:101], s[100:101], s[48:49]
    s_xor_b64 s[48:49], s[72:73], s[98:99]
    s_or_b64 s[100:101], s[100:101], s[48:49]
    s_xor_b64 s[48:49], s[74:75], s[98:99]
    s_or_b64 s[100:101], s[100:101], s[48:49]
    s_xor_b64 s[48:49], s[76:77], s[98:99]
    s_or_b64 s[100:101], s[100:101], s[48:49]
    s_xor_b64 s[48:49], s[78:79], s[98:99]
    s_or_b64 s[100:101], s[100:101], s[48:49]
    s_xor_b64 s[48:49], s[80:81], s[98:99]
    s_or_b64 s[100:101], s[100:101], s[48:49]
    s_xor_b64 s[48:49], s[82:83], s[98:99]
    s_or_b64 s[100:101], s[100:101], s[48:49]
    s_xor_b64 s[48:49], s[84:85], s[98:99]
    s_or_b64 s[100:101], s[100:101], s[48:49]
    s_xor_b64 s[48:49], s[86:87], s[98:99]
    s_or_b64 s[100:101], s[100:101], s[48:49]
    s_xor_b64 s[48:49], s[88:89], s[98:99]
    s_or_b64 s[100:101], s[100:101], s[48:49]
    s_xor_b64 s[48:49], s[90:91], s[98:99]
    s_or_b64 s[100:101], s[100:101], s[48:49]
    s_xor_b64 s[48:49], s[92:93], s[98:99]
    s_or_b64 s[100:101], s[100:101], s[48:49]
    s_xor_b64 s[48:49], s[94:95], s[98:99]
    s_or_b64 s[100:101], s[100:101], s[48:49]
    s_cbranch_scc1 poll_5
poll_5_ok:
    s_waitcnt lgkmcnt(0)
    ds_write_b32 v10, v13
    s_mov_b32 m0, 147456
    s_mov_b32 s48, 0
    buffer_load_dwordx4 v6, s[20:23], s48 offen sc1 lds
    s_mov_b32 m0, 148480
    s_mov_b32 s48, 2048
    buffer_load_dwordx4 v6, s[20:23], s48 offen sc1 lds
    s_mov_b32 m0, 149504
    s_mov_b32 s48, 4096
    buffer_load_dwordx4 v6, s[20:23], s48 offen sc1 lds
    s_mov_b32 m0, 150528
    s_mov_b32 s48, 6144
    buffer_load_dwordx4 v6, s[20:23], s48 offen sc1 lds
    s_barrier
    s_mov_b32 m0, 151552
    s_mov_b32 s48, 8192
    buffer_load_dwordx4 v6, s[20:23], s48 offen sc1 lds
    s_mov_b32 m0, 152576
    s_mov_b32 s48, 10240
    buffer_load_dwordx4 v6, s[20:23], s48 offen sc1 lds
    s_mov_b32 m0, 153600
    s_mov_b32 s48, 12288
    buffer_load_dwordx4 v6, s[20:23], s48 offen sc1 lds
    s_mov_b32 m0, 154624
    s_mov_b32 s48, 14336
    buffer_load_dwordx4 v6, s[20:23], s48 offen sc1 lds
    s_lshl_b32 s56, s7, 12
    s_and_b32 s57, s6, 1
    s_lshl_b32 s57, s57, 7
    s_add_u32 s56, s56, s57
    s_add_u32 s56, s56, 63963136
    v_lshlrev_b32 v15, 7, v1
    s_lshr_b32 s59, s2, 3
    s_mul_i32 s59, s59, 3
    s_lshr_b32 s59, s59, 5
    s_lshl_b32 s3, s9, 4
    s_add_u32 s59, s59, s3
    s_and_b32 s58, s6, 14
    s_lshl_b32 s58, s58, 18
    s_lshl_b32 s57, s9, 22
    s_add_u32 s58, s58, s57
    s_and_b32 s57, s7, 3
    s_lshl_b32 s57, s57, 11
    s_add_u32 s58, s58, s57
    s_waitcnt vmcnt(4)
    s_barrier
    s_waitcnt vmcnt(0)
    s_barrier
    s_mov_b32 m0, 147456
    s_mov_b32 s48, 16384
    buffer_load_dwordx4 v6, s[20:23], s48 offen sc1 lds
    s_mov_b32 m0, 148480
    s_mov_b32 s48, 18432
    buffer_load_dwordx4 v6, s[20:23], s48 offen sc1 lds
    s_mov_b32 m0, 149504
    s_mov_b32 s48, 20480
    buffer_load_dwordx4 v6, s[20:23], s48 offen sc1 lds
    s_mov_b32 m0, 150528
    s_mov_b32 s48, 22528
    buffer_load_dwordx4 v6, s[20:23], s48 offen sc1 lds
    s_waitcnt vmcnt(0)
    s_barrier
    s_mov_b32 m0, 151552
    s_mov_b32 s48, 24576
    buffer_load_dwordx4 v6, s[20:23], s48 offen sc1 lds
    s_mov_b32 m0, 152576
    s_mov_b32 s48, 26624
    buffer_load_dwordx4 v6, s[20:23], s48 offen sc1 lds
    s_mov_b32 m0, 153600
    s_mov_b32 s48, 28672
    buffer_load_dwordx4 v6, s[20:23], s48 offen sc1 lds
    s_mov_b32 m0, 154624
    s_mov_b32 s48, 30720
    buffer_load_dwordx4 v6, s[20:23], s48 offen sc1 lds
    buffer_load_dwordx2 v[32:33], v11, s[12:15], s56 offen offset:0 sc1
    buffer_load_dwordx2 v[34:35], v11, s[12:15], s56 offen offset:256 sc1
    buffer_load_dwordx2 v[36:37], v11, s[12:15], s56 offen offset:512 sc1
    buffer_load_dwordx2 v[38:39], v11, s[12:15], s56 offen offset:768 sc1
    buffer_load_dwordx2 v[40:41], v11, s[12:15], s56 offen offset:1024 sc1
    buffer_load_dwordx2 v[42:43], v11, s[12:15], s56 offen offset:1280 sc1
    buffer_load_dwordx2 v[44:45], v11, s[12:15], s56 offen offset:1536 sc1
    buffer_load_dwordx2 v[46:47], v11, s[12:15], s56 offen offset:1792 sc1
    buffer_load_dwordx2 v[48:49], v11, s[12:15], s56 offen offset:2048 sc1
    buffer_load_dwordx2 v[50:51], v11, s[12:15], s56 offen offset:2304 sc1
    buffer_load_dwordx2 v[52:53], v11, s[12:15], s56 offen offset:2560 sc1
    buffer_load_dwordx2 v[54:55], v11, s[12:15], s56 offen offset:2816 sc1
    s_waitcnt vmcnt(12)
    s_barrier
    s_mov_b32 m0, 147456
    s_mov_b32 s48, 32768
    buffer_load_dwordx4 v6, s[20:23], s48 offen sc1 lds
    s_mov_b32 m0, 148480
    s_mov_b32 s48, 34816
    buffer_load_dwordx4 v6, s[20:23], s48 offen sc1 lds
    s_mov_b32 m0, 149504
    s_mov_b32 s48, 36864
    buffer_load_dwordx4 v6, s[20:23], s48 offen sc1 lds
    s_mov_b32 m0, 150528
    s_mov_b32 s48, 38912
    buffer_load_dwordx4 v6, s[20:23], s48 offen sc1 lds
    buffer_load_dwordx2 v[56:57], v11, s[12:15], s56 offen offset:3072 sc1
    buffer_load_dwordx2 v[58:59], v11, s[12:15], s56 offen offset:3328 sc1
    buffer_load_dwordx2 v[60:61], v11, s[12:15], s56 offen offset:3584 sc1
    buffer_load_dwordx2 v[62:63], v11, s[12:15], s56 offen offset:3840 sc1
    s_waitcnt vmcnt(4)
    s_barrier
    s_mov_b32 m0, 151552
    s_mov_b32 s48, 40960
    buffer_load_dwordx4 v6, s[20:23], s48 offen sc1 lds
    s_mov_b32 m0, 152576
    s_mov_b32 s48, 43008
    buffer_load_dwordx4 v6, s[20:23], s48 offen sc1 lds
    s_mov_b32 m0, 153600
    s_mov_b32 s48, 45056
    buffer_load_dwordx4 v6, s[20:23], s48 offen sc1 lds
    s_mov_b32 m0, 154624
    s_mov_b32 s48, 47104
    buffer_load_dwordx4 v6, s[20:23], s48 offen sc1 lds
    s_waitcnt vmcnt(4)
    v_add_f32 v32, v32, v48
    v_add_f32 v33, v33, v49
    v_add_f32 v34, v34, v50
    v_add_f32 v35, v35, v51
    v_add_f32 v36, v36, v52
    v_add_f32 v37, v37, v53
    v_add_f32 v38, v38, v54
    v_add_f32 v39, v39, v55
    v_add_f32 v40, v40, v56
    v_add_f32 v41, v41, v57
    v_add_f32 v42, v42, v58
    v_add_f32 v43, v43, v59
    s_waitcnt vmcnt(0)
    s_barrier
    s_mov_b32 m0, 147456
    s_mov_b32 s48, 49152
    buffer_load_dwordx4 v6, s[20:23], s48 offen sc1 lds
    s_mov_b32 m0, 148480
    s_mov_b32 s48, 51200
    buffer_load_dwordx4 v6, s[20:23], s48 offen sc1 lds
    s_mov_b32 m0, 149504
    s_mov_b32 s48, 53248
    buffer_load_dwordx4 v6, s[20:23], s48 offen sc1 lds
    s_mov_b32 m0, 150528
    s_mov_b32 s48, 55296
    buffer_load_dwordx4 v6, s[20:23], s48 offen sc1 lds
    v_add_f32 v44, v44, v60
    v_add_f32 v45, v45, v61
    v_add_f32 v46, v46, v62
    v_add_f32 v47, v47, v63
    v_add_f32 v32, v32, v40
    v_add_f32 v33, v33, v41
    v_add_f32 v34, v34, v42
    v_add_f32 v35, v35, v43
    v_add_f32 v36, v36, v44
    v_add_f32 v37, v37, v45
    v_add_f32 v38, v38, v46
    v_add_f32 v39, v39, v47
    s_waitcnt vmcnt(0)
    s_barrier
    s_mov_b32 m0, 151552
    s_mov_b32 s48, 57344
    buffer_load_dwordx4 v6, s[20:23], s48 offen sc1 lds
    s_mov_b32 m0, 152576
    s_mov_b32 s48, 59392
    buffer_load_dwordx4 v6, s[20:23], s48 offen sc1 lds
    s_mov_b32 m0, 153600
    s_mov_b32 s48, 61440
    buffer_load_dwordx4 v6, s[20:23], s48 offen sc1 lds
    s_mov_b32 m0, 154624
    s_mov_b32 s48, 63488
    buffer_load_dwordx4 v6, s[20:23], s48 offen sc1 lds
    v_add_f32 v32, v32, v36
    v_add_f32 v33, v33, v37
    v_add_f32 v34, v34, v38
    v_add_f32 v35, v35, v39
    v_add_f32 v32, v32, v34
    v_add_f32 v33, v33, v35
    ds_write_b64 v12, v[32:33]
    s_waitcnt lgkmcnt(0)
    s_waitcnt vmcnt(0)
    s_barrier
    s_barrier
    s_barrier
    s_branch h_wo
h_qkvB:
    s_mul_i32 s98, s9, 786432
    s_add_u32 s98, s98, 65273856
    s_lshl_b32 s99, s11, 10
    s_add_u32 s98, s98, s99
    s_add_u32 s96, s4, s98
    s_addc_u32 s97, s5, 0
    s_mov_b32 s98, s10
    s_mov_b32 s99, s10
    v_and_b32 v1, 63, v0
    v_lshlrev_b32 v5, 4, v1
    v_and_b32 v20, 15, v1
    v_lshrrev_b32 v11, 4, v1
    v_min_u32 v11, 2, v11
    v_lshlrev_b32 v21, 3, v20
    v_lshl_add_u32 v12, v11, 7, v21
    v_add_u32 v12, 156032, v12
    v_lshl_add_u32 v11, v11, 16, v21
    v_mov_b32 v10, 159496
    s_add_u32 s3, s9, 1
    v_mov_b32 v13, s3
    s_mov_b32 s3, 0x20000
poll_6:
    s_load_dwordx8 s[64:71], s[96:97], 0 glc
    s_load_dwordx8 s[72:79], s[96:97], 128 glc
    s_load_dwordx8 s[80:87], s[96:97], 256 glc
    s_load_dwordx8 s[88:95], s[96:97], 384 glc
    s_sub_u32 s3, s3, 1
    s_cbranch_scc1 poll_6_ok
    s_waitcnt lgkmcnt(0)
    s_xor_b64 s[100:101], s[64:65], s[98:99]
    s_xor_b64 s[64:65], s[66:67], s[98:99]
    s_or_b64 s[100:101], s[100:101], s[64:65]
    s_xor_b64 s[64:65], s[68:69], s[98:99]
    s_or_b64 s[100:101], s[100:101], s[64:65]
    s_xor_b64 s[64:65], s[70:71], s[98:99]
    s_or_b64 s[100:101], s[100:101], s[64:65]
    s_xor_b64 s[64:65], s[72:73], s[98:99]
    s_or_b64 s[100:101], s[100:101], s[64:65]
    s_xor_b64 s[64:65], s[74:75], s[98:99]
    s_or_b64 s[100:101], s[100:101], s[64:65]
    s_xor_b64 s[64:65], s[76:77], s[98:99]
    s_or_b64 s[100:101], s[100:101], s[64:65]
    s_xor_b64 s[64:65], s[78:79], s[98:99]
    s_or_b64 s[100:101], s[100:101], s[64:65]
    s_xor_b64 s[64:65], s[80:81], s[98:99]
    s_or_b64 s[100:101], s[100:101], s[64:65]
    s_xor_b64 s[64:65], s[82:83], s[98:99]
    s_or_b64 s[100:101], s[100:101], s[64:65]
    s_xor_b64 s[64:65], s[84:85], s[98:99]
    s_or_b64 s[100:101], s[100:101], s[64:65]
    s_xor_b64 s[64:65], s[86:87], s[98:99]
    s_or_b64 s[100:101], s[100:101], s[64:65]
    s_xor_b64 s[64:65], s[88:89], s[98:99]
    s_or_b64 s[100:101], s[100:101], s[64:65]
    s_xor_b64 s[64:65], s[90:91], s[98:99]
    s_or_b64 s[100:101], s[100:101], s[64:65]
    s_xor_b64 s[64:65], s[92:93], s[98:99]
    s_or_b64 s[100:101], s[100:101], s[64:65]
    s_xor_b64 s[64:65], s[94:95], s[98:99]
    s_or_b64 s[100:101], s[100:101], s[64:65]
    s_cbranch_scc1 poll_6
poll_6_ok:
    s_waitcnt lgkmcnt(0)
    ds_write_b32 v10, v13
    s_barrier
    s_lshl_b32 s56, s7, 12
    s_and_b32 s57, s6, 1
    s_lshl_b32 s57, s57, 7
    s_add_u32 s56, s56, s57
    s_add_u32 s56, s56, 64159744
    s_and_b32 s58, s6, 14
    s_lshl_b32 s58, s58, 18
    s_lshl_b32 s57, s9, 22
    s_add_u32 s58, s58, s57
    s_and_b32 s57, s7, 3
    s_lshl_b32 s57, s57, 11
    s_add_u32 s58, s58, s57
    s_barrier
    s_barrier
    s_barrier
    buffer_load_dwordx2 v[32:33], v11, s[12:15], s56 offen offset:0 sc1
    buffer_load_dwordx2 v[34:35], v11, s[12:15], s56 offen offset:256 sc1
    buffer_load_dwordx2 v[36:37], v11, s[12:15], s56 offen offset:512 sc1
    buffer_load_dwordx2 v[38:39], v11, s[12:15], s56 offen offset:768 sc1
    buffer_load_dwordx2 v[40:41], v11, s[12:15], s56 offen offset:1024 sc1
    buffer_load_dwordx2 v[42:43], v11, s[12:15], s56 offen offset:1280 sc1
    buffer_load_dwordx2 v[44:45], v11, s[12:15], s56 offen offset:1536 sc1
    buffer_load_dwordx2 v[46:47], v11, s[12:15], s56 offen offset:1792 sc1
    buffer_load_dwordx2 v[48:49], v11, s[12:15], s56 offen offset:2048 sc1
    buffer_load_dwordx2 v[50:51], v11, s[12:15], s56 offen offset:2304 sc1
    buffer_load_dwordx2 v[52:53], v11, s[12:15], s56 offen offset:2560 sc1
    buffer_load_dwordx2 v[54:55], v11, s[12:15], s56 offen offset:2816 sc1
    s_barrier
    buffer_load_dwordx2 v[56:57], v11, s[12:15], s56 offen offset:3072 sc1
    buffer_load_dwordx2 v[58:59], v11, s[12:15], s56 offen offset:3328 sc1
    buffer_load_dwordx2 v[60:61], v11, s[12:15], s56 offen offset:3584 sc1
    buffer_load_dwordx2 v[62:63], v11, s[12:15], s56 offen offset:3840 sc1
    s_barrier
    s_waitcnt vmcnt(0)
    v_add_f32 v32, v32, v48
    v_add_f32 v33, v33, v49
    v_add_f32 v34, v34, v50
    v_add_f32 v35, v35, v51
    v_add_f32 v36, v36, v52
    v_add_f32 v37, v37, v53
    v_add_f32 v38, v38, v54
    v_add_f32 v39, v39, v55
    v_add_f32 v40, v40, v56
    v_add_f32 v41, v41, v57
    v_add_f32 v42, v42, v58
    v_add_f32 v43, v43, v59
    s_barrier
    v_add_f32 v44, v44, v60
    v_add_f32 v45, v45, v61
    v_add_f32 v46, v46, v62
    v_add_f32 v47, v47, v63
    v_add_f32 v32, v32, v40
    v_add_f32 v33, v33, v41
    v_add_f32 v34, v34, v42
    v_add_f32 v35, v35, v43
    v_add_f32 v36, v36, v44
    v_add_f32 v37, v37, v45
    v_add_f32 v38, v38, v46
    v_add_f32 v39, v39, v47
    s_barrier
    v_add_f32 v32, v32, v36
    v_add_f32 v33, v33, v37
    v_add_f32 v34, v34, v38
    v_add_f32 v35, v35, v39
    v_add_f32 v32, v32, v34
    v_add_f32 v33, v33, v35
    ds_write_b64 v12, v[32:33]
    s_waitcnt lgkmcnt(0)
    s_barrier
    s_barrier
    s_branch s_attn
.p2align 6
l_first:
    s_sub_u32 s51, s8, 5
    s_lshl_b32 s61, s51, 8
    s_add_u32 s61, s61, s2
    s_and_b32 s62, s61, 15
    s_lshr_b32 s63, s61, 4
    v_lshrrev_b32 v20, 3, v1
    v_mul_u32_u24 v12, 6144, v20
    v_and_b32 v21, 7, v1
    v_lshl_add_u32 v12, v21, 4, v12
    s_mov_b32 s20, s34
    s_mov_b32 s21, s35
    s_mov_b32 s22, 6291456
    s_mov_b32 s23, 0x00020000
    s_mov_b32 s28, s40
    s_mov_b32 s29, s41
    s_mov_b32 s30, 6291456
    s_mov_b32 s31, 0x00020000
    s_mul_i32 s52, s62, 393216
    s_lshl_b32 s56, s63, 7
    s_add_u32 s52, s52, s56
    s_barrier
    s_add_u32 s53, s52, 0
    buffer_load_dwordx4 v[136:139], v12, s[20:23], s53 offen nt
    s_add_u32 s53, s52, 49152
    buffer_load_dwordx4 v[140:143], v12, s[20:23], s53 offen nt
    s_add_u32 s53, s52, 98304
    buffer_load_dwordx4 v[144:147], v12, s[20:23], s53 offen nt
    s_add_u32 s53, s52, 147456
    buffer_load_dwordx4 v[148:151], v12, s[20:23], s53 offen nt
    v_lshlrev_b32 v14, 6, v20
    v_lshrrev_b32 v22, 5, v1
    v_bfe_u32 v23, v1, 1, 1
    v_xor_b32 v22, v22, v23
    v_lshl_add_u32 v14, v22, 5, v14
    v_and_b32 v22, 1, v1
    v_lshl_add_u32 v14, v22, 4, v14
    v_bfe_u32 v23, v1, 2, 1
    v_mul_u32_u24 v23, 196608, v23
    v_add_u32 v14, v14, v23
    v_lshlrev_b32 v22, 4, v22
    v_mov_b32 v23, 0x3f80
    v_lshlrev_b32 v23, v22, v23
    v_bfe_u32 v22, v1, 1, 3
    v_cmp_eq_u32 vcc, 0, v22
    s_nop 1
    v_cndmask_b32 v24, 0, v23, vcc
    v_cmp_eq_u32 vcc, 1, v22
    s_nop 1
    v_cndmask_b32 v25, 0, v23, vcc
    v_cmp_eq_u32 vcc, 2, v22
    s_nop 1
    v_cndmask_b32 v26, 0, v23, vcc
    v_cmp_eq_u32 vcc, 3, v22
    s_nop 1
    v_cndmask_b32 v27, 0, v23, vcc
    v_lshlrev_b32 v15, 5, v21
    v_and_b32 v22, 16, v1
    v_add_u32 v15, v15, v22
    v_lshlrev_b32 v16, 14, v1
    s_mov_b32 s9, 0
    s_lshr_b32 s55, s63, 4
    s_and_b32 s56, s63, 15
    s_mul_i32 s57, s56, 6
    s_add_u32 s57, s57, s55
    s_lshl_b32 s57, s57, 16
    s_lshl_b32 s58, s62, 12
    s_add_u32 s57, s57, s58
    s_add_u32 s57, s57, 50331648
    s_lshl_b32 s54, s61, 8
    s_add_u32 s54, s54, 63963136
    s_lshl_b32 s56, s56, 10
    s_lshl_b32 s55, s55, 7
    s_add_u32 s55, s55, s56
    s_lshl_b32 s56, s62, 2
    s_add_u32 s55, s55, s56
    s_add_u32 s55, s55, 64487424
    s_waitcnt vmcnt(3)
    s_add_u32 s53, s52, 196608
    buffer_load_dwordx4 v[152:155], v12, s[20:23], s53 offen nt
    s_add_u32 s53, s52, 245760
    buffer_load_dwordx4 v[156:159], v12, s[20:23], s53 offen nt
    s_add_u32 s53, s52, 294912
    buffer_load_dwordx4 v[160:163], v12, s[20:23], s53 offen nt
    buffer_store_dwordx4 v[136:139], v14, s[12:15], s57 offen offset:0 sc1
    v_mfma_f32_16x16x32_bf16 v[28:31], v[24:27], v[136:139], 0
    s_barrier
    s_waitcnt vmcnt(6)
    s_add_u32 s53, s52, 344064
    buffer_load_dwordx4 v[164:167], v12, s[20:23], s53 offen nt
    buffer_store_dwordx4 v[140:143], v14, s[12:15], s57 offen offset:512 sc1
    v_mfma_f32_16x16x32_bf16 v[28:31], v[24:27], v[140:143], v[28:31]
    s_waitcnt vmcnt(7)
    buffer_store_dwordx4 v[144:147], v14, s[12:15], s57 offen offset:1024 sc1
    v_mfma_f32_16x16x32_bf16 v[28:31], v[24:27], v[144:147], v[28:31]
    s_waitcnt vmcnt(7)
    buffer_store_dwordx4 v[148:151], v14, s[12:15], s57 offen offset:1536 sc1
    v_mfma_f32_16x16x32_bf16 v[28:31], v[24:27], v[148:151], v[28:31]
    s_waitcnt vmcnt(7)
    buffer_store_dwordx4 v[152:155], v14, s[12:15], s57 offen offset:2048 sc1
    v_mfma_f32_16x16x32_bf16 v[28:31], v[24:27], v[152:155], v[28:31]
    s_waitcnt vmcnt(7)
    buffer_store_dwordx4 v[156:159], v14, s[12:15], s57 offen offset:2560 sc1
    v_mfma_f32_16x16x32_bf16 v[28:31], v[24:27], v[156:159], v[28:31]
    s_waitcnt vmcnt(7)
    buffer_store_dwordx4 v[160:163], v14, s[12:15], s57 offen offset:3072 sc1
    v_mfma_f32_16x16x32_bf16 v[28:31], v[24:27], v[160:163], v[28:31]
    s_waitcnt vmcnt(6)
    buffer_store_dwordx4 v[164:167], v14, s[12:15], s57 offen offset:3584 sc1
    v_mfma_f32_16x16x32_bf16 v[28:31], v[24:27], v[164:167], v[28:31]
    s_nop 7
    v_add_f32_dpp v28, v28, v28 row_ror:8 row_mask:0xf bank_mask:0xf
    v_add_f32_dpp v29, v29, v29 row_ror:8 row_mask:0xf bank_mask:0xf
    v_add_f32_dpp v30, v30, v30 row_ror:8 row_mask:0xf bank_mask:0xf
    v_add_f32_dpp v31, v31, v31 row_ror:8 row_mask:0xf bank_mask:0xf
    s_mov_b64 exec, 0x00ff00ff
    buffer_store_dwordx4 v[28:31], v15, s[12:15], s54 offen sc1
    s_mov_b64 exec, -1
    s_add_u32 s57, s57, 6291456
    s_add_u32 s54, s54, 196608
    s_add_u32 s53, s52, 0
    buffer_load_dwordx4 v[168:171], v12, s[28:31], s53 offen nt
    s_add_u32 s53, s52, 49152
    buffer_load_dwordx4 v[172:175], v12, s[28:31], s53 offen nt
    s_add_u32 s53, s52, 98304
    buffer_load_dwordx4 v[176:179], v12, s[28:31], s53 offen nt
    s_add_u32 s53, s52, 147456
    buffer_load_dwordx4 v[180:183], v12, s[28:31], s53 offen nt
    s_add_u32 s53, s52, 196608
    buffer_load_dwordx4 v[184:187], v12, s[28:31], s53 offen nt
    s_add_u32 s53, s52, 245760
    buffer_load_dwordx4 v[188:191], v12, s[28:31], s53 offen nt
    s_add_u32 s53, s52, 294912
    buffer_load_dwordx4 v[192:195], v12, s[28:31], s53 offen nt
    s_add_u32 s53, s52, 344064
    buffer_load_dwordx4 v[196:199], v12, s[28:31], s53 offen nt
    v_mov_b32 v8, 159492
non_7:
    ds_read_b32 v9, v8
    s_waitcnt lgkmcnt(0)
    v_readfirstlane_b32 s10, v9
    s_cmp_eq_u32 s10, 0
    s_cbranch_scc1 non_7
    s_mov_b64 exec, 0xffff
    s_waitcnt vmcnt(8)
    buffer_store_dword v9, v16, s[12:15], s55 offen offset:0 sc1
    s_mov_b64 exec, -1
    s_mov_b32 s58, s52
    s_lshr_b32 s60, s2, 3
    s_mul_i32 s60, s60, 3
    s_lshr_b32 s60, s60, 5
    s_add_u32 s60, s60, 1
    s_branch l_qkv2
l_qkv:
    s_mov_b32 s60, 0
l_qkv2:
    v_and_b32 v1, 63, v0
    v_lshlrev_b32 v5, 4, v1
    s_sub_u32 s51, s8, 5
    s_lshl_b32 s48, s51, 13
    s_and_b32 s53, s9, 1
    s_lshl_b32 s52, s53, 4
    s_add_u32 s49, s7, s52
    s_lshl_b32 s49, s49, 1
    s_and_b32 s52, s6, 1
    s_add_u32 s49, s49, s52
    s_mul_i32 s49, s49, 3
    s_add_u32 s49, s49, s51
    s_lshl_b32 s49, s49, 16
    s_add_u32 s49, s49, 50331648
    v_mov_b32 v13, 159496
    s_cmp_lg_u32 s9, 0
    s_cbranch_scc1 l_qkv_tiled
    s_lshl_b32 s53, s8, 7
    s_lshl_b32 s52, s11, 10
    s_add_u32 s53, s53, s52
    s_add_u32 s53, s53, 64486784
    s_add_u32 s96, s4, s53
    s_addc_u32 s97, s5, 0
    s_mov_b32 s98, s10
    s_mov_b32 s99, s10
    s_mov_b32 s3, 0x20000
poll_8:
    s_load_dwordx16 s[80:95], s[96:97], 0 glc
    s_sub_u32 s3, s3, 1
    s_cbranch_scc1 poll_8_ok
    s_waitcnt lgkmcnt(0)
    s_xor_b64 s[100:101], s[80:81], s[98:99]
    s_xor_b64 s[80:81], s[82:83], s[98:99]
    s_or_b64 s[100:101], s[100:101], s[80:81]
    s_xor_b64 s[80:81], s[84:85], s[98:99]
    s_or_b64 s[100:101], s[100:101], s[80:81]
    s_xor_b64 s[80:81], s[86:87], s[98:99]
    s_or_b64 s[100:101], s[100:101], s[80:81]
    s_xor_b64 s[80:81], s[88:89], s[98:99]
    s_or_b64 s[100:101], s[100:101], s[80:81]
    s_xor_b64 s[80:81], s[90:91], s[98:99]
    s_or_b64 s[100:101], s[100:101], s[80:81]
    s_xor_b64 s[80:81], s[92:93], s[98:99]
    s_or_b64 s[100:101], s[100:101], s[80:81]
    s_xor_b64 s[80:81], s[94:95], s[98:99]
    s_or_b64 s[100:101], s[100:101], s[80:81]
    s_cbranch_scc1 poll_8
poll_8_ok:
    s_waitcnt lgkmcnt(0)
l_qkv_tiled:
    s_mov_b32 s50, 0
    s_mov_b32 m0, s48
    s_add_u32 s50, s50, 1
    buffer_load_dwordx4 v5, s[12:15], s49 offen offset:0 sc1 lds
    buffer_load_dwordx4 v5, s[12:15], s49 offen offset:1024 sc1 lds
    buffer_load_dwordx4 v5, s[12:15], s49 offen offset:2048 sc1 lds
    buffer_load_dwordx4 v5, s[12:15], s49 offen offset:3072 sc1 lds
    s_add_u32 s49, s49, 4096
    s_bitcmp1_b32 s50, 0
    s_cselect_b32 s3, 0, 16384
    s_add_u32 s48, s48, s3
    s_cmp_eq_u32 s50, 12
    s_cselect_b32 s3, 4294819840, 0
    s_add_u32 s48, s48, 4096
    s_add_u32 s48, s48, s3
    s_mov_b32 m0, s48
    s_add_u32 s50, s50, 1
    buffer_load_dwordx4 v5, s[12:15], s49 offen offset:0 sc1 lds
    buffer_load_dwordx4 v5, s[12:15], s49 offen offset:1024 sc1 lds
    buffer_load_dwordx4 v5, s[12:15], s49 offen offset:2048 sc1 lds
    buffer_load_dwordx4 v5, s[12:15], s49 offen offset:3072 sc1 lds
    s_add_u32 s49, s49, 4096
    s_bitcmp1_b32 s50, 0
    s_cselect_b32 s3, 0, 16384
    s_add_u32 s48, s48, s3
    s_cmp_eq_u32 s50, 12
    s_cselect_b32 s3, 4294819840, 0
    s_add_u32 s48, s48, 4096
    s_add_u32 s48, s48, s3
    v_lshrrev_b32 v10, 4, v1
    v_and_b32 v11, 0xff, v5
    v_lshl_add_u32 v10, v10, 12, v11
    s_lshl_b32 s3, s51, 9
    s_add_u32 s3, s3, 155648
    v_lshl_add_u32 v11, v1, 3, s3
    s_and_b32 s59, s6, 14
    s_add_u32 s59, s59, s51
    s_sub_u32 s59, s59, 1
    s_max_i32 s59, s59, 0
    s_lshl_b32 s59, s59, 14
    s_lshl_b32 s3, s9, 18
    s_add_u32 s59, s59, s3
    s_add_u32 s59, s59, 62914560
    s_and_b32 s3, s9, 1
    s_lshl_b32 s3, s3, 3
    s_add_u32 s3, s3, 56
    s_cmp_eq_u32 s51, 0
    s_cselect_b32 s3, s3, 0
    v_cmp_gt_u32 vcc, s3, v1
    v_mov_b32 v20, 0x7ff00000
    s_nop 0
    v_cndmask_b32 v10, v10, v20, vcc
    s_lshl_b32 s3, s7, 7
    v_lshrrev_b32 v20, 3, v1
    v_lshlrev_b32 v21, 11, v20
    v_lshrrev_b32 v22, 2, v1
    v_lshrrev_b32 v23, 4, v1
    v_xor_b32 v22, v22, v23
    v_and_b32 v22, 1, v22
    v_lshl_add_u32 v21, v22, 6, v21
    v_and_b32 v22, 3, v1
    v_lshl_add_u32 v21, v22, 4, v21
    v_add_u32 v17, s3, v21
    s_add_u32 s52, s9, 1
    s_mov_b32 m0, s48
    s_add_u32 s50, s50, 1
    buffer_load_dwordx4 v5, s[12:15], s49 offen offset:0 sc1 lds
    s_waitcnt vmcnt(10)
    buffer_load_dwordx4 v5, s[12:15], s49 offen offset:1024 sc1 lds
    s_waitcnt vmcnt(10)
    buffer_load_dwordx4 v5, s[12:15], s49 offen offset:2048 sc1 lds
    s_waitcnt vmcnt(10)
    buffer_load_dwordx4 v5, s[12:15], s49 offen offset:3072 sc1 lds
    s_waitcnt vmcnt(10)
    s_add_u32 s49, s49, 4096
    s_bitcmp1_b32 s50, 0
    s_cselect_b32 s3, 0, 16384
    s_add_u32 s48, s48, s3
    s_cmp_eq_u32 s50, 12
    s_cselect_b32 s3, 4294819840, 0
    s_add_u32 s48, s48, 4096
    s_add_u32 s48, s48, s3
l_qkv_pre:
    s_mov_b32 m0, s48
    s_add_u32 s50, s50, 1
    buffer_load_dwordx4 v5, s[12:15], s49 offen offset:0 sc1 lds
    s_waitcnt vmcnt(10)
    buffer_load_dwordx4 v5, s[12:15], s49 offen offset:1024 sc1 lds
    s_waitcnt vmcnt(10)
    buffer_load_dwordx4 v5, s[12:15], s49 offen offset:2048 sc1 lds
    s_waitcnt vmcnt(10)
    buffer_load_dwordx4 v5, s[12:15], s49 offen offset:3072 sc1 lds
    s_waitcnt vmcnt(10)
    s_add_u32 s49, s49, 4096
    s_bitcmp1_b32 s50, 0
    s_cselect_b32 s3, 0, 16384
    s_add_u32 s48, s48, s3
    s_cmp_eq_u32 s50, 12
    s_cselect_b32 s3, 4294819840, 0
    s_add_u32 s48, s48, 4096
    s_add_u32 s48, s48, s3
    ds_read_b32 v8, v13
    s_cmp_ge_u32 s50, 12
    s_cbranch_scc1 l_qkv_go
    s_waitcnt lgkmcnt(0)
    v_readfirstlane_b32 s3, v8
    s_cmp_lg_u32 s3, s52
    s_cbranch_scc1 l_qkv_pre
    s_cmp_ge_u32 s50, 5
    s_cbranch_scc1 l_qkv_go
    s_waitcnt vmcnt(8)
l_qkv_go:
    s_waitcnt lgkmcnt(0)
    s_barrier
    s_barrier
    s_bitcmp0_b32 s50, 0
    s_cbranch_scc1 l_qkv_even
    s_mov_b32 m0, s48
    s_add_u32 s50, s50, 1
    buffer_load_dwordx4 v5, s[12:15], s49 offen offset:0 sc1 lds
    buffer_load_dwordx4 v5, s[12:15], s49 offen offset:1024 sc1 lds
    buffer_load_dwordx4 v5, s[12:15], s49 offen offset:2048 sc1 lds
    buffer_load_dwordx4 v5, s[12:15], s49 offen offset:3072 sc1 lds
    s_add_u32 s49, s49, 4096
    s_bitcmp1_b32 s50, 0
    s_cselect_b32 s3, 0, 16384
    s_add_u32 s48, s48, s3
    s_cmp_eq_u32 s50, 12
    s_cselect_b32 s3, 4294819840, 0
    s_add_u32 s48, s48, 4096
    s_add_u32 s48, s48, s3
l_qkv_even:
    s_cmp_gt_u32 s50, 10
    s_cbranch_scc1 stg_9
    s_mov_b32 m0, s48
    s_add_u32 s50, s50, 1
    buffer_load_dwordx4 v5, s[12:15], s49 offen offset:0 sc1 lds
    buffer_load_dwordx4 v5, s[12:15], s49 offen offset:1024 sc1 lds
    buffer_load_dwordx4 v5, s[12:15], s49 offen offset:2048 sc1 lds
    buffer_load_dwordx4 v5, s[12:15], s49 offen offset:3072 sc1 lds
    s_add_u32 s49, s49, 4096
    s_bitcmp1_b32 s50, 0
    s_cselect_b32 s3, 0, 16384
    s_add_u32 s48, s48, s3
    s_cmp_eq_u32 s50, 12
    s_cselect_b32 s3, 4294819840, 0
    s_add_u32 s48, s48, 4096
    s_add_u32 s48, s48, s3
    s_mov_b32 m0, s48
    s_add_u32 s50, s50, 1
    buffer_load_dwordx4 v5, s[12:15], s49 offen offset:0 sc1 lds
    buffer_load_dwordx4 v5, s[12:15], s49 offen offset:1024 sc1 lds
    buffer_load_dwordx4 v5, s[12:15], s49 offen offset:2048 sc1 lds
    buffer_load_dwordx4 v5, s[12:15], s49 offen offset:3072 sc1 lds
    s_add_u32 s49, s49, 4096
    s_bitcmp1_b32 s50, 0
    s_cselect_b32 s3, 0, 16384
    s_add_u32 s48, s48, s3
    s_cmp_eq_u32 s50, 12
    s_cselect_b32 s3, 4294819840, 0
    s_add_u32 s48, s48, 4096
    s_add_u32 s48, s48, s3
stg_9:
    s_waitcnt vmcnt(8)
    s_barrier
    s_cmp_gt_u32 s50, 12
    s_cbranch_scc1 stg_10
    s_mov_b32 m0, s48
    s_add_u32 s50, s50, 1
    buffer_load_dwordx4 v5, s[12:15], s49 offen offset:0 sc1 lds
    buffer_load_dwordx4 v5, s[12:15], s49 offen offset:1024 sc1 lds
    buffer_load_dwordx4 v5, s[12:15], s49 offen offset:2048 sc1 lds
    buffer_load_dwordx4 v5, s[12:15], s49 offen offset:3072 sc1 lds
    s_add_u32 s49, s49, 4096
    s_bitcmp1_b32 s50, 0
    s_cselect_b32 s3, 0, 16384
    s_add_u32 s48, s48, s3
    s_cmp_eq_u32 s50, 12
    s_cselect_b32 s3, 4294819840, 0
    s_add_u32 s48, s48, 4096
    s_add_u32 s48, s48, s3
    s_mov_b32 m0, s48
    s_add_u32 s50, s50, 1
    buffer_load_dwordx4 v5, s[12:15], s49 offen offset:0 sc1 lds
    buffer_load_dwordx4 v5, s[12:15], s49 offen offset:1024 sc1 lds
    buffer_load_dwordx4 v5, s[12:15], s49 offen offset:2048 sc1 lds
    buffer_load_dwordx4 v5, s[12:15], s49 offen offset:3072 sc1 lds
    s_add_u32 s49, s49, 4096
    s_bitcmp1_b32 s50, 0
    s_cselect_b32 s3, 0, 16384
    s_add_u32 s48, s48, s3
    s_cmp_eq_u32 s50, 12
    s_cselect_b32 s3, 4294819840, 0
    s_add_u32 s48, s48, 4096
    s_add_u32 s48, s48, s3
stg_10:
    s_cmp_eq_u32 s60, 0
    s_cbranch_scc1 ub_11
    buffer_store_dwordx4 v[168:171], v14, s[12:15], s57 offen offset:0 sc1
    v_mfma_f32_16x16x32_bf16 v[28:31], v[24:27], v[168:171], 0
    buffer_store_dwordx4 v[172:175], v14, s[12:15], s57 offen offset:512 sc1
    v_mfma_f32_16x16x32_bf16 v[28:31], v[24:27], v[172:175], v[28:31]
ub_11:
    buffer_load_dwordx4 v[72:75], v10, s[12:15], s59 offen offset:0 sc1
    buffer_load_dwordx4 v[76:79], v10, s[12:15], s59 offen offset:256 sc1
    buffer_load_dwordx4 v[80:83], v10, s[12:15], s59 offen offset:512 sc1
    buffer_load_dwordx4 v[84:87], v10, s[12:15], s59 offen offset:768 sc1
    buffer_load_dwordx4 v[88:91], v10, s[12:15], s59 offen offset:1024 sc1
    buffer_load_dwordx4 v[92:95], v10, s[12:15], s59 offen offset:1280 sc1
    buffer_load_dwordx4 v[96:99], v10, s[12:15], s59 offen offset:1536 sc1
    buffer_load_dwordx4 v[100:103], v10, s[12:15], s59 offen offset:1792 sc1
    s_waitcnt vmcnt(8)
    s_barrier
    s_cmp_gt_u32 s50, 14
    s_cbranch_scc1 stg_12
    s_mov_b32 m0, s48
    s_add_u32 s50, s50, 1
    buffer_load_dwordx4 v5, s[12:15], s49 offen offset:0 sc1 lds
    buffer_load_dwordx4 v5, s[12:15], s49 offen offset:1024 sc1 lds
    buffer_load_dwordx4 v5, s[12:15], s49 offen offset:2048 sc1 lds
    buffer_load_dwordx4 v5, s[12:15], s49 offen offset:3072 sc1 lds
    s_add_u32 s49, s49, 4096
    s_bitcmp1_b32 s50, 0
    s_cselect_b32 s3, 0, 16384
    s_add_u32 s48, s48, s3
    s_cmp_eq_u32 s50, 12
    s_cselect_b32 s3, 4294819840, 0
    s_add_u32 s48, s48, 4096
    s_add_u32 s48, s48, s3
    s_mov_b32 m0, s48
    s_add_u32 s50, s50, 1
    buffer_load_dwordx4 v5, s[12:15], s49 offen offset:0 sc1 lds
    buffer_load_dwordx4 v5, s[12:15], s49 offen offset:1024 sc1 lds
    buffer_load_dwordx4 v5, s[12:15], s49 offen offset:2048 sc1 lds
    buffer_load_dwordx4 v5, s[12:15], s49 offen offset:3072 sc1 lds
    s_add_u32 s49, s49, 4096
    s_bitcmp1_b32 s50, 0
    s_cselect_b32 s3, 0, 16384
    s_add_u32 s48, s48, s3
    s_cmp_eq_u32 s50, 12
    s_cselect_b32 s3, 4294819840, 0
    s_add_u32 s48, s48, 4096
    s_add_u32 s48, s48, s3
stg_12:
    s_cmp_eq_u32 s60, 0
    s_cbranch_scc1 ub_13
    buffer_store_dwordx4 v[176:179], v14, s[12:15], s57 offen offset:1024 sc1
    v_mfma_f32_16x16x32_bf16 v[28:31], v[24:27], v[176:179], v[28:31]
    buffer_store_dwordx4 v[180:183], v14, s[12:15], s57 offen offset:1536 sc1
    v_mfma_f32_16x16x32_bf16 v[28:31], v[24:27], v[180:183], v[28:31]
ub_13:
    buffer_load_dwordx4 v[104:107], v10, s[12:15], s59 offen offset:2048 sc1
    buffer_load_dwordx4 v[108:111], v10, s[12:15], s59 offen offset:2304 sc1
    buffer_load_dwordx4 v[112:115], v10, s[12:15], s59 offen offset:2560 sc1
    buffer_load_dwordx4 v[116:119], v10, s[12:15], s59 offen offset:2816 sc1
    buffer_load_dwordx4 v[120:123], v10, s[12:15], s59 offen offset:3072 sc1
    buffer_load_dwordx4 v[124:127], v10, s[12:15], s59 offen offset:3328 sc1
    buffer_load_dwordx4 v[128:131], v10, s[12:15], s59 offen offset:3584 sc1
    buffer_load_dwordx4 v[132:135], v10, s[12:15], s59 offen offset:3840 sc1
    s_waitcnt vmcnt(8)
    s_barrier
    s_waitcnt vmcnt(0)
    s_cmp_gt_u32 s50, 14
    s_cbranch_scc1 stg_14
    s_mov_b32 m0, s48
    s_add_u32 s50, s50, 1
    buffer_load_dwordx4 v5, s[12:15], s49 offen offset:0 sc1 lds
    buffer_load_dwordx4 v5, s[12:15], s49 offen offset:1024 sc1 lds
    buffer_load_dwordx4 v5, s[12:15], s49 offen offset:2048 sc1 lds
    buffer_load_dwordx4 v5, s[12:15], s49 offen offset:3072 sc1 lds
    s_add_u32 s49, s49, 4096
    s_bitcmp1_b32 s50, 0
    s_cselect_b32 s3, 0, 16384
    s_add_u32 s48, s48, s3
    s_cmp_eq_u32 s50, 12
    s_cselect_b32 s3, 4294819840, 0
    s_add_u32 s48, s48, 4096
    s_add_u32 s48, s48, s3
    s_mov_b32 m0, s48
    s_add_u32 s50, s50, 1
    buffer_load_dwordx4 v5, s[12:15], s49 offen offset:0 sc1 lds
    buffer_load_dwordx4 v5, s[12:15], s49 offen offset:1024 sc1 lds
    buffer_load_dwordx4 v5, s[12:15], s49 offen offset:2048 sc1 lds
    buffer_load_dwordx4 v5, s[12:15], s49 offen offset:3072 sc1 lds
    s_add_u32 s49, s49, 4096
    s_bitcmp1_b32 s50, 0
    s_cselect_b32 s3, 0, 16384
    s_add_u32 s48, s48, s3
    s_cmp_eq_u32 s50, 12
    s_cselect_b32 s3, 4294819840, 0
    s_add_u32 s48, s48, 4096
    s_add_u32 s48, s48, s3
stg_14:
    s_cmp_eq_u32 s60, 0
    s_cbranch_scc1 ub_15
    buffer_store_dwordx4 v[184:187], v14, s[12:15], s57 offen offset:2048 sc1
    v_mfma_f32_16x16x32_bf16 v[28:31], v[24:27], v[184:187], v[28:31]
    buffer_store_dwordx4 v[188:191], v14, s[12:15], s57 offen offset:2560 sc1
    v_mfma_f32_16x16x32_bf16 v[28:31], v[24:27], v[188:191], v[28:31]
ub_15:
    v_add_f32 v72, v72, v104
    v_add_f32 v73, v73, v105
    v_add_f32 v74, v74, v106
    v_add_f32 v75, v75, v107
    v_add_f32 v76, v76, v108
    v_add_f32 v77, v77, v109
    v_add_f32 v78, v78, v110
    v_add_f32 v79, v79, v111
    v_add_f32 v80, v80, v112
    v_add_f32 v81, v81, v113
    v_add_f32 v82, v82, v114
    v_add_f32 v83, v83, v115
    v_add_f32 v84, v84, v116
    v_add_f32 v85, v85, v117
    v_add_f32 v86, v86, v118
    v_add_f32 v87, v87, v119
    s_waitcnt vmcnt(8)
    s_barrier
    s_cmp_gt_u32 s50, 14
    s_cbranch_scc1 stg_16
    s_mov_b32 m0, s48
    s_add_u32 s50, s50, 1
    buffer_load_dwordx4 v5, s[12:15], s49 offen offset:0 sc1 lds
    buffer_load_dwordx4 v5, s[12:15], s49 offen offset:1024 sc1 lds
    buffer_load_dwordx4 v5, s[12:15], s49 offen offset:2048 sc1 lds
    buffer_load_dwordx4 v5, s[12:15], s49 offen offset:3072 sc1 lds
    s_add_u32 s49, s49, 4096
    s_bitcmp1_b32 s50, 0
    s_cselect_b32 s3, 0, 16384
    s_add_u32 s48, s48, s3
    s_cmp_eq_u32 s50, 12
    s_cselect_b32 s3, 4294819840, 0
    s_add_u32 s48, s48, 4096
    s_add_u32 s48, s48, s3
    s_mov_b32 m0, s48
    s_add_u32 s50, s50, 1
    buffer_load_dwordx4 v5, s[12:15], s49 offen offset:0 sc1 lds
    buffer_load_dwordx4 v5, s[12:15], s49 offen offset:1024 sc1 lds
    buffer_load_dwordx4 v5, s[12:15], s49 offen offset:2048 sc1 lds
    buffer_load_dwordx4 v5, s[12:15], s49 offen offset:3072 sc1 lds
    s_add_u32 s49, s49, 4096
    s_bitcmp1_b32 s50, 0
    s_cselect_b32 s3, 0, 16384
    s_add_u32 s48, s48, s3
    s_cmp_eq_u32 s50, 12
    s_cselect_b32 s3, 4294819840, 0
    s_add_u32 s48, s48, 4096
    s_add_u32 s48, s48, s3
stg_16:
    s_cmp_eq_u32 s60, 0
    s_cbranch_scc1 ub_17
    buffer_store_dwordx4 v[192:195], v14, s[12:15], s57 offen offset:3072 sc1
    v_mfma_f32_16x16x32_bf16 v[28:31], v[24:27], v[192:195], v[28:31]
    buffer_store_dwordx4 v[196:199], v14, s[12:15], s57 offen offset:3584 sc1
    v_mfma_f32_16x16x32_bf16 v[28:31], v[24:27], v[196:199], v[28:31]
ub_17:
    v_add_f32 v88, v88, v120
    v_add_f32 v89, v89, v121
    v_add_f32 v90, v90, v122
    v_add_f32 v91, v91, v123
    v_add_f32 v92, v92, v124
    v_add_f32 v93, v93, v125
    v_add_f32 v94, v94, v126
    v_add_f32 v95, v95, v127
    v_add_f32 v96, v96, v128
    v_add_f32 v97, v97, v129
    v_add_f32 v98, v98, v130
    v_add_f32 v99, v99, v131
    v_add_f32 v100, v100, v132
    v_add_f32 v101, v101, v133
    v_add_f32 v102, v102, v134
    v_add_f32 v103, v103, v135
    s_waitcnt vmcnt(8)
    s_barrier
    s_cmp_gt_u32 s50, 14
    s_cbranch_scc1 stg_18
    s_mov_b32 m0, s48
    s_add_u32 s50, s50, 1
    buffer_load_dwordx4 v5, s[12:15], s49 offen offset:0 sc1 lds
    buffer_load_dwordx4 v5, s[12:15], s49 offen offset:1024 sc1 lds
    buffer_load_dwordx4 v5, s[12:15], s49 offen offset:2048 sc1 lds
    buffer_load_dwordx4 v5, s[12:15], s49 offen offset:3072 sc1 lds
    s_add_u32 s49, s49, 4096
    s_bitcmp1_b32 s50, 0
    s_cselect_b32 s3, 0, 16384
    s_add_u32 s48, s48, s3
    s_cmp_eq_u32 s50, 12
    s_cselect_b32 s3, 4294819840, 0
    s_add_u32 s48, s48, 4096
    s_add_u32 s48, s48, s3
    s_mov_b32 m0, s48
    s_add_u32 s50, s50, 1
    buffer_load_dwordx4 v5, s[12:15], s49 offen offset:0 sc1 lds
    buffer_load_dwordx4 v5, s[12:15], s49 offen offset:1024 sc1 lds
    buffer_load_dwordx4 v5, s[12:15], s49 offen offset:2048 sc1 lds
    buffer_load_dwordx4 v5, s[12:15], s49 offen offset:3072 sc1 lds
    s_add_u32 s49, s49, 4096
    s_bitcmp1_b32 s50, 0
    s_cselect_b32 s3, 0, 16384
    s_add_u32 s48, s48, s3
    s_cmp_eq_u32 s50, 12
    s_cselect_b32 s3, 4294819840, 0
    s_add_u32 s48, s48, 4096
    s_add_u32 s48, s48, s3
stg_18:
    s_cmp_eq_u32 s60, 0
    s_cbranch_scc1 ub_19
    v_add_f32_dpp v28, v28, v28 row_ror:8 row_mask:0xf bank_mask:0xf
    v_add_f32_dpp v29, v29, v29 row_ror:8 row_mask:0xf bank_mask:0xf
    v_add_f32_dpp v30, v30, v30 row_ror:8 row_mask:0xf bank_mask:0xf
    v_add_f32_dpp v31, v31, v31 row_ror:8 row_mask:0xf bank_mask:0xf
    s_mov_b64 exec, 0x00ff00ff
    buffer_store_dwordx4 v[28:31], v15, s[12:15], s54 offen sc1
    s_mov_b64 exec, -1
ub_19:
    v_add_f32 v72, v72, v88
    v_add_f32 v73, v73, v89
    v_add_f32 v74, v74, v90
    v_add_f32 v75, v75, v91
    v_add_f32 v76, v76, v92
    v_add_f32 v77, v77, v93
    v_add_f32 v78, v78, v94
    v_add_f32 v79, v79, v95
    v_add_f32 v80, v80, v96
    v_add_f32 v81, v81, v97
    v_add_f32 v82, v82, v98
    v_add_f32 v83, v83, v99
    v_add_f32 v84, v84, v100
    v_add_f32 v85, v85, v101
    v_add_f32 v86, v86, v102
    v_add_f32 v87, v87, v103
    s_waitcnt vmcnt(8)
    s_barrier
    v_add_f32 v72, v72, v80
    v_add_f32 v73, v73, v81
    v_add_f32 v74, v74, v82
    v_add_f32 v75, v75, v83
    v_add_f32 v76, v76, v84
    v_add_f32 v77, v77, v85
    v_add_f32 v78, v78, v86
    v_add_f32 v79, v79, v87
    v_add_f32 v72, v72, v76
    v_add_f32 v73, v73, v77
    v_add_f32 v74, v74, v78
    v_add_f32 v75, v75, v79
    v_mul_f32 v72, 0x3a800000, v72
    v_mul_f32 v74, 0x3a800000, v74
    v_mul_f32 v73, 0x3a800000, v73
    v_mul_f32 v75, 0x3a800000, v75
    s_waitcnt vmcnt(0)
    s_barrier
    s_cmp_eq_u32 s60, 0
    s_cbranch_scc1 ub_20
    s_mov_b64 exec, 0xffff
    buffer_store_dword v9, v16, s[12:15], s55 offen offset:384 sc1
    s_mov_b64 exec, -1
ub_20:
    v_fma_f32 v73, -v72, v72, v73
    v_fma_f32 v75, -v74, v74, v75
    v_max_f32 v73, 0, v73
    v_max_f32 v75, 0, v75
    v_add_f32 v73, 0x3727c5ac, v73
    v_add_f32 v75, 0x3727c5ac, v75
    v_rsq_f32 v73, v73
    v_rsq_f32 v75, v75
    v_swap_b32 v73, v74
    ds_write_b64 v11, v[72:73] offset:768
    ds_write_b64 v11, v[74:75] offset:2304
    s_waitcnt lgkmcnt(0)
    s_barrier
    s_bitcmp1_b32 s9, 0
    s_cbranch_scc1 s_attn
    s_mov_b32 s24, s36
    s_mov_b32 s25, s37
    s_mov_b32 s26, 2097152
    s_mov_b32 s27, 0x00020000
    s_add_u32 s60, s51, 48
wop_21:
    s_lshl_b32 m0, s60, 10
    s_lshl_b32 s3, s60, 14
    buffer_load_dwordx4 v17, s[24:27], s3 offen lds
    s_add_u32 s60, s60, 3
    s_waitcnt vmcnt(7)
    s_cmp_lt_u32 s60, 84
    s_cbranch_scc1 wop_21
    s_barrier
wop_22:
    s_lshl_b32 m0, s60, 10
    s_lshl_b32 s3, s60, 14
    buffer_load_dwordx4 v17, s[24:27], s3 offen lds
    s_add_u32 s60, s60, 3
    s_waitcnt vmcnt(7)
    s_cmp_lt_u32 s60, 128
    s_cbranch_scc1 wop_22
    s_mov_b32 s60, s51
wop_23:
    s_lshl_b32 m0, s60, 10
    s_lshl_b32 s3, s60, 14
    buffer_load_dwordx4 v17, s[24:27], s3 offen lds
    s_add_u32 s60, s60, 3
    s_waitcnt vmcnt(7)
    s_cmp_lt_u32 s60, 48
    s_cbranch_scc1 wop_23
    s_branch l_wo
.p2align 6
h_wo:
    s_mul_i32 s98, s9, 786432
    s_add_u32 s98, s98, 65798144
    s_lshl_b32 s99, s11, 10
    s_add_u32 s98, s98, s99
    s_add_u32 s96, s4, s98
    s_addc_u32 s97, s5, 0
    s_mov_b32 s98, s10
    s_mov_b32 s99, s10
    s_mov_b32 s3, 0x20000
poll_24:
    s_load_dwordx8 s[64:71], s[96:97], 0 glc
    s_load_dwordx8 s[72:79], s[96:97], 128 glc
    s_load_dwordx8 s[80:87], s[96:97], 256 glc
    s_load_dwordx8 s[88:95], s[96:97], 384 glc
    s_sub_u32 s3, s3, 1
    s_cbranch_scc1 poll_24_ok
    s_waitcnt lgkmcnt(0)
    s_xor_b64 s[100:101], s[64:65], s[98:99]
    s_xor_b64 s[64:65], s[66:67], s[98:99]
    s_or_b64 s[100:101], s[100:101], s[64:65]
    s_xor_b64 s[64:65], s[68:69], s[98:99]
    s_or_b64 s[100:101], s[100:101], s[64:65]
    s_xor_b64 s[64:65], s[70:71], s[98:99]
    s_or_b64 s[100:101], s[100:101], s[64:65]
    s_xor_b64 s[64:65], s[72:73], s[98:99]
    s_or_b64 s[100:101], s[100:101], s[64:65]
    s_xor_b64 s[64:65], s[74:75], s[98:99]
    s_or_b64 s[100:101], s[100:101], s[64:65]
    s_xor_b64 s[64:65], s[76:77], s[98:99]
    s_or_b64 s[100:101], s[100:101], s[64:65]
    s_xor_b64 s[64:65], s[78:79], s[98:99]
    s_or_b64 s[100:101], s[100:101], s[64:65]
    s_xor_b64 s[64:65], s[80:81], s[98:99]
    s_or_b64 s[100:101], s[100:101], s[64:65]
    s_xor_b64 s[64:65], s[82:83], s[98:99]
    s_or_b64 s[100:101], s[100:101], s[64:65]
    s_xor_b64 s[64:65], s[84:85], s[98:99]
    s_or_b64 s[100:101], s[100:101], s[64:65]
    s_xor_b64 s[64:65], s[86:87], s[98:99]
    s_or_b64 s[100:101], s[100:101], s[64:65]
    s_xor_b64 s[64:65], s[88:89], s[98:99]
    s_or_b64 s[100:101], s[100:101], s[64:65]
    s_xor_b64 s[64:65], s[90:91], s[98:99]
    s_or_b64 s[100:101], s[100:101], s[64:65]
    s_xor_b64 s[64:65], s[92:93], s[98:99]
    s_or_b64 s[100:101], s[100:101], s[64:65]
    s_xor_b64 s[64:65], s[94:95], s[98:99]
    s_or_b64 s[100:101], s[100:101], s[64:65]
    s_cbranch_scc1 poll_24
poll_24_ok:
    s_waitcnt lgkmcnt(0)
l_wo:
    s_waitcnt vmcnt(0)
    s_barrier
    s_cmp_eq_u32 s8, 4
    s_cbranch_scc1 l_wo_end
    s_cmp_lg_u32 s9, 0
    s_cbranch_scc1 l_wo_end
    s_lshl_b32 s53, s8, 7
    s_lshl_b32 s52, s11, 10
    s_add_u32 s53, s53, s52
    s_add_u32 s53, s53, 64487168
    s_add_u32 s96, s4, s53
    s_addc_u32 s97, s5, 0
    s_mov_b32 s98, s10
    s_mov_b32 s99, s10
    s_mov_b32 s3, 0x20000
poll_25:
    s_load_dwordx16 s[80:95], s[96:97], 0 glc
    s_sub_u32 s3, s3, 1
    s_cbranch_scc1 poll_25_ok
    s_waitcnt lgkmcnt(0)
    s_xor_b64 s[100:101], s[80:81], s[98:99]
    s_xor_b64 s[80:81], s[82:83], s[98:99]
    s_or_b64 s[100:101], s[100:101], s[80:81]
    s_xor_b64 s[80:81], s[84:85], s[98:99]
    s_or_b64 s[100:101], s[100:101], s[80:81]
    s_xor_b64 s[80:81], s[86:87], s[98:99]
    s_or_b64 s[100:101], s[100:101], s[80:81]
    s_xor_b64 s[80:81], s[88:89], s[98:99]
    s_or_b64 s[100:101], s[100:101], s[80:81]
    s_xor_b64 s[80:81], s[90:91], s[98:99]
    s_or_b64 s[100:101], s[100:101], s[80:81]
    s_xor_b64 s[80:81], s[92:93], s[98:99]
    s_or_b64 s[100:101], s[100:101], s[80:81]
    s_xor_b64 s[80:81], s[94:95], s[98:99]
    s_or_b64 s[100:101], s[100:101], s[80:81]
    s_cbranch_scc1 poll_25
poll_25_ok:
    s_waitcnt lgkmcnt(0)
l_wo_end:
    s_barrier
    s_add_u32 s9, s9, 1
    s_cmp_eq_u32 s9, 4
    s_cbranch_scc1 k_exit
    s_cmp_lg_u32 s8, 4
    s_cbranch_scc1 l_qkv
    s_cmp_eq_u32 s9, 2
    s_cbranch_scc1 h_qkvA
    s_branch h_qkvB
.p2align 6
s_attn:
    s_sub_u32 s48, s8, 4
    s_lshl_b32 s3, s7, 7
    v_lshrrev_b32 v20, 3, v1
    v_lshlrev_b32 v21, 11, v20
    v_lshrrev_b32 v22, 2, v1
    v_lshrrev_b32 v23, 4, v1
    v_xor_b32 v22, v22, v23
    v_and_b32 v22, 1, v22
    v_lshl_add_u32 v21, v22, 6, v21
    v_and_b32 v22, 3, v1
    v_lshl_add_u32 v21, v22, 4, v21
    v_add_u32 v7, s3, v21
    s_mov_b32 s24, s42
    s_mov_b32 s25, s43
    s_mov_b32 s26, 2097152
    s_mov_b32 s27, 0x00020000
    s_lshr_b32 s49, s9, 1
    s_lshl_b32 s49, s49, 23
    s_lshl_b32 s52, s7, 19
    s_add_u32 s49, s49, s52
    s_and_b32 s52, s6, 1
    s_lshl_b32 s52, s52, 18
    s_add_u32 s49, s49, s52
    s_add_u32 s49, s49, 33554432
    s_lshr_b32 s61, s6, 1
    s_lshl_b32 s52, s48, 13
    s_add_u32 s53, s52, 81920
    v_add_u32 v8, s53, v5
    s_lshl_b32 s53, s61, 15
    s_add_u32 s52, s52, s53
    s_add_u32 s62, s52, s49
    s_add_u32 s63, s62, 4096
    s_mul_i32 s59, s9, 786432
    s_add_u32 s59, s59, 66322432
    s_and_b32 s52, s11, 31
    s_lshl_b32 s52, s52, 10
    s_add_u32 s59, s59, s52
    s_lshr_b32 s52, s61, 1
    s_lshl_b32 s52, s52, 7
    s_add_u32 s59, s59, s52
    s_and_b32 s52, s61, 1
    s_lshl_b32 s52, s52, 2
    s_add_u32 s52, s52, s48
    s_lshl_b32 s52, s52, 2
    s_add_u32 s59, s59, s52
    v_lshlrev_b32 v20, 15, v1
    v_mov_b32 v21, s10
    s_mul_i32 s54, s9, 786432
    s_add_u32 s54, s54, 66322432
    s_lshl_b32 s55, s11, 10
    s_add_u32 s54, s54, s55
    s_add_u32 s52, s4, s54
    s_addc_u32 s53, s5, 0
    s_mov_b32 s54, s10
    s_mov_b32 s55, s10
    s_lshl_b32 s51, s48, 11
    s_add_u32 s49, s49, s51
    s_add_u32 s51, s51, 81920
    s_mov_b32 s60, s48
    s_setprio 3
    s_barrier
    ds_read_b128 v[32:35], v8 offset:0
    ds_read_b128 v[36:39], v8 offset:1024
    ds_read_b128 v[40:43], v8 offset:2048
    ds_read_b128 v[44:47], v8 offset:3072
    ds_read_b128 v[48:51], v8 offset:4096
    ds_read_b128 v[52:55], v8 offset:5120
    ds_read_b128 v[56:59], v8 offset:6144
    ds_read_b128 v[60:63], v8 offset:7168
    s_waitcnt lgkmcnt(7)
    buffer_store_dwordx4 v[32:35], v5, s[12:15], s62 offen offset:0 sc1
    s_waitcnt lgkmcnt(6)
    buffer_store_dwordx4 v[36:39], v5, s[12:15], s62 offen offset:1024 sc1
    s_waitcnt lgkmcnt(5)
    buffer_store_dwordx4 v[40:43], v5, s[12:15], s62 offen offset:2048 sc1
    s_waitcnt lgkmcnt(4)
    buffer_store_dwordx4 v[44:47], v5, s[12:15], s62 offen offset:3072 sc1
    s_waitcnt lgkmcnt(3)
    buffer_store_dwordx4 v[48:51], v5, s[12:15], s63 offen offset:0 sc1
    s_waitcnt lgkmcnt(2)
    buffer_store_dwordx4 v[52:55], v5, s[12:15], s63 offen offset:1024 sc1
    s_waitcnt lgkmcnt(1)
    buffer_store_dwordx4 v[56:59], v5, s[12:15], s63 offen offset:2048 sc1
    s_waitcnt lgkmcnt(0)
    buffer_store_dwordx4 v[60:63], v5, s[12:15], s63 offen offset:3072 sc1
    s_mov_b64 exec, 0xff
    s_waitcnt vmcnt(0)
    buffer_store_dword v21, v20, s[12:15], s59 offen sc1
    s_mov_b64 exec, -1
    s_lshl_b32 s58, 1, s61
    s_mov_b32 s57, 0
    s_add_u32 s62, s61, 1
    s_and_b32 s62, s62, 7
    s_lshl_b32 s50, s62, 15
    s_add_u32 s50, s50, s49
    s_lshr_b32 s63, s62, 1
    s_lshl_b32 s63, s63, 7
    s_and_b32 s62, s62, 1
    s_lshl_b32 s62, s62, 4
    s_add_u32 s62, s62, s63
    s_mov_b32 s58, 0x20000
need_26:
    s_load_dwordx4 s[64:67], s[52:53], s62 glc
    s_sub_u32 s58, s58, 1
    s_cbranch_scc1 need_26_ok
    s_waitcnt lgkmcnt(0)
    s_xor_b64 s[64:65], s[64:65], s[54:55]
    s_xor_b64 s[66:67], s[66:67], s[54:55]
    s_or_b64 s[64:65], s[64:65], s[66:67]
    s_cbranch_scc1 need_26
need_26_ok:
    s_waitcnt lgkmcnt(0)
    s_add_u32 m0, s51, 32768
    s_nop 0
    buffer_load_dwordx4 v5, s[12:15], s50 offen offset:0 sc1 lds
    buffer_load_dwordx4 v5, s[12:15], s50 offen offset:1024 sc1 lds
    s_add_u32 s50, s50, 8192
    s_add_u32 m0, s51, 40960
    s_nop 0
    buffer_load_dwordx4 v5, s[12:15], s50 offen offset:0 sc1 lds
    buffer_load_dwordx4 v5, s[12:15], s50 offen offset:1024 sc1 lds
    s_add_u32 s50, s50, 8192
    s_add_u32 m0, s51, 49152
    s_nop 0
    buffer_load_dwordx4 v5, s[12:15], s50 offen offset:0 sc1 lds
    buffer_load_dwordx4 v5, s[12:15], s50 offen offset:1024 sc1 lds
    s_add_u32 s50, s50, 8192
    s_add_u32 m0, s51, 57344
    s_nop 0
    buffer_load_dwordx4 v5, s[12:15], s50 offen offset:0 sc1 lds
    buffer_load_dwordx4 v5, s[12:15], s50 offen offset:1024 sc1 lds
    s_add_u32 s50, s50, 8192
    s_waitcnt vmcnt(4)
    s_barrier
    s_add_u32 s62, s61, 2
    s_and_b32 s62, s62, 7
    s_lshl_b32 s50, s62, 15
    s_add_u32 s50, s50, s49
    s_lshr_b32 s63, s62, 1
    s_lshl_b32 s63, s63, 7
    s_and_b32 s62, s62, 1
    s_lshl_b32 s62, s62, 4
    s_add_u32 s62, s62, s63
    s_mov_b32 s58, 0x20000
need_27:
    s_load_dwordx4 s[64:67], s[52:53], s62 glc
    s_sub_u32 s58, s58, 1
    s_cbranch_scc1 need_27_ok
    s_waitcnt lgkmcnt(0)
    s_xor_b64 s[64:65], s[64:65], s[54:55]
    s_xor_b64 s[66:67], s[66:67], s[54:55]
    s_or_b64 s[64:65], s[64:65], s[66:67]
    s_cbranch_scc1 need_27
need_27_ok:
    s_waitcnt lgkmcnt(0)
    s_add_u32 m0, s51, 0
    s_nop 0
    buffer_load_dwordx4 v5, s[12:15], s50 offen offset:0 sc1 lds
    buffer_load_dwordx4 v5, s[12:15], s50 offen offset:1024 sc1 lds
    s_add_u32 s50, s50, 8192
    s_add_u32 m0, s51, 8192
    s_nop 0
    buffer_load_dwordx4 v5, s[12:15], s50 offen offset:0 sc1 lds
    buffer_load_dwordx4 v5, s[12:15], s50 offen offset:1024 sc1 lds
    s_add_u32 s50, s50, 8192
    s_waitcnt vmcnt(4)
    s_barrier
    s_add_u32 m0, s51, 16384
    s_nop 0
    buffer_load_dwordx4 v5, s[12:15], s50 offen offset:0 sc1 lds
    buffer_load_dwordx4 v5, s[12:15], s50 offen offset:1024 sc1 lds
    s_add_u32 s50, s50, 8192
    s_add_u32 m0, s51, 24576
    s_nop 0
    buffer_load_dwordx4 v5, s[12:15], s50 offen offset:0 sc1 lds
    buffer_load_dwordx4 v5, s[12:15], s50 offen offset:1024 sc1 lds
    s_add_u32 s50, s50, 8192
    s_waitcnt vmcnt(4)
    s_barrier
    s_add_u32 s62, s61, 3
    s_and_b32 s62, s62, 7
    s_lshl_b32 s50, s62, 15
    s_add_u32 s50, s50, s49
    s_lshr_b32 s63, s62, 1
    s_lshl_b32 s63, s63, 7
    s_and_b32 s62, s62, 1
    s_lshl_b32 s62, s62, 4
    s_add_u32 s62, s62, s63
    s_mov_b32 s58, 0x20000
need_28:
    s_load_dwordx4 s[64:67], s[52:53], s62 glc
    s_sub_u32 s58, s58, 1
    s_cbranch_scc1 need_28_ok
    s_waitcnt lgkmcnt(0)
    s_xor_b64 s[64:65], s[64:65], s[54:55]
    s_xor_b64 s[66:67], s[66:67], s[54:55]
    s_or_b64 s[64:65], s[64:65], s[66:67]
    s_cbranch_scc1 need_28
need_28_ok:
    s_waitcnt lgkmcnt(0)
    s_add_u32 m0, s51, 32768
    s_nop 0
    buffer_load_dwordx4 v5, s[12:15], s50 offen offset:0 sc1 lds
    buffer_load_dwordx4 v5, s[12:15], s50 offen offset:1024 sc1 lds
    s_add_u32 s50, s50, 8192
    s_add_u32 m0, s51, 40960
    s_nop 0
    buffer_load_dwordx4 v5, s[12:15], s50 offen offset:0 sc1 lds
    buffer_load_dwordx4 v5, s[12:15], s50 offen offset:1024 sc1 lds
    s_add_u32 s50, s50, 8192
    s_lshl_b32 m0, s60, 10
    s_lshl_b32 s3, s60, 14
    buffer_load_dwordx4 v7, s[24:27], s3 offen lds
    s_add_u32 s60, s60, 4
    s_lshl_b32 m0, s60, 10
    s_lshl_b32 s3, s60, 14
    buffer_load_dwordx4 v7, s[24:27], s3 offen lds
    s_add_u32 s60, s60, 4
    s_waitcnt vmcnt(6)
    s_barrier
    s_add_u32 m0, s51, 49152
    s_nop 0
    buffer_load_dwordx4 v5, s[12:15], s50 offen offset:0 sc1 lds
    buffer_load_dwordx4 v5, s[12:15], s50 offen offset:1024 sc1 lds
    s_add_u32 s50, s50, 8192
    s_add_u32 m0, s51, 57344
    s_nop 0
    buffer_load_dwordx4 v5, s[12:15], s50 offen offset:0 sc1 lds
    buffer_load_dwordx4 v5, s[12:15], s50 offen offset:1024 sc1 lds
    s_add_u32 s50, s50, 8192
    s_lshl_b32 m0, s60, 10
    s_lshl_b32 s3, s60, 14
    buffer_load_dwordx4 v7, s[24:27], s3 offen lds
    s_add_u32 s60, s60, 4
    s_lshl_b32 m0, s60, 10
    s_lshl_b32 s3, s60, 14
    buffer_load_dwordx4 v7, s[24:27], s3 offen lds
    s_add_u32 s60, s60, 4
    s_waitcnt vmcnt(8)
    s_barrier
    s_add_u32 s62, s61, 4
    s_and_b32 s62, s62, 7
    s_lshl_b32 s50, s62, 15
    s_add_u32 s50, s50, s49
    s_lshr_b32 s63, s62, 1
    s_lshl_b32 s63, s63, 7
    s_and_b32 s62, s62, 1
    s_lshl_b32 s62, s62, 4
    s_add_u32 s62, s62, s63
    s_mov_b32 s58, 0x20000
need_29:
    s_load_dwordx4 s[64:67], s[52:53], s62 glc
    s_sub_u32 s58, s58, 1
    s_cbranch_scc1 need_29_ok
    s_waitcnt lgkmcnt(0)
    s_xor_b64 s[64:65], s[64:65], s[54:55]
    s_xor_b64 s[66:67], s[66:67], s[54:55]
    s_or_b64 s[64:65], s[64:65], s[66:67]
    s_cbranch_scc1 need_29
need_29_ok:
    s_waitcnt lgkmcnt(0)
    s_add_u32 m0, s51, 0
    s_nop 0
    buffer_load_dwordx4 v5, s[12:15], s50 offen offset:0 sc1 lds
    buffer_load_dwordx4 v5, s[12:15], s50 offen offset:1024 sc1 lds
    s_add_u32 s50, s50, 8192
    s_add_u32 m0, s51, 8192
    s_nop 0
    buffer_load_dwordx4 v5, s[12:15], s50 offen offset:0 sc1 lds
    buffer_load_dwordx4 v5, s[12:15], s50 offen offset:1024 sc1 lds
    s_add_u32 s50, s50, 8192
    s_lshl_b32 m0, s60, 10
    s_lshl_b32 s3, s60, 14
    buffer_load_dwordx4 v7, s[24:27], s3 offen lds
    s_add_u32 s60, s60, 4
    s_lshl_b32 m0, s60, 10
    s_lshl_b32 s3, s60, 14
    buffer_load_dwordx4 v7, s[24:27], s3 offen lds
    s_add_u32 s60, s60, 4
    s_waitcnt vmcnt(8)
    s_barrier
    s_add_u32 m0, s51, 16384
    s_nop 0
    buffer_load_dwordx4 v5, s[12:15], s50 offen offset:0 sc1 lds
    buffer_load_dwordx4 v5, s[12:15], s50 offen offset:1024 sc1 lds
    s_add_u32 s50, s50, 8192
    s_add_u32 m0, s51, 24576
    s_nop 0
    buffer_load_dwordx4 v5, s[12:15], s50 offen offset:0 sc1 lds
    buffer_load_dwordx4 v5, s[12:15], s50 offen offset:1024 sc1 lds
    s_add_u32 s50, s50, 8192
    s_lshl_b32 m0, s60, 10
    s_lshl_b32 s3, s60, 14
    buffer_load_dwordx4 v7, s[24:27], s3 offen lds
    s_add_u32 s60, s60, 4
    s_lshl_b32 m0, s60, 10
    s_lshl_b32 s3, s60, 14
    buffer_load_dwordx4 v7, s[24:27], s3 offen lds
    s_add_u32 s60, s60, 4
    s_waitcnt vmcnt(8)
    s_barrier
    s_add_u32 s62, s61, 5
    s_and_b32 s62, s62, 7
    s_lshl_b32 s50, s62, 15
    s_add_u32 s50, s50, s49
    s_lshr_b32 s63, s62, 1
    s_lshl_b32 s63, s63, 7
    s_and_b32 s62, s62, 1
    s_lshl_b32 s62, s62, 4
    s_add_u32 s62, s62, s63
    s_mov_b32 s58, 0x20000
need_30:
    s_load_dwordx4 s[64:67], s[52:53], s62 glc
    s_sub_u32 s58, s58, 1
    s_cbranch_scc1 need_30_ok
    s_waitcnt lgkmcnt(0)
    s_xor_b64 s[64:65], s[64:65], s[54:55]
    s_xor_b64 s[66:67], s[66:67], s[54:55]
    s_or_b64 s[64:65], s[64:65], s[66:67]
    s_cbranch_scc1 need_30
need_30_ok:
    s_waitcnt lgkmcnt(0)
    s_add_u32 m0, s51, 32768
    s_nop 0
    buffer_load_dwordx4 v5, s[12:15], s50 offen offset:0 sc1 lds
    buffer_load_dwordx4 v5, s[12:15], s50 offen offset:1024 sc1 lds
    s_add_u32 s50, s50, 8192
    s_add_u32 m0, s51, 40960
    s_nop 0
    buffer_load_dwordx4 v5, s[12:15], s50 offen offset:0 sc1 lds
    buffer_load_dwordx4 v5, s[12:15], s50 offen offset:1024 sc1 lds
    s_add_u32 s50, s50, 8192
    s_lshl_b32 m0, s60, 10
    s_lshl_b32 s3, s60, 14
    buffer_load_dwordx4 v7, s[24:27], s3 offen lds
    s_add_u32 s60, s60, 4
    s_lshl_b32 m0, s60, 10
    s_lshl_b32 s3, s60, 14
    buffer_load_dwordx4 v7, s[24:27], s3 offen lds
    s_add_u32 s60, s60, 4
    s_waitcnt vmcnt(8)
    s_barrier
    s_add_u32 m0, s51, 49152
    s_nop 0
    buffer_load_dwordx4 v5, s[12:15], s50 offen offset:0 sc1 lds
    buffer_load_dwordx4 v5, s[12:15], s50 offen offset:1024 sc1 lds
    s_add_u32 s50, s50, 8192
    s_add_u32 m0, s51, 57344
    s_nop 0
    buffer_load_dwordx4 v5, s[12:15], s50 offen offset:0 sc1 lds
    buffer_load_dwordx4 v5, s[12:15], s50 offen offset:1024 sc1 lds
    s_add_u32 s50, s50, 8192
    s_lshl_b32 m0, s60, 10
    s_lshl_b32 s3, s60, 14
    buffer_load_dwordx4 v7, s[24:27], s3 offen lds
    s_add_u32 s60, s60, 4
    s_lshl_b32 m0, s60, 10
    s_lshl_b32 s3, s60, 14
    buffer_load_dwordx4 v7, s[24:27], s3 offen lds
    s_add_u32 s60, s60, 4
    s_waitcnt vmcnt(8)
    s_barrier
    s_add_u32 s62, s61, 6
    s_and_b32 s62, s62, 7
    s_lshl_b32 s50, s62, 15
    s_add_u32 s50, s50, s49
    s_lshr_b32 s63, s62, 1
    s_lshl_b32 s63, s63, 7
    s_and_b32 s62, s62, 1
    s_lshl_b32 s62, s62, 4
    s_add_u32 s62, s62, s63
    s_mov_b32 s58, 0x20000
need_31:
    s_load_dwordx4 s[64:67], s[52:53], s62 glc
    s_sub_u32 s58, s58, 1
    s_cbranch_scc1 need_31_ok
    s_waitcnt lgkmcnt(0)
    s_xor_b64 s[64:65], s[64:65], s[54:55]
    s_xor_b64 s[66:67], s[66:67], s[54:55]
    s_or_b64 s[64:65], s[64:65], s[66:67]
    s_cbranch_scc1 need_31
need_31_ok:
    s_waitcnt lgkmcnt(0)
    s_add_u32 m0, s51, 0
    s_nop 0
    buffer_load_dwordx4 v5, s[12:15], s50 offen offset:0 sc1 lds
    buffer_load_dwordx4 v5, s[12:15], s50 offen offset:1024 sc1 lds
    s_add_u32 s50, s50, 8192
    s_add_u32 m0, s51, 8192
    s_nop 0
    buffer_load_dwordx4 v5, s[12:15], s50 offen offset:0 sc1 lds
    buffer_load_dwordx4 v5, s[12:15], s50 offen offset:1024 sc1 lds
    s_add_u32 s50, s50, 8192
    s_lshl_b32 m0, s60, 10
    s_lshl_b32 s3, s60, 14
    buffer_load_dwordx4 v7, s[24:27], s3 offen lds
    s_add_u32 s60, s60, 4
    s_lshl_b32 m0, s60, 10
    s_lshl_b32 s3, s60, 14
    buffer_load_dwordx4 v7, s[24:27], s3 offen lds
    s_add_u32 s60, s60, 4
    s_waitcnt vmcnt(8)
    s_barrier
    s_add_u32 m0, s51, 16384
    s_nop 0
    buffer_load_dwordx4 v5, s[12:15], s50 offen offset:0 sc1 lds
    buffer_load_dwordx4 v5, s[12:15], s50 offen offset:1024 sc1 lds
    s_add_u32 s50, s50, 8192
    s_add_u32 m0, s51, 24576
    s_nop 0
    buffer_load_dwordx4 v5, s[12:15], s50 offen offset:0 sc1 lds
    buffer_load_dwordx4 v5, s[12:15], s50 offen offset:1024 sc1 lds
    s_add_u32 s50, s50, 8192
    s_lshl_b32 m0, s60, 10
    s_lshl_b32 s3, s60, 14
    buffer_load_dwordx4 v7, s[24:27], s3 offen lds
    s_add_u32 s60, s60, 4
    s_lshl_b32 m0, s60, 10
    s_lshl_b32 s3, s60, 14
    buffer_load_dwordx4 v7, s[24:27], s3 offen lds
    s_add_u32 s60, s60, 4
    s_waitcnt vmcnt(8)
    s_barrier
    s_add_u32 s62, s61, 7
    s_and_b32 s62, s62, 7
    s_lshl_b32 s50, s62, 15
    s_add_u32 s50, s50, s49
    s_lshr_b32 s63, s62, 1
    s_lshl_b32 s63, s63, 7
    s_and_b32 s62, s62, 1
    s_lshl_b32 s62, s62, 4
    s_add_u32 s62, s62, s63
    s_mov_b32 s58, 0x20000
need_32:
    s_load_dwordx4 s[64:67], s[52:53], s62 glc
    s_sub_u32 s58, s58, 1
    s_cbranch_scc1 need_32_ok
    s_waitcnt lgkmcnt(0)
    s_xor_b64 s[64:65], s[64:65], s[54:55]
    s_xor_b64 s[66:67], s[66:67], s[54:55]
    s_or_b64 s[64:65], s[64:65], s[66:67]
    s_cbranch_scc1 need_32
need_32_ok:
    s_waitcnt lgkmcnt(0)
    s_add_u32 m0, s51, 32768
    s_nop 0
    buffer_load_dwordx4 v5, s[12:15], s50 offen offset:0 sc1 lds
    buffer_load_dwordx4 v5, s[12:15], s50 offen offset:1024 sc1 lds
    s_add_u32 s50, s50, 8192
    s_add_u32 m0, s51, 40960
    s_nop 0
    buffer_load_dwordx4 v5, s[12:15], s50 offen offset:0 sc1 lds
    buffer_load_dwordx4 v5, s[12:15], s50 offen offset:1024 sc1 lds
    s_add_u32 s50, s50, 8192
    s_lshl_b32 m0, s60, 10
    s_lshl_b32 s3, s60, 14
    buffer_load_dwordx4 v7, s[24:27], s3 offen lds
    s_add_u32 s60, s60, 4
    s_lshl_b32 m0, s60, 10
    s_lshl_b32 s3, s60, 14
    buffer_load_dwordx4 v7, s[24:27], s3 offen lds
    s_add_u32 s60, s60, 4
    s_waitcnt vmcnt(8)
    s_barrier
    s_add_u32 m0, s51, 49152
    s_nop 0
    buffer_load_dwordx4 v5, s[12:15], s50 offen offset:0 sc1 lds
    buffer_load_dwordx4 v5, s[12:15], s50 offen offset:1024 sc1 lds
    s_add_u32 s50, s50, 8192
    s_add_u32 m0, s51, 57344
    s_nop 0
    buffer_load_dwordx4 v5, s[12:15], s50 offen offset:0 sc1 lds
    buffer_load_dwordx4 v5, s[12:15], s50 offen offset:1024 sc1 lds
    s_add_u32 s50, s50, 8192
    s_lshl_b32 m0, s60, 10
    s_lshl_b32 s3, s60, 14
    buffer_load_dwordx4 v7, s[24:27], s3 offen lds
    s_add_u32 s60, s60, 4
    s_lshl_b32 m0, s60, 10
    s_lshl_b32 s3, s60, 14
    buffer_load_dwordx4 v7, s[24:27], s3 offen lds
    s_add_u32 s60, s60, 4
    s_waitcnt vmcnt(8)
    s_barrier
    s_lshl_b32 m0, s60, 10
    s_lshl_b32 s3, s60, 14
    buffer_load_dwordx4 v7, s[24:27], s3 offen lds
    s_add_u32 s60, s60, 4
    s_lshl_b32 m0, s60, 10
    s_lshl_b32 s3, s60, 14
    buffer_load_dwordx4 v7, s[24:27], s3 offen lds
    s_add_u32 s60, s60, 4
    s_lshl_b32 m0, s60, 10
    s_lshl_b32 s3, s60, 14
    buffer_load_dwordx4 v7, s[24:27], s3 offen lds
    s_add_u32 s60, s60, 4
    s_lshl_b32 m0, s60, 10
    s_lshl_b32 s3, s60, 14
    buffer_load_dwordx4 v7, s[24:27], s3 offen lds
    s_add_u32 s60, s60, 4
    s_waitcnt vmcnt(6)
    s_barrier
    s_lshl_b32 m0, s60, 10
    s_lshl_b32 s3, s60, 14
    buffer_load_dwordx4 v7, s[24:27], s3 offen lds
    s_add_u32 s60, s60, 4
    s_lshl_b32 m0, s60, 10
    s_lshl_b32 s3, s60, 14
    buffer_load_dwordx4 v7, s[24:27], s3 offen lds
    s_add_u32 s60, s60, 4
    s_lshl_b32 m0, s60, 10
    s_lshl_b32 s3, s60, 14
    buffer_load_dwordx4 v7, s[24:27], s3 offen lds
    s_add_u32 s60, s60, 4
    s_lshl_b32 m0, s60, 10
    s_lshl_b32 s3, s60, 14
    buffer_load_dwordx4 v7, s[24:27], s3 offen lds
    s_add_u32 s60, s60, 4
    s_barrier
    s_lshl_b32 m0, s60, 10
    s_lshl_b32 s3, s60, 14
    buffer_load_dwordx4 v7, s[24:27], s3 offen lds
    s_add_u32 s60, s60, 4
    s_lshl_b32 m0, s60, 10
    s_lshl_b32 s3, s60, 14
    buffer_load_dwordx4 v7, s[24:27], s3 offen lds
    s_add_u32 s60, s60, 4
    s_lshl_b32 m0, s60, 10
    s_lshl_b32 s3, s60, 14
    buffer_load_dwordx4 v7, s[24:27], s3 offen lds
    s_add_u32 s60, s60, 4
    s_lshl_b32 m0, s60, 10
    s_lshl_b32 s3, s60, 14
    buffer_load_dwordx4 v7, s[24:27], s3 offen lds
    s_add_u32 s60, s60, 4
    s_setprio 0
    s_cmp_eq_u32 s8, 4
    s_cbranch_scc1 h_wo
    s_branch l_wo
.p2align 6
c_attn_slow:
    s_waitcnt lgkmcnt(0)
    s_lshr_b32 s56, s9, 1
    s_lshl_b32 s56, s56, 23
    s_lshl_b32 s55, s7, 19
    s_add_u32 s56, s56, s55
    s_and_b32 s55, s6, 1
    s_lshl_b32 s55, s55, 18
    s_add_u32 s56, s56, s55
    s_add_u32 s56, s56, 33554432
    v_mov_b32 v28, 0xff800000
    v_mov_b32 v30, 0xff800000
    s_mov_b32 s57, 0
c_attn_slow1:
    s_lshr_b32 s55, s57, 2
    s_lshl_b32 s55, s55, 14
    s_and_b32 s58, s57, 3
    s_lshl_b32 s58, s58, 11
    s_add_u32 s55, s55, s58
    s_add_u32 s55, s55, s56
    buffer_load_dwordx4 v[128:131], v5, s[12:15], s55 offen offset:0 sc1
    buffer_load_dwordx4 v[132:135], v5, s[12:15], s55 offen offset:1024 sc1
    s_waitcnt vmcnt(0)
    v_mfma_f32_32x32x16_bf16 v[64:79], v[128:131], v[8:11], 0
    v_mfma_f32_32x32x16_bf16 v[80:95], v[128:131], v[16:19], 0
    v_mfma_f32_32x32x16_bf16 v[64:79], v[132:135], v[12:15], v[64:79]
    v_mfma_f32_32x32x16_bf16 v[80:95], v[132:135], v[20:23], v[80:95]
    s_nop 10
    v_max3_f32 v28, v28, v64, v65
    v_max3_f32 v28, v28, v66, v67
    v_max3_f32 v28, v28, v68, v69
    v_max3_f32 v28, v28, v70, v71
    v_max3_f32 v28, v28, v72, v73
    v_max3_f32 v28, v28, v74, v75
    v_max3_f32 v28, v28, v76, v77
    v_max3_f32 v28, v28, v78, v79
    v_max3_f32 v30, v30, v80, v81
    v_max3_f32 v30, v30, v82, v83
    v_max3_f32 v30, v30, v84, v85
    v_max3_f32 v30, v30, v86, v87
    v_max3_f32 v30, v30, v88, v89
    v_max3_f32 v30, v30, v90, v91
    v_max3_f32 v30, v30, v92, v93
    v_max3_f32 v30, v30, v94, v95
    s_add_u32 s57, s57, 1
    s_cmp_lt_u32 s57, 64
    s_cbranch_scc1 c_attn_slow1
    v_mov_b32 v29, v28
    s_nop 1
    v_permlane32_swap_b32 v28, v29
    v_max_f32 v28, v28, v29
    v_sub_f32 v96, 0, v28
    v_sub_f32 v97, 0, v28
    v_sub_f32 v98, 0, v28
    v_sub_f32 v99, 0, v28
    v_sub_f32 v100, 0, v28
    v_sub_f32 v101, 0, v28
    v_sub_f32 v102, 0, v28
    v_sub_f32 v103, 0, v28
    v_sub_f32 v104, 0, v28
    v_sub_f32 v105, 0, v28
    v_sub_f32 v106, 0, v28
    v_sub_f32 v107, 0, v28
    v_sub_f32 v108, 0, v28
    v_sub_f32 v109, 0, v28
    v_sub_f32 v110, 0, v28
    v_sub_f32 v111, 0, v28
    v_mov_b32 v160, 0
    v_mov_b32 v161, 0
    v_mov_b32 v162, 0
    v_mov_b32 v163, 0
    v_mov_b32 v164, 0
    v_mov_b32 v165, 0
    v_mov_b32 v166, 0
    v_mov_b32 v167, 0
    v_mov_b32 v168, 0
    v_mov_b32 v169, 0
    v_mov_b32 v170, 0
    v_mov_b32 v171, 0
    v_mov_b32 v172, 0
    v_mov_b32 v173, 0
    v_mov_b32 v174, 0
    v_mov_b32 v175, 0
    v_mov_b32 v192, 0
    v_mov_b32 v193, 0
    v_mov_b32 v194, 0
    v_mov_b32 v195, 0
    v_mov_b32 v31, v30
    s_nop 1
    v_permlane32_swap_b32 v30, v31
    v_max_f32 v30, v30, v31
    v_sub_f32 v112, 0, v30
    v_sub_f32 v113, 0, v30
    v_sub_f32 v114, 0, v30
    v_sub_f32 v115, 0, v30
    v_sub_f32 v116, 0, v30
    v_sub_f32 v117, 0, v30
    v_sub_f32 v118, 0, v30
    v_sub_f32 v119, 0, v30
    v_sub_f32 v120, 0, v30
    v_sub_f32 v121, 0, v30
    v_sub_f32 v122, 0, v30
    v_sub_f32 v123, 0, v30
    v_sub_f32 v124, 0, v30
    v_sub_f32 v125, 0, v30
    v_sub_f32 v126, 0, v30
    v_sub_f32 v127, 0, v30
    v_mov_b32 v176, 0
    v_mov_b32 v177, 0
    v_mov_b32 v178, 0
    v_mov_b32 v179, 0
    v_mov_b32 v180, 0
    v_mov_b32 v181, 0
    v_mov_b32 v182, 0
    v_mov_b32 v183, 0
    v_mov_b32 v184, 0
    v_mov_b32 v185, 0
    v_mov_b32 v186, 0
    v_mov_b32 v187, 0
    v_mov_b32 v188, 0
    v_mov_b32 v189, 0
    v_mov_b32 v190, 0
    v_mov_b32 v191, 0
    v_mov_b32 v196, 0
    v_mov_b32 v197, 0
    v_mov_b32 v198, 0
    v_mov_b32 v199, 0
    s_mov_b32 s57, 0
c_attn_slow2:
    s_lshr_b32 s55, s57, 2
    s_lshl_b32 s55, s55, 14
    s_and_b32 s58, s57, 3
    s_lshl_b32 s58, s58, 11
    s_add_u32 s55, s55, s58
    s_add_u32 s55, s55, s56
    buffer_load_dwordx4 v[128:131], v5, s[12:15], s55 offen offset:0 sc1
    buffer_load_dwordx4 v[132:135], v5, s[12:15], s55 offen offset:1024 sc1
    s_add_u32 s55, s55, 8192
    buffer_load_dwordx4 v[144:147], v5, s[12:15], s55 offen offset:0 sc1
    buffer_load_dwordx4 v[148:151], v5, s[12:15], s55 offen offset:1024 sc1
    s_waitcnt vmcnt(0)
    v_mfma_f32_32x32x16_bf16 v[64:79], v[128:131], v[8:11], v[96:111]
    v_mfma_f32_32x32x16_bf16 v[80:95], v[128:131], v[16:19], v[112:127]
    v_mfma_f32_32x32x16_bf16 v[64:79], v[132:135], v[12:15], v[64:79]
    v_mfma_f32_32x32x16_bf16 v[80:95], v[132:135], v[20:23], v[80:95]
    s_nop 10
    v_exp_f32 v64, v64
    v_exp_f32 v65, v65
    v_exp_f32 v66, v66
    v_exp_f32 v67, v67
    v_exp_f32 v68, v68
    v_exp_f32 v69, v69
    v_exp_f32 v70, v70
    v_exp_f32 v71, v71
    v_exp_f32 v72, v72
    v_exp_f32 v73, v73
    v_exp_f32 v74, v74
    v_exp_f32 v75, v75
    v_exp_f32 v76, v76
    v_exp_f32 v77, v77
    v_exp_f32 v78, v78
    v_exp_f32 v79, v79
    v_exp_f32 v80, v80
    v_exp_f32 v81, v81
    v_exp_f32 v82, v82
    v_exp_f32 v83, v83
    v_exp_f32 v84, v84
    v_exp_f32 v85, v85
    v_exp_f32 v86, v86
    v_exp_f32 v87, v87
    v_exp_f32 v88, v88
    v_exp_f32 v89, v89
    v_exp_f32 v90, v90
    v_exp_f32 v91, v91
    v_exp_f32 v92, v92
    v_exp_f32 v93, v93
    v_exp_f32 v94, v94
    v_exp_f32 v95, v95
    v_smfmac_f32_32x32x32_bf16 v[160:175], v[144:147], v[64:71], v204
    v_smfmac_f32_16x16x64_bf16 v[192:195], v[200:203], v[64:71], v204
    v_smfmac_f32_32x32x32_bf16 v[160:175], v[148:151], v[72:79], v204
    v_smfmac_f32_16x16x64_bf16 v[192:195], v[200:203], v[72:79], v204
    v_smfmac_f32_32x32x32_bf16 v[176:191], v[144:147], v[80:87], v204
    v_smfmac_f32_16x16x64_bf16 v[196:199], v[200:203], v[80:87], v204
    v_smfmac_f32_32x32x32_bf16 v[176:191], v[148:151], v[88:95], v204
    v_smfmac_f32_16x16x64_bf16 v[196:199], v[200:203], v[88:95], v204
    s_add_u32 s57, s57, 1
    s_cmp_lt_u32 s57, 64
    s_nop 15
    s_cbranch_scc1 c_attn_slow2
    s_branch c_attn_fin
    s_endpgm
.section .rodata,"a"
.p2align 6
.amdhsa_kernel interleave_layers__sliding_local_dilated__softmax_full_mha__prompt_kernel
  .amdhsa_next_free_vgpr 256
  .amdhsa_next_free_sgpr 102
  .amdhsa_accum_offset 224
  .amdhsa_group_segment_fixed_size 0
  .amdhsa_kernarg_size 72
  .amdhsa_user_sgpr_count 2
  .amdhsa_user_sgpr_kernarg_segment_ptr 1
  .amdhsa_system_sgpr_workgroup_id_x 1
.end_amdhsa_kernel
```

```asm
; @launch grid=(256,1,1) block=(512,1,1) lds=159744
.amdgcn_target "amdgcn-amd-amdhsa--gfx950"
.text
.globl interleave_layers__sliding_local_dilated__softmax_full_mha__prompt_kernel
.type interleave_layers__sliding_local_dilated__softmax_full_mha__prompt_kernel,@function
.p2align 8
interleave_layers__sliding_local_dilated__softmax_full_mha__prompt_kernel:
    s_cmp_ge_u32 s2, 256
    s_cbranch_scc1 k_exit2
    s_load_dwordx16 s[32:47], s[0:1], 0
    s_load_dwordx2 s[4:5], s[0:1], 64
    v_lshrrev_b32 v2, 6, v0
    v_and_b32 v1, 63, v0
    v_mov_b32 v12, 0
    v_mov_b32 v14, 0
    v_mov_b32 v15, 0
    v_mov_b32 v16, 0
    v_readfirstlane_b32 s8, v2
    s_and_b32 s3, s2, 1
    s_lshl_b32 s3, s3, 3
    s_bfe_u32 s6, s2, 0x30003
    s_add_u32 s6, s3, s6
    s_bfe_u32 s3, s2, 0x20001
    s_lshl_b32 s3, s3, 2
    s_lshr_b32 s7, s2, 6
    s_add_u32 s7, s3, s7
    s_lshl_b32 s11, s6, 4
    s_add_u32 s11, s11, s7
    s_mov_b32 s9, -1
    s_mov_b32 s96, 0
    s_mov_b32 s10, 0
    s_waitcnt lgkmcnt(0)
    s_mov_b32 s12, s4
    s_mov_b32 s13, s5
    s_mov_b32 s14, 71303168
    s_mov_b32 s15, 0x00020000
    s_cmp_lt_u32 s8, 4
    s_cbranch_scc1 c_prep
    s_cmp_eq_u32 s8, 4
    s_cbranch_scc1 h_first
    s_branch l_first
k_exit:
k_exit2:
    s_endpgm
.p2align 6
c_qkvA:
    v_and_b32 v1, 63, v0
    v_lshrrev_b32 v2, 6, v0
    v_lshlrev_b32 v5, 4, v1
    v_lshrrev_b32 v3, 5, v1
    v_and_b32 v4, 15, v0
    v_bfe_u32 v7, v1, 4, 1
    v_lshl_add_u32 v6, v7, 5, v4
    v_lshlrev_b32 v6, 4, v6
    v_lshl_add_u32 v6, v3, 10, v6
    s_lshr_b32 s48, s6, 1
    s_lshl_b32 s48, s48, 2
    s_add_u32 s48, s48, s8
    s_lshl_b32 s55, s48, 17
    s_lshl_b32 s56, s9, 22
    s_add_u32 s55, s55, s56
    s_add_u32 s16, s4, s55
    s_addc_u32 s17, s5, 0
    s_mov_b32 s18, 65536
    s_mov_b32 s19, 0x00020000
    s_add_u32 s56, s55, 65536
    s_add_u32 s20, s4, s56
    s_addc_u32 s21, s5, 0
    s_mov_b32 s22, 65536
    s_mov_b32 s23, 0x00020000
    s_lshl_b32 s49, s7, 12
    s_add_u32 s49, s49, s55
    s_and_b32 s56, s6, 1
    s_lshl_b32 s56, s56, 11
    s_add_u32 s49, s49, s56
    s_add_u32 s49, s49, 16777216
    s_movk_i32 s54, 4096
    v_lshrrev_b32 v16, 2, v4
    v_lshl_add_u32 v18, v7, 2, v16
    v_lshl_add_u32 v18, v3, 4, v18
    v_lshlrev_b32 v18, 6, v18
    v_and_b32 v17, 3, v4
    v_lshl_add_u32 v18, v17, 3, v18
    v_lshl_add_u32 v26, v7, 5, v18
    v_xor_b32 v27, 32, v26
    v_mov_b32 v24, v26
    v_mov_b32 v25, v27
    v_and_b32 v18, 0x30, v1
    v_add_u32 v10, 155648, v18
    v_lshlrev_b32 v11, 2, v4
    v_add_u32 v11, 155648, v11
    v_lshl_add_u32 v8, v2, 8, v11
    v_lshl_add_u32 v9, v2, 8, v10
    s_lshr_b32 s3, s8, 1
    s_and_b32 s55, s8, 1
    s_lshl_b32 s56, s55, 5
    v_xor_b32 v29, s56, v26
    s_lshl_b32 s56, s3, 13
    s_add_u32 s56, s56, 8192
    v_add_u32 v29, s56, v29
    v_mov_b32 v28, v29
    v_add_u32 v30, 147456, v5
    v_lshl_add_u32 v14, v2, 6, v10
    v_lshl_add_u32 v12, v2, 11, v5
    v_add_u32 v12, 131072, v12
    v_lshlrev_b32 v16, 8, v16
    v_lshl_add_u32 v16, v18, 2, v16
    v_lshl_add_u32 v16, v17, 1, v16
    v_add_u32 v16, 1024, v16
    v_cmp_gt_u32 vcc, 2, v2
    s_nop 1
    v_cndmask_b32 v13, v16, v5, vcc
    s_lshl_b32 s56, s55, 3
    s_add_u32 s56, s56, 131072
    v_add_u32 v13, s56, v13
    v_lshrrev_b32 v18, 2, v18
    v_sub_u32 v18, v4, v18
    v_mov_b32 v19, 0xf149f2ca
    v_add_u32 v16, 0x0, v18
    v_and_b32 v16, 0xfffffff1, v16
    v_cmp_eq_u32 vcc, 0, v16
    s_nop 1
    v_cndmask_b32 v196, v19, 0, vcc
    v_add_u32 v16, 0xffffffff, v18
    v_and_b32 v16, 0xfffffff1, v16
    v_cmp_eq_u32 vcc, 0, v16
    s_nop 1
    v_cndmask_b32 v197, v19, 0, vcc
    v_add_u32 v16, 0xfffffffe, v18
    v_and_b32 v16, 0xfffffff1, v16
    v_cmp_eq_u32 vcc, 0, v16
    s_nop 1
    v_cndmask_b32 v198, v19, 0, vcc
    v_add_u32 v16, 0xfffffffd, v18
    v_and_b32 v16, 0xfffffff1, v16
    v_cmp_eq_u32 vcc, 0, v16
    s_nop 1
    v_cndmask_b32 v199, v19, 0, vcc
    v_add_u32 v16, 0x10, v18
    v_and_b32 v16, 0xfffffff1, v16
    v_cmp_eq_u32 vcc, 0, v16
    s_nop 1
    v_cndmask_b32 v200, v19, 0, vcc
    v_add_u32 v16, 0xf, v18
    v_and_b32 v16, 0xfffffff1, v16
    v_cmp_eq_u32 vcc, 0, v16
    s_nop 1
    v_cndmask_b32 v201, v19, 0, vcc
    v_add_u32 v16, 0xe, v18
    v_and_b32 v16, 0xfffffff1, v16
    v_cmp_eq_u32 vcc, 0, v16
    s_nop 1
    v_cndmask_b32 v202, v19, 0, vcc
    v_add_u32 v16, 0xd, v18
    v_and_b32 v16, 0xfffffff1, v16
    v_cmp_eq_u32 vcc, 0, v16
    s_nop 1
    v_cndmask_b32 v203, v19, 0, vcc
    s_cmp_eq_u32 s48, 0
    s_cselect_b64 vcc, -1, 0
    v_cndmask_b32 v204, v200, v19, vcc
    v_cndmask_b32 v205, v201, v19, vcc
    v_cndmask_b32 v206, v202, v19, vcc
    v_cndmask_b32 v207, v203, v19, vcc
    v_mov_b32 v208, 0x3f803f80
    v_mov_b32 v209, 0x3f803f80
    v_mov_b32 v210, 0x3f803f80
    v_mov_b32 v211, 0x3f803f80
    v_mov_b32 v184, 0
    v_mov_b32 v185, 0
    v_mov_b32 v186, 0
    v_mov_b32 v187, 0
    v_mov_b32 v188, 0
    v_mov_b32 v189, 0
    v_mov_b32 v190, 0
    v_mov_b32 v191, 0
    v_mov_b32 v192, 0
    v_mov_b32 v193, 0
    v_mov_b32 v194, 0
    v_mov_b32 v195, 0
    v_mov_b32 v32, 0
    v_mov_b32 v33, 0
    v_mov_b32 v34, 0
    v_mov_b32 v35, 0
    v_mov_b32 v36, 0
    v_mov_b32 v37, 0
    v_mov_b32 v38, 0
    v_mov_b32 v39, 0
    v_mov_b32 v40, 0
    v_mov_b32 v41, 0
    v_mov_b32 v42, 0
    v_mov_b32 v43, 0
    v_mov_b32 v44, 0
    v_mov_b32 v45, 0
    v_mov_b32 v46, 0
    v_mov_b32 v47, 0
    v_mov_b32 v48, 0
    v_mov_b32 v49, 0
    v_mov_b32 v50, 0
    v_mov_b32 v51, 0
    v_mov_b32 v52, 0
    v_mov_b32 v53, 0
    v_mov_b32 v54, 0
    v_mov_b32 v55, 0
    v_mov_b32 v56, 0
    v_mov_b32 v57, 0
    v_mov_b32 v58, 0
    v_mov_b32 v59, 0
    v_mov_b32 v60, 0
    v_mov_b32 v61, 0
    v_mov_b32 v62, 0
    v_mov_b32 v63, 0
    v_mov_b32 v64, 0
    v_mov_b32 v65, 0
    v_mov_b32 v66, 0
    v_mov_b32 v67, 0
    v_mov_b32 v68, 0
    v_mov_b32 v69, 0
    v_mov_b32 v70, 0
    v_mov_b32 v71, 0
    v_mov_b32 v72, 0
    v_mov_b32 v73, 0
    v_mov_b32 v74, 0
    v_mov_b32 v75, 0
    v_mov_b32 v76, 0
    v_mov_b32 v77, 0
    v_mov_b32 v78, 0
    v_mov_b32 v79, 0
    v_mov_b32 v80, 0
    v_mov_b32 v81, 0
    v_mov_b32 v82, 0
    v_mov_b32 v83, 0
    v_mov_b32 v84, 0
    v_mov_b32 v85, 0
    v_mov_b32 v86, 0
    v_mov_b32 v87, 0
    v_mov_b32 v88, 0
    v_mov_b32 v89, 0
    v_mov_b32 v90, 0
    v_mov_b32 v91, 0
    v_mov_b32 v92, 0
    v_mov_b32 v93, 0
    v_mov_b32 v94, 0
    v_mov_b32 v95, 0
    v_mov_b32 v96, 0
    v_mov_b32 v97, 0
    v_mov_b32 v98, 0
    v_mov_b32 v99, 0
    v_mov_b32 v100, 0
    v_mov_b32 v101, 0
    v_mov_b32 v102, 0
    v_mov_b32 v103, 0
    v_mov_b32 v104, 0
    v_mov_b32 v105, 0
    v_mov_b32 v106, 0
    v_mov_b32 v107, 0
    v_mov_b32 v108, 0
    v_mov_b32 v109, 0
    v_mov_b32 v110, 0
    v_mov_b32 v111, 0
    v_mov_b32 v112, 0
    v_mov_b32 v113, 0
    v_mov_b32 v114, 0
    v_mov_b32 v115, 0
    v_mov_b32 v116, 0
    v_mov_b32 v117, 0
    v_mov_b32 v118, 0
    v_mov_b32 v119, 0
    v_mov_b32 v120, 0
    v_mov_b32 v121, 0
    v_mov_b32 v122, 0
    v_mov_b32 v123, 0
    v_mov_b32 v124, 0
    v_mov_b32 v125, 0
    v_mov_b32 v126, 0
    v_mov_b32 v127, 0
    s_mov_b32 s50, 8192
    s_mov_b32 s58, 6144
    s_mov_b32 s51, 12288
    s_mov_b32 s59, 10240
    s_mov_b32 s52, 0
    s_mul_i32 s60, s9, 786432
    s_add_u32 s60, s60, 65273856
    s_lshl_b32 s61, s11, 10
    s_add_u32 s60, s60, s61
    s_lshl_b32 s61, s8, 7
    s_add_u32 s60, s60, s61
    s_mov_b32 s98, s10
    s_mov_b32 s99, s10
    s_mov_b32 s3, 0x20000
cp_1:
    s_load_dwordx8 s[24:31], s[4:5], s60 glc
    s_sub_u32 s3, s3, 1
    s_cbranch_scc1 cp_1_ok
    s_waitcnt lgkmcnt(0)
    s_xor_b64 s[24:25], s[24:25], s[98:99]
    s_xor_b64 s[26:27], s[26:27], s[98:99]
    s_xor_b64 s[28:29], s[28:29], s[98:99]
    s_xor_b64 s[30:31], s[30:31], s[98:99]
    s_or_b64 s[24:25], s[24:25], s[26:27]
    s_or_b64 s[28:29], s[28:29], s[30:31]
    s_or_b64 s[24:25], s[24:25], s[28:29]
    s_cbranch_scc1 cp_1
cp_1_ok:
    s_waitcnt lgkmcnt(0)
    s_barrier
    buffer_load_dwordx4 v[152:155], v6, s[16:19], 0 offen offset:0 sc1
    buffer_load_dwordx4 v[156:159], v6, s[16:19], 0 offen offset:256 sc1
    buffer_load_dwordx4 v[160:163], v6, s[20:23], 0 offen offset:0 sc1
    buffer_load_dwordx4 v[164:167], v6, s[20:23], 0 offen offset:256 sc1
    ds_read_b64_tr_b16 v[128:129], v24 offset:0
    ds_read_b64_tr_b16 v[130:131], v24 offset:512
    ds_read_b64_tr_b16 v[132:133], v25 offset:0
    ds_read_b64_tr_b16 v[134:135], v25 offset:512
    ds_read_b64_tr_b16 v[136:137], v24 offset:8192
    ds_read_b64_tr_b16 v[138:139], v24 offset:8704
    ds_read_b64_tr_b16 v[140:141], v25 offset:8192
    ds_read_b64_tr_b16 v[142:143], v25 offset:8704
    ds_read_b64_tr_b16 v[144:145], v24 offset:16384
    ds_read_b64_tr_b16 v[146:147], v24 offset:16896
    buffer_load_dwordx4 v[168:171], v6, s[16:19], 0 offen offset:2048 sc1
    buffer_load_dwordx4 v[172:175], v6, s[16:19], 0 offen offset:2304 sc1
    buffer_load_dwordx4 v[176:179], v6, s[20:23], 0 offen offset:2048 sc1
    buffer_load_dwordx4 v[180:183], v6, s[20:23], 0 offen offset:2304 sc1
    buffer_load_dwordx4 a[0:3], v6, s[16:19], s54 offen offset:0 sc1
    buffer_load_dwordx4 a[4:7], v6, s[16:19], s54 offen offset:256 sc1
    buffer_load_dwordx4 a[8:11], v6, s[20:23], s54 offen offset:0 sc1
    buffer_load_dwordx4 a[12:15], v6, s[20:23], s54 offen offset:256 sc1
    buffer_load_dwordx4 a[16:19], v6, s[16:19], s54 offen offset:2048 sc1
    buffer_load_dwordx4 a[20:23], v6, s[16:19], s54 offen offset:2304 sc1
    s_mov_b32 s54, 7
    s_waitcnt vmcnt(12)
    s_barrier
.p2align 3
c_qkvA_loop:
    s_waitcnt vmcnt(12) lgkmcnt(8)
    v_mfma_f32_16x16x32_bf16 v[184:187], v[188:191], v[192:195], v[184:187]
    v_mfma_f32_16x16x32_bf16 v[32:35], v[128:131], v[152:155], v[32:35]
    ds_read_b64_tr_b16 v[148:149], v25 offset:16384
    buffer_load_dwordx4 a[24:27], v6, s[20:23], s58 offen offset:0 sc1
    v_mfma_f32_16x16x32_bf16 v[36:39], v[128:131], v[156:159], v[36:39]
    ds_read_b64_tr_b16 v[150:151], v25 offset:16896
    s_waitcnt lgkmcnt(8)
    v_mfma_f32_16x16x32_bf16 v[52:55], v[132:135], v[156:159], v[52:55]
    v_mfma_f32_16x16x32_bf16 v[48:51], v[132:135], v[152:155], v[48:51]
    ds_read_b64_tr_b16 v[188:189], v28 offset:0
    s_waitcnt lgkmcnt(7)
    v_mfma_f32_16x16x32_bf16 v[64:67], v[136:139], v[152:155], v[64:67]
    v_mfma_f32_16x16x32_bf16 v[68:71], v[136:139], v[156:159], v[68:71]
    ds_read_b64_tr_b16 v[190:191], v28 offset:512
    s_waitcnt lgkmcnt(6)
    v_mfma_f32_16x16x32_bf16 v[84:87], v[140:143], v[156:159], v[84:87]
    buffer_load_dwordx4 a[28:31], v6, s[20:23], s58 offen offset:256 sc1
    v_mfma_f32_16x16x32_bf16 v[80:83], v[140:143], v[152:155], v[80:83]
    ds_read_b128 v[192:195], v30 offset:0
    s_waitcnt lgkmcnt(5)
    v_mfma_f32_16x16x32_bf16 v[96:99], v[152:155], v[144:147], v[96:99]
    v_mfma_f32_16x16x32_bf16 v[100:103], v[156:159], v[144:147], v[100:103]
    s_waitcnt lgkmcnt(3)
    v_mfma_f32_16x16x32_bf16 v[116:119], v[156:159], v[148:151], v[116:119]
    v_mfma_f32_16x16x32_bf16 v[112:115], v[152:155], v[148:151], v[112:115]
    s_waitcnt vmcnt(12)
    v_mfma_f32_16x16x32_bf16 v[40:43], v[128:131], v[160:163], v[40:43]
    buffer_load_dwordx4 v[152:155], v6, s[16:19], s50 offen offset:0 sc1
    v_mfma_f32_16x16x32_bf16 v[44:47], v[128:131], v[164:167], v[44:47]
    v_mfma_f32_16x16x32_bf16 v[60:63], v[132:135], v[164:167], v[60:63]
    ds_read_b64_tr_b16 v[128:129], v24 offset:2048
    v_mfma_f32_16x16x32_bf16 v[56:59], v[132:135], v[160:163], v[56:59]
    ds_read_b64_tr_b16 v[130:131], v24 offset:2560
    v_mfma_f32_16x16x32_bf16 v[72:75], v[136:139], v[160:163], v[72:75]
    ds_read_b64_tr_b16 v[132:133], v25 offset:2048
    v_mfma_f32_16x16x32_bf16 v[76:79], v[136:139], v[164:167], v[76:79]
    ds_read_b64_tr_b16 v[134:135], v25 offset:2560
    v_mfma_f32_16x16x32_bf16 v[92:95], v[140:143], v[164:167], v[92:95]
    ds_read_b64_tr_b16 v[136:137], v24 offset:10240
    buffer_load_dwordx4 v[156:159], v6, s[16:19], s50 offen offset:256 sc1
    v_mfma_f32_16x16x32_bf16 v[88:91], v[140:143], v[160:163], v[88:91]
    ds_read_b64_tr_b16 v[138:139], v24 offset:10752
    v_mfma_f32_16x16x32_bf16 v[104:107], v[160:163], v[144:147], v[104:107]
    ds_read_b64_tr_b16 v[140:141], v25 offset:10240
    v_mfma_f32_16x16x32_bf16 v[108:111], v[164:167], v[144:147], v[108:111]
    ds_read_b64_tr_b16 v[142:143], v25 offset:10752
    v_mfma_f32_16x16x32_bf16 v[124:127], v[164:167], v[148:151], v[124:127]
    ds_read_b64_tr_b16 v[144:145], v24 offset:18432
    v_mfma_f32_16x16x32_bf16 v[120:123], v[160:163], v[148:151], v[120:123]
    ds_read_b64_tr_b16 v[146:147], v24 offset:18944
    s_waitcnt vmcnt(12) lgkmcnt(8)
    v_mfma_f32_16x16x32_bf16 v[184:187], v[188:191], v[192:195], v[184:187]
    v_mfma_f32_16x16x32_bf16 v[32:35], v[128:131], v[168:171], v[32:35]
    ds_read_b64_tr_b16 v[148:149], v25 offset:18432
    buffer_load_dwordx4 v[160:163], v6, s[20:23], s58 offen offset:2048 sc1
    v_mfma_f32_16x16x32_bf16 v[36:39], v[128:131], v[172:175], v[36:39]
    ds_read_b64_tr_b16 v[150:151], v25 offset:18944
    s_waitcnt lgkmcnt(8)
    v_mfma_f32_16x16x32_bf16 v[52:55], v[132:135], v[172:175], v[52:55]
    v_mfma_f32_16x16x32_bf16 v[48:51], v[132:135], v[168:171], v[48:51]
    ds_read_b64_tr_b16 v[188:189], v28 offset:2048
    s_waitcnt lgkmcnt(7)
    v_mfma_f32_16x16x32_bf16 v[64:67], v[136:139], v[168:171], v[64:67]
    v_mfma_f32_16x16x32_bf16 v[68:71], v[136:139], v[172:175], v[68:71]
    ds_read_b64_tr_b16 v[190:191], v28 offset:2560
    s_waitcnt lgkmcnt(6)
    v_mfma_f32_16x16x32_bf16 v[84:87], v[140:143], v[172:175], v[84:87]
    buffer_load_dwordx4 v[164:167], v6, s[20:23], s58 offen offset:2304 sc1
    v_mfma_f32_16x16x32_bf16 v[80:83], v[140:143], v[168:171], v[80:83]
    ds_read_b128 v[192:195], v30 offset:1024
    s_waitcnt lgkmcnt(5)
    v_mfma_f32_16x16x32_bf16 v[96:99], v[168:171], v[144:147], v[96:99]
    v_mfma_f32_16x16x32_bf16 v[100:103], v[172:175], v[144:147], v[100:103]
    s_waitcnt lgkmcnt(3)
    v_mfma_f32_16x16x32_bf16 v[116:119], v[172:175], v[148:151], v[116:119]
    v_mfma_f32_16x16x32_bf16 v[112:115], v[168:171], v[148:151], v[112:115]
    s_waitcnt vmcnt(12)
    v_mfma_f32_16x16x32_bf16 v[40:43], v[128:131], v[176:179], v[40:43]
    buffer_load_dwordx4 v[168:171], v6, s[16:19], s50 offen offset:2048 sc1
    v_mfma_f32_16x16x32_bf16 v[44:47], v[128:131], v[180:183], v[44:47]
    v_mfma_f32_16x16x32_bf16 v[60:63], v[132:135], v[180:183], v[60:63]
    ds_read_b64_tr_b16 v[128:129], v24 offset:4096
    v_mfma_f32_16x16x32_bf16 v[56:59], v[132:135], v[176:179], v[56:59]
    ds_read_b64_tr_b16 v[130:131], v24 offset:4608
    v_mfma_f32_16x16x32_bf16 v[72:75], v[136:139], v[176:179], v[72:75]
    ds_read_b64_tr_b16 v[132:133], v25 offset:4096
    v_mfma_f32_16x16x32_bf16 v[76:79], v[136:139], v[180:183], v[76:79]
    ds_read_b64_tr_b16 v[134:135], v25 offset:4608
    v_mfma_f32_16x16x32_bf16 v[92:95], v[140:143], v[180:183], v[92:95]
    ds_read_b64_tr_b16 v[136:137], v24 offset:12288
    buffer_load_dwordx4 v[172:175], v6, s[16:19], s50 offen offset:2304 sc1
    v_mfma_f32_16x16x32_bf16 v[88:91], v[140:143], v[176:179], v[88:91]
    ds_read_b64_tr_b16 v[138:139], v24 offset:12800
    v_mfma_f32_16x16x32_bf16 v[104:107], v[176:179], v[144:147], v[104:107]
    ds_read_b64_tr_b16 v[140:141], v25 offset:12288
    v_mfma_f32_16x16x32_bf16 v[108:111], v[180:183], v[144:147], v[108:111]
    ds_read_b64_tr_b16 v[142:143], v25 offset:12800
    v_mfma_f32_16x16x32_bf16 v[124:127], v[180:183], v[148:151], v[124:127]
    ds_read_b64_tr_b16 v[144:145], v24 offset:20480
    v_mfma_f32_16x16x32_bf16 v[120:123], v[176:179], v[148:151], v[120:123]
    ds_read_b64_tr_b16 v[146:147], v24 offset:20992
    s_waitcnt vmcnt(12) lgkmcnt(8)
    v_mfma_f32_16x16x32_bf16 v[184:187], v[188:191], v[192:195], v[184:187]
    v_mfma_f32_16x16x32_bf16 v[32:35], v[128:131], a[0:3], v[32:35]
    ds_read_b64_tr_b16 v[148:149], v25 offset:20480
    buffer_load_dwordx4 v[176:179], v6, s[20:23], s59 offen offset:0 sc1
    v_mfma_f32_16x16x32_bf16 v[36:39], v[128:131], a[4:7], v[36:39]
    ds_read_b64_tr_b16 v[150:151], v25 offset:20992
    s_waitcnt lgkmcnt(8)
    v_mfma_f32_16x16x32_bf16 v[52:55], v[132:135], a[4:7], v[52:55]
    v_mfma_f32_16x16x32_bf16 v[48:51], v[132:135], a[0:3], v[48:51]
    ds_read_b64_tr_b16 v[188:189], v28 offset:4096
    s_waitcnt lgkmcnt(7)
    v_mfma_f32_16x16x32_bf16 v[64:67], v[136:139], a[0:3], v[64:67]
    v_mfma_f32_16x16x32_bf16 v[68:71], v[136:139], a[4:7], v[68:71]
    ds_read_b64_tr_b16 v[190:191], v28 offset:4608
    s_waitcnt lgkmcnt(6)
    v_mfma_f32_16x16x32_bf16 v[84:87], v[140:143], a[4:7], v[84:87]
    buffer_load_dwordx4 v[180:183], v6, s[20:23], s59 offen offset:256 sc1
    v_mfma_f32_16x16x32_bf16 v[80:83], v[140:143], a[0:3], v[80:83]
    ds_read_b128 v[192:195], v30 offset:2048
    s_waitcnt lgkmcnt(5)
    v_mfma_f32_16x16x32_bf16 v[96:99], a[0:3], v[144:147], v[96:99]
    v_mfma_f32_16x16x32_bf16 v[100:103], a[4:7], v[144:147], v[100:103]
    s_waitcnt lgkmcnt(3)
    v_mfma_f32_16x16x32_bf16 v[116:119], a[4:7], v[148:151], v[116:119]
    v_mfma_f32_16x16x32_bf16 v[112:115], a[0:3], v[148:151], v[112:115]
    s_waitcnt vmcnt(12)
    v_mfma_f32_16x16x32_bf16 v[40:43], v[128:131], a[8:11], v[40:43]
    buffer_load_dwordx4 a[0:3], v6, s[16:19], s51 offen offset:0 sc1
    v_mfma_f32_16x16x32_bf16 v[44:47], v[128:131], a[12:15], v[44:47]
    v_mfma_f32_16x16x32_bf16 v[60:63], v[132:135], a[12:15], v[60:63]
    ds_read_b64_tr_b16 v[128:129], v24 offset:6144
    v_mfma_f32_16x16x32_bf16 v[56:59], v[132:135], a[8:11], v[56:59]
    ds_read_b64_tr_b16 v[130:131], v24 offset:6656
    v_mfma_f32_16x16x32_bf16 v[72:75], v[136:139], a[8:11], v[72:75]
    ds_read_b64_tr_b16 v[132:133], v25 offset:6144
    v_mfma_f32_16x16x32_bf16 v[76:79], v[136:139], a[12:15], v[76:79]
    ds_read_b64_tr_b16 v[134:135], v25 offset:6656
    v_mfma_f32_16x16x32_bf16 v[92:95], v[140:143], a[12:15], v[92:95]
    ds_read_b64_tr_b16 v[136:137], v24 offset:14336
    buffer_load_dwordx4 a[4:7], v6, s[16:19], s51 offen offset:256 sc1
    v_mfma_f32_16x16x32_bf16 v[88:91], v[140:143], a[8:11], v[88:91]
    ds_read_b64_tr_b16 v[138:139], v24 offset:14848
    v_mfma_f32_16x16x32_bf16 v[104:107], a[8:11], v[144:147], v[104:107]
    ds_read_b64_tr_b16 v[140:141], v25 offset:14336
    v_mfma_f32_16x16x32_bf16 v[108:111], a[12:15], v[144:147], v[108:111]
    ds_read_b64_tr_b16 v[142:143], v25 offset:14848
    v_mfma_f32_16x16x32_bf16 v[124:127], a[12:15], v[148:151], v[124:127]
    ds_read_b64_tr_b16 v[144:145], v24 offset:22528
    v_mfma_f32_16x16x32_bf16 v[120:123], a[8:11], v[148:151], v[120:123]
    ds_read_b64_tr_b16 v[146:147], v24 offset:23040
    s_waitcnt vmcnt(12) lgkmcnt(8)
    v_mfma_f32_16x16x32_bf16 v[184:187], v[188:191], v[192:195], v[184:187]
    v_mfma_f32_16x16x32_bf16 v[32:35], v[128:131], a[16:19], v[32:35]
    ds_read_b64_tr_b16 v[148:149], v25 offset:22528
    buffer_load_dwordx4 a[8:11], v6, s[20:23], s59 offen offset:2048 sc1
    v_mfma_f32_16x16x32_bf16 v[36:39], v[128:131], a[20:23], v[36:39]
    ds_read_b64_tr_b16 v[150:151], v25 offset:23040
    s_waitcnt lgkmcnt(8)
    v_mfma_f32_16x16x32_bf16 v[52:55], v[132:135], a[20:23], v[52:55]
    v_mfma_f32_16x16x32_bf16 v[48:51], v[132:135], a[16:19], v[48:51]
    ds_read_b64_tr_b16 v[188:189], v28 offset:6144
    s_waitcnt lgkmcnt(7)
    v_mfma_f32_16x16x32_bf16 v[64:67], v[136:139], a[16:19], v[64:67]
    v_mfma_f32_16x16x32_bf16 v[68:71], v[136:139], a[20:23], v[68:71]
    ds_read_b64_tr_b16 v[190:191], v28 offset:6656
    s_waitcnt lgkmcnt(6)
    v_mfma_f32_16x16x32_bf16 v[84:87], v[140:143], a[20:23], v[84:87]
    buffer_load_dwordx4 a[12:15], v6, s[20:23], s59 offen offset:2304 sc1
    v_mfma_f32_16x16x32_bf16 v[80:83], v[140:143], a[16:19], v[80:83]
    ds_read_b128 v[192:195], v30 offset:3072
    s_waitcnt lgkmcnt(5)
    v_mfma_f32_16x16x32_bf16 v[96:99], a[16:19], v[144:147], v[96:99]
    s_add_u32 s52, s52, 24576
    v_mfma_f32_16x16x32_bf16 v[100:103], a[20:23], v[144:147], v[100:103]
    s_cmp_eq_u32 s52, 147456
    s_waitcnt lgkmcnt(3)
    v_mfma_f32_16x16x32_bf16 v[116:119], a[20:23], v[148:151], v[116:119]
    s_cselect_b32 s52, 0, s52
    v_mfma_f32_16x16x32_bf16 v[112:115], a[16:19], v[148:151], v[112:115]
    s_add_u32 s58, s58, 8192
    s_add_u32 s59, s59, 8192
    s_waitcnt vmcnt(12) lgkmcnt(0)
    v_mfma_f32_16x16x32_bf16 v[40:43], v[128:131], a[24:27], v[40:43]
    buffer_load_dwordx4 a[16:19], v6, s[16:19], s51 offen offset:2048 sc1
    s_barrier
    v_add_u32 v24, s52, v26
    v_mfma_f32_16x16x32_bf16 v[44:47], v[128:131], a[28:31], v[44:47]
    v_add_u32 v25, s52, v27
    v_add_u32 v28, s52, v29
    v_mfma_f32_16x16x32_bf16 v[60:63], v[132:135], a[28:31], v[60:63]
    ds_read_b64_tr_b16 v[128:129], v24 offset:0
    v_mfma_f32_16x16x32_bf16 v[56:59], v[132:135], a[24:27], v[56:59]
    ds_read_b64_tr_b16 v[130:131], v24 offset:512
    v_mfma_f32_16x16x32_bf16 v[72:75], v[136:139], a[24:27], v[72:75]
    ds_read_b64_tr_b16 v[132:133], v25 offset:0
    v_mfma_f32_16x16x32_bf16 v[76:79], v[136:139], a[28:31], v[76:79]
    ds_read_b64_tr_b16 v[134:135], v25 offset:512
    v_xor_b32 v30, 4096, v30
    v_mfma_f32_16x16x32_bf16 v[92:95], v[140:143], a[28:31], v[92:95]
    ds_read_b64_tr_b16 v[136:137], v24 offset:8192
    buffer_load_dwordx4 a[20:23], v6, s[16:19], s51 offen offset:2304 sc1
    v_mfma_f32_16x16x32_bf16 v[88:91], v[140:143], a[24:27], v[88:91]
    ds_read_b64_tr_b16 v[138:139], v24 offset:8704
    v_mfma_f32_16x16x32_bf16 v[104:107], a[24:27], v[144:147], v[104:107]
    ds_read_b64_tr_b16 v[140:141], v25 offset:8192
    s_add_u32 s50, s50, 8192
    v_mfma_f32_16x16x32_bf16 v[108:111], a[28:31], v[144:147], v[108:111]
    ds_read_b64_tr_b16 v[142:143], v25 offset:8704
    s_add_u32 s51, s51, 8192
    v_mfma_f32_16x16x32_bf16 v[124:127], a[28:31], v[148:151], v[124:127]
    ds_read_b64_tr_b16 v[144:145], v24 offset:16384
    s_sub_u32 s54, s54, 1
    v_mfma_f32_16x16x32_bf16 v[120:123], a[24:27], v[148:151], v[120:123]
    ds_read_b64_tr_b16 v[146:147], v24 offset:16896
    s_cmp_lg_u32 s54, 0
    s_cbranch_scc1 c_qkvA_loop
    s_waitcnt vmcnt(12) lgkmcnt(8)
    v_mfma_f32_16x16x32_bf16 v[184:187], v[188:191], v[192:195], v[184:187]
    v_mfma_f32_16x16x32_bf16 v[32:35], v[128:131], v[152:155], v[32:35]
    ds_read_b64_tr_b16 v[148:149], v25 offset:16384
    buffer_load_dwordx4 a[24:27], v6, s[20:23], s58 offen offset:0 sc1
    v_mfma_f32_16x16x32_bf16 v[36:39], v[128:131], v[156:159], v[36:39]
    ds_read_b64_tr_b16 v[150:151], v25 offset:16896
    s_waitcnt lgkmcnt(8)
    v_mfma_f32_16x16x32_bf16 v[52:55], v[132:135], v[156:159], v[52:55]
    ds_read_b32 v16, v8 offset:1280
    v_mfma_f32_16x16x32_bf16 v[48:51], v[132:135], v[152:155], v[48:51]
    ds_read_b64_tr_b16 v[188:189], v28 offset:0
    ds_read_b32 v18, v8 offset:1344
    s_waitcnt lgkmcnt(9)
    v_mfma_f32_16x16x32_bf16 v[64:67], v[136:139], v[152:155], v[64:67]
    ds_read_b32 v20, v8 offset:1408
    v_mfma_f32_16x16x32_bf16 v[68:71], v[136:139], v[156:159], v[68:71]
    ds_read_b64_tr_b16 v[190:191], v28 offset:512
    s_waitcnt lgkmcnt(9)
    v_mfma_f32_16x16x32_bf16 v[84:87], v[140:143], v[156:159], v[84:87]
    buffer_load_dwordx4 a[28:31], v6, s[20:23], s58 offen offset:256 sc1
    ds_read_b32 v22, v8 offset:1472
    v_mfma_f32_16x16x32_bf16 v[80:83], v[140:143], v[152:155], v[80:83]
    ds_read_b128 v[192:195], v30 offset:0
    ds_read_b128 v[212:215], v10 offset:128
    s_waitcnt lgkmcnt(10)
    v_mfma_f32_16x16x32_bf16 v[96:99], v[152:155], v[144:147], v[96:99]
    ds_read_b128 v[216:219], v10 offset:192
    v_mfma_f32_16x16x32_bf16 v[100:103], v[156:159], v[144:147], v[100:103]
    s_waitcnt lgkmcnt(9)
    v_mfma_f32_16x16x32_bf16 v[116:119], v[156:159], v[148:151], v[116:119]
    v_mfma_f32_16x16x32_bf16 v[112:115], v[152:155], v[148:151], v[112:115]
    s_waitcnt vmcnt(12)
    v_mfma_f32_16x16x32_bf16 v[40:43], v[128:131], v[160:163], v[40:43]
    s_waitcnt lgkmcnt(0)
    v_fma_f32 v64, -v16, v212, v64
    v_fma_f32 v65, -v16, v213, v65
    v_mfma_f32_16x16x32_bf16 v[44:47], v[128:131], v[164:167], v[44:47]
    v_fma_f32 v66, -v16, v214, v66
    v_mfma_f32_16x16x32_bf16 v[60:63], v[132:135], v[164:167], v[60:63]
    ds_read_b64_tr_b16 v[128:129], v24 offset:2048
    v_fma_f32 v67, -v16, v215, v67
    v_mfma_f32_16x16x32_bf16 v[56:59], v[132:135], v[160:163], v[56:59]
    ds_read_b64_tr_b16 v[130:131], v24 offset:2560
    v_fma_f32 v68, -v18, v212, v68
    v_fma_f32 v69, -v18, v213, v69
    v_mfma_f32_16x16x32_bf16 v[72:75], v[136:139], v[160:163], v[72:75]
    ds_read_b64_tr_b16 v[132:133], v25 offset:2048
    v_fma_f32 v70, -v18, v214, v70
    v_mfma_f32_16x16x32_bf16 v[76:79], v[136:139], v[164:167], v[76:79]
    ds_read_b64_tr_b16 v[134:135], v25 offset:2560
    v_fma_f32 v71, -v18, v215, v71
    v_mfma_f32_16x16x32_bf16 v[92:95], v[140:143], v[164:167], v[92:95]
    ds_read_b64_tr_b16 v[136:137], v24 offset:10240
    v_fma_f32 v80, -v16, v216, v80
    v_fma_f32 v81, -v16, v217, v81
    v_mfma_f32_16x16x32_bf16 v[88:91], v[140:143], v[160:163], v[88:91]
    ds_read_b64_tr_b16 v[138:139], v24 offset:10752
    v_fma_f32 v82, -v16, v218, v82
    v_mfma_f32_16x16x32_bf16 v[104:107], v[160:163], v[144:147], v[104:107]
    ds_read_b64_tr_b16 v[140:141], v25 offset:10240
    v_fma_f32 v83, -v16, v219, v83
    v_mfma_f32_16x16x32_bf16 v[108:111], v[164:167], v[144:147], v[108:111]
    ds_read_b64_tr_b16 v[142:143], v25 offset:10752
    v_fma_f32 v84, -v18, v216, v84
    v_fma_f32 v85, -v18, v217, v85
    v_mfma_f32_16x16x32_bf16 v[124:127], v[164:167], v[148:151], v[124:127]
    ds_read_b64_tr_b16 v[144:145], v24 offset:18432
    v_fma_f32 v86, -v18, v218, v86
    v_mfma_f32_16x16x32_bf16 v[120:123], v[160:163], v[148:151], v[120:123]
    ds_read_b64_tr_b16 v[146:147], v24 offset:18944
    v_fma_f32 v87, -v18, v219, v87
    s_waitcnt vmcnt(10) lgkmcnt(8)
    v_mfma_f32_16x16x32_bf16 v[184:187], v[188:191], v[192:195], v[184:187]
    v_mfma_f32_16x16x32_bf16 v[32:35], v[128:131], v[168:171], v[32:35]
    ds_read_b64_tr_b16 v[148:149], v25 offset:18432
    v_fma_f32 v72, -v20, v212, v72
    v_fma_f32 v73, -v20, v213, v73
    v_mfma_f32_16x16x32_bf16 v[36:39], v[128:131], v[172:175], v[36:39]
    ds_read_b64_tr_b16 v[150:151], v25 offset:18944
    v_fma_f32 v74, -v20, v214, v74
    s_waitcnt lgkmcnt(8)
    v_mfma_f32_16x16x32_bf16 v[52:55], v[132:135], v[172:175], v[52:55]
    v_fma_f32 v75, -v20, v215, v75
    ds_read_b128 v[152:155], v10 offset:0
    v_mfma_f32_16x16x32_bf16 v[48:51], v[132:135], v[168:171], v[48:51]
    ds_read_b64_tr_b16 v[188:189], v28 offset:2048
    v_fma_f32 v76, -v22, v212, v76
    v_fma_f32 v77, -v22, v213, v77
    ds_read_b128 v[156:159], v10 offset:64
    s_waitcnt lgkmcnt(9)
    v_mfma_f32_16x16x32_bf16 v[64:67], v[136:139], v[168:171], v[64:67]
    v_fma_f32 v78, -v22, v214, v78
    ds_read_b32 v17, v8 offset:2816
    v_mfma_f32_16x16x32_bf16 v[68:71], v[136:139], v[172:175], v[68:71]
    ds_read_b64_tr_b16 v[190:191], v28 offset:2560
    v_fma_f32 v79, -v22, v215, v79
    s_waitcnt lgkmcnt(9)
    v_mfma_f32_16x16x32_bf16 v[84:87], v[140:143], v[172:175], v[84:87]
    v_fma_f32 v88, -v20, v216, v88
    v_fma_f32 v89, -v20, v217, v89
    ds_read_b32 v19, v8 offset:2880
    v_mfma_f32_16x16x32_bf16 v[80:83], v[140:143], v[168:171], v[80:83]
    ds_read_b128 v[192:195], v30 offset:1024
    v_fma_f32 v90, -v20, v218, v90
    ds_read_b32 v21, v8 offset:2944
    s_waitcnt lgkmcnt(10)
    v_mfma_f32_16x16x32_bf16 v[96:99], v[168:171], v[144:147], v[96:99]
    v_fma_f32 v91, -v20, v219, v91
    ds_read_b32 v23, v8 offset:3008
    v_mfma_f32_16x16x32_bf16 v[100:103], v[172:175], v[144:147], v[100:103]
    v_fma_f32 v92, -v22, v216, v92
    v_fma_f32 v93, -v22, v217, v93
    s_waitcnt lgkmcnt(9)
    v_mfma_f32_16x16x32_bf16 v[116:119], v[172:175], v[148:151], v[116:119]
    v_fma_f32 v94, -v22, v218, v94
    v_mfma_f32_16x16x32_bf16 v[112:115], v[168:171], v[148:151], v[112:115]
    v_fma_f32 v95, -v22, v219, v95
    s_waitcnt vmcnt(8)
    v_mfma_f32_16x16x32_bf16 v[40:43], v[128:131], v[176:179], v[40:43]
    s_waitcnt lgkmcnt(0)
    v_fma_f32 v32, -v16, v152, v32
    v_fma_f32 v33, -v16, v153, v33
    v_mfma_f32_16x16x32_bf16 v[44:47], v[128:131], v[180:183], v[44:47]
    v_fma_f32 v34, -v16, v154, v34
    v_mfma_f32_16x16x32_bf16 v[60:63], v[132:135], v[180:183], v[60:63]
    ds_read_b64_tr_b16 v[128:129], v24 offset:4096
    v_fma_f32 v35, -v16, v155, v35
    v_fma_f32 v36, -v18, v152, v36
    v_mfma_f32_16x16x32_bf16 v[56:59], v[132:135], v[176:179], v[56:59]
    ds_read_b64_tr_b16 v[130:131], v24 offset:4608
    v_fma_f32 v37, -v18, v153, v37
    v_mfma_f32_16x16x32_bf16 v[72:75], v[136:139], v[176:179], v[72:75]
    ds_read_b64_tr_b16 v[132:133], v25 offset:4096
    v_fma_f32 v38, -v18, v154, v38
    v_fma_f32 v39, -v18, v155, v39
    v_mfma_f32_16x16x32_bf16 v[76:79], v[136:139], v[180:183], v[76:79]
    ds_read_b64_tr_b16 v[134:135], v25 offset:4608
    v_fma_f32 v48, -v16, v156, v48
    v_mfma_f32_16x16x32_bf16 v[92:95], v[140:143], v[180:183], v[92:95]
    ds_read_b64_tr_b16 v[136:137], v24 offset:12288
    v_fma_f32 v49, -v16, v157, v49
    v_fma_f32 v50, -v16, v158, v50
    v_mfma_f32_16x16x32_bf16 v[88:91], v[140:143], v[176:179], v[88:91]
    ds_read_b64_tr_b16 v[138:139], v24 offset:12800
    v_fma_f32 v51, -v16, v159, v51
    v_mfma_f32_16x16x32_bf16 v[104:107], v[176:179], v[144:147], v[104:107]
    ds_read_b64_tr_b16 v[140:141], v25 offset:12288
    v_fma_f32 v52, -v18, v156, v52
    v_fma_f32 v53, -v18, v157, v53
    v_mfma_f32_16x16x32_bf16 v[108:111], v[180:183], v[144:147], v[108:111]
    ds_read_b64_tr_b16 v[142:143], v25 offset:12800
    v_fma_f32 v54, -v18, v158, v54
    v_mfma_f32_16x16x32_bf16 v[124:127], v[180:183], v[148:151], v[124:127]
    ds_read_b64_tr_b16 v[144:145], v24 offset:20480
    v_fma_f32 v55, -v18, v159, v55
    v_mfma_f32_16x16x32_bf16 v[120:123], v[176:179], v[148:151], v[120:123]
    ds_read_b64_tr_b16 v[146:147], v24 offset:20992
    s_waitcnt vmcnt(6) lgkmcnt(8)
    v_mfma_f32_16x16x32_bf16 v[184:187], v[188:191], v[192:195], v[184:187]
    v_mfma_f32_16x16x32_bf16 v[32:35], v[128:131], a[0:3], v[32:35]
    ds_read_b64_tr_b16 v[148:149], v25 offset:20480
    v_fma_f32 v40, -v20, v152, v40
    v_fma_f32 v41, -v20, v153, v41
    v_mfma_f32_16x16x32_bf16 v[36:39], v[128:131], a[4:7], v[36:39]
    ds_read_b64_tr_b16 v[150:151], v25 offset:20992
    v_fma_f32 v42, -v20, v154, v42
    s_waitcnt lgkmcnt(8)
    v_mfma_f32_16x16x32_bf16 v[52:55], v[132:135], a[4:7], v[52:55]
    v_fma_f32 v43, -v20, v155, v43
    v_fma_f32 v44, -v22, v152, v44
    ds_read_b128 v[168:171], v9 offset:1280
    v_mfma_f32_16x16x32_bf16 v[48:51], v[132:135], a[0:3], v[48:51]
    ds_read_b64_tr_b16 v[188:189], v28 offset:4096
    v_fma_f32 v45, -v22, v153, v45
    ds_read_b128 v[172:175], v9 offset:1344
    s_waitcnt lgkmcnt(9)
    v_mfma_f32_16x16x32_bf16 v[64:67], v[136:139], a[0:3], v[64:67]
    v_fma_f32 v46, -v22, v154, v46
    v_fma_f32 v47, -v22, v155, v47
    v_mfma_f32_16x16x32_bf16 v[68:71], v[136:139], a[4:7], v[68:71]
    ds_read_b64_tr_b16 v[190:191], v28 offset:4608
    v_fma_f32 v56, -v20, v156, v56
    ds_read_b128 v[176:179], v9 offset:1408
    s_waitcnt lgkmcnt(9)
    v_mfma_f32_16x16x32_bf16 v[84:87], v[140:143], a[4:7], v[84:87]
    v_fma_f32 v57, -v20, v157, v57
    v_fma_f32 v58, -v20, v158, v58
    ds_read_b128 v[180:183], v9 offset:1472
    v_mfma_f32_16x16x32_bf16 v[80:83], v[140:143], a[0:3], v[80:83]
    ds_read_b128 v[192:195], v30 offset:2048
    v_fma_f32 v59, -v20, v159, v59
    s_waitcnt lgkmcnt(9)
    v_mfma_f32_16x16x32_bf16 v[96:99], a[0:3], v[144:147], v[96:99]
    v_fma_f32 v60, -v22, v156, v60
    v_fma_f32 v61, -v22, v157, v61
    ds_read2_b32 v[220:221], v11 offset0:64 offset1:80
    v_mfma_f32_16x16x32_bf16 v[100:103], a[4:7], v[144:147], v[100:103]
    v_fma_f32 v62, -v22, v158, v62
    s_waitcnt lgkmcnt(8)
    v_mfma_f32_16x16x32_bf16 v[116:119], a[4:7], v[148:151], v[116:119]
    v_fma_f32 v63, -v22, v159, v63
    v_mfma_f32_16x16x32_bf16 v[112:115], a[0:3], v[148:151], v[112:115]
    s_waitcnt vmcnt(4)
    v_mfma_f32_16x16x32_bf16 v[40:43], v[128:131], a[8:11], v[40:43]
    v_mfma_f32_16x16x32_bf16 v[44:47], v[128:131], a[12:15], v[44:47]
    s_waitcnt lgkmcnt(0)
    v_fma_f32 v96, -v168, v220, v96
    v_fma_f32 v97, -v169, v220, v97
    v_mfma_f32_16x16x32_bf16 v[60:63], v[132:135], a[12:15], v[60:63]
    ds_read_b64_tr_b16 v[128:129], v24 offset:6144
    v_fma_f32 v98, -v170, v220, v98
    v_mfma_f32_16x16x32_bf16 v[56:59], v[132:135], a[8:11], v[56:59]
    ds_read_b64_tr_b16 v[130:131], v24 offset:6656
    v_fma_f32 v99, -v171, v220, v99
    v_fma_f32 v100, -v172, v220, v100
    v_mfma_f32_16x16x32_bf16 v[72:75], v[136:139], a[8:11], v[72:75]
    ds_read_b64_tr_b16 v[132:133], v25 offset:6144
    v_fma_f32 v101, -v173, v220, v101
    v_mfma_f32_16x16x32_bf16 v[76:79], v[136:139], a[12:15], v[76:79]
    ds_read_b64_tr_b16 v[134:135], v25 offset:6656
    v_fma_f32 v102, -v174, v220, v102
    v_fma_f32 v103, -v175, v220, v103
    v_mfma_f32_16x16x32_bf16 v[92:95], v[140:143], a[12:15], v[92:95]
    ds_read_b64_tr_b16 v[136:137], v24 offset:14336
    v_fma_f32 v112, -v168, v221, v112
    v_mfma_f32_16x16x32_bf16 v[88:91], v[140:143], a[8:11], v[88:91]
    ds_read_b64_tr_b16 v[138:139], v24 offset:14848
    v_fma_f32 v113, -v169, v221, v113
    v_fma_f32 v114, -v170, v221, v114
    v_mfma_f32_16x16x32_bf16 v[104:107], a[8:11], v[144:147], v[104:107]
    ds_read_b64_tr_b16 v[140:141], v25 offset:14336
    v_fma_f32 v115, -v171, v221, v115
    v_mfma_f32_16x16x32_bf16 v[108:111], a[12:15], v[144:147], v[108:111]
    ds_read_b64_tr_b16 v[142:143], v25 offset:14848
    v_fma_f32 v116, -v172, v221, v116
    v_fma_f32 v117, -v173, v221, v117
    v_mfma_f32_16x16x32_bf16 v[124:127], a[12:15], v[148:151], v[124:127]
    ds_read_b64_tr_b16 v[144:145], v24 offset:22528
    v_fma_f32 v118, -v174, v221, v118
    v_mfma_f32_16x16x32_bf16 v[120:123], a[8:11], v[148:151], v[120:123]
    ds_read_b64_tr_b16 v[146:147], v24 offset:23040
    v_fma_f32 v119, -v175, v221, v119
    s_waitcnt vmcnt(2) lgkmcnt(8)
    v_mfma_f32_16x16x32_bf16 v[184:187], v[188:191], v[192:195], v[184:187]
    v_mfma_f32_16x16x32_bf16 v[32:35], v[128:131], a[16:19], v[32:35]
    ds_read_b64_tr_b16 v[148:149], v25 offset:22528
    v_mfma_f32_16x16x32_bf16 v[36:39], v[128:131], a[20:23], v[36:39]
    ds_read_b64_tr_b16 v[150:151], v25 offset:23040
    v_fma_f32 v104, -v176, v220, v104
    v_fma_f32 v105, -v177, v220, v105
    s_waitcnt lgkmcnt(8)
    v_mfma_f32_16x16x32_bf16 v[52:55], v[132:135], a[20:23], v[52:55]
    v_fma_f32 v106, -v178, v220, v106
    ds_read_b128 v[152:155], v9 offset:2816
    v_mfma_f32_16x16x32_bf16 v[48:51], v[132:135], a[16:19], v[48:51]
    ds_read_b64_tr_b16 v[188:189], v28 offset:6144
    v_fma_f32 v107, -v179, v220, v107
    v_fma_f32 v108, -v180, v220, v108
    ds_read_b128 v[156:159], v9 offset:2880
    s_waitcnt lgkmcnt(9)
    v_mfma_f32_16x16x32_bf16 v[64:67], v[136:139], a[16:19], v[64:67]
    v_fma_f32 v109, -v181, v220, v109
    ds_read_b128 v[160:163], v9 offset:2944
    v_mfma_f32_16x16x32_bf16 v[68:71], v[136:139], a[20:23], v[68:71]
    ds_read_b64_tr_b16 v[190:191], v28 offset:6656
    v_fma_f32 v110, -v182, v220, v110
    v_fma_f32 v111, -v183, v220, v111
    ds_read_b128 v[164:167], v9 offset:3008
    s_waitcnt lgkmcnt(10)
    v_mfma_f32_16x16x32_bf16 v[84:87], v[140:143], a[20:23], v[84:87]
    v_fma_f32 v120, -v176, v221, v120
    ds_read_b128 v[212:215], v14 offset:128
    v_mfma_f32_16x16x32_bf16 v[80:83], v[140:143], a[16:19], v[80:83]
    ds_read_b128 v[192:195], v30 offset:3072
    v_fma_f32 v121, -v177, v221, v121
    v_fma_f32 v122, -v178, v221, v122
    ds_read_b32 v222, v11 offset:1216
    s_waitcnt lgkmcnt(11)
    v_mfma_f32_16x16x32_bf16 v[96:99], a[16:19], v[144:147], v[96:99]
    v_fma_f32 v123, -v179, v221, v123
    ds_read_b32 v223, v11 offset:2752
    v_mfma_f32_16x16x32_bf16 v[100:103], a[20:23], v[144:147], v[100:103]
    v_fma_f32 v124, -v180, v221, v124
    v_fma_f32 v125, -v181, v221, v125
    s_waitcnt lgkmcnt(10)
    v_mfma_f32_16x16x32_bf16 v[116:119], a[20:23], v[148:151], v[116:119]
    v_fma_f32 v126, -v182, v221, v126
    v_mfma_f32_16x16x32_bf16 v[112:115], a[16:19], v[148:151], v[112:115]
    v_fma_f32 v127, -v183, v221, v127
    s_waitcnt vmcnt(0) lgkmcnt(2)
    v_mfma_f32_16x16x32_bf16 v[40:43], v[128:131], a[24:27], v[40:43]
    v_mul_f32 v64, v17, v64
    v_mul_f32 v65, v17, v65
    s_barrier
    v_mfma_f32_16x16x32_bf16 v[44:47], v[128:131], a[28:31], v[44:47]
    v_mul_f32 v66, v17, v66
    v_mul_f32 v67, v17, v67
    v_mfma_f32_16x16x32_bf16 v[60:63], v[132:135], a[28:31], v[60:63]
    v_mul_f32 v80, v17, v80
    v_mul_f32 v81, v17, v81
    v_mfma_f32_16x16x32_bf16 v[56:59], v[132:135], a[24:27], v[56:59]
    v_mul_f32 v82, v17, v82
    v_mul_f32 v83, v17, v83
    v_mfma_f32_16x16x32_bf16 v[72:75], v[136:139], a[24:27], v[72:75]
    v_cvt_pk_bf16_f32 v64, v64, v65
    v_cvt_pk_bf16_f32 v65, v66, v67
    v_mfma_f32_16x16x32_bf16 v[76:79], v[136:139], a[28:31], v[76:79]
    v_cvt_pk_bf16_f32 v66, v80, v81
    v_cvt_pk_bf16_f32 v67, v82, v83
    v_mfma_f32_16x16x32_bf16 v[92:95], v[140:143], a[28:31], v[92:95]
    v_mul_f32 v68, v19, v68
    v_mul_f32 v69, v19, v69
    v_mfma_f32_16x16x32_bf16 v[88:91], v[140:143], a[24:27], v[88:91]
    v_mul_f32 v70, v19, v70
    v_mul_f32 v71, v19, v71
    v_mfma_f32_16x16x32_bf16 v[104:107], a[24:27], v[144:147], v[104:107]
    v_mul_f32 v84, v19, v84
    v_mul_f32 v85, v19, v85
    v_mfma_f32_16x16x32_bf16 v[108:111], a[28:31], v[144:147], v[108:111]
    v_mul_f32 v86, v19, v86
    v_mul_f32 v87, v19, v87
    v_mfma_f32_16x16x32_bf16 v[124:127], a[28:31], v[148:151], v[124:127]
    v_cvt_pk_bf16_f32 v68, v68, v69
    v_cvt_pk_bf16_f32 v69, v70, v71
    v_mfma_f32_16x16x32_bf16 v[120:123], a[24:27], v[148:151], v[120:123]
    v_cvt_pk_bf16_f32 v70, v84, v85
    v_cvt_pk_bf16_f32 v71, v86, v87
    v_mfma_f32_16x16x32_bf16 v[184:187], v[188:191], v[192:195], v[184:187]
    v_pk_mul_f32 v[72:73], v[20:21], v[72:73] op_sel:[1,0] op_sel_hi:[1,1]
    v_pk_mul_f32 v[74:75], v[20:21], v[74:75] op_sel:[1,0] op_sel_hi:[1,1]
    v_pk_mul_f32 v[88:89], v[20:21], v[88:89] op_sel:[1,0] op_sel_hi:[1,1]
    v_pk_mul_f32 v[90:91], v[20:21], v[90:91] op_sel:[1,0] op_sel_hi:[1,1]
    v_cvt_pk_bf16_f32 v72, v72, v73
    v_cvt_pk_bf16_f32 v73, v74, v75
    v_cvt_pk_bf16_f32 v74, v88, v89
    v_cvt_pk_bf16_f32 v75, v90, v91
    v_pk_mul_f32 v[76:77], v[22:23], v[76:77] op_sel:[1,0] op_sel_hi:[1,1]
    v_pk_mul_f32 v[78:79], v[22:23], v[78:79] op_sel:[1,0] op_sel_hi:[1,1]
    v_pk_mul_f32 v[92:93], v[22:23], v[92:93] op_sel:[1,0] op_sel_hi:[1,1]
    v_pk_mul_f32 v[94:95], v[22:23], v[94:95] op_sel:[1,0] op_sel_hi:[1,1]
    v_cvt_pk_bf16_f32 v76, v76, v77
    v_cvt_pk_bf16_f32 v77, v78, v79
    v_cvt_pk_bf16_f32 v78, v92, v93
    v_cvt_pk_bf16_f32 v79, v94, v95
    ds_write_b128 v12, v[76:79] offset:2048
    s_waitcnt lgkmcnt(1)
    v_pk_mul_f32 v[96:97], v[152:153], v[96:97]
    v_pk_mul_f32 v[98:99], v[154:155], v[98:99]
    v_pk_mul_f32 v[112:113], v[152:153], v[112:113]
    v_pk_mul_f32 v[114:115], v[154:155], v[114:115]
    v_cvt_pk_bf16_f32 v99, v98, v99
    v_cvt_pk_bf16_f32 v98, v96, v97
    v_cvt_pk_bf16_f32 v115, v114, v115
    v_cvt_pk_bf16_f32 v114, v112, v113
    v_pk_mul_f32 v[100:101], v[156:157], v[100:101]
    v_pk_mul_f32 v[102:103], v[158:159], v[102:103]
    v_pk_mul_f32 v[116:117], v[156:157], v[116:117]
    v_pk_mul_f32 v[118:119], v[158:159], v[118:119]
    v_cvt_pk_bf16_f32 v100, v100, v101
    v_cvt_pk_bf16_f32 v101, v102, v103
    v_cvt_pk_bf16_f32 v116, v116, v117
    v_cvt_pk_bf16_f32 v117, v118, v119
    v_pk_mul_f32 v[104:105], v[160:161], v[104:105]
    v_pk_mul_f32 v[106:107], v[162:163], v[106:107]
    v_pk_mul_f32 v[120:121], v[160:161], v[120:121]
    v_pk_mul_f32 v[122:123], v[162:163], v[122:123]
    v_cvt_pk_bf16_f32 v102, v104, v105
    v_cvt_pk_bf16_f32 v103, v106, v107
    v_cvt_pk_bf16_f32 v118, v120, v121
    v_cvt_pk_bf16_f32 v119, v122, v123
    v_pk_mul_f32 v[108:109], v[164:165], v[108:109]
    v_pk_mul_f32 v[110:111], v[166:167], v[110:111]
    v_pk_mul_f32 v[124:125], v[164:165], v[124:125]
    v_pk_mul_f32 v[126:127], v[166:167], v[126:127]
    v_cvt_pk_bf16_f32 v104, v108, v109
    v_cvt_pk_bf16_f32 v105, v110, v111
    v_cvt_pk_bf16_f32 v120, v124, v125
    v_cvt_pk_bf16_f32 v121, v126, v127
    ds_write_b64 v12, v[104:105] offset:3072
    ds_write_b64 v12, v[120:121] offset:3080
    v_pk_fma_f32 v[184:185], v[222:223], v[212:213], v[184:185] op_sel_hi:[0,1,1] neg_lo:[1,0,0] neg_hi:[1,0,0]
    v_pk_fma_f32 v[186:187], v[222:223], v[214:215], v[186:187] op_sel_hi:[0,1,1] neg_lo:[1,0,0] neg_hi:[1,0,0]
    v_pk_mul_f32 v[184:185], v[222:223], v[184:185] op_sel:[1,0] op_sel_hi:[1,1]
    v_pk_mul_f32 v[186:187], v[222:223], v[186:187] op_sel:[1,0] op_sel_hi:[1,1]
    v_cvt_pk_bf16_f32 v184, v184, v185
    v_cvt_pk_bf16_f32 v185, v186, v187
    s_cmp_ge_u32 s8, 2
    s_cbranch_scc1 c_qkvA_hv
    ds_write_b64 v13, v[184:185]
    s_branch c_qkvA_hd
c_qkvA_hv:
    ds_write_b16 v13, v184 offset:0
    ds_write_b16_d16_hi v13, v184 offset:16
    ds_write_b16 v13, v185 offset:32
    ds_write_b16_d16_hi v13, v185 offset:48
c_qkvA_hd:
    v_cvt_pk_bf16_f32 v44, v44, v45
    v_cvt_pk_bf16_f32 v45, v46, v47
    v_cvt_pk_bf16_f32 v46, v60, v61
    v_cvt_pk_bf16_f32 v47, v62, v63
    v_mul_f32 v23, 0x3e8293ee, v23
    v_cvt_pk_bf16_f32 v40, v40, v41
    v_cvt_pk_bf16_f32 v41, v42, v43
    v_cvt_pk_bf16_f32 v42, v56, v57
    v_cvt_pk_bf16_f32 v43, v58, v59
    v_mul_f32 v21, 0x3e8293ee, v21
    s_waitcnt lgkmcnt(0)
    s_barrier
    ds_read_b128 v[172:175], v12
    ds_read_b64 v[96:97], v12 offset:1024
    ds_read_b64 v[112:113], v12 offset:1032
    v_mfma_f32_16x16x32_bf16 v[156:159], v[76:79], v[44:47], v[196:199]
    v_mfma_f32_16x16x32_bf16 v[152:155], v[72:75], v[44:47], v[200:203]
    v_cvt_pk_bf16_f32 v36, v36, v37
    v_cvt_pk_bf16_f32 v37, v38, v39
    v_cvt_pk_bf16_f32 v38, v52, v53
    v_cvt_pk_bf16_f32 v39, v54, v55
    v_mul_f32 v19, 0x3e8293ee, v19
    v_mfma_f32_16x16x32_bf16 v[148:151], v[72:75], v[40:43], v[196:199]
    v_mfma_f32_16x16x32_bf16 v[144:147], v[68:71], v[40:43], v[200:203]
    v_cvt_pk_bf16_f32 v32, v32, v33
    v_cvt_pk_bf16_f32 v33, v34, v35
    v_cvt_pk_bf16_f32 v34, v48, v49
    v_cvt_pk_bf16_f32 v35, v50, v51
    v_mul_f32 v17, 0x3e8293ee, v17
    v_mfma_f32_16x16x32_bf16 v[140:143], v[68:71], v[36:39], v[196:199]
    v_mfma_f32_16x16x32_bf16 v[136:139], v[64:67], v[36:39], v[200:203]
    s_waitcnt lgkmcnt(2)
    v_mfma_f32_16x16x32_bf16 v[132:135], v[64:67], v[32:35], v[196:199]
    v_mfma_f32_16x16x32_bf16 v[128:131], v[172:175], v[32:35], v[204:207]
    v_max3_f32 v179, v152, v153, v154
    v_max3_f32 v183, v155, v156, v157
    v_max3_f32 v179, v179, v158, v159
    v_max_f32 v179, v179, v183
    v_max3_f32 v178, v144, v145, v146
    v_max3_f32 v182, v147, v148, v149
    v_max3_f32 v178, v178, v150, v151
    v_max_f32 v178, v178, v182
    v_max3_f32 v177, v136, v137, v138
    v_max3_f32 v181, v139, v140, v141
    v_max3_f32 v177, v177, v142, v143
    v_max_f32 v177, v177, v181
    v_max3_f32 v176, v128, v129, v130
    v_max3_f32 v180, v131, v132, v133
    v_max3_f32 v176, v176, v134, v135
    v_max_f32 v176, v176, v180
    v_mov_b32 v183, v179
    v_mov_b32 v182, v178
    v_mov_b32 v181, v177
    v_mov_b32 v180, v176
    v_permlane32_swap_b32 v179, v183
    v_permlane32_swap_b32 v178, v182
    v_permlane32_swap_b32 v177, v181
    v_permlane32_swap_b32 v176, v180
    v_max_f32 v179, v179, v183
    v_max_f32 v178, v178, v182
    v_max_f32 v177, v177, v181
    v_max_f32 v176, v176, v180
    v_mov_b32 v183, v179
    v_mov_b32 v182, v178
    v_mov_b32 v181, v177
    v_mov_b32 v180, v176
    v_permlane16_swap_b32 v179, v183
    v_permlane16_swap_b32 v178, v182
    v_permlane16_swap_b32 v177, v181
    v_permlane16_swap_b32 v176, v180
    v_max_f32 v179, v179, v183
    v_max_f32 v178, v178, v182
    v_max_f32 v177, v177, v181
    v_max_f32 v176, v176, v180
    v_mul_f32_e64 v22, -v179, v23
    v_mul_f32_e64 v20, -v178, v21
    v_mul_f32_e64 v18, -v177, v19
    v_mul_f32_e64 v16, -v176, v17
    s_waitcnt lgkmcnt(0)
    s_add_u32 s51, s49, 65536
    v_pk_fma_f32 v[152:153], v[152:153], v[22:23], v[22:23] op_sel:[0,1,0] op_sel_hi:[1,1,0]
    v_pk_fma_f32 v[154:155], v[154:155], v[22:23], v[22:23] op_sel:[0,1,0] op_sel_hi:[1,1,0]
    v_pk_fma_f32 v[156:157], v[156:157], v[22:23], v[22:23] op_sel:[0,1,0] op_sel_hi:[1,1,0]
    v_pk_fma_f32 v[158:159], v[158:159], v[22:23], v[22:23] op_sel:[0,1,0] op_sel_hi:[1,1,0]
    v_exp_f32 v152, v152
    v_exp_f32 v153, v153
    v_exp_f32 v154, v154
    v_exp_f32 v155, v155
    v_exp_f32 v156, v156
    v_exp_f32 v157, v157
    v_exp_f32 v158, v158
    v_exp_f32 v159, v159
    v_cvt_pk_bf16_f32 v172, v152, v153
    v_cvt_pk_bf16_f32 v173, v154, v155
    v_cvt_pk_bf16_f32 v174, v156, v157
    v_cvt_pk_bf16_f32 v175, v158, v159
    s_nop 1
    v_mfma_f32_16x16x32_bf16 v[92:95], v[208:211], v[172:175], 0
    v_mfma_f32_16x16x32_bf16 v[60:63], v[102:105], v[172:175], 0
    v_mfma_f32_16x16x32_bf16 v[76:79], v[118:121], v[172:175], 0
    v_pk_fma_f32 v[144:145], v[144:145], v[20:21], v[20:21] op_sel:[0,1,0] op_sel_hi:[1,1,0]
    v_pk_fma_f32 v[146:147], v[146:147], v[20:21], v[20:21] op_sel:[0,1,0] op_sel_hi:[1,1,0]
    v_pk_fma_f32 v[148:149], v[148:149], v[20:21], v[20:21] op_sel:[0,1,0] op_sel_hi:[1,1,0]
    v_pk_fma_f32 v[150:151], v[150:151], v[20:21], v[20:21] op_sel:[0,1,0] op_sel_hi:[1,1,0]
    v_exp_f32 v144, v144
    v_exp_f32 v145, v145
    v_exp_f32 v146, v146
    v_exp_f32 v147, v147
    v_exp_f32 v148, v148
    v_exp_f32 v149, v149
    v_exp_f32 v150, v150
    v_exp_f32 v151, v151
    v_cvt_pk_bf16_f32 v168, v144, v145
    v_cvt_pk_bf16_f32 v169, v146, v147
    v_cvt_pk_bf16_f32 v170, v148, v149
    v_cvt_pk_bf16_f32 v171, v150, v151
    v_rcp_f32 v92, v92
    s_nop 0
    v_pk_mul_f32 v[60:61], v[92:93], v[60:61] op_sel_hi:[0,1]
    v_pk_mul_f32 v[62:63], v[92:93], v[62:63] op_sel_hi:[0,1]
    v_pk_mul_f32 v[76:77], v[92:93], v[76:77] op_sel_hi:[0,1]
    v_pk_mul_f32 v[78:79], v[92:93], v[78:79] op_sel_hi:[0,1]
    v_cvt_pk_bf16_f32 v60, v60, v61
    v_cvt_pk_bf16_f32 v61, v62, v63
    v_cvt_pk_bf16_f32 v62, v76, v77
    v_cvt_pk_bf16_f32 v63, v78, v79
    s_nop 0
    v_permlane32_swap_b32 v60, v62
    v_permlane32_swap_b32 v61, v63
    buffer_store_dwordx4 v[60:63], v6, s[12:15], s51 offen offset:256 sc1
    v_mfma_f32_16x16x32_bf16 v[88:91], v[208:211], v[168:171], 0
    v_mfma_f32_16x16x32_bf16 v[56:59], v[100:103], v[168:171], 0
    v_mfma_f32_16x16x32_bf16 v[72:75], v[116:119], v[168:171], 0
    v_pk_fma_f32 v[136:137], v[136:137], v[18:19], v[18:19] op_sel:[0,1,0] op_sel_hi:[1,1,0]
    v_pk_fma_f32 v[138:139], v[138:139], v[18:19], v[18:19] op_sel:[0,1,0] op_sel_hi:[1,1,0]
    v_pk_fma_f32 v[140:141], v[140:141], v[18:19], v[18:19] op_sel:[0,1,0] op_sel_hi:[1,1,0]
    v_pk_fma_f32 v[142:143], v[142:143], v[18:19], v[18:19] op_sel:[0,1,0] op_sel_hi:[1,1,0]
    v_exp_f32 v136, v136
    v_exp_f32 v137, v137
    v_exp_f32 v138, v138
    v_exp_f32 v139, v139
    v_exp_f32 v140, v140
    v_exp_f32 v141, v141
    v_exp_f32 v142, v142
    v_exp_f32 v143, v143
    v_cvt_pk_bf16_f32 v164, v136, v137
    v_cvt_pk_bf16_f32 v165, v138, v139
    v_cvt_pk_bf16_f32 v166, v140, v141
    v_cvt_pk_bf16_f32 v167, v142, v143
    v_rcp_f32 v88, v88
    s_nop 0
    v_pk_mul_f32 v[56:57], v[88:89], v[56:57] op_sel_hi:[0,1]
    v_pk_mul_f32 v[58:59], v[88:89], v[58:59] op_sel_hi:[0,1]
    v_pk_mul_f32 v[72:73], v[88:89], v[72:73] op_sel_hi:[0,1]
    v_pk_mul_f32 v[74:75], v[88:89], v[74:75] op_sel_hi:[0,1]
    v_cvt_pk_bf16_f32 v56, v56, v57
    v_cvt_pk_bf16_f32 v57, v58, v59
    v_cvt_pk_bf16_f32 v58, v72, v73
    v_cvt_pk_bf16_f32 v59, v74, v75
    s_nop 0
    v_permlane32_swap_b32 v56, v58
    v_permlane32_swap_b32 v57, v59
    buffer_store_dwordx4 v[56:59], v6, s[12:15], s51 offen offset:0 sc1
    v_mfma_f32_16x16x32_bf16 v[84:87], v[208:211], v[164:167], 0
    v_mfma_f32_16x16x32_bf16 v[52:55], v[98:101], v[164:167], 0
    v_mfma_f32_16x16x32_bf16 v[68:71], v[114:117], v[164:167], 0
    v_pk_fma_f32 v[128:129], v[128:129], v[16:17], v[16:17] op_sel:[0,1,0] op_sel_hi:[1,1,0]
    v_pk_fma_f32 v[130:131], v[130:131], v[16:17], v[16:17] op_sel:[0,1,0] op_sel_hi:[1,1,0]
    v_pk_fma_f32 v[132:133], v[132:133], v[16:17], v[16:17] op_sel:[0,1,0] op_sel_hi:[1,1,0]
    v_pk_fma_f32 v[134:135], v[134:135], v[16:17], v[16:17] op_sel:[0,1,0] op_sel_hi:[1,1,0]
    v_exp_f32 v128, v128
    v_exp_f32 v129, v129
    v_exp_f32 v130, v130
    v_exp_f32 v131, v131
    v_exp_f32 v132, v132
    v_exp_f32 v133, v133
    v_exp_f32 v134, v134
    v_exp_f32 v135, v135
    v_cvt_pk_bf16_f32 v160, v128, v129
    v_cvt_pk_bf16_f32 v161, v130, v131
    v_cvt_pk_bf16_f32 v162, v132, v133
    v_cvt_pk_bf16_f32 v163, v134, v135
    v_rcp_f32 v84, v84
    s_nop 0
    v_pk_mul_f32 v[52:53], v[84:85], v[52:53] op_sel_hi:[0,1]
    v_pk_mul_f32 v[54:55], v[84:85], v[54:55] op_sel_hi:[0,1]
    v_pk_mul_f32 v[68:69], v[84:85], v[68:69] op_sel_hi:[0,1]
    v_pk_mul_f32 v[70:71], v[84:85], v[70:71] op_sel_hi:[0,1]
    v_cvt_pk_bf16_f32 v52, v52, v53
    v_cvt_pk_bf16_f32 v53, v54, v55
    v_cvt_pk_bf16_f32 v54, v68, v69
    v_cvt_pk_bf16_f32 v55, v70, v71
    s_nop 0
    v_permlane32_swap_b32 v52, v54
    v_permlane32_swap_b32 v53, v55
    buffer_store_dwordx4 v[52:55], v6, s[12:15], s49 offen offset:256 sc1
    v_mfma_f32_16x16x32_bf16 v[80:83], v[208:211], v[160:163], 0
    v_mfma_f32_16x16x32_bf16 v[48:51], v[96:99], v[160:163], 0
    v_mfma_f32_16x16x32_bf16 v[64:67], v[112:115], v[160:163], 0
    s_nop 5
    v_rcp_f32 v80, v80
    s_nop 0
    v_pk_mul_f32 v[48:49], v[80:81], v[48:49] op_sel_hi:[0,1]
    v_pk_mul_f32 v[50:51], v[80:81], v[50:51] op_sel_hi:[0,1]
    v_pk_mul_f32 v[64:65], v[80:81], v[64:65] op_sel_hi:[0,1]
    v_pk_mul_f32 v[66:67], v[80:81], v[66:67] op_sel_hi:[0,1]
    v_cvt_pk_bf16_f32 v48, v48, v49
    v_cvt_pk_bf16_f32 v49, v50, v51
    v_cvt_pk_bf16_f32 v50, v64, v65
    v_cvt_pk_bf16_f32 v51, v66, v67
    s_nop 0
    v_permlane32_swap_b32 v48, v50
    v_permlane32_swap_b32 v49, v51
    buffer_store_dwordx4 v[48:51], v6, s[12:15], s49 offen offset:0 sc1
    s_mul_i32 s55, s9, 786432
    s_add_u32 s55, s55, 65798144
    v_and_b32 v16, 63, v0
    s_and_b32 s56, s11, 0xe0
    v_lshrrev_b32 v17, 5, v16
    v_add_u32 v16, s56, v16
    v_and_b32 v16, 255, v16
    v_lshlrev_b32 v16, 10, v16
    v_lshl_add_u32 v16, v17, 8, v16
    s_bfe_u32 s56, s11, 0x20003
    s_and_b32 s57, s11, 7
    s_lshl_b32 s56, s56, 7
    s_lshl_b32 s57, s57, 2
    s_add_u32 s55, s55, s56
    s_add_u32 s55, s55, s57
    v_mov_b32 v17, 159488
    v_mov_b32 v18, 1
    v_mov_b32 v19, s10
    s_mov_b64 exec, 1
    s_waitcnt vmcnt(0)
    ds_add_rtn_u32 v18, v17, v18
    s_waitcnt lgkmcnt(0)
    v_readfirstlane_b32 s56, v18
    s_and_b32 s56, s56, 3
    s_cmp_lg_u32 s56, 3
    s_cbranch_scc1 pub_2
    s_mov_b32 exec_lo, -1
    buffer_store_dword v19, v16, s[12:15], s55 offen sc1
pub_2:
    s_mov_b64 exec, -1
    s_branch c_wo
.p2align 6
c_wo:
    v_and_b32 v1, 63, v0
    v_lshrrev_b32 v2, 6, v0
    v_lshlrev_b32 v5, 4, v1
    v_lshrrev_b32 v3, 5, v1
    s_lshl_b32 s48, s6, 2
    s_add_u32 s48, s48, s8
    s_lshl_b32 s55, s48, 16
    s_lshl_b32 s56, s9, 22
    s_add_u32 s55, s55, s56
    s_lshl_b32 s56, s7, 12
    s_add_u32 s58, s55, s56
    buffer_load_dwordx4 v[96:99], v5, s[12:15], s58 offen offset:0 sc1
    buffer_load_dwordx4 v[100:103], v5, s[12:15], s58 offen offset:1024 sc1
    buffer_load_dwordx4 v[104:107], v5, s[12:15], s58 offen offset:2048 sc1
    buffer_load_dwordx4 v[108:111], v5, s[12:15], s58 offen offset:3072 sc1
    s_add_u32 s55, s55, 16777216
    s_add_u32 s16, s4, s55
    s_addc_u32 s17, s5, 0
    s_mov_b32 s18, 65536
    s_mov_b32 s19, 0x00020000
    v_and_b32 v4, 15, v0
    v_lshrrev_b32 v16, 2, v4
    v_lshl_add_u32 v16, v3, 2, v16
    v_lshlrev_b32 v16, 7, v16
    v_bfe_u32 v17, v1, 4, 1
    v_lshl_add_u32 v16, v17, 5, v16
    v_and_b32 v17, 3, v4
    v_lshl_add_u32 v16, v17, 3, v16
    v_lshrrev_b32 v17, 3, v4
    v_lshlrev_b32 v18, 6, v17
    v_add_u32 v12, v16, v18
    v_sub_u32 v13, v16, v18
    s_mov_b32 s57, 0xffff0000
    s_waitcnt vmcnt(0)
    v_lshlrev_b32 v32, 16, v96
    v_and_b32 v33, s57, v96
    v_lshlrev_b32 v34, 16, v97
    v_and_b32 v35, s57, v97
    v_lshlrev_b32 v36, 16, v98
    v_and_b32 v37, s57, v98
    v_lshlrev_b32 v38, 16, v99
    v_and_b32 v39, s57, v99
    v_lshlrev_b32 v40, 16, v100
    v_and_b32 v41, s57, v100
    v_lshlrev_b32 v42, 16, v101
    v_and_b32 v43, s57, v101
    v_lshlrev_b32 v44, 16, v102
    v_and_b32 v45, s57, v102
    v_lshlrev_b32 v46, 16, v103
    v_and_b32 v47, s57, v103
    v_lshlrev_b32 v48, 16, v104
    v_and_b32 v49, s57, v104
    v_lshlrev_b32 v50, 16, v105
    v_and_b32 v51, s57, v105
    v_lshlrev_b32 v52, 16, v106
    v_and_b32 v53, s57, v106
    v_lshlrev_b32 v54, 16, v107
    v_and_b32 v55, s57, v107
    v_lshlrev_b32 v56, 16, v108
    v_and_b32 v57, s57, v108
    v_lshlrev_b32 v58, 16, v109
    v_and_b32 v59, s57, v109
    v_lshlrev_b32 v60, 16, v110
    v_and_b32 v61, s57, v110
    v_lshlrev_b32 v62, 16, v111
    v_and_b32 v63, s57, v111
    s_mov_b32 s50, 0
    s_mov_b32 s51, 4096
    s_mov_b32 s52, 8192
    s_mov_b32 s53, 12288
    s_mov_b32 s54, 3
    s_mul_i32 s60, s9, 786432
    s_add_u32 s60, s60, 65798144
    s_lshl_b32 s61, s11, 10
    s_add_u32 s60, s60, s61
    s_lshl_b32 s61, s8, 7
    s_add_u32 s60, s60, s61
    s_mov_b32 s98, s10
    s_mov_b32 s99, s10
    s_mov_b32 s3, 0x20000
cp_3:
    s_load_dwordx8 s[24:31], s[4:5], s60 glc
    s_sub_u32 s3, s3, 1
    s_cbranch_scc1 cp_3_ok
    s_waitcnt lgkmcnt(0)
    s_xor_b64 s[24:25], s[24:25], s[98:99]
    s_xor_b64 s[26:27], s[26:27], s[98:99]
    s_xor_b64 s[28:29], s[28:29], s[98:99]
    s_xor_b64 s[30:31], s[30:31], s[98:99]
    s_or_b64 s[24:25], s[24:25], s[26:27]
    s_or_b64 s[28:29], s[28:29], s[30:31]
    s_or_b64 s[24:25], s[24:25], s[28:29]
    s_cbranch_scc1 cp_3
cp_3_ok:
    s_waitcnt lgkmcnt(0)
    s_barrier
    buffer_load_dwordx4 v[112:115], v5, s[16:19], s50 offen offset:0 sc1
    buffer_load_dwordx4 v[116:119], v5, s[16:19], s50 offen offset:1024 sc1
    buffer_load_dwordx4 v[120:123], v5, s[16:19], s50 offen offset:2048 sc1
    buffer_load_dwordx4 v[124:127], v5, s[16:19], s50 offen offset:3072 sc1
    ds_read_b64_tr_b16 v[64:65], v12 offset:0
    ds_read_b64_tr_b16 v[66:67], v12 offset:1024
    ds_read_b64_tr_b16 v[68:69], v13 offset:64
    ds_read_b64_tr_b16 v[70:71], v13 offset:1088
    ds_read_b64_tr_b16 v[72:73], v12 offset:2048
    ds_read_b64_tr_b16 v[74:75], v12 offset:3072
    ds_read_b64_tr_b16 v[76:77], v13 offset:2112
    ds_read_b64_tr_b16 v[78:79], v13 offset:3136
    ds_read_b64_tr_b16 v[80:81], v12 offset:4096
    ds_read_b64_tr_b16 v[82:83], v12 offset:5120
    ds_read_b64_tr_b16 v[84:85], v13 offset:4160
    ds_read_b64_tr_b16 v[86:87], v13 offset:5184
    buffer_load_dwordx4 v[128:131], v5, s[16:19], s51 offen offset:0 sc1
    buffer_load_dwordx4 v[132:135], v5, s[16:19], s51 offen offset:1024 sc1
    buffer_load_dwordx4 v[136:139], v5, s[16:19], s51 offen offset:2048 sc1
    buffer_load_dwordx4 v[140:143], v5, s[16:19], s51 offen offset:3072 sc1
    buffer_load_dwordx4 v[144:147], v5, s[16:19], s52 offen offset:0 sc1
    buffer_load_dwordx4 v[148:151], v5, s[16:19], s52 offen offset:1024 sc1
    buffer_load_dwordx4 v[152:155], v5, s[16:19], s52 offen offset:2048 sc1
    buffer_load_dwordx4 v[156:159], v5, s[16:19], s52 offen offset:3072 sc1
    buffer_load_dwordx4 v[160:163], v5, s[16:19], s53 offen offset:0 sc1
    buffer_load_dwordx4 v[164:167], v5, s[16:19], s53 offen offset:1024 sc1
    buffer_load_dwordx4 v[168:171], v5, s[16:19], s53 offen offset:2048 sc1
    s_add_u32 s50, s50, 15360
    s_add_u32 s51, s51, 15360
    s_add_u32 s52, s52, 15360
    s_add_u32 s53, s53, 15360
.p2align 3
c_wo_loop:
    s_waitcnt vmcnt(14) lgkmcnt(8)
    v_mfma_f32_32x32x16_bf16 v[32:47], v[64:67], v[112:115], v[32:47]
    ds_read_b64_tr_b16 v[88:89], v12 offset:6144
    ds_read_b64_tr_b16 v[90:91], v12 offset:7168
    buffer_load_dwordx4 v[172:175], v5, s[16:19], s50 offen offset:0 sc1
    v_mfma_f32_32x32x16_bf16 v[48:63], v[68:71], v[112:115], v[48:63]
    ds_read_b64_tr_b16 v[92:93], v13 offset:6208
    ds_read_b64_tr_b16 v[94:95], v13 offset:7232
    s_waitcnt vmcnt(14) lgkmcnt(8)
    v_mfma_f32_32x32x16_bf16 v[32:47], v[72:75], v[116:119], v[32:47]
    ds_read_b64_tr_b16 v[64:65], v12 offset:8192
    ds_read_b64_tr_b16 v[66:67], v12 offset:9216
    buffer_load_dwordx4 v[112:115], v5, s[16:19], s50 offen offset:1024 sc1
    v_mfma_f32_32x32x16_bf16 v[48:63], v[76:79], v[116:119], v[48:63]
    ds_read_b64_tr_b16 v[68:69], v13 offset:8256
    ds_read_b64_tr_b16 v[70:71], v13 offset:9280
    s_waitcnt vmcnt(14) lgkmcnt(8)
    v_mfma_f32_32x32x16_bf16 v[32:47], v[80:83], v[120:123], v[32:47]
    ds_read_b64_tr_b16 v[72:73], v12 offset:10240
    ds_read_b64_tr_b16 v[74:75], v12 offset:11264
    buffer_load_dwordx4 v[116:119], v5, s[16:19], s50 offen offset:2048 sc1
    v_mfma_f32_32x32x16_bf16 v[48:63], v[84:87], v[120:123], v[48:63]
    ds_read_b64_tr_b16 v[76:77], v13 offset:10304
    ds_read_b64_tr_b16 v[78:79], v13 offset:11328
    s_waitcnt vmcnt(14) lgkmcnt(8)
    v_mfma_f32_32x32x16_bf16 v[32:47], v[88:91], v[124:127], v[32:47]
    ds_read_b64_tr_b16 v[80:81], v12 offset:12288
    ds_read_b64_tr_b16 v[82:83], v12 offset:13312
    buffer_load_dwordx4 v[120:123], v5, s[16:19], s50 offen offset:3072 sc1
    v_mfma_f32_32x32x16_bf16 v[48:63], v[92:95], v[124:127], v[48:63]
    ds_read_b64_tr_b16 v[84:85], v13 offset:12352
    ds_read_b64_tr_b16 v[86:87], v13 offset:13376
    s_add_u32 s50, s50, 16384
    s_waitcnt vmcnt(14) lgkmcnt(8)
    v_mfma_f32_32x32x16_bf16 v[32:47], v[64:67], v[128:131], v[32:47]
    ds_read_b64_tr_b16 v[88:89], v12 offset:14336
    ds_read_b64_tr_b16 v[90:91], v12 offset:15360
    buffer_load_dwordx4 v[124:127], v5, s[16:19], s51 offen offset:0 sc1
    v_mfma_f32_32x32x16_bf16 v[48:63], v[68:71], v[128:131], v[48:63]
    ds_read_b64_tr_b16 v[92:93], v13 offset:14400
    ds_read_b64_tr_b16 v[94:95], v13 offset:15424
    s_waitcnt vmcnt(14) lgkmcnt(8)
    v_mfma_f32_32x32x16_bf16 v[32:47], v[72:75], v[132:135], v[32:47]
    ds_read_b64_tr_b16 v[64:65], v12 offset:16384
    ds_read_b64_tr_b16 v[66:67], v12 offset:17408
    buffer_load_dwordx4 v[128:131], v5, s[16:19], s51 offen offset:1024 sc1
    v_mfma_f32_32x32x16_bf16 v[48:63], v[76:79], v[132:135], v[48:63]
    ds_read_b64_tr_b16 v[68:69], v13 offset:16448
    ds_read_b64_tr_b16 v[70:71], v13 offset:17472
    s_waitcnt vmcnt(14) lgkmcnt(8)
    v_mfma_f32_32x32x16_bf16 v[32:47], v[80:83], v[136:139], v[32:47]
    ds_read_b64_tr_b16 v[72:73], v12 offset:18432
    ds_read_b64_tr_b16 v[74:75], v12 offset:19456
    buffer_load_dwordx4 v[132:135], v5, s[16:19], s51 offen offset:2048 sc1
    v_mfma_f32_32x32x16_bf16 v[48:63], v[84:87], v[136:139], v[48:63]
    ds_read_b64_tr_b16 v[76:77], v13 offset:18496
    ds_read_b64_tr_b16 v[78:79], v13 offset:19520
    s_waitcnt vmcnt(14) lgkmcnt(8)
    v_mfma_f32_32x32x16_bf16 v[32:47], v[88:91], v[140:143], v[32:47]
    ds_read_b64_tr_b16 v[80:81], v12 offset:20480
    ds_read_b64_tr_b16 v[82:83], v12 offset:21504
    buffer_load_dwordx4 v[136:139], v5, s[16:19], s51 offen offset:3072 sc1
    v_mfma_f32_32x32x16_bf16 v[48:63], v[92:95], v[140:143], v[48:63]
    ds_read_b64_tr_b16 v[84:85], v13 offset:20544
    ds_read_b64_tr_b16 v[86:87], v13 offset:21568
    s_add_u32 s51, s51, 16384
    s_waitcnt vmcnt(14) lgkmcnt(8)
    v_mfma_f32_32x32x16_bf16 v[32:47], v[64:67], v[144:147], v[32:47]
    ds_read_b64_tr_b16 v[88:89], v12 offset:22528
    ds_read_b64_tr_b16 v[90:91], v12 offset:23552
    buffer_load_dwordx4 v[140:143], v5, s[16:19], s52 offen offset:0 sc1
    v_mfma_f32_32x32x16_bf16 v[48:63], v[68:71], v[144:147], v[48:63]
    ds_read_b64_tr_b16 v[92:93], v13 offset:22592
    ds_read_b64_tr_b16 v[94:95], v13 offset:23616
    s_waitcnt vmcnt(14) lgkmcnt(8)
    v_mfma_f32_32x32x16_bf16 v[32:47], v[72:75], v[148:151], v[32:47]
    ds_read_b64_tr_b16 v[64:65], v12 offset:24576
    ds_read_b64_tr_b16 v[66:67], v12 offset:25600
    buffer_load_dwordx4 v[144:147], v5, s[16:19], s52 offen offset:1024 sc1
    v_mfma_f32_32x32x16_bf16 v[48:63], v[76:79], v[148:151], v[48:63]
    ds_read_b64_tr_b16 v[68:69], v13 offset:24640
    ds_read_b64_tr_b16 v[70:71], v13 offset:25664
    s_waitcnt vmcnt(14) lgkmcnt(8)
    v_mfma_f32_32x32x16_bf16 v[32:47], v[80:83], v[152:155], v[32:47]
    ds_read_b64_tr_b16 v[72:73], v12 offset:26624
    ds_read_b64_tr_b16 v[74:75], v12 offset:27648
    buffer_load_dwordx4 v[148:151], v5, s[16:19], s52 offen offset:2048 sc1
    v_mfma_f32_32x32x16_bf16 v[48:63], v[84:87], v[152:155], v[48:63]
    ds_read_b64_tr_b16 v[76:77], v13 offset:26688
    ds_read_b64_tr_b16 v[78:79], v13 offset:27712
    s_waitcnt vmcnt(14) lgkmcnt(8)
    v_mfma_f32_32x32x16_bf16 v[32:47], v[88:91], v[156:159], v[32:47]
    ds_read_b64_tr_b16 v[80:81], v12 offset:28672
    ds_read_b64_tr_b16 v[82:83], v12 offset:29696
    buffer_load_dwordx4 v[152:155], v5, s[16:19], s52 offen offset:3072 sc1
    v_mfma_f32_32x32x16_bf16 v[48:63], v[92:95], v[156:159], v[48:63]
    ds_read_b64_tr_b16 v[84:85], v13 offset:28736
    ds_read_b64_tr_b16 v[86:87], v13 offset:29760
    s_add_u32 s52, s52, 16384
    s_waitcnt vmcnt(14) lgkmcnt(8)
    v_mfma_f32_32x32x16_bf16 v[32:47], v[64:67], v[160:163], v[32:47]
    ds_read_b64_tr_b16 v[88:89], v12 offset:30720
    ds_read_b64_tr_b16 v[90:91], v12 offset:31744
    buffer_load_dwordx4 v[156:159], v5, s[16:19], s53 offen offset:0 sc1
    v_mfma_f32_32x32x16_bf16 v[48:63], v[68:71], v[160:163], v[48:63]
    ds_read_b64_tr_b16 v[92:93], v13 offset:30784
    ds_read_b64_tr_b16 v[94:95], v13 offset:31808
    s_waitcnt vmcnt(14) lgkmcnt(8)
    v_mfma_f32_32x32x16_bf16 v[32:47], v[72:75], v[164:167], v[32:47]
    ds_read_b64_tr_b16 v[64:65], v12 offset:32768
    ds_read_b64_tr_b16 v[66:67], v12 offset:33792
    buffer_load_dwordx4 v[160:163], v5, s[16:19], s53 offen offset:1024 sc1
    v_mfma_f32_32x32x16_bf16 v[48:63], v[76:79], v[164:167], v[48:63]
    ds_read_b64_tr_b16 v[68:69], v13 offset:32832
    ds_read_b64_tr_b16 v[70:71], v13 offset:33856
    s_waitcnt vmcnt(14) lgkmcnt(8)
    v_mfma_f32_32x32x16_bf16 v[32:47], v[80:83], v[168:171], v[32:47]
    ds_read_b64_tr_b16 v[72:73], v12 offset:34816
    ds_read_b64_tr_b16 v[74:75], v12 offset:35840
    buffer_load_dwordx4 v[164:167], v5, s[16:19], s53 offen offset:2048 sc1
    v_mfma_f32_32x32x16_bf16 v[48:63], v[84:87], v[168:171], v[48:63]
    ds_read_b64_tr_b16 v[76:77], v13 offset:34880
    ds_read_b64_tr_b16 v[78:79], v13 offset:35904
    s_waitcnt vmcnt(14) lgkmcnt(8)
    v_mfma_f32_32x32x16_bf16 v[32:47], v[88:91], v[172:175], v[32:47]
    ds_read_b64_tr_b16 v[80:81], v12 offset:36864
    ds_read_b64_tr_b16 v[82:83], v12 offset:37888
    buffer_load_dwordx4 v[168:171], v5, s[16:19], s53 offen offset:3072 sc1
    v_add_u32 v12, 32768, v12
    v_mfma_f32_32x32x16_bf16 v[48:63], v[92:95], v[172:175], v[48:63]
    ds_read_b64_tr_b16 v[84:85], v13 offset:36928
    ds_read_b64_tr_b16 v[86:87], v13 offset:37952
    v_add_u32 v13, 32768, v13
    s_add_u32 s53, s53, 16384
    s_sub_u32 s54, s54, 1
    s_cmp_lg_u32 s54, 0
    s_cbranch_scc1 c_wo_loop
    s_waitcnt vmcnt(14) lgkmcnt(8)
    v_mfma_f32_32x32x16_bf16 v[32:47], v[64:67], v[112:115], v[32:47]
    ds_read_b64_tr_b16 v[88:89], v12 offset:6144
    ds_read_b64_tr_b16 v[90:91], v12 offset:7168
    buffer_load_dwordx4 v[172:175], v5, s[16:19], s50 offen offset:0 sc1
    v_mfma_f32_32x32x16_bf16 v[48:63], v[68:71], v[112:115], v[48:63]
    ds_read_b64_tr_b16 v[92:93], v13 offset:6208
    ds_read_b64_tr_b16 v[94:95], v13 offset:7232
    s_waitcnt vmcnt(14) lgkmcnt(8)
    v_mfma_f32_32x32x16_bf16 v[32:47], v[72:75], v[116:119], v[32:47]
    ds_read_b64_tr_b16 v[64:65], v12 offset:8192
    ds_read_b64_tr_b16 v[66:67], v12 offset:9216
    v_mfma_f32_32x32x16_bf16 v[48:63], v[76:79], v[116:119], v[48:63]
    ds_read_b64_tr_b16 v[68:69], v13 offset:8256
    ds_read_b64_tr_b16 v[70:71], v13 offset:9280
    s_waitcnt vmcnt(13) lgkmcnt(8)
    v_mfma_f32_32x32x16_bf16 v[32:47], v[80:83], v[120:123], v[32:47]
    ds_read_b64_tr_b16 v[72:73], v12 offset:10240
    ds_read_b64_tr_b16 v[74:75], v12 offset:11264
    v_mfma_f32_32x32x16_bf16 v[48:63], v[84:87], v[120:123], v[48:63]
    ds_read_b64_tr_b16 v[76:77], v13 offset:10304
    ds_read_b64_tr_b16 v[78:79], v13 offset:11328
    s_waitcnt vmcnt(12) lgkmcnt(8)
    v_mfma_f32_32x32x16_bf16 v[32:47], v[88:91], v[124:127], v[32:47]
    ds_read_b64_tr_b16 v[80:81], v12 offset:12288
    ds_read_b64_tr_b16 v[82:83], v12 offset:13312
    v_mfma_f32_32x32x16_bf16 v[48:63], v[92:95], v[124:127], v[48:63]
    ds_read_b64_tr_b16 v[84:85], v13 offset:12352
    ds_read_b64_tr_b16 v[86:87], v13 offset:13376
    s_waitcnt vmcnt(11) lgkmcnt(8)
    v_mfma_f32_32x32x16_bf16 v[32:47], v[64:67], v[128:131], v[32:47]
    ds_read_b64_tr_b16 v[88:89], v12 offset:14336
    ds_read_b64_tr_b16 v[90:91], v12 offset:15360
    v_mfma_f32_32x32x16_bf16 v[48:63], v[68:71], v[128:131], v[48:63]
    ds_read_b64_tr_b16 v[92:93], v13 offset:14400
    ds_read_b64_tr_b16 v[94:95], v13 offset:15424
    s_waitcnt vmcnt(10) lgkmcnt(8)
    v_mfma_f32_32x32x16_bf16 v[32:47], v[72:75], v[132:135], v[32:47]
    ds_read_b64_tr_b16 v[64:65], v12 offset:16384
    ds_read_b64_tr_b16 v[66:67], v12 offset:17408
    v_mfma_f32_32x32x16_bf16 v[48:63], v[76:79], v[132:135], v[48:63]
    ds_read_b64_tr_b16 v[68:69], v13 offset:16448
    ds_read_b64_tr_b16 v[70:71], v13 offset:17472
    s_waitcnt vmcnt(9) lgkmcnt(8)
    v_mfma_f32_32x32x16_bf16 v[32:47], v[80:83], v[136:139], v[32:47]
    ds_read_b64_tr_b16 v[72:73], v12 offset:18432
    ds_read_b64_tr_b16 v[74:75], v12 offset:19456
    v_mfma_f32_32x32x16_bf16 v[48:63], v[84:87], v[136:139], v[48:63]
    ds_read_b64_tr_b16 v[76:77], v13 offset:18496
    ds_read_b64_tr_b16 v[78:79], v13 offset:19520
    s_waitcnt vmcnt(8) lgkmcnt(8)
    v_mfma_f32_32x32x16_bf16 v[32:47], v[88:91], v[140:143], v[32:47]
    ds_read_b64_tr_b16 v[80:81], v12 offset:20480
    ds_read_b64_tr_b16 v[82:83], v12 offset:21504
    v_mfma_f32_32x32x16_bf16 v[48:63], v[92:95], v[140:143], v[48:63]
    ds_read_b64_tr_b16 v[84:85], v13 offset:20544
    ds_read_b64_tr_b16 v[86:87], v13 offset:21568
    s_waitcnt vmcnt(7) lgkmcnt(8)
    v_mfma_f32_32x32x16_bf16 v[32:47], v[64:67], v[144:147], v[32:47]
    ds_read_b64_tr_b16 v[88:89], v12 offset:22528
    ds_read_b64_tr_b16 v[90:91], v12 offset:23552
    v_mfma_f32_32x32x16_bf16 v[48:63], v[68:71], v[144:147], v[48:63]
    ds_read_b64_tr_b16 v[92:93], v13 offset:22592
    ds_read_b64_tr_b16 v[94:95], v13 offset:23616
    s_waitcnt vmcnt(6) lgkmcnt(8)
    v_mfma_f32_32x32x16_bf16 v[32:47], v[72:75], v[148:151], v[32:47]
    ds_read_b64_tr_b16 v[64:65], v12 offset:24576
    ds_read_b64_tr_b16 v[66:67], v12 offset:25600
    v_mfma_f32_32x32x16_bf16 v[48:63], v[76:79], v[148:151], v[48:63]
    ds_read_b64_tr_b16 v[68:69], v13 offset:24640
    ds_read_b64_tr_b16 v[70:71], v13 offset:25664
    s_waitcnt vmcnt(5) lgkmcnt(8)
    v_mfma_f32_32x32x16_bf16 v[32:47], v[80:83], v[152:155], v[32:47]
    ds_read_b64_tr_b16 v[72:73], v12 offset:26624
    ds_read_b64_tr_b16 v[74:75], v12 offset:27648
    v_mfma_f32_32x32x16_bf16 v[48:63], v[84:87], v[152:155], v[48:63]
    ds_read_b64_tr_b16 v[76:77], v13 offset:26688
    ds_read_b64_tr_b16 v[78:79], v13 offset:27712
    s_waitcnt vmcnt(4) lgkmcnt(8)
    v_mfma_f32_32x32x16_bf16 v[32:47], v[88:91], v[156:159], v[32:47]
    ds_read_b64_tr_b16 v[80:81], v12 offset:28672
    ds_read_b64_tr_b16 v[82:83], v12 offset:29696
    v_mfma_f32_32x32x16_bf16 v[48:63], v[92:95], v[156:159], v[48:63]
    ds_read_b64_tr_b16 v[84:85], v13 offset:28736
    ds_read_b64_tr_b16 v[86:87], v13 offset:29760
    s_waitcnt vmcnt(3) lgkmcnt(8)
    v_mfma_f32_32x32x16_bf16 v[32:47], v[64:67], v[160:163], v[32:47]
    ds_read_b64_tr_b16 v[88:89], v12 offset:30720
    ds_read_b64_tr_b16 v[90:91], v12 offset:31744
    v_mfma_f32_32x32x16_bf16 v[48:63], v[68:71], v[160:163], v[48:63]
    ds_read_b64_tr_b16 v[92:93], v13 offset:30784
    ds_read_b64_tr_b16 v[94:95], v13 offset:31808
    s_waitcnt vmcnt(2) lgkmcnt(8)
    v_mfma_f32_32x32x16_bf16 v[32:47], v[72:75], v[164:167], v[32:47]
    v_mfma_f32_32x32x16_bf16 v[48:63], v[76:79], v[164:167], v[48:63]
    s_waitcnt vmcnt(1) lgkmcnt(4)
    v_mfma_f32_32x32x16_bf16 v[32:47], v[80:83], v[168:171], v[32:47]
    v_mfma_f32_32x32x16_bf16 v[48:63], v[84:87], v[168:171], v[48:63]
    s_waitcnt vmcnt(0) lgkmcnt(0)
    v_mfma_f32_32x32x16_bf16 v[32:47], v[88:91], v[172:175], v[32:47]
    v_mfma_f32_32x32x16_bf16 v[48:63], v[92:95], v[172:175], v[48:63]
    s_cmp_eq_u32 s9, 3
    s_nop 7
    s_cbranch_scc1 c_wo_fin
    s_add_u32 s58, s58, 4194304
    s_nop 7
    v_cvt_pk_bf16_f32 v96, v32, v33
    v_cvt_pk_bf16_f32 v97, v34, v35
    v_cvt_pk_bf16_f32 v98, v36, v37
    v_cvt_pk_bf16_f32 v99, v38, v39
    buffer_store_dwordx4 v[96:99], v5, s[12:15], s58 offen offset:0 sc1
    v_cvt_pk_bf16_f32 v100, v40, v41
    v_cvt_pk_bf16_f32 v101, v42, v43
    v_cvt_pk_bf16_f32 v102, v44, v45
    v_cvt_pk_bf16_f32 v103, v46, v47
    buffer_store_dwordx4 v[100:103], v5, s[12:15], s58 offen offset:1024 sc1
    v_cvt_pk_bf16_f32 v104, v48, v49
    v_cvt_pk_bf16_f32 v105, v50, v51
    v_cvt_pk_bf16_f32 v106, v52, v53
    v_cvt_pk_bf16_f32 v107, v54, v55
    buffer_store_dwordx4 v[104:107], v5, s[12:15], s58 offen offset:2048 sc1
    v_cvt_pk_bf16_f32 v108, v56, v57
    v_cvt_pk_bf16_f32 v109, v58, v59
    v_cvt_pk_bf16_f32 v110, v60, v61
    v_cvt_pk_bf16_f32 v111, v62, v63
    buffer_store_dwordx4 v[108:111], v5, s[12:15], s58 offen offset:3072 sc1
    s_barrier
c_wo_stat:
    v_mov_b32 v22, 0x3f803f80
    v_mov_b32 v18, 0
    v_mov_b32 v19, 0
    v_dot2_f32_bf16 v18, v96, v22, v18
    v_dot2_f32_bf16 v19, v96, v96, v19
    v_dot2_f32_bf16 v18, v97, v22, v18
    v_dot2_f32_bf16 v19, v97, v97, v19
    v_dot2_f32_bf16 v18, v98, v22, v18
    v_dot2_f32_bf16 v19, v98, v98, v19
    v_dot2_f32_bf16 v18, v99, v22, v18
    v_dot2_f32_bf16 v19, v99, v99, v19
    v_dot2_f32_bf16 v18, v100, v22, v18
    v_dot2_f32_bf16 v19, v100, v100, v19
    v_dot2_f32_bf16 v18, v101, v22, v18
    v_dot2_f32_bf16 v19, v101, v101, v19
    v_dot2_f32_bf16 v18, v102, v22, v18
    v_dot2_f32_bf16 v19, v102, v102, v19
    v_dot2_f32_bf16 v18, v103, v22, v18
    v_dot2_f32_bf16 v19, v103, v103, v19
    v_dot2_f32_bf16 v18, v104, v22, v18
    v_dot2_f32_bf16 v19, v104, v104, v19
    v_dot2_f32_bf16 v18, v105, v22, v18
    v_dot2_f32_bf16 v19, v105, v105, v19
    v_dot2_f32_bf16 v18, v106, v22, v18
    v_dot2_f32_bf16 v19, v106, v106, v19
    v_dot2_f32_bf16 v18, v107, v22, v18
    v_dot2_f32_bf16 v19, v107, v107, v19
    v_dot2_f32_bf16 v18, v108, v22, v18
    v_dot2_f32_bf16 v19, v108, v108, v19
    v_dot2_f32_bf16 v18, v109, v22, v18
    v_dot2_f32_bf16 v19, v109, v109, v19
    v_dot2_f32_bf16 v18, v110, v22, v18
    v_dot2_f32_bf16 v19, v110, v110, v19
    v_dot2_f32_bf16 v18, v111, v22, v18
    v_dot2_f32_bf16 v19, v111, v111, v19
    v_lshlrev_b32 v16, 3, v1
    s_lshl_b32 s3, s48, 12
    s_lshl_b32 s55, s7, 8
    v_mov_b32 v20, v18
    v_mov_b32 v21, v19
    s_add_u32 s3, s3, s55
    s_lshl_b32 s55, s9, 18
    v_permlane32_swap_b32 v18, v20
    v_permlane32_swap_b32 v19, v21
    s_add_u32 s3, s3, s55
    s_add_u32 s3, s3, 63176704
    v_pk_add_f32 v[18:19], v[18:19], v[20:21]
    s_mov_b32 exec_hi, 0
    buffer_store_dwordx2 v[18:19], v16, s[12:15], s3 offen sc1
    s_mov_b64 exec, -1
    s_cmp_lg_u32 s9, -1
    s_cbranch_scc1 c_wo_pub
    s_barrier
    v_mov_b32 v24, 159492
non_4:
    ds_read_b32 v25, v24
    s_waitcnt lgkmcnt(0)
    v_readfirstlane_b32 s10, v25
    s_cmp_eq_u32 s10, 0
    s_cbranch_scc1 non_4
c_wo_pub:
    s_mul_i32 s55, s9, 786432
    s_add_u32 s55, s55, 66060288
    v_and_b32 v24, 63, v0
    s_and_b32 s56, s11, 0xe0
    v_lshrrev_b32 v25, 5, v24
    v_add_u32 v24, s56, v24
    v_and_b32 v24, 255, v24
    v_lshlrev_b32 v24, 10, v24
    v_lshl_add_u32 v24, v25, 8, v24
    s_bfe_u32 s56, s11, 0x20003
    s_and_b32 s57, s11, 7
    s_lshl_b32 s56, s56, 7
    s_lshl_b32 s57, s57, 2
    s_add_u32 s55, s55, s56
    s_add_u32 s55, s55, s57
    s_and_b32 s57, s6, s9
    s_bfe_i32 s57, s57, 0x10000
    v_mov_b32 v25, 159488
    v_mov_b32 v26, 1
    v_mov_b32 v27, s10
    s_mov_b64 exec, 1
    s_waitcnt vmcnt(0)
    ds_add_rtn_u32 v26, v25, v26
    s_waitcnt lgkmcnt(0)
    v_readfirstlane_b32 s56, v26
    s_and_b32 s56, s56, 3
    s_cmp_lg_u32 s56, 3
    s_cbranch_scc1 pub_5
    s_mov_b32 exec_lo, -1
    s_mov_b32 exec_hi, s57
    buffer_store_dword v27, v24, s[12:15], s55 offen sc1
pub_5:
    s_mov_b64 exec, -1
    s_add_u32 s9, s9, 1
    s_bitcmp1_b32 s9, 0
    s_cbranch_scc1 c_qkvB
    s_branch c_qkvA
c_wo_fin:
    s_barrier
    v_cvt_pk_bf16_f32 v96, v32, v33
    v_cvt_pk_bf16_f32 v97, v34, v35
    v_cvt_pk_bf16_f32 v98, v36, v37
    v_cvt_pk_bf16_f32 v99, v38, v39
    v_cvt_pk_bf16_f32 v100, v40, v41
    v_cvt_pk_bf16_f32 v101, v42, v43
    v_cvt_pk_bf16_f32 v102, v44, v45
    v_cvt_pk_bf16_f32 v103, v46, v47
    v_cvt_pk_bf16_f32 v104, v48, v49
    v_cvt_pk_bf16_f32 v105, v50, v51
    v_cvt_pk_bf16_f32 v106, v52, v53
    v_cvt_pk_bf16_f32 v107, v54, v55
    v_cvt_pk_bf16_f32 v108, v56, v57
    v_cvt_pk_bf16_f32 v109, v58, v59
    v_cvt_pk_bf16_f32 v110, v60, v61
    v_cvt_pk_bf16_f32 v111, v62, v63
    s_mov_b32 s28, s44
    s_mov_b32 s29, s45
    s_mov_b32 s30, 4194304
    s_mov_b32 s31, 0x00020000
    v_and_b32 v16, 31, v1
    v_mul_u32_u24 v16, 144, v16
    v_lshl_add_u32 v16, v3, 3, v16
    v_mul_u32_u24 v17, 4608, v2
    v_add_u32 v16, v16, v17
    ds_write_b64 v16, v[96:97] offset:0
    ds_write_b64 v16, v[98:99] offset:16
    ds_write_b64 v16, v[100:101] offset:32
    ds_write_b64 v16, v[102:103] offset:48
    ds_write_b64 v16, v[104:105] offset:64
    ds_write_b64 v16, v[106:107] offset:80
    ds_write_b64 v16, v[108:109] offset:96
    ds_write_b64 v16, v[110:111] offset:112
    v_lshrrev_b32 v18, 3, v1
    v_and_b32 v19, 7, v1
    v_mul_u32_u24 v20, 144, v18
    v_lshl_add_u32 v20, v19, 4, v20
    v_add_u32 v20, v20, v17
    v_lshlrev_b32 v21, 11, v18
    v_lshl_add_u32 v21, v19, 4, v21
    s_lshl_b32 s3, s48, 16
    s_lshl_b32 s55, s7, 7
    s_add_u32 s3, s3, s55
    s_waitcnt lgkmcnt(0)
    ds_read_b128 v[32:35], v20 offset:0
    ds_read_b128 v[36:39], v20 offset:1152
    ds_read_b128 v[40:43], v20 offset:2304
    ds_read_b128 v[44:47], v20 offset:3456
    s_waitcnt lgkmcnt(3)
    buffer_store_dwordx4 v[32:35], v21, s[28:31], s3 offen sc1
    s_add_u32 s3, s3, 16384
    s_waitcnt lgkmcnt(2)
    buffer_store_dwordx4 v[36:39], v21, s[28:31], s3 offen sc1
    s_add_u32 s3, s3, 16384
    s_waitcnt lgkmcnt(1)
    buffer_store_dwordx4 v[40:43], v21, s[28:31], s3 offen sc1
    s_add_u32 s3, s3, 16384
    s_waitcnt lgkmcnt(0)
    buffer_store_dwordx4 v[44:47], v21, s[28:31], s3 offen sc1
    s_add_u32 s3, s3, 16384
    s_branch k_exit
c_prep:
    s_mov_b32 s28, s32
    s_mov_b32 s29, s33
    s_mov_b32 s30, 4194304
    s_mov_b32 s31, 0x00020000
    s_lshl_b32 s48, s6, 2
    s_add_u32 s48, s48, s8
    v_lshrrev_b32 v16, 3, v1
    v_and_b32 v17, 7, v1
    v_lshlrev_b32 v18, 11, v16
    v_lshl_add_u32 v18, v17, 4, v18
    s_lshl_b32 s55, s48, 16
    s_lshl_b32 s56, s7, 7
    s_add_u32 s3, s55, s56
    buffer_load_dwordx4 v[32:35], v18, s[28:31], s3 offen nt
    s_add_u32 s3, s3, 16384
    buffer_load_dwordx4 v[36:39], v18, s[28:31], s3 offen nt
    s_add_u32 s3, s3, 16384
    buffer_load_dwordx4 v[40:43], v18, s[28:31], s3 offen nt
    s_add_u32 s3, s3, 16384
    buffer_load_dwordx4 v[44:47], v18, s[28:31], s3 offen nt
    s_add_u32 s3, s3, 16384
    s_barrier
    s_lshl_b32 s56, s7, 12
    s_add_u32 s58, s55, s56
    v_lshlrev_b32 v5, 4, v1
    s_lshl_b32 s3, s8, 12
    s_add_u32 s3, s3, 131072
    v_lshrrev_b32 v18, 1, v17
    v_lshlrev_b32 v18, 10, v18
    v_lshl_add_u32 v18, v16, 4, v18
    v_and_b32 v17, 1, v17
    v_lshl_add_u32 v18, v17, 3, v18
    v_add_u32 v18, s3, v18
    v_add_u32 v19, s3, v5
    s_waitcnt vmcnt(3)
    ds_write_b64 v18, v[32:33] offset:0
    ds_write_b64 v18, v[34:35] offset:512
    s_waitcnt vmcnt(2)
    ds_write_b64 v18, v[36:37] offset:128
    ds_write_b64 v18, v[38:39] offset:640
    s_waitcnt vmcnt(1)
    ds_write_b64 v18, v[40:41] offset:256
    ds_write_b64 v18, v[42:43] offset:768
    s_waitcnt vmcnt(0)
    ds_write_b64 v18, v[44:45] offset:384
    ds_write_b64 v18, v[46:47] offset:896
    s_waitcnt lgkmcnt(0)
    ds_read_b128 v[96:99], v19 offset:0
    ds_read_b128 v[100:103], v19 offset:1024
    ds_read_b128 v[104:107], v19 offset:2048
    ds_read_b128 v[108:111], v19 offset:3072
    s_waitcnt lgkmcnt(3)
    buffer_store_dwordx4 v[96:99], v5, s[12:15], s58 offen offset:0 sc1
    s_waitcnt lgkmcnt(2)
    buffer_store_dwordx4 v[100:103], v5, s[12:15], s58 offen offset:1024 sc1
    s_waitcnt lgkmcnt(1)
    buffer_store_dwordx4 v[104:107], v5, s[12:15], s58 offen offset:2048 sc1
    s_waitcnt lgkmcnt(0)
    buffer_store_dwordx4 v[108:111], v5, s[12:15], s58 offen offset:3072 sc1
    s_branch c_wo_stat
.p2align 6
c_qkvB:
    v_and_b32 v1, 63, v0
    v_lshrrev_b32 v2, 6, v0
    v_lshlrev_b32 v5, 4, v1
    v_lshrrev_b32 v3, 5, v1
    v_and_b32 v4, 15, v0
    v_bfe_u32 v7, v1, 4, 1
    v_lshl_add_u32 v6, v7, 5, v4
    v_lshlrev_b32 v6, 4, v6
    v_lshl_add_u32 v6, v3, 10, v6
    s_lshr_b32 s48, s6, 1
    s_lshl_b32 s48, s48, 2
    s_add_u32 s48, s48, s8
    s_lshl_b32 s55, s48, 17
    s_lshl_b32 s56, s9, 22
    s_add_u32 s55, s55, s56
    s_add_u32 s16, s4, s55
    s_addc_u32 s17, s5, 0
    s_mov_b32 s18, 65536
    s_mov_b32 s19, 0x00020000
    s_add_u32 s56, s55, 65536
    s_add_u32 s20, s4, s56
    s_addc_u32 s21, s5, 0
    s_mov_b32 s22, 65536
    s_mov_b32 s23, 0x00020000
    s_lshl_b32 s49, s7, 12
    s_add_u32 s49, s49, s55
    s_and_b32 s56, s6, 1
    s_lshl_b32 s56, s56, 11
    s_add_u32 s49, s49, s56
    s_add_u32 s49, s49, 16777216
    s_movk_i32 s54, 4096
    v_lshrrev_b32 v16, 2, v4
    v_lshl_add_u32 v18, v7, 2, v16
    v_lshl_add_u32 v18, v3, 4, v18
    v_lshlrev_b32 v18, 6, v18
    v_and_b32 v17, 3, v4
    v_lshl_add_u32 v18, v17, 3, v18
    v_lshl_add_u32 v26, v7, 5, v18
    v_xor_b32 v27, 32, v26
    v_mov_b32 v24, v26
    v_mov_b32 v25, v27
    v_and_b32 v18, 0x30, v1
    v_add_u32 v10, 155648, v18
    v_lshlrev_b32 v11, 2, v4
    v_add_u32 v11, 155648, v11
    v_lshl_add_u32 v8, v2, 8, v11
    v_lshl_add_u32 v9, v2, 8, v10
    s_lshr_b32 s3, s8, 1
    s_and_b32 s55, s8, 1
    s_lshl_b32 s3, s3, 14
    s_lshl_b32 s55, s55, 12
    s_add_u32 s3, s3, s55
    s_add_u32 s3, s3, 81920
    v_lshl_add_u32 v12, v3, 5, v4
    v_lshlrev_b32 v12, 4, v12
    v_lshl_add_u32 v12, v7, 10, v12
    v_add_u32 v12, s3, v12
    v_add_u32 v13, s3, v5
    v_mov_b32 v32, 0
    v_mov_b32 v33, 0
    v_mov_b32 v34, 0
    v_mov_b32 v35, 0
    v_mov_b32 v36, 0
    v_mov_b32 v37, 0
    v_mov_b32 v38, 0
    v_mov_b32 v39, 0
    v_mov_b32 v40, 0
    v_mov_b32 v41, 0
    v_mov_b32 v42, 0
    v_mov_b32 v43, 0
    v_mov_b32 v44, 0
    v_mov_b32 v45, 0
    v_mov_b32 v46, 0
    v_mov_b32 v47, 0
    v_mov_b32 v48, 0
    v_mov_b32 v49, 0
    v_mov_b32 v50, 0
    v_mov_b32 v51, 0
    v_mov_b32 v52, 0
    v_mov_b32 v53, 0
    v_mov_b32 v54, 0
    v_mov_b32 v55, 0
    v_mov_b32 v56, 0
    v_mov_b32 v57, 0
    v_mov_b32 v58, 0
    v_mov_b32 v59, 0
    v_mov_b32 v60, 0
    v_mov_b32 v61, 0
    v_mov_b32 v62, 0
    v_mov_b32 v63, 0
    v_mov_b32 v64, 0
    v_mov_b32 v65, 0
    v_mov_b32 v66, 0
    v_mov_b32 v67, 0
    v_mov_b32 v68, 0
    v_mov_b32 v69, 0
    v_mov_b32 v70, 0
    v_mov_b32 v71, 0
    v_mov_b32 v72, 0
    v_mov_b32 v73, 0
    v_mov_b32 v74, 0
    v_mov_b32 v75, 0
    v_mov_b32 v76, 0
    v_mov_b32 v77, 0
    v_mov_b32 v78, 0
    v_mov_b32 v79, 0
    v_mov_b32 v80, 0
    v_mov_b32 v81, 0
    v_mov_b32 v82, 0
    v_mov_b32 v83, 0
    v_mov_b32 v84, 0
    v_mov_b32 v85, 0
    v_mov_b32 v86, 0
    v_mov_b32 v87, 0
    v_mov_b32 v88, 0
    v_mov_b32 v89, 0
    v_mov_b32 v90, 0
    v_mov_b32 v91, 0
    v_mov_b32 v92, 0
    v_mov_b32 v93, 0
    v_mov_b32 v94, 0
    v_mov_b32 v95, 0
    v_mov_b32 v96, 0
    v_mov_b32 v97, 0
    v_mov_b32 v98, 0
    v_mov_b32 v99, 0
    v_mov_b32 v100, 0
    v_mov_b32 v101, 0
    v_mov_b32 v102, 0
    v_mov_b32 v103, 0
    v_mov_b32 v104, 0
    v_mov_b32 v105, 0
    v_mov_b32 v106, 0
    v_mov_b32 v107, 0
    v_mov_b32 v108, 0
    v_mov_b32 v109, 0
    v_mov_b32 v110, 0
    v_mov_b32 v111, 0
    v_mov_b32 v112, 0
    v_mov_b32 v113, 0
    v_mov_b32 v114, 0
    v_mov_b32 v115, 0
    v_mov_b32 v116, 0
    v_mov_b32 v117, 0
    v_mov_b32 v118, 0
    v_mov_b32 v119, 0
    v_mov_b32 v120, 0
    v_mov_b32 v121, 0
    v_mov_b32 v122, 0
    v_mov_b32 v123, 0
    v_mov_b32 v124, 0
    v_mov_b32 v125, 0
    v_mov_b32 v126, 0
    v_mov_b32 v127, 0
    s_mov_b32 s50, 8192
    s_mov_b32 s58, 6144
    s_mov_b32 s51, 12288
    s_mov_b32 s59, 10240
    s_mov_b32 s52, 0
    s_mul_i32 s60, s9, 786432
    s_add_u32 s60, s60, 65273856
    s_lshl_b32 s61, s11, 10
    s_add_u32 s60, s60, s61
    s_lshl_b32 s61, s8, 7
    s_add_u32 s60, s60, s61
    s_mov_b32 s98, s10
    s_mov_b32 s99, s10
    s_mov_b32 s3, 0x20000
cp_6:
    s_load_dwordx8 s[24:31], s[4:5], s60 glc
    s_sub_u32 s3, s3, 1
    s_cbranch_scc1 cp_6_ok
    s_waitcnt lgkmcnt(0)
    s_xor_b64 s[24:25], s[24:25], s[98:99]
    s_xor_b64 s[26:27], s[26:27], s[98:99]
    s_xor_b64 s[28:29], s[28:29], s[98:99]
    s_xor_b64 s[30:31], s[30:31], s[98:99]
    s_or_b64 s[24:25], s[24:25], s[26:27]
    s_or_b64 s[28:29], s[28:29], s[30:31]
    s_or_b64 s[24:25], s[24:25], s[28:29]
    s_cbranch_scc1 cp_6
cp_6_ok:
    s_waitcnt lgkmcnt(0)
    s_barrier
    buffer_load_dwordx4 v[152:155], v6, s[16:19], 0 offen offset:0 sc1
    buffer_load_dwordx4 v[156:159], v6, s[16:19], 0 offen offset:256 sc1
    buffer_load_dwordx4 v[160:163], v6, s[20:23], 0 offen offset:0 sc1
    buffer_load_dwordx4 v[164:167], v6, s[20:23], 0 offen offset:256 sc1
    ds_read_b64_tr_b16 v[128:129], v24 offset:0
    ds_read_b64_tr_b16 v[130:131], v24 offset:512
    ds_read_b64_tr_b16 v[132:133], v25 offset:0
    ds_read_b64_tr_b16 v[134:135], v25 offset:512
    ds_read_b64_tr_b16 v[136:137], v24 offset:8192
    ds_read_b64_tr_b16 v[138:139], v24 offset:8704
    ds_read_b64_tr_b16 v[140:141], v25 offset:8192
    ds_read_b64_tr_b16 v[142:143], v25 offset:8704
    ds_read_b64_tr_b16 v[144:145], v24 offset:16384
    ds_read_b64_tr_b16 v[146:147], v24 offset:16896
    buffer_load_dwordx4 v[168:171], v6, s[16:19], 0 offen offset:2048 sc1
    buffer_load_dwordx4 v[172:175], v6, s[16:19], 0 offen offset:2304 sc1
    buffer_load_dwordx4 v[176:179], v6, s[20:23], 0 offen offset:2048 sc1
    buffer_load_dwordx4 v[180:183], v6, s[20:23], 0 offen offset:2304 sc1
    buffer_load_dwordx4 a[0:3], v6, s[16:19], s54 offen offset:0 sc1
    buffer_load_dwordx4 a[4:7], v6, s[16:19], s54 offen offset:256 sc1
    buffer_load_dwordx4 a[8:11], v6, s[20:23], s54 offen offset:0 sc1
    buffer_load_dwordx4 a[12:15], v6, s[20:23], s54 offen offset:256 sc1
    buffer_load_dwordx4 a[16:19], v6, s[16:19], s54 offen offset:2048 sc1
    buffer_load_dwordx4 a[20:23], v6, s[16:19], s54 offen offset:2304 sc1
    s_mov_b32 s54, 7
    s_waitcnt vmcnt(12)
    s_barrier
.p2align 3
c_qkvB_loop:
    s_waitcnt vmcnt(12) lgkmcnt(8)
    v_mfma_f32_16x16x32_bf16 v[32:35], v[128:131], v[152:155], v[32:35]
    ds_read_b64_tr_b16 v[148:149], v25 offset:16384
    buffer_load_dwordx4 a[24:27], v6, s[20:23], s58 offen offset:0 sc1
    v_mfma_f32_16x16x32_bf16 v[36:39], v[128:131], v[156:159], v[36:39]
    ds_read_b64_tr_b16 v[150:151], v25 offset:16896
    s_waitcnt lgkmcnt(8)
    v_mfma_f32_16x16x32_bf16 v[52:55], v[132:135], v[156:159], v[52:55]
    v_mfma_f32_16x16x32_bf16 v[48:51], v[132:135], v[152:155], v[48:51]
    s_waitcnt lgkmcnt(6)
    v_mfma_f32_16x16x32_bf16 v[64:67], v[136:139], v[152:155], v[64:67]
    v_mfma_f32_16x16x32_bf16 v[68:71], v[136:139], v[156:159], v[68:71]
    s_waitcnt lgkmcnt(4)
    v_mfma_f32_16x16x32_bf16 v[84:87], v[140:143], v[156:159], v[84:87]
    buffer_load_dwordx4 a[28:31], v6, s[20:23], s58 offen offset:256 sc1
    v_mfma_f32_16x16x32_bf16 v[80:83], v[140:143], v[152:155], v[80:83]
    s_waitcnt lgkmcnt(2)
    v_mfma_f32_16x16x32_bf16 v[96:99], v[152:155], v[144:147], v[96:99]
    v_mfma_f32_16x16x32_bf16 v[100:103], v[156:159], v[144:147], v[100:103]
    s_waitcnt lgkmcnt(0)
    v_mfma_f32_16x16x32_bf16 v[116:119], v[156:159], v[148:151], v[116:119]
    v_mfma_f32_16x16x32_bf16 v[112:115], v[152:155], v[148:151], v[112:115]
    s_waitcnt vmcnt(12)
    v_mfma_f32_16x16x32_bf16 v[40:43], v[128:131], v[160:163], v[40:43]
    buffer_load_dwordx4 v[152:155], v6, s[16:19], s50 offen offset:0 sc1
    v_mfma_f32_16x16x32_bf16 v[44:47], v[128:131], v[164:167], v[44:47]
    v_mfma_f32_16x16x32_bf16 v[60:63], v[132:135], v[164:167], v[60:63]
    ds_read_b64_tr_b16 v[128:129], v24 offset:2048
    v_mfma_f32_16x16x32_bf16 v[56:59], v[132:135], v[160:163], v[56:59]
    ds_read_b64_tr_b16 v[130:131], v24 offset:2560
    v_mfma_f32_16x16x32_bf16 v[72:75], v[136:139], v[160:163], v[72:75]
    ds_read_b64_tr_b16 v[132:133], v25 offset:2048
    v_mfma_f32_16x16x32_bf16 v[76:79], v[136:139], v[164:167], v[76:79]
    ds_read_b64_tr_b16 v[134:135], v25 offset:2560
    v_mfma_f32_16x16x32_bf16 v[92:95], v[140:143], v[164:167], v[92:95]
    ds_read_b64_tr_b16 v[136:137], v24 offset:10240
    buffer_load_dwordx4 v[156:159], v6, s[16:19], s50 offen offset:256 sc1
    v_mfma_f32_16x16x32_bf16 v[88:91], v[140:143], v[160:163], v[88:91]
    ds_read_b64_tr_b16 v[138:139], v24 offset:10752
    v_mfma_f32_16x16x32_bf16 v[104:107], v[160:163], v[144:147], v[104:107]
    ds_read_b64_tr_b16 v[140:141], v25 offset:10240
    v_mfma_f32_16x16x32_bf16 v[108:111], v[164:167], v[144:147], v[108:111]
    ds_read_b64_tr_b16 v[142:143], v25 offset:10752
    v_mfma_f32_16x16x32_bf16 v[124:127], v[164:167], v[148:151], v[124:127]
    ds_read_b64_tr_b16 v[144:145], v24 offset:18432
    v_mfma_f32_16x16x32_bf16 v[120:123], v[160:163], v[148:151], v[120:123]
    ds_read_b64_tr_b16 v[146:147], v24 offset:18944
    s_waitcnt vmcnt(12) lgkmcnt(8)
    v_mfma_f32_16x16x32_bf16 v[32:35], v[128:131], v[168:171], v[32:35]
    ds_read_b64_tr_b16 v[148:149], v25 offset:18432
    buffer_load_dwordx4 v[160:163], v6, s[20:23], s58 offen offset:2048 sc1
    v_mfma_f32_16x16x32_bf16 v[36:39], v[128:131], v[172:175], v[36:39]
    ds_read_b64_tr_b16 v[150:151], v25 offset:18944
    s_waitcnt lgkmcnt(8)
    v_mfma_f32_16x16x32_bf16 v[52:55], v[132:135], v[172:175], v[52:55]
    v_mfma_f32_16x16x32_bf16 v[48:51], v[132:135], v[168:171], v[48:51]
    s_waitcnt lgkmcnt(6)
    v_mfma_f32_16x16x32_bf16 v[64:67], v[136:139], v[168:171], v[64:67]
    v_mfma_f32_16x16x32_bf16 v[68:71], v[136:139], v[172:175], v[68:71]
    s_waitcnt lgkmcnt(4)
    v_mfma_f32_16x16x32_bf16 v[84:87], v[140:143], v[172:175], v[84:87]
    buffer_load_dwordx4 v[164:167], v6, s[20:23], s58 offen offset:2304 sc1
    v_mfma_f32_16x16x32_bf16 v[80:83], v[140:143], v[168:171], v[80:83]
    s_waitcnt lgkmcnt(2)
    v_mfma_f32_16x16x32_bf16 v[96:99], v[168:171], v[144:147], v[96:99]
    v_mfma_f32_16x16x32_bf16 v[100:103], v[172:175], v[144:147], v[100:103]
    s_waitcnt lgkmcnt(0)
    v_mfma_f32_16x16x32_bf16 v[116:119], v[172:175], v[148:151], v[116:119]
    v_mfma_f32_16x16x32_bf16 v[112:115], v[168:171], v[148:151], v[112:115]
    s_waitcnt vmcnt(12)
    v_mfma_f32_16x16x32_bf16 v[40:43], v[128:131], v[176:179], v[40:43]
    buffer_load_dwordx4 v[168:171], v6, s[16:19], s50 offen offset:2048 sc1
    v_mfma_f32_16x16x32_bf16 v[44:47], v[128:131], v[180:183], v[44:47]
    v_mfma_f32_16x16x32_bf16 v[60:63], v[132:135], v[180:183], v[60:63]
    ds_read_b64_tr_b16 v[128:129], v24 offset:4096
    v_mfma_f32_16x16x32_bf16 v[56:59], v[132:135], v[176:179], v[56:59]
    ds_read_b64_tr_b16 v[130:131], v24 offset:4608
    v_mfma_f32_16x16x32_bf16 v[72:75], v[136:139], v[176:179], v[72:75]
    ds_read_b64_tr_b16 v[132:133], v25 offset:4096
    v_mfma_f32_16x16x32_bf16 v[76:79], v[136:139], v[180:183], v[76:79]
    ds_read_b64_tr_b16 v[134:135], v25 offset:4608
    v_mfma_f32_16x16x32_bf16 v[92:95], v[140:143], v[180:183], v[92:95]
    ds_read_b64_tr_b16 v[136:137], v24 offset:12288
    buffer_load_dwordx4 v[172:175], v6, s[16:19], s50 offen offset:2304 sc1
    v_mfma_f32_16x16x32_bf16 v[88:91], v[140:143], v[176:179], v[88:91]
    ds_read_b64_tr_b16 v[138:139], v24 offset:12800
    v_mfma_f32_16x16x32_bf16 v[104:107], v[176:179], v[144:147], v[104:107]
    ds_read_b64_tr_b16 v[140:141], v25 offset:12288
    v_mfma_f32_16x16x32_bf16 v[108:111], v[180:183], v[144:147], v[108:111]
    ds_read_b64_tr_b16 v[142:143], v25 offset:12800
    v_mfma_f32_16x16x32_bf16 v[124:127], v[180:183], v[148:151], v[124:127]
    ds_read_b64_tr_b16 v[144:145], v24 offset:20480
    v_mfma_f32_16x16x32_bf16 v[120:123], v[176:179], v[148:151], v[120:123]
    ds_read_b64_tr_b16 v[146:147], v24 offset:20992
    s_waitcnt vmcnt(12) lgkmcnt(8)
    v_mfma_f32_16x16x32_bf16 v[32:35], v[128:131], a[0:3], v[32:35]
    ds_read_b64_tr_b16 v[148:149], v25 offset:20480
    buffer_load_dwordx4 v[176:179], v6, s[20:23], s59 offen offset:0 sc1
    v_mfma_f32_16x16x32_bf16 v[36:39], v[128:131], a[4:7], v[36:39]
    ds_read_b64_tr_b16 v[150:151], v25 offset:20992
    s_waitcnt lgkmcnt(8)
    v_mfma_f32_16x16x32_bf16 v[52:55], v[132:135], a[4:7], v[52:55]
    v_mfma_f32_16x16x32_bf16 v[48:51], v[132:135], a[0:3], v[48:51]
    s_waitcnt lgkmcnt(6)
    v_mfma_f32_16x16x32_bf16 v[64:67], v[136:139], a[0:3], v[64:67]
    v_mfma_f32_16x16x32_bf16 v[68:71], v[136:139], a[4:7], v[68:71]
    s_waitcnt lgkmcnt(4)
    v_mfma_f32_16x16x32_bf16 v[84:87], v[140:143], a[4:7], v[84:87]
    buffer_load_dwordx4 v[180:183], v6, s[20:23], s59 offen offset:256 sc1
    v_mfma_f32_16x16x32_bf16 v[80:83], v[140:143], a[0:3], v[80:83]
    s_waitcnt lgkmcnt(2)
    v_mfma_f32_16x16x32_bf16 v[96:99], a[0:3], v[144:147], v[96:99]
    v_mfma_f32_16x16x32_bf16 v[100:103], a[4:7], v[144:147], v[100:103]
    s_waitcnt lgkmcnt(0)
    v_mfma_f32_16x16x32_bf16 v[116:119], a[4:7], v[148:151], v[116:119]
    v_mfma_f32_16x16x32_bf16 v[112:115], a[0:3], v[148:151], v[112:115]
    s_waitcnt vmcnt(12)
    v_mfma_f32_16x16x32_bf16 v[40:43], v[128:131], a[8:11], v[40:43]
    buffer_load_dwordx4 a[0:3], v6, s[16:19], s51 offen offset:0 sc1
    v_mfma_f32_16x16x32_bf16 v[44:47], v[128:131], a[12:15], v[44:47]
    v_mfma_f32_16x16x32_bf16 v[60:63], v[132:135], a[12:15], v[60:63]
    ds_read_b64_tr_b16 v[128:129], v24 offset:6144
    v_mfma_f32_16x16x32_bf16 v[56:59], v[132:135], a[8:11], v[56:59]
    ds_read_b64_tr_b16 v[130:131], v24 offset:6656
    v_mfma_f32_16x16x32_bf16 v[72:75], v[136:139], a[8:11], v[72:75]
    ds_read_b64_tr_b16 v[132:133], v25 offset:6144
    v_mfma_f32_16x16x32_bf16 v[76:79], v[136:139], a[12:15], v[76:79]
    ds_read_b64_tr_b16 v[134:135], v25 offset:6656
    v_mfma_f32_16x16x32_bf16 v[92:95], v[140:143], a[12:15], v[92:95]
    ds_read_b64_tr_b16 v[136:137], v24 offset:14336
    buffer_load_dwordx4 a[4:7], v6, s[16:19], s51 offen offset:256 sc1
    v_mfma_f32_16x16x32_bf16 v[88:91], v[140:143], a[8:11], v[88:91]
    ds_read_b64_tr_b16 v[138:139], v24 offset:14848
    v_mfma_f32_16x16x32_bf16 v[104:107], a[8:11], v[144:147], v[104:107]
    ds_read_b64_tr_b16 v[140:141], v25 offset:14336
    v_mfma_f32_16x16x32_bf16 v[108:111], a[12:15], v[144:147], v[108:111]
    ds_read_b64_tr_b16 v[142:143], v25 offset:14848
    v_mfma_f32_16x16x32_bf16 v[124:127], a[12:15], v[148:151], v[124:127]
    ds_read_b64_tr_b16 v[144:145], v24 offset:22528
    v_mfma_f32_16x16x32_bf16 v[120:123], a[8:11], v[148:151], v[120:123]
    ds_read_b64_tr_b16 v[146:147], v24 offset:23040
    s_waitcnt vmcnt(12) lgkmcnt(8)
    v_mfma_f32_16x16x32_bf16 v[32:35], v[128:131], a[16:19], v[32:35]
    ds_read_b64_tr_b16 v[148:149], v25 offset:22528
    buffer_load_dwordx4 a[8:11], v6, s[20:23], s59 offen offset:2048 sc1
    v_mfma_f32_16x16x32_bf16 v[36:39], v[128:131], a[20:23], v[36:39]
    ds_read_b64_tr_b16 v[150:151], v25 offset:23040
    s_waitcnt lgkmcnt(8)
    v_mfma_f32_16x16x32_bf16 v[52:55], v[132:135], a[20:23], v[52:55]
    v_mfma_f32_16x16x32_bf16 v[48:51], v[132:135], a[16:19], v[48:51]
    s_waitcnt lgkmcnt(6)
    v_mfma_f32_16x16x32_bf16 v[64:67], v[136:139], a[16:19], v[64:67]
    v_mfma_f32_16x16x32_bf16 v[68:71], v[136:139], a[20:23], v[68:71]
    s_waitcnt lgkmcnt(4)
    v_mfma_f32_16x16x32_bf16 v[84:87], v[140:143], a[20:23], v[84:87]
    buffer_load_dwordx4 a[12:15], v6, s[20:23], s59 offen offset:2304 sc1
    v_mfma_f32_16x16x32_bf16 v[80:83], v[140:143], a[16:19], v[80:83]
    s_waitcnt lgkmcnt(2)
    v_mfma_f32_16x16x32_bf16 v[96:99], a[16:19], v[144:147], v[96:99]
    s_add_u32 s52, s52, 24576
    v_mfma_f32_16x16x32_bf16 v[100:103], a[20:23], v[144:147], v[100:103]
    s_cmp_eq_u32 s52, 147456
    s_waitcnt lgkmcnt(0)
    v_mfma_f32_16x16x32_bf16 v[116:119], a[20:23], v[148:151], v[116:119]
    s_cselect_b32 s52, 0, s52
    v_mfma_f32_16x16x32_bf16 v[112:115], a[16:19], v[148:151], v[112:115]
    s_add_u32 s58, s58, 8192
    s_add_u32 s59, s59, 8192
    s_waitcnt vmcnt(12)
    v_mfma_f32_16x16x32_bf16 v[40:43], v[128:131], a[24:27], v[40:43]
    buffer_load_dwordx4 a[16:19], v6, s[16:19], s51 offen offset:2048 sc1
    s_barrier
    v_add_u32 v24, s52, v26
    v_mfma_f32_16x16x32_bf16 v[44:47], v[128:131], a[28:31], v[44:47]
    v_add_u32 v25, s52, v27
    v_mfma_f32_16x16x32_bf16 v[60:63], v[132:135], a[28:31], v[60:63]
    ds_read_b64_tr_b16 v[128:129], v24 offset:0
    v_mfma_f32_16x16x32_bf16 v[56:59], v[132:135], a[24:27], v[56:59]
    ds_read_b64_tr_b16 v[130:131], v24 offset:512
    v_mfma_f32_16x16x32_bf16 v[72:75], v[136:139], a[24:27], v[72:75]
    ds_read_b64_tr_b16 v[132:133], v25 offset:0
    v_mfma_f32_16x16x32_bf16 v[76:79], v[136:139], a[28:31], v[76:79]
    ds_read_b64_tr_b16 v[134:135], v25 offset:512
    v_mfma_f32_16x16x32_bf16 v[92:95], v[140:143], a[28:31], v[92:95]
    ds_read_b64_tr_b16 v[136:137], v24 offset:8192
    buffer_load_dwordx4 a[20:23], v6, s[16:19], s51 offen offset:2304 sc1
    v_mfma_f32_16x16x32_bf16 v[88:91], v[140:143], a[24:27], v[88:91]
    ds_read_b64_tr_b16 v[138:139], v24 offset:8704
    v_mfma_f32_16x16x32_bf16 v[104:107], a[24:27], v[144:147], v[104:107]
    ds_read_b64_tr_b16 v[140:141], v25 offset:8192
    s_add_u32 s50, s50, 8192
    v_mfma_f32_16x16x32_bf16 v[108:111], a[28:31], v[144:147], v[108:111]
    ds_read_b64_tr_b16 v[142:143], v25 offset:8704
    s_add_u32 s51, s51, 8192
    v_mfma_f32_16x16x32_bf16 v[124:127], a[28:31], v[148:151], v[124:127]
    ds_read_b64_tr_b16 v[144:145], v24 offset:16384
    s_sub_u32 s54, s54, 1
    v_mfma_f32_16x16x32_bf16 v[120:123], a[24:27], v[148:151], v[120:123]
    ds_read_b64_tr_b16 v[146:147], v24 offset:16896
    s_cmp_lg_u32 s54, 0
    s_cbranch_scc1 c_qkvB_loop
    s_waitcnt vmcnt(12) lgkmcnt(8)
    v_mfma_f32_16x16x32_bf16 v[32:35], v[128:131], v[152:155], v[32:35]
    ds_read_b64_tr_b16 v[148:149], v25 offset:16384
    buffer_load_dwordx4 a[24:27], v6, s[20:23], s58 offen offset:0 sc1
    v_mfma_f32_16x16x32_bf16 v[36:39], v[128:131], v[156:159], v[36:39]
    ds_read_b64_tr_b16 v[150:151], v25 offset:16896
    s_waitcnt lgkmcnt(8)
    v_mfma_f32_16x16x32_bf16 v[52:55], v[132:135], v[156:159], v[52:55]
    ds_read_b32 v184, v8 offset:1280
    v_mfma_f32_16x16x32_bf16 v[48:51], v[132:135], v[152:155], v[48:51]
    ds_read_b32 v186, v8 offset:1344
    s_waitcnt lgkmcnt(8)
    v_mfma_f32_16x16x32_bf16 v[64:67], v[136:139], v[152:155], v[64:67]
    ds_read_b32 v188, v8 offset:1408
    v_mfma_f32_16x16x32_bf16 v[68:71], v[136:139], v[156:159], v[68:71]
    s_waitcnt lgkmcnt(7)
    v_mfma_f32_16x16x32_bf16 v[84:87], v[140:143], v[156:159], v[84:87]
    buffer_load_dwordx4 a[28:31], v6, s[20:23], s58 offen offset:256 sc1
    ds_read_b32 v190, v8 offset:1472
    v_mfma_f32_16x16x32_bf16 v[80:83], v[140:143], v[152:155], v[80:83]
    ds_read_b128 v[212:215], v10 offset:512
    s_waitcnt lgkmcnt(7)
    v_mfma_f32_16x16x32_bf16 v[96:99], v[152:155], v[144:147], v[96:99]
    ds_read_b128 v[216:219], v10 offset:576
    v_mfma_f32_16x16x32_bf16 v[100:103], v[156:159], v[144:147], v[100:103]
    s_waitcnt lgkmcnt(6)
    v_mfma_f32_16x16x32_bf16 v[116:119], v[156:159], v[148:151], v[116:119]
    v_mfma_f32_16x16x32_bf16 v[112:115], v[152:155], v[148:151], v[112:115]
    s_waitcnt vmcnt(12)
    v_mfma_f32_16x16x32_bf16 v[40:43], v[128:131], v[160:163], v[40:43]
    s_waitcnt lgkmcnt(0)
    v_fma_f32 v64, -v184, v212, v64
    v_fma_f32 v65, -v184, v213, v65
    v_mfma_f32_16x16x32_bf16 v[44:47], v[128:131], v[164:167], v[44:47]
    v_fma_f32 v66, -v184, v214, v66
    v_mfma_f32_16x16x32_bf16 v[60:63], v[132:135], v[164:167], v[60:63]
    ds_read_b64_tr_b16 v[128:129], v24 offset:2048
    v_fma_f32 v67, -v184, v215, v67
    v_mfma_f32_16x16x32_bf16 v[56:59], v[132:135], v[160:163], v[56:59]
    ds_read_b64_tr_b16 v[130:131], v24 offset:2560
    v_fma_f32 v68, -v186, v212, v68
    v_fma_f32 v69, -v186, v213, v69
    v_mfma_f32_16x16x32_bf16 v[72:75], v[136:139], v[160:163], v[72:75]
    ds_read_b64_tr_b16 v[132:133], v25 offset:2048
    v_fma_f32 v70, -v186, v214, v70
    v_mfma_f32_16x16x32_bf16 v[76:79], v[136:139], v[164:167], v[76:79]
    ds_read_b64_tr_b16 v[134:135], v25 offset:2560
    v_fma_f32 v71, -v186, v215, v71
    v_mfma_f32_16x16x32_bf16 v[92:95], v[140:143], v[164:167], v[92:95]
    ds_read_b64_tr_b16 v[136:137], v24 offset:10240
    v_fma_f32 v80, -v184, v216, v80
    v_fma_f32 v81, -v184, v217, v81
    v_mfma_f32_16x16x32_bf16 v[88:91], v[140:143], v[160:163], v[88:91]
    ds_read_b64_tr_b16 v[138:139], v24 offset:10752
    v_fma_f32 v82, -v184, v218, v82
    v_mfma_f32_16x16x32_bf16 v[104:107], v[160:163], v[144:147], v[104:107]
    ds_read_b64_tr_b16 v[140:141], v25 offset:10240
    v_fma_f32 v83, -v184, v219, v83
    v_mfma_f32_16x16x32_bf16 v[108:111], v[164:167], v[144:147], v[108:111]
    ds_read_b64_tr_b16 v[142:143], v25 offset:10752
    v_fma_f32 v84, -v186, v216, v84
    v_fma_f32 v85, -v186, v217, v85
    v_mfma_f32_16x16x32_bf16 v[124:127], v[164:167], v[148:151], v[124:127]
    ds_read_b64_tr_b16 v[144:145], v24 offset:18432
    v_fma_f32 v86, -v186, v218, v86
    v_mfma_f32_16x16x32_bf16 v[120:123], v[160:163], v[148:151], v[120:123]
    ds_read_b64_tr_b16 v[146:147], v24 offset:18944
    v_fma_f32 v87, -v186, v219, v87
    s_waitcnt vmcnt(10) lgkmcnt(8)
    v_mfma_f32_16x16x32_bf16 v[32:35], v[128:131], v[168:171], v[32:35]
    ds_read_b64_tr_b16 v[148:149], v25 offset:18432
    v_fma_f32 v72, -v188, v212, v72
    v_fma_f32 v73, -v188, v213, v73
    v_mfma_f32_16x16x32_bf16 v[36:39], v[128:131], v[172:175], v[36:39]
    ds_read_b64_tr_b16 v[150:151], v25 offset:18944
    v_fma_f32 v74, -v188, v214, v74
    s_waitcnt lgkmcnt(8)
    v_mfma_f32_16x16x32_bf16 v[52:55], v[132:135], v[172:175], v[52:55]
    v_fma_f32 v75, -v188, v215, v75
    ds_read_b128 v[152:155], v10 offset:384
    v_mfma_f32_16x16x32_bf16 v[48:51], v[132:135], v[168:171], v[48:51]
    v_fma_f32 v76, -v190, v212, v76
    v_fma_f32 v77, -v190, v213, v77
    ds_read_b128 v[156:159], v10 offset:448
    s_waitcnt lgkmcnt(8)
    v_mfma_f32_16x16x32_bf16 v[64:67], v[136:139], v[168:171], v[64:67]
    v_fma_f32 v78, -v190, v214, v78
    ds_read_b32 v185, v8 offset:2816
    v_mfma_f32_16x16x32_bf16 v[68:71], v[136:139], v[172:175], v[68:71]
    v_fma_f32 v79, -v190, v215, v79
    s_waitcnt lgkmcnt(7)
    v_mfma_f32_16x16x32_bf16 v[84:87], v[140:143], v[172:175], v[84:87]
    v_fma_f32 v88, -v188, v216, v88
    v_fma_f32 v89, -v188, v217, v89
    ds_read_b32 v187, v8 offset:2880
    v_mfma_f32_16x16x32_bf16 v[80:83], v[140:143], v[168:171], v[80:83]
    v_fma_f32 v90, -v188, v218, v90
    ds_read_b32 v189, v8 offset:2944
    s_waitcnt lgkmcnt(7)
    v_mfma_f32_16x16x32_bf16 v[96:99], v[168:171], v[144:147], v[96:99]
    v_fma_f32 v91, -v188, v219, v91
    ds_read_b32 v191, v8 offset:3008
    v_mfma_f32_16x16x32_bf16 v[100:103], v[172:175], v[144:147], v[100:103]
    v_fma_f32 v92, -v190, v216, v92
    v_fma_f32 v93, -v190, v217, v93
    s_waitcnt lgkmcnt(6)
    v_mfma_f32_16x16x32_bf16 v[116:119], v[172:175], v[148:151], v[116:119]
    v_fma_f32 v94, -v190, v218, v94
    v_mfma_f32_16x16x32_bf16 v[112:115], v[168:171], v[148:151], v[112:115]
    v_fma_f32 v95, -v190, v219, v95
    s_waitcnt vmcnt(8)
    v_mfma_f32_16x16x32_bf16 v[40:43], v[128:131], v[176:179], v[40:43]
    s_waitcnt lgkmcnt(0)
    v_fma_f32 v32, -v184, v152, v32
    v_fma_f32 v33, -v184, v153, v33
    v_mfma_f32_16x16x32_bf16 v[44:47], v[128:131], v[180:183], v[44:47]
    v_fma_f32 v34, -v184, v154, v34
    v_mfma_f32_16x16x32_bf16 v[60:63], v[132:135], v[180:183], v[60:63]
    ds_read_b64_tr_b16 v[128:129], v24 offset:4096
    v_fma_f32 v35, -v184, v155, v35
    v_fma_f32 v36, -v186, v152, v36
    v_mfma_f32_16x16x32_bf16 v[56:59], v[132:135], v[176:179], v[56:59]
    ds_read_b64_tr_b16 v[130:131], v24 offset:4608
    v_fma_f32 v37, -v186, v153, v37
    v_mfma_f32_16x16x32_bf16 v[72:75], v[136:139], v[176:179], v[72:75]
    ds_read_b64_tr_b16 v[132:133], v25 offset:4096
    v_fma_f32 v38, -v186, v154, v38
    v_fma_f32 v39, -v186, v155, v39
    v_mfma_f32_16x16x32_bf16 v[76:79], v[136:139], v[180:183], v[76:79]
    ds_read_b64_tr_b16 v[134:135], v25 offset:4608
    v_fma_f32 v48, -v184, v156, v48
    v_mfma_f32_16x16x32_bf16 v[92:95], v[140:143], v[180:183], v[92:95]
    ds_read_b64_tr_b16 v[136:137], v24 offset:12288
    v_fma_f32 v49, -v184, v157, v49
    v_fma_f32 v50, -v184, v158, v50
    v_mfma_f32_16x16x32_bf16 v[88:91], v[140:143], v[176:179], v[88:91]
    ds_read_b64_tr_b16 v[138:139], v24 offset:12800
    v_fma_f32 v51, -v184, v159, v51
    v_mfma_f32_16x16x32_bf16 v[104:107], v[176:179], v[144:147], v[104:107]
    ds_read_b64_tr_b16 v[140:141], v25 offset:12288
    v_fma_f32 v52, -v186, v156, v52
    v_fma_f32 v53, -v186, v157, v53
    v_mfma_f32_16x16x32_bf16 v[108:111], v[180:183], v[144:147], v[108:111]
    ds_read_b64_tr_b16 v[142:143], v25 offset:12800
    v_fma_f32 v54, -v186, v158, v54
    v_mfma_f32_16x16x32_bf16 v[124:127], v[180:183], v[148:151], v[124:127]
    ds_read_b64_tr_b16 v[144:145], v24 offset:20480
    v_fma_f32 v55, -v186, v159, v55
    v_mfma_f32_16x16x32_bf16 v[120:123], v[176:179], v[148:151], v[120:123]
    ds_read_b64_tr_b16 v[146:147], v24 offset:20992
    s_waitcnt vmcnt(6) lgkmcnt(8)
    v_mfma_f32_16x16x32_bf16 v[32:35], v[128:131], a[0:3], v[32:35]
    ds_read_b64_tr_b16 v[148:149], v25 offset:20480
    v_fma_f32 v40, -v188, v152, v40
    v_fma_f32 v41, -v188, v153, v41
    v_mfma_f32_16x16x32_bf16 v[36:39], v[128:131], a[4:7], v[36:39]
    ds_read_b64_tr_b16 v[150:151], v25 offset:20992
    v_fma_f32 v42, -v188, v154, v42
    s_waitcnt lgkmcnt(8)
    v_mfma_f32_16x16x32_bf16 v[52:55], v[132:135], a[4:7], v[52:55]
    v_fma_f32 v43, -v188, v155, v43
    v_fma_f32 v44, -v190, v152, v44
    ds_read_b128 v[168:171], v9 offset:1280
    v_mfma_f32_16x16x32_bf16 v[48:51], v[132:135], a[0:3], v[48:51]
    v_fma_f32 v45, -v190, v153, v45
    ds_read_b128 v[172:175], v9 offset:1344
    s_waitcnt lgkmcnt(8)
    v_mfma_f32_16x16x32_bf16 v[64:67], v[136:139], a[0:3], v[64:67]
    v_fma_f32 v46, -v190, v154, v46
    v_fma_f32 v47, -v190, v155, v47
    v_mfma_f32_16x16x32_bf16 v[68:71], v[136:139], a[4:7], v[68:71]
    v_fma_f32 v56, -v188, v156, v56
    ds_read_b128 v[176:179], v9 offset:1408
    s_waitcnt lgkmcnt(7)
    v_mfma_f32_16x16x32_bf16 v[84:87], v[140:143], a[4:7], v[84:87]
    v_fma_f32 v57, -v188, v157, v57
    v_fma_f32 v58, -v188, v158, v58
    ds_read_b128 v[180:183], v9 offset:1472
    v_mfma_f32_16x16x32_bf16 v[80:83], v[140:143], a[0:3], v[80:83]
    v_fma_f32 v59, -v188, v159, v59
    s_waitcnt lgkmcnt(6)
    v_mfma_f32_16x16x32_bf16 v[96:99], a[0:3], v[144:147], v[96:99]
    v_fma_f32 v60, -v190, v156, v60
    v_fma_f32 v61, -v190, v157, v61
    ds_read2_b32 v[220:221], v11 offset0:160 offset1:176
    v_mfma_f32_16x16x32_bf16 v[100:103], a[4:7], v[144:147], v[100:103]
    v_fma_f32 v62, -v190, v158, v62
    s_waitcnt lgkmcnt(5)
    v_mfma_f32_16x16x32_bf16 v[116:119], a[4:7], v[148:151], v[116:119]
    v_fma_f32 v63, -v190, v159, v63
    v_mfma_f32_16x16x32_bf16 v[112:115], a[0:3], v[148:151], v[112:115]
    s_waitcnt vmcnt(4)
    v_mfma_f32_16x16x32_bf16 v[40:43], v[128:131], a[8:11], v[40:43]
    v_mfma_f32_16x16x32_bf16 v[44:47], v[128:131], a[12:15], v[44:47]
    s_waitcnt lgkmcnt(0)
    v_fma_f32 v96, -v168, v220, v96
    v_fma_f32 v97, -v169, v220, v97
    v_mfma_f32_16x16x32_bf16 v[60:63], v[132:135], a[12:15], v[60:63]
    ds_read_b64_tr_b16 v[128:129], v24 offset:6144
    v_fma_f32 v98, -v170, v220, v98
    v_mfma_f32_16x16x32_bf16 v[56:59], v[132:135], a[8:11], v[56:59]
    ds_read_b64_tr_b16 v[130:131], v24 offset:6656
    v_fma_f32 v99, -v171, v220, v99
    v_fma_f32 v100, -v172, v220, v100
    v_mfma_f32_16x16x32_bf16 v[72:75], v[136:139], a[8:11], v[72:75]
    ds_read_b64_tr_b16 v[132:133], v25 offset:6144
    v_fma_f32 v101, -v173, v220, v101
    v_mfma_f32_16x16x32_bf16 v[76:79], v[136:139], a[12:15], v[76:79]
    ds_read_b64_tr_b16 v[134:135], v25 offset:6656
    v_fma_f32 v102, -v174, v220, v102
    v_fma_f32 v103, -v175, v220, v103
    v_mfma_f32_16x16x32_bf16 v[92:95], v[140:143], a[12:15], v[92:95]
    ds_read_b64_tr_b16 v[136:137], v24 offset:14336
    v_fma_f32 v112, -v168, v221, v112
    v_mfma_f32_16x16x32_bf16 v[88:91], v[140:143], a[8:11], v[88:91]
    ds_read_b64_tr_b16 v[138:139], v24 offset:14848
    v_fma_f32 v113, -v169, v221, v113
    v_fma_f32 v114, -v170, v221, v114
    v_mfma_f32_16x16x32_bf16 v[104:107], a[8:11], v[144:147], v[104:107]
    ds_read_b64_tr_b16 v[140:141], v25 offset:14336
    v_fma_f32 v115, -v171, v221, v115
    v_mfma_f32_16x16x32_bf16 v[108:111], a[12:15], v[144:147], v[108:111]
    ds_read_b64_tr_b16 v[142:143], v25 offset:14848
    v_fma_f32 v116, -v172, v221, v116
    v_fma_f32 v117, -v173, v221, v117
    v_mfma_f32_16x16x32_bf16 v[124:127], a[12:15], v[148:151], v[124:127]
    ds_read_b64_tr_b16 v[144:145], v24 offset:22528
    v_fma_f32 v118, -v174, v221, v118
    v_mfma_f32_16x16x32_bf16 v[120:123], a[8:11], v[148:151], v[120:123]
    ds_read_b64_tr_b16 v[146:147], v24 offset:23040
    v_fma_f32 v119, -v175, v221, v119
    s_waitcnt vmcnt(2) lgkmcnt(8)
    v_mfma_f32_16x16x32_bf16 v[32:35], v[128:131], a[16:19], v[32:35]
    ds_read_b64_tr_b16 v[148:149], v25 offset:22528
    v_mfma_f32_16x16x32_bf16 v[36:39], v[128:131], a[20:23], v[36:39]
    ds_read_b64_tr_b16 v[150:151], v25 offset:23040
    v_fma_f32 v104, -v176, v220, v104
    v_fma_f32 v105, -v177, v220, v105
    s_waitcnt lgkmcnt(8)
    v_mfma_f32_16x16x32_bf16 v[52:55], v[132:135], a[20:23], v[52:55]
    v_fma_f32 v106, -v178, v220, v106
    ds_read_b128 v[152:155], v9 offset:2816
    v_mfma_f32_16x16x32_bf16 v[48:51], v[132:135], a[16:19], v[48:51]
    v_fma_f32 v107, -v179, v220, v107
    v_fma_f32 v108, -v180, v220, v108
    s_waitcnt lgkmcnt(7)
    v_mfma_f32_16x16x32_bf16 v[64:67], v[136:139], a[16:19], v[64:67]
    v_fma_f32 v109, -v181, v220, v109
    ds_read_b128 v[156:159], v9 offset:2880
    v_mfma_f32_16x16x32_bf16 v[68:71], v[136:139], a[20:23], v[68:71]
    v_fma_f32 v110, -v182, v220, v110
    v_fma_f32 v111, -v183, v220, v111
    s_waitcnt lgkmcnt(6)
    v_mfma_f32_16x16x32_bf16 v[84:87], v[140:143], a[20:23], v[84:87]
    v_fma_f32 v120, -v176, v221, v120
    ds_read_b128 v[160:163], v9 offset:2944
    v_mfma_f32_16x16x32_bf16 v[80:83], v[140:143], a[16:19], v[80:83]
    v_fma_f32 v121, -v177, v221, v121
    v_fma_f32 v122, -v178, v221, v122
    s_waitcnt lgkmcnt(5)
    v_mfma_f32_16x16x32_bf16 v[96:99], a[16:19], v[144:147], v[96:99]
    v_fma_f32 v123, -v179, v221, v123
    ds_read_b128 v[164:167], v9 offset:3008
    v_mfma_f32_16x16x32_bf16 v[100:103], a[20:23], v[144:147], v[100:103]
    v_fma_f32 v124, -v180, v221, v124
    v_fma_f32 v125, -v181, v221, v125
    s_waitcnt lgkmcnt(4)
    v_mfma_f32_16x16x32_bf16 v[116:119], a[20:23], v[148:151], v[116:119]
    v_fma_f32 v126, -v182, v221, v126
    v_mfma_f32_16x16x32_bf16 v[112:115], a[16:19], v[148:151], v[112:115]
    v_fma_f32 v127, -v183, v221, v127
    s_waitcnt vmcnt(0)
    v_mfma_f32_16x16x32_bf16 v[40:43], v[128:131], a[24:27], v[40:43]
    v_mul_f32 v64, v185, v64
    v_mul_f32 v65, v185, v65
    s_barrier
    v_mfma_f32_16x16x32_bf16 v[44:47], v[128:131], a[28:31], v[44:47]
    v_mul_f32 v66, v185, v66
    v_mul_f32 v67, v185, v67
    v_mfma_f32_16x16x32_bf16 v[60:63], v[132:135], a[28:31], v[60:63]
    v_mul_f32 v80, v185, v80
    v_mul_f32 v81, v185, v81
    v_mfma_f32_16x16x32_bf16 v[56:59], v[132:135], a[24:27], v[56:59]
    v_mul_f32 v82, v185, v82
    v_mul_f32 v83, v185, v83
    v_mfma_f32_16x16x32_bf16 v[72:75], v[136:139], a[24:27], v[72:75]
    v_cvt_pk_bf16_f32 v64, v64, v65
    v_cvt_pk_bf16_f32 v65, v66, v67
    v_mfma_f32_16x16x32_bf16 v[76:79], v[136:139], a[28:31], v[76:79]
    v_cvt_pk_bf16_f32 v66, v80, v81
    v_cvt_pk_bf16_f32 v67, v82, v83
    v_mfma_f32_16x16x32_bf16 v[92:95], v[140:143], a[28:31], v[92:95]
    v_mul_f32 v68, v187, v68
    v_mul_f32 v69, v187, v69
    v_mfma_f32_16x16x32_bf16 v[88:91], v[140:143], a[24:27], v[88:91]
    v_mul_f32 v70, v187, v70
    v_mul_f32 v71, v187, v71
    v_mfma_f32_16x16x32_bf16 v[104:107], a[24:27], v[144:147], v[104:107]
    v_mul_f32 v84, v187, v84
    v_mul_f32 v85, v187, v85
    v_mfma_f32_16x16x32_bf16 v[108:111], a[28:31], v[144:147], v[108:111]
    v_mul_f32 v86, v187, v86
    v_mul_f32 v87, v187, v87
    v_mfma_f32_16x16x32_bf16 v[124:127], a[28:31], v[148:151], v[124:127]
    v_cvt_pk_bf16_f32 v68, v68, v69
    v_cvt_pk_bf16_f32 v69, v70, v71
    v_mfma_f32_16x16x32_bf16 v[120:123], a[24:27], v[148:151], v[120:123]
    v_cvt_pk_bf16_f32 v70, v84, v85
    v_cvt_pk_bf16_f32 v71, v86, v87
    ds_write_b128 v12, v[64:67] offset:0
    ds_write_b128 v12, v[68:71] offset:256
    v_pk_mul_f32 v[72:73], v[188:189], v[72:73] op_sel:[1,0] op_sel_hi:[1,1]
    v_pk_mul_f32 v[74:75], v[188:189], v[74:75] op_sel:[1,0] op_sel_hi:[1,1]
    v_pk_mul_f32 v[88:89], v[188:189], v[88:89] op_sel:[1,0] op_sel_hi:[1,1]
    v_pk_mul_f32 v[90:91], v[188:189], v[90:91] op_sel:[1,0] op_sel_hi:[1,1]
    v_cvt_pk_bf16_f32 v72, v72, v73
    v_cvt_pk_bf16_f32 v73, v74, v75
    v_cvt_pk_bf16_f32 v74, v88, v89
    v_cvt_pk_bf16_f32 v75, v90, v91
    ds_write_b128 v12, v[72:75] offset:2048
    v_pk_mul_f32 v[76:77], v[190:191], v[76:77] op_sel:[1,0] op_sel_hi:[1,1]
    v_pk_mul_f32 v[78:79], v[190:191], v[78:79] op_sel:[1,0] op_sel_hi:[1,1]
    v_pk_mul_f32 v[92:93], v[190:191], v[92:93] op_sel:[1,0] op_sel_hi:[1,1]
    v_pk_mul_f32 v[94:95], v[190:191], v[94:95] op_sel:[1,0] op_sel_hi:[1,1]
    v_cvt_pk_bf16_f32 v76, v76, v77
    v_cvt_pk_bf16_f32 v77, v78, v79
    v_cvt_pk_bf16_f32 v78, v92, v93
    v_cvt_pk_bf16_f32 v79, v94, v95
    ds_write_b128 v12, v[76:79] offset:2304
    s_waitcnt lgkmcnt(4)
    v_pk_mul_f32 v[96:97], v[152:153], v[96:97]
    v_pk_mul_f32 v[98:99], v[154:155], v[98:99]
    v_pk_mul_f32 v[112:113], v[152:153], v[112:113]
    v_pk_mul_f32 v[114:115], v[154:155], v[114:115]
    v_cvt_pk_bf16_f32 v96, v96, v97
    v_cvt_pk_bf16_f32 v97, v98, v99
    v_cvt_pk_bf16_f32 v98, v112, v113
    v_cvt_pk_bf16_f32 v99, v114, v115
    v_mul_f32 v185, 0x3e8293ee, v185
    v_permlane16_swap_b32 v96, v98
    v_permlane16_swap_b32 v97, v99
    ds_write_b128 v13, v[96:99] offset:8192
    v_pk_mul_f32 v[100:101], v[156:157], v[100:101]
    v_pk_mul_f32 v[102:103], v[158:159], v[102:103]
    v_pk_mul_f32 v[116:117], v[156:157], v[116:117]
    v_pk_mul_f32 v[118:119], v[158:159], v[118:119]
    v_cvt_pk_bf16_f32 v100, v100, v101
    v_cvt_pk_bf16_f32 v101, v102, v103
    v_cvt_pk_bf16_f32 v102, v116, v117
    v_cvt_pk_bf16_f32 v103, v118, v119
    v_mul_f32 v187, 0x3e8293ee, v187
    v_permlane16_swap_b32 v100, v102
    v_permlane16_swap_b32 v101, v103
    ds_write_b128 v13, v[100:103] offset:9216
    v_pk_mul_f32 v[104:105], v[160:161], v[104:105]
    v_pk_mul_f32 v[106:107], v[162:163], v[106:107]
    v_pk_mul_f32 v[120:121], v[160:161], v[120:121]
    v_pk_mul_f32 v[122:123], v[162:163], v[122:123]
    v_cvt_pk_bf16_f32 v104, v104, v105
    v_cvt_pk_bf16_f32 v105, v106, v107
    v_cvt_pk_bf16_f32 v106, v120, v121
    v_cvt_pk_bf16_f32 v107, v122, v123
    v_mul_f32 v189, 0x3e8293ee, v189
    v_permlane16_swap_b32 v104, v106
    v_permlane16_swap_b32 v105, v107
    ds_write_b128 v13, v[104:107] offset:10240
    v_pk_mul_f32 v[108:109], v[164:165], v[108:109]
    v_pk_mul_f32 v[110:111], v[166:167], v[110:111]
    v_pk_mul_f32 v[124:125], v[164:165], v[124:125]
    v_pk_mul_f32 v[126:127], v[166:167], v[126:127]
    v_cvt_pk_bf16_f32 v108, v108, v109
    v_cvt_pk_bf16_f32 v109, v110, v111
    v_cvt_pk_bf16_f32 v110, v124, v125
    v_cvt_pk_bf16_f32 v111, v126, v127
    v_mul_f32 v191, 0x3e8293ee, v191
    v_permlane16_swap_b32 v108, v110
    v_permlane16_swap_b32 v109, v111
    ds_write_b128 v13, v[108:111] offset:11264
    v_add_u32 v24, 81920, v5
    s_waitcnt lgkmcnt(0)
    s_barrier
    ds_read_b128 v[128:131], v24 offset:0
    ds_read_b128 v[132:135], v24 offset:1024
    ds_read_b128 v[136:139], v24 offset:2048
    ds_read_b128 v[140:143], v24 offset:3072
    v_pk_mul_f32 v[32:33], v[184:185], v[32:33] op_sel:[1,0] op_sel_hi:[1,1]
    v_pk_mul_f32 v[34:35], v[184:185], v[34:35] op_sel:[1,0] op_sel_hi:[1,1]
    v_pk_mul_f32 v[48:49], v[184:185], v[48:49] op_sel:[1,0] op_sel_hi:[1,1]
    v_pk_mul_f32 v[50:51], v[184:185], v[50:51] op_sel:[1,0] op_sel_hi:[1,1]
    v_cvt_pk_bf16_f32 v8, v32, v33
    v_cvt_pk_bf16_f32 v9, v34, v35
    v_cvt_pk_bf16_f32 v10, v48, v49
    v_cvt_pk_bf16_f32 v11, v50, v51
    v_pk_mul_f32 v[36:37], v[186:187], v[36:37] op_sel:[1,0] op_sel_hi:[1,1]
    v_pk_mul_f32 v[38:39], v[186:187], v[38:39] op_sel:[1,0] op_sel_hi:[1,1]
    v_pk_mul_f32 v[52:53], v[186:187], v[52:53] op_sel:[1,0] op_sel_hi:[1,1]
    v_pk_mul_f32 v[54:55], v[186:187], v[54:55] op_sel:[1,0] op_sel_hi:[1,1]
    v_cvt_pk_bf16_f32 v12, v36, v37
    v_cvt_pk_bf16_f32 v13, v38, v39
    v_cvt_pk_bf16_f32 v14, v52, v53
    v_cvt_pk_bf16_f32 v15, v54, v55
    v_pk_mul_f32 v[40:41], v[188:189], v[40:41] op_sel:[1,0] op_sel_hi:[1,1]
    v_pk_mul_f32 v[42:43], v[188:189], v[42:43] op_sel:[1,0] op_sel_hi:[1,1]
    v_pk_mul_f32 v[56:57], v[188:189], v[56:57] op_sel:[1,0] op_sel_hi:[1,1]
    v_pk_mul_f32 v[58:59], v[188:189], v[58:59] op_sel:[1,0] op_sel_hi:[1,1]
    v_cvt_pk_bf16_f32 v16, v40, v41
    v_cvt_pk_bf16_f32 v17, v42, v43
    v_cvt_pk_bf16_f32 v18, v56, v57
    v_cvt_pk_bf16_f32 v19, v58, v59
    v_pk_mul_f32 v[44:45], v[190:191], v[44:45] op_sel:[1,0] op_sel_hi:[1,1]
    v_pk_mul_f32 v[46:47], v[190:191], v[46:47] op_sel:[1,0] op_sel_hi:[1,1]
    v_pk_mul_f32 v[60:61], v[190:191], v[60:61] op_sel:[1,0] op_sel_hi:[1,1]
    v_pk_mul_f32 v[62:63], v[190:191], v[62:63] op_sel:[1,0] op_sel_hi:[1,1]
    v_cvt_pk_bf16_f32 v20, v44, v45
    v_cvt_pk_bf16_f32 v21, v46, v47
    v_cvt_pk_bf16_f32 v22, v60, v61
    v_cvt_pk_bf16_f32 v23, v62, v63
    v_permlane16_swap_b32 v8, v12
    v_permlane16_swap_b32 v9, v13
    v_permlane16_swap_b32 v10, v14
    v_permlane16_swap_b32 v11, v15
    v_permlane16_swap_b32 v16, v20
    v_permlane16_swap_b32 v17, v21
    v_permlane16_swap_b32 v18, v22
    v_permlane16_swap_b32 v19, v23
    s_waitcnt lgkmcnt(0)
    v_mfma_f32_32x32x16_bf16 v[64:79], v[128:131], v[8:11], 0
    v_mfma_f32_32x32x16_bf16 v[64:79], v[132:135], v[12:15], v[64:79]
    v_and_b32 v28, 7, v1
    v_mov_b32 v29, 0x3f803f80
    v_cmp_eq_u32 vcc, 0, v28
    s_nop 1
    v_cndmask_b32 v200, 0, v29, vcc
    v_cndmask_b32 v201, 0, v29, vcc
    v_cmp_eq_u32 vcc, 4, v28
    s_nop 1
    v_cndmask_b32 v202, 0, v29, vcc
    v_cndmask_b32 v203, 0, v29, vcc
    v_mov_b32 v204, 0xdddddddd
    v_mov_b32 v160, 0
    v_mov_b32 v161, 0
    v_mov_b32 v162, 0
    v_mov_b32 v163, 0
    v_mov_b32 v164, 0
    v_mov_b32 v165, 0
    v_mov_b32 v166, 0
    v_mov_b32 v167, 0
    v_mov_b32 v168, 0
    v_mov_b32 v169, 0
    v_mov_b32 v170, 0
    v_mov_b32 v171, 0
    v_mov_b32 v172, 0
    v_mov_b32 v173, 0
    v_mov_b32 v174, 0
    v_mov_b32 v175, 0
    v_mov_b32 v192, 0
    v_mov_b32 v193, 0
    v_mov_b32 v194, 0
    v_mov_b32 v195, 0
    v_mov_b32 v176, 0
    v_mov_b32 v177, 0
    v_mov_b32 v178, 0
    v_mov_b32 v179, 0
    v_mov_b32 v180, 0
    v_mov_b32 v181, 0
    v_mov_b32 v182, 0
    v_mov_b32 v183, 0
    v_mov_b32 v184, 0
    v_mov_b32 v185, 0
    v_mov_b32 v186, 0
    v_mov_b32 v187, 0
    v_mov_b32 v188, 0
    v_mov_b32 v189, 0
    v_mov_b32 v190, 0
    v_mov_b32 v191, 0
    v_mov_b32 v196, 0
    v_mov_b32 v197, 0
    v_mov_b32 v198, 0
    v_mov_b32 v199, 0
    v_mov_b32 v112, 0
    v_mov_b32 v113, 0
    v_mov_b32 v114, 0
    v_mov_b32 v115, 0
    v_mov_b32 v116, 0
    v_mov_b32 v117, 0
    v_mov_b32 v118, 0
    v_mov_b32 v119, 0
    v_mov_b32 v120, 0
    v_mov_b32 v121, 0
    v_mov_b32 v122, 0
    v_mov_b32 v123, 0
    v_mov_b32 v124, 0
    v_mov_b32 v125, 0
    v_mov_b32 v126, 0
    v_mov_b32 v127, 0
    v_mov_b32 v152, 0
    v_mov_b32 v153, 0
    v_mov_b32 v154, 0
    v_mov_b32 v155, 0
    v_mov_b32 v156, 0
    v_mov_b32 v157, 0
    v_mov_b32 v158, 0
    v_mov_b32 v159, 0
    s_mov_b32 s54, 4
.p2align 3
c_attn_loop:
    v_mfma_f32_32x32x16_bf16 v[80:95], v[128:131], v[16:19], 0
    v_exp_f32 v64, v64
    v_exp_f32 v65, v65
    v_exp_f32 v66, v66
    v_mfma_f32_32x32x16_bf16 v[80:95], v[132:135], v[20:23], v[80:95]
    v_exp_f32 v67, v67
    v_exp_f32 v68, v68
    v_exp_f32 v69, v69
    v_smfmac_f32_32x32x32_bf16 v[176:191], v[152:155], v[112:119], v204
    s_waitcnt lgkmcnt(0)
    v_exp_f32 v70, v70
    v_exp_f32 v71, v71
    v_exp_f32 v72, v72
    v_smfmac_f32_16x16x64_bf16 v[196:199], v[200:203], v[112:119], v204
    ds_read_b128 v[144:147], v24 offset:8192
    v_exp_f32 v73, v73
    v_exp_f32 v74, v74
    v_smfmac_f32_32x32x32_bf16 v[176:191], v[156:159], v[120:127], v204
    v_exp_f32 v75, v75
    v_exp_f32 v76, v76
    v_exp_f32 v77, v77
    v_smfmac_f32_16x16x64_bf16 v[196:199], v[200:203], v[120:127], v204
    ds_read_b128 v[148:151], v24 offset:9216
    v_exp_f32 v78, v78
    v_exp_f32 v79, v79
    v_mfma_f32_32x32x16_bf16 v[96:111], v[136:139], v[8:11], 0
    v_exp_f32 v80, v80
    v_exp_f32 v81, v81
    v_exp_f32 v82, v82
    v_mfma_f32_32x32x16_bf16 v[96:111], v[140:143], v[12:15], v[96:111]
    s_waitcnt lgkmcnt(1)
    v_exp_f32 v83, v83
    v_exp_f32 v84, v84
    v_exp_f32 v85, v85
    v_smfmac_f32_32x32x32_bf16 v[160:175], v[144:147], v[64:71], v204
    s_waitcnt lgkmcnt(0)
    v_exp_f32 v86, v86
    v_exp_f32 v87, v87
    v_exp_f32 v88, v88
    v_smfmac_f32_16x16x64_bf16 v[192:195], v[200:203], v[64:71], v204
    ds_read_b128 v[128:131], v24 offset:4096
    v_exp_f32 v89, v89
    v_exp_f32 v90, v90
    v_smfmac_f32_32x32x32_bf16 v[160:175], v[148:151], v[72:79], v204
    v_exp_f32 v91, v91
    v_exp_f32 v92, v92
    v_exp_f32 v93, v93
    v_smfmac_f32_16x16x64_bf16 v[192:195], v[200:203], v[72:79], v204
    ds_read_b128 v[132:135], v24 offset:5120
    v_exp_f32 v94, v94
    v_exp_f32 v95, v95
    v_mfma_f32_32x32x16_bf16 v[112:127], v[136:139], v[16:19], 0
    v_exp_f32 v96, v96
    v_exp_f32 v97, v97
    v_exp_f32 v98, v98
    v_mfma_f32_32x32x16_bf16 v[112:127], v[140:143], v[20:23], v[112:127]
    v_exp_f32 v99, v99
    v_exp_f32 v100, v100
    v_exp_f32 v101, v101
    v_smfmac_f32_32x32x32_bf16 v[176:191], v[144:147], v[80:87], v204
    s_waitcnt lgkmcnt(0)
    v_exp_f32 v102, v102
    v_exp_f32 v103, v103
    v_exp_f32 v104, v104
    v_smfmac_f32_16x16x64_bf16 v[196:199], v[200:203], v[80:87], v204
    ds_read_b128 v[152:155], v24 offset:10240
    v_exp_f32 v105, v105
    v_exp_f32 v106, v106
    v_smfmac_f32_32x32x32_bf16 v[176:191], v[148:151], v[88:95], v204
    v_exp_f32 v107, v107
    v_exp_f32 v108, v108
    v_exp_f32 v109, v109
    v_smfmac_f32_16x16x64_bf16 v[196:199], v[200:203], v[88:95], v204
    ds_read_b128 v[156:159], v24 offset:11264
    v_exp_f32 v110, v110
    v_exp_f32 v111, v111
    v_mfma_f32_32x32x16_bf16 v[64:79], v[128:131], v[8:11], 0
    v_exp_f32 v112, v112
    v_exp_f32 v113, v113
    v_exp_f32 v114, v114
    v_mfma_f32_32x32x16_bf16 v[64:79], v[132:135], v[12:15], v[64:79]
    s_waitcnt lgkmcnt(1)
    v_exp_f32 v115, v115
    v_exp_f32 v116, v116
    v_exp_f32 v117, v117
    v_smfmac_f32_32x32x32_bf16 v[160:175], v[152:155], v[96:103], v204
    s_waitcnt lgkmcnt(0)
    v_exp_f32 v118, v118
    v_exp_f32 v119, v119
    v_exp_f32 v120, v120
    v_smfmac_f32_16x16x64_bf16 v[192:195], v[200:203], v[96:103], v204
    ds_read_b128 v[136:139], v24 offset:6144
    v_exp_f32 v121, v121
    v_exp_f32 v122, v122
    v_smfmac_f32_32x32x32_bf16 v[160:175], v[156:159], v[104:111], v204
    v_exp_f32 v123, v123
    v_exp_f32 v124, v124
    v_exp_f32 v125, v125
    v_smfmac_f32_16x16x64_bf16 v[192:195], v[200:203], v[104:111], v204
    ds_read_b128 v[140:143], v24 offset:7168
    v_exp_f32 v126, v126
    v_exp_f32 v127, v127
    v_mfma_f32_32x32x16_bf16 v[80:95], v[128:131], v[16:19], 0
    s_cmp_eq_u32 s54, 4
    v_exp_f32 v64, v64
    v_exp_f32 v65, v65
    v_exp_f32 v66, v66
    v_mfma_f32_32x32x16_bf16 v[80:95], v[132:135], v[20:23], v[80:95]
    v_exp_f32 v67, v67
    v_exp_f32 v68, v68
    v_exp_f32 v69, v69
    v_smfmac_f32_32x32x32_bf16 v[176:191], v[152:155], v[112:119], v204
    s_waitcnt lgkmcnt(0)
    v_exp_f32 v70, v70
    v_exp_f32 v71, v71
    v_exp_f32 v72, v72
    v_smfmac_f32_16x16x64_bf16 v[196:199], v[200:203], v[112:119], v204
    ds_read_b128 v[144:147], v24 offset:12288
    v_exp_f32 v73, v73
    v_exp_f32 v74, v74
    v_smfmac_f32_32x32x32_bf16 v[176:191], v[156:159], v[120:127], v204
    v_exp_f32 v75, v75
    v_exp_f32 v76, v76
    v_exp_f32 v77, v77
    v_smfmac_f32_16x16x64_bf16 v[196:199], v[200:203], v[120:127], v204
    ds_read_b128 v[148:151], v24 offset:13312
    v_exp_f32 v78, v78
    v_exp_f32 v79, v79
    v_mfma_f32_32x32x16_bf16 v[96:111], v[136:139], v[8:11], 0
    s_cbranch_scc1 c_attn_nobar
    s_barrier
c_attn_nobar:
    v_exp_f32 v80, v80
    v_exp_f32 v81, v81
    v_exp_f32 v82, v82
    v_mfma_f32_32x32x16_bf16 v[96:111], v[140:143], v[12:15], v[96:111]
    s_waitcnt lgkmcnt(1)
    v_exp_f32 v83, v83
    v_exp_f32 v84, v84
    v_exp_f32 v85, v85
    v_smfmac_f32_32x32x32_bf16 v[160:175], v[144:147], v[64:71], v204
    s_waitcnt lgkmcnt(0)
    v_exp_f32 v86, v86
    v_exp_f32 v87, v87
    v_exp_f32 v88, v88
    v_smfmac_f32_16x16x64_bf16 v[192:195], v[200:203], v[64:71], v204
    ds_read_b128 v[128:131], v24 offset:16384
    v_exp_f32 v89, v89
    v_exp_f32 v90, v90
    v_smfmac_f32_32x32x32_bf16 v[160:175], v[148:151], v[72:79], v204
    v_exp_f32 v91, v91
    v_exp_f32 v92, v92
    v_exp_f32 v93, v93
    v_smfmac_f32_16x16x64_bf16 v[192:195], v[200:203], v[72:79], v204
    ds_read_b128 v[132:135], v24 offset:17408
    v_exp_f32 v94, v94
    v_exp_f32 v95, v95
    v_mfma_f32_32x32x16_bf16 v[112:127], v[136:139], v[16:19], 0
    v_exp_f32 v96, v96
    v_exp_f32 v97, v97
    v_exp_f32 v98, v98
    v_mfma_f32_32x32x16_bf16 v[112:127], v[140:143], v[20:23], v[112:127]
    v_exp_f32 v99, v99
    v_exp_f32 v100, v100
    v_exp_f32 v101, v101
    v_smfmac_f32_32x32x32_bf16 v[176:191], v[144:147], v[80:87], v204
    s_waitcnt lgkmcnt(0)
    v_exp_f32 v102, v102
    v_exp_f32 v103, v103
    v_exp_f32 v104, v104
    v_smfmac_f32_16x16x64_bf16 v[196:199], v[200:203], v[80:87], v204
    ds_read_b128 v[152:155], v24 offset:14336
    v_exp_f32 v105, v105
    v_exp_f32 v106, v106
    v_smfmac_f32_32x32x32_bf16 v[176:191], v[148:151], v[88:95], v204
    v_exp_f32 v107, v107
    v_exp_f32 v108, v108
    v_exp_f32 v109, v109
    v_smfmac_f32_16x16x64_bf16 v[196:199], v[200:203], v[88:95], v204
    ds_read_b128 v[156:159], v24 offset:15360
    v_exp_f32 v110, v110
    v_exp_f32 v111, v111
    v_mfma_f32_32x32x16_bf16 v[64:79], v[128:131], v[8:11], 0
    v_exp_f32 v112, v112
    v_exp_f32 v113, v113
    v_exp_f32 v114, v114
    v_mfma_f32_32x32x16_bf16 v[64:79], v[132:135], v[12:15], v[64:79]
    s_waitcnt lgkmcnt(1)
    v_exp_f32 v115, v115
    v_exp_f32 v116, v116
    v_exp_f32 v117, v117
    v_smfmac_f32_32x32x32_bf16 v[160:175], v[152:155], v[96:103], v204
    s_waitcnt lgkmcnt(0)
    v_exp_f32 v118, v118
    v_exp_f32 v119, v119
    v_exp_f32 v120, v120
    v_smfmac_f32_16x16x64_bf16 v[192:195], v[200:203], v[96:103], v204
    ds_read_b128 v[136:139], v24 offset:18432
    v_exp_f32 v121, v121
    v_exp_f32 v122, v122
    v_smfmac_f32_32x32x32_bf16 v[160:175], v[156:159], v[104:111], v204
    v_exp_f32 v123, v123
    v_exp_f32 v124, v124
    v_exp_f32 v125, v125
    v_smfmac_f32_16x16x64_bf16 v[192:195], v[200:203], v[104:111], v204
    ds_read_b128 v[140:143], v24 offset:19456
    v_exp_f32 v126, v126
    v_exp_f32 v127, v127
    v_mfma_f32_32x32x16_bf16 v[80:95], v[128:131], v[16:19], 0
    v_exp_f32 v64, v64
    v_exp_f32 v65, v65
    v_exp_f32 v66, v66
    v_mfma_f32_32x32x16_bf16 v[80:95], v[132:135], v[20:23], v[80:95]
    v_exp_f32 v67, v67
    v_exp_f32 v68, v68
    v_exp_f32 v69, v69
    v_smfmac_f32_32x32x32_bf16 v[176:191], v[152:155], v[112:119], v204
    s_waitcnt lgkmcnt(0)
    v_exp_f32 v70, v70
    v_exp_f32 v71, v71
    v_exp_f32 v72, v72
    v_smfmac_f32_16x16x64_bf16 v[196:199], v[200:203], v[112:119], v204
    ds_read_b128 v[144:147], v24 offset:24576
    v_exp_f32 v73, v73
    v_exp_f32 v74, v74
    v_smfmac_f32_32x32x32_bf16 v[176:191], v[156:159], v[120:127], v204
    v_exp_f32 v75, v75
    v_exp_f32 v76, v76
    v_exp_f32 v77, v77
    v_smfmac_f32_16x16x64_bf16 v[196:199], v[200:203], v[120:127], v204
    ds_read_b128 v[148:151], v24 offset:25600
    v_exp_f32 v78, v78
    v_exp_f32 v79, v79
    v_mfma_f32_32x32x16_bf16 v[96:111], v[136:139], v[8:11], 0
    v_exp_f32 v80, v80
    v_exp_f32 v81, v81
    v_exp_f32 v82, v82
    v_mfma_f32_32x32x16_bf16 v[96:111], v[140:143], v[12:15], v[96:111]
    s_waitcnt lgkmcnt(1)
    v_exp_f32 v83, v83
    v_exp_f32 v84, v84
    v_exp_f32 v85, v85
    v_smfmac_f32_32x32x32_bf16 v[160:175], v[144:147], v[64:71], v204
    s_waitcnt lgkmcnt(0)
    v_exp_f32 v86, v86
    v_exp_f32 v87, v87
    v_exp_f32 v88, v88
    v_smfmac_f32_16x16x64_bf16 v[192:195], v[200:203], v[64:71], v204
    ds_read_b128 v[128:131], v24 offset:20480
    v_exp_f32 v89, v89
    v_exp_f32 v90, v90
    v_smfmac_f32_32x32x32_bf16 v[160:175], v[148:151], v[72:79], v204
    v_exp_f32 v91, v91
    v_exp_f32 v92, v92
    v_exp_f32 v93, v93
    v_smfmac_f32_16x16x64_bf16 v[192:195], v[200:203], v[72:79], v204
    ds_read_b128 v[132:135], v24 offset:21504
    v_exp_f32 v94, v94
    v_exp_f32 v95, v95
    v_mfma_f32_32x32x16_bf16 v[112:127], v[136:139], v[16:19], 0
    v_exp_f32 v96, v96
    v_exp_f32 v97, v97
    v_exp_f32 v98, v98
    v_mfma_f32_32x32x16_bf16 v[112:127], v[140:143], v[20:23], v[112:127]
    v_exp_f32 v99, v99
    v_exp_f32 v100, v100
    v_exp_f32 v101, v101
    v_smfmac_f32_32x32x32_bf16 v[176:191], v[144:147], v[80:87], v204
    s_waitcnt lgkmcnt(0)
    v_exp_f32 v102, v102
    v_exp_f32 v103, v103
    v_exp_f32 v104, v104
    v_smfmac_f32_16x16x64_bf16 v[196:199], v[200:203], v[80:87], v204
    ds_read_b128 v[152:155], v24 offset:26624
    v_exp_f32 v105, v105
    v_exp_f32 v106, v106
    v_smfmac_f32_32x32x32_bf16 v[176:191], v[148:151], v[88:95], v204
    v_exp_f32 v107, v107
    v_exp_f32 v108, v108
    v_exp_f32 v109, v109
    v_smfmac_f32_16x16x64_bf16 v[196:199], v[200:203], v[88:95], v204
    ds_read_b128 v[156:159], v24 offset:27648
    v_exp_f32 v110, v110
    v_exp_f32 v111, v111
    v_mfma_f32_32x32x16_bf16 v[64:79], v[128:131], v[8:11], 0
    v_exp_f32 v112, v112
    v_exp_f32 v113, v113
    v_exp_f32 v114, v114
    v_mfma_f32_32x32x16_bf16 v[64:79], v[132:135], v[12:15], v[64:79]
    s_waitcnt lgkmcnt(1)
    v_exp_f32 v115, v115
    v_exp_f32 v116, v116
    v_exp_f32 v117, v117
    v_smfmac_f32_32x32x32_bf16 v[160:175], v[152:155], v[96:103], v204
    s_waitcnt lgkmcnt(0)
    v_exp_f32 v118, v118
    v_exp_f32 v119, v119
    v_exp_f32 v120, v120
    v_smfmac_f32_16x16x64_bf16 v[192:195], v[200:203], v[96:103], v204
    ds_read_b128 v[136:139], v24 offset:22528
    v_exp_f32 v121, v121
    v_exp_f32 v122, v122
    v_smfmac_f32_32x32x32_bf16 v[160:175], v[156:159], v[104:111], v204
    v_exp_f32 v123, v123
    v_exp_f32 v124, v124
    v_exp_f32 v125, v125
    v_smfmac_f32_16x16x64_bf16 v[192:195], v[200:203], v[104:111], v204
    ds_read_b128 v[140:143], v24 offset:23552
    v_exp_f32 v126, v126
    v_exp_f32 v127, v127
    v_mfma_f32_32x32x16_bf16 v[80:95], v[128:131], v[16:19], 0
    v_exp_f32 v64, v64
    v_exp_f32 v65, v65
    v_exp_f32 v66, v66
    v_mfma_f32_32x32x16_bf16 v[80:95], v[132:135], v[20:23], v[80:95]
    v_exp_f32 v67, v67
    v_exp_f32 v68, v68
    v_exp_f32 v69, v69
    v_smfmac_f32_32x32x32_bf16 v[176:191], v[152:155], v[112:119], v204
    s_waitcnt lgkmcnt(0)
    v_exp_f32 v70, v70
    v_exp_f32 v71, v71
    v_exp_f32 v72, v72
    v_smfmac_f32_16x16x64_bf16 v[196:199], v[200:203], v[112:119], v204
    ds_read_b128 v[144:147], v24 offset:28672
    v_exp_f32 v73, v73
    v_exp_f32 v74, v74
    v_smfmac_f32_32x32x32_bf16 v[176:191], v[156:159], v[120:127], v204
    v_exp_f32 v75, v75
    v_exp_f32 v76, v76
    v_exp_f32 v77, v77
    v_smfmac_f32_16x16x64_bf16 v[196:199], v[200:203], v[120:127], v204
    ds_read_b128 v[148:151], v24 offset:29696
    v_exp_f32 v78, v78
    v_exp_f32 v79, v79
    v_mfma_f32_32x32x16_bf16 v[96:111], v[136:139], v[8:11], 0
    s_barrier
    v_exp_f32 v80, v80
    v_exp_f32 v81, v81
    v_exp_f32 v82, v82
    v_mfma_f32_32x32x16_bf16 v[96:111], v[140:143], v[12:15], v[96:111]
    s_waitcnt lgkmcnt(1)
    v_exp_f32 v83, v83
    v_exp_f32 v84, v84
    v_exp_f32 v85, v85
    v_smfmac_f32_32x32x32_bf16 v[160:175], v[144:147], v[64:71], v204
    s_waitcnt lgkmcnt(0)
    v_exp_f32 v86, v86
    v_exp_f32 v87, v87
    v_exp_f32 v88, v88
    v_smfmac_f32_16x16x64_bf16 v[192:195], v[200:203], v[64:71], v204
    ds_read_b128 v[128:131], v24 offset:32768
    v_exp_f32 v89, v89
    v_exp_f32 v90, v90
    v_smfmac_f32_32x32x32_bf16 v[160:175], v[148:151], v[72:79], v204
    v_exp_f32 v91, v91
    v_exp_f32 v92, v92
    v_exp_f32 v93, v93
    v_smfmac_f32_16x16x64_bf16 v[192:195], v[200:203], v[72:79], v204
    ds_read_b128 v[132:135], v24 offset:33792
    v_exp_f32 v94, v94
    v_exp_f32 v95, v95
    v_mfma_f32_32x32x16_bf16 v[112:127], v[136:139], v[16:19], 0
    v_exp_f32 v96, v96
    v_exp_f32 v97, v97
    v_exp_f32 v98, v98
    v_mfma_f32_32x32x16_bf16 v[112:127], v[140:143], v[20:23], v[112:127]
    v_exp_f32 v99, v99
    v_exp_f32 v100, v100
    v_exp_f32 v101, v101
    v_smfmac_f32_32x32x32_bf16 v[176:191], v[144:147], v[80:87], v204
    s_waitcnt lgkmcnt(0)
    v_exp_f32 v102, v102
    v_exp_f32 v103, v103
    v_exp_f32 v104, v104
    v_smfmac_f32_16x16x64_bf16 v[196:199], v[200:203], v[80:87], v204
    ds_read_b128 v[152:155], v24 offset:30720
    v_exp_f32 v105, v105
    v_exp_f32 v106, v106
    v_smfmac_f32_32x32x32_bf16 v[176:191], v[148:151], v[88:95], v204
    v_exp_f32 v107, v107
    v_exp_f32 v108, v108
    v_exp_f32 v109, v109
    v_smfmac_f32_16x16x64_bf16 v[196:199], v[200:203], v[88:95], v204
    ds_read_b128 v[156:159], v24 offset:31744
    v_exp_f32 v110, v110
    v_exp_f32 v111, v111
    v_mfma_f32_32x32x16_bf16 v[64:79], v[128:131], v[8:11], 0
    v_exp_f32 v112, v112
    v_exp_f32 v113, v113
    v_exp_f32 v114, v114
    v_mfma_f32_32x32x16_bf16 v[64:79], v[132:135], v[12:15], v[64:79]
    s_waitcnt lgkmcnt(1)
    v_exp_f32 v115, v115
    v_exp_f32 v116, v116
    v_exp_f32 v117, v117
    v_smfmac_f32_32x32x32_bf16 v[160:175], v[152:155], v[96:103], v204
    s_waitcnt lgkmcnt(0)
    v_exp_f32 v118, v118
    v_exp_f32 v119, v119
    v_exp_f32 v120, v120
    v_smfmac_f32_16x16x64_bf16 v[192:195], v[200:203], v[96:103], v204
    ds_read_b128 v[136:139], v24 offset:34816
    v_exp_f32 v121, v121
    v_exp_f32 v122, v122
    v_smfmac_f32_32x32x32_bf16 v[160:175], v[156:159], v[104:111], v204
    v_exp_f32 v123, v123
    v_exp_f32 v124, v124
    v_exp_f32 v125, v125
    v_smfmac_f32_16x16x64_bf16 v[192:195], v[200:203], v[104:111], v204
    ds_read_b128 v[140:143], v24 offset:35840
    v_exp_f32 v126, v126
    v_exp_f32 v127, v127
    v_mfma_f32_32x32x16_bf16 v[80:95], v[128:131], v[16:19], 0
    v_exp_f32 v64, v64
    v_exp_f32 v65, v65
    v_exp_f32 v66, v66
    v_mfma_f32_32x32x16_bf16 v[80:95], v[132:135], v[20:23], v[80:95]
    v_exp_f32 v67, v67
    v_exp_f32 v68, v68
    v_exp_f32 v69, v69
    v_smfmac_f32_32x32x32_bf16 v[176:191], v[152:155], v[112:119], v204
    s_waitcnt lgkmcnt(0)
    v_exp_f32 v70, v70
    v_exp_f32 v71, v71
    v_exp_f32 v72, v72
    v_smfmac_f32_16x16x64_bf16 v[196:199], v[200:203], v[112:119], v204
    ds_read_b128 v[144:147], v24 offset:40960
    v_exp_f32 v73, v73
    v_exp_f32 v74, v74
    v_smfmac_f32_32x32x32_bf16 v[176:191], v[156:159], v[120:127], v204
    v_exp_f32 v75, v75
    v_exp_f32 v76, v76
    v_exp_f32 v77, v77
    v_smfmac_f32_16x16x64_bf16 v[196:199], v[200:203], v[120:127], v204
    ds_read_b128 v[148:151], v24 offset:41984
    v_exp_f32 v78, v78
    v_exp_f32 v79, v79
    v_mfma_f32_32x32x16_bf16 v[96:111], v[136:139], v[8:11], 0
    v_exp_f32 v80, v80
    v_exp_f32 v81, v81
    v_exp_f32 v82, v82
    v_mfma_f32_32x32x16_bf16 v[96:111], v[140:143], v[12:15], v[96:111]
    s_waitcnt lgkmcnt(1)
    v_exp_f32 v83, v83
    v_exp_f32 v84, v84
    v_exp_f32 v85, v85
    v_smfmac_f32_32x32x32_bf16 v[160:175], v[144:147], v[64:71], v204
    s_waitcnt lgkmcnt(0)
    v_exp_f32 v86, v86
    v_exp_f32 v87, v87
    v_exp_f32 v88, v88
    v_smfmac_f32_16x16x64_bf16 v[192:195], v[200:203], v[64:71], v204
    ds_read_b128 v[128:131], v24 offset:36864
    v_exp_f32 v89, v89
    v_exp_f32 v90, v90
    v_smfmac_f32_32x32x32_bf16 v[160:175], v[148:151], v[72:79], v204
    v_exp_f32 v91, v91
    v_exp_f32 v92, v92
    v_exp_f32 v93, v93
    v_smfmac_f32_16x16x64_bf16 v[192:195], v[200:203], v[72:79], v204
    ds_read_b128 v[132:135], v24 offset:37888
    v_exp_f32 v94, v94
    v_exp_f32 v95, v95
    v_mfma_f32_32x32x16_bf16 v[112:127], v[136:139], v[16:19], 0
    v_exp_f32 v96, v96
    v_exp_f32 v97, v97
    v_exp_f32 v98, v98
    v_mfma_f32_32x32x16_bf16 v[112:127], v[140:143], v[20:23], v[112:127]
    v_exp_f32 v99, v99
    v_exp_f32 v100, v100
    v_exp_f32 v101, v101
    v_smfmac_f32_32x32x32_bf16 v[176:191], v[144:147], v[80:87], v204
    s_waitcnt lgkmcnt(0)
    v_exp_f32 v102, v102
    v_exp_f32 v103, v103
    v_exp_f32 v104, v104
    v_smfmac_f32_16x16x64_bf16 v[196:199], v[200:203], v[80:87], v204
    ds_read_b128 v[152:155], v24 offset:43008
    v_exp_f32 v105, v105
    v_exp_f32 v106, v106
    v_smfmac_f32_32x32x32_bf16 v[176:191], v[148:151], v[88:95], v204
    v_exp_f32 v107, v107
    v_exp_f32 v108, v108
    v_exp_f32 v109, v109
    v_smfmac_f32_16x16x64_bf16 v[196:199], v[200:203], v[88:95], v204
    ds_read_b128 v[156:159], v24 offset:44032
    v_exp_f32 v110, v110
    v_exp_f32 v111, v111
    v_mfma_f32_32x32x16_bf16 v[64:79], v[128:131], v[8:11], 0
    v_exp_f32 v112, v112
    v_exp_f32 v113, v113
    v_exp_f32 v114, v114
    v_mfma_f32_32x32x16_bf16 v[64:79], v[132:135], v[12:15], v[64:79]
    s_waitcnt lgkmcnt(1)
    v_exp_f32 v115, v115
    v_exp_f32 v116, v116
    v_exp_f32 v117, v117
    v_smfmac_f32_32x32x32_bf16 v[160:175], v[152:155], v[96:103], v204
    s_waitcnt lgkmcnt(0)
    v_exp_f32 v118, v118
    v_exp_f32 v119, v119
    v_exp_f32 v120, v120
    v_smfmac_f32_16x16x64_bf16 v[192:195], v[200:203], v[96:103], v204
    ds_read_b128 v[136:139], v24 offset:38912
    v_exp_f32 v121, v121
    v_exp_f32 v122, v122
    v_smfmac_f32_32x32x32_bf16 v[160:175], v[156:159], v[104:111], v204
    v_exp_f32 v123, v123
    v_exp_f32 v124, v124
    v_exp_f32 v125, v125
    v_smfmac_f32_16x16x64_bf16 v[192:195], v[200:203], v[104:111], v204
    ds_read_b128 v[140:143], v24 offset:39936
    v_exp_f32 v126, v126
    v_exp_f32 v127, v127
    v_mfma_f32_32x32x16_bf16 v[80:95], v[128:131], v[16:19], 0
    v_exp_f32 v64, v64
    v_exp_f32 v65, v65
    v_exp_f32 v66, v66
    v_mfma_f32_32x32x16_bf16 v[80:95], v[132:135], v[20:23], v[80:95]
    v_exp_f32 v67, v67
    v_exp_f32 v68, v68
    v_exp_f32 v69, v69
    v_smfmac_f32_32x32x32_bf16 v[176:191], v[152:155], v[112:119], v204
    s_waitcnt lgkmcnt(0)
    v_exp_f32 v70, v70
    v_exp_f32 v71, v71
    v_exp_f32 v72, v72
    v_smfmac_f32_16x16x64_bf16 v[196:199], v[200:203], v[112:119], v204
    ds_read_b128 v[144:147], v24 offset:45056
    v_exp_f32 v73, v73
    v_exp_f32 v74, v74
    v_smfmac_f32_32x32x32_bf16 v[176:191], v[156:159], v[120:127], v204
    v_exp_f32 v75, v75
    v_exp_f32 v76, v76
    v_exp_f32 v77, v77
    v_smfmac_f32_16x16x64_bf16 v[196:199], v[200:203], v[120:127], v204
    ds_read_b128 v[148:151], v24 offset:46080
    v_exp_f32 v78, v78
    v_exp_f32 v79, v79
    v_mfma_f32_32x32x16_bf16 v[96:111], v[136:139], v[8:11], 0
    s_barrier
    v_exp_f32 v80, v80
    v_exp_f32 v81, v81
    v_exp_f32 v82, v82
    v_mfma_f32_32x32x16_bf16 v[96:111], v[140:143], v[12:15], v[96:111]
    s_waitcnt lgkmcnt(1)
    v_exp_f32 v83, v83
    v_exp_f32 v84, v84
    v_exp_f32 v85, v85
    v_smfmac_f32_32x32x32_bf16 v[160:175], v[144:147], v[64:71], v204
    s_waitcnt lgkmcnt(0)
    v_exp_f32 v86, v86
    v_exp_f32 v87, v87
    v_exp_f32 v88, v88
    v_smfmac_f32_16x16x64_bf16 v[192:195], v[200:203], v[64:71], v204
    ds_read_b128 v[128:131], v24 offset:49152
    v_exp_f32 v89, v89
    v_exp_f32 v90, v90
    v_smfmac_f32_32x32x32_bf16 v[160:175], v[148:151], v[72:79], v204
    v_exp_f32 v91, v91
    v_exp_f32 v92, v92
    v_exp_f32 v93, v93
    v_smfmac_f32_16x16x64_bf16 v[192:195], v[200:203], v[72:79], v204
    ds_read_b128 v[132:135], v24 offset:50176
    v_exp_f32 v94, v94
    v_exp_f32 v95, v95
    v_mfma_f32_32x32x16_bf16 v[112:127], v[136:139], v[16:19], 0
    v_exp_f32 v96, v96
    v_exp_f32 v97, v97
    v_exp_f32 v98, v98
    v_mfma_f32_32x32x16_bf16 v[112:127], v[140:143], v[20:23], v[112:127]
    v_exp_f32 v99, v99
    v_exp_f32 v100, v100
    v_exp_f32 v101, v101
    v_smfmac_f32_32x32x32_bf16 v[176:191], v[144:147], v[80:87], v204
    s_waitcnt lgkmcnt(0)
    v_exp_f32 v102, v102
    v_exp_f32 v103, v103
    v_exp_f32 v104, v104
    v_smfmac_f32_16x16x64_bf16 v[196:199], v[200:203], v[80:87], v204
    ds_read_b128 v[152:155], v24 offset:47104
    v_exp_f32 v105, v105
    v_exp_f32 v106, v106
    v_smfmac_f32_32x32x32_bf16 v[176:191], v[148:151], v[88:95], v204
    v_exp_f32 v107, v107
    v_exp_f32 v108, v108
    v_exp_f32 v109, v109
    v_smfmac_f32_16x16x64_bf16 v[196:199], v[200:203], v[88:95], v204
    ds_read_b128 v[156:159], v24 offset:48128
    v_exp_f32 v110, v110
    v_exp_f32 v111, v111
    v_mfma_f32_32x32x16_bf16 v[64:79], v[128:131], v[8:11], 0
    v_exp_f32 v112, v112
    v_exp_f32 v113, v113
    v_exp_f32 v114, v114
    v_mfma_f32_32x32x16_bf16 v[64:79], v[132:135], v[12:15], v[64:79]
    s_waitcnt lgkmcnt(1)
    v_exp_f32 v115, v115
    v_exp_f32 v116, v116
    v_exp_f32 v117, v117
    v_smfmac_f32_32x32x32_bf16 v[160:175], v[152:155], v[96:103], v204
    s_waitcnt lgkmcnt(0)
    v_exp_f32 v118, v118
    v_exp_f32 v119, v119
    v_exp_f32 v120, v120
    v_smfmac_f32_16x16x64_bf16 v[192:195], v[200:203], v[96:103], v204
    ds_read_b128 v[136:139], v24 offset:51200
    v_exp_f32 v121, v121
    v_exp_f32 v122, v122
    v_smfmac_f32_32x32x32_bf16 v[160:175], v[156:159], v[104:111], v204
    v_exp_f32 v123, v123
    v_exp_f32 v124, v124
    v_exp_f32 v125, v125
    v_smfmac_f32_16x16x64_bf16 v[192:195], v[200:203], v[104:111], v204
    ds_read_b128 v[140:143], v24 offset:52224
    v_exp_f32 v126, v126
    v_exp_f32 v127, v127
    v_mfma_f32_32x32x16_bf16 v[80:95], v[128:131], v[16:19], 0
    v_exp_f32 v64, v64
    v_exp_f32 v65, v65
    v_exp_f32 v66, v66
    v_mfma_f32_32x32x16_bf16 v[80:95], v[132:135], v[20:23], v[80:95]
    v_exp_f32 v67, v67
    v_exp_f32 v68, v68
    v_exp_f32 v69, v69
    v_smfmac_f32_32x32x32_bf16 v[176:191], v[152:155], v[112:119], v204
    s_waitcnt lgkmcnt(0)
    v_exp_f32 v70, v70
    v_exp_f32 v71, v71
    v_exp_f32 v72, v72
    v_smfmac_f32_16x16x64_bf16 v[196:199], v[200:203], v[112:119], v204
    ds_read_b128 v[144:147], v24 offset:57344
    v_exp_f32 v73, v73
    v_exp_f32 v74, v74
    v_smfmac_f32_32x32x32_bf16 v[176:191], v[156:159], v[120:127], v204
    v_exp_f32 v75, v75
    v_exp_f32 v76, v76
    v_exp_f32 v77, v77
    v_smfmac_f32_16x16x64_bf16 v[196:199], v[200:203], v[120:127], v204
    ds_read_b128 v[148:151], v24 offset:58368
    v_exp_f32 v78, v78
    v_exp_f32 v79, v79
    v_mfma_f32_32x32x16_bf16 v[96:111], v[136:139], v[8:11], 0
    v_exp_f32 v80, v80
    v_exp_f32 v81, v81
    v_exp_f32 v82, v82
    v_mfma_f32_32x32x16_bf16 v[96:111], v[140:143], v[12:15], v[96:111]
    s_waitcnt lgkmcnt(1)
    v_exp_f32 v83, v83
    v_exp_f32 v84, v84
    v_exp_f32 v85, v85
    v_smfmac_f32_32x32x32_bf16 v[160:175], v[144:147], v[64:71], v204
    s_waitcnt lgkmcnt(0)
    v_exp_f32 v86, v86
    v_exp_f32 v87, v87
    v_exp_f32 v88, v88
    v_smfmac_f32_16x16x64_bf16 v[192:195], v[200:203], v[64:71], v204
    ds_read_b128 v[128:131], v24 offset:53248
    v_exp_f32 v89, v89
    v_exp_f32 v90, v90
    v_smfmac_f32_32x32x32_bf16 v[160:175], v[148:151], v[72:79], v204
    v_exp_f32 v91, v91
    v_exp_f32 v92, v92
    v_exp_f32 v93, v93
    v_smfmac_f32_16x16x64_bf16 v[192:195], v[200:203], v[72:79], v204
    ds_read_b128 v[132:135], v24 offset:54272
    v_exp_f32 v94, v94
    v_exp_f32 v95, v95
    v_mfma_f32_32x32x16_bf16 v[112:127], v[136:139], v[16:19], 0
    v_exp_f32 v96, v96
    v_exp_f32 v97, v97
    v_exp_f32 v98, v98
    v_mfma_f32_32x32x16_bf16 v[112:127], v[140:143], v[20:23], v[112:127]
    v_exp_f32 v99, v99
    v_exp_f32 v100, v100
    v_exp_f32 v101, v101
    v_smfmac_f32_32x32x32_bf16 v[176:191], v[144:147], v[80:87], v204
    s_waitcnt lgkmcnt(0)
    v_exp_f32 v102, v102
    v_exp_f32 v103, v103
    v_exp_f32 v104, v104
    v_smfmac_f32_16x16x64_bf16 v[196:199], v[200:203], v[80:87], v204
    ds_read_b128 v[152:155], v24 offset:59392
    v_exp_f32 v105, v105
    v_exp_f32 v106, v106
    v_smfmac_f32_32x32x32_bf16 v[176:191], v[148:151], v[88:95], v204
    v_exp_f32 v107, v107
    v_exp_f32 v108, v108
    v_exp_f32 v109, v109
    v_smfmac_f32_16x16x64_bf16 v[196:199], v[200:203], v[88:95], v204
    ds_read_b128 v[156:159], v24 offset:60416
    v_exp_f32 v110, v110
    v_exp_f32 v111, v111
    v_mfma_f32_32x32x16_bf16 v[64:79], v[128:131], v[8:11], 0
    v_exp_f32 v112, v112
    v_exp_f32 v113, v113
    v_exp_f32 v114, v114
    v_mfma_f32_32x32x16_bf16 v[64:79], v[132:135], v[12:15], v[64:79]
    s_waitcnt lgkmcnt(1)
    v_exp_f32 v115, v115
    v_exp_f32 v116, v116
    v_exp_f32 v117, v117
    v_smfmac_f32_32x32x32_bf16 v[160:175], v[152:155], v[96:103], v204
    s_waitcnt lgkmcnt(0)
    v_exp_f32 v118, v118
    v_exp_f32 v119, v119
    v_exp_f32 v120, v120
    v_smfmac_f32_16x16x64_bf16 v[192:195], v[200:203], v[96:103], v204
    ds_read_b128 v[136:139], v24 offset:55296
    v_exp_f32 v121, v121
    v_exp_f32 v122, v122
    v_smfmac_f32_32x32x32_bf16 v[160:175], v[156:159], v[104:111], v204
    v_exp_f32 v123, v123
    v_exp_f32 v124, v124
    v_exp_f32 v125, v125
    v_smfmac_f32_16x16x64_bf16 v[192:195], v[200:203], v[104:111], v204
    ds_read_b128 v[140:143], v24 offset:56320
    v_exp_f32 v126, v126
    v_exp_f32 v127, v127
    v_mfma_f32_32x32x16_bf16 v[80:95], v[128:131], v[16:19], 0
    v_exp_f32 v64, v64
    v_exp_f32 v65, v65
    v_exp_f32 v66, v66
    v_mfma_f32_32x32x16_bf16 v[80:95], v[132:135], v[20:23], v[80:95]
    v_exp_f32 v67, v67
    v_exp_f32 v68, v68
    v_exp_f32 v69, v69
    v_smfmac_f32_32x32x32_bf16 v[176:191], v[152:155], v[112:119], v204
    s_waitcnt lgkmcnt(0)
    v_exp_f32 v70, v70
    v_exp_f32 v71, v71
    v_exp_f32 v72, v72
    v_smfmac_f32_16x16x64_bf16 v[196:199], v[200:203], v[112:119], v204
    ds_read_b128 v[144:147], v24 offset:61440
    v_exp_f32 v73, v73
    v_exp_f32 v74, v74
    v_smfmac_f32_32x32x32_bf16 v[176:191], v[156:159], v[120:127], v204
    v_exp_f32 v75, v75
    v_exp_f32 v76, v76
    v_exp_f32 v77, v77
    v_smfmac_f32_16x16x64_bf16 v[196:199], v[200:203], v[120:127], v204
    ds_read_b128 v[148:151], v24 offset:62464
    v_exp_f32 v78, v78
    v_exp_f32 v79, v79
    v_mfma_f32_32x32x16_bf16 v[96:111], v[136:139], v[8:11], 0
    s_barrier
    v_exp_f32 v80, v80
    v_exp_f32 v81, v81
    v_exp_f32 v82, v82
    v_mfma_f32_32x32x16_bf16 v[96:111], v[140:143], v[12:15], v[96:111]
    s_waitcnt lgkmcnt(1)
    v_exp_f32 v83, v83
    v_exp_f32 v84, v84
    v_exp_f32 v85, v85
    v_smfmac_f32_32x32x32_bf16 v[160:175], v[144:147], v[64:71], v204
    s_waitcnt lgkmcnt(0)
    v_exp_f32 v86, v86
    v_exp_f32 v87, v87
    v_exp_f32 v88, v88
    v_smfmac_f32_16x16x64_bf16 v[192:195], v[200:203], v[64:71], v204
    ds_read_b128 v[128:131], v24 offset:0
    v_exp_f32 v89, v89
    v_exp_f32 v90, v90
    v_smfmac_f32_32x32x32_bf16 v[160:175], v[148:151], v[72:79], v204
    v_exp_f32 v91, v91
    v_exp_f32 v92, v92
    v_exp_f32 v93, v93
    v_smfmac_f32_16x16x64_bf16 v[192:195], v[200:203], v[72:79], v204
    ds_read_b128 v[132:135], v24 offset:1024
    v_exp_f32 v94, v94
    v_exp_f32 v95, v95
    v_mfma_f32_32x32x16_bf16 v[112:127], v[136:139], v[16:19], 0
    v_exp_f32 v96, v96
    v_exp_f32 v97, v97
    v_exp_f32 v98, v98
    v_mfma_f32_32x32x16_bf16 v[112:127], v[140:143], v[20:23], v[112:127]
    v_exp_f32 v99, v99
    v_exp_f32 v100, v100
    v_exp_f32 v101, v101
    v_smfmac_f32_32x32x32_bf16 v[176:191], v[144:147], v[80:87], v204
    s_waitcnt lgkmcnt(0)
    v_exp_f32 v102, v102
    v_exp_f32 v103, v103
    v_exp_f32 v104, v104
    v_smfmac_f32_16x16x64_bf16 v[196:199], v[200:203], v[80:87], v204
    ds_read_b128 v[152:155], v24 offset:63488
    v_exp_f32 v105, v105
    v_exp_f32 v106, v106
    v_smfmac_f32_32x32x32_bf16 v[176:191], v[148:151], v[88:95], v204
    v_exp_f32 v107, v107
    v_exp_f32 v108, v108
    v_exp_f32 v109, v109
    v_smfmac_f32_16x16x64_bf16 v[196:199], v[200:203], v[88:95], v204
    ds_read_b128 v[156:159], v24 offset:64512
    v_exp_f32 v110, v110
    v_exp_f32 v111, v111
    v_mfma_f32_32x32x16_bf16 v[64:79], v[128:131], v[8:11], 0
    s_sub_u32 s54, s54, 1
    v_exp_f32 v112, v112
    v_exp_f32 v113, v113
    v_exp_f32 v114, v114
    v_mfma_f32_32x32x16_bf16 v[64:79], v[132:135], v[12:15], v[64:79]
    s_waitcnt lgkmcnt(1)
    v_exp_f32 v115, v115
    v_exp_f32 v116, v116
    v_exp_f32 v117, v117
    v_smfmac_f32_32x32x32_bf16 v[160:175], v[152:155], v[96:103], v204
    s_waitcnt lgkmcnt(0)
    v_exp_f32 v118, v118
    v_exp_f32 v119, v119
    v_exp_f32 v120, v120
    v_smfmac_f32_16x16x64_bf16 v[192:195], v[200:203], v[96:103], v204
    ds_read_b128 v[136:139], v24 offset:2048
    v_exp_f32 v121, v121
    v_exp_f32 v122, v122
    v_smfmac_f32_32x32x32_bf16 v[160:175], v[156:159], v[104:111], v204
    s_cmp_lg_u32 s54, 0
    v_exp_f32 v123, v123
    v_exp_f32 v124, v124
    v_exp_f32 v125, v125
    v_smfmac_f32_16x16x64_bf16 v[192:195], v[200:203], v[104:111], v204
    ds_read_b128 v[140:143], v24 offset:3072
    v_exp_f32 v126, v126
    v_exp_f32 v127, v127
    s_cbranch_scc1 c_attn_loop
    v_smfmac_f32_16x16x64_bf16 v[196:199], v[200:203], v[112:119], v204
    v_smfmac_f32_16x16x64_bf16 v[196:199], v[200:203], v[120:127], v204
    v_smfmac_f32_32x32x32_bf16 v[176:191], v[152:155], v[112:119], v204
    v_smfmac_f32_32x32x32_bf16 v[176:191], v[156:159], v[120:127], v204
    v_mov_b32 v28, 0x5f000000
    v_mov_b32 v29, 0x2b800000
    v_cmp_lt_f32 s[56:57], v192, v28
    v_cmp_gt_f32 vcc, v192, v29
    s_and_b64 s[56:57], s[56:57], vcc
    s_nop 0
    v_cmp_lt_f32 vcc, v196, v28
    s_and_b64 s[56:57], s[56:57], vcc
    v_cmp_gt_f32 vcc, v196, v29
    s_and_b64 s[56:57], s[56:57], vcc
    s_cmp_lg_u64 s[56:57], -1
    s_cbranch_scc1 c_attn_slow
c_attn_fin:
    s_lshl_b32 s3, s48, 17
    s_lshl_b32 s55, s7, 12
    s_add_u32 s3, s3, s55
    s_and_b32 s55, s6, 1
    s_lshl_b32 s55, s55, 11
    s_add_u32 s3, s3, s55
    s_lshl_b32 s55, s9, 22
    s_add_u32 s3, s3, s55
    s_add_u32 s3, s3, 16777216
    v_rcp_f32 v192, v192
    s_nop 0
    v_pk_mul_f32 v[160:161], v[192:193], v[160:161] op_sel_hi:[0,1]
    v_pk_mul_f32 v[162:163], v[192:193], v[162:163] op_sel_hi:[0,1]
    v_pk_mul_f32 v[164:165], v[192:193], v[164:165] op_sel_hi:[0,1]
    v_pk_mul_f32 v[166:167], v[192:193], v[166:167] op_sel_hi:[0,1]
    v_pk_mul_f32 v[168:169], v[192:193], v[168:169] op_sel_hi:[0,1]
    v_pk_mul_f32 v[170:171], v[192:193], v[170:171] op_sel_hi:[0,1]
    v_pk_mul_f32 v[172:173], v[192:193], v[172:173] op_sel_hi:[0,1]
    v_pk_mul_f32 v[174:175], v[192:193], v[174:175] op_sel_hi:[0,1]
    v_cvt_pk_bf16_f32 v160, v160, v161
    v_cvt_pk_bf16_f32 v161, v162, v163
    v_cvt_pk_bf16_f32 v162, v164, v165
    v_cvt_pk_bf16_f32 v163, v166, v167
    v_cvt_pk_bf16_f32 v164, v168, v169
    v_cvt_pk_bf16_f32 v165, v170, v171
    v_cvt_pk_bf16_f32 v166, v172, v173
    v_cvt_pk_bf16_f32 v167, v174, v175
    buffer_store_dwordx4 v[160:163], v5, s[12:15], s3 offen offset:0 sc1
    buffer_store_dwordx4 v[164:167], v5, s[12:15], s3 offen offset:1024 sc1
    s_add_u32 s3, s3, 65536
    v_rcp_f32 v196, v196
    s_nop 0
    v_pk_mul_f32 v[176:177], v[196:197], v[176:177] op_sel_hi:[0,1]
    v_pk_mul_f32 v[178:179], v[196:197], v[178:179] op_sel_hi:[0,1]
    v_pk_mul_f32 v[180:181], v[196:197], v[180:181] op_sel_hi:[0,1]
    v_pk_mul_f32 v[182:183], v[196:197], v[182:183] op_sel_hi:[0,1]
    v_pk_mul_f32 v[184:185], v[196:197], v[184:185] op_sel_hi:[0,1]
    v_pk_mul_f32 v[186:187], v[196:197], v[186:187] op_sel_hi:[0,1]
    v_pk_mul_f32 v[188:189], v[196:197], v[188:189] op_sel_hi:[0,1]
    v_pk_mul_f32 v[190:191], v[196:197], v[190:191] op_sel_hi:[0,1]
    v_cvt_pk_bf16_f32 v176, v176, v177
    v_cvt_pk_bf16_f32 v177, v178, v179
    v_cvt_pk_bf16_f32 v178, v180, v181
    v_cvt_pk_bf16_f32 v179, v182, v183
    v_cvt_pk_bf16_f32 v180, v184, v185
    v_cvt_pk_bf16_f32 v181, v186, v187
    v_cvt_pk_bf16_f32 v182, v188, v189
    v_cvt_pk_bf16_f32 v183, v190, v191
    buffer_store_dwordx4 v[176:179], v5, s[12:15], s3 offen offset:0 sc1
    buffer_store_dwordx4 v[180:183], v5, s[12:15], s3 offen offset:1024 sc1
    s_add_u32 s3, s3, 65536
    s_mul_i32 s55, s9, 786432
    s_add_u32 s55, s55, 65798144
    v_and_b32 v28, 63, v0
    s_and_b32 s56, s11, 0xe0
    v_lshrrev_b32 v29, 5, v28
    v_add_u32 v28, s56, v28
    v_and_b32 v28, 255, v28
    v_lshlrev_b32 v28, 10, v28
    v_lshl_add_u32 v28, v29, 8, v28
    s_bfe_u32 s56, s11, 0x20003
    s_and_b32 s57, s11, 7
    s_lshl_b32 s56, s56, 7
    s_lshl_b32 s57, s57, 2
    s_add_u32 s55, s55, s56
    s_add_u32 s55, s55, s57
    v_mov_b32 v29, 159488
    v_mov_b32 v30, 1
    v_mov_b32 v31, s10
    s_mov_b64 exec, 1
    s_waitcnt vmcnt(0)
    ds_add_rtn_u32 v30, v29, v30
    s_waitcnt lgkmcnt(0)
    v_readfirstlane_b32 s56, v30
    s_and_b32 s56, s56, 3
    s_cmp_lg_u32 s56, 3
    s_cbranch_scc1 pub_7
    s_mov_b32 exec_lo, -1
    buffer_store_dword v31, v28, s[12:15], s55 offen sc1
pub_7:
    s_mov_b64 exec, -1
    s_branch c_wo
.p2align 6
h_first:
    s_memrealtime s[50:51]
    s_cmp_lg_u32 s2, 0
    s_cbranch_scc1 h_first_nonon
    s_mov_b32 s16, s46
    s_mov_b32 s17, s47
    s_mov_b32 s18, 256
    s_mov_b32 s19, 0x00020000
    v_lshlrev_b32 v14, 6, v1
    s_waitcnt lgkmcnt(0)
    s_or_b32 s50, s50, 1
    v_mov_b32 v13, s50
    buffer_store_dword v13, v14, s[16:19], 0 offen sc1
h_first_nonon:
    v_mov_b32 v8, 0
    v_mov_b32 v9, 0
    v_mov_b32 v10, 159488
    ds_write_b64 v10, v[8:9]
    ds_write_b32 v10, v8 offset:8
    s_waitcnt lgkmcnt(0)
    s_barrier
    s_barrier
    s_sub_u32 s50, s50, 8000
    s_load_dword s10, s[46:47], 0
    s_waitcnt lgkmcnt(0)
    s_sub_u32 s51, s10, s50
    s_and_b32 s3, s10, 1
    s_cselect_b32 s51, s51, -1
    s_cmp_ge_i32 s51, 0
    s_cbranch_scc1 h_first_non_ok
    s_load_dword s10, s[46:47], 128
    s_waitcnt lgkmcnt(0)
    s_sub_u32 s51, s10, s50
    s_and_b32 s3, s10, 1
    s_cselect_b32 s51, s51, -1
    s_cmp_ge_i32 s51, 0
    s_cbranch_scc1 h_first_non_ok
    s_load_dword s10, s[46:47], 64
    s_waitcnt lgkmcnt(0)
    s_sub_u32 s51, s10, s50
    s_and_b32 s3, s10, 1
    s_cselect_b32 s51, s51, -1
    s_cmp_ge_i32 s51, 0
    s_cbranch_scc1 h_first_non_ok
    s_load_dword s10, s[46:47], 192
    s_waitcnt lgkmcnt(0)
    s_sub_u32 s51, s10, s50
    s_and_b32 s3, s10, 1
    s_cselect_b32 s51, s51, -1
    s_cmp_ge_i32 s51, 0
    s_cbranch_scc1 h_first_non_ok
    s_mov_b32 s58, 0
    s_and_b32 s57, s2, 0xc0
h_first_non:
    s_load_dword s10, s[46:47], s57 glc
    s_waitcnt lgkmcnt(0)
    s_sub_u32 s51, s10, s50
    s_and_b32 s3, s10, 1
    s_cselect_b32 s51, s51, -1
    s_cmp_ge_i32 s51, 0
    s_cbranch_scc1 h_first_non_ok
    s_add_u32 s58, s58, 1
    s_cmp_gt_u32 s58, 100
    s_cselect_b32 s50, s10, s50
    s_cmp_lt_u32 s58, 0x8000
    s_cbranch_scc1 h_first_non
    s_mov_b32 s10, 1
h_first_non_ok:
    v_mov_b32 v12, s10
    ds_write_b32 v10, v12 offset:4
    s_waitcnt vmcnt(0)
    v_lshlrev_b32 v13, 7, v1
    s_lshl_b32 s50, s2, 13
    s_mov_b32 s28, s36
    s_mov_b32 s29, s37
    s_mov_b32 s30, 2097152
    s_mov_b32 s31, 0x00020000
    buffer_load_dword v14, v13, s[28:31], s50 offen
    s_mov_b32 s9, 0
h_qkvA:
    s_mul_i32 s98, s9, 786432
    s_add_u32 s98, s98, 65273856
    s_lshl_b32 s99, s11, 10
    s_add_u32 s98, s98, s99
    s_add_u32 s96, s4, s98
    s_addc_u32 s97, s5, 0
    s_mov_b32 s98, s10
    s_mov_b32 s99, s10
    v_and_b32 v1, 63, v0
    v_lshlrev_b32 v5, 4, v1
    v_and_b32 v20, 15, v1
    v_lshrrev_b32 v11, 4, v1
    v_min_u32 v11, 2, v11
    v_lshlrev_b32 v21, 3, v20
    v_lshl_add_u32 v12, v11, 7, v21
    v_add_u32 v12, 155648, v12
    v_lshl_add_u32 v11, v11, 16, v21
    v_mov_b32 v10, 159496
    s_add_u32 s3, s9, 1
    v_mov_b32 v13, s3
    s_and_b32 s3, s6, 14
    s_lshl_b32 s3, s3, 2
    s_sub_u32 s3, s3, 1
    s_max_i32 s3, s3, 0
    s_lshl_b32 s3, s3, 16
    s_lshl_b32 s48, s9, 22
    s_add_u32 s3, s3, s48
    s_add_u32 s20, s4, s3
    s_addc_u32 s21, s5, 0
    s_mov_b32 s22, 65536
    s_mov_b32 s23, 0x00020000
    v_bfe_u32 v21, v1, 4, 1
    v_lshl_add_u32 v6, v21, 5, v20
    v_lshlrev_b32 v6, 4, v6
    v_lshrrev_b32 v21, 5, v1
    v_lshl_add_u32 v6, v21, 10, v6
    v_add_u32 v6, 256, v6
    s_mov_b32 s3, 0x20000
poll_8:
    s_load_dwordx8 s[80:87], s[96:97], 512 glc
    s_load_dwordx8 s[88:95], s[96:97], 640 glc
    s_sub_u32 s3, s3, 1
    s_cbranch_scc1 poll_8_ok
    s_waitcnt lgkmcnt(0)
    s_xor_b64 s[100:101], s[80:81], s[98:99]
    s_xor_b64 s[80:81], s[82:83], s[98:99]
    s_or_b64 s[100:101], s[100:101], s[80:81]
    s_xor_b64 s[80:81], s[84:85], s[98:99]
    s_or_b64 s[100:101], s[100:101], s[80:81]
    s_xor_b64 s[80:81], s[86:87], s[98:99]
    s_or_b64 s[100:101], s[100:101], s[80:81]
    s_xor_b64 s[80:81], s[88:89], s[98:99]
    s_or_b64 s[100:101], s[100:101], s[80:81]
    s_xor_b64 s[80:81], s[90:91], s[98:99]
    s_or_b64 s[100:101], s[100:101], s[80:81]
    s_xor_b64 s[80:81], s[92:93], s[98:99]
    s_or_b64 s[100:101], s[100:101], s[80:81]
    s_xor_b64 s[80:81], s[94:95], s[98:99]
    s_or_b64 s[100:101], s[100:101], s[80:81]
    s_cbranch_scc1 poll_8
poll_8_ok:
    s_waitcnt lgkmcnt(0)
    ds_write_b32 v10, v13
    s_mov_b32 m0, 147456
    s_mov_b32 s48, 0
    buffer_load_dwordx4 v6, s[20:23], s48 offen sc1 lds
    s_mov_b32 m0, 148480
    s_mov_b32 s48, 2048
    buffer_load_dwordx4 v6, s[20:23], s48 offen sc1 lds
    s_mov_b32 m0, 149504
    s_mov_b32 s48, 4096
    buffer_load_dwordx4 v6, s[20:23], s48 offen sc1 lds
    s_mov_b32 m0, 150528
    s_mov_b32 s48, 6144
    buffer_load_dwordx4 v6, s[20:23], s48 offen sc1 lds
    s_barrier
    s_mov_b32 m0, 151552
    s_mov_b32 s48, 8192
    buffer_load_dwordx4 v6, s[20:23], s48 offen sc1 lds
    s_mov_b32 m0, 152576
    s_mov_b32 s48, 10240
    buffer_load_dwordx4 v6, s[20:23], s48 offen sc1 lds
    s_mov_b32 m0, 153600
    s_mov_b32 s48, 12288
    buffer_load_dwordx4 v6, s[20:23], s48 offen sc1 lds
    s_mov_b32 m0, 154624
    s_mov_b32 s48, 14336
    buffer_load_dwordx4 v6, s[20:23], s48 offen sc1 lds
    s_lshl_b32 s56, s7, 12
    s_and_b32 s57, s6, 1
    s_lshl_b32 s57, s57, 7
    s_add_u32 s56, s56, s57
    s_add_u32 s56, s56, 63963136
    v_lshlrev_b32 v15, 7, v1
    s_lshr_b32 s59, s2, 3
    s_mul_i32 s59, s59, 3
    s_lshr_b32 s59, s59, 5
    s_lshl_b32 s3, s9, 4
    s_add_u32 s59, s59, s3
    s_and_b32 s58, s6, 14
    s_lshl_b32 s58, s58, 18
    s_lshl_b32 s57, s9, 22
    s_add_u32 s58, s58, s57
    s_and_b32 s57, s7, 3
    s_lshl_b32 s57, s57, 11
    s_add_u32 s58, s58, s57
    s_waitcnt vmcnt(4)
    s_barrier
    s_waitcnt vmcnt(0)
    s_barrier
    s_mov_b32 m0, 147456
    s_mov_b32 s48, 16384
    buffer_load_dwordx4 v6, s[20:23], s48 offen sc1 lds
    s_mov_b32 m0, 148480
    s_mov_b32 s48, 18432
    buffer_load_dwordx4 v6, s[20:23], s48 offen sc1 lds
    s_mov_b32 m0, 149504
    s_mov_b32 s48, 20480
    buffer_load_dwordx4 v6, s[20:23], s48 offen sc1 lds
    s_mov_b32 m0, 150528
    s_mov_b32 s48, 22528
    buffer_load_dwordx4 v6, s[20:23], s48 offen sc1 lds
    s_waitcnt vmcnt(0)
    s_barrier
    s_mov_b32 m0, 151552
    s_mov_b32 s48, 24576
    buffer_load_dwordx4 v6, s[20:23], s48 offen sc1 lds
    s_mov_b32 m0, 152576
    s_mov_b32 s48, 26624
    buffer_load_dwordx4 v6, s[20:23], s48 offen sc1 lds
    s_mov_b32 m0, 153600
    s_mov_b32 s48, 28672
    buffer_load_dwordx4 v6, s[20:23], s48 offen sc1 lds
    s_mov_b32 m0, 154624
    s_mov_b32 s48, 30720
    buffer_load_dwordx4 v6, s[20:23], s48 offen sc1 lds
    buffer_load_dwordx2 v[32:33], v11, s[12:15], s56 offen offset:0 sc1
    buffer_load_dwordx2 v[34:35], v11, s[12:15], s56 offen offset:256 sc1
    buffer_load_dwordx2 v[36:37], v11, s[12:15], s56 offen offset:512 sc1
    buffer_load_dwordx2 v[38:39], v11, s[12:15], s56 offen offset:768 sc1
    buffer_load_dwordx2 v[40:41], v11, s[12:15], s56 offen offset:1024 sc1
    buffer_load_dwordx2 v[42:43], v11, s[12:15], s56 offen offset:1280 sc1
    buffer_load_dwordx2 v[44:45], v11, s[12:15], s56 offen offset:1536 sc1
    buffer_load_dwordx2 v[46:47], v11, s[12:15], s56 offen offset:1792 sc1
    buffer_load_dwordx2 v[48:49], v11, s[12:15], s56 offen offset:2048 sc1
    buffer_load_dwordx2 v[50:51], v11, s[12:15], s56 offen offset:2304 sc1
    buffer_load_dwordx2 v[52:53], v11, s[12:15], s56 offen offset:2560 sc1
    buffer_load_dwordx2 v[54:55], v11, s[12:15], s56 offen offset:2816 sc1
    s_waitcnt vmcnt(12)
    s_barrier
    s_mov_b32 m0, 147456
    s_mov_b32 s48, 32768
    buffer_load_dwordx4 v6, s[20:23], s48 offen sc1 lds
    s_mov_b32 m0, 148480
    s_mov_b32 s48, 34816
    buffer_load_dwordx4 v6, s[20:23], s48 offen sc1 lds
    s_mov_b32 m0, 149504
    s_mov_b32 s48, 36864
    buffer_load_dwordx4 v6, s[20:23], s48 offen sc1 lds
    s_mov_b32 m0, 150528
    s_mov_b32 s48, 38912
    buffer_load_dwordx4 v6, s[20:23], s48 offen sc1 lds
    buffer_load_dwordx2 v[56:57], v11, s[12:15], s56 offen offset:3072 sc1
    buffer_load_dwordx2 v[58:59], v11, s[12:15], s56 offen offset:3328 sc1
    buffer_load_dwordx2 v[60:61], v11, s[12:15], s56 offen offset:3584 sc1
    buffer_load_dwordx2 v[62:63], v11, s[12:15], s56 offen offset:3840 sc1
    s_waitcnt vmcnt(4)
    s_barrier
    s_mov_b32 m0, 151552
    s_mov_b32 s48, 40960
    buffer_load_dwordx4 v6, s[20:23], s48 offen sc1 lds
    s_mov_b32 m0, 152576
    s_mov_b32 s48, 43008
    buffer_load_dwordx4 v6, s[20:23], s48 offen sc1 lds
    s_mov_b32 m0, 153600
    s_mov_b32 s48, 45056
    buffer_load_dwordx4 v6, s[20:23], s48 offen sc1 lds
    s_mov_b32 m0, 154624
    s_mov_b32 s48, 47104
    buffer_load_dwordx4 v6, s[20:23], s48 offen sc1 lds
    s_waitcnt vmcnt(4)
    v_add_f32 v32, v32, v48
    v_add_f32 v33, v33, v49
    v_add_f32 v34, v34, v50
    v_add_f32 v35, v35, v51
    v_add_f32 v36, v36, v52
    v_add_f32 v37, v37, v53
    v_add_f32 v38, v38, v54
    v_add_f32 v39, v39, v55
    v_add_f32 v40, v40, v56
    v_add_f32 v41, v41, v57
    v_add_f32 v42, v42, v58
    v_add_f32 v43, v43, v59
    s_waitcnt vmcnt(0)
    s_barrier
    s_mov_b32 m0, 147456
    s_mov_b32 s48, 49152
    buffer_load_dwordx4 v6, s[20:23], s48 offen sc1 lds
    s_mov_b32 m0, 148480
    s_mov_b32 s48, 51200
    buffer_load_dwordx4 v6, s[20:23], s48 offen sc1 lds
    s_mov_b32 m0, 149504
    s_mov_b32 s48, 53248
    buffer_load_dwordx4 v6, s[20:23], s48 offen sc1 lds
    s_mov_b32 m0, 150528
    s_mov_b32 s48, 55296
    buffer_load_dwordx4 v6, s[20:23], s48 offen sc1 lds
    v_add_f32 v44, v44, v60
    v_add_f32 v45, v45, v61
    v_add_f32 v46, v46, v62
    v_add_f32 v47, v47, v63
    v_add_f32 v32, v32, v40
    v_add_f32 v33, v33, v41
    v_add_f32 v34, v34, v42
    v_add_f32 v35, v35, v43
    v_add_f32 v36, v36, v44
    v_add_f32 v37, v37, v45
    v_add_f32 v38, v38, v46
    v_add_f32 v39, v39, v47
    s_waitcnt vmcnt(0)
    s_barrier
    s_mov_b32 m0, 151552
    s_mov_b32 s48, 57344
    buffer_load_dwordx4 v6, s[20:23], s48 offen sc1 lds
    s_mov_b32 m0, 152576
    s_mov_b32 s48, 59392
    buffer_load_dwordx4 v6, s[20:23], s48 offen sc1 lds
    s_mov_b32 m0, 153600
    s_mov_b32 s48, 61440
    buffer_load_dwordx4 v6, s[20:23], s48 offen sc1 lds
    s_mov_b32 m0, 154624
    s_mov_b32 s48, 63488
    buffer_load_dwordx4 v6, s[20:23], s48 offen sc1 lds
    v_add_f32 v32, v32, v36
    v_add_f32 v33, v33, v37
    v_add_f32 v34, v34, v38
    v_add_f32 v35, v35, v39
    v_add_f32 v32, v32, v34
    v_add_f32 v33, v33, v35
    ds_write_b64 v12, v[32:33]
    s_waitcnt lgkmcnt(0)
    s_waitcnt vmcnt(0)
    s_barrier
    s_barrier
    s_barrier
    s_branch h_wo
h_qkvB:
    s_mul_i32 s98, s9, 786432
    s_add_u32 s98, s98, 65273856
    s_lshl_b32 s99, s11, 10
    s_add_u32 s98, s98, s99
    s_add_u32 s96, s4, s98
    s_addc_u32 s97, s5, 0
    s_mov_b32 s98, s10
    s_mov_b32 s99, s10
    v_and_b32 v1, 63, v0
    v_lshlrev_b32 v5, 4, v1
    v_and_b32 v20, 15, v1
    v_lshrrev_b32 v11, 4, v1
    v_min_u32 v11, 2, v11
    v_lshlrev_b32 v21, 3, v20
    v_lshl_add_u32 v12, v11, 7, v21
    v_add_u32 v12, 156032, v12
    v_lshl_add_u32 v11, v11, 16, v21
    v_mov_b32 v10, 159496
    s_add_u32 s3, s9, 1
    v_mov_b32 v13, s3
    s_mov_b32 s3, 0x20000
poll_9:
    s_load_dwordx8 s[88:95], s[96:97], 0 glc
    s_sub_u32 s3, s3, 1
    s_cbranch_scc1 poll_9_ok
    s_waitcnt lgkmcnt(0)
    s_xor_b64 s[100:101], s[88:89], s[98:99]
    s_xor_b64 s[88:89], s[90:91], s[98:99]
    s_or_b64 s[100:101], s[100:101], s[88:89]
    s_xor_b64 s[88:89], s[92:93], s[98:99]
    s_or_b64 s[100:101], s[100:101], s[88:89]
    s_xor_b64 s[88:89], s[94:95], s[98:99]
    s_or_b64 s[100:101], s[100:101], s[88:89]
    s_cbranch_scc1 poll_9
poll_9_ok:
    s_waitcnt lgkmcnt(0)
    ds_write_b32 v10, v13
    s_barrier
    s_lshl_b32 s56, s7, 12
    s_and_b32 s57, s6, 1
    s_lshl_b32 s57, s57, 7
    s_add_u32 s56, s56, s57
    s_add_u32 s56, s56, 64159744
    s_and_b32 s58, s6, 14
    s_lshl_b32 s58, s58, 18
    s_lshl_b32 s57, s9, 22
    s_add_u32 s58, s58, s57
    s_and_b32 s57, s7, 3
    s_lshl_b32 s57, s57, 11
    s_add_u32 s58, s58, s57
    s_barrier
    s_barrier
    s_barrier
    buffer_load_dwordx2 v[32:33], v11, s[12:15], s56 offen offset:0 sc1
    buffer_load_dwordx2 v[34:35], v11, s[12:15], s56 offen offset:256 sc1
    buffer_load_dwordx2 v[36:37], v11, s[12:15], s56 offen offset:512 sc1
    buffer_load_dwordx2 v[38:39], v11, s[12:15], s56 offen offset:768 sc1
    buffer_load_dwordx2 v[40:41], v11, s[12:15], s56 offen offset:1024 sc1
    buffer_load_dwordx2 v[42:43], v11, s[12:15], s56 offen offset:1280 sc1
    buffer_load_dwordx2 v[44:45], v11, s[12:15], s56 offen offset:1536 sc1
    buffer_load_dwordx2 v[46:47], v11, s[12:15], s56 offen offset:1792 sc1
    buffer_load_dwordx2 v[48:49], v11, s[12:15], s56 offen offset:2048 sc1
    buffer_load_dwordx2 v[50:51], v11, s[12:15], s56 offen offset:2304 sc1
    buffer_load_dwordx2 v[52:53], v11, s[12:15], s56 offen offset:2560 sc1
    buffer_load_dwordx2 v[54:55], v11, s[12:15], s56 offen offset:2816 sc1
    s_barrier
    buffer_load_dwordx2 v[56:57], v11, s[12:15], s56 offen offset:3072 sc1
    buffer_load_dwordx2 v[58:59], v11, s[12:15], s56 offen offset:3328 sc1
    buffer_load_dwordx2 v[60:61], v11, s[12:15], s56 offen offset:3584 sc1
    buffer_load_dwordx2 v[62:63], v11, s[12:15], s56 offen offset:3840 sc1
    s_barrier
    s_waitcnt vmcnt(0)
    v_add_f32 v32, v32, v48
    v_add_f32 v33, v33, v49
    v_add_f32 v34, v34, v50
    v_add_f32 v35, v35, v51
    v_add_f32 v36, v36, v52
    v_add_f32 v37, v37, v53
    v_add_f32 v38, v38, v54
    v_add_f32 v39, v39, v55
    v_add_f32 v40, v40, v56
    v_add_f32 v41, v41, v57
    v_add_f32 v42, v42, v58
    v_add_f32 v43, v43, v59
    s_barrier
    v_add_f32 v44, v44, v60
    v_add_f32 v45, v45, v61
    v_add_f32 v46, v46, v62
    v_add_f32 v47, v47, v63
    v_add_f32 v32, v32, v40
    v_add_f32 v33, v33, v41
    v_add_f32 v34, v34, v42
    v_add_f32 v35, v35, v43
    v_add_f32 v36, v36, v44
    v_add_f32 v37, v37, v45
    v_add_f32 v38, v38, v46
    v_add_f32 v39, v39, v47
    s_barrier
    v_add_f32 v32, v32, v36
    v_add_f32 v33, v33, v37
    v_add_f32 v34, v34, v38
    v_add_f32 v35, v35, v39
    v_add_f32 v32, v32, v34
    v_add_f32 v33, v33, v35
    ds_write_b64 v12, v[32:33]
    s_waitcnt lgkmcnt(0)
    s_barrier
    s_barrier
    s_branch s_attn
.p2align 6
l_first:
    s_sub_u32 s51, s8, 5
    s_lshl_b32 s61, s51, 8
    s_add_u32 s61, s61, s2
    s_and_b32 s62, s61, 15
    s_lshr_b32 s63, s61, 4
    v_lshrrev_b32 v20, 3, v1
    v_mul_u32_u24 v12, 6144, v20
    v_and_b32 v21, 7, v1
    v_lshl_add_u32 v12, v21, 4, v12
    s_mov_b32 s20, s34
    s_mov_b32 s21, s35
    s_mov_b32 s22, 6291456
    s_mov_b32 s23, 0x00020000
    s_mov_b32 s28, s40
    s_mov_b32 s29, s41
    s_mov_b32 s30, 6291456
    s_mov_b32 s31, 0x00020000
    s_mul_i32 s52, s62, 393216
    s_lshl_b32 s56, s63, 7
    s_add_u32 s52, s52, s56
    s_barrier
    s_add_u32 s53, s52, 0
    buffer_load_dwordx4 v[136:139], v12, s[20:23], s53 offen nt
    s_add_u32 s53, s52, 49152
    buffer_load_dwordx4 v[140:143], v12, s[20:23], s53 offen nt
    s_add_u32 s53, s52, 98304
    buffer_load_dwordx4 v[144:147], v12, s[20:23], s53 offen nt
    s_add_u32 s53, s52, 147456
    buffer_load_dwordx4 v[148:151], v12, s[20:23], s53 offen nt
    v_lshlrev_b32 v14, 6, v20
    v_lshrrev_b32 v22, 5, v1
    v_bfe_u32 v23, v1, 1, 1
    v_xor_b32 v22, v22, v23
    v_lshl_add_u32 v14, v22, 5, v14
    v_and_b32 v22, 1, v1
    v_lshl_add_u32 v14, v22, 4, v14
    v_bfe_u32 v23, v1, 2, 1
    v_mul_u32_u24 v23, 196608, v23
    v_add_u32 v14, v14, v23
    v_lshlrev_b32 v22, 4, v22
    v_mov_b32 v23, 0x3f80
    v_lshlrev_b32 v23, v22, v23
    v_bfe_u32 v22, v1, 1, 3
    v_cmp_eq_u32 vcc, 0, v22
    s_nop 1
    v_cndmask_b32 v24, 0, v23, vcc
    v_cmp_eq_u32 vcc, 1, v22
    s_nop 1
    v_cndmask_b32 v25, 0, v23, vcc
    v_cmp_eq_u32 vcc, 2, v22
    s_nop 1
    v_cndmask_b32 v26, 0, v23, vcc
    v_cmp_eq_u32 vcc, 3, v22
    s_nop 1
    v_cndmask_b32 v27, 0, v23, vcc
    v_lshlrev_b32 v15, 5, v21
    v_and_b32 v22, 16, v1
    v_add_u32 v15, v15, v22
    v_lshlrev_b32 v16, 14, v1
    s_mov_b32 s9, 0
    s_lshr_b32 s55, s63, 4
    s_and_b32 s56, s63, 15
    s_mul_i32 s57, s56, 6
    s_add_u32 s57, s57, s55
    s_lshl_b32 s57, s57, 16
    s_lshl_b32 s58, s62, 12
    s_add_u32 s57, s57, s58
    s_add_u32 s57, s57, 50331648
    s_lshl_b32 s54, s61, 8
    s_add_u32 s54, s54, 63963136
    s_lshl_b32 s56, s56, 10
    s_lshl_b32 s55, s55, 7
    s_add_u32 s55, s55, s56
    s_lshl_b32 s56, s62, 2
    s_add_u32 s55, s55, s56
    s_add_u32 s55, s55, 64487424
    s_waitcnt vmcnt(3)
    s_add_u32 s53, s52, 196608
    buffer_load_dwordx4 v[152:155], v12, s[20:23], s53 offen nt
    s_add_u32 s53, s52, 245760
    buffer_load_dwordx4 v[156:159], v12, s[20:23], s53 offen nt
    s_add_u32 s53, s52, 294912
    buffer_load_dwordx4 v[160:163], v12, s[20:23], s53 offen nt
    buffer_store_dwordx4 v[136:139], v14, s[12:15], s57 offen offset:0 sc1
    v_mfma_f32_16x16x32_bf16 v[28:31], v[24:27], v[136:139], 0
    s_barrier
    s_waitcnt vmcnt(6)
    s_add_u32 s53, s52, 344064
    buffer_load_dwordx4 v[164:167], v12, s[20:23], s53 offen nt
    buffer_store_dwordx4 v[140:143], v14, s[12:15], s57 offen offset:512 sc1
    v_mfma_f32_16x16x32_bf16 v[28:31], v[24:27], v[140:143], v[28:31]
    s_waitcnt vmcnt(7)
    buffer_store_dwordx4 v[144:147], v14, s[12:15], s57 offen offset:1024 sc1
    v_mfma_f32_16x16x32_bf16 v[28:31], v[24:27], v[144:147], v[28:31]
    s_waitcnt vmcnt(7)
    buffer_store_dwordx4 v[148:151], v14, s[12:15], s57 offen offset:1536 sc1
    v_mfma_f32_16x16x32_bf16 v[28:31], v[24:27], v[148:151], v[28:31]
    s_waitcnt vmcnt(7)
    buffer_store_dwordx4 v[152:155], v14, s[12:15], s57 offen offset:2048 sc1
    v_mfma_f32_16x16x32_bf16 v[28:31], v[24:27], v[152:155], v[28:31]
    s_waitcnt vmcnt(7)
    buffer_store_dwordx4 v[156:159], v14, s[12:15], s57 offen offset:2560 sc1
    v_mfma_f32_16x16x32_bf16 v[28:31], v[24:27], v[156:159], v[28:31]
    s_waitcnt vmcnt(7)
    buffer_store_dwordx4 v[160:163], v14, s[12:15], s57 offen offset:3072 sc1
    v_mfma_f32_16x16x32_bf16 v[28:31], v[24:27], v[160:163], v[28:31]
    s_waitcnt vmcnt(6)
    buffer_store_dwordx4 v[164:167], v14, s[12:15], s57 offen offset:3584 sc1
    v_mfma_f32_16x16x32_bf16 v[28:31], v[24:27], v[164:167], v[28:31]
    s_nop 7
    v_add_f32_dpp v28, v28, v28 row_ror:8 row_mask:0xf bank_mask:0xf
    v_add_f32_dpp v29, v29, v29 row_ror:8 row_mask:0xf bank_mask:0xf
    v_add_f32_dpp v30, v30, v30 row_ror:8 row_mask:0xf bank_mask:0xf
    v_add_f32_dpp v31, v31, v31 row_ror:8 row_mask:0xf bank_mask:0xf
    s_mov_b64 exec, 0x00ff00ff
    buffer_store_dwordx4 v[28:31], v15, s[12:15], s54 offen sc1
    s_mov_b64 exec, -1
    s_add_u32 s57, s57, 6291456
    s_add_u32 s54, s54, 196608
    s_add_u32 s53, s52, 0
    buffer_load_dwordx4 v[168:171], v12, s[28:31], s53 offen nt
    s_add_u32 s53, s52, 49152
    buffer_load_dwordx4 v[172:175], v12, s[28:31], s53 offen nt
    s_add_u32 s53, s52, 98304
    buffer_load_dwordx4 v[176:179], v12, s[28:31], s53 offen nt
    s_add_u32 s53, s52, 147456
    buffer_load_dwordx4 v[180:183], v12, s[28:31], s53 offen nt
    s_add_u32 s53, s52, 196608
    buffer_load_dwordx4 v[184:187], v12, s[28:31], s53 offen nt
    s_add_u32 s53, s52, 245760
    buffer_load_dwordx4 v[188:191], v12, s[28:31], s53 offen nt
    s_add_u32 s53, s52, 294912
    buffer_load_dwordx4 v[192:195], v12, s[28:31], s53 offen nt
    s_add_u32 s53, s52, 344064
    buffer_load_dwordx4 v[196:199], v12, s[28:31], s53 offen nt
    v_mov_b32 v8, 159492
non_10:
    ds_read_b32 v9, v8
    s_waitcnt lgkmcnt(0)
    v_readfirstlane_b32 s10, v9
    s_cmp_eq_u32 s10, 0
    s_cbranch_scc1 non_10
    s_mov_b64 exec, 0xffff
    s_waitcnt vmcnt(8)
    buffer_store_dword v9, v16, s[12:15], s55 offen offset:0 sc1
    s_mov_b64 exec, -1
    s_mov_b32 s58, s52
    s_lshr_b32 s60, s2, 3
    s_mul_i32 s60, s60, 3
    s_lshr_b32 s60, s60, 5
    s_add_u32 s60, s60, 1
    s_branch l_qkv2
l_qkv:
    s_mov_b32 s60, 0
l_qkv2:
    v_and_b32 v1, 63, v0
    v_lshlrev_b32 v5, 4, v1
    s_sub_u32 s51, s8, 5
    s_lshl_b32 s48, s51, 13
    s_and_b32 s53, s9, 1
    s_lshl_b32 s52, s53, 4
    s_add_u32 s49, s7, s52
    s_lshl_b32 s49, s49, 1
    s_and_b32 s52, s6, 1
    s_add_u32 s49, s49, s52
    s_mul_i32 s49, s49, 3
    s_add_u32 s49, s49, s51
    s_lshl_b32 s49, s49, 16
    s_add_u32 s49, s49, 50331648
    v_mov_b32 v13, 159496
    s_cmp_lg_u32 s9, 0
    s_cbranch_scc1 l_qkv_tiled
    s_lshl_b32 s53, s8, 7
    s_lshl_b32 s52, s11, 10
    s_add_u32 s53, s53, s52
    s_add_u32 s53, s53, 64486784
    s_add_u32 s96, s4, s53
    s_addc_u32 s97, s5, 0
    s_mov_b32 s98, s10
    s_mov_b32 s99, s10
    s_mov_b32 s3, 0x20000
poll_11:
    s_load_dwordx16 s[80:95], s[96:97], 0 glc
    s_sub_u32 s3, s3, 1
    s_cbranch_scc1 poll_11_ok
    s_waitcnt lgkmcnt(0)
    s_xor_b64 s[100:101], s[80:81], s[98:99]
    s_xor_b64 s[80:81], s[82:83], s[98:99]
    s_or_b64 s[100:101], s[100:101], s[80:81]
    s_xor_b64 s[80:81], s[84:85], s[98:99]
    s_or_b64 s[100:101], s[100:101], s[80:81]
    s_xor_b64 s[80:81], s[86:87], s[98:99]
    s_or_b64 s[100:101], s[100:101], s[80:81]
    s_xor_b64 s[80:81], s[88:89], s[98:99]
    s_or_b64 s[100:101], s[100:101], s[80:81]
    s_xor_b64 s[80:81], s[90:91], s[98:99]
    s_or_b64 s[100:101], s[100:101], s[80:81]
    s_xor_b64 s[80:81], s[92:93], s[98:99]
    s_or_b64 s[100:101], s[100:101], s[80:81]
    s_xor_b64 s[80:81], s[94:95], s[98:99]
    s_or_b64 s[100:101], s[100:101], s[80:81]
    s_cbranch_scc1 poll_11
poll_11_ok:
    s_waitcnt lgkmcnt(0)
l_qkv_tiled:
    s_mov_b32 s50, 0
    s_mov_b32 m0, s48
    s_add_u32 s50, s50, 1
    buffer_load_dwordx4 v5, s[12:15], s49 offen offset:0 sc1 lds
    buffer_load_dwordx4 v5, s[12:15], s49 offen offset:1024 sc1 lds
    buffer_load_dwordx4 v5, s[12:15], s49 offen offset:2048 sc1 lds
    buffer_load_dwordx4 v5, s[12:15], s49 offen offset:3072 sc1 lds
    s_add_u32 s49, s49, 4096
    s_bitcmp1_b32 s50, 0
    s_cselect_b32 s3, 0, 16384
    s_add_u32 s48, s48, s3
    s_cmp_eq_u32 s50, 12
    s_cselect_b32 s3, 4294819840, 0
    s_add_u32 s48, s48, 4096
    s_add_u32 s48, s48, s3
    s_mov_b32 m0, s48
    s_add_u32 s50, s50, 1
    buffer_load_dwordx4 v5, s[12:15], s49 offen offset:0 sc1 lds
    buffer_load_dwordx4 v5, s[12:15], s49 offen offset:1024 sc1 lds
    buffer_load_dwordx4 v5, s[12:15], s49 offen offset:2048 sc1 lds
    buffer_load_dwordx4 v5, s[12:15], s49 offen offset:3072 sc1 lds
    s_add_u32 s49, s49, 4096
    s_bitcmp1_b32 s50, 0
    s_cselect_b32 s3, 0, 16384
    s_add_u32 s48, s48, s3
    s_cmp_eq_u32 s50, 12
    s_cselect_b32 s3, 4294819840, 0
    s_add_u32 s48, s48, 4096
    s_add_u32 s48, s48, s3
    v_lshrrev_b32 v10, 4, v1
    v_and_b32 v11, 0xff, v5
    v_lshl_add_u32 v10, v10, 12, v11
    s_lshl_b32 s3, s51, 9
    s_add_u32 s3, s3, 155648
    v_lshl_add_u32 v11, v1, 3, s3
    s_and_b32 s59, s6, 14
    s_add_u32 s59, s59, s51
    s_sub_u32 s59, s59, 1
    s_max_i32 s59, s59, 0
    s_lshl_b32 s59, s59, 14
    s_lshl_b32 s3, s9, 18
    s_add_u32 s59, s59, s3
    s_add_u32 s59, s59, 62914560
    s_and_b32 s3, s9, 1
    s_lshl_b32 s3, s3, 3
    s_add_u32 s3, s3, 56
    s_cmp_eq_u32 s51, 0
    s_cselect_b32 s3, s3, 0
    v_cmp_gt_u32 vcc, s3, v1
    v_mov_b32 v20, 0x7ff00000
    s_nop 0
    v_cndmask_b32 v10, v10, v20, vcc
    s_lshl_b32 s3, s7, 7
    v_lshrrev_b32 v20, 3, v1
    v_lshlrev_b32 v21, 11, v20
    v_lshrrev_b32 v22, 2, v1
    v_lshrrev_b32 v23, 4, v1
    v_xor_b32 v22, v22, v23
    v_and_b32 v22, 1, v22
    v_lshl_add_u32 v21, v22, 6, v21
    v_and_b32 v22, 3, v1
    v_lshl_add_u32 v21, v22, 4, v21
    v_add_u32 v17, s3, v21
    s_add_u32 s52, s9, 1
    s_mov_b32 m0, s48
    s_add_u32 s50, s50, 1
    buffer_load_dwordx4 v5, s[12:15], s49 offen offset:0 sc1 lds
    s_waitcnt vmcnt(10)
    buffer_load_dwordx4 v5, s[12:15], s49 offen offset:1024 sc1 lds
    s_waitcnt vmcnt(10)
    buffer_load_dwordx4 v5, s[12:15], s49 offen offset:2048 sc1 lds
    s_waitcnt vmcnt(10)
    buffer_load_dwordx4 v5, s[12:15], s49 offen offset:3072 sc1 lds
    s_waitcnt vmcnt(10)
    s_add_u32 s49, s49, 4096
    s_bitcmp1_b32 s50, 0
    s_cselect_b32 s3, 0, 16384
    s_add_u32 s48, s48, s3
    s_cmp_eq_u32 s50, 12
    s_cselect_b32 s3, 4294819840, 0
    s_add_u32 s48, s48, 4096
    s_add_u32 s48, s48, s3
l_qkv_pre:
    s_mov_b32 m0, s48
    s_add_u32 s50, s50, 1
    buffer_load_dwordx4 v5, s[12:15], s49 offen offset:0 sc1 lds
    s_waitcnt vmcnt(10)
    buffer_load_dwordx4 v5, s[12:15], s49 offen offset:1024 sc1 lds
    s_waitcnt vmcnt(10)
    buffer_load_dwordx4 v5, s[12:15], s49 offen offset:2048 sc1 lds
    s_waitcnt vmcnt(10)
    buffer_load_dwordx4 v5, s[12:15], s49 offen offset:3072 sc1 lds
    s_waitcnt vmcnt(10)
    s_add_u32 s49, s49, 4096
    s_bitcmp1_b32 s50, 0
    s_cselect_b32 s3, 0, 16384
    s_add_u32 s48, s48, s3
    s_cmp_eq_u32 s50, 12
    s_cselect_b32 s3, 4294819840, 0
    s_add_u32 s48, s48, 4096
    s_add_u32 s48, s48, s3
    ds_read_b32 v8, v13
    s_cmp_ge_u32 s50, 12
    s_cbranch_scc1 l_qkv_go
    s_waitcnt lgkmcnt(0)
    v_readfirstlane_b32 s3, v8
    s_cmp_lg_u32 s3, s52
    s_cbranch_scc1 l_qkv_pre
    s_cmp_ge_u32 s50, 5
    s_cbranch_scc1 l_qkv_go
    s_waitcnt vmcnt(8)
l_qkv_go:
    s_waitcnt lgkmcnt(0)
    s_barrier
    s_barrier
    s_bitcmp0_b32 s50, 0
    s_cbranch_scc1 l_qkv_even
    s_mov_b32 m0, s48
    s_add_u32 s50, s50, 1
    buffer_load_dwordx4 v5, s[12:15], s49 offen offset:0 sc1 lds
    buffer_load_dwordx4 v5, s[12:15], s49 offen offset:1024 sc1 lds
    buffer_load_dwordx4 v5, s[12:15], s49 offen offset:2048 sc1 lds
    buffer_load_dwordx4 v5, s[12:15], s49 offen offset:3072 sc1 lds
    s_add_u32 s49, s49, 4096
    s_bitcmp1_b32 s50, 0
    s_cselect_b32 s3, 0, 16384
    s_add_u32 s48, s48, s3
    s_cmp_eq_u32 s50, 12
    s_cselect_b32 s3, 4294819840, 0
    s_add_u32 s48, s48, 4096
    s_add_u32 s48, s48, s3
l_qkv_even:
    s_cmp_gt_u32 s50, 10
    s_cbranch_scc1 stg_12
    s_mov_b32 m0, s48
    s_add_u32 s50, s50, 1
    buffer_load_dwordx4 v5, s[12:15], s49 offen offset:0 sc1 lds
    buffer_load_dwordx4 v5, s[12:15], s49 offen offset:1024 sc1 lds
    buffer_load_dwordx4 v5, s[12:15], s49 offen offset:2048 sc1 lds
    buffer_load_dwordx4 v5, s[12:15], s49 offen offset:3072 sc1 lds
    s_add_u32 s49, s49, 4096
    s_bitcmp1_b32 s50, 0
    s_cselect_b32 s3, 0, 16384
    s_add_u32 s48, s48, s3
    s_cmp_eq_u32 s50, 12
    s_cselect_b32 s3, 4294819840, 0
    s_add_u32 s48, s48, 4096
    s_add_u32 s48, s48, s3
    s_mov_b32 m0, s48
    s_add_u32 s50, s50, 1
    buffer_load_dwordx4 v5, s[12:15], s49 offen offset:0 sc1 lds
    buffer_load_dwordx4 v5, s[12:15], s49 offen offset:1024 sc1 lds
    buffer_load_dwordx4 v5, s[12:15], s49 offen offset:2048 sc1 lds
    buffer_load_dwordx4 v5, s[12:15], s49 offen offset:3072 sc1 lds
    s_add_u32 s49, s49, 4096
    s_bitcmp1_b32 s50, 0
    s_cselect_b32 s3, 0, 16384
    s_add_u32 s48, s48, s3
    s_cmp_eq_u32 s50, 12
    s_cselect_b32 s3, 4294819840, 0
    s_add_u32 s48, s48, 4096
    s_add_u32 s48, s48, s3
stg_12:
    s_waitcnt vmcnt(8)
    s_barrier
    s_cmp_gt_u32 s50, 12
    s_cbranch_scc1 stg_13
    s_mov_b32 m0, s48
    s_add_u32 s50, s50, 1
    buffer_load_dwordx4 v5, s[12:15], s49 offen offset:0 sc1 lds
    buffer_load_dwordx4 v5, s[12:15], s49 offen offset:1024 sc1 lds
    buffer_load_dwordx4 v5, s[12:15], s49 offen offset:2048 sc1 lds
    buffer_load_dwordx4 v5, s[12:15], s49 offen offset:3072 sc1 lds
    s_add_u32 s49, s49, 4096
    s_bitcmp1_b32 s50, 0
    s_cselect_b32 s3, 0, 16384
    s_add_u32 s48, s48, s3
    s_cmp_eq_u32 s50, 12
    s_cselect_b32 s3, 4294819840, 0
    s_add_u32 s48, s48, 4096
    s_add_u32 s48, s48, s3
    s_mov_b32 m0, s48
    s_add_u32 s50, s50, 1
    buffer_load_dwordx4 v5, s[12:15], s49 offen offset:0 sc1 lds
    buffer_load_dwordx4 v5, s[12:15], s49 offen offset:1024 sc1 lds
    buffer_load_dwordx4 v5, s[12:15], s49 offen offset:2048 sc1 lds
    buffer_load_dwordx4 v5, s[12:15], s49 offen offset:3072 sc1 lds
    s_add_u32 s49, s49, 4096
    s_bitcmp1_b32 s50, 0
    s_cselect_b32 s3, 0, 16384
    s_add_u32 s48, s48, s3
    s_cmp_eq_u32 s50, 12
    s_cselect_b32 s3, 4294819840, 0
    s_add_u32 s48, s48, 4096
    s_add_u32 s48, s48, s3
stg_13:
    s_cmp_eq_u32 s60, 0
    s_cbranch_scc1 ub_14
    buffer_store_dwordx4 v[168:171], v14, s[12:15], s57 offen offset:0 sc1
    v_mfma_f32_16x16x32_bf16 v[28:31], v[24:27], v[168:171], 0
    buffer_store_dwordx4 v[172:175], v14, s[12:15], s57 offen offset:512 sc1
    v_mfma_f32_16x16x32_bf16 v[28:31], v[24:27], v[172:175], v[28:31]
ub_14:
    buffer_load_dwordx4 v[72:75], v10, s[12:15], s59 offen offset:0 sc1
    buffer_load_dwordx4 v[76:79], v10, s[12:15], s59 offen offset:256 sc1
    buffer_load_dwordx4 v[80:83], v10, s[12:15], s59 offen offset:512 sc1
    buffer_load_dwordx4 v[84:87], v10, s[12:15], s59 offen offset:768 sc1
    buffer_load_dwordx4 v[88:91], v10, s[12:15], s59 offen offset:1024 sc1
    buffer_load_dwordx4 v[92:95], v10, s[12:15], s59 offen offset:1280 sc1
    buffer_load_dwordx4 v[96:99], v10, s[12:15], s59 offen offset:1536 sc1
    buffer_load_dwordx4 v[100:103], v10, s[12:15], s59 offen offset:1792 sc1
    buffer_load_dwordx4 v[104:107], v10, s[12:15], s59 offen offset:2048 sc1
    buffer_load_dwordx4 v[108:111], v10, s[12:15], s59 offen offset:2304 sc1
    s_waitcnt vmcnt(8)
    s_barrier
    s_cmp_gt_u32 s50, 14
    s_cbranch_scc1 stg_15
    s_mov_b32 m0, s48
    s_add_u32 s50, s50, 1
    buffer_load_dwordx4 v5, s[12:15], s49 offen offset:0 sc1 lds
    buffer_load_dwordx4 v5, s[12:15], s49 offen offset:1024 sc1 lds
    buffer_load_dwordx4 v5, s[12:15], s49 offen offset:2048 sc1 lds
    buffer_load_dwordx4 v5, s[12:15], s49 offen offset:3072 sc1 lds
    s_add_u32 s49, s49, 4096
    s_bitcmp1_b32 s50, 0
    s_cselect_b32 s3, 0, 16384
    s_add_u32 s48, s48, s3
    s_cmp_eq_u32 s50, 12
    s_cselect_b32 s3, 4294819840, 0
    s_add_u32 s48, s48, 4096
    s_add_u32 s48, s48, s3
    s_mov_b32 m0, s48
    s_add_u32 s50, s50, 1
    buffer_load_dwordx4 v5, s[12:15], s49 offen offset:0 sc1 lds
    buffer_load_dwordx4 v5, s[12:15], s49 offen offset:1024 sc1 lds
    buffer_load_dwordx4 v5, s[12:15], s49 offen offset:2048 sc1 lds
    buffer_load_dwordx4 v5, s[12:15], s49 offen offset:3072 sc1 lds
    s_add_u32 s49, s49, 4096
    s_bitcmp1_b32 s50, 0
    s_cselect_b32 s3, 0, 16384
    s_add_u32 s48, s48, s3
    s_cmp_eq_u32 s50, 12
    s_cselect_b32 s3, 4294819840, 0
    s_add_u32 s48, s48, 4096
    s_add_u32 s48, s48, s3
stg_15:
    s_cmp_eq_u32 s60, 0
    s_cbranch_scc1 ub_16
    buffer_store_dwordx4 v[176:179], v14, s[12:15], s57 offen offset:1024 sc1
    v_mfma_f32_16x16x32_bf16 v[28:31], v[24:27], v[176:179], v[28:31]
    buffer_store_dwordx4 v[180:183], v14, s[12:15], s57 offen offset:1536 sc1
    v_mfma_f32_16x16x32_bf16 v[28:31], v[24:27], v[180:183], v[28:31]
ub_16:
    buffer_load_dwordx4 v[112:115], v10, s[12:15], s59 offen offset:2560 sc1
    buffer_load_dwordx4 v[116:119], v10, s[12:15], s59 offen offset:2816 sc1
    buffer_load_dwordx4 v[120:123], v10, s[12:15], s59 offen offset:3072 sc1
    buffer_load_dwordx4 v[124:127], v10, s[12:15], s59 offen offset:3328 sc1
    buffer_load_dwordx4 v[128:131], v10, s[12:15], s59 offen offset:3584 sc1
    buffer_load_dwordx4 v[132:135], v10, s[12:15], s59 offen offset:3840 sc1
    s_waitcnt vmcnt(8)
    s_barrier
    s_waitcnt vmcnt(0)
    s_cmp_gt_u32 s50, 14
    s_cbranch_scc1 stg_17
    s_mov_b32 m0, s48
    s_add_u32 s50, s50, 1
    buffer_load_dwordx4 v5, s[12:15], s49 offen offset:0 sc1 lds
    buffer_load_dwordx4 v5, s[12:15], s49 offen offset:1024 sc1 lds
    buffer_load_dwordx4 v5, s[12:15], s49 offen offset:2048 sc1 lds
    buffer_load_dwordx4 v5, s[12:15], s49 offen offset:3072 sc1 lds
    s_add_u32 s49, s49, 4096
    s_bitcmp1_b32 s50, 0
    s_cselect_b32 s3, 0, 16384
    s_add_u32 s48, s48, s3
    s_cmp_eq_u32 s50, 12
    s_cselect_b32 s3, 4294819840, 0
    s_add_u32 s48, s48, 4096
    s_add_u32 s48, s48, s3
    s_mov_b32 m0, s48
    s_add_u32 s50, s50, 1
    buffer_load_dwordx4 v5, s[12:15], s49 offen offset:0 sc1 lds
    buffer_load_dwordx4 v5, s[12:15], s49 offen offset:1024 sc1 lds
    buffer_load_dwordx4 v5, s[12:15], s49 offen offset:2048 sc1 lds
    buffer_load_dwordx4 v5, s[12:15], s49 offen offset:3072 sc1 lds
    s_add_u32 s49, s49, 4096
    s_bitcmp1_b32 s50, 0
    s_cselect_b32 s3, 0, 16384
    s_add_u32 s48, s48, s3
    s_cmp_eq_u32 s50, 12
    s_cselect_b32 s3, 4294819840, 0
    s_add_u32 s48, s48, 4096
    s_add_u32 s48, s48, s3
stg_17:
    s_cmp_eq_u32 s60, 0
    s_cbranch_scc1 ub_18
    buffer_store_dwordx4 v[184:187], v14, s[12:15], s57 offen offset:2048 sc1
    v_mfma_f32_16x16x32_bf16 v[28:31], v[24:27], v[184:187], v[28:31]
    buffer_store_dwordx4 v[188:191], v14, s[12:15], s57 offen offset:2560 sc1
    v_mfma_f32_16x16x32_bf16 v[28:31], v[24:27], v[188:191], v[28:31]
ub_18:
    v_add_f32 v72, v72, v104
    v_add_f32 v73, v73, v105
    v_add_f32 v74, v74, v106
    v_add_f32 v75, v75, v107
    v_add_f32 v76, v76, v108
    v_add_f32 v77, v77, v109
    v_add_f32 v78, v78, v110
    v_add_f32 v79, v79, v111
    v_add_f32 v80, v80, v112
    v_add_f32 v81, v81, v113
    v_add_f32 v82, v82, v114
    v_add_f32 v83, v83, v115
    v_add_f32 v84, v84, v116
    v_add_f32 v85, v85, v117
    v_add_f32 v86, v86, v118
    v_add_f32 v87, v87, v119
    v_add_f32 v88, v88, v120
    v_add_f32 v89, v89, v121
    v_add_f32 v90, v90, v122
    s_waitcnt vmcnt(8)
    s_barrier
    s_cmp_gt_u32 s50, 14
    s_cbranch_scc1 stg_19
    s_mov_b32 m0, s48
    s_add_u32 s50, s50, 1
    buffer_load_dwordx4 v5, s[12:15], s49 offen offset:0 sc1 lds
    buffer_load_dwordx4 v5, s[12:15], s49 offen offset:1024 sc1 lds
    buffer_load_dwordx4 v5, s[12:15], s49 offen offset:2048 sc1 lds
    buffer_load_dwordx4 v5, s[12:15], s49 offen offset:3072 sc1 lds
    s_add_u32 s49, s49, 4096
    s_bitcmp1_b32 s50, 0
    s_cselect_b32 s3, 0, 16384
    s_add_u32 s48, s48, s3
    s_cmp_eq_u32 s50, 12
    s_cselect_b32 s3, 4294819840, 0
    s_add_u32 s48, s48, 4096
    s_add_u32 s48, s48, s3
    s_mov_b32 m0, s48
    s_add_u32 s50, s50, 1
    buffer_load_dwordx4 v5, s[12:15], s49 offen offset:0 sc1 lds
    buffer_load_dwordx4 v5, s[12:15], s49 offen offset:1024 sc1 lds
    buffer_load_dwordx4 v5, s[12:15], s49 offen offset:2048 sc1 lds
    buffer_load_dwordx4 v5, s[12:15], s49 offen offset:3072 sc1 lds
    s_add_u32 s49, s49, 4096
    s_bitcmp1_b32 s50, 0
    s_cselect_b32 s3, 0, 16384
    s_add_u32 s48, s48, s3
    s_cmp_eq_u32 s50, 12
    s_cselect_b32 s3, 4294819840, 0
    s_add_u32 s48, s48, 4096
    s_add_u32 s48, s48, s3
stg_19:
    s_cmp_eq_u32 s60, 0
    s_cbranch_scc1 ub_20
    buffer_store_dwordx4 v[192:195], v14, s[12:15], s57 offen offset:3072 sc1
    v_mfma_f32_16x16x32_bf16 v[28:31], v[24:27], v[192:195], v[28:31]
    buffer_store_dwordx4 v[196:199], v14, s[12:15], s57 offen offset:3584 sc1
    v_mfma_f32_16x16x32_bf16 v[28:31], v[24:27], v[196:199], v[28:31]
ub_20:
    v_add_f32 v91, v91, v123
    v_add_f32 v92, v92, v124
    v_add_f32 v93, v93, v125
    v_add_f32 v94, v94, v126
    v_add_f32 v95, v95, v127
    v_add_f32 v96, v96, v128
    v_add_f32 v97, v97, v129
    v_add_f32 v98, v98, v130
    v_add_f32 v99, v99, v131
    v_add_f32 v100, v100, v132
    v_add_f32 v101, v101, v133
    v_add_f32 v102, v102, v134
    v_add_f32 v103, v103, v135
    v_add_f32 v72, v72, v88
    v_add_f32 v73, v73, v89
    v_add_f32 v74, v74, v90
    v_add_f32 v75, v75, v91
    v_add_f32 v76, v76, v92
    v_add_f32 v77, v77, v93
    s_waitcnt vmcnt(8)
    s_barrier
    s_cmp_gt_u32 s50, 14
    s_cbranch_scc1 stg_21
    s_mov_b32 m0, s48
    s_add_u32 s50, s50, 1
    buffer_load_dwordx4 v5, s[12:15], s49 offen offset:0 sc1 lds
    buffer_load_dwordx4 v5, s[12:15], s49 offen offset:1024 sc1 lds
    buffer_load_dwordx4 v5, s[12:15], s49 offen offset:2048 sc1 lds
    buffer_load_dwordx4 v5, s[12:15], s49 offen offset:3072 sc1 lds
    s_add_u32 s49, s49, 4096
    s_bitcmp1_b32 s50, 0
    s_cselect_b32 s3, 0, 16384
    s_add_u32 s48, s48, s3
    s_cmp_eq_u32 s50, 12
    s_cselect_b32 s3, 4294819840, 0
    s_add_u32 s48, s48, 4096
    s_add_u32 s48, s48, s3
    s_mov_b32 m0, s48
    s_add_u32 s50, s50, 1
    buffer_load_dwordx4 v5, s[12:15], s49 offen offset:0 sc1 lds
    buffer_load_dwordx4 v5, s[12:15], s49 offen offset:1024 sc1 lds
    buffer_load_dwordx4 v5, s[12:15], s49 offen offset:2048 sc1 lds
    buffer_load_dwordx4 v5, s[12:15], s49 offen offset:3072 sc1 lds
    s_add_u32 s49, s49, 4096
    s_bitcmp1_b32 s50, 0
    s_cselect_b32 s3, 0, 16384
    s_add_u32 s48, s48, s3
    s_cmp_eq_u32 s50, 12
    s_cselect_b32 s3, 4294819840, 0
    s_add_u32 s48, s48, 4096
    s_add_u32 s48, s48, s3
stg_21:
    s_cmp_eq_u32 s60, 0
    s_cbranch_scc1 ub_22
    v_add_f32_dpp v28, v28, v28 row_ror:8 row_mask:0xf bank_mask:0xf
    v_add_f32_dpp v29, v29, v29 row_ror:8 row_mask:0xf bank_mask:0xf
    v_add_f32_dpp v30, v30, v30 row_ror:8 row_mask:0xf bank_mask:0xf
    v_add_f32_dpp v31, v31, v31 row_ror:8 row_mask:0xf bank_mask:0xf
    s_mov_b64 exec, 0x00ff00ff
    buffer_store_dwordx4 v[28:31], v15, s[12:15], s54 offen sc1
    s_mov_b64 exec, -1
ub_22:
    v_add_f32 v78, v78, v94
    v_add_f32 v79, v79, v95
    v_add_f32 v80, v80, v96
    v_add_f32 v81, v81, v97
    v_add_f32 v82, v82, v98
    v_add_f32 v83, v83, v99
    v_add_f32 v84, v84, v100
    v_add_f32 v85, v85, v101
    v_add_f32 v86, v86, v102
    v_add_f32 v87, v87, v103
    v_add_f32 v72, v72, v80
    v_add_f32 v73, v73, v81
    v_add_f32 v74, v74, v82
    v_add_f32 v75, v75, v83
    v_add_f32 v76, v76, v84
    v_add_f32 v77, v77, v85
    v_add_f32 v78, v78, v86
    v_add_f32 v79, v79, v87
    v_add_f32 v72, v72, v76
    s_waitcnt vmcnt(8)
    s_barrier
    v_add_f32 v73, v73, v77
    v_add_f32 v74, v74, v78
    v_add_f32 v75, v75, v79
    v_mul_f32 v72, 0x3a800000, v72
    v_mul_f32 v74, 0x3a800000, v74
    v_mul_f32 v73, 0x3a800000, v73
    v_mul_f32 v75, 0x3a800000, v75
    v_fma_f32 v73, -v72, v72, v73
    v_fma_f32 v75, -v74, v74, v75
    v_max_f32 v73, 0, v73
    v_max_f32 v75, 0, v75
    v_add_f32 v73, 0x3727c5ac, v73
    v_add_f32 v75, 0x3727c5ac, v75
    v_rsq_f32 v73, v73
    v_rsq_f32 v75, v75
    v_swap_b32 v73, v74
    ds_write_b64 v11, v[72:73] offset:768
    ds_write_b64 v11, v[74:75] offset:2304
    s_waitcnt lgkmcnt(0)
    s_waitcnt vmcnt(0)
    s_barrier
    s_cmp_eq_u32 s60, 0
    s_cbranch_scc1 ub_23
    s_mov_b64 exec, 0xffff
    buffer_store_dword v9, v16, s[12:15], s55 offen offset:384 sc1
    s_mov_b64 exec, -1
ub_23:
    s_add_u32 s60, s51, 48
    s_bitcmp1_b32 s9, 0
    s_cbranch_scc1 l_qkv_now6
    s_mov_b32 s24, s36
    s_mov_b32 s25, s37
    s_mov_b32 s26, 2097152
    s_mov_b32 s27, 0x00020000
wop_24:
    s_lshl_b32 m0, s60, 10
    s_lshl_b32 s3, s60, 14
    buffer_load_dwordx4 v17, s[24:27], s3 offen lds
    s_add_u32 s60, s60, 3
    s_waitcnt vmcnt(7)
    s_cmp_lt_u32 s60, 96
    s_cbranch_scc1 wop_24
l_qkv_now6:
    s_barrier
    s_bitcmp1_b32 s9, 0
    s_cbranch_scc1 s_attn
    s_mov_b32 s24, s36
    s_mov_b32 s25, s37
    s_mov_b32 s26, 2097152
    s_mov_b32 s27, 0x00020000
wop_25:
    s_lshl_b32 m0, s60, 10
    s_lshl_b32 s3, s60, 14
    buffer_load_dwordx4 v17, s[24:27], s3 offen lds
    s_add_u32 s60, s60, 3
    s_waitcnt vmcnt(7)
    s_cmp_lt_u32 s60, 128
    s_cbranch_scc1 wop_25
    s_mov_b32 s60, s51
wop_26:
    s_lshl_b32 m0, s60, 10
    s_lshl_b32 s3, s60, 14
    buffer_load_dwordx4 v17, s[24:27], s3 offen lds
    s_add_u32 s60, s60, 3
    s_waitcnt vmcnt(7)
    s_cmp_lt_u32 s60, 12
    s_cbranch_scc1 wop_26
    s_barrier
wop_27:
    s_lshl_b32 m0, s60, 10
    s_lshl_b32 s3, s60, 14
    buffer_load_dwordx4 v17, s[24:27], s3 offen lds
    s_add_u32 s60, s60, 3
    s_waitcnt vmcnt(7)
    s_cmp_lt_u32 s60, 48
    s_cbranch_scc1 wop_27
    s_branch l_wo
.p2align 6
h_wo:
l_wo:
    s_waitcnt vmcnt(0)
    s_barrier
    s_cmp_eq_u32 s8, 4
    s_cbranch_scc1 l_wo_end
    s_cmp_lg_u32 s9, 0
    s_cbranch_scc1 l_wo_end
    s_lshl_b32 s53, s8, 7
    s_lshl_b32 s52, s11, 10
    s_add_u32 s53, s53, s52
    s_add_u32 s53, s53, 64487168
    s_add_u32 s96, s4, s53
    s_addc_u32 s97, s5, 0
    s_mov_b32 s98, s10
    s_mov_b32 s99, s10
    s_mov_b32 s3, 0x20000
poll_28:
    s_load_dwordx16 s[80:95], s[96:97], 0 glc
    s_sub_u32 s3, s3, 1
    s_cbranch_scc1 poll_28_ok
    s_waitcnt lgkmcnt(0)
    s_xor_b64 s[100:101], s[80:81], s[98:99]
    s_xor_b64 s[80:81], s[82:83], s[98:99]
    s_or_b64 s[100:101], s[100:101], s[80:81]
    s_xor_b64 s[80:81], s[84:85], s[98:99]
    s_or_b64 s[100:101], s[100:101], s[80:81]
    s_xor_b64 s[80:81], s[86:87], s[98:99]
    s_or_b64 s[100:101], s[100:101], s[80:81]
    s_xor_b64 s[80:81], s[88:89], s[98:99]
    s_or_b64 s[100:101], s[100:101], s[80:81]
    s_xor_b64 s[80:81], s[90:91], s[98:99]
    s_or_b64 s[100:101], s[100:101], s[80:81]
    s_xor_b64 s[80:81], s[92:93], s[98:99]
    s_or_b64 s[100:101], s[100:101], s[80:81]
    s_xor_b64 s[80:81], s[94:95], s[98:99]
    s_or_b64 s[100:101], s[100:101], s[80:81]
    s_cbranch_scc1 poll_28
poll_28_ok:
    s_waitcnt lgkmcnt(0)
l_wo_end:
    s_barrier
    s_add_u32 s9, s9, 1
    s_cmp_eq_u32 s9, 4
    s_cbranch_scc1 k_exit
    s_cmp_lg_u32 s8, 4
    s_cbranch_scc1 l_qkv
    s_cmp_eq_u32 s9, 2
    s_cbranch_scc1 h_qkvA
    s_branch h_qkvB
.p2align 6
s_attn:
    s_sub_u32 s48, s8, 4
    s_lshl_b32 s3, s7, 7
    v_lshrrev_b32 v20, 3, v1
    v_lshlrev_b32 v21, 11, v20
    v_lshrrev_b32 v22, 2, v1
    v_lshrrev_b32 v23, 4, v1
    v_xor_b32 v22, v22, v23
    v_and_b32 v22, 1, v22
    v_lshl_add_u32 v21, v22, 6, v21
    v_and_b32 v22, 3, v1
    v_lshl_add_u32 v21, v22, 4, v21
    v_add_u32 v7, s3, v21
    s_mov_b32 s24, s42
    s_mov_b32 s25, s43
    s_mov_b32 s26, 2097152
    s_mov_b32 s27, 0x00020000
    s_lshr_b32 s49, s9, 1
    s_lshl_b32 s49, s49, 23
    s_lshl_b32 s52, s7, 19
    s_add_u32 s49, s49, s52
    s_and_b32 s52, s6, 1
    s_lshl_b32 s52, s52, 18
    s_add_u32 s49, s49, s52
    s_add_u32 s49, s49, 33554432
    s_lshr_b32 s61, s6, 1
    s_lshl_b32 s52, s48, 13
    s_add_u32 s53, s52, 81920
    v_add_u32 v8, s53, v5
    s_lshl_b32 s53, s61, 15
    s_add_u32 s52, s52, s53
    s_add_u32 s62, s52, s49
    s_add_u32 s63, s62, 4096
    s_mul_i32 s59, s9, 786432
    s_add_u32 s59, s59, 66322432
    s_and_b32 s52, s11, 31
    s_lshl_b32 s52, s52, 10
    s_add_u32 s59, s59, s52
    s_lshr_b32 s52, s61, 1
    s_lshl_b32 s52, s52, 7
    s_add_u32 s59, s59, s52
    s_and_b32 s52, s61, 1
    s_lshl_b32 s52, s52, 2
    s_add_u32 s52, s52, s48
    s_lshl_b32 s52, s52, 2
    s_add_u32 s59, s59, s52
    v_lshlrev_b32 v20, 15, v1
    v_mov_b32 v21, s10
    s_mul_i32 s54, s9, 786432
    s_add_u32 s54, s54, 66322432
    s_lshl_b32 s55, s11, 10
    s_add_u32 s54, s54, s55
    s_add_u32 s52, s4, s54
    s_addc_u32 s53, s5, 0
    s_mov_b32 s54, s10
    s_mov_b32 s55, s10
    s_lshl_b32 s51, s48, 11
    s_add_u32 s49, s49, s51
    s_add_u32 s51, s51, 81920
    s_mov_b32 s60, s48
    s_setprio 3
    s_barrier
    ds_read_b128 v[32:35], v8 offset:0
    ds_read_b128 v[36:39], v8 offset:1024
    ds_read_b128 v[40:43], v8 offset:2048
    ds_read_b128 v[44:47], v8 offset:3072
    ds_read_b128 v[48:51], v8 offset:4096
    ds_read_b128 v[52:55], v8 offset:5120
    ds_read_b128 v[56:59], v8 offset:6144
    ds_read_b128 v[60:63], v8 offset:7168
    s_waitcnt lgkmcnt(7)
    buffer_store_dwordx4 v[32:35], v5, s[12:15], s62 offen offset:0 sc1
    s_waitcnt lgkmcnt(6)
    buffer_store_dwordx4 v[36:39], v5, s[12:15], s62 offen offset:1024 sc1
    s_waitcnt lgkmcnt(5)
    buffer_store_dwordx4 v[40:43], v5, s[12:15], s62 offen offset:2048 sc1
    s_waitcnt lgkmcnt(4)
    buffer_store_dwordx4 v[44:47], v5, s[12:15], s62 offen offset:3072 sc1
    s_waitcnt lgkmcnt(3)
    buffer_store_dwordx4 v[48:51], v5, s[12:15], s63 offen offset:0 sc1
    s_waitcnt lgkmcnt(2)
    buffer_store_dwordx4 v[52:55], v5, s[12:15], s63 offen offset:1024 sc1
    s_waitcnt lgkmcnt(1)
    buffer_store_dwordx4 v[56:59], v5, s[12:15], s63 offen offset:2048 sc1
    s_waitcnt lgkmcnt(0)
    buffer_store_dwordx4 v[60:63], v5, s[12:15], s63 offen offset:3072 sc1
    s_mov_b64 exec, 0xff
    s_waitcnt vmcnt(0)
    buffer_store_dword v21, v20, s[12:15], s59 offen sc1
    s_mov_b64 exec, -1
    s_lshl_b32 s58, 1, s61
    s_mov_b32 s57, 0
    s_add_u32 s62, s61, 1
    s_and_b32 s62, s62, 7
    s_lshl_b32 s50, s62, 15
    s_add_u32 s50, s50, s49
    s_lshr_b32 s63, s62, 1
    s_lshl_b32 s63, s63, 7
    s_and_b32 s62, s62, 1
    s_lshl_b32 s62, s62, 4
    s_add_u32 s62, s62, s63
    s_mov_b32 s58, 0x20000
need_29:
    s_load_dwordx4 s[64:67], s[52:53], s62 glc
    s_sub_u32 s58, s58, 1
    s_cbranch_scc1 need_29_ok
    s_waitcnt lgkmcnt(0)
    s_xor_b64 s[64:65], s[64:65], s[54:55]
    s_xor_b64 s[66:67], s[66:67], s[54:55]
    s_or_b64 s[64:65], s[64:65], s[66:67]
    s_cbranch_scc1 need_29
need_29_ok:
    s_waitcnt lgkmcnt(0)
    s_add_u32 m0, s51, 32768
    s_nop 0
    buffer_load_dwordx4 v5, s[12:15], s50 offen offset:0 sc1 lds
    buffer_load_dwordx4 v5, s[12:15], s50 offen offset:1024 sc1 lds
    s_add_u32 s50, s50, 8192
    s_add_u32 m0, s51, 40960
    s_nop 0
    buffer_load_dwordx4 v5, s[12:15], s50 offen offset:0 sc1 lds
    buffer_load_dwordx4 v5, s[12:15], s50 offen offset:1024 sc1 lds
    s_add_u32 s50, s50, 8192
    s_add_u32 m0, s51, 49152
    s_nop 0
    buffer_load_dwordx4 v5, s[12:15], s50 offen offset:0 sc1 lds
    buffer_load_dwordx4 v5, s[12:15], s50 offen offset:1024 sc1 lds
    s_add_u32 s50, s50, 8192
    s_add_u32 m0, s51, 57344
    s_nop 0
    buffer_load_dwordx4 v5, s[12:15], s50 offen offset:0 sc1 lds
    buffer_load_dwordx4 v5, s[12:15], s50 offen offset:1024 sc1 lds
    s_add_u32 s50, s50, 8192
    s_waitcnt vmcnt(4)
    s_barrier
    s_add_u32 s62, s61, 2
    s_and_b32 s62, s62, 7
    s_lshl_b32 s50, s62, 15
    s_add_u32 s50, s50, s49
    s_lshr_b32 s63, s62, 1
    s_lshl_b32 s63, s63, 7
    s_and_b32 s62, s62, 1
    s_lshl_b32 s62, s62, 4
    s_add_u32 s62, s62, s63
    s_mov_b32 s58, 0x20000
need_30:
    s_load_dwordx4 s[64:67], s[52:53], s62 glc
    s_sub_u32 s58, s58, 1
    s_cbranch_scc1 need_30_ok
    s_waitcnt lgkmcnt(0)
    s_xor_b64 s[64:65], s[64:65], s[54:55]
    s_xor_b64 s[66:67], s[66:67], s[54:55]
    s_or_b64 s[64:65], s[64:65], s[66:67]
    s_cbranch_scc1 need_30
need_30_ok:
    s_waitcnt lgkmcnt(0)
    s_add_u32 m0, s51, 0
    s_nop 0
    buffer_load_dwordx4 v5, s[12:15], s50 offen offset:0 sc1 lds
    buffer_load_dwordx4 v5, s[12:15], s50 offen offset:1024 sc1 lds
    s_add_u32 s50, s50, 8192
    s_add_u32 m0, s51, 8192
    s_nop 0
    buffer_load_dwordx4 v5, s[12:15], s50 offen offset:0 sc1 lds
    buffer_load_dwordx4 v5, s[12:15], s50 offen offset:1024 sc1 lds
    s_add_u32 s50, s50, 8192
    s_waitcnt vmcnt(4)
    s_barrier
    s_add_u32 m0, s51, 16384
    s_nop 0
    buffer_load_dwordx4 v5, s[12:15], s50 offen offset:0 sc1 lds
    buffer_load_dwordx4 v5, s[12:15], s50 offen offset:1024 sc1 lds
    s_add_u32 s50, s50, 8192
    s_add_u32 m0, s51, 24576
    s_nop 0
    buffer_load_dwordx4 v5, s[12:15], s50 offen offset:0 sc1 lds
    buffer_load_dwordx4 v5, s[12:15], s50 offen offset:1024 sc1 lds
    s_add_u32 s50, s50, 8192
    s_waitcnt vmcnt(4)
    s_barrier
    s_add_u32 s62, s61, 3
    s_and_b32 s62, s62, 7
    s_lshl_b32 s50, s62, 15
    s_add_u32 s50, s50, s49
    s_lshr_b32 s63, s62, 1
    s_lshl_b32 s63, s63, 7
    s_and_b32 s62, s62, 1
    s_lshl_b32 s62, s62, 4
    s_add_u32 s62, s62, s63
    s_mov_b32 s58, 0x20000
need_31:
    s_load_dwordx4 s[64:67], s[52:53], s62 glc
    s_sub_u32 s58, s58, 1
    s_cbranch_scc1 need_31_ok
    s_waitcnt lgkmcnt(0)
    s_xor_b64 s[64:65], s[64:65], s[54:55]
    s_xor_b64 s[66:67], s[66:67], s[54:55]
    s_or_b64 s[64:65], s[64:65], s[66:67]
    s_cbranch_scc1 need_31
need_31_ok:
    s_waitcnt lgkmcnt(0)
    s_add_u32 m0, s51, 32768
    s_nop 0
    buffer_load_dwordx4 v5, s[12:15], s50 offen offset:0 sc1 lds
    buffer_load_dwordx4 v5, s[12:15], s50 offen offset:1024 sc1 lds
    s_add_u32 s50, s50, 8192
    s_add_u32 m0, s51, 40960
    s_nop 0
    buffer_load_dwordx4 v5, s[12:15], s50 offen offset:0 sc1 lds
    buffer_load_dwordx4 v5, s[12:15], s50 offen offset:1024 sc1 lds
    s_add_u32 s50, s50, 8192
    s_lshl_b32 m0, s60, 10
    s_lshl_b32 s3, s60, 14
    buffer_load_dwordx4 v7, s[24:27], s3 offen lds
    s_add_u32 s60, s60, 4
    s_lshl_b32 m0, s60, 10
    s_lshl_b32 s3, s60, 14
    buffer_load_dwordx4 v7, s[24:27], s3 offen lds
    s_add_u32 s60, s60, 4
    s_waitcnt vmcnt(6)
    s_barrier
    s_add_u32 m0, s51, 49152
    s_nop 0
    buffer_load_dwordx4 v5, s[12:15], s50 offen offset:0 sc1 lds
    buffer_load_dwordx4 v5, s[12:15], s50 offen offset:1024 sc1 lds
    s_add_u32 s50, s50, 8192
    s_add_u32 m0, s51, 57344
    s_nop 0
    buffer_load_dwordx4 v5, s[12:15], s50 offen offset:0 sc1 lds
    buffer_load_dwordx4 v5, s[12:15], s50 offen offset:1024 sc1 lds
    s_add_u32 s50, s50, 8192
    s_lshl_b32 m0, s60, 10
    s_lshl_b32 s3, s60, 14
    buffer_load_dwordx4 v7, s[24:27], s3 offen lds
    s_add_u32 s60, s60, 4
    s_lshl_b32 m0, s60, 10
    s_lshl_b32 s3, s60, 14
    buffer_load_dwordx4 v7, s[24:27], s3 offen lds
    s_add_u32 s60, s60, 4
    s_waitcnt vmcnt(8)
    s_barrier
    s_add_u32 s62, s61, 4
    s_and_b32 s62, s62, 7
    s_lshl_b32 s50, s62, 15
    s_add_u32 s50, s50, s49
    s_lshr_b32 s63, s62, 1
    s_lshl_b32 s63, s63, 7
    s_and_b32 s62, s62, 1
    s_lshl_b32 s62, s62, 4
    s_add_u32 s62, s62, s63
    s_mov_b32 s58, 0x20000
need_32:
    s_load_dwordx4 s[64:67], s[52:53], s62 glc
    s_sub_u32 s58, s58, 1
    s_cbranch_scc1 need_32_ok
    s_waitcnt lgkmcnt(0)
    s_xor_b64 s[64:65], s[64:65], s[54:55]
    s_xor_b64 s[66:67], s[66:67], s[54:55]
    s_or_b64 s[64:65], s[64:65], s[66:67]
    s_cbranch_scc1 need_32
need_32_ok:
    s_waitcnt lgkmcnt(0)
    s_add_u32 m0, s51, 0
    s_nop 0
    buffer_load_dwordx4 v5, s[12:15], s50 offen offset:0 sc1 lds
    buffer_load_dwordx4 v5, s[12:15], s50 offen offset:1024 sc1 lds
    s_add_u32 s50, s50, 8192
    s_add_u32 m0, s51, 8192
    s_nop 0
    buffer_load_dwordx4 v5, s[12:15], s50 offen offset:0 sc1 lds
    buffer_load_dwordx4 v5, s[12:15], s50 offen offset:1024 sc1 lds
    s_add_u32 s50, s50, 8192
    s_lshl_b32 m0, s60, 10
    s_lshl_b32 s3, s60, 14
    buffer_load_dwordx4 v7, s[24:27], s3 offen lds
    s_add_u32 s60, s60, 4
    s_lshl_b32 m0, s60, 10
    s_lshl_b32 s3, s60, 14
    buffer_load_dwordx4 v7, s[24:27], s3 offen lds
    s_add_u32 s60, s60, 4
    s_waitcnt vmcnt(8)
    s_barrier
    s_add_u32 m0, s51, 16384
    s_nop 0
    buffer_load_dwordx4 v5, s[12:15], s50 offen offset:0 sc1 lds
    buffer_load_dwordx4 v5, s[12:15], s50 offen offset:1024 sc1 lds
    s_add_u32 s50, s50, 8192
    s_add_u32 m0, s51, 24576
    s_nop 0
    buffer_load_dwordx4 v5, s[12:15], s50 offen offset:0 sc1 lds
    buffer_load_dwordx4 v5, s[12:15], s50 offen offset:1024 sc1 lds
    s_add_u32 s50, s50, 8192
    s_lshl_b32 m0, s60, 10
    s_lshl_b32 s3, s60, 14
    buffer_load_dwordx4 v7, s[24:27], s3 offen lds
    s_add_u32 s60, s60, 4
    s_lshl_b32 m0, s60, 10
    s_lshl_b32 s3, s60, 14
    buffer_load_dwordx4 v7, s[24:27], s3 offen lds
    s_add_u32 s60, s60, 4
    s_waitcnt vmcnt(8)
    s_barrier
    s_add_u32 s62, s61, 5
    s_and_b32 s62, s62, 7
    s_lshl_b32 s50, s62, 15
    s_add_u32 s50, s50, s49
    s_lshr_b32 s63, s62, 1
    s_lshl_b32 s63, s63, 7
    s_and_b32 s62, s62, 1
    s_lshl_b32 s62, s62, 4
    s_add_u32 s62, s62, s63
    s_mov_b32 s58, 0x20000
need_33:
    s_load_dwordx4 s[64:67], s[52:53], s62 glc
    s_sub_u32 s58, s58, 1
    s_cbranch_scc1 need_33_ok
    s_waitcnt lgkmcnt(0)
    s_xor_b64 s[64:65], s[64:65], s[54:55]
    s_xor_b64 s[66:67], s[66:67], s[54:55]
    s_or_b64 s[64:65], s[64:65], s[66:67]
    s_cbranch_scc1 need_33
need_33_ok:
    s_waitcnt lgkmcnt(0)
    s_add_u32 m0, s51, 32768
    s_nop 0
    buffer_load_dwordx4 v5, s[12:15], s50 offen offset:0 sc1 lds
    buffer_load_dwordx4 v5, s[12:15], s50 offen offset:1024 sc1 lds
    s_add_u32 s50, s50, 8192
    s_add_u32 m0, s51, 40960
    s_nop 0
    buffer_load_dwordx4 v5, s[12:15], s50 offen offset:0 sc1 lds
    buffer_load_dwordx4 v5, s[12:15], s50 offen offset:1024 sc1 lds
    s_add_u32 s50, s50, 8192
    s_lshl_b32 m0, s60, 10
    s_lshl_b32 s3, s60, 14
    buffer_load_dwordx4 v7, s[24:27], s3 offen lds
    s_add_u32 s60, s60, 4
    s_lshl_b32 m0, s60, 10
    s_lshl_b32 s3, s60, 14
    buffer_load_dwordx4 v7, s[24:27], s3 offen lds
    s_add_u32 s60, s60, 4
    s_waitcnt vmcnt(8)
    s_barrier
    s_add_u32 m0, s51, 49152
    s_nop 0
    buffer_load_dwordx4 v5, s[12:15], s50 offen offset:0 sc1 lds
    buffer_load_dwordx4 v5, s[12:15], s50 offen offset:1024 sc1 lds
    s_add_u32 s50, s50, 8192
    s_add_u32 m0, s51, 57344
    s_nop 0
    buffer_load_dwordx4 v5, s[12:15], s50 offen offset:0 sc1 lds
    buffer_load_dwordx4 v5, s[12:15], s50 offen offset:1024 sc1 lds
    s_add_u32 s50, s50, 8192
    s_lshl_b32 m0, s60, 10
    s_lshl_b32 s3, s60, 14
    buffer_load_dwordx4 v7, s[24:27], s3 offen lds
    s_add_u32 s60, s60, 4
    s_lshl_b32 m0, s60, 10
    s_lshl_b32 s3, s60, 14
    buffer_load_dwordx4 v7, s[24:27], s3 offen lds
    s_add_u32 s60, s60, 4
    s_waitcnt vmcnt(8)
    s_barrier
    s_add_u32 s62, s61, 6
    s_and_b32 s62, s62, 7
    s_lshl_b32 s50, s62, 15
    s_add_u32 s50, s50, s49
    s_lshr_b32 s63, s62, 1
    s_lshl_b32 s63, s63, 7
    s_and_b32 s62, s62, 1
    s_lshl_b32 s62, s62, 4
    s_add_u32 s62, s62, s63
    s_mov_b32 s58, 0x20000
need_34:
    s_load_dwordx4 s[64:67], s[52:53], s62 glc
    s_sub_u32 s58, s58, 1
    s_cbranch_scc1 need_34_ok
    s_waitcnt lgkmcnt(0)
    s_xor_b64 s[64:65], s[64:65], s[54:55]
    s_xor_b64 s[66:67], s[66:67], s[54:55]
    s_or_b64 s[64:65], s[64:65], s[66:67]
    s_cbranch_scc1 need_34
need_34_ok:
    s_waitcnt lgkmcnt(0)
    s_add_u32 m0, s51, 0
    s_nop 0
    buffer_load_dwordx4 v5, s[12:15], s50 offen offset:0 sc1 lds
    buffer_load_dwordx4 v5, s[12:15], s50 offen offset:1024 sc1 lds
    s_add_u32 s50, s50, 8192
    s_add_u32 m0, s51, 8192
    s_nop 0
    buffer_load_dwordx4 v5, s[12:15], s50 offen offset:0 sc1 lds
    buffer_load_dwordx4 v5, s[12:15], s50 offen offset:1024 sc1 lds
    s_add_u32 s50, s50, 8192
    s_lshl_b32 m0, s60, 10
    s_lshl_b32 s3, s60, 14
    buffer_load_dwordx4 v7, s[24:27], s3 offen lds
    s_add_u32 s60, s60, 4
    s_lshl_b32 m0, s60, 10
    s_lshl_b32 s3, s60, 14
    buffer_load_dwordx4 v7, s[24:27], s3 offen lds
    s_add_u32 s60, s60, 4
    s_waitcnt vmcnt(8)
    s_barrier
    s_add_u32 m0, s51, 16384
    s_nop 0
    buffer_load_dwordx4 v5, s[12:15], s50 offen offset:0 sc1 lds
    buffer_load_dwordx4 v5, s[12:15], s50 offen offset:1024 sc1 lds
    s_add_u32 s50, s50, 8192
    s_add_u32 m0, s51, 24576
    s_nop 0
    buffer_load_dwordx4 v5, s[12:15], s50 offen offset:0 sc1 lds
    buffer_load_dwordx4 v5, s[12:15], s50 offen offset:1024 sc1 lds
    s_add_u32 s50, s50, 8192
    s_lshl_b32 m0, s60, 10
    s_lshl_b32 s3, s60, 14
    buffer_load_dwordx4 v7, s[24:27], s3 offen lds
    s_add_u32 s60, s60, 4
    s_lshl_b32 m0, s60, 10
    s_lshl_b32 s3, s60, 14
    buffer_load_dwordx4 v7, s[24:27], s3 offen lds
    s_add_u32 s60, s60, 4
    s_waitcnt vmcnt(8)
    s_barrier
    s_add_u32 s62, s61, 7
    s_and_b32 s62, s62, 7
    s_lshl_b32 s50, s62, 15
    s_add_u32 s50, s50, s49
    s_lshr_b32 s63, s62, 1
    s_lshl_b32 s63, s63, 7
    s_and_b32 s62, s62, 1
    s_lshl_b32 s62, s62, 4
    s_add_u32 s62, s62, s63
    s_mov_b32 s58, 0x20000
need_35:
    s_load_dwordx4 s[64:67], s[52:53], s62 glc
    s_sub_u32 s58, s58, 1
    s_cbranch_scc1 need_35_ok
    s_waitcnt lgkmcnt(0)
    s_xor_b64 s[64:65], s[64:65], s[54:55]
    s_xor_b64 s[66:67], s[66:67], s[54:55]
    s_or_b64 s[64:65], s[64:65], s[66:67]
    s_cbranch_scc1 need_35
need_35_ok:
    s_waitcnt lgkmcnt(0)
    s_add_u32 m0, s51, 32768
    s_nop 0
    buffer_load_dwordx4 v5, s[12:15], s50 offen offset:0 sc1 lds
    buffer_load_dwordx4 v5, s[12:15], s50 offen offset:1024 sc1 lds
    s_add_u32 s50, s50, 8192
    s_add_u32 m0, s51, 40960
    s_nop 0
    buffer_load_dwordx4 v5, s[12:15], s50 offen offset:0 sc1 lds
    buffer_load_dwordx4 v5, s[12:15], s50 offen offset:1024 sc1 lds
    s_add_u32 s50, s50, 8192
    s_lshl_b32 m0, s60, 10
    s_lshl_b32 s3, s60, 14
    buffer_load_dwordx4 v7, s[24:27], s3 offen lds
    s_add_u32 s60, s60, 4
    s_lshl_b32 m0, s60, 10
    s_lshl_b32 s3, s60, 14
    buffer_load_dwordx4 v7, s[24:27], s3 offen lds
    s_add_u32 s60, s60, 4
    s_waitcnt vmcnt(8)
    s_barrier
    s_add_u32 m0, s51, 49152
    s_nop 0
    buffer_load_dwordx4 v5, s[12:15], s50 offen offset:0 sc1 lds
    buffer_load_dwordx4 v5, s[12:15], s50 offen offset:1024 sc1 lds
    s_add_u32 s50, s50, 8192
    s_add_u32 m0, s51, 57344
    s_nop 0
    buffer_load_dwordx4 v5, s[12:15], s50 offen offset:0 sc1 lds
    buffer_load_dwordx4 v5, s[12:15], s50 offen offset:1024 sc1 lds
    s_add_u32 s50, s50, 8192
    s_lshl_b32 m0, s60, 10
    s_lshl_b32 s3, s60, 14
    buffer_load_dwordx4 v7, s[24:27], s3 offen lds
    s_add_u32 s60, s60, 4
    s_lshl_b32 m0, s60, 10
    s_lshl_b32 s3, s60, 14
    buffer_load_dwordx4 v7, s[24:27], s3 offen lds
    s_add_u32 s60, s60, 4
    s_waitcnt vmcnt(8)
    s_barrier
    s_lshl_b32 m0, s60, 10
    s_lshl_b32 s3, s60, 14
    buffer_load_dwordx4 v7, s[24:27], s3 offen lds
    s_add_u32 s60, s60, 4
    s_lshl_b32 m0, s60, 10
    s_lshl_b32 s3, s60, 14
    buffer_load_dwordx4 v7, s[24:27], s3 offen lds
    s_add_u32 s60, s60, 4
    s_lshl_b32 m0, s60, 10
    s_lshl_b32 s3, s60, 14
    buffer_load_dwordx4 v7, s[24:27], s3 offen lds
    s_add_u32 s60, s60, 4
    s_lshl_b32 m0, s60, 10
    s_lshl_b32 s3, s60, 14
    buffer_load_dwordx4 v7, s[24:27], s3 offen lds
    s_add_u32 s60, s60, 4
    s_waitcnt vmcnt(6)
    s_barrier
    s_lshl_b32 m0, s60, 10
    s_lshl_b32 s3, s60, 14
    buffer_load_dwordx4 v7, s[24:27], s3 offen lds
    s_add_u32 s60, s60, 4
    s_lshl_b32 m0, s60, 10
    s_lshl_b32 s3, s60, 14
    buffer_load_dwordx4 v7, s[24:27], s3 offen lds
    s_add_u32 s60, s60, 4
    s_lshl_b32 m0, s60, 10
    s_lshl_b32 s3, s60, 14
    buffer_load_dwordx4 v7, s[24:27], s3 offen lds
    s_add_u32 s60, s60, 4
    s_lshl_b32 m0, s60, 10
    s_lshl_b32 s3, s60, 14
    buffer_load_dwordx4 v7, s[24:27], s3 offen lds
    s_add_u32 s60, s60, 4
    s_barrier
    s_lshl_b32 m0, s60, 10
    s_lshl_b32 s3, s60, 14
    buffer_load_dwordx4 v7, s[24:27], s3 offen lds
    s_add_u32 s60, s60, 4
    s_lshl_b32 m0, s60, 10
    s_lshl_b32 s3, s60, 14
    buffer_load_dwordx4 v7, s[24:27], s3 offen lds
    s_add_u32 s60, s60, 4
    s_lshl_b32 m0, s60, 10
    s_lshl_b32 s3, s60, 14
    buffer_load_dwordx4 v7, s[24:27], s3 offen lds
    s_add_u32 s60, s60, 4
    s_lshl_b32 m0, s60, 10
    s_lshl_b32 s3, s60, 14
    buffer_load_dwordx4 v7, s[24:27], s3 offen lds
    s_add_u32 s60, s60, 4
    s_setprio 0
    s_cmp_eq_u32 s8, 4
    s_cbranch_scc1 h_wo
    s_branch l_wo
.p2align 6
c_attn_slow:
    s_waitcnt lgkmcnt(0)
    s_lshr_b32 s56, s9, 1
    s_lshl_b32 s56, s56, 23
    s_lshl_b32 s55, s7, 19
    s_add_u32 s56, s56, s55
    s_and_b32 s55, s6, 1
    s_lshl_b32 s55, s55, 18
    s_add_u32 s56, s56, s55
    s_add_u32 s56, s56, 33554432
    v_mov_b32 v28, 0xff800000
    v_mov_b32 v30, 0xff800000
    s_mov_b32 s57, 0
c_attn_slow1:
    s_lshr_b32 s55, s57, 2
    s_lshl_b32 s55, s55, 14
    s_and_b32 s58, s57, 3
    s_lshl_b32 s58, s58, 11
    s_add_u32 s55, s55, s58
    s_add_u32 s55, s55, s56
    buffer_load_dwordx4 v[128:131], v5, s[12:15], s55 offen offset:0 sc1
    buffer_load_dwordx4 v[132:135], v5, s[12:15], s55 offen offset:1024 sc1
    s_waitcnt vmcnt(0)
    v_mfma_f32_32x32x16_bf16 v[64:79], v[128:131], v[8:11], 0
    v_mfma_f32_32x32x16_bf16 v[80:95], v[128:131], v[16:19], 0
    v_mfma_f32_32x32x16_bf16 v[64:79], v[132:135], v[12:15], v[64:79]
    v_mfma_f32_32x32x16_bf16 v[80:95], v[132:135], v[20:23], v[80:95]
    s_nop 10
    v_max3_f32 v28, v28, v64, v65
    v_max3_f32 v28, v28, v66, v67
    v_max3_f32 v28, v28, v68, v69
    v_max3_f32 v28, v28, v70, v71
    v_max3_f32 v28, v28, v72, v73
    v_max3_f32 v28, v28, v74, v75
    v_max3_f32 v28, v28, v76, v77
    v_max3_f32 v28, v28, v78, v79
    v_max3_f32 v30, v30, v80, v81
    v_max3_f32 v30, v30, v82, v83
    v_max3_f32 v30, v30, v84, v85
    v_max3_f32 v30, v30, v86, v87
    v_max3_f32 v30, v30, v88, v89
    v_max3_f32 v30, v30, v90, v91
    v_max3_f32 v30, v30, v92, v93
    v_max3_f32 v30, v30, v94, v95
    s_add_u32 s57, s57, 1
    s_cmp_lt_u32 s57, 64
    s_cbranch_scc1 c_attn_slow1
    v_mov_b32 v29, v28
    s_nop 1
    v_permlane32_swap_b32 v28, v29
    v_max_f32 v28, v28, v29
    v_sub_f32 v96, 0, v28
    v_sub_f32 v97, 0, v28
    v_sub_f32 v98, 0, v28
    v_sub_f32 v99, 0, v28
    v_sub_f32 v100, 0, v28
    v_sub_f32 v101, 0, v28
    v_sub_f32 v102, 0, v28
    v_sub_f32 v103, 0, v28
    v_sub_f32 v104, 0, v28
    v_sub_f32 v105, 0, v28
    v_sub_f32 v106, 0, v28
    v_sub_f32 v107, 0, v28
    v_sub_f32 v108, 0, v28
    v_sub_f32 v109, 0, v28
    v_sub_f32 v110, 0, v28
    v_sub_f32 v111, 0, v28
    v_mov_b32 v160, 0
    v_mov_b32 v161, 0
    v_mov_b32 v162, 0
    v_mov_b32 v163, 0
    v_mov_b32 v164, 0
    v_mov_b32 v165, 0
    v_mov_b32 v166, 0
    v_mov_b32 v167, 0
    v_mov_b32 v168, 0
    v_mov_b32 v169, 0
    v_mov_b32 v170, 0
    v_mov_b32 v171, 0
    v_mov_b32 v172, 0
    v_mov_b32 v173, 0
    v_mov_b32 v174, 0
    v_mov_b32 v175, 0
    v_mov_b32 v192, 0
    v_mov_b32 v193, 0
    v_mov_b32 v194, 0
    v_mov_b32 v195, 0
    v_mov_b32 v31, v30
    s_nop 1
    v_permlane32_swap_b32 v30, v31
    v_max_f32 v30, v30, v31
    v_sub_f32 v112, 0, v30
    v_sub_f32 v113, 0, v30
    v_sub_f32 v114, 0, v30
    v_sub_f32 v115, 0, v30
    v_sub_f32 v116, 0, v30
    v_sub_f32 v117, 0, v30
    v_sub_f32 v118, 0, v30
    v_sub_f32 v119, 0, v30
    v_sub_f32 v120, 0, v30
    v_sub_f32 v121, 0, v30
    v_sub_f32 v122, 0, v30
    v_sub_f32 v123, 0, v30
    v_sub_f32 v124, 0, v30
    v_sub_f32 v125, 0, v30
    v_sub_f32 v126, 0, v30
    v_sub_f32 v127, 0, v30
    v_mov_b32 v176, 0
    v_mov_b32 v177, 0
    v_mov_b32 v178, 0
    v_mov_b32 v179, 0
    v_mov_b32 v180, 0
    v_mov_b32 v181, 0
    v_mov_b32 v182, 0
    v_mov_b32 v183, 0
    v_mov_b32 v184, 0
    v_mov_b32 v185, 0
    v_mov_b32 v186, 0
    v_mov_b32 v187, 0
    v_mov_b32 v188, 0
    v_mov_b32 v189, 0
    v_mov_b32 v190, 0
    v_mov_b32 v191, 0
    v_mov_b32 v196, 0
    v_mov_b32 v197, 0
    v_mov_b32 v198, 0
    v_mov_b32 v199, 0
    s_mov_b32 s57, 0
c_attn_slow2:
    s_lshr_b32 s55, s57, 2
    s_lshl_b32 s55, s55, 14
    s_and_b32 s58, s57, 3
    s_lshl_b32 s58, s58, 11
    s_add_u32 s55, s55, s58
    s_add_u32 s55, s55, s56
    buffer_load_dwordx4 v[128:131], v5, s[12:15], s55 offen offset:0 sc1
    buffer_load_dwordx4 v[132:135], v5, s[12:15], s55 offen offset:1024 sc1
    s_add_u32 s55, s55, 8192
    buffer_load_dwordx4 v[144:147], v5, s[12:15], s55 offen offset:0 sc1
    buffer_load_dwordx4 v[148:151], v5, s[12:15], s55 offen offset:1024 sc1
    s_waitcnt vmcnt(0)
    v_mfma_f32_32x32x16_bf16 v[64:79], v[128:131], v[8:11], v[96:111]
    v_mfma_f32_32x32x16_bf16 v[80:95], v[128:131], v[16:19], v[112:127]
    v_mfma_f32_32x32x16_bf16 v[64:79], v[132:135], v[12:15], v[64:79]
    v_mfma_f32_32x32x16_bf16 v[80:95], v[132:135], v[20:23], v[80:95]
    s_nop 10
    v_exp_f32 v64, v64
    v_exp_f32 v65, v65
    v_exp_f32 v66, v66
    v_exp_f32 v67, v67
    v_exp_f32 v68, v68
    v_exp_f32 v69, v69
    v_exp_f32 v70, v70
    v_exp_f32 v71, v71
    v_exp_f32 v72, v72
    v_exp_f32 v73, v73
    v_exp_f32 v74, v74
    v_exp_f32 v75, v75
    v_exp_f32 v76, v76
    v_exp_f32 v77, v77
    v_exp_f32 v78, v78
    v_exp_f32 v79, v79
    v_exp_f32 v80, v80
    v_exp_f32 v81, v81
    v_exp_f32 v82, v82
    v_exp_f32 v83, v83
    v_exp_f32 v84, v84
    v_exp_f32 v85, v85
    v_exp_f32 v86, v86
    v_exp_f32 v87, v87
    v_exp_f32 v88, v88
    v_exp_f32 v89, v89
    v_exp_f32 v90, v90
    v_exp_f32 v91, v91
    v_exp_f32 v92, v92
    v_exp_f32 v93, v93
    v_exp_f32 v94, v94
    v_exp_f32 v95, v95
    v_smfmac_f32_32x32x32_bf16 v[160:175], v[144:147], v[64:71], v204
    v_smfmac_f32_16x16x64_bf16 v[192:195], v[200:203], v[64:71], v204
    v_smfmac_f32_32x32x32_bf16 v[160:175], v[148:151], v[72:79], v204
    v_smfmac_f32_16x16x64_bf16 v[192:195], v[200:203], v[72:79], v204
    v_smfmac_f32_32x32x32_bf16 v[176:191], v[144:147], v[80:87], v204
    v_smfmac_f32_16x16x64_bf16 v[196:199], v[200:203], v[80:87], v204
    v_smfmac_f32_32x32x32_bf16 v[176:191], v[148:151], v[88:95], v204
    v_smfmac_f32_16x16x64_bf16 v[196:199], v[200:203], v[88:95], v204
    s_add_u32 s57, s57, 1
    s_cmp_lt_u32 s57, 64
    s_nop 15
    s_cbranch_scc1 c_attn_slow2
    s_branch c_attn_fin
    s_endpgm
.section .rodata,"a"
.p2align 6
.amdhsa_kernel interleave_layers__sliding_local_dilated__softmax_full_mha__prompt_kernel
  .amdhsa_next_free_vgpr 256
  .amdhsa_next_free_sgpr 102
  .amdhsa_accum_offset 224
  .amdhsa_group_segment_fixed_size 0
  .amdhsa_kernarg_size 72
  .amdhsa_user_sgpr_count 2
  .amdhsa_user_sgpr_kernarg_segment_ptr 1
  .amdhsa_system_sgpr_workgroup_id_x 1
.end_amdhsa_kernel
```

```asm
; @launch grid=(256,1,1) block=(512,1,1) lds=159744
.amdgcn_target "amdgcn-amd-amdhsa--gfx950"
.text
.globl interleave_layers__sliding_local_dilated__softmax_full_mha__prompt_kernel
.type interleave_layers__sliding_local_dilated__softmax_full_mha__prompt_kernel,@function
.p2align 8
interleave_layers__sliding_local_dilated__softmax_full_mha__prompt_kernel:
    s_cmp_ge_u32 s2, 256
    s_cbranch_scc1 k_exit2
    s_load_dwordx16 s[32:47], s[0:1], 0
    s_load_dwordx2 s[4:5], s[0:1], 64
    v_lshrrev_b32 v2, 6, v0
    v_and_b32 v1, 63, v0
    v_mov_b32 v12, 0
    v_mov_b32 v14, 0
    v_mov_b32 v15, 0
    v_mov_b32 v16, 0
    v_readfirstlane_b32 s8, v2
    s_and_b32 s3, s2, 1
    s_lshl_b32 s3, s3, 3
    s_bfe_u32 s6, s2, 0x30003
    s_add_u32 s6, s3, s6
    s_bfe_u32 s3, s2, 0x20001
    s_lshl_b32 s3, s3, 2
    s_lshr_b32 s7, s2, 6
    s_add_u32 s7, s3, s7
    s_lshl_b32 s11, s6, 4
    s_add_u32 s11, s11, s7
    s_mov_b32 s9, -1
    s_mov_b32 s96, 0
    s_mov_b32 s10, 0
    s_waitcnt lgkmcnt(0)
    s_mov_b32 s12, s4
    s_mov_b32 s13, s5
    s_mov_b32 s14, 71303168
    s_mov_b32 s15, 0x00020000
    s_cmp_lt_u32 s8, 4
    s_cbranch_scc1 c_prep
    s_cmp_eq_u32 s8, 4
    s_cbranch_scc1 h_first
    s_branch l_first
k_exit:
k_exit2:
    s_endpgm
.p2align 6
c_qkvA:
    v_and_b32 v1, 63, v0
    v_lshrrev_b32 v2, 6, v0
    v_lshlrev_b32 v5, 4, v1
    v_lshrrev_b32 v3, 5, v1
    v_and_b32 v4, 15, v0
    v_bfe_u32 v7, v1, 4, 1
    v_lshl_add_u32 v6, v7, 5, v4
    v_lshlrev_b32 v6, 4, v6
    v_lshl_add_u32 v6, v3, 10, v6
    s_lshr_b32 s48, s6, 1
    s_lshl_b32 s48, s48, 2
    s_add_u32 s48, s48, s8
    s_lshl_b32 s55, s48, 17
    s_lshl_b32 s56, s9, 22
    s_add_u32 s55, s55, s56
    s_add_u32 s16, s4, s55
    s_addc_u32 s17, s5, 0
    s_mov_b32 s18, 65536
    s_mov_b32 s19, 0x00020000
    s_add_u32 s56, s55, 65536
    s_add_u32 s20, s4, s56
    s_addc_u32 s21, s5, 0
    s_mov_b32 s22, 65536
    s_mov_b32 s23, 0x00020000
    s_lshl_b32 s49, s7, 12
    s_add_u32 s49, s49, s55
    s_and_b32 s56, s6, 1
    s_lshl_b32 s56, s56, 11
    s_add_u32 s49, s49, s56
    s_add_u32 s49, s49, 16777216
    s_movk_i32 s54, 4096
    v_lshrrev_b32 v16, 2, v4
    v_lshl_add_u32 v18, v7, 2, v16
    v_lshl_add_u32 v18, v3, 4, v18
    v_lshlrev_b32 v18, 6, v18
    v_and_b32 v17, 3, v4
    v_lshl_add_u32 v18, v17, 3, v18
    v_lshl_add_u32 v26, v7, 5, v18
    v_xor_b32 v27, 32, v26
    v_mov_b32 v24, v26
    v_mov_b32 v25, v27
    v_and_b32 v18, 0x30, v1
    v_add_u32 v10, 155648, v18
    v_lshlrev_b32 v11, 2, v4
    v_add_u32 v11, 155648, v11
    v_lshl_add_u32 v8, v2, 8, v11
    v_lshl_add_u32 v9, v2, 8, v10
    s_lshr_b32 s3, s8, 1
    s_and_b32 s55, s8, 1
    s_lshl_b32 s56, s55, 5
    v_xor_b32 v29, s56, v26
    s_lshl_b32 s56, s3, 13
    s_add_u32 s56, s56, 8192
    v_add_u32 v29, s56, v29
    v_mov_b32 v28, v29
    v_add_u32 v30, 147456, v5
    v_lshl_add_u32 v14, v2, 6, v10
    v_lshl_add_u32 v12, v2, 11, v5
    v_add_u32 v12, 131072, v12
    v_lshlrev_b32 v16, 8, v16
    v_lshl_add_u32 v16, v18, 2, v16
    v_lshl_add_u32 v16, v17, 1, v16
    v_add_u32 v16, 1024, v16
    v_cmp_gt_u32 vcc, 2, v2
    s_nop 1
    v_cndmask_b32 v13, v16, v5, vcc
    s_lshl_b32 s56, s55, 3
    s_add_u32 s56, s56, 131072
    v_add_u32 v13, s56, v13
    v_lshrrev_b32 v18, 2, v18
    v_sub_u32 v18, v4, v18
    v_mov_b32 v19, 0xf149f2ca
    v_add_u32 v16, 0x0, v18
    v_and_b32 v16, 0xfffffff1, v16
    v_cmp_eq_u32 vcc, 0, v16
    s_nop 1
    v_cndmask_b32 v196, v19, 0, vcc
    v_add_u32 v16, 0xffffffff, v18
    v_and_b32 v16, 0xfffffff1, v16
    v_cmp_eq_u32 vcc, 0, v16
    s_nop 1
    v_cndmask_b32 v197, v19, 0, vcc
    v_add_u32 v16, 0xfffffffe, v18
    v_and_b32 v16, 0xfffffff1, v16
    v_cmp_eq_u32 vcc, 0, v16
    s_nop 1
    v_cndmask_b32 v198, v19, 0, vcc
    v_add_u32 v16, 0xfffffffd, v18
    v_and_b32 v16, 0xfffffff1, v16
    v_cmp_eq_u32 vcc, 0, v16
    s_nop 1
    v_cndmask_b32 v199, v19, 0, vcc
    v_add_u32 v16, 0x10, v18
    v_and_b32 v16, 0xfffffff1, v16
    v_cmp_eq_u32 vcc, 0, v16
    s_nop 1
    v_cndmask_b32 v200, v19, 0, vcc
    v_add_u32 v16, 0xf, v18
    v_and_b32 v16, 0xfffffff1, v16
    v_cmp_eq_u32 vcc, 0, v16
    s_nop 1
    v_cndmask_b32 v201, v19, 0, vcc
    v_add_u32 v16, 0xe, v18
    v_and_b32 v16, 0xfffffff1, v16
    v_cmp_eq_u32 vcc, 0, v16
    s_nop 1
    v_cndmask_b32 v202, v19, 0, vcc
    v_add_u32 v16, 0xd, v18
    v_and_b32 v16, 0xfffffff1, v16
    v_cmp_eq_u32 vcc, 0, v16
    s_nop 1
    v_cndmask_b32 v203, v19, 0, vcc
    s_cmp_eq_u32 s48, 0
    s_cselect_b64 vcc, -1, 0
    v_cndmask_b32 v204, v200, v19, vcc
    v_cndmask_b32 v205, v201, v19, vcc
    v_cndmask_b32 v206, v202, v19, vcc
    v_cndmask_b32 v207, v203, v19, vcc
    v_mov_b32 v208, 0x3f803f80
    v_mov_b32 v209, 0x3f803f80
    v_mov_b32 v210, 0x3f803f80
    v_mov_b32 v211, 0x3f803f80
    v_mov_b32 v184, 0
    v_mov_b32 v185, 0
    v_mov_b32 v186, 0
    v_mov_b32 v187, 0
    v_mov_b32 v188, 0
    v_mov_b32 v189, 0
    v_mov_b32 v190, 0
    v_mov_b32 v191, 0
    v_mov_b32 v192, 0
    v_mov_b32 v193, 0
    v_mov_b32 v194, 0
    v_mov_b32 v195, 0
    v_mov_b32 v32, 0
    v_mov_b32 v33, 0
    v_mov_b32 v34, 0
    v_mov_b32 v35, 0
    v_mov_b32 v36, 0
    v_mov_b32 v37, 0
    v_mov_b32 v38, 0
    v_mov_b32 v39, 0
    v_mov_b32 v40, 0
    v_mov_b32 v41, 0
    v_mov_b32 v42, 0
    v_mov_b32 v43, 0
    v_mov_b32 v44, 0
    v_mov_b32 v45, 0
    v_mov_b32 v46, 0
    v_mov_b32 v47, 0
    v_mov_b32 v48, 0
    v_mov_b32 v49, 0
    v_mov_b32 v50, 0
    v_mov_b32 v51, 0
    v_mov_b32 v52, 0
    v_mov_b32 v53, 0
    v_mov_b32 v54, 0
    v_mov_b32 v55, 0
    v_mov_b32 v56, 0
    v_mov_b32 v57, 0
    v_mov_b32 v58, 0
    v_mov_b32 v59, 0
    v_mov_b32 v60, 0
    v_mov_b32 v61, 0
    v_mov_b32 v62, 0
    v_mov_b32 v63, 0
    v_mov_b32 v64, 0
    v_mov_b32 v65, 0
    v_mov_b32 v66, 0
    v_mov_b32 v67, 0
    v_mov_b32 v68, 0
    v_mov_b32 v69, 0
    v_mov_b32 v70, 0
    v_mov_b32 v71, 0
    v_mov_b32 v72, 0
    v_mov_b32 v73, 0
    v_mov_b32 v74, 0
    v_mov_b32 v75, 0
    v_mov_b32 v76, 0
    v_mov_b32 v77, 0
    v_mov_b32 v78, 0
    v_mov_b32 v79, 0
    v_mov_b32 v80, 0
    v_mov_b32 v81, 0
    v_mov_b32 v82, 0
    v_mov_b32 v83, 0
    v_mov_b32 v84, 0
    v_mov_b32 v85, 0
    v_mov_b32 v86, 0
    v_mov_b32 v87, 0
    v_mov_b32 v88, 0
    v_mov_b32 v89, 0
    v_mov_b32 v90, 0
    v_mov_b32 v91, 0
    v_mov_b32 v92, 0
    v_mov_b32 v93, 0
    v_mov_b32 v94, 0
    v_mov_b32 v95, 0
    v_mov_b32 v96, 0
    v_mov_b32 v97, 0
    v_mov_b32 v98, 0
    v_mov_b32 v99, 0
    v_mov_b32 v100, 0
    v_mov_b32 v101, 0
    v_mov_b32 v102, 0
    v_mov_b32 v103, 0
    v_mov_b32 v104, 0
    v_mov_b32 v105, 0
    v_mov_b32 v106, 0
    v_mov_b32 v107, 0
    v_mov_b32 v108, 0
    v_mov_b32 v109, 0
    v_mov_b32 v110, 0
    v_mov_b32 v111, 0
    v_mov_b32 v112, 0
    v_mov_b32 v113, 0
    v_mov_b32 v114, 0
    v_mov_b32 v115, 0
    v_mov_b32 v116, 0
    v_mov_b32 v117, 0
    v_mov_b32 v118, 0
    v_mov_b32 v119, 0
    v_mov_b32 v120, 0
    v_mov_b32 v121, 0
    v_mov_b32 v122, 0
    v_mov_b32 v123, 0
    v_mov_b32 v124, 0
    v_mov_b32 v125, 0
    v_mov_b32 v126, 0
    v_mov_b32 v127, 0
    s_mov_b32 s50, 8192
    s_mov_b32 s58, 6144
    s_mov_b32 s51, 12288
    s_mov_b32 s59, 10240
    s_mov_b32 s52, 0
    s_mul_i32 s60, s9, 786432
    s_add_u32 s60, s60, 65273856
    s_lshl_b32 s61, s11, 10
    s_add_u32 s60, s60, s61
    s_lshl_b32 s61, s8, 7
    s_add_u32 s60, s60, s61
    s_mov_b32 s98, s10
    s_mov_b32 s99, s10
    s_mov_b32 s3, 0x20000
cp_1:
    s_load_dwordx8 s[24:31], s[4:5], s60 glc
    s_sub_u32 s3, s3, 1
    s_cbranch_scc1 cp_1_ok
    s_waitcnt lgkmcnt(0)
    s_xor_b64 s[24:25], s[24:25], s[98:99]
    s_xor_b64 s[26:27], s[26:27], s[98:99]
    s_xor_b64 s[28:29], s[28:29], s[98:99]
    s_xor_b64 s[30:31], s[30:31], s[98:99]
    s_or_b64 s[24:25], s[24:25], s[26:27]
    s_or_b64 s[28:29], s[28:29], s[30:31]
    s_or_b64 s[24:25], s[24:25], s[28:29]
    s_cbranch_scc1 cp_1
cp_1_ok:
    s_waitcnt lgkmcnt(0)
    s_barrier
    buffer_load_dwordx4 v[152:155], v6, s[16:19], 0 offen offset:0 sc1
    buffer_load_dwordx4 v[156:159], v6, s[16:19], 0 offen offset:256 sc1
    buffer_load_dwordx4 v[160:163], v6, s[20:23], 0 offen offset:0 sc1
    buffer_load_dwordx4 v[164:167], v6, s[20:23], 0 offen offset:256 sc1
    ds_read_b64_tr_b16 v[128:129], v24 offset:0
    ds_read_b64_tr_b16 v[130:131], v24 offset:512
    ds_read_b64_tr_b16 v[132:133], v25 offset:0
    ds_read_b64_tr_b16 v[134:135], v25 offset:512
    ds_read_b64_tr_b16 v[136:137], v24 offset:8192
    ds_read_b64_tr_b16 v[138:139], v24 offset:8704
    ds_read_b64_tr_b16 v[140:141], v25 offset:8192
    ds_read_b64_tr_b16 v[142:143], v25 offset:8704
    ds_read_b64_tr_b16 v[144:145], v24 offset:16384
    ds_read_b64_tr_b16 v[146:147], v24 offset:16896
    buffer_load_dwordx4 v[168:171], v6, s[16:19], 0 offen offset:2048 sc1
    buffer_load_dwordx4 v[172:175], v6, s[16:19], 0 offen offset:2304 sc1
    buffer_load_dwordx4 v[176:179], v6, s[20:23], 0 offen offset:2048 sc1
    buffer_load_dwordx4 v[180:183], v6, s[20:23], 0 offen offset:2304 sc1
    buffer_load_dwordx4 a[0:3], v6, s[16:19], s54 offen offset:0 sc1
    buffer_load_dwordx4 a[4:7], v6, s[16:19], s54 offen offset:256 sc1
    buffer_load_dwordx4 a[8:11], v6, s[20:23], s54 offen offset:0 sc1
    buffer_load_dwordx4 a[12:15], v6, s[20:23], s54 offen offset:256 sc1
    buffer_load_dwordx4 a[16:19], v6, s[16:19], s54 offen offset:2048 sc1
    buffer_load_dwordx4 a[20:23], v6, s[16:19], s54 offen offset:2304 sc1
    s_mov_b32 s54, 7
    s_waitcnt vmcnt(12)
    s_barrier
.p2align 3
c_qkvA_loop:
    s_waitcnt vmcnt(12) lgkmcnt(8)
    v_mfma_f32_16x16x32_bf16 v[184:187], v[188:191], v[192:195], v[184:187]
    v_mfma_f32_16x16x32_bf16 v[32:35], v[128:131], v[152:155], v[32:35]
    ds_read_b64_tr_b16 v[148:149], v25 offset:16384
    buffer_load_dwordx4 a[24:27], v6, s[20:23], s58 offen offset:0 sc1
    v_mfma_f32_16x16x32_bf16 v[36:39], v[128:131], v[156:159], v[36:39]
    ds_read_b64_tr_b16 v[150:151], v25 offset:16896
    s_waitcnt lgkmcnt(8)
    v_mfma_f32_16x16x32_bf16 v[52:55], v[132:135], v[156:159], v[52:55]
    v_mfma_f32_16x16x32_bf16 v[48:51], v[132:135], v[152:155], v[48:51]
    ds_read_b64_tr_b16 v[188:189], v28 offset:0
    s_waitcnt lgkmcnt(7)
    v_mfma_f32_16x16x32_bf16 v[64:67], v[136:139], v[152:155], v[64:67]
    v_mfma_f32_16x16x32_bf16 v[68:71], v[136:139], v[156:159], v[68:71]
    ds_read_b64_tr_b16 v[190:191], v28 offset:512
    s_waitcnt lgkmcnt(6)
    v_mfma_f32_16x16x32_bf16 v[84:87], v[140:143], v[156:159], v[84:87]
    buffer_load_dwordx4 a[28:31], v6, s[20:23], s58 offen offset:256 sc1
    v_mfma_f32_16x16x32_bf16 v[80:83], v[140:143], v[152:155], v[80:83]
    ds_read_b128 v[192:195], v30 offset:0
    s_waitcnt lgkmcnt(5)
    v_mfma_f32_16x16x32_bf16 v[96:99], v[152:155], v[144:147], v[96:99]
    v_mfma_f32_16x16x32_bf16 v[100:103], v[156:159], v[144:147], v[100:103]
    s_waitcnt lgkmcnt(3)
    v_mfma_f32_16x16x32_bf16 v[116:119], v[156:159], v[148:151], v[116:119]
    v_mfma_f32_16x16x32_bf16 v[112:115], v[152:155], v[148:151], v[112:115]
    s_waitcnt vmcnt(12)
    v_mfma_f32_16x16x32_bf16 v[40:43], v[128:131], v[160:163], v[40:43]
    buffer_load_dwordx4 v[152:155], v6, s[16:19], s50 offen offset:0 sc1
    v_mfma_f32_16x16x32_bf16 v[44:47], v[128:131], v[164:167], v[44:47]
    v_mfma_f32_16x16x32_bf16 v[60:63], v[132:135], v[164:167], v[60:63]
    ds_read_b64_tr_b16 v[128:129], v24 offset:2048
    v_mfma_f32_16x16x32_bf16 v[56:59], v[132:135], v[160:163], v[56:59]
    ds_read_b64_tr_b16 v[130:131], v24 offset:2560
    v_mfma_f32_16x16x32_bf16 v[72:75], v[136:139], v[160:163], v[72:75]
    ds_read_b64_tr_b16 v[132:133], v25 offset:2048
    v_mfma_f32_16x16x32_bf16 v[76:79], v[136:139], v[164:167], v[76:79]
    ds_read_b64_tr_b16 v[134:135], v25 offset:2560
    v_mfma_f32_16x16x32_bf16 v[92:95], v[140:143], v[164:167], v[92:95]
    ds_read_b64_tr_b16 v[136:137], v24 offset:10240
    buffer_load_dwordx4 v[156:159], v6, s[16:19], s50 offen offset:256 sc1
    v_mfma_f32_16x16x32_bf16 v[88:91], v[140:143], v[160:163], v[88:91]
    ds_read_b64_tr_b16 v[138:139], v24 offset:10752
    v_mfma_f32_16x16x32_bf16 v[104:107], v[160:163], v[144:147], v[104:107]
    ds_read_b64_tr_b16 v[140:141], v25 offset:10240
    v_mfma_f32_16x16x32_bf16 v[108:111], v[164:167], v[144:147], v[108:111]
    ds_read_b64_tr_b16 v[142:143], v25 offset:10752
    v_mfma_f32_16x16x32_bf16 v[124:127], v[164:167], v[148:151], v[124:127]
    ds_read_b64_tr_b16 v[144:145], v24 offset:18432
    v_mfma_f32_16x16x32_bf16 v[120:123], v[160:163], v[148:151], v[120:123]
    ds_read_b64_tr_b16 v[146:147], v24 offset:18944
    s_waitcnt vmcnt(12) lgkmcnt(8)
    v_mfma_f32_16x16x32_bf16 v[184:187], v[188:191], v[192:195], v[184:187]
    v_mfma_f32_16x16x32_bf16 v[32:35], v[128:131], v[168:171], v[32:35]
    ds_read_b64_tr_b16 v[148:149], v25 offset:18432
    buffer_load_dwordx4 v[160:163], v6, s[20:23], s58 offen offset:2048 sc1
    v_mfma_f32_16x16x32_bf16 v[36:39], v[128:131], v[172:175], v[36:39]
    ds_read_b64_tr_b16 v[150:151], v25 offset:18944
    s_waitcnt lgkmcnt(8)
    v_mfma_f32_16x16x32_bf16 v[52:55], v[132:135], v[172:175], v[52:55]
    v_mfma_f32_16x16x32_bf16 v[48:51], v[132:135], v[168:171], v[48:51]
    ds_read_b64_tr_b16 v[188:189], v28 offset:2048
    s_waitcnt lgkmcnt(7)
    v_mfma_f32_16x16x32_bf16 v[64:67], v[136:139], v[168:171], v[64:67]
    v_mfma_f32_16x16x32_bf16 v[68:71], v[136:139], v[172:175], v[68:71]
    ds_read_b64_tr_b16 v[190:191], v28 offset:2560
    s_waitcnt lgkmcnt(6)
    v_mfma_f32_16x16x32_bf16 v[84:87], v[140:143], v[172:175], v[84:87]
    buffer_load_dwordx4 v[164:167], v6, s[20:23], s58 offen offset:2304 sc1
    v_mfma_f32_16x16x32_bf16 v[80:83], v[140:143], v[168:171], v[80:83]
    ds_read_b128 v[192:195], v30 offset:1024
    s_waitcnt lgkmcnt(5)
    v_mfma_f32_16x16x32_bf16 v[96:99], v[168:171], v[144:147], v[96:99]
    v_mfma_f32_16x16x32_bf16 v[100:103], v[172:175], v[144:147], v[100:103]
    s_waitcnt lgkmcnt(3)
    v_mfma_f32_16x16x32_bf16 v[116:119], v[172:175], v[148:151], v[116:119]
    v_mfma_f32_16x16x32_bf16 v[112:115], v[168:171], v[148:151], v[112:115]
    s_waitcnt vmcnt(12)
    v_mfma_f32_16x16x32_bf16 v[40:43], v[128:131], v[176:179], v[40:43]
    buffer_load_dwordx4 v[168:171], v6, s[16:19], s50 offen offset:2048 sc1
    v_mfma_f32_16x16x32_bf16 v[44:47], v[128:131], v[180:183], v[44:47]
    v_mfma_f32_16x16x32_bf16 v[60:63], v[132:135], v[180:183], v[60:63]
    ds_read_b64_tr_b16 v[128:129], v24 offset:4096
    v_mfma_f32_16x16x32_bf16 v[56:59], v[132:135], v[176:179], v[56:59]
    ds_read_b64_tr_b16 v[130:131], v24 offset:4608
    v_mfma_f32_16x16x32_bf16 v[72:75], v[136:139], v[176:179], v[72:75]
    ds_read_b64_tr_b16 v[132:133], v25 offset:4096
    v_mfma_f32_16x16x32_bf16 v[76:79], v[136:139], v[180:183], v[76:79]
    ds_read_b64_tr_b16 v[134:135], v25 offset:4608
    v_mfma_f32_16x16x32_bf16 v[92:95], v[140:143], v[180:183], v[92:95]
    ds_read_b64_tr_b16 v[136:137], v24 offset:12288
    buffer_load_dwordx4 v[172:175], v6, s[16:19], s50 offen offset:2304 sc1
    v_mfma_f32_16x16x32_bf16 v[88:91], v[140:143], v[176:179], v[88:91]
    ds_read_b64_tr_b16 v[138:139], v24 offset:12800
    v_mfma_f32_16x16x32_bf16 v[104:107], v[176:179], v[144:147], v[104:107]
    ds_read_b64_tr_b16 v[140:141], v25 offset:12288
    v_mfma_f32_16x16x32_bf16 v[108:111], v[180:183], v[144:147], v[108:111]
    ds_read_b64_tr_b16 v[142:143], v25 offset:12800
    v_mfma_f32_16x16x32_bf16 v[124:127], v[180:183], v[148:151], v[124:127]
    ds_read_b64_tr_b16 v[144:145], v24 offset:20480
    v_mfma_f32_16x16x32_bf16 v[120:123], v[176:179], v[148:151], v[120:123]
    ds_read_b64_tr_b16 v[146:147], v24 offset:20992
    s_waitcnt vmcnt(12) lgkmcnt(8)
    v_mfma_f32_16x16x32_bf16 v[184:187], v[188:191], v[192:195], v[184:187]
    v_mfma_f32_16x16x32_bf16 v[32:35], v[128:131], a[0:3], v[32:35]
    ds_read_b64_tr_b16 v[148:149], v25 offset:20480
    buffer_load_dwordx4 v[176:179], v6, s[20:23], s59 offen offset:0 sc1
    v_mfma_f32_16x16x32_bf16 v[36:39], v[128:131], a[4:7], v[36:39]
    ds_read_b64_tr_b16 v[150:151], v25 offset:20992
    s_waitcnt lgkmcnt(8)
    v_mfma_f32_16x16x32_bf16 v[52:55], v[132:135], a[4:7], v[52:55]
    v_mfma_f32_16x16x32_bf16 v[48:51], v[132:135], a[0:3], v[48:51]
    ds_read_b64_tr_b16 v[188:189], v28 offset:4096
    s_waitcnt lgkmcnt(7)
    v_mfma_f32_16x16x32_bf16 v[64:67], v[136:139], a[0:3], v[64:67]
    v_mfma_f32_16x16x32_bf16 v[68:71], v[136:139], a[4:7], v[68:71]
    ds_read_b64_tr_b16 v[190:191], v28 offset:4608
    s_waitcnt lgkmcnt(6)
    v_mfma_f32_16x16x32_bf16 v[84:87], v[140:143], a[4:7], v[84:87]
    buffer_load_dwordx4 v[180:183], v6, s[20:23], s59 offen offset:256 sc1
    v_mfma_f32_16x16x32_bf16 v[80:83], v[140:143], a[0:3], v[80:83]
    ds_read_b128 v[192:195], v30 offset:2048
    s_waitcnt lgkmcnt(5)
    v_mfma_f32_16x16x32_bf16 v[96:99], a[0:3], v[144:147], v[96:99]
    v_mfma_f32_16x16x32_bf16 v[100:103], a[4:7], v[144:147], v[100:103]
    s_waitcnt lgkmcnt(3)
    v_mfma_f32_16x16x32_bf16 v[116:119], a[4:7], v[148:151], v[116:119]
    v_mfma_f32_16x16x32_bf16 v[112:115], a[0:3], v[148:151], v[112:115]
    s_waitcnt vmcnt(12)
    v_mfma_f32_16x16x32_bf16 v[40:43], v[128:131], a[8:11], v[40:43]
    buffer_load_dwordx4 a[0:3], v6, s[16:19], s51 offen offset:0 sc1
    v_mfma_f32_16x16x32_bf16 v[44:47], v[128:131], a[12:15], v[44:47]
    v_mfma_f32_16x16x32_bf16 v[60:63], v[132:135], a[12:15], v[60:63]
    ds_read_b64_tr_b16 v[128:129], v24 offset:6144
    v_mfma_f32_16x16x32_bf16 v[56:59], v[132:135], a[8:11], v[56:59]
    ds_read_b64_tr_b16 v[130:131], v24 offset:6656
    v_mfma_f32_16x16x32_bf16 v[72:75], v[136:139], a[8:11], v[72:75]
    ds_read_b64_tr_b16 v[132:133], v25 offset:6144
    v_mfma_f32_16x16x32_bf16 v[76:79], v[136:139], a[12:15], v[76:79]
    ds_read_b64_tr_b16 v[134:135], v25 offset:6656
    v_mfma_f32_16x16x32_bf16 v[92:95], v[140:143], a[12:15], v[92:95]
    ds_read_b64_tr_b16 v[136:137], v24 offset:14336
    buffer_load_dwordx4 a[4:7], v6, s[16:19], s51 offen offset:256 sc1
    v_mfma_f32_16x16x32_bf16 v[88:91], v[140:143], a[8:11], v[88:91]
    ds_read_b64_tr_b16 v[138:139], v24 offset:14848
    v_mfma_f32_16x16x32_bf16 v[104:107], a[8:11], v[144:147], v[104:107]
    ds_read_b64_tr_b16 v[140:141], v25 offset:14336
    v_mfma_f32_16x16x32_bf16 v[108:111], a[12:15], v[144:147], v[108:111]
    ds_read_b64_tr_b16 v[142:143], v25 offset:14848
    v_mfma_f32_16x16x32_bf16 v[124:127], a[12:15], v[148:151], v[124:127]
    ds_read_b64_tr_b16 v[144:145], v24 offset:22528
    v_mfma_f32_16x16x32_bf16 v[120:123], a[8:11], v[148:151], v[120:123]
    ds_read_b64_tr_b16 v[146:147], v24 offset:23040
    s_waitcnt vmcnt(12) lgkmcnt(8)
    v_mfma_f32_16x16x32_bf16 v[184:187], v[188:191], v[192:195], v[184:187]
    v_mfma_f32_16x16x32_bf16 v[32:35], v[128:131], a[16:19], v[32:35]
    ds_read_b64_tr_b16 v[148:149], v25 offset:22528
    buffer_load_dwordx4 a[8:11], v6, s[20:23], s59 offen offset:2048 sc1
    v_mfma_f32_16x16x32_bf16 v[36:39], v[128:131], a[20:23], v[36:39]
    ds_read_b64_tr_b16 v[150:151], v25 offset:23040
    s_waitcnt lgkmcnt(8)
    v_mfma_f32_16x16x32_bf16 v[52:55], v[132:135], a[20:23], v[52:55]
    v_mfma_f32_16x16x32_bf16 v[48:51], v[132:135], a[16:19], v[48:51]
    ds_read_b64_tr_b16 v[188:189], v28 offset:6144
    s_waitcnt lgkmcnt(7)
    v_mfma_f32_16x16x32_bf16 v[64:67], v[136:139], a[16:19], v[64:67]
    v_mfma_f32_16x16x32_bf16 v[68:71], v[136:139], a[20:23], v[68:71]
    ds_read_b64_tr_b16 v[190:191], v28 offset:6656
    s_waitcnt lgkmcnt(6)
    v_mfma_f32_16x16x32_bf16 v[84:87], v[140:143], a[20:23], v[84:87]
    buffer_load_dwordx4 a[12:15], v6, s[20:23], s59 offen offset:2304 sc1
    v_mfma_f32_16x16x32_bf16 v[80:83], v[140:143], a[16:19], v[80:83]
    ds_read_b128 v[192:195], v30 offset:3072
    s_waitcnt lgkmcnt(5)
    v_mfma_f32_16x16x32_bf16 v[96:99], a[16:19], v[144:147], v[96:99]
    s_add_u32 s52, s52, 24576
    v_mfma_f32_16x16x32_bf16 v[100:103], a[20:23], v[144:147], v[100:103]
    s_cmp_eq_u32 s52, 147456
    s_waitcnt lgkmcnt(3)
    v_mfma_f32_16x16x32_bf16 v[116:119], a[20:23], v[148:151], v[116:119]
    s_cselect_b32 s52, 0, s52
    v_mfma_f32_16x16x32_bf16 v[112:115], a[16:19], v[148:151], v[112:115]
    s_add_u32 s58, s58, 8192
    s_add_u32 s59, s59, 8192
    s_waitcnt vmcnt(12) lgkmcnt(0)
    v_mfma_f32_16x16x32_bf16 v[40:43], v[128:131], a[24:27], v[40:43]
    buffer_load_dwordx4 a[16:19], v6, s[16:19], s51 offen offset:2048 sc1
    s_barrier
    v_add_u32 v24, s52, v26
    v_mfma_f32_16x16x32_bf16 v[44:47], v[128:131], a[28:31], v[44:47]
    v_add_u32 v25, s52, v27
    v_add_u32 v28, s52, v29
    v_mfma_f32_16x16x32_bf16 v[60:63], v[132:135], a[28:31], v[60:63]
    ds_read_b64_tr_b16 v[128:129], v24 offset:0
    v_mfma_f32_16x16x32_bf16 v[56:59], v[132:135], a[24:27], v[56:59]
    ds_read_b64_tr_b16 v[130:131], v24 offset:512
    v_mfma_f32_16x16x32_bf16 v[72:75], v[136:139], a[24:27], v[72:75]
    ds_read_b64_tr_b16 v[132:133], v25 offset:0
    v_mfma_f32_16x16x32_bf16 v[76:79], v[136:139], a[28:31], v[76:79]
    ds_read_b64_tr_b16 v[134:135], v25 offset:512
    v_xor_b32 v30, 4096, v30
    v_mfma_f32_16x16x32_bf16 v[92:95], v[140:143], a[28:31], v[92:95]
    ds_read_b64_tr_b16 v[136:137], v24 offset:8192
    buffer_load_dwordx4 a[20:23], v6, s[16:19], s51 offen offset:2304 sc1
    v_mfma_f32_16x16x32_bf16 v[88:91], v[140:143], a[24:27], v[88:91]
    ds_read_b64_tr_b16 v[138:139], v24 offset:8704
    v_mfma_f32_16x16x32_bf16 v[104:107], a[24:27], v[144:147], v[104:107]
    ds_read_b64_tr_b16 v[140:141], v25 offset:8192
    s_add_u32 s50, s50, 8192
    v_mfma_f32_16x16x32_bf16 v[108:111], a[28:31], v[144:147], v[108:111]
    ds_read_b64_tr_b16 v[142:143], v25 offset:8704
    s_add_u32 s51, s51, 8192
    v_mfma_f32_16x16x32_bf16 v[124:127], a[28:31], v[148:151], v[124:127]
    ds_read_b64_tr_b16 v[144:145], v24 offset:16384
    s_sub_u32 s54, s54, 1
    v_mfma_f32_16x16x32_bf16 v[120:123], a[24:27], v[148:151], v[120:123]
    ds_read_b64_tr_b16 v[146:147], v24 offset:16896
    s_cmp_lg_u32 s54, 0
    s_cbranch_scc1 c_qkvA_loop
    s_waitcnt vmcnt(12) lgkmcnt(8)
    v_mfma_f32_16x16x32_bf16 v[184:187], v[188:191], v[192:195], v[184:187]
    v_mfma_f32_16x16x32_bf16 v[32:35], v[128:131], v[152:155], v[32:35]
    ds_read_b64_tr_b16 v[148:149], v25 offset:16384
    buffer_load_dwordx4 a[24:27], v6, s[20:23], s58 offen offset:0 sc1
    v_mfma_f32_16x16x32_bf16 v[36:39], v[128:131], v[156:159], v[36:39]
    ds_read_b64_tr_b16 v[150:151], v25 offset:16896
    s_waitcnt lgkmcnt(8)
    v_mfma_f32_16x16x32_bf16 v[52:55], v[132:135], v[156:159], v[52:55]
    ds_read_b32 v16, v8 offset:1280
    v_mfma_f32_16x16x32_bf16 v[48:51], v[132:135], v[152:155], v[48:51]
    ds_read_b64_tr_b16 v[188:189], v28 offset:0
    ds_read_b32 v18, v8 offset:1344
    s_waitcnt lgkmcnt(9)
    v_mfma_f32_16x16x32_bf16 v[64:67], v[136:139], v[152:155], v[64:67]
    ds_read_b32 v20, v8 offset:1408
    v_mfma_f32_16x16x32_bf16 v[68:71], v[136:139], v[156:159], v[68:71]
    ds_read_b64_tr_b16 v[190:191], v28 offset:512
    s_waitcnt lgkmcnt(9)
    v_mfma_f32_16x16x32_bf16 v[84:87], v[140:143], v[156:159], v[84:87]
    buffer_load_dwordx4 a[28:31], v6, s[20:23], s58 offen offset:256 sc1
    ds_read_b32 v22, v8 offset:1472
    v_mfma_f32_16x16x32_bf16 v[80:83], v[140:143], v[152:155], v[80:83]
    ds_read_b128 v[192:195], v30 offset:0
    ds_read_b128 v[212:215], v10 offset:128
    s_waitcnt lgkmcnt(10)
    v_mfma_f32_16x16x32_bf16 v[96:99], v[152:155], v[144:147], v[96:99]
    ds_read_b128 v[216:219], v10 offset:192
    v_mfma_f32_16x16x32_bf16 v[100:103], v[156:159], v[144:147], v[100:103]
    s_waitcnt lgkmcnt(9)
    v_mfma_f32_16x16x32_bf16 v[116:119], v[156:159], v[148:151], v[116:119]
    v_mfma_f32_16x16x32_bf16 v[112:115], v[152:155], v[148:151], v[112:115]
    s_waitcnt vmcnt(12)
    v_mfma_f32_16x16x32_bf16 v[40:43], v[128:131], v[160:163], v[40:43]
    s_waitcnt lgkmcnt(0)
    v_fma_f32 v64, -v16, v212, v64
    v_fma_f32 v65, -v16, v213, v65
    v_mfma_f32_16x16x32_bf16 v[44:47], v[128:131], v[164:167], v[44:47]
    v_fma_f32 v66, -v16, v214, v66
    v_mfma_f32_16x16x32_bf16 v[60:63], v[132:135], v[164:167], v[60:63]
    ds_read_b64_tr_b16 v[128:129], v24 offset:2048
    v_fma_f32 v67, -v16, v215, v67
    v_mfma_f32_16x16x32_bf16 v[56:59], v[132:135], v[160:163], v[56:59]
    ds_read_b64_tr_b16 v[130:131], v24 offset:2560
    v_fma_f32 v68, -v18, v212, v68
    v_fma_f32 v69, -v18, v213, v69
    v_mfma_f32_16x16x32_bf16 v[72:75], v[136:139], v[160:163], v[72:75]
    ds_read_b64_tr_b16 v[132:133], v25 offset:2048
    v_fma_f32 v70, -v18, v214, v70
    v_mfma_f32_16x16x32_bf16 v[76:79], v[136:139], v[164:167], v[76:79]
    ds_read_b64_tr_b16 v[134:135], v25 offset:2560
    v_fma_f32 v71, -v18, v215, v71
    v_mfma_f32_16x16x32_bf16 v[92:95], v[140:143], v[164:167], v[92:95]
    ds_read_b64_tr_b16 v[136:137], v24 offset:10240
    v_fma_f32 v80, -v16, v216, v80
    v_fma_f32 v81, -v16, v217, v81
    v_mfma_f32_16x16x32_bf16 v[88:91], v[140:143], v[160:163], v[88:91]
    ds_read_b64_tr_b16 v[138:139], v24 offset:10752
    v_fma_f32 v82, -v16, v218, v82
    v_mfma_f32_16x16x32_bf16 v[104:107], v[160:163], v[144:147], v[104:107]
    ds_read_b64_tr_b16 v[140:141], v25 offset:10240
    v_fma_f32 v83, -v16, v219, v83
    v_mfma_f32_16x16x32_bf16 v[108:111], v[164:167], v[144:147], v[108:111]
    ds_read_b64_tr_b16 v[142:143], v25 offset:10752
    v_fma_f32 v84, -v18, v216, v84
    v_fma_f32 v85, -v18, v217, v85
    v_mfma_f32_16x16x32_bf16 v[124:127], v[164:167], v[148:151], v[124:127]
    ds_read_b64_tr_b16 v[144:145], v24 offset:18432
    v_fma_f32 v86, -v18, v218, v86
    v_mfma_f32_16x16x32_bf16 v[120:123], v[160:163], v[148:151], v[120:123]
    ds_read_b64_tr_b16 v[146:147], v24 offset:18944
    v_fma_f32 v87, -v18, v219, v87
    s_waitcnt vmcnt(10) lgkmcnt(8)
    v_mfma_f32_16x16x32_bf16 v[184:187], v[188:191], v[192:195], v[184:187]
    v_mfma_f32_16x16x32_bf16 v[32:35], v[128:131], v[168:171], v[32:35]
    ds_read_b64_tr_b16 v[148:149], v25 offset:18432
    v_fma_f32 v72, -v20, v212, v72
    v_fma_f32 v73, -v20, v213, v73
    v_mfma_f32_16x16x32_bf16 v[36:39], v[128:131], v[172:175], v[36:39]
    ds_read_b64_tr_b16 v[150:151], v25 offset:18944
    v_fma_f32 v74, -v20, v214, v74
    s_waitcnt lgkmcnt(8)
    v_mfma_f32_16x16x32_bf16 v[52:55], v[132:135], v[172:175], v[52:55]
    v_fma_f32 v75, -v20, v215, v75
    ds_read_b128 v[152:155], v10 offset:0
    v_mfma_f32_16x16x32_bf16 v[48:51], v[132:135], v[168:171], v[48:51]
    ds_read_b64_tr_b16 v[188:189], v28 offset:2048
    v_fma_f32 v76, -v22, v212, v76
    v_fma_f32 v77, -v22, v213, v77
    ds_read_b128 v[156:159], v10 offset:64
    s_waitcnt lgkmcnt(9)
    v_mfma_f32_16x16x32_bf16 v[64:67], v[136:139], v[168:171], v[64:67]
    v_fma_f32 v78, -v22, v214, v78
    ds_read_b32 v17, v8 offset:2816
    v_mfma_f32_16x16x32_bf16 v[68:71], v[136:139], v[172:175], v[68:71]
    ds_read_b64_tr_b16 v[190:191], v28 offset:2560
    v_fma_f32 v79, -v22, v215, v79
    s_waitcnt lgkmcnt(9)
    v_mfma_f32_16x16x32_bf16 v[84:87], v[140:143], v[172:175], v[84:87]
    v_fma_f32 v88, -v20, v216, v88
    v_fma_f32 v89, -v20, v217, v89
    ds_read_b32 v19, v8 offset:2880
    v_mfma_f32_16x16x32_bf16 v[80:83], v[140:143], v[168:171], v[80:83]
    ds_read_b128 v[192:195], v30 offset:1024
    v_fma_f32 v90, -v20, v218, v90
    ds_read_b32 v21, v8 offset:2944
    s_waitcnt lgkmcnt(10)
    v_mfma_f32_16x16x32_bf16 v[96:99], v[168:171], v[144:147], v[96:99]
    v_fma_f32 v91, -v20, v219, v91
    ds_read_b32 v23, v8 offset:3008
    v_mfma_f32_16x16x32_bf16 v[100:103], v[172:175], v[144:147], v[100:103]
    v_fma_f32 v92, -v22, v216, v92
    v_fma_f32 v93, -v22, v217, v93
    s_waitcnt lgkmcnt(9)
    v_mfma_f32_16x16x32_bf16 v[116:119], v[172:175], v[148:151], v[116:119]
    v_fma_f32 v94, -v22, v218, v94
    v_mfma_f32_16x16x32_bf16 v[112:115], v[168:171], v[148:151], v[112:115]
    v_fma_f32 v95, -v22, v219, v95
    s_waitcnt vmcnt(8)
    v_mfma_f32_16x16x32_bf16 v[40:43], v[128:131], v[176:179], v[40:43]
    s_waitcnt lgkmcnt(0)
    v_fma_f32 v32, -v16, v152, v32
    v_fma_f32 v33, -v16, v153, v33
    v_mfma_f32_16x16x32_bf16 v[44:47], v[128:131], v[180:183], v[44:47]
    v_fma_f32 v34, -v16, v154, v34
    v_mfma_f32_16x16x32_bf16 v[60:63], v[132:135], v[180:183], v[60:63]
    ds_read_b64_tr_b16 v[128:129], v24 offset:4096
    v_fma_f32 v35, -v16, v155, v35
    v_fma_f32 v36, -v18, v152, v36
    v_mfma_f32_16x16x32_bf16 v[56:59], v[132:135], v[176:179], v[56:59]
    ds_read_b64_tr_b16 v[130:131], v24 offset:4608
    v_fma_f32 v37, -v18, v153, v37
    v_mfma_f32_16x16x32_bf16 v[72:75], v[136:139], v[176:179], v[72:75]
    ds_read_b64_tr_b16 v[132:133], v25 offset:4096
    v_fma_f32 v38, -v18, v154, v38
    v_fma_f32 v39, -v18, v155, v39
    v_mfma_f32_16x16x32_bf16 v[76:79], v[136:139], v[180:183], v[76:79]
    ds_read_b64_tr_b16 v[134:135], v25 offset:4608
    v_fma_f32 v48, -v16, v156, v48
    v_mfma_f32_16x16x32_bf16 v[92:95], v[140:143], v[180:183], v[92:95]
    ds_read_b64_tr_b16 v[136:137], v24 offset:12288
    v_fma_f32 v49, -v16, v157, v49
    v_fma_f32 v50, -v16, v158, v50
    v_mfma_f32_16x16x32_bf16 v[88:91], v[140:143], v[176:179], v[88:91]
    ds_read_b64_tr_b16 v[138:139], v24 offset:12800
    v_fma_f32 v51, -v16, v159, v51
    v_mfma_f32_16x16x32_bf16 v[104:107], v[176:179], v[144:147], v[104:107]
    ds_read_b64_tr_b16 v[140:141], v25 offset:12288
    v_fma_f32 v52, -v18, v156, v52
    v_fma_f32 v53, -v18, v157, v53
    v_mfma_f32_16x16x32_bf16 v[108:111], v[180:183], v[144:147], v[108:111]
    ds_read_b64_tr_b16 v[142:143], v25 offset:12800
    v_fma_f32 v54, -v18, v158, v54
    v_mfma_f32_16x16x32_bf16 v[124:127], v[180:183], v[148:151], v[124:127]
    ds_read_b64_tr_b16 v[144:145], v24 offset:20480
    v_fma_f32 v55, -v18, v159, v55
    v_mfma_f32_16x16x32_bf16 v[120:123], v[176:179], v[148:151], v[120:123]
    ds_read_b64_tr_b16 v[146:147], v24 offset:20992
    s_waitcnt vmcnt(6) lgkmcnt(8)
    v_mfma_f32_16x16x32_bf16 v[184:187], v[188:191], v[192:195], v[184:187]
    v_mfma_f32_16x16x32_bf16 v[32:35], v[128:131], a[0:3], v[32:35]
    ds_read_b64_tr_b16 v[148:149], v25 offset:20480
    v_fma_f32 v40, -v20, v152, v40
    v_fma_f32 v41, -v20, v153, v41
    v_mfma_f32_16x16x32_bf16 v[36:39], v[128:131], a[4:7], v[36:39]
    ds_read_b64_tr_b16 v[150:151], v25 offset:20992
    v_fma_f32 v42, -v20, v154, v42
    s_waitcnt lgkmcnt(8)
    v_mfma_f32_16x16x32_bf16 v[52:55], v[132:135], a[4:7], v[52:55]
    v_fma_f32 v43, -v20, v155, v43
    v_fma_f32 v44, -v22, v152, v44
    ds_read_b128 v[168:171], v9 offset:1280
    v_mfma_f32_16x16x32_bf16 v[48:51], v[132:135], a[0:3], v[48:51]
    ds_read_b64_tr_b16 v[188:189], v28 offset:4096
    v_fma_f32 v45, -v22, v153, v45
    ds_read_b128 v[172:175], v9 offset:1344
    s_waitcnt lgkmcnt(9)
    v_mfma_f32_16x16x32_bf16 v[64:67], v[136:139], a[0:3], v[64:67]
    v_fma_f32 v46, -v22, v154, v46
    v_fma_f32 v47, -v22, v155, v47
    v_mfma_f32_16x16x32_bf16 v[68:71], v[136:139], a[4:7], v[68:71]
    ds_read_b64_tr_b16 v[190:191], v28 offset:4608
    v_fma_f32 v56, -v20, v156, v56
    ds_read_b128 v[176:179], v9 offset:1408
    s_waitcnt lgkmcnt(9)
    v_mfma_f32_16x16x32_bf16 v[84:87], v[140:143], a[4:7], v[84:87]
    v_fma_f32 v57, -v20, v157, v57
    v_fma_f32 v58, -v20, v158, v58
    ds_read_b128 v[180:183], v9 offset:1472
    v_mfma_f32_16x16x32_bf16 v[80:83], v[140:143], a[0:3], v[80:83]
    ds_read_b128 v[192:195], v30 offset:2048
    v_fma_f32 v59, -v20, v159, v59
    s_waitcnt lgkmcnt(9)
    v_mfma_f32_16x16x32_bf16 v[96:99], a[0:3], v[144:147], v[96:99]
    v_fma_f32 v60, -v22, v156, v60
    v_fma_f32 v61, -v22, v157, v61
    ds_read2_b32 v[220:221], v11 offset0:64 offset1:80
    v_mfma_f32_16x16x32_bf16 v[100:103], a[4:7], v[144:147], v[100:103]
    v_fma_f32 v62, -v22, v158, v62
    s_waitcnt lgkmcnt(8)
    v_mfma_f32_16x16x32_bf16 v[116:119], a[4:7], v[148:151], v[116:119]
    v_fma_f32 v63, -v22, v159, v63
    v_mfma_f32_16x16x32_bf16 v[112:115], a[0:3], v[148:151], v[112:115]
    s_waitcnt vmcnt(4)
    v_mfma_f32_16x16x32_bf16 v[40:43], v[128:131], a[8:11], v[40:43]
    v_mfma_f32_16x16x32_bf16 v[44:47], v[128:131], a[12:15], v[44:47]
    s_waitcnt lgkmcnt(0)
    v_fma_f32 v96, -v168, v220, v96
    v_fma_f32 v97, -v169, v220, v97
    v_mfma_f32_16x16x32_bf16 v[60:63], v[132:135], a[12:15], v[60:63]
    ds_read_b64_tr_b16 v[128:129], v24 offset:6144
    v_fma_f32 v98, -v170, v220, v98
    v_mfma_f32_16x16x32_bf16 v[56:59], v[132:135], a[8:11], v[56:59]
    ds_read_b64_tr_b16 v[130:131], v24 offset:6656
    v_fma_f32 v99, -v171, v220, v99
    v_fma_f32 v100, -v172, v220, v100
    v_mfma_f32_16x16x32_bf16 v[72:75], v[136:139], a[8:11], v[72:75]
    ds_read_b64_tr_b16 v[132:133], v25 offset:6144
    v_fma_f32 v101, -v173, v220, v101
    v_mfma_f32_16x16x32_bf16 v[76:79], v[136:139], a[12:15], v[76:79]
    ds_read_b64_tr_b16 v[134:135], v25 offset:6656
    v_fma_f32 v102, -v174, v220, v102
    v_fma_f32 v103, -v175, v220, v103
    v_mfma_f32_16x16x32_bf16 v[92:95], v[140:143], a[12:15], v[92:95]
    ds_read_b64_tr_b16 v[136:137], v24 offset:14336
    v_fma_f32 v112, -v168, v221, v112
    v_mfma_f32_16x16x32_bf16 v[88:91], v[140:143], a[8:11], v[88:91]
    ds_read_b64_tr_b16 v[138:139], v24 offset:14848
    v_fma_f32 v113, -v169, v221, v113
    v_fma_f32 v114, -v170, v221, v114
    v_mfma_f32_16x16x32_bf16 v[104:107], a[8:11], v[144:147], v[104:107]
    ds_read_b64_tr_b16 v[140:141], v25 offset:14336
    v_fma_f32 v115, -v171, v221, v115
    v_mfma_f32_16x16x32_bf16 v[108:111], a[12:15], v[144:147], v[108:111]
    ds_read_b64_tr_b16 v[142:143], v25 offset:14848
    v_fma_f32 v116, -v172, v221, v116
    v_fma_f32 v117, -v173, v221, v117
    v_mfma_f32_16x16x32_bf16 v[124:127], a[12:15], v[148:151], v[124:127]
    ds_read_b64_tr_b16 v[144:145], v24 offset:22528
    v_fma_f32 v118, -v174, v221, v118
    v_mfma_f32_16x16x32_bf16 v[120:123], a[8:11], v[148:151], v[120:123]
    ds_read_b64_tr_b16 v[146:147], v24 offset:23040
    v_fma_f32 v119, -v175, v221, v119
    s_waitcnt vmcnt(2) lgkmcnt(8)
    v_mfma_f32_16x16x32_bf16 v[184:187], v[188:191], v[192:195], v[184:187]
    v_mfma_f32_16x16x32_bf16 v[32:35], v[128:131], a[16:19], v[32:35]
    ds_read_b64_tr_b16 v[148:149], v25 offset:22528
    v_mfma_f32_16x16x32_bf16 v[36:39], v[128:131], a[20:23], v[36:39]
    ds_read_b64_tr_b16 v[150:151], v25 offset:23040
    v_fma_f32 v104, -v176, v220, v104
    v_fma_f32 v105, -v177, v220, v105
    s_waitcnt lgkmcnt(8)
    v_mfma_f32_16x16x32_bf16 v[52:55], v[132:135], a[20:23], v[52:55]
    v_fma_f32 v106, -v178, v220, v106
    ds_read_b128 v[152:155], v9 offset:2816
    v_mfma_f32_16x16x32_bf16 v[48:51], v[132:135], a[16:19], v[48:51]
    ds_read_b64_tr_b16 v[188:189], v28 offset:6144
    v_fma_f32 v107, -v179, v220, v107
    v_fma_f32 v108, -v180, v220, v108
    ds_read_b128 v[156:159], v9 offset:2880
    s_waitcnt lgkmcnt(9)
    v_mfma_f32_16x16x32_bf16 v[64:67], v[136:139], a[16:19], v[64:67]
    v_fma_f32 v109, -v181, v220, v109
    ds_read_b128 v[160:163], v9 offset:2944
    v_mfma_f32_16x16x32_bf16 v[68:71], v[136:139], a[20:23], v[68:71]
    ds_read_b64_tr_b16 v[190:191], v28 offset:6656
    v_fma_f32 v110, -v182, v220, v110
    v_fma_f32 v111, -v183, v220, v111
    ds_read_b128 v[164:167], v9 offset:3008
    s_waitcnt lgkmcnt(10)
    v_mfma_f32_16x16x32_bf16 v[84:87], v[140:143], a[20:23], v[84:87]
    v_fma_f32 v120, -v176, v221, v120
    ds_read_b128 v[212:215], v14 offset:128
    v_mfma_f32_16x16x32_bf16 v[80:83], v[140:143], a[16:19], v[80:83]
    ds_read_b128 v[192:195], v30 offset:3072
    v_fma_f32 v121, -v177, v221, v121
    v_fma_f32 v122, -v178, v221, v122
    ds_read_b32 v222, v11 offset:1216
    s_waitcnt lgkmcnt(11)
    v_mfma_f32_16x16x32_bf16 v[96:99], a[16:19], v[144:147], v[96:99]
    v_fma_f32 v123, -v179, v221, v123
    ds_read_b32 v223, v11 offset:2752
    v_mfma_f32_16x16x32_bf16 v[100:103], a[20:23], v[144:147], v[100:103]
    v_fma_f32 v124, -v180, v221, v124
    v_fma_f32 v125, -v181, v221, v125
    s_waitcnt lgkmcnt(10)
    v_mfma_f32_16x16x32_bf16 v[116:119], a[20:23], v[148:151], v[116:119]
    v_fma_f32 v126, -v182, v221, v126
    v_mfma_f32_16x16x32_bf16 v[112:115], a[16:19], v[148:151], v[112:115]
    v_fma_f32 v127, -v183, v221, v127
    s_waitcnt vmcnt(0) lgkmcnt(2)
    v_mfma_f32_16x16x32_bf16 v[40:43], v[128:131], a[24:27], v[40:43]
    v_mul_f32 v64, v17, v64
    v_mul_f32 v65, v17, v65
    s_barrier
    v_mfma_f32_16x16x32_bf16 v[44:47], v[128:131], a[28:31], v[44:47]
    v_mul_f32 v66, v17, v66
    v_mul_f32 v67, v17, v67
    v_mfma_f32_16x16x32_bf16 v[60:63], v[132:135], a[28:31], v[60:63]
    v_mul_f32 v80, v17, v80
    v_mul_f32 v81, v17, v81
    v_mfma_f32_16x16x32_bf16 v[56:59], v[132:135], a[24:27], v[56:59]
    v_mul_f32 v82, v17, v82
    v_mul_f32 v83, v17, v83
    v_mfma_f32_16x16x32_bf16 v[72:75], v[136:139], a[24:27], v[72:75]
    v_cvt_pk_bf16_f32 v64, v64, v65
    v_cvt_pk_bf16_f32 v65, v66, v67
    v_mfma_f32_16x16x32_bf16 v[76:79], v[136:139], a[28:31], v[76:79]
    v_cvt_pk_bf16_f32 v66, v80, v81
    v_cvt_pk_bf16_f32 v67, v82, v83
    v_mfma_f32_16x16x32_bf16 v[92:95], v[140:143], a[28:31], v[92:95]
    v_mul_f32 v68, v19, v68
    v_mul_f32 v69, v19, v69
    v_mfma_f32_16x16x32_bf16 v[88:91], v[140:143], a[24:27], v[88:91]
    v_mul_f32 v70, v19, v70
    v_mul_f32 v71, v19, v71
    v_mfma_f32_16x16x32_bf16 v[104:107], a[24:27], v[144:147], v[104:107]
    v_mul_f32 v84, v19, v84
    v_mul_f32 v85, v19, v85
    v_mfma_f32_16x16x32_bf16 v[108:111], a[28:31], v[144:147], v[108:111]
    v_mul_f32 v86, v19, v86
    v_mul_f32 v87, v19, v87
    v_mfma_f32_16x16x32_bf16 v[124:127], a[28:31], v[148:151], v[124:127]
    v_cvt_pk_bf16_f32 v68, v68, v69
    v_cvt_pk_bf16_f32 v69, v70, v71
    v_mfma_f32_16x16x32_bf16 v[120:123], a[24:27], v[148:151], v[120:123]
    v_cvt_pk_bf16_f32 v70, v84, v85
    v_cvt_pk_bf16_f32 v71, v86, v87
    v_mfma_f32_16x16x32_bf16 v[184:187], v[188:191], v[192:195], v[184:187]
    v_pk_mul_f32 v[72:73], v[20:21], v[72:73] op_sel:[1,0] op_sel_hi:[1,1]
    v_pk_mul_f32 v[74:75], v[20:21], v[74:75] op_sel:[1,0] op_sel_hi:[1,1]
    v_pk_mul_f32 v[88:89], v[20:21], v[88:89] op_sel:[1,0] op_sel_hi:[1,1]
    v_pk_mul_f32 v[90:91], v[20:21], v[90:91] op_sel:[1,0] op_sel_hi:[1,1]
    v_cvt_pk_bf16_f32 v72, v72, v73
    v_cvt_pk_bf16_f32 v73, v74, v75
    v_cvt_pk_bf16_f32 v74, v88, v89
    v_cvt_pk_bf16_f32 v75, v90, v91
    v_pk_mul_f32 v[76:77], v[22:23], v[76:77] op_sel:[1,0] op_sel_hi:[1,1]
    v_pk_mul_f32 v[78:79], v[22:23], v[78:79] op_sel:[1,0] op_sel_hi:[1,1]
    v_pk_mul_f32 v[92:93], v[22:23], v[92:93] op_sel:[1,0] op_sel_hi:[1,1]
    v_pk_mul_f32 v[94:95], v[22:23], v[94:95] op_sel:[1,0] op_sel_hi:[1,1]
    v_cvt_pk_bf16_f32 v76, v76, v77
    v_cvt_pk_bf16_f32 v77, v78, v79
    v_cvt_pk_bf16_f32 v78, v92, v93
    v_cvt_pk_bf16_f32 v79, v94, v95
    ds_write_b128 v12, v[76:79] offset:2048
    s_waitcnt lgkmcnt(1)
    v_pk_mul_f32 v[96:97], v[152:153], v[96:97]
    v_pk_mul_f32 v[98:99], v[154:155], v[98:99]
    v_pk_mul_f32 v[112:113], v[152:153], v[112:113]
    v_pk_mul_f32 v[114:115], v[154:155], v[114:115]
    v_cvt_pk_bf16_f32 v99, v98, v99
    v_cvt_pk_bf16_f32 v98, v96, v97
    v_cvt_pk_bf16_f32 v115, v114, v115
    v_cvt_pk_bf16_f32 v114, v112, v113
    v_pk_mul_f32 v[100:101], v[156:157], v[100:101]
    v_pk_mul_f32 v[102:103], v[158:159], v[102:103]
    v_pk_mul_f32 v[116:117], v[156:157], v[116:117]
    v_pk_mul_f32 v[118:119], v[158:159], v[118:119]
    v_cvt_pk_bf16_f32 v100, v100, v101
    v_cvt_pk_bf16_f32 v101, v102, v103
    v_cvt_pk_bf16_f32 v116, v116, v117
    v_cvt_pk_bf16_f32 v117, v118, v119
    v_pk_mul_f32 v[104:105], v[160:161], v[104:105]
    v_pk_mul_f32 v[106:107], v[162:163], v[106:107]
    v_pk_mul_f32 v[120:121], v[160:161], v[120:121]
    v_pk_mul_f32 v[122:123], v[162:163], v[122:123]
    v_cvt_pk_bf16_f32 v102, v104, v105
    v_cvt_pk_bf16_f32 v103, v106, v107
    v_cvt_pk_bf16_f32 v118, v120, v121
    v_cvt_pk_bf16_f32 v119, v122, v123
    v_pk_mul_f32 v[108:109], v[164:165], v[108:109]
    v_pk_mul_f32 v[110:111], v[166:167], v[110:111]
    v_pk_mul_f32 v[124:125], v[164:165], v[124:125]
    v_pk_mul_f32 v[126:127], v[166:167], v[126:127]
    v_cvt_pk_bf16_f32 v104, v108, v109
    v_cvt_pk_bf16_f32 v105, v110, v111
    v_cvt_pk_bf16_f32 v120, v124, v125
    v_cvt_pk_bf16_f32 v121, v126, v127
    ds_write_b64 v12, v[104:105] offset:3072
    ds_write_b64 v12, v[120:121] offset:3080
    v_pk_fma_f32 v[184:185], v[222:223], v[212:213], v[184:185] op_sel_hi:[0,1,1] neg_lo:[1,0,0] neg_hi:[1,0,0]
    v_pk_fma_f32 v[186:187], v[222:223], v[214:215], v[186:187] op_sel_hi:[0,1,1] neg_lo:[1,0,0] neg_hi:[1,0,0]
    v_pk_mul_f32 v[184:185], v[222:223], v[184:185] op_sel:[1,0] op_sel_hi:[1,1]
    v_pk_mul_f32 v[186:187], v[222:223], v[186:187] op_sel:[1,0] op_sel_hi:[1,1]
    v_cvt_pk_bf16_f32 v184, v184, v185
    v_cvt_pk_bf16_f32 v185, v186, v187
    s_cmp_ge_u32 s8, 2
    s_cbranch_scc1 c_qkvA_hv
    ds_write_b64 v13, v[184:185]
    s_branch c_qkvA_hd
c_qkvA_hv:
    ds_write_b16 v13, v184 offset:0
    ds_write_b16_d16_hi v13, v184 offset:16
    ds_write_b16 v13, v185 offset:32
    ds_write_b16_d16_hi v13, v185 offset:48
c_qkvA_hd:
    v_cvt_pk_bf16_f32 v44, v44, v45
    v_cvt_pk_bf16_f32 v45, v46, v47
    v_cvt_pk_bf16_f32 v46, v60, v61
    v_cvt_pk_bf16_f32 v47, v62, v63
    v_mul_f32 v23, 0x3e8293ee, v23
    v_cvt_pk_bf16_f32 v40, v40, v41
    v_cvt_pk_bf16_f32 v41, v42, v43
    v_cvt_pk_bf16_f32 v42, v56, v57
    v_cvt_pk_bf16_f32 v43, v58, v59
    v_mul_f32 v21, 0x3e8293ee, v21
    s_waitcnt lgkmcnt(0)
    s_barrier
    ds_read_b128 v[172:175], v12
    ds_read_b64 v[96:97], v12 offset:1024
    ds_read_b64 v[112:113], v12 offset:1032
    v_mfma_f32_16x16x32_bf16 v[156:159], v[76:79], v[44:47], v[196:199]
    v_mfma_f32_16x16x32_bf16 v[152:155], v[72:75], v[44:47], v[200:203]
    v_cvt_pk_bf16_f32 v36, v36, v37
    v_cvt_pk_bf16_f32 v37, v38, v39
    v_cvt_pk_bf16_f32 v38, v52, v53
    v_cvt_pk_bf16_f32 v39, v54, v55
    v_mul_f32 v19, 0x3e8293ee, v19
    v_mfma_f32_16x16x32_bf16 v[148:151], v[72:75], v[40:43], v[196:199]
    v_mfma_f32_16x16x32_bf16 v[144:147], v[68:71], v[40:43], v[200:203]
    v_cvt_pk_bf16_f32 v32, v32, v33
    v_cvt_pk_bf16_f32 v33, v34, v35
    v_cvt_pk_bf16_f32 v34, v48, v49
    v_cvt_pk_bf16_f32 v35, v50, v51
    v_mul_f32 v17, 0x3e8293ee, v17
    v_mfma_f32_16x16x32_bf16 v[140:143], v[68:71], v[36:39], v[196:199]
    v_mfma_f32_16x16x32_bf16 v[136:139], v[64:67], v[36:39], v[200:203]
    s_waitcnt lgkmcnt(2)
    v_mfma_f32_16x16x32_bf16 v[132:135], v[64:67], v[32:35], v[196:199]
    v_mfma_f32_16x16x32_bf16 v[128:131], v[172:175], v[32:35], v[204:207]
    v_max3_f32 v179, v152, v153, v154
    v_max3_f32 v183, v155, v156, v157
    v_max3_f32 v179, v179, v158, v159
    v_max_f32 v179, v179, v183
    v_max3_f32 v178, v144, v145, v146
    v_max3_f32 v182, v147, v148, v149
    v_max3_f32 v178, v178, v150, v151
    v_max_f32 v178, v178, v182
    v_max3_f32 v177, v136, v137, v138
    v_max3_f32 v181, v139, v140, v141
    v_max3_f32 v177, v177, v142, v143
    v_max_f32 v177, v177, v181
    v_max3_f32 v176, v128, v129, v130
    v_max3_f32 v180, v131, v132, v133
    v_max3_f32 v176, v176, v134, v135
    v_max_f32 v176, v176, v180
    v_mov_b32 v183, v179
    v_mov_b32 v182, v178
    v_mov_b32 v181, v177
    v_mov_b32 v180, v176
    v_permlane32_swap_b32 v179, v183
    v_permlane32_swap_b32 v178, v182
    v_permlane32_swap_b32 v177, v181
    v_permlane32_swap_b32 v176, v180
    v_max_f32 v179, v179, v183
    v_max_f32 v178, v178, v182
    v_max_f32 v177, v177, v181
    v_max_f32 v176, v176, v180
    v_mov_b32 v183, v179
    v_mov_b32 v182, v178
    v_mov_b32 v181, v177
    v_mov_b32 v180, v176
    v_permlane16_swap_b32 v179, v183
    v_permlane16_swap_b32 v178, v182
    v_permlane16_swap_b32 v177, v181
    v_permlane16_swap_b32 v176, v180
    v_max_f32 v179, v179, v183
    v_max_f32 v178, v178, v182
    v_max_f32 v177, v177, v181
    v_max_f32 v176, v176, v180
    v_mul_f32_e64 v22, -v179, v23
    v_mul_f32_e64 v20, -v178, v21
    v_mul_f32_e64 v18, -v177, v19
    v_mul_f32_e64 v16, -v176, v17
    s_waitcnt lgkmcnt(0)
    s_add_u32 s51, s49, 65536
    v_pk_fma_f32 v[152:153], v[152:153], v[22:23], v[22:23] op_sel:[0,1,0] op_sel_hi:[1,1,0]
    v_pk_fma_f32 v[154:155], v[154:155], v[22:23], v[22:23] op_sel:[0,1,0] op_sel_hi:[1,1,0]
    v_pk_fma_f32 v[156:157], v[156:157], v[22:23], v[22:23] op_sel:[0,1,0] op_sel_hi:[1,1,0]
    v_pk_fma_f32 v[158:159], v[158:159], v[22:23], v[22:23] op_sel:[0,1,0] op_sel_hi:[1,1,0]
    v_exp_f32 v152, v152
    v_exp_f32 v153, v153
    v_exp_f32 v154, v154
    v_exp_f32 v155, v155
    v_exp_f32 v156, v156
    v_exp_f32 v157, v157
    v_exp_f32 v158, v158
    v_exp_f32 v159, v159
    v_cvt_pk_bf16_f32 v172, v152, v153
    v_cvt_pk_bf16_f32 v173, v154, v155
    v_cvt_pk_bf16_f32 v174, v156, v157
    v_cvt_pk_bf16_f32 v175, v158, v159
    s_nop 1
    v_mfma_f32_16x16x32_bf16 v[92:95], v[208:211], v[172:175], 0
    v_mfma_f32_16x16x32_bf16 v[60:63], v[102:105], v[172:175], 0
    v_mfma_f32_16x16x32_bf16 v[76:79], v[118:121], v[172:175], 0
    v_pk_fma_f32 v[144:145], v[144:145], v[20:21], v[20:21] op_sel:[0,1,0] op_sel_hi:[1,1,0]
    v_pk_fma_f32 v[146:147], v[146:147], v[20:21], v[20:21] op_sel:[0,1,0] op_sel_hi:[1,1,0]
    v_pk_fma_f32 v[148:149], v[148:149], v[20:21], v[20:21] op_sel:[0,1,0] op_sel_hi:[1,1,0]
    v_pk_fma_f32 v[150:151], v[150:151], v[20:21], v[20:21] op_sel:[0,1,0] op_sel_hi:[1,1,0]
    v_exp_f32 v144, v144
    v_exp_f32 v145, v145
    v_exp_f32 v146, v146
    v_exp_f32 v147, v147
    v_exp_f32 v148, v148
    v_exp_f32 v149, v149
    v_exp_f32 v150, v150
    v_exp_f32 v151, v151
    v_cvt_pk_bf16_f32 v168, v144, v145
    v_cvt_pk_bf16_f32 v169, v146, v147
    v_cvt_pk_bf16_f32 v170, v148, v149
    v_cvt_pk_bf16_f32 v171, v150, v151
    v_rcp_f32 v92, v92
    s_nop 0
    v_pk_mul_f32 v[60:61], v[92:93], v[60:61] op_sel_hi:[0,1]
    v_pk_mul_f32 v[62:63], v[92:93], v[62:63] op_sel_hi:[0,1]
    v_pk_mul_f32 v[76:77], v[92:93], v[76:77] op_sel_hi:[0,1]
    v_pk_mul_f32 v[78:79], v[92:93], v[78:79] op_sel_hi:[0,1]
    v_cvt_pk_bf16_f32 v60, v60, v61
    v_cvt_pk_bf16_f32 v61, v62, v63
    v_cvt_pk_bf16_f32 v62, v76, v77
    v_cvt_pk_bf16_f32 v63, v78, v79
    s_nop 0
    v_permlane32_swap_b32 v60, v62
    v_permlane32_swap_b32 v61, v63
    buffer_store_dwordx4 v[60:63], v6, s[12:15], s51 offen offset:256 sc1
    v_mfma_f32_16x16x32_bf16 v[88:91], v[208:211], v[168:171], 0
    v_mfma_f32_16x16x32_bf16 v[56:59], v[100:103], v[168:171], 0
    v_mfma_f32_16x16x32_bf16 v[72:75], v[116:119], v[168:171], 0
    v_pk_fma_f32 v[136:137], v[136:137], v[18:19], v[18:19] op_sel:[0,1,0] op_sel_hi:[1,1,0]
    v_pk_fma_f32 v[138:139], v[138:139], v[18:19], v[18:19] op_sel:[0,1,0] op_sel_hi:[1,1,0]
    v_pk_fma_f32 v[140:141], v[140:141], v[18:19], v[18:19] op_sel:[0,1,0] op_sel_hi:[1,1,0]
    v_pk_fma_f32 v[142:143], v[142:143], v[18:19], v[18:19] op_sel:[0,1,0] op_sel_hi:[1,1,0]
    v_exp_f32 v136, v136
    v_exp_f32 v137, v137
    v_exp_f32 v138, v138
    v_exp_f32 v139, v139
    v_exp_f32 v140, v140
    v_exp_f32 v141, v141
    v_exp_f32 v142, v142
    v_exp_f32 v143, v143
    v_cvt_pk_bf16_f32 v164, v136, v137
    v_cvt_pk_bf16_f32 v165, v138, v139
    v_cvt_pk_bf16_f32 v166, v140, v141
    v_cvt_pk_bf16_f32 v167, v142, v143
    v_rcp_f32 v88, v88
    s_nop 0
    v_pk_mul_f32 v[56:57], v[88:89], v[56:57] op_sel_hi:[0,1]
    v_pk_mul_f32 v[58:59], v[88:89], v[58:59] op_sel_hi:[0,1]
    v_pk_mul_f32 v[72:73], v[88:89], v[72:73] op_sel_hi:[0,1]
    v_pk_mul_f32 v[74:75], v[88:89], v[74:75] op_sel_hi:[0,1]
    v_cvt_pk_bf16_f32 v56, v56, v57
    v_cvt_pk_bf16_f32 v57, v58, v59
    v_cvt_pk_bf16_f32 v58, v72, v73
    v_cvt_pk_bf16_f32 v59, v74, v75
    s_nop 0
    v_permlane32_swap_b32 v56, v58
    v_permlane32_swap_b32 v57, v59
    buffer_store_dwordx4 v[56:59], v6, s[12:15], s51 offen offset:0 sc1
    v_mfma_f32_16x16x32_bf16 v[84:87], v[208:211], v[164:167], 0
    v_mfma_f32_16x16x32_bf16 v[52:55], v[98:101], v[164:167], 0
    v_mfma_f32_16x16x32_bf16 v[68:71], v[114:117], v[164:167], 0
    v_pk_fma_f32 v[128:129], v[128:129], v[16:17], v[16:17] op_sel:[0,1,0] op_sel_hi:[1,1,0]
    v_pk_fma_f32 v[130:131], v[130:131], v[16:17], v[16:17] op_sel:[0,1,0] op_sel_hi:[1,1,0]
    v_pk_fma_f32 v[132:133], v[132:133], v[16:17], v[16:17] op_sel:[0,1,0] op_sel_hi:[1,1,0]
    v_pk_fma_f32 v[134:135], v[134:135], v[16:17], v[16:17] op_sel:[0,1,0] op_sel_hi:[1,1,0]
    v_exp_f32 v128, v128
    v_exp_f32 v129, v129
    v_exp_f32 v130, v130
    v_exp_f32 v131, v131
    v_exp_f32 v132, v132
    v_exp_f32 v133, v133
    v_exp_f32 v134, v134
    v_exp_f32 v135, v135
    v_cvt_pk_bf16_f32 v160, v128, v129
    v_cvt_pk_bf16_f32 v161, v130, v131
    v_cvt_pk_bf16_f32 v162, v132, v133
    v_cvt_pk_bf16_f32 v163, v134, v135
    v_rcp_f32 v84, v84
    s_nop 0
    v_pk_mul_f32 v[52:53], v[84:85], v[52:53] op_sel_hi:[0,1]
    v_pk_mul_f32 v[54:55], v[84:85], v[54:55] op_sel_hi:[0,1]
    v_pk_mul_f32 v[68:69], v[84:85], v[68:69] op_sel_hi:[0,1]
    v_pk_mul_f32 v[70:71], v[84:85], v[70:71] op_sel_hi:[0,1]
    v_cvt_pk_bf16_f32 v52, v52, v53
    v_cvt_pk_bf16_f32 v53, v54, v55
    v_cvt_pk_bf16_f32 v54, v68, v69
    v_cvt_pk_bf16_f32 v55, v70, v71
    s_nop 0
    v_permlane32_swap_b32 v52, v54
    v_permlane32_swap_b32 v53, v55
    buffer_store_dwordx4 v[52:55], v6, s[12:15], s49 offen offset:256 sc1
    v_mfma_f32_16x16x32_bf16 v[80:83], v[208:211], v[160:163], 0
    v_mfma_f32_16x16x32_bf16 v[48:51], v[96:99], v[160:163], 0
    v_mfma_f32_16x16x32_bf16 v[64:67], v[112:115], v[160:163], 0
    s_nop 5
    v_rcp_f32 v80, v80
    s_nop 0
    v_pk_mul_f32 v[48:49], v[80:81], v[48:49] op_sel_hi:[0,1]
    v_pk_mul_f32 v[50:51], v[80:81], v[50:51] op_sel_hi:[0,1]
    v_pk_mul_f32 v[64:65], v[80:81], v[64:65] op_sel_hi:[0,1]
    v_pk_mul_f32 v[66:67], v[80:81], v[66:67] op_sel_hi:[0,1]
    v_cvt_pk_bf16_f32 v48, v48, v49
    v_cvt_pk_bf16_f32 v49, v50, v51
    v_cvt_pk_bf16_f32 v50, v64, v65
    v_cvt_pk_bf16_f32 v51, v66, v67
    s_nop 0
    v_permlane32_swap_b32 v48, v50
    v_permlane32_swap_b32 v49, v51
    buffer_store_dwordx4 v[48:51], v6, s[12:15], s49 offen offset:0 sc1
    s_mul_i32 s55, s9, 786432
    s_add_u32 s55, s55, 65798144
    v_and_b32 v16, 63, v0
    s_and_b32 s56, s11, 0xe0
    v_lshrrev_b32 v17, 5, v16
    v_add_u32 v16, s56, v16
    v_and_b32 v16, 255, v16
    v_lshlrev_b32 v16, 10, v16
    v_lshl_add_u32 v16, v17, 8, v16
    s_bfe_u32 s56, s11, 0x20003
    s_and_b32 s57, s11, 7
    s_lshl_b32 s56, s56, 7
    s_lshl_b32 s57, s57, 2
    s_add_u32 s55, s55, s56
    s_add_u32 s55, s55, s57
    v_mov_b32 v17, 159488
    v_mov_b32 v18, 1
    v_mov_b32 v19, s10
    s_mov_b64 exec, 1
    s_waitcnt vmcnt(0)
    ds_add_rtn_u32 v18, v17, v18
    s_waitcnt lgkmcnt(0)
    v_readfirstlane_b32 s56, v18
    s_and_b32 s56, s56, 3
    s_cmp_lg_u32 s56, 3
    s_cbranch_scc1 pub_2
    s_mov_b32 exec_lo, -1
    buffer_store_dword v19, v16, s[12:15], s55 offen sc1
pub_2:
    s_mov_b64 exec, -1
    s_branch c_wo
.p2align 6
c_wo:
    v_and_b32 v1, 63, v0
    v_lshrrev_b32 v2, 6, v0
    v_lshlrev_b32 v5, 4, v1
    v_lshrrev_b32 v3, 5, v1
    s_lshl_b32 s48, s6, 2
    s_add_u32 s48, s48, s8
    s_lshl_b32 s55, s48, 16
    s_lshl_b32 s56, s9, 22
    s_add_u32 s55, s55, s56
    s_lshl_b32 s56, s7, 12
    s_add_u32 s58, s55, s56
    buffer_load_dwordx4 v[96:99], v5, s[12:15], s58 offen offset:0 sc1
    buffer_load_dwordx4 v[100:103], v5, s[12:15], s58 offen offset:1024 sc1
    buffer_load_dwordx4 v[104:107], v5, s[12:15], s58 offen offset:2048 sc1
    buffer_load_dwordx4 v[108:111], v5, s[12:15], s58 offen offset:3072 sc1
    s_add_u32 s55, s55, 16777216
    s_add_u32 s16, s4, s55
    s_addc_u32 s17, s5, 0
    s_mov_b32 s18, 65536
    s_mov_b32 s19, 0x00020000
    v_and_b32 v4, 15, v0
    v_lshrrev_b32 v16, 2, v4
    v_lshl_add_u32 v16, v3, 2, v16
    v_lshlrev_b32 v16, 7, v16
    v_bfe_u32 v17, v1, 4, 1
    v_lshl_add_u32 v16, v17, 5, v16
    v_and_b32 v17, 3, v4
    v_lshl_add_u32 v16, v17, 3, v16
    v_lshrrev_b32 v17, 3, v4
    v_lshlrev_b32 v18, 6, v17
    v_add_u32 v12, v16, v18
    v_sub_u32 v13, v16, v18
    s_mov_b32 s57, 0xffff0000
    s_waitcnt vmcnt(0)
    v_lshlrev_b32 v32, 16, v96
    v_and_b32 v33, s57, v96
    v_lshlrev_b32 v34, 16, v97
    v_and_b32 v35, s57, v97
    v_lshlrev_b32 v36, 16, v98
    v_and_b32 v37, s57, v98
    v_lshlrev_b32 v38, 16, v99
    v_and_b32 v39, s57, v99
    v_lshlrev_b32 v40, 16, v100
    v_and_b32 v41, s57, v100
    v_lshlrev_b32 v42, 16, v101
    v_and_b32 v43, s57, v101
    v_lshlrev_b32 v44, 16, v102
    v_and_b32 v45, s57, v102
    v_lshlrev_b32 v46, 16, v103
    v_and_b32 v47, s57, v103
    v_lshlrev_b32 v48, 16, v104
    v_and_b32 v49, s57, v104
    v_lshlrev_b32 v50, 16, v105
    v_and_b32 v51, s57, v105
    v_lshlrev_b32 v52, 16, v106
    v_and_b32 v53, s57, v106
    v_lshlrev_b32 v54, 16, v107
    v_and_b32 v55, s57, v107
    v_lshlrev_b32 v56, 16, v108
    v_and_b32 v57, s57, v108
    v_lshlrev_b32 v58, 16, v109
    v_and_b32 v59, s57, v109
    v_lshlrev_b32 v60, 16, v110
    v_and_b32 v61, s57, v110
    v_lshlrev_b32 v62, 16, v111
    v_and_b32 v63, s57, v111
    s_mov_b32 s50, 0
    s_mov_b32 s51, 4096
    s_mov_b32 s52, 8192
    s_mov_b32 s53, 12288
    s_mov_b32 s54, 3
    s_mul_i32 s60, s9, 786432
    s_add_u32 s60, s60, 65798144
    s_lshl_b32 s61, s11, 10
    s_add_u32 s60, s60, s61
    s_lshl_b32 s61, s8, 7
    s_add_u32 s60, s60, s61
    s_mov_b32 s98, s10
    s_mov_b32 s99, s10
    s_mov_b32 s3, 0x20000
cp_3:
    s_load_dwordx8 s[24:31], s[4:5], s60 glc
    s_sub_u32 s3, s3, 1
    s_cbranch_scc1 cp_3_ok
    s_waitcnt lgkmcnt(0)
    s_xor_b64 s[24:25], s[24:25], s[98:99]
    s_xor_b64 s[26:27], s[26:27], s[98:99]
    s_xor_b64 s[28:29], s[28:29], s[98:99]
    s_xor_b64 s[30:31], s[30:31], s[98:99]
    s_or_b64 s[24:25], s[24:25], s[26:27]
    s_or_b64 s[28:29], s[28:29], s[30:31]
    s_or_b64 s[24:25], s[24:25], s[28:29]
    s_cbranch_scc1 cp_3
cp_3_ok:
    s_waitcnt lgkmcnt(0)
    s_barrier
    buffer_load_dwordx4 v[112:115], v5, s[16:19], s50 offen offset:0 sc1
    buffer_load_dwordx4 v[116:119], v5, s[16:19], s50 offen offset:1024 sc1
    buffer_load_dwordx4 v[120:123], v5, s[16:19], s50 offen offset:2048 sc1
    buffer_load_dwordx4 v[124:127], v5, s[16:19], s50 offen offset:3072 sc1
    ds_read_b64_tr_b16 v[64:65], v12 offset:0
    ds_read_b64_tr_b16 v[66:67], v12 offset:1024
    ds_read_b64_tr_b16 v[68:69], v13 offset:64
    ds_read_b64_tr_b16 v[70:71], v13 offset:1088
    ds_read_b64_tr_b16 v[72:73], v12 offset:2048
    ds_read_b64_tr_b16 v[74:75], v12 offset:3072
    ds_read_b64_tr_b16 v[76:77], v13 offset:2112
    ds_read_b64_tr_b16 v[78:79], v13 offset:3136
    ds_read_b64_tr_b16 v[80:81], v12 offset:4096
    ds_read_b64_tr_b16 v[82:83], v12 offset:5120
    ds_read_b64_tr_b16 v[84:85], v13 offset:4160
    ds_read_b64_tr_b16 v[86:87], v13 offset:5184
    buffer_load_dwordx4 v[128:131], v5, s[16:19], s51 offen offset:0 sc1
    buffer_load_dwordx4 v[132:135], v5, s[16:19], s51 offen offset:1024 sc1
    buffer_load_dwordx4 v[136:139], v5, s[16:19], s51 offen offset:2048 sc1
    buffer_load_dwordx4 v[140:143], v5, s[16:19], s51 offen offset:3072 sc1
    buffer_load_dwordx4 v[144:147], v5, s[16:19], s52 offen offset:0 sc1
    buffer_load_dwordx4 v[148:151], v5, s[16:19], s52 offen offset:1024 sc1
    buffer_load_dwordx4 v[152:155], v5, s[16:19], s52 offen offset:2048 sc1
    buffer_load_dwordx4 v[156:159], v5, s[16:19], s52 offen offset:3072 sc1
    buffer_load_dwordx4 v[160:163], v5, s[16:19], s53 offen offset:0 sc1
    buffer_load_dwordx4 v[164:167], v5, s[16:19], s53 offen offset:1024 sc1
    buffer_load_dwordx4 v[168:171], v5, s[16:19], s53 offen offset:2048 sc1
    s_add_u32 s50, s50, 15360
    s_add_u32 s51, s51, 15360
    s_add_u32 s52, s52, 15360
    s_add_u32 s53, s53, 15360
.p2align 3
c_wo_loop:
    s_waitcnt vmcnt(14) lgkmcnt(8)
    v_mfma_f32_32x32x16_bf16 v[32:47], v[64:67], v[112:115], v[32:47]
    ds_read_b64_tr_b16 v[88:89], v12 offset:6144
    ds_read_b64_tr_b16 v[90:91], v12 offset:7168
    buffer_load_dwordx4 v[172:175], v5, s[16:19], s50 offen offset:0 sc1
    v_mfma_f32_32x32x16_bf16 v[48:63], v[68:71], v[112:115], v[48:63]
    ds_read_b64_tr_b16 v[92:93], v13 offset:6208
    ds_read_b64_tr_b16 v[94:95], v13 offset:7232
    s_waitcnt vmcnt(14) lgkmcnt(8)
    v_mfma_f32_32x32x16_bf16 v[32:47], v[72:75], v[116:119], v[32:47]
    ds_read_b64_tr_b16 v[64:65], v12 offset:8192
    ds_read_b64_tr_b16 v[66:67], v12 offset:9216
    buffer_load_dwordx4 v[112:115], v5, s[16:19], s50 offen offset:1024 sc1
    v_mfma_f32_32x32x16_bf16 v[48:63], v[76:79], v[116:119], v[48:63]
    ds_read_b64_tr_b16 v[68:69], v13 offset:8256
    ds_read_b64_tr_b16 v[70:71], v13 offset:9280
    s_waitcnt vmcnt(14) lgkmcnt(8)
    v_mfma_f32_32x32x16_bf16 v[32:47], v[80:83], v[120:123], v[32:47]
    ds_read_b64_tr_b16 v[72:73], v12 offset:10240
    ds_read_b64_tr_b16 v[74:75], v12 offset:11264
    buffer_load_dwordx4 v[116:119], v5, s[16:19], s50 offen offset:2048 sc1
    v_mfma_f32_32x32x16_bf16 v[48:63], v[84:87], v[120:123], v[48:63]
    ds_read_b64_tr_b16 v[76:77], v13 offset:10304
    ds_read_b64_tr_b16 v[78:79], v13 offset:11328
    s_waitcnt vmcnt(14) lgkmcnt(8)
    v_mfma_f32_32x32x16_bf16 v[32:47], v[88:91], v[124:127], v[32:47]
    ds_read_b64_tr_b16 v[80:81], v12 offset:12288
    ds_read_b64_tr_b16 v[82:83], v12 offset:13312
    buffer_load_dwordx4 v[120:123], v5, s[16:19], s50 offen offset:3072 sc1
    v_mfma_f32_32x32x16_bf16 v[48:63], v[92:95], v[124:127], v[48:63]
    ds_read_b64_tr_b16 v[84:85], v13 offset:12352
    ds_read_b64_tr_b16 v[86:87], v13 offset:13376
    s_add_u32 s50, s50, 16384
    s_waitcnt vmcnt(14) lgkmcnt(8)
    v_mfma_f32_32x32x16_bf16 v[32:47], v[64:67], v[128:131], v[32:47]
    ds_read_b64_tr_b16 v[88:89], v12 offset:14336
    ds_read_b64_tr_b16 v[90:91], v12 offset:15360
    buffer_load_dwordx4 v[124:127], v5, s[16:19], s51 offen offset:0 sc1
    v_mfma_f32_32x32x16_bf16 v[48:63], v[68:71], v[128:131], v[48:63]
    ds_read_b64_tr_b16 v[92:93], v13 offset:14400
    ds_read_b64_tr_b16 v[94:95], v13 offset:15424
    s_waitcnt vmcnt(14) lgkmcnt(8)
    v_mfma_f32_32x32x16_bf16 v[32:47], v[72:75], v[132:135], v[32:47]
    ds_read_b64_tr_b16 v[64:65], v12 offset:16384
    ds_read_b64_tr_b16 v[66:67], v12 offset:17408
    buffer_load_dwordx4 v[128:131], v5, s[16:19], s51 offen offset:1024 sc1
    v_mfma_f32_32x32x16_bf16 v[48:63], v[76:79], v[132:135], v[48:63]
    ds_read_b64_tr_b16 v[68:69], v13 offset:16448
    ds_read_b64_tr_b16 v[70:71], v13 offset:17472
    s_waitcnt vmcnt(14) lgkmcnt(8)
    v_mfma_f32_32x32x16_bf16 v[32:47], v[80:83], v[136:139], v[32:47]
    ds_read_b64_tr_b16 v[72:73], v12 offset:18432
    ds_read_b64_tr_b16 v[74:75], v12 offset:19456
    buffer_load_dwordx4 v[132:135], v5, s[16:19], s51 offen offset:2048 sc1
    v_mfma_f32_32x32x16_bf16 v[48:63], v[84:87], v[136:139], v[48:63]
    ds_read_b64_tr_b16 v[76:77], v13 offset:18496
    ds_read_b64_tr_b16 v[78:79], v13 offset:19520
    s_waitcnt vmcnt(14) lgkmcnt(8)
    v_mfma_f32_32x32x16_bf16 v[32:47], v[88:91], v[140:143], v[32:47]
    ds_read_b64_tr_b16 v[80:81], v12 offset:20480
    ds_read_b64_tr_b16 v[82:83], v12 offset:21504
    buffer_load_dwordx4 v[136:139], v5, s[16:19], s51 offen offset:3072 sc1
    v_mfma_f32_32x32x16_bf16 v[48:63], v[92:95], v[140:143], v[48:63]
    ds_read_b64_tr_b16 v[84:85], v13 offset:20544
    ds_read_b64_tr_b16 v[86:87], v13 offset:21568
    s_add_u32 s51, s51, 16384
    s_waitcnt vmcnt(14) lgkmcnt(8)
    v_mfma_f32_32x32x16_bf16 v[32:47], v[64:67], v[144:147], v[32:47]
    ds_read_b64_tr_b16 v[88:89], v12 offset:22528
    ds_read_b64_tr_b16 v[90:91], v12 offset:23552
    buffer_load_dwordx4 v[140:143], v5, s[16:19], s52 offen offset:0 sc1
    v_mfma_f32_32x32x16_bf16 v[48:63], v[68:71], v[144:147], v[48:63]
    ds_read_b64_tr_b16 v[92:93], v13 offset:22592
    ds_read_b64_tr_b16 v[94:95], v13 offset:23616
    s_waitcnt vmcnt(14) lgkmcnt(8)
    v_mfma_f32_32x32x16_bf16 v[32:47], v[72:75], v[148:151], v[32:47]
    ds_read_b64_tr_b16 v[64:65], v12 offset:24576
    ds_read_b64_tr_b16 v[66:67], v12 offset:25600
    buffer_load_dwordx4 v[144:147], v5, s[16:19], s52 offen offset:1024 sc1
    v_mfma_f32_32x32x16_bf16 v[48:63], v[76:79], v[148:151], v[48:63]
    ds_read_b64_tr_b16 v[68:69], v13 offset:24640
    ds_read_b64_tr_b16 v[70:71], v13 offset:25664
    s_waitcnt vmcnt(14) lgkmcnt(8)
    v_mfma_f32_32x32x16_bf16 v[32:47], v[80:83], v[152:155], v[32:47]
    ds_read_b64_tr_b16 v[72:73], v12 offset:26624
    ds_read_b64_tr_b16 v[74:75], v12 offset:27648
    buffer_load_dwordx4 v[148:151], v5, s[16:19], s52 offen offset:2048 sc1
    v_mfma_f32_32x32x16_bf16 v[48:63], v[84:87], v[152:155], v[48:63]
    ds_read_b64_tr_b16 v[76:77], v13 offset:26688
    ds_read_b64_tr_b16 v[78:79], v13 offset:27712
    s_waitcnt vmcnt(14) lgkmcnt(8)
    v_mfma_f32_32x32x16_bf16 v[32:47], v[88:91], v[156:159], v[32:47]
    ds_read_b64_tr_b16 v[80:81], v12 offset:28672
    ds_read_b64_tr_b16 v[82:83], v12 offset:29696
    buffer_load_dwordx4 v[152:155], v5, s[16:19], s52 offen offset:3072 sc1
    v_mfma_f32_32x32x16_bf16 v[48:63], v[92:95], v[156:159], v[48:63]
    ds_read_b64_tr_b16 v[84:85], v13 offset:28736
    ds_read_b64_tr_b16 v[86:87], v13 offset:29760
    s_add_u32 s52, s52, 16384
    s_waitcnt vmcnt(14) lgkmcnt(8)
    v_mfma_f32_32x32x16_bf16 v[32:47], v[64:67], v[160:163], v[32:47]
    ds_read_b64_tr_b16 v[88:89], v12 offset:30720
    ds_read_b64_tr_b16 v[90:91], v12 offset:31744
    buffer_load_dwordx4 v[156:159], v5, s[16:19], s53 offen offset:0 sc1
    v_mfma_f32_32x32x16_bf16 v[48:63], v[68:71], v[160:163], v[48:63]
    ds_read_b64_tr_b16 v[92:93], v13 offset:30784
    ds_read_b64_tr_b16 v[94:95], v13 offset:31808
    s_waitcnt vmcnt(14) lgkmcnt(8)
    v_mfma_f32_32x32x16_bf16 v[32:47], v[72:75], v[164:167], v[32:47]
    ds_read_b64_tr_b16 v[64:65], v12 offset:32768
    ds_read_b64_tr_b16 v[66:67], v12 offset:33792
    buffer_load_dwordx4 v[160:163], v5, s[16:19], s53 offen offset:1024 sc1
    v_mfma_f32_32x32x16_bf16 v[48:63], v[76:79], v[164:167], v[48:63]
    ds_read_b64_tr_b16 v[68:69], v13 offset:32832
    ds_read_b64_tr_b16 v[70:71], v13 offset:33856
    s_waitcnt vmcnt(14) lgkmcnt(8)
    v_mfma_f32_32x32x16_bf16 v[32:47], v[80:83], v[168:171], v[32:47]
    ds_read_b64_tr_b16 v[72:73], v12 offset:34816
    ds_read_b64_tr_b16 v[74:75], v12 offset:35840
    buffer_load_dwordx4 v[164:167], v5, s[16:19], s53 offen offset:2048 sc1
    v_mfma_f32_32x32x16_bf16 v[48:63], v[84:87], v[168:171], v[48:63]
    ds_read_b64_tr_b16 v[76:77], v13 offset:34880
    ds_read_b64_tr_b16 v[78:79], v13 offset:35904
    s_waitcnt vmcnt(14) lgkmcnt(8)
    v_mfma_f32_32x32x16_bf16 v[32:47], v[88:91], v[172:175], v[32:47]
    ds_read_b64_tr_b16 v[80:81], v12 offset:36864
    ds_read_b64_tr_b16 v[82:83], v12 offset:37888
    buffer_load_dwordx4 v[168:171], v5, s[16:19], s53 offen offset:3072 sc1
    v_add_u32 v12, 32768, v12
    v_mfma_f32_32x32x16_bf16 v[48:63], v[92:95], v[172:175], v[48:63]
    ds_read_b64_tr_b16 v[84:85], v13 offset:36928
    ds_read_b64_tr_b16 v[86:87], v13 offset:37952
    v_add_u32 v13, 32768, v13
    s_add_u32 s53, s53, 16384
    s_sub_u32 s54, s54, 1
    s_cmp_lg_u32 s54, 0
    s_cbranch_scc1 c_wo_loop
    s_waitcnt vmcnt(14) lgkmcnt(8)
    v_mfma_f32_32x32x16_bf16 v[32:47], v[64:67], v[112:115], v[32:47]
    ds_read_b64_tr_b16 v[88:89], v12 offset:6144
    ds_read_b64_tr_b16 v[90:91], v12 offset:7168
    buffer_load_dwordx4 v[172:175], v5, s[16:19], s50 offen offset:0 sc1
    v_mfma_f32_32x32x16_bf16 v[48:63], v[68:71], v[112:115], v[48:63]
    ds_read_b64_tr_b16 v[92:93], v13 offset:6208
    ds_read_b64_tr_b16 v[94:95], v13 offset:7232
    s_waitcnt vmcnt(14) lgkmcnt(8)
    v_mfma_f32_32x32x16_bf16 v[32:47], v[72:75], v[116:119], v[32:47]
    ds_read_b64_tr_b16 v[64:65], v12 offset:8192
    ds_read_b64_tr_b16 v[66:67], v12 offset:9216
    v_mfma_f32_32x32x16_bf16 v[48:63], v[76:79], v[116:119], v[48:63]
    ds_read_b64_tr_b16 v[68:69], v13 offset:8256
    ds_read_b64_tr_b16 v[70:71], v13 offset:9280
    s_waitcnt vmcnt(13) lgkmcnt(8)
    v_mfma_f32_32x32x16_bf16 v[32:47], v[80:83], v[120:123], v[32:47]
    ds_read_b64_tr_b16 v[72:73], v12 offset:10240
    ds_read_b64_tr_b16 v[74:75], v12 offset:11264
    v_mfma_f32_32x32x16_bf16 v[48:63], v[84:87], v[120:123], v[48:63]
    ds_read_b64_tr_b16 v[76:77], v13 offset:10304
    ds_read_b64_tr_b16 v[78:79], v13 offset:11328
    s_waitcnt vmcnt(12) lgkmcnt(8)
    v_mfma_f32_32x32x16_bf16 v[32:47], v[88:91], v[124:127], v[32:47]
    ds_read_b64_tr_b16 v[80:81], v12 offset:12288
    ds_read_b64_tr_b16 v[82:83], v12 offset:13312
    v_mfma_f32_32x32x16_bf16 v[48:63], v[92:95], v[124:127], v[48:63]
    ds_read_b64_tr_b16 v[84:85], v13 offset:12352
    ds_read_b64_tr_b16 v[86:87], v13 offset:13376
    s_waitcnt vmcnt(11) lgkmcnt(8)
    v_mfma_f32_32x32x16_bf16 v[32:47], v[64:67], v[128:131], v[32:47]
    ds_read_b64_tr_b16 v[88:89], v12 offset:14336
    ds_read_b64_tr_b16 v[90:91], v12 offset:15360
    v_mfma_f32_32x32x16_bf16 v[48:63], v[68:71], v[128:131], v[48:63]
    ds_read_b64_tr_b16 v[92:93], v13 offset:14400
    ds_read_b64_tr_b16 v[94:95], v13 offset:15424
    s_waitcnt vmcnt(10) lgkmcnt(8)
    v_mfma_f32_32x32x16_bf16 v[32:47], v[72:75], v[132:135], v[32:47]
    ds_read_b64_tr_b16 v[64:65], v12 offset:16384
    ds_read_b64_tr_b16 v[66:67], v12 offset:17408
    v_mfma_f32_32x32x16_bf16 v[48:63], v[76:79], v[132:135], v[48:63]
    ds_read_b64_tr_b16 v[68:69], v13 offset:16448
    ds_read_b64_tr_b16 v[70:71], v13 offset:17472
    s_waitcnt vmcnt(9) lgkmcnt(8)
    v_mfma_f32_32x32x16_bf16 v[32:47], v[80:83], v[136:139], v[32:47]
    ds_read_b64_tr_b16 v[72:73], v12 offset:18432
    ds_read_b64_tr_b16 v[74:75], v12 offset:19456
    v_mfma_f32_32x32x16_bf16 v[48:63], v[84:87], v[136:139], v[48:63]
    ds_read_b64_tr_b16 v[76:77], v13 offset:18496
    ds_read_b64_tr_b16 v[78:79], v13 offset:19520
    s_waitcnt vmcnt(8) lgkmcnt(8)
    v_mfma_f32_32x32x16_bf16 v[32:47], v[88:91], v[140:143], v[32:47]
    ds_read_b64_tr_b16 v[80:81], v12 offset:20480
    ds_read_b64_tr_b16 v[82:83], v12 offset:21504
    v_mfma_f32_32x32x16_bf16 v[48:63], v[92:95], v[140:143], v[48:63]
    ds_read_b64_tr_b16 v[84:85], v13 offset:20544
    ds_read_b64_tr_b16 v[86:87], v13 offset:21568
    s_waitcnt vmcnt(7) lgkmcnt(8)
    v_mfma_f32_32x32x16_bf16 v[32:47], v[64:67], v[144:147], v[32:47]
    ds_read_b64_tr_b16 v[88:89], v12 offset:22528
    ds_read_b64_tr_b16 v[90:91], v12 offset:23552
    v_mfma_f32_32x32x16_bf16 v[48:63], v[68:71], v[144:147], v[48:63]
    ds_read_b64_tr_b16 v[92:93], v13 offset:22592
    ds_read_b64_tr_b16 v[94:95], v13 offset:23616
    s_waitcnt vmcnt(6) lgkmcnt(8)
    v_mfma_f32_32x32x16_bf16 v[32:47], v[72:75], v[148:151], v[32:47]
    ds_read_b64_tr_b16 v[64:65], v12 offset:24576
    ds_read_b64_tr_b16 v[66:67], v12 offset:25600
    v_mfma_f32_32x32x16_bf16 v[48:63], v[76:79], v[148:151], v[48:63]
    ds_read_b64_tr_b16 v[68:69], v13 offset:24640
    ds_read_b64_tr_b16 v[70:71], v13 offset:25664
    s_waitcnt vmcnt(5) lgkmcnt(8)
    v_mfma_f32_32x32x16_bf16 v[32:47], v[80:83], v[152:155], v[32:47]
    ds_read_b64_tr_b16 v[72:73], v12 offset:26624
    ds_read_b64_tr_b16 v[74:75], v12 offset:27648
    v_mfma_f32_32x32x16_bf16 v[48:63], v[84:87], v[152:155], v[48:63]
    ds_read_b64_tr_b16 v[76:77], v13 offset:26688
    ds_read_b64_tr_b16 v[78:79], v13 offset:27712
    s_waitcnt vmcnt(4) lgkmcnt(8)
    v_mfma_f32_32x32x16_bf16 v[32:47], v[88:91], v[156:159], v[32:47]
    ds_read_b64_tr_b16 v[80:81], v12 offset:28672
    ds_read_b64_tr_b16 v[82:83], v12 offset:29696
    v_mfma_f32_32x32x16_bf16 v[48:63], v[92:95], v[156:159], v[48:63]
    ds_read_b64_tr_b16 v[84:85], v13 offset:28736
    ds_read_b64_tr_b16 v[86:87], v13 offset:29760
    s_waitcnt vmcnt(3) lgkmcnt(8)
    v_mfma_f32_32x32x16_bf16 v[32:47], v[64:67], v[160:163], v[32:47]
    ds_read_b64_tr_b16 v[88:89], v12 offset:30720
    ds_read_b64_tr_b16 v[90:91], v12 offset:31744
    v_mfma_f32_32x32x16_bf16 v[48:63], v[68:71], v[160:163], v[48:63]
    ds_read_b64_tr_b16 v[92:93], v13 offset:30784
    ds_read_b64_tr_b16 v[94:95], v13 offset:31808
    s_waitcnt vmcnt(2) lgkmcnt(8)
    v_mfma_f32_32x32x16_bf16 v[32:47], v[72:75], v[164:167], v[32:47]
    v_mfma_f32_32x32x16_bf16 v[48:63], v[76:79], v[164:167], v[48:63]
    s_waitcnt vmcnt(1) lgkmcnt(4)
    v_mfma_f32_32x32x16_bf16 v[32:47], v[80:83], v[168:171], v[32:47]
    v_mfma_f32_32x32x16_bf16 v[48:63], v[84:87], v[168:171], v[48:63]
    s_waitcnt vmcnt(0) lgkmcnt(0)
    v_mfma_f32_32x32x16_bf16 v[32:47], v[88:91], v[172:175], v[32:47]
    v_mfma_f32_32x32x16_bf16 v[48:63], v[92:95], v[172:175], v[48:63]
    s_cmp_eq_u32 s9, 3
    s_nop 7
    s_cbranch_scc1 c_wo_fin
    s_add_u32 s58, s58, 4194304
    s_nop 7
    v_cvt_pk_bf16_f32 v96, v32, v33
    v_cvt_pk_bf16_f32 v97, v34, v35
    v_cvt_pk_bf16_f32 v98, v36, v37
    v_cvt_pk_bf16_f32 v99, v38, v39
    buffer_store_dwordx4 v[96:99], v5, s[12:15], s58 offen offset:0 sc1
    v_cvt_pk_bf16_f32 v100, v40, v41
    v_cvt_pk_bf16_f32 v101, v42, v43
    v_cvt_pk_bf16_f32 v102, v44, v45
    v_cvt_pk_bf16_f32 v103, v46, v47
    buffer_store_dwordx4 v[100:103], v5, s[12:15], s58 offen offset:1024 sc1
    v_cvt_pk_bf16_f32 v104, v48, v49
    v_cvt_pk_bf16_f32 v105, v50, v51
    v_cvt_pk_bf16_f32 v106, v52, v53
    v_cvt_pk_bf16_f32 v107, v54, v55
    buffer_store_dwordx4 v[104:107], v5, s[12:15], s58 offen offset:2048 sc1
    v_cvt_pk_bf16_f32 v108, v56, v57
    v_cvt_pk_bf16_f32 v109, v58, v59
    v_cvt_pk_bf16_f32 v110, v60, v61
    v_cvt_pk_bf16_f32 v111, v62, v63
    buffer_store_dwordx4 v[108:111], v5, s[12:15], s58 offen offset:3072 sc1
    s_barrier
c_wo_stat:
    v_mov_b32 v22, 0x3f803f80
    v_mov_b32 v18, 0
    v_mov_b32 v19, 0
    v_dot2_f32_bf16 v18, v96, v22, v18
    v_dot2_f32_bf16 v19, v96, v96, v19
    v_dot2_f32_bf16 v18, v97, v22, v18
    v_dot2_f32_bf16 v19, v97, v97, v19
    v_dot2_f32_bf16 v18, v98, v22, v18
    v_dot2_f32_bf16 v19, v98, v98, v19
    v_dot2_f32_bf16 v18, v99, v22, v18
    v_dot2_f32_bf16 v19, v99, v99, v19
    v_dot2_f32_bf16 v18, v100, v22, v18
    v_dot2_f32_bf16 v19, v100, v100, v19
    v_dot2_f32_bf16 v18, v101, v22, v18
    v_dot2_f32_bf16 v19, v101, v101, v19
    v_dot2_f32_bf16 v18, v102, v22, v18
    v_dot2_f32_bf16 v19, v102, v102, v19
    v_dot2_f32_bf16 v18, v103, v22, v18
    v_dot2_f32_bf16 v19, v103, v103, v19
    v_dot2_f32_bf16 v18, v104, v22, v18
    v_dot2_f32_bf16 v19, v104, v104, v19
    v_dot2_f32_bf16 v18, v105, v22, v18
    v_dot2_f32_bf16 v19, v105, v105, v19
    v_dot2_f32_bf16 v18, v106, v22, v18
    v_dot2_f32_bf16 v19, v106, v106, v19
    v_dot2_f32_bf16 v18, v107, v22, v18
    v_dot2_f32_bf16 v19, v107, v107, v19
    v_dot2_f32_bf16 v18, v108, v22, v18
    v_dot2_f32_bf16 v19, v108, v108, v19
    v_dot2_f32_bf16 v18, v109, v22, v18
    v_dot2_f32_bf16 v19, v109, v109, v19
    v_dot2_f32_bf16 v18, v110, v22, v18
    v_dot2_f32_bf16 v19, v110, v110, v19
    v_dot2_f32_bf16 v18, v111, v22, v18
    v_dot2_f32_bf16 v19, v111, v111, v19
    v_lshlrev_b32 v16, 3, v1
    s_lshl_b32 s3, s48, 12
    s_lshl_b32 s55, s7, 8
    v_mov_b32 v20, v18
    v_mov_b32 v21, v19
    s_add_u32 s3, s3, s55
    s_lshl_b32 s55, s9, 18
    v_permlane32_swap_b32 v18, v20
    v_permlane32_swap_b32 v19, v21
    s_add_u32 s3, s3, s55
    s_add_u32 s3, s3, 63176704
    v_pk_add_f32 v[18:19], v[18:19], v[20:21]
    s_mov_b32 exec_hi, 0
    buffer_store_dwordx2 v[18:19], v16, s[12:15], s3 offen sc1
    s_mov_b64 exec, -1
    s_cmp_lg_u32 s9, -1
    s_cbranch_scc1 c_wo_pub
    s_barrier
    v_mov_b32 v24, 159492
non_4:
    ds_read_b32 v25, v24
    s_waitcnt lgkmcnt(0)
    v_readfirstlane_b32 s10, v25
    s_cmp_eq_u32 s10, 0
    s_cbranch_scc1 non_4
c_wo_pub:
    s_mul_i32 s55, s9, 786432
    s_add_u32 s55, s55, 66060288
    v_and_b32 v24, 63, v0
    s_and_b32 s56, s11, 0xe0
    v_lshrrev_b32 v25, 5, v24
    v_add_u32 v24, s56, v24
    v_and_b32 v24, 255, v24
    v_lshlrev_b32 v24, 10, v24
    v_lshl_add_u32 v24, v25, 8, v24
    s_bfe_u32 s56, s11, 0x20003
    s_and_b32 s57, s11, 7
    s_lshl_b32 s56, s56, 7
    s_lshl_b32 s57, s57, 2
    s_add_u32 s55, s55, s56
    s_add_u32 s55, s55, s57
    s_and_b32 s57, s6, s9
    s_bfe_i32 s57, s57, 0x10000
    v_mov_b32 v25, 159488
    v_mov_b32 v26, 1
    v_mov_b32 v27, s10
    s_mov_b64 exec, 1
    s_waitcnt vmcnt(0)
    ds_add_rtn_u32 v26, v25, v26
    s_waitcnt lgkmcnt(0)
    v_readfirstlane_b32 s56, v26
    s_and_b32 s56, s56, 3
    s_cmp_lg_u32 s56, 3
    s_cbranch_scc1 pub_5
    s_mov_b32 exec_lo, -1
    s_mov_b32 exec_hi, s57
    buffer_store_dword v27, v24, s[12:15], s55 offen sc1
pub_5:
    s_mov_b64 exec, -1
    s_add_u32 s9, s9, 1
    s_bitcmp1_b32 s9, 0
    s_cbranch_scc1 c_qkvB
    s_branch c_qkvA
c_wo_fin:
    s_barrier
    v_cvt_pk_bf16_f32 v96, v32, v33
    v_cvt_pk_bf16_f32 v97, v34, v35
    v_cvt_pk_bf16_f32 v98, v36, v37
    v_cvt_pk_bf16_f32 v99, v38, v39
    v_cvt_pk_bf16_f32 v100, v40, v41
    v_cvt_pk_bf16_f32 v101, v42, v43
    v_cvt_pk_bf16_f32 v102, v44, v45
    v_cvt_pk_bf16_f32 v103, v46, v47
    v_cvt_pk_bf16_f32 v104, v48, v49
    v_cvt_pk_bf16_f32 v105, v50, v51
    v_cvt_pk_bf16_f32 v106, v52, v53
    v_cvt_pk_bf16_f32 v107, v54, v55
    v_cvt_pk_bf16_f32 v108, v56, v57
    v_cvt_pk_bf16_f32 v109, v58, v59
    v_cvt_pk_bf16_f32 v110, v60, v61
    v_cvt_pk_bf16_f32 v111, v62, v63
    s_mov_b32 s28, s44
    s_mov_b32 s29, s45
    s_mov_b32 s30, 4194304
    s_mov_b32 s31, 0x00020000
    v_and_b32 v16, 31, v1
    v_mul_u32_u24 v16, 144, v16
    v_lshl_add_u32 v16, v3, 3, v16
    v_mul_u32_u24 v17, 4608, v2
    v_add_u32 v16, v16, v17
    ds_write_b64 v16, v[96:97] offset:0
    ds_write_b64 v16, v[98:99] offset:16
    ds_write_b64 v16, v[100:101] offset:32
    ds_write_b64 v16, v[102:103] offset:48
    ds_write_b64 v16, v[104:105] offset:64
    ds_write_b64 v16, v[106:107] offset:80
    ds_write_b64 v16, v[108:109] offset:96
    ds_write_b64 v16, v[110:111] offset:112
    v_lshrrev_b32 v18, 3, v1
    v_and_b32 v19, 7, v1
    v_mul_u32_u24 v20, 144, v18
    v_lshl_add_u32 v20, v19, 4, v20
    v_add_u32 v20, v20, v17
    v_lshlrev_b32 v21, 11, v18
    v_lshl_add_u32 v21, v19, 4, v21
    s_lshl_b32 s3, s48, 16
    s_lshl_b32 s55, s7, 7
    s_add_u32 s3, s3, s55
    s_waitcnt lgkmcnt(0)
    ds_read_b128 v[32:35], v20 offset:0
    ds_read_b128 v[36:39], v20 offset:1152
    ds_read_b128 v[40:43], v20 offset:2304
    ds_read_b128 v[44:47], v20 offset:3456
    s_waitcnt lgkmcnt(3)
    buffer_store_dwordx4 v[32:35], v21, s[28:31], s3 offen sc1
    s_add_u32 s3, s3, 16384
    s_waitcnt lgkmcnt(2)
    buffer_store_dwordx4 v[36:39], v21, s[28:31], s3 offen sc1
    s_add_u32 s3, s3, 16384
    s_waitcnt lgkmcnt(1)
    buffer_store_dwordx4 v[40:43], v21, s[28:31], s3 offen sc1
    s_add_u32 s3, s3, 16384
    s_waitcnt lgkmcnt(0)
    buffer_store_dwordx4 v[44:47], v21, s[28:31], s3 offen sc1
    s_add_u32 s3, s3, 16384
    s_branch k_exit
c_prep:
    s_mov_b32 s28, s32
    s_mov_b32 s29, s33
    s_mov_b32 s30, 4194304
    s_mov_b32 s31, 0x00020000
    s_lshl_b32 s48, s6, 2
    s_add_u32 s48, s48, s8
    v_lshrrev_b32 v16, 3, v1
    v_and_b32 v17, 7, v1
    v_lshlrev_b32 v18, 11, v16
    v_lshl_add_u32 v18, v17, 4, v18
    s_lshl_b32 s55, s48, 16
    s_lshl_b32 s56, s7, 7
    s_add_u32 s3, s55, s56
    buffer_load_dwordx4 v[32:35], v18, s[28:31], s3 offen nt
    s_add_u32 s3, s3, 16384
    buffer_load_dwordx4 v[36:39], v18, s[28:31], s3 offen nt
    s_add_u32 s3, s3, 16384
    buffer_load_dwordx4 v[40:43], v18, s[28:31], s3 offen nt
    s_add_u32 s3, s3, 16384
    buffer_load_dwordx4 v[44:47], v18, s[28:31], s3 offen nt
    s_add_u32 s3, s3, 16384
    s_barrier
    s_lshl_b32 s56, s7, 12
    s_add_u32 s58, s55, s56
    v_lshlrev_b32 v5, 4, v1
    s_lshl_b32 s3, s8, 12
    s_add_u32 s3, s3, 131072
    v_lshrrev_b32 v18, 1, v17
    v_lshlrev_b32 v18, 10, v18
    v_lshl_add_u32 v18, v16, 4, v18
    v_and_b32 v17, 1, v17
    v_lshl_add_u32 v18, v17, 3, v18
    v_add_u32 v18, s3, v18
    v_add_u32 v19, s3, v5
    s_waitcnt vmcnt(3)
    ds_write_b64 v18, v[32:33] offset:0
    ds_write_b64 v18, v[34:35] offset:512
    s_waitcnt vmcnt(2)
    ds_write_b64 v18, v[36:37] offset:128
    ds_write_b64 v18, v[38:39] offset:640
    s_waitcnt vmcnt(1)
    ds_write_b64 v18, v[40:41] offset:256
    ds_write_b64 v18, v[42:43] offset:768
    s_waitcnt vmcnt(0)
    ds_write_b64 v18, v[44:45] offset:384
    ds_write_b64 v18, v[46:47] offset:896
    s_waitcnt lgkmcnt(0)
    ds_read_b128 v[96:99], v19 offset:0
    ds_read_b128 v[100:103], v19 offset:1024
    ds_read_b128 v[104:107], v19 offset:2048
    ds_read_b128 v[108:111], v19 offset:3072
    s_waitcnt lgkmcnt(3)
    buffer_store_dwordx4 v[96:99], v5, s[12:15], s58 offen offset:0 sc1
    s_waitcnt lgkmcnt(2)
    buffer_store_dwordx4 v[100:103], v5, s[12:15], s58 offen offset:1024 sc1
    s_waitcnt lgkmcnt(1)
    buffer_store_dwordx4 v[104:107], v5, s[12:15], s58 offen offset:2048 sc1
    s_waitcnt lgkmcnt(0)
    buffer_store_dwordx4 v[108:111], v5, s[12:15], s58 offen offset:3072 sc1
    s_branch c_wo_stat
.p2align 6
c_qkvB:
    v_and_b32 v1, 63, v0
    v_lshrrev_b32 v2, 6, v0
    v_lshlrev_b32 v5, 4, v1
    v_lshrrev_b32 v3, 5, v1
    v_and_b32 v4, 15, v0
    v_bfe_u32 v7, v1, 4, 1
    v_lshl_add_u32 v6, v7, 5, v4
    v_lshlrev_b32 v6, 4, v6
    v_lshl_add_u32 v6, v3, 10, v6
    s_lshr_b32 s48, s6, 1
    s_lshl_b32 s48, s48, 2
    s_add_u32 s48, s48, s8
    s_lshl_b32 s55, s48, 17
    s_lshl_b32 s56, s9, 22
    s_add_u32 s55, s55, s56
    s_add_u32 s16, s4, s55
    s_addc_u32 s17, s5, 0
    s_mov_b32 s18, 65536
    s_mov_b32 s19, 0x00020000
    s_add_u32 s56, s55, 65536
    s_add_u32 s20, s4, s56
    s_addc_u32 s21, s5, 0
    s_mov_b32 s22, 65536
    s_mov_b32 s23, 0x00020000
    s_lshl_b32 s49, s7, 12
    s_add_u32 s49, s49, s55
    s_and_b32 s56, s6, 1
    s_lshl_b32 s56, s56, 11
    s_add_u32 s49, s49, s56
    s_add_u32 s49, s49, 16777216
    s_movk_i32 s54, 4096
    v_lshrrev_b32 v16, 2, v4
    v_lshl_add_u32 v18, v7, 2, v16
    v_lshl_add_u32 v18, v3, 4, v18
    v_lshlrev_b32 v18, 6, v18
    v_and_b32 v17, 3, v4
    v_lshl_add_u32 v18, v17, 3, v18
    v_lshl_add_u32 v26, v7, 5, v18
    v_xor_b32 v27, 32, v26
    v_mov_b32 v24, v26
    v_mov_b32 v25, v27
    v_and_b32 v18, 0x30, v1
    v_add_u32 v10, 155648, v18
    v_lshlrev_b32 v11, 2, v4
    v_add_u32 v11, 155648, v11
    v_lshl_add_u32 v8, v2, 8, v11
    v_lshl_add_u32 v9, v2, 8, v10
    s_lshr_b32 s3, s8, 1
    s_and_b32 s55, s8, 1
    s_lshl_b32 s3, s3, 14
    s_lshl_b32 s55, s55, 12
    s_add_u32 s3, s3, s55
    s_add_u32 s3, s3, 81920
    v_lshl_add_u32 v12, v3, 5, v4
    v_lshlrev_b32 v12, 4, v12
    v_lshl_add_u32 v12, v7, 10, v12
    v_add_u32 v12, s3, v12
    v_add_u32 v13, s3, v5
    v_mov_b32 v32, 0
    v_mov_b32 v33, 0
    v_mov_b32 v34, 0
    v_mov_b32 v35, 0
    v_mov_b32 v36, 0
    v_mov_b32 v37, 0
    v_mov_b32 v38, 0
    v_mov_b32 v39, 0
    v_mov_b32 v40, 0
    v_mov_b32 v41, 0
    v_mov_b32 v42, 0
    v_mov_b32 v43, 0
    v_mov_b32 v44, 0
    v_mov_b32 v45, 0
    v_mov_b32 v46, 0
    v_mov_b32 v47, 0
    v_mov_b32 v48, 0
    v_mov_b32 v49, 0
    v_mov_b32 v50, 0
    v_mov_b32 v51, 0
    v_mov_b32 v52, 0
    v_mov_b32 v53, 0
    v_mov_b32 v54, 0
    v_mov_b32 v55, 0
    v_mov_b32 v56, 0
    v_mov_b32 v57, 0
    v_mov_b32 v58, 0
    v_mov_b32 v59, 0
    v_mov_b32 v60, 0
    v_mov_b32 v61, 0
    v_mov_b32 v62, 0
    v_mov_b32 v63, 0
    v_mov_b32 v64, 0
    v_mov_b32 v65, 0
    v_mov_b32 v66, 0
    v_mov_b32 v67, 0
    v_mov_b32 v68, 0
    v_mov_b32 v69, 0
    v_mov_b32 v70, 0
    v_mov_b32 v71, 0
    v_mov_b32 v72, 0
    v_mov_b32 v73, 0
    v_mov_b32 v74, 0
    v_mov_b32 v75, 0
    v_mov_b32 v76, 0
    v_mov_b32 v77, 0
    v_mov_b32 v78, 0
    v_mov_b32 v79, 0
    v_mov_b32 v80, 0
    v_mov_b32 v81, 0
    v_mov_b32 v82, 0
    v_mov_b32 v83, 0
    v_mov_b32 v84, 0
    v_mov_b32 v85, 0
    v_mov_b32 v86, 0
    v_mov_b32 v87, 0
    v_mov_b32 v88, 0
    v_mov_b32 v89, 0
    v_mov_b32 v90, 0
    v_mov_b32 v91, 0
    v_mov_b32 v92, 0
    v_mov_b32 v93, 0
    v_mov_b32 v94, 0
    v_mov_b32 v95, 0
    v_mov_b32 v96, 0
    v_mov_b32 v97, 0
    v_mov_b32 v98, 0
    v_mov_b32 v99, 0
    v_mov_b32 v100, 0
    v_mov_b32 v101, 0
    v_mov_b32 v102, 0
    v_mov_b32 v103, 0
    v_mov_b32 v104, 0
    v_mov_b32 v105, 0
    v_mov_b32 v106, 0
    v_mov_b32 v107, 0
    v_mov_b32 v108, 0
    v_mov_b32 v109, 0
    v_mov_b32 v110, 0
    v_mov_b32 v111, 0
    v_mov_b32 v112, 0
    v_mov_b32 v113, 0
    v_mov_b32 v114, 0
    v_mov_b32 v115, 0
    v_mov_b32 v116, 0
    v_mov_b32 v117, 0
    v_mov_b32 v118, 0
    v_mov_b32 v119, 0
    v_mov_b32 v120, 0
    v_mov_b32 v121, 0
    v_mov_b32 v122, 0
    v_mov_b32 v123, 0
    v_mov_b32 v124, 0
    v_mov_b32 v125, 0
    v_mov_b32 v126, 0
    v_mov_b32 v127, 0
    s_mov_b32 s50, 8192
    s_mov_b32 s58, 6144
    s_mov_b32 s51, 12288
    s_mov_b32 s59, 10240
    s_mov_b32 s52, 0
    s_mul_i32 s60, s9, 786432
    s_add_u32 s60, s60, 65273856
    s_lshl_b32 s61, s11, 10
    s_add_u32 s60, s60, s61
    s_lshl_b32 s61, s8, 7
    s_add_u32 s60, s60, s61
    s_mov_b32 s98, s10
    s_mov_b32 s99, s10
    s_mov_b32 s3, 0x20000
cp_6:
    s_load_dwordx8 s[24:31], s[4:5], s60 glc
    s_sub_u32 s3, s3, 1
    s_cbranch_scc1 cp_6_ok
    s_waitcnt lgkmcnt(0)
    s_xor_b64 s[24:25], s[24:25], s[98:99]
    s_xor_b64 s[26:27], s[26:27], s[98:99]
    s_xor_b64 s[28:29], s[28:29], s[98:99]
    s_xor_b64 s[30:31], s[30:31], s[98:99]
    s_or_b64 s[24:25], s[24:25], s[26:27]
    s_or_b64 s[28:29], s[28:29], s[30:31]
    s_or_b64 s[24:25], s[24:25], s[28:29]
    s_cbranch_scc1 cp_6
cp_6_ok:
    s_waitcnt lgkmcnt(0)
    s_barrier
    buffer_load_dwordx4 v[152:155], v6, s[16:19], 0 offen offset:0 sc1
    buffer_load_dwordx4 v[156:159], v6, s[16:19], 0 offen offset:256 sc1
    buffer_load_dwordx4 v[160:163], v6, s[20:23], 0 offen offset:0 sc1
    buffer_load_dwordx4 v[164:167], v6, s[20:23], 0 offen offset:256 sc1
    ds_read_b64_tr_b16 v[128:129], v24 offset:0
    ds_read_b64_tr_b16 v[130:131], v24 offset:512
    ds_read_b64_tr_b16 v[132:133], v25 offset:0
    ds_read_b64_tr_b16 v[134:135], v25 offset:512
    ds_read_b64_tr_b16 v[136:137], v24 offset:8192
    ds_read_b64_tr_b16 v[138:139], v24 offset:8704
    ds_read_b64_tr_b16 v[140:141], v25 offset:8192
    ds_read_b64_tr_b16 v[142:143], v25 offset:8704
    ds_read_b64_tr_b16 v[144:145], v24 offset:16384
    ds_read_b64_tr_b16 v[146:147], v24 offset:16896
    buffer_load_dwordx4 v[168:171], v6, s[16:19], 0 offen offset:2048 sc1
    buffer_load_dwordx4 v[172:175], v6, s[16:19], 0 offen offset:2304 sc1
    buffer_load_dwordx4 v[176:179], v6, s[20:23], 0 offen offset:2048 sc1
    buffer_load_dwordx4 v[180:183], v6, s[20:23], 0 offen offset:2304 sc1
    buffer_load_dwordx4 a[0:3], v6, s[16:19], s54 offen offset:0 sc1
    buffer_load_dwordx4 a[4:7], v6, s[16:19], s54 offen offset:256 sc1
    buffer_load_dwordx4 a[8:11], v6, s[20:23], s54 offen offset:0 sc1
    buffer_load_dwordx4 a[12:15], v6, s[20:23], s54 offen offset:256 sc1
    buffer_load_dwordx4 a[16:19], v6, s[16:19], s54 offen offset:2048 sc1
    buffer_load_dwordx4 a[20:23], v6, s[16:19], s54 offen offset:2304 sc1
    s_mov_b32 s54, 7
    s_waitcnt vmcnt(12)
    s_barrier
.p2align 3
c_qkvB_loop:
    s_waitcnt vmcnt(12) lgkmcnt(8)
    v_mfma_f32_16x16x32_bf16 v[32:35], v[128:131], v[152:155], v[32:35]
    ds_read_b64_tr_b16 v[148:149], v25 offset:16384
    buffer_load_dwordx4 a[24:27], v6, s[20:23], s58 offen offset:0 sc1
    v_mfma_f32_16x16x32_bf16 v[36:39], v[128:131], v[156:159], v[36:39]
    ds_read_b64_tr_b16 v[150:151], v25 offset:16896
    s_waitcnt lgkmcnt(8)
    v_mfma_f32_16x16x32_bf16 v[52:55], v[132:135], v[156:159], v[52:55]
    v_mfma_f32_16x16x32_bf16 v[48:51], v[132:135], v[152:155], v[48:51]
    s_waitcnt lgkmcnt(6)
    v_mfma_f32_16x16x32_bf16 v[64:67], v[136:139], v[152:155], v[64:67]
    v_mfma_f32_16x16x32_bf16 v[68:71], v[136:139], v[156:159], v[68:71]
    s_waitcnt lgkmcnt(4)
    v_mfma_f32_16x16x32_bf16 v[84:87], v[140:143], v[156:159], v[84:87]
    buffer_load_dwordx4 a[28:31], v6, s[20:23], s58 offen offset:256 sc1
    v_mfma_f32_16x16x32_bf16 v[80:83], v[140:143], v[152:155], v[80:83]
    s_waitcnt lgkmcnt(2)
    v_mfma_f32_16x16x32_bf16 v[96:99], v[152:155], v[144:147], v[96:99]
    v_mfma_f32_16x16x32_bf16 v[100:103], v[156:159], v[144:147], v[100:103]
    s_waitcnt lgkmcnt(0)
    v_mfma_f32_16x16x32_bf16 v[116:119], v[156:159], v[148:151], v[116:119]
    v_mfma_f32_16x16x32_bf16 v[112:115], v[152:155], v[148:151], v[112:115]
    s_waitcnt vmcnt(12)
    v_mfma_f32_16x16x32_bf16 v[40:43], v[128:131], v[160:163], v[40:43]
    buffer_load_dwordx4 v[152:155], v6, s[16:19], s50 offen offset:0 sc1
    v_mfma_f32_16x16x32_bf16 v[44:47], v[128:131], v[164:167], v[44:47]
    v_mfma_f32_16x16x32_bf16 v[60:63], v[132:135], v[164:167], v[60:63]
    ds_read_b64_tr_b16 v[128:129], v24 offset:2048
    v_mfma_f32_16x16x32_bf16 v[56:59], v[132:135], v[160:163], v[56:59]
    ds_read_b64_tr_b16 v[130:131], v24 offset:2560
    v_mfma_f32_16x16x32_bf16 v[72:75], v[136:139], v[160:163], v[72:75]
    ds_read_b64_tr_b16 v[132:133], v25 offset:2048
    v_mfma_f32_16x16x32_bf16 v[76:79], v[136:139], v[164:167], v[76:79]
    ds_read_b64_tr_b16 v[134:135], v25 offset:2560
    v_mfma_f32_16x16x32_bf16 v[92:95], v[140:143], v[164:167], v[92:95]
    ds_read_b64_tr_b16 v[136:137], v24 offset:10240
    buffer_load_dwordx4 v[156:159], v6, s[16:19], s50 offen offset:256 sc1
    v_mfma_f32_16x16x32_bf16 v[88:91], v[140:143], v[160:163], v[88:91]
    ds_read_b64_tr_b16 v[138:139], v24 offset:10752
    v_mfma_f32_16x16x32_bf16 v[104:107], v[160:163], v[144:147], v[104:107]
    ds_read_b64_tr_b16 v[140:141], v25 offset:10240
    v_mfma_f32_16x16x32_bf16 v[108:111], v[164:167], v[144:147], v[108:111]
    ds_read_b64_tr_b16 v[142:143], v25 offset:10752
    v_mfma_f32_16x16x32_bf16 v[124:127], v[164:167], v[148:151], v[124:127]
    ds_read_b64_tr_b16 v[144:145], v24 offset:18432
    v_mfma_f32_16x16x32_bf16 v[120:123], v[160:163], v[148:151], v[120:123]
    ds_read_b64_tr_b16 v[146:147], v24 offset:18944
    s_waitcnt vmcnt(12) lgkmcnt(8)
    v_mfma_f32_16x16x32_bf16 v[32:35], v[128:131], v[168:171], v[32:35]
    ds_read_b64_tr_b16 v[148:149], v25 offset:18432
    buffer_load_dwordx4 v[160:163], v6, s[20:23], s58 offen offset:2048 sc1
    v_mfma_f32_16x16x32_bf16 v[36:39], v[128:131], v[172:175], v[36:39]
    ds_read_b64_tr_b16 v[150:151], v25 offset:18944
    s_waitcnt lgkmcnt(8)
    v_mfma_f32_16x16x32_bf16 v[52:55], v[132:135], v[172:175], v[52:55]
    v_mfma_f32_16x16x32_bf16 v[48:51], v[132:135], v[168:171], v[48:51]
    s_waitcnt lgkmcnt(6)
    v_mfma_f32_16x16x32_bf16 v[64:67], v[136:139], v[168:171], v[64:67]
    v_mfma_f32_16x16x32_bf16 v[68:71], v[136:139], v[172:175], v[68:71]
    s_waitcnt lgkmcnt(4)
    v_mfma_f32_16x16x32_bf16 v[84:87], v[140:143], v[172:175], v[84:87]
    buffer_load_dwordx4 v[164:167], v6, s[20:23], s58 offen offset:2304 sc1
    v_mfma_f32_16x16x32_bf16 v[80:83], v[140:143], v[168:171], v[80:83]
    s_waitcnt lgkmcnt(2)
    v_mfma_f32_16x16x32_bf16 v[96:99], v[168:171], v[144:147], v[96:99]
    v_mfma_f32_16x16x32_bf16 v[100:103], v[172:175], v[144:147], v[100:103]
    s_waitcnt lgkmcnt(0)
    v_mfma_f32_16x16x32_bf16 v[116:119], v[172:175], v[148:151], v[116:119]
    v_mfma_f32_16x16x32_bf16 v[112:115], v[168:171], v[148:151], v[112:115]
    s_waitcnt vmcnt(12)
    v_mfma_f32_16x16x32_bf16 v[40:43], v[128:131], v[176:179], v[40:43]
    buffer_load_dwordx4 v[168:171], v6, s[16:19], s50 offen offset:2048 sc1
    v_mfma_f32_16x16x32_bf16 v[44:47], v[128:131], v[180:183], v[44:47]
    v_mfma_f32_16x16x32_bf16 v[60:63], v[132:135], v[180:183], v[60:63]
    ds_read_b64_tr_b16 v[128:129], v24 offset:4096
    v_mfma_f32_16x16x32_bf16 v[56:59], v[132:135], v[176:179], v[56:59]
    ds_read_b64_tr_b16 v[130:131], v24 offset:4608
    v_mfma_f32_16x16x32_bf16 v[72:75], v[136:139], v[176:179], v[72:75]
    ds_read_b64_tr_b16 v[132:133], v25 offset:4096
    v_mfma_f32_16x16x32_bf16 v[76:79], v[136:139], v[180:183], v[76:79]
    ds_read_b64_tr_b16 v[134:135], v25 offset:4608
    v_mfma_f32_16x16x32_bf16 v[92:95], v[140:143], v[180:183], v[92:95]
    ds_read_b64_tr_b16 v[136:137], v24 offset:12288
    buffer_load_dwordx4 v[172:175], v6, s[16:19], s50 offen offset:2304 sc1
    v_mfma_f32_16x16x32_bf16 v[88:91], v[140:143], v[176:179], v[88:91]
    ds_read_b64_tr_b16 v[138:139], v24 offset:12800
    v_mfma_f32_16x16x32_bf16 v[104:107], v[176:179], v[144:147], v[104:107]
    ds_read_b64_tr_b16 v[140:141], v25 offset:12288
    v_mfma_f32_16x16x32_bf16 v[108:111], v[180:183], v[144:147], v[108:111]
    ds_read_b64_tr_b16 v[142:143], v25 offset:12800
    v_mfma_f32_16x16x32_bf16 v[124:127], v[180:183], v[148:151], v[124:127]
    ds_read_b64_tr_b16 v[144:145], v24 offset:20480
    v_mfma_f32_16x16x32_bf16 v[120:123], v[176:179], v[148:151], v[120:123]
    ds_read_b64_tr_b16 v[146:147], v24 offset:20992
    s_waitcnt vmcnt(12) lgkmcnt(8)
    v_mfma_f32_16x16x32_bf16 v[32:35], v[128:131], a[0:3], v[32:35]
    ds_read_b64_tr_b16 v[148:149], v25 offset:20480
    buffer_load_dwordx4 v[176:179], v6, s[20:23], s59 offen offset:0 sc1
    v_mfma_f32_16x16x32_bf16 v[36:39], v[128:131], a[4:7], v[36:39]
    ds_read_b64_tr_b16 v[150:151], v25 offset:20992
    s_waitcnt lgkmcnt(8)
    v_mfma_f32_16x16x32_bf16 v[52:55], v[132:135], a[4:7], v[52:55]
    v_mfma_f32_16x16x32_bf16 v[48:51], v[132:135], a[0:3], v[48:51]
    s_waitcnt lgkmcnt(6)
    v_mfma_f32_16x16x32_bf16 v[64:67], v[136:139], a[0:3], v[64:67]
    v_mfma_f32_16x16x32_bf16 v[68:71], v[136:139], a[4:7], v[68:71]
    s_waitcnt lgkmcnt(4)
    v_mfma_f32_16x16x32_bf16 v[84:87], v[140:143], a[4:7], v[84:87]
    buffer_load_dwordx4 v[180:183], v6, s[20:23], s59 offen offset:256 sc1
    v_mfma_f32_16x16x32_bf16 v[80:83], v[140:143], a[0:3], v[80:83]
    s_waitcnt lgkmcnt(2)
    v_mfma_f32_16x16x32_bf16 v[96:99], a[0:3], v[144:147], v[96:99]
    v_mfma_f32_16x16x32_bf16 v[100:103], a[4:7], v[144:147], v[100:103]
    s_waitcnt lgkmcnt(0)
    v_mfma_f32_16x16x32_bf16 v[116:119], a[4:7], v[148:151], v[116:119]
    v_mfma_f32_16x16x32_bf16 v[112:115], a[0:3], v[148:151], v[112:115]
    s_waitcnt vmcnt(12)
    v_mfma_f32_16x16x32_bf16 v[40:43], v[128:131], a[8:11], v[40:43]
    buffer_load_dwordx4 a[0:3], v6, s[16:19], s51 offen offset:0 sc1
    v_mfma_f32_16x16x32_bf16 v[44:47], v[128:131], a[12:15], v[44:47]
    v_mfma_f32_16x16x32_bf16 v[60:63], v[132:135], a[12:15], v[60:63]
    ds_read_b64_tr_b16 v[128:129], v24 offset:6144
    v_mfma_f32_16x16x32_bf16 v[56:59], v[132:135], a[8:11], v[56:59]
    ds_read_b64_tr_b16 v[130:131], v24 offset:6656
    v_mfma_f32_16x16x32_bf16 v[72:75], v[136:139], a[8:11], v[72:75]
    ds_read_b64_tr_b16 v[132:133], v25 offset:6144
    v_mfma_f32_16x16x32_bf16 v[76:79], v[136:139], a[12:15], v[76:79]
    ds_read_b64_tr_b16 v[134:135], v25 offset:6656
    v_mfma_f32_16x16x32_bf16 v[92:95], v[140:143], a[12:15], v[92:95]
    ds_read_b64_tr_b16 v[136:137], v24 offset:14336
    buffer_load_dwordx4 a[4:7], v6, s[16:19], s51 offen offset:256 sc1
    v_mfma_f32_16x16x32_bf16 v[88:91], v[140:143], a[8:11], v[88:91]
    ds_read_b64_tr_b16 v[138:139], v24 offset:14848
    v_mfma_f32_16x16x32_bf16 v[104:107], a[8:11], v[144:147], v[104:107]
    ds_read_b64_tr_b16 v[140:141], v25 offset:14336
    v_mfma_f32_16x16x32_bf16 v[108:111], a[12:15], v[144:147], v[108:111]
    ds_read_b64_tr_b16 v[142:143], v25 offset:14848
    v_mfma_f32_16x16x32_bf16 v[124:127], a[12:15], v[148:151], v[124:127]
    ds_read_b64_tr_b16 v[144:145], v24 offset:22528
    v_mfma_f32_16x16x32_bf16 v[120:123], a[8:11], v[148:151], v[120:123]
    ds_read_b64_tr_b16 v[146:147], v24 offset:23040
    s_waitcnt vmcnt(12) lgkmcnt(8)
    v_mfma_f32_16x16x32_bf16 v[32:35], v[128:131], a[16:19], v[32:35]
    ds_read_b64_tr_b16 v[148:149], v25 offset:22528
    buffer_load_dwordx4 a[8:11], v6, s[20:23], s59 offen offset:2048 sc1
    v_mfma_f32_16x16x32_bf16 v[36:39], v[128:131], a[20:23], v[36:39]
    ds_read_b64_tr_b16 v[150:151], v25 offset:23040
    s_waitcnt lgkmcnt(8)
    v_mfma_f32_16x16x32_bf16 v[52:55], v[132:135], a[20:23], v[52:55]
    v_mfma_f32_16x16x32_bf16 v[48:51], v[132:135], a[16:19], v[48:51]
    s_waitcnt lgkmcnt(6)
    v_mfma_f32_16x16x32_bf16 v[64:67], v[136:139], a[16:19], v[64:67]
    v_mfma_f32_16x16x32_bf16 v[68:71], v[136:139], a[20:23], v[68:71]
    s_waitcnt lgkmcnt(4)
    v_mfma_f32_16x16x32_bf16 v[84:87], v[140:143], a[20:23], v[84:87]
    buffer_load_dwordx4 a[12:15], v6, s[20:23], s59 offen offset:2304 sc1
    v_mfma_f32_16x16x32_bf16 v[80:83], v[140:143], a[16:19], v[80:83]
    s_waitcnt lgkmcnt(2)
    v_mfma_f32_16x16x32_bf16 v[96:99], a[16:19], v[144:147], v[96:99]
    s_add_u32 s52, s52, 24576
    v_mfma_f32_16x16x32_bf16 v[100:103], a[20:23], v[144:147], v[100:103]
    s_cmp_eq_u32 s52, 147456
    s_waitcnt lgkmcnt(0)
    v_mfma_f32_16x16x32_bf16 v[116:119], a[20:23], v[148:151], v[116:119]
    s_cselect_b32 s52, 0, s52
    v_mfma_f32_16x16x32_bf16 v[112:115], a[16:19], v[148:151], v[112:115]
    s_add_u32 s58, s58, 8192
    s_add_u32 s59, s59, 8192
    s_waitcnt vmcnt(12)
    v_mfma_f32_16x16x32_bf16 v[40:43], v[128:131], a[24:27], v[40:43]
    buffer_load_dwordx4 a[16:19], v6, s[16:19], s51 offen offset:2048 sc1
    s_barrier
    v_add_u32 v24, s52, v26
    v_mfma_f32_16x16x32_bf16 v[44:47], v[128:131], a[28:31], v[44:47]
    v_add_u32 v25, s52, v27
    v_mfma_f32_16x16x32_bf16 v[60:63], v[132:135], a[28:31], v[60:63]
    ds_read_b64_tr_b16 v[128:129], v24 offset:0
    v_mfma_f32_16x16x32_bf16 v[56:59], v[132:135], a[24:27], v[56:59]
    ds_read_b64_tr_b16 v[130:131], v24 offset:512
    v_mfma_f32_16x16x32_bf16 v[72:75], v[136:139], a[24:27], v[72:75]
    ds_read_b64_tr_b16 v[132:133], v25 offset:0
    v_mfma_f32_16x16x32_bf16 v[76:79], v[136:139], a[28:31], v[76:79]
    ds_read_b64_tr_b16 v[134:135], v25 offset:512
    v_mfma_f32_16x16x32_bf16 v[92:95], v[140:143], a[28:31], v[92:95]
    ds_read_b64_tr_b16 v[136:137], v24 offset:8192
    buffer_load_dwordx4 a[20:23], v6, s[16:19], s51 offen offset:2304 sc1
    v_mfma_f32_16x16x32_bf16 v[88:91], v[140:143], a[24:27], v[88:91]
    ds_read_b64_tr_b16 v[138:139], v24 offset:8704
    v_mfma_f32_16x16x32_bf16 v[104:107], a[24:27], v[144:147], v[104:107]
    ds_read_b64_tr_b16 v[140:141], v25 offset:8192
    s_add_u32 s50, s50, 8192
    v_mfma_f32_16x16x32_bf16 v[108:111], a[28:31], v[144:147], v[108:111]
    ds_read_b64_tr_b16 v[142:143], v25 offset:8704
    s_add_u32 s51, s51, 8192
    v_mfma_f32_16x16x32_bf16 v[124:127], a[28:31], v[148:151], v[124:127]
    ds_read_b64_tr_b16 v[144:145], v24 offset:16384
    s_sub_u32 s54, s54, 1
    v_mfma_f32_16x16x32_bf16 v[120:123], a[24:27], v[148:151], v[120:123]
    ds_read_b64_tr_b16 v[146:147], v24 offset:16896
    s_cmp_lg_u32 s54, 0
    s_cbranch_scc1 c_qkvB_loop
    s_waitcnt vmcnt(12) lgkmcnt(8)
    v_mfma_f32_16x16x32_bf16 v[32:35], v[128:131], v[152:155], v[32:35]
    ds_read_b64_tr_b16 v[148:149], v25 offset:16384
    buffer_load_dwordx4 a[24:27], v6, s[20:23], s58 offen offset:0 sc1
    v_mfma_f32_16x16x32_bf16 v[36:39], v[128:131], v[156:159], v[36:39]
    ds_read_b64_tr_b16 v[150:151], v25 offset:16896
    s_waitcnt lgkmcnt(8)
    v_mfma_f32_16x16x32_bf16 v[52:55], v[132:135], v[156:159], v[52:55]
    ds_read_b32 v184, v8 offset:1280
    v_mfma_f32_16x16x32_bf16 v[48:51], v[132:135], v[152:155], v[48:51]
    ds_read_b32 v186, v8 offset:1344
    s_waitcnt lgkmcnt(8)
    v_mfma_f32_16x16x32_bf16 v[64:67], v[136:139], v[152:155], v[64:67]
    ds_read_b32 v188, v8 offset:1408
    v_mfma_f32_16x16x32_bf16 v[68:71], v[136:139], v[156:159], v[68:71]
    s_waitcnt lgkmcnt(7)
    v_mfma_f32_16x16x32_bf16 v[84:87], v[140:143], v[156:159], v[84:87]
    buffer_load_dwordx4 a[28:31], v6, s[20:23], s58 offen offset:256 sc1
    ds_read_b32 v190, v8 offset:1472
    v_mfma_f32_16x16x32_bf16 v[80:83], v[140:143], v[152:155], v[80:83]
    ds_read_b128 v[212:215], v10 offset:512
    s_waitcnt lgkmcnt(7)
    v_mfma_f32_16x16x32_bf16 v[96:99], v[152:155], v[144:147], v[96:99]
    ds_read_b128 v[216:219], v10 offset:576
    v_mfma_f32_16x16x32_bf16 v[100:103], v[156:159], v[144:147], v[100:103]
    s_waitcnt lgkmcnt(6)
    v_mfma_f32_16x16x32_bf16 v[116:119], v[156:159], v[148:151], v[116:119]
    v_mfma_f32_16x16x32_bf16 v[112:115], v[152:155], v[148:151], v[112:115]
    s_waitcnt vmcnt(12)
    v_mfma_f32_16x16x32_bf16 v[40:43], v[128:131], v[160:163], v[40:43]
    s_waitcnt lgkmcnt(0)
    v_fma_f32 v64, -v184, v212, v64
    v_fma_f32 v65, -v184, v213, v65
    v_mfma_f32_16x16x32_bf16 v[44:47], v[128:131], v[164:167], v[44:47]
    v_fma_f32 v66, -v184, v214, v66
    v_mfma_f32_16x16x32_bf16 v[60:63], v[132:135], v[164:167], v[60:63]
    ds_read_b64_tr_b16 v[128:129], v24 offset:2048
    v_fma_f32 v67, -v184, v215, v67
    v_mfma_f32_16x16x32_bf16 v[56:59], v[132:135], v[160:163], v[56:59]
    ds_read_b64_tr_b16 v[130:131], v24 offset:2560
    v_fma_f32 v68, -v186, v212, v68
    v_fma_f32 v69, -v186, v213, v69
    v_mfma_f32_16x16x32_bf16 v[72:75], v[136:139], v[160:163], v[72:75]
    ds_read_b64_tr_b16 v[132:133], v25 offset:2048
    v_fma_f32 v70, -v186, v214, v70
    v_mfma_f32_16x16x32_bf16 v[76:79], v[136:139], v[164:167], v[76:79]
    ds_read_b64_tr_b16 v[134:135], v25 offset:2560
    v_fma_f32 v71, -v186, v215, v71
    v_mfma_f32_16x16x32_bf16 v[92:95], v[140:143], v[164:167], v[92:95]
    ds_read_b64_tr_b16 v[136:137], v24 offset:10240
    v_fma_f32 v80, -v184, v216, v80
    v_fma_f32 v81, -v184, v217, v81
    v_mfma_f32_16x16x32_bf16 v[88:91], v[140:143], v[160:163], v[88:91]
    ds_read_b64_tr_b16 v[138:139], v24 offset:10752
    v_fma_f32 v82, -v184, v218, v82
    v_mfma_f32_16x16x32_bf16 v[104:107], v[160:163], v[144:147], v[104:107]
    ds_read_b64_tr_b16 v[140:141], v25 offset:10240
    v_fma_f32 v83, -v184, v219, v83
    v_mfma_f32_16x16x32_bf16 v[108:111], v[164:167], v[144:147], v[108:111]
    ds_read_b64_tr_b16 v[142:143], v25 offset:10752
    v_fma_f32 v84, -v186, v216, v84
    v_fma_f32 v85, -v186, v217, v85
    v_mfma_f32_16x16x32_bf16 v[124:127], v[164:167], v[148:151], v[124:127]
    ds_read_b64_tr_b16 v[144:145], v24 offset:18432
    v_fma_f32 v86, -v186, v218, v86
    v_mfma_f32_16x16x32_bf16 v[120:123], v[160:163], v[148:151], v[120:123]
    ds_read_b64_tr_b16 v[146:147], v24 offset:18944
    v_fma_f32 v87, -v186, v219, v87
    s_waitcnt vmcnt(10) lgkmcnt(8)
    v_mfma_f32_16x16x32_bf16 v[32:35], v[128:131], v[168:171], v[32:35]
    ds_read_b64_tr_b16 v[148:149], v25 offset:18432
    v_fma_f32 v72, -v188, v212, v72
    v_fma_f32 v73, -v188, v213, v73
    v_mfma_f32_16x16x32_bf16 v[36:39], v[128:131], v[172:175], v[36:39]
    ds_read_b64_tr_b16 v[150:151], v25 offset:18944
    v_fma_f32 v74, -v188, v214, v74
    s_waitcnt lgkmcnt(8)
    v_mfma_f32_16x16x32_bf16 v[52:55], v[132:135], v[172:175], v[52:55]
    v_fma_f32 v75, -v188, v215, v75
    ds_read_b128 v[152:155], v10 offset:384
    v_mfma_f32_16x16x32_bf16 v[48:51], v[132:135], v[168:171], v[48:51]
    v_fma_f32 v76, -v190, v212, v76
    v_fma_f32 v77, -v190, v213, v77
    ds_read_b128 v[156:159], v10 offset:448
    s_waitcnt lgkmcnt(8)
    v_mfma_f32_16x16x32_bf16 v[64:67], v[136:139], v[168:171], v[64:67]
    v_fma_f32 v78, -v190, v214, v78
    ds_read_b32 v185, v8 offset:2816
    v_mfma_f32_16x16x32_bf16 v[68:71], v[136:139], v[172:175], v[68:71]
    v_fma_f32 v79, -v190, v215, v79
    s_waitcnt lgkmcnt(7)
    v_mfma_f32_16x16x32_bf16 v[84:87], v[140:143], v[172:175], v[84:87]
    v_fma_f32 v88, -v188, v216, v88
    v_fma_f32 v89, -v188, v217, v89
    ds_read_b32 v187, v8 offset:2880
    v_mfma_f32_16x16x32_bf16 v[80:83], v[140:143], v[168:171], v[80:83]
    v_fma_f32 v90, -v188, v218, v90
    ds_read_b32 v189, v8 offset:2944
    s_waitcnt lgkmcnt(7)
    v_mfma_f32_16x16x32_bf16 v[96:99], v[168:171], v[144:147], v[96:99]
    v_fma_f32 v91, -v188, v219, v91
    ds_read_b32 v191, v8 offset:3008
    v_mfma_f32_16x16x32_bf16 v[100:103], v[172:175], v[144:147], v[100:103]
    v_fma_f32 v92, -v190, v216, v92
    v_fma_f32 v93, -v190, v217, v93
    s_waitcnt lgkmcnt(6)
    v_mfma_f32_16x16x32_bf16 v[116:119], v[172:175], v[148:151], v[116:119]
    v_fma_f32 v94, -v190, v218, v94
    v_mfma_f32_16x16x32_bf16 v[112:115], v[168:171], v[148:151], v[112:115]
    v_fma_f32 v95, -v190, v219, v95
    s_waitcnt vmcnt(8)
    v_mfma_f32_16x16x32_bf16 v[40:43], v[128:131], v[176:179], v[40:43]
    s_waitcnt lgkmcnt(0)
    v_fma_f32 v32, -v184, v152, v32
    v_fma_f32 v33, -v184, v153, v33
    v_mfma_f32_16x16x32_bf16 v[44:47], v[128:131], v[180:183], v[44:47]
    v_fma_f32 v34, -v184, v154, v34
    v_mfma_f32_16x16x32_bf16 v[60:63], v[132:135], v[180:183], v[60:63]
    ds_read_b64_tr_b16 v[128:129], v24 offset:4096
    v_fma_f32 v35, -v184, v155, v35
    v_fma_f32 v36, -v186, v152, v36
    v_mfma_f32_16x16x32_bf16 v[56:59], v[132:135], v[176:179], v[56:59]
    ds_read_b64_tr_b16 v[130:131], v24 offset:4608
    v_fma_f32 v37, -v186, v153, v37
    v_mfma_f32_16x16x32_bf16 v[72:75], v[136:139], v[176:179], v[72:75]
    ds_read_b64_tr_b16 v[132:133], v25 offset:4096
    v_fma_f32 v38, -v186, v154, v38
    v_fma_f32 v39, -v186, v155, v39
    v_mfma_f32_16x16x32_bf16 v[76:79], v[136:139], v[180:183], v[76:79]
    ds_read_b64_tr_b16 v[134:135], v25 offset:4608
    v_fma_f32 v48, -v184, v156, v48
    v_mfma_f32_16x16x32_bf16 v[92:95], v[140:143], v[180:183], v[92:95]
    ds_read_b64_tr_b16 v[136:137], v24 offset:12288
    v_fma_f32 v49, -v184, v157, v49
    v_fma_f32 v50, -v184, v158, v50
    v_mfma_f32_16x16x32_bf16 v[88:91], v[140:143], v[176:179], v[88:91]
    ds_read_b64_tr_b16 v[138:139], v24 offset:12800
    v_fma_f32 v51, -v184, v159, v51
    v_mfma_f32_16x16x32_bf16 v[104:107], v[176:179], v[144:147], v[104:107]
    ds_read_b64_tr_b16 v[140:141], v25 offset:12288
    v_fma_f32 v52, -v186, v156, v52
    v_fma_f32 v53, -v186, v157, v53
    v_mfma_f32_16x16x32_bf16 v[108:111], v[180:183], v[144:147], v[108:111]
    ds_read_b64_tr_b16 v[142:143], v25 offset:12800
    v_fma_f32 v54, -v186, v158, v54
    v_mfma_f32_16x16x32_bf16 v[124:127], v[180:183], v[148:151], v[124:127]
    ds_read_b64_tr_b16 v[144:145], v24 offset:20480
    v_fma_f32 v55, -v186, v159, v55
    v_mfma_f32_16x16x32_bf16 v[120:123], v[176:179], v[148:151], v[120:123]
    ds_read_b64_tr_b16 v[146:147], v24 offset:20992
    s_waitcnt vmcnt(6) lgkmcnt(8)
    v_mfma_f32_16x16x32_bf16 v[32:35], v[128:131], a[0:3], v[32:35]
    ds_read_b64_tr_b16 v[148:149], v25 offset:20480
    v_fma_f32 v40, -v188, v152, v40
    v_fma_f32 v41, -v188, v153, v41
    v_mfma_f32_16x16x32_bf16 v[36:39], v[128:131], a[4:7], v[36:39]
    ds_read_b64_tr_b16 v[150:151], v25 offset:20992
    v_fma_f32 v42, -v188, v154, v42
    s_waitcnt lgkmcnt(8)
    v_mfma_f32_16x16x32_bf16 v[52:55], v[132:135], a[4:7], v[52:55]
    v_fma_f32 v43, -v188, v155, v43
    v_fma_f32 v44, -v190, v152, v44
    ds_read_b128 v[168:171], v9 offset:1280
    v_mfma_f32_16x16x32_bf16 v[48:51], v[132:135], a[0:3], v[48:51]
    v_fma_f32 v45, -v190, v153, v45
    ds_read_b128 v[172:175], v9 offset:1344
    s_waitcnt lgkmcnt(8)
    v_mfma_f32_16x16x32_bf16 v[64:67], v[136:139], a[0:3], v[64:67]
    v_fma_f32 v46, -v190, v154, v46
    v_fma_f32 v47, -v190, v155, v47
    v_mfma_f32_16x16x32_bf16 v[68:71], v[136:139], a[4:7], v[68:71]
    v_fma_f32 v56, -v188, v156, v56
    ds_read_b128 v[176:179], v9 offset:1408
    s_waitcnt lgkmcnt(7)
    v_mfma_f32_16x16x32_bf16 v[84:87], v[140:143], a[4:7], v[84:87]
    v_fma_f32 v57, -v188, v157, v57
    v_fma_f32 v58, -v188, v158, v58
    ds_read_b128 v[180:183], v9 offset:1472
    v_mfma_f32_16x16x32_bf16 v[80:83], v[140:143], a[0:3], v[80:83]
    v_fma_f32 v59, -v188, v159, v59
    s_waitcnt lgkmcnt(6)
    v_mfma_f32_16x16x32_bf16 v[96:99], a[0:3], v[144:147], v[96:99]
    v_fma_f32 v60, -v190, v156, v60
    v_fma_f32 v61, -v190, v157, v61
    ds_read2_b32 v[220:221], v11 offset0:160 offset1:176
    v_mfma_f32_16x16x32_bf16 v[100:103], a[4:7], v[144:147], v[100:103]
    v_fma_f32 v62, -v190, v158, v62
    s_waitcnt lgkmcnt(5)
    v_mfma_f32_16x16x32_bf16 v[116:119], a[4:7], v[148:151], v[116:119]
    v_fma_f32 v63, -v190, v159, v63
    v_mfma_f32_16x16x32_bf16 v[112:115], a[0:3], v[148:151], v[112:115]
    s_waitcnt vmcnt(4)
    v_mfma_f32_16x16x32_bf16 v[40:43], v[128:131], a[8:11], v[40:43]
    v_mfma_f32_16x16x32_bf16 v[44:47], v[128:131], a[12:15], v[44:47]
    s_waitcnt lgkmcnt(0)
    v_fma_f32 v96, -v168, v220, v96
    v_fma_f32 v97, -v169, v220, v97
    v_mfma_f32_16x16x32_bf16 v[60:63], v[132:135], a[12:15], v[60:63]
    ds_read_b64_tr_b16 v[128:129], v24 offset:6144
    v_fma_f32 v98, -v170, v220, v98
    v_mfma_f32_16x16x32_bf16 v[56:59], v[132:135], a[8:11], v[56:59]
    ds_read_b64_tr_b16 v[130:131], v24 offset:6656
    v_fma_f32 v99, -v171, v220, v99
    v_fma_f32 v100, -v172, v220, v100
    v_mfma_f32_16x16x32_bf16 v[72:75], v[136:139], a[8:11], v[72:75]
    ds_read_b64_tr_b16 v[132:133], v25 offset:6144
    v_fma_f32 v101, -v173, v220, v101
    v_mfma_f32_16x16x32_bf16 v[76:79], v[136:139], a[12:15], v[76:79]
    ds_read_b64_tr_b16 v[134:135], v25 offset:6656
    v_fma_f32 v102, -v174, v220, v102
    v_fma_f32 v103, -v175, v220, v103
    v_mfma_f32_16x16x32_bf16 v[92:95], v[140:143], a[12:15], v[92:95]
    ds_read_b64_tr_b16 v[136:137], v24 offset:14336
    v_fma_f32 v112, -v168, v221, v112
    v_mfma_f32_16x16x32_bf16 v[88:91], v[140:143], a[8:11], v[88:91]
    ds_read_b64_tr_b16 v[138:139], v24 offset:14848
    v_fma_f32 v113, -v169, v221, v113
    v_fma_f32 v114, -v170, v221, v114
    v_mfma_f32_16x16x32_bf16 v[104:107], a[8:11], v[144:147], v[104:107]
    ds_read_b64_tr_b16 v[140:141], v25 offset:14336
    v_fma_f32 v115, -v171, v221, v115
    v_mfma_f32_16x16x32_bf16 v[108:111], a[12:15], v[144:147], v[108:111]
    ds_read_b64_tr_b16 v[142:143], v25 offset:14848
    v_fma_f32 v116, -v172, v221, v116
    v_fma_f32 v117, -v173, v221, v117
    v_mfma_f32_16x16x32_bf16 v[124:127], a[12:15], v[148:151], v[124:127]
    ds_read_b64_tr_b16 v[144:145], v24 offset:22528
    v_fma_f32 v118, -v174, v221, v118
    v_mfma_f32_16x16x32_bf16 v[120:123], a[8:11], v[148:151], v[120:123]
    ds_read_b64_tr_b16 v[146:147], v24 offset:23040
    v_fma_f32 v119, -v175, v221, v119
    s_waitcnt vmcnt(2) lgkmcnt(8)
    v_mfma_f32_16x16x32_bf16 v[32:35], v[128:131], a[16:19], v[32:35]
    ds_read_b64_tr_b16 v[148:149], v25 offset:22528
    v_mfma_f32_16x16x32_bf16 v[36:39], v[128:131], a[20:23], v[36:39]
    ds_read_b64_tr_b16 v[150:151], v25 offset:23040
    v_fma_f32 v104, -v176, v220, v104
    v_fma_f32 v105, -v177, v220, v105
    s_waitcnt lgkmcnt(8)
    v_mfma_f32_16x16x32_bf16 v[52:55], v[132:135], a[20:23], v[52:55]
    v_fma_f32 v106, -v178, v220, v106
    ds_read_b128 v[152:155], v9 offset:2816
    v_mfma_f32_16x16x32_bf16 v[48:51], v[132:135], a[16:19], v[48:51]
    v_fma_f32 v107, -v179, v220, v107
    v_fma_f32 v108, -v180, v220, v108
    s_waitcnt lgkmcnt(7)
    v_mfma_f32_16x16x32_bf16 v[64:67], v[136:139], a[16:19], v[64:67]
    v_fma_f32 v109, -v181, v220, v109
    ds_read_b128 v[156:159], v9 offset:2880
    v_mfma_f32_16x16x32_bf16 v[68:71], v[136:139], a[20:23], v[68:71]
    v_fma_f32 v110, -v182, v220, v110
    v_fma_f32 v111, -v183, v220, v111
    s_waitcnt lgkmcnt(6)
    v_mfma_f32_16x16x32_bf16 v[84:87], v[140:143], a[20:23], v[84:87]
    v_fma_f32 v120, -v176, v221, v120
    ds_read_b128 v[160:163], v9 offset:2944
    v_mfma_f32_16x16x32_bf16 v[80:83], v[140:143], a[16:19], v[80:83]
    v_fma_f32 v121, -v177, v221, v121
    v_fma_f32 v122, -v178, v221, v122
    s_waitcnt lgkmcnt(5)
    v_mfma_f32_16x16x32_bf16 v[96:99], a[16:19], v[144:147], v[96:99]
    v_fma_f32 v123, -v179, v221, v123
    ds_read_b128 v[164:167], v9 offset:3008
    v_mfma_f32_16x16x32_bf16 v[100:103], a[20:23], v[144:147], v[100:103]
    v_fma_f32 v124, -v180, v221, v124
    v_fma_f32 v125, -v181, v221, v125
    s_waitcnt lgkmcnt(4)
    v_mfma_f32_16x16x32_bf16 v[116:119], a[20:23], v[148:151], v[116:119]
    v_fma_f32 v126, -v182, v221, v126
    v_mfma_f32_16x16x32_bf16 v[112:115], a[16:19], v[148:151], v[112:115]
    v_fma_f32 v127, -v183, v221, v127
    s_waitcnt vmcnt(0)
    v_mfma_f32_16x16x32_bf16 v[40:43], v[128:131], a[24:27], v[40:43]
    v_mul_f32 v64, v185, v64
    v_mul_f32 v65, v185, v65
    s_barrier
    v_mfma_f32_16x16x32_bf16 v[44:47], v[128:131], a[28:31], v[44:47]
    v_mul_f32 v66, v185, v66
    v_mul_f32 v67, v185, v67
    v_mfma_f32_16x16x32_bf16 v[60:63], v[132:135], a[28:31], v[60:63]
    v_mul_f32 v80, v185, v80
    v_mul_f32 v81, v185, v81
    v_mfma_f32_16x16x32_bf16 v[56:59], v[132:135], a[24:27], v[56:59]
    v_mul_f32 v82, v185, v82
    v_mul_f32 v83, v185, v83
    v_mfma_f32_16x16x32_bf16 v[72:75], v[136:139], a[24:27], v[72:75]
    v_cvt_pk_bf16_f32 v64, v64, v65
    v_cvt_pk_bf16_f32 v65, v66, v67
    v_mfma_f32_16x16x32_bf16 v[76:79], v[136:139], a[28:31], v[76:79]
    v_cvt_pk_bf16_f32 v66, v80, v81
    v_cvt_pk_bf16_f32 v67, v82, v83
    v_mfma_f32_16x16x32_bf16 v[92:95], v[140:143], a[28:31], v[92:95]
    v_mul_f32 v68, v187, v68
    v_mul_f32 v69, v187, v69
    v_mfma_f32_16x16x32_bf16 v[88:91], v[140:143], a[24:27], v[88:91]
    v_mul_f32 v70, v187, v70
    v_mul_f32 v71, v187, v71
    v_mfma_f32_16x16x32_bf16 v[104:107], a[24:27], v[144:147], v[104:107]
    v_mul_f32 v84, v187, v84
    v_mul_f32 v85, v187, v85
    v_mfma_f32_16x16x32_bf16 v[108:111], a[28:31], v[144:147], v[108:111]
    v_mul_f32 v86, v187, v86
    v_mul_f32 v87, v187, v87
    v_mfma_f32_16x16x32_bf16 v[124:127], a[28:31], v[148:151], v[124:127]
    v_cvt_pk_bf16_f32 v68, v68, v69
    v_cvt_pk_bf16_f32 v69, v70, v71
    v_mfma_f32_16x16x32_bf16 v[120:123], a[24:27], v[148:151], v[120:123]
    v_cvt_pk_bf16_f32 v70, v84, v85
    v_cvt_pk_bf16_f32 v71, v86, v87
    ds_write_b128 v12, v[64:67] offset:0
    ds_write_b128 v12, v[68:71] offset:256
    v_pk_mul_f32 v[72:73], v[188:189], v[72:73] op_sel:[1,0] op_sel_hi:[1,1]
    v_pk_mul_f32 v[74:75], v[188:189], v[74:75] op_sel:[1,0] op_sel_hi:[1,1]
    v_pk_mul_f32 v[88:89], v[188:189], v[88:89] op_sel:[1,0] op_sel_hi:[1,1]
    v_pk_mul_f32 v[90:91], v[188:189], v[90:91] op_sel:[1,0] op_sel_hi:[1,1]
    v_cvt_pk_bf16_f32 v72, v72, v73
    v_cvt_pk_bf16_f32 v73, v74, v75
    v_cvt_pk_bf16_f32 v74, v88, v89
    v_cvt_pk_bf16_f32 v75, v90, v91
    ds_write_b128 v12, v[72:75] offset:2048
    v_pk_mul_f32 v[76:77], v[190:191], v[76:77] op_sel:[1,0] op_sel_hi:[1,1]
    v_pk_mul_f32 v[78:79], v[190:191], v[78:79] op_sel:[1,0] op_sel_hi:[1,1]
    v_pk_mul_f32 v[92:93], v[190:191], v[92:93] op_sel:[1,0] op_sel_hi:[1,1]
    v_pk_mul_f32 v[94:95], v[190:191], v[94:95] op_sel:[1,0] op_sel_hi:[1,1]
    v_cvt_pk_bf16_f32 v76, v76, v77
    v_cvt_pk_bf16_f32 v77, v78, v79
    v_cvt_pk_bf16_f32 v78, v92, v93
    v_cvt_pk_bf16_f32 v79, v94, v95
    ds_write_b128 v12, v[76:79] offset:2304
    s_waitcnt lgkmcnt(4)
    v_pk_mul_f32 v[96:97], v[152:153], v[96:97]
    v_pk_mul_f32 v[98:99], v[154:155], v[98:99]
    v_pk_mul_f32 v[112:113], v[152:153], v[112:113]
    v_pk_mul_f32 v[114:115], v[154:155], v[114:115]
    v_cvt_pk_bf16_f32 v96, v96, v97
    v_cvt_pk_bf16_f32 v97, v98, v99
    v_cvt_pk_bf16_f32 v98, v112, v113
    v_cvt_pk_bf16_f32 v99, v114, v115
    v_mul_f32 v185, 0x3e8293ee, v185
    v_permlane16_swap_b32 v96, v98
    v_permlane16_swap_b32 v97, v99
    ds_write_b128 v13, v[96:99] offset:8192
    v_pk_mul_f32 v[100:101], v[156:157], v[100:101]
    v_pk_mul_f32 v[102:103], v[158:159], v[102:103]
    v_pk_mul_f32 v[116:117], v[156:157], v[116:117]
    v_pk_mul_f32 v[118:119], v[158:159], v[118:119]
    v_cvt_pk_bf16_f32 v100, v100, v101
    v_cvt_pk_bf16_f32 v101, v102, v103
    v_cvt_pk_bf16_f32 v102, v116, v117
    v_cvt_pk_bf16_f32 v103, v118, v119
    v_mul_f32 v187, 0x3e8293ee, v187
    v_permlane16_swap_b32 v100, v102
    v_permlane16_swap_b32 v101, v103
    ds_write_b128 v13, v[100:103] offset:9216
    v_pk_mul_f32 v[104:105], v[160:161], v[104:105]
    v_pk_mul_f32 v[106:107], v[162:163], v[106:107]
    v_pk_mul_f32 v[120:121], v[160:161], v[120:121]
    v_pk_mul_f32 v[122:123], v[162:163], v[122:123]
    v_cvt_pk_bf16_f32 v104, v104, v105
    v_cvt_pk_bf16_f32 v105, v106, v107
    v_cvt_pk_bf16_f32 v106, v120, v121
    v_cvt_pk_bf16_f32 v107, v122, v123
    v_mul_f32 v189, 0x3e8293ee, v189
    v_permlane16_swap_b32 v104, v106
    v_permlane16_swap_b32 v105, v107
    ds_write_b128 v13, v[104:107] offset:10240
    v_pk_mul_f32 v[108:109], v[164:165], v[108:109]
    v_pk_mul_f32 v[110:111], v[166:167], v[110:111]
    v_pk_mul_f32 v[124:125], v[164:165], v[124:125]
    v_pk_mul_f32 v[126:127], v[166:167], v[126:127]
    v_cvt_pk_bf16_f32 v108, v108, v109
    v_cvt_pk_bf16_f32 v109, v110, v111
    v_cvt_pk_bf16_f32 v110, v124, v125
    v_cvt_pk_bf16_f32 v111, v126, v127
    v_mul_f32 v191, 0x3e8293ee, v191
    v_permlane16_swap_b32 v108, v110
    v_permlane16_swap_b32 v109, v111
    ds_write_b128 v13, v[108:111] offset:11264
    v_add_u32 v24, 81920, v5
    s_waitcnt lgkmcnt(0)
    s_barrier
    ds_read_b128 v[128:131], v24 offset:0
    ds_read_b128 v[132:135], v24 offset:1024
    ds_read_b128 v[136:139], v24 offset:2048
    ds_read_b128 v[140:143], v24 offset:3072
    v_pk_mul_f32 v[32:33], v[184:185], v[32:33] op_sel:[1,0] op_sel_hi:[1,1]
    v_pk_mul_f32 v[34:35], v[184:185], v[34:35] op_sel:[1,0] op_sel_hi:[1,1]
    v_pk_mul_f32 v[48:49], v[184:185], v[48:49] op_sel:[1,0] op_sel_hi:[1,1]
    v_pk_mul_f32 v[50:51], v[184:185], v[50:51] op_sel:[1,0] op_sel_hi:[1,1]
    v_cvt_pk_bf16_f32 v8, v32, v33
    v_cvt_pk_bf16_f32 v9, v34, v35
    v_cvt_pk_bf16_f32 v10, v48, v49
    v_cvt_pk_bf16_f32 v11, v50, v51
    v_pk_mul_f32 v[36:37], v[186:187], v[36:37] op_sel:[1,0] op_sel_hi:[1,1]
    v_pk_mul_f32 v[38:39], v[186:187], v[38:39] op_sel:[1,0] op_sel_hi:[1,1]
    v_pk_mul_f32 v[52:53], v[186:187], v[52:53] op_sel:[1,0] op_sel_hi:[1,1]
    v_pk_mul_f32 v[54:55], v[186:187], v[54:55] op_sel:[1,0] op_sel_hi:[1,1]
    v_cvt_pk_bf16_f32 v12, v36, v37
    v_cvt_pk_bf16_f32 v13, v38, v39
    v_cvt_pk_bf16_f32 v14, v52, v53
    v_cvt_pk_bf16_f32 v15, v54, v55
    v_pk_mul_f32 v[40:41], v[188:189], v[40:41] op_sel:[1,0] op_sel_hi:[1,1]
    v_pk_mul_f32 v[42:43], v[188:189], v[42:43] op_sel:[1,0] op_sel_hi:[1,1]
    v_pk_mul_f32 v[56:57], v[188:189], v[56:57] op_sel:[1,0] op_sel_hi:[1,1]
    v_pk_mul_f32 v[58:59], v[188:189], v[58:59] op_sel:[1,0] op_sel_hi:[1,1]
    v_cvt_pk_bf16_f32 v16, v40, v41
    v_cvt_pk_bf16_f32 v17, v42, v43
    v_cvt_pk_bf16_f32 v18, v56, v57
    v_cvt_pk_bf16_f32 v19, v58, v59
    v_pk_mul_f32 v[44:45], v[190:191], v[44:45] op_sel:[1,0] op_sel_hi:[1,1]
    v_pk_mul_f32 v[46:47], v[190:191], v[46:47] op_sel:[1,0] op_sel_hi:[1,1]
    v_pk_mul_f32 v[60:61], v[190:191], v[60:61] op_sel:[1,0] op_sel_hi:[1,1]
    v_pk_mul_f32 v[62:63], v[190:191], v[62:63] op_sel:[1,0] op_sel_hi:[1,1]
    v_cvt_pk_bf16_f32 v20, v44, v45
    v_cvt_pk_bf16_f32 v21, v46, v47
    v_cvt_pk_bf16_f32 v22, v60, v61
    v_cvt_pk_bf16_f32 v23, v62, v63
    v_permlane16_swap_b32 v8, v12
    v_permlane16_swap_b32 v9, v13
    v_permlane16_swap_b32 v10, v14
    v_permlane16_swap_b32 v11, v15
    v_permlane16_swap_b32 v16, v20
    v_permlane16_swap_b32 v17, v21
    v_permlane16_swap_b32 v18, v22
    v_permlane16_swap_b32 v19, v23
    s_waitcnt lgkmcnt(0)
    v_mfma_f32_32x32x16_bf16 v[64:79], v[128:131], v[8:11], 0
    v_mfma_f32_32x32x16_bf16 v[64:79], v[132:135], v[12:15], v[64:79]
    v_and_b32 v28, 7, v1
    v_mov_b32 v29, 0x3f803f80
    v_cmp_eq_u32 vcc, 0, v28
    s_nop 1
    v_cndmask_b32 v200, 0, v29, vcc
    v_cndmask_b32 v201, 0, v29, vcc
    v_cmp_eq_u32 vcc, 4, v28
    s_nop 1
    v_cndmask_b32 v202, 0, v29, vcc
    v_cndmask_b32 v203, 0, v29, vcc
    v_mov_b32 v204, 0xdddddddd
    v_mov_b32 v160, 0
    v_mov_b32 v161, 0
    v_mov_b32 v162, 0
    v_mov_b32 v163, 0
    v_mov_b32 v164, 0
    v_mov_b32 v165, 0
    v_mov_b32 v166, 0
    v_mov_b32 v167, 0
    v_mov_b32 v168, 0
    v_mov_b32 v169, 0
    v_mov_b32 v170, 0
    v_mov_b32 v171, 0
    v_mov_b32 v172, 0
    v_mov_b32 v173, 0
    v_mov_b32 v174, 0
    v_mov_b32 v175, 0
    v_mov_b32 v192, 0
    v_mov_b32 v193, 0
    v_mov_b32 v194, 0
    v_mov_b32 v195, 0
    v_mov_b32 v176, 0
    v_mov_b32 v177, 0
    v_mov_b32 v178, 0
    v_mov_b32 v179, 0
    v_mov_b32 v180, 0
    v_mov_b32 v181, 0
    v_mov_b32 v182, 0
    v_mov_b32 v183, 0
    v_mov_b32 v184, 0
    v_mov_b32 v185, 0
    v_mov_b32 v186, 0
    v_mov_b32 v187, 0
    v_mov_b32 v188, 0
    v_mov_b32 v189, 0
    v_mov_b32 v190, 0
    v_mov_b32 v191, 0
    v_mov_b32 v196, 0
    v_mov_b32 v197, 0
    v_mov_b32 v198, 0
    v_mov_b32 v199, 0
    v_mov_b32 v112, 0
    v_mov_b32 v113, 0
    v_mov_b32 v114, 0
    v_mov_b32 v115, 0
    v_mov_b32 v116, 0
    v_mov_b32 v117, 0
    v_mov_b32 v118, 0
    v_mov_b32 v119, 0
    v_mov_b32 v120, 0
    v_mov_b32 v121, 0
    v_mov_b32 v122, 0
    v_mov_b32 v123, 0
    v_mov_b32 v124, 0
    v_mov_b32 v125, 0
    v_mov_b32 v126, 0
    v_mov_b32 v127, 0
    v_mov_b32 v152, 0
    v_mov_b32 v153, 0
    v_mov_b32 v154, 0
    v_mov_b32 v155, 0
    v_mov_b32 v156, 0
    v_mov_b32 v157, 0
    v_mov_b32 v158, 0
    v_mov_b32 v159, 0
    s_mov_b32 s54, 4
.p2align 3
c_attn_loop:
    v_mfma_f32_32x32x16_bf16 v[80:95], v[128:131], v[16:19], 0
    v_exp_f32 v64, v64
    v_exp_f32 v65, v65
    v_exp_f32 v66, v66
    v_mfma_f32_32x32x16_bf16 v[80:95], v[132:135], v[20:23], v[80:95]
    v_exp_f32 v67, v67
    v_exp_f32 v68, v68
    v_exp_f32 v69, v69
    v_smfmac_f32_32x32x32_bf16 v[176:191], v[152:155], v[112:119], v204
    s_waitcnt lgkmcnt(0)
    v_exp_f32 v70, v70
    v_exp_f32 v71, v71
    v_exp_f32 v72, v72
    v_smfmac_f32_16x16x64_bf16 v[196:199], v[200:203], v[112:119], v204
    ds_read_b128 v[144:147], v24 offset:8192
    v_exp_f32 v73, v73
    v_exp_f32 v74, v74
    v_smfmac_f32_32x32x32_bf16 v[176:191], v[156:159], v[120:127], v204
    v_exp_f32 v75, v75
    v_exp_f32 v76, v76
    v_exp_f32 v77, v77
    v_smfmac_f32_16x16x64_bf16 v[196:199], v[200:203], v[120:127], v204
    ds_read_b128 v[148:151], v24 offset:9216
    v_exp_f32 v78, v78
    v_exp_f32 v79, v79
    v_mfma_f32_32x32x16_bf16 v[96:111], v[136:139], v[8:11], 0
    v_exp_f32 v80, v80
    v_exp_f32 v81, v81
    v_exp_f32 v82, v82
    v_mfma_f32_32x32x16_bf16 v[96:111], v[140:143], v[12:15], v[96:111]
    s_waitcnt lgkmcnt(1)
    v_exp_f32 v83, v83
    v_exp_f32 v84, v84
    v_exp_f32 v85, v85
    v_smfmac_f32_32x32x32_bf16 v[160:175], v[144:147], v[64:71], v204
    s_waitcnt lgkmcnt(0)
    v_exp_f32 v86, v86
    v_exp_f32 v87, v87
    v_exp_f32 v88, v88
    v_smfmac_f32_16x16x64_bf16 v[192:195], v[200:203], v[64:71], v204
    ds_read_b128 v[128:131], v24 offset:4096
    v_exp_f32 v89, v89
    v_exp_f32 v90, v90
    v_smfmac_f32_32x32x32_bf16 v[160:175], v[148:151], v[72:79], v204
    v_exp_f32 v91, v91
    v_exp_f32 v92, v92
    v_exp_f32 v93, v93
    v_smfmac_f32_16x16x64_bf16 v[192:195], v[200:203], v[72:79], v204
    ds_read_b128 v[132:135], v24 offset:5120
    v_exp_f32 v94, v94
    v_exp_f32 v95, v95
    v_mfma_f32_32x32x16_bf16 v[112:127], v[136:139], v[16:19], 0
    v_exp_f32 v96, v96
    v_exp_f32 v97, v97
    v_exp_f32 v98, v98
    v_mfma_f32_32x32x16_bf16 v[112:127], v[140:143], v[20:23], v[112:127]
    v_exp_f32 v99, v99
    v_exp_f32 v100, v100
    v_exp_f32 v101, v101
    v_smfmac_f32_32x32x32_bf16 v[176:191], v[144:147], v[80:87], v204
    s_waitcnt lgkmcnt(0)
    v_exp_f32 v102, v102
    v_exp_f32 v103, v103
    v_exp_f32 v104, v104
    v_smfmac_f32_16x16x64_bf16 v[196:199], v[200:203], v[80:87], v204
    ds_read_b128 v[152:155], v24 offset:10240
    v_exp_f32 v105, v105
    v_exp_f32 v106, v106
    v_smfmac_f32_32x32x32_bf16 v[176:191], v[148:151], v[88:95], v204
    v_exp_f32 v107, v107
    v_exp_f32 v108, v108
    v_exp_f32 v109, v109
    v_smfmac_f32_16x16x64_bf16 v[196:199], v[200:203], v[88:95], v204
    ds_read_b128 v[156:159], v24 offset:11264
    v_exp_f32 v110, v110
    v_exp_f32 v111, v111
    v_mfma_f32_32x32x16_bf16 v[64:79], v[128:131], v[8:11], 0
    v_exp_f32 v112, v112
    v_exp_f32 v113, v113
    v_exp_f32 v114, v114
    v_mfma_f32_32x32x16_bf16 v[64:79], v[132:135], v[12:15], v[64:79]
    s_waitcnt lgkmcnt(1)
    v_exp_f32 v115, v115
    v_exp_f32 v116, v116
    v_exp_f32 v117, v117
    v_smfmac_f32_32x32x32_bf16 v[160:175], v[152:155], v[96:103], v204
    s_waitcnt lgkmcnt(0)
    v_exp_f32 v118, v118
    v_exp_f32 v119, v119
    v_exp_f32 v120, v120
    v_smfmac_f32_16x16x64_bf16 v[192:195], v[200:203], v[96:103], v204
    ds_read_b128 v[136:139], v24 offset:6144
    v_exp_f32 v121, v121
    v_exp_f32 v122, v122
    v_smfmac_f32_32x32x32_bf16 v[160:175], v[156:159], v[104:111], v204
    v_exp_f32 v123, v123
    v_exp_f32 v124, v124
    v_exp_f32 v125, v125
    v_smfmac_f32_16x16x64_bf16 v[192:195], v[200:203], v[104:111], v204
    ds_read_b128 v[140:143], v24 offset:7168
    v_exp_f32 v126, v126
    v_exp_f32 v127, v127
    v_mfma_f32_32x32x16_bf16 v[80:95], v[128:131], v[16:19], 0
    s_cmp_eq_u32 s54, 4
    v_exp_f32 v64, v64
    v_exp_f32 v65, v65
    v_exp_f32 v66, v66
    v_mfma_f32_32x32x16_bf16 v[80:95], v[132:135], v[20:23], v[80:95]
    v_exp_f32 v67, v67
    v_exp_f32 v68, v68
    v_exp_f32 v69, v69
    v_smfmac_f32_32x32x32_bf16 v[176:191], v[152:155], v[112:119], v204
    s_waitcnt lgkmcnt(0)
    v_exp_f32 v70, v70
    v_exp_f32 v71, v71
    v_exp_f32 v72, v72
    v_smfmac_f32_16x16x64_bf16 v[196:199], v[200:203], v[112:119], v204
    ds_read_b128 v[144:147], v24 offset:12288
    v_exp_f32 v73, v73
    v_exp_f32 v74, v74
    v_smfmac_f32_32x32x32_bf16 v[176:191], v[156:159], v[120:127], v204
    v_exp_f32 v75, v75
    v_exp_f32 v76, v76
    v_exp_f32 v77, v77
    v_smfmac_f32_16x16x64_bf16 v[196:199], v[200:203], v[120:127], v204
    ds_read_b128 v[148:151], v24 offset:13312
    v_exp_f32 v78, v78
    v_exp_f32 v79, v79
    v_mfma_f32_32x32x16_bf16 v[96:111], v[136:139], v[8:11], 0
    s_cbranch_scc1 c_attn_nobar
    s_barrier
c_attn_nobar:
    v_exp_f32 v80, v80
    v_exp_f32 v81, v81
    v_exp_f32 v82, v82
    v_mfma_f32_32x32x16_bf16 v[96:111], v[140:143], v[12:15], v[96:111]
    s_waitcnt lgkmcnt(1)
    v_exp_f32 v83, v83
    v_exp_f32 v84, v84
    v_exp_f32 v85, v85
    v_smfmac_f32_32x32x32_bf16 v[160:175], v[144:147], v[64:71], v204
    s_waitcnt lgkmcnt(0)
    v_exp_f32 v86, v86
    v_exp_f32 v87, v87
    v_exp_f32 v88, v88
    v_smfmac_f32_16x16x64_bf16 v[192:195], v[200:203], v[64:71], v204
    ds_read_b128 v[128:131], v24 offset:16384
    v_exp_f32 v89, v89
    v_exp_f32 v90, v90
    v_smfmac_f32_32x32x32_bf16 v[160:175], v[148:151], v[72:79], v204
    v_exp_f32 v91, v91
    v_exp_f32 v92, v92
    v_exp_f32 v93, v93
    v_smfmac_f32_16x16x64_bf16 v[192:195], v[200:203], v[72:79], v204
    ds_read_b128 v[132:135], v24 offset:17408
    v_exp_f32 v94, v94
    v_exp_f32 v95, v95
    v_mfma_f32_32x32x16_bf16 v[112:127], v[136:139], v[16:19], 0
    v_exp_f32 v96, v96
    v_exp_f32 v97, v97
    v_exp_f32 v98, v98
    v_mfma_f32_32x32x16_bf16 v[112:127], v[140:143], v[20:23], v[112:127]
    v_exp_f32 v99, v99
    v_exp_f32 v100, v100
    v_exp_f32 v101, v101
    v_smfmac_f32_32x32x32_bf16 v[176:191], v[144:147], v[80:87], v204
    s_waitcnt lgkmcnt(0)
    v_exp_f32 v102, v102
    v_exp_f32 v103, v103
    v_exp_f32 v104, v104
    v_smfmac_f32_16x16x64_bf16 v[196:199], v[200:203], v[80:87], v204
    ds_read_b128 v[152:155], v24 offset:14336
    v_exp_f32 v105, v105
    v_exp_f32 v106, v106
    v_smfmac_f32_32x32x32_bf16 v[176:191], v[148:151], v[88:95], v204
    v_exp_f32 v107, v107
    v_exp_f32 v108, v108
    v_exp_f32 v109, v109
    v_smfmac_f32_16x16x64_bf16 v[196:199], v[200:203], v[88:95], v204
    ds_read_b128 v[156:159], v24 offset:15360
    v_exp_f32 v110, v110
    v_exp_f32 v111, v111
    v_mfma_f32_32x32x16_bf16 v[64:79], v[128:131], v[8:11], 0
    v_exp_f32 v112, v112
    v_exp_f32 v113, v113
    v_exp_f32 v114, v114
    v_mfma_f32_32x32x16_bf16 v[64:79], v[132:135], v[12:15], v[64:79]
    s_waitcnt lgkmcnt(1)
    v_exp_f32 v115, v115
    v_exp_f32 v116, v116
    v_exp_f32 v117, v117
    v_smfmac_f32_32x32x32_bf16 v[160:175], v[152:155], v[96:103], v204
    s_waitcnt lgkmcnt(0)
    v_exp_f32 v118, v118
    v_exp_f32 v119, v119
    v_exp_f32 v120, v120
    v_smfmac_f32_16x16x64_bf16 v[192:195], v[200:203], v[96:103], v204
    ds_read_b128 v[136:139], v24 offset:18432
    v_exp_f32 v121, v121
    v_exp_f32 v122, v122
    v_smfmac_f32_32x32x32_bf16 v[160:175], v[156:159], v[104:111], v204
    v_exp_f32 v123, v123
    v_exp_f32 v124, v124
    v_exp_f32 v125, v125
    v_smfmac_f32_16x16x64_bf16 v[192:195], v[200:203], v[104:111], v204
    ds_read_b128 v[140:143], v24 offset:19456
    v_exp_f32 v126, v126
    v_exp_f32 v127, v127
    v_mfma_f32_32x32x16_bf16 v[80:95], v[128:131], v[16:19], 0
    v_exp_f32 v64, v64
    v_exp_f32 v65, v65
    v_exp_f32 v66, v66
    v_mfma_f32_32x32x16_bf16 v[80:95], v[132:135], v[20:23], v[80:95]
    v_exp_f32 v67, v67
    v_exp_f32 v68, v68
    v_exp_f32 v69, v69
    v_smfmac_f32_32x32x32_bf16 v[176:191], v[152:155], v[112:119], v204
    s_waitcnt lgkmcnt(0)
    v_exp_f32 v70, v70
    v_exp_f32 v71, v71
    v_exp_f32 v72, v72
    v_smfmac_f32_16x16x64_bf16 v[196:199], v[200:203], v[112:119], v204
    ds_read_b128 v[144:147], v24 offset:24576
    v_exp_f32 v73, v73
    v_exp_f32 v74, v74
    v_smfmac_f32_32x32x32_bf16 v[176:191], v[156:159], v[120:127], v204
    v_exp_f32 v75, v75
    v_exp_f32 v76, v76
    v_exp_f32 v77, v77
    v_smfmac_f32_16x16x64_bf16 v[196:199], v[200:203], v[120:127], v204
    ds_read_b128 v[148:151], v24 offset:25600
    v_exp_f32 v78, v78
    v_exp_f32 v79, v79
    v_mfma_f32_32x32x16_bf16 v[96:111], v[136:139], v[8:11], 0
    v_exp_f32 v80, v80
    v_exp_f32 v81, v81
    v_exp_f32 v82, v82
    v_mfma_f32_32x32x16_bf16 v[96:111], v[140:143], v[12:15], v[96:111]
    s_waitcnt lgkmcnt(1)
    v_exp_f32 v83, v83
    v_exp_f32 v84, v84
    v_exp_f32 v85, v85
    v_smfmac_f32_32x32x32_bf16 v[160:175], v[144:147], v[64:71], v204
    s_waitcnt lgkmcnt(0)
    v_exp_f32 v86, v86
    v_exp_f32 v87, v87
    v_exp_f32 v88, v88
    v_smfmac_f32_16x16x64_bf16 v[192:195], v[200:203], v[64:71], v204
    ds_read_b128 v[128:131], v24 offset:20480
    v_exp_f32 v89, v89
    v_exp_f32 v90, v90
    v_smfmac_f32_32x32x32_bf16 v[160:175], v[148:151], v[72:79], v204
    v_exp_f32 v91, v91
    v_exp_f32 v92, v92
    v_exp_f32 v93, v93
    v_smfmac_f32_16x16x64_bf16 v[192:195], v[200:203], v[72:79], v204
    ds_read_b128 v[132:135], v24 offset:21504
    v_exp_f32 v94, v94
    v_exp_f32 v95, v95
    v_mfma_f32_32x32x16_bf16 v[112:127], v[136:139], v[16:19], 0
    v_exp_f32 v96, v96
    v_exp_f32 v97, v97
    v_exp_f32 v98, v98
    v_mfma_f32_32x32x16_bf16 v[112:127], v[140:143], v[20:23], v[112:127]
    v_exp_f32 v99, v99
    v_exp_f32 v100, v100
    v_exp_f32 v101, v101
    v_smfmac_f32_32x32x32_bf16 v[176:191], v[144:147], v[80:87], v204
    s_waitcnt lgkmcnt(0)
    v_exp_f32 v102, v102
    v_exp_f32 v103, v103
    v_exp_f32 v104, v104
    v_smfmac_f32_16x16x64_bf16 v[196:199], v[200:203], v[80:87], v204
    ds_read_b128 v[152:155], v24 offset:26624
    v_exp_f32 v105, v105
    v_exp_f32 v106, v106
    v_smfmac_f32_32x32x32_bf16 v[176:191], v[148:151], v[88:95], v204
    v_exp_f32 v107, v107
    v_exp_f32 v108, v108
    v_exp_f32 v109, v109
    v_smfmac_f32_16x16x64_bf16 v[196:199], v[200:203], v[88:95], v204
    ds_read_b128 v[156:159], v24 offset:27648
    v_exp_f32 v110, v110
    v_exp_f32 v111, v111
    v_mfma_f32_32x32x16_bf16 v[64:79], v[128:131], v[8:11], 0
    v_exp_f32 v112, v112
    v_exp_f32 v113, v113
    v_exp_f32 v114, v114
    v_mfma_f32_32x32x16_bf16 v[64:79], v[132:135], v[12:15], v[64:79]
    s_waitcnt lgkmcnt(1)
    v_exp_f32 v115, v115
    v_exp_f32 v116, v116
    v_exp_f32 v117, v117
    v_smfmac_f32_32x32x32_bf16 v[160:175], v[152:155], v[96:103], v204
    s_waitcnt lgkmcnt(0)
    v_exp_f32 v118, v118
    v_exp_f32 v119, v119
    v_exp_f32 v120, v120
    v_smfmac_f32_16x16x64_bf16 v[192:195], v[200:203], v[96:103], v204
    ds_read_b128 v[136:139], v24 offset:22528
    v_exp_f32 v121, v121
    v_exp_f32 v122, v122
    v_smfmac_f32_32x32x32_bf16 v[160:175], v[156:159], v[104:111], v204
    v_exp_f32 v123, v123
    v_exp_f32 v124, v124
    v_exp_f32 v125, v125
    v_smfmac_f32_16x16x64_bf16 v[192:195], v[200:203], v[104:111], v204
    ds_read_b128 v[140:143], v24 offset:23552
    v_exp_f32 v126, v126
    v_exp_f32 v127, v127
    v_mfma_f32_32x32x16_bf16 v[80:95], v[128:131], v[16:19], 0
    v_exp_f32 v64, v64
    v_exp_f32 v65, v65
    v_exp_f32 v66, v66
    v_mfma_f32_32x32x16_bf16 v[80:95], v[132:135], v[20:23], v[80:95]
    v_exp_f32 v67, v67
    v_exp_f32 v68, v68
    v_exp_f32 v69, v69
    v_smfmac_f32_32x32x32_bf16 v[176:191], v[152:155], v[112:119], v204
    s_waitcnt lgkmcnt(0)
    v_exp_f32 v70, v70
    v_exp_f32 v71, v71
    v_exp_f32 v72, v72
    v_smfmac_f32_16x16x64_bf16 v[196:199], v[200:203], v[112:119], v204
    ds_read_b128 v[144:147], v24 offset:28672
    v_exp_f32 v73, v73
    v_exp_f32 v74, v74
    v_smfmac_f32_32x32x32_bf16 v[176:191], v[156:159], v[120:127], v204
    v_exp_f32 v75, v75
    v_exp_f32 v76, v76
    v_exp_f32 v77, v77
    v_smfmac_f32_16x16x64_bf16 v[196:199], v[200:203], v[120:127], v204
    ds_read_b128 v[148:151], v24 offset:29696
    v_exp_f32 v78, v78
    v_exp_f32 v79, v79
    v_mfma_f32_32x32x16_bf16 v[96:111], v[136:139], v[8:11], 0
    s_barrier
    v_exp_f32 v80, v80
    v_exp_f32 v81, v81
    v_exp_f32 v82, v82
    v_mfma_f32_32x32x16_bf16 v[96:111], v[140:143], v[12:15], v[96:111]
    s_waitcnt lgkmcnt(1)
    v_exp_f32 v83, v83
    v_exp_f32 v84, v84
    v_exp_f32 v85, v85
    v_smfmac_f32_32x32x32_bf16 v[160:175], v[144:147], v[64:71], v204
    s_waitcnt lgkmcnt(0)
    v_exp_f32 v86, v86
    v_exp_f32 v87, v87
    v_exp_f32 v88, v88
    v_smfmac_f32_16x16x64_bf16 v[192:195], v[200:203], v[64:71], v204
    ds_read_b128 v[128:131], v24 offset:32768
    v_exp_f32 v89, v89
    v_exp_f32 v90, v90
    v_smfmac_f32_32x32x32_bf16 v[160:175], v[148:151], v[72:79], v204
    v_exp_f32 v91, v91
    v_exp_f32 v92, v92
    v_exp_f32 v93, v93
    v_smfmac_f32_16x16x64_bf16 v[192:195], v[200:203], v[72:79], v204
    ds_read_b128 v[132:135], v24 offset:33792
    v_exp_f32 v94, v94
    v_exp_f32 v95, v95
    v_mfma_f32_32x32x16_bf16 v[112:127], v[136:139], v[16:19], 0
    v_exp_f32 v96, v96
    v_exp_f32 v97, v97
    v_exp_f32 v98, v98
    v_mfma_f32_32x32x16_bf16 v[112:127], v[140:143], v[20:23], v[112:127]
    v_exp_f32 v99, v99
    v_exp_f32 v100, v100
    v_exp_f32 v101, v101
    v_smfmac_f32_32x32x32_bf16 v[176:191], v[144:147], v[80:87], v204
    s_waitcnt lgkmcnt(0)
    v_exp_f32 v102, v102
    v_exp_f32 v103, v103
    v_exp_f32 v104, v104
    v_smfmac_f32_16x16x64_bf16 v[196:199], v[200:203], v[80:87], v204
    ds_read_b128 v[152:155], v24 offset:30720
    v_exp_f32 v105, v105
    v_exp_f32 v106, v106
    v_smfmac_f32_32x32x32_bf16 v[176:191], v[148:151], v[88:95], v204
    v_exp_f32 v107, v107
    v_exp_f32 v108, v108
    v_exp_f32 v109, v109
    v_smfmac_f32_16x16x64_bf16 v[196:199], v[200:203], v[88:95], v204
    ds_read_b128 v[156:159], v24 offset:31744
    v_exp_f32 v110, v110
    v_exp_f32 v111, v111
    v_mfma_f32_32x32x16_bf16 v[64:79], v[128:131], v[8:11], 0
    v_exp_f32 v112, v112
    v_exp_f32 v113, v113
    v_exp_f32 v114, v114
    v_mfma_f32_32x32x16_bf16 v[64:79], v[132:135], v[12:15], v[64:79]
    s_waitcnt lgkmcnt(1)
    v_exp_f32 v115, v115
    v_exp_f32 v116, v116
    v_exp_f32 v117, v117
    v_smfmac_f32_32x32x32_bf16 v[160:175], v[152:155], v[96:103], v204
    s_waitcnt lgkmcnt(0)
    v_exp_f32 v118, v118
    v_exp_f32 v119, v119
    v_exp_f32 v120, v120
    v_smfmac_f32_16x16x64_bf16 v[192:195], v[200:203], v[96:103], v204
    ds_read_b128 v[136:139], v24 offset:34816
    v_exp_f32 v121, v121
    v_exp_f32 v122, v122
    v_smfmac_f32_32x32x32_bf16 v[160:175], v[156:159], v[104:111], v204
    v_exp_f32 v123, v123
    v_exp_f32 v124, v124
    v_exp_f32 v125, v125
    v_smfmac_f32_16x16x64_bf16 v[192:195], v[200:203], v[104:111], v204
    ds_read_b128 v[140:143], v24 offset:35840
    v_exp_f32 v126, v126
    v_exp_f32 v127, v127
    v_mfma_f32_32x32x16_bf16 v[80:95], v[128:131], v[16:19], 0
    v_exp_f32 v64, v64
    v_exp_f32 v65, v65
    v_exp_f32 v66, v66
    v_mfma_f32_32x32x16_bf16 v[80:95], v[132:135], v[20:23], v[80:95]
    v_exp_f32 v67, v67
    v_exp_f32 v68, v68
    v_exp_f32 v69, v69
    v_smfmac_f32_32x32x32_bf16 v[176:191], v[152:155], v[112:119], v204
    s_waitcnt lgkmcnt(0)
    v_exp_f32 v70, v70
    v_exp_f32 v71, v71
    v_exp_f32 v72, v72
    v_smfmac_f32_16x16x64_bf16 v[196:199], v[200:203], v[112:119], v204
    ds_read_b128 v[144:147], v24 offset:40960
    v_exp_f32 v73, v73
    v_exp_f32 v74, v74
    v_smfmac_f32_32x32x32_bf16 v[176:191], v[156:159], v[120:127], v204
    v_exp_f32 v75, v75
    v_exp_f32 v76, v76
    v_exp_f32 v77, v77
    v_smfmac_f32_16x16x64_bf16 v[196:199], v[200:203], v[120:127], v204
    ds_read_b128 v[148:151], v24 offset:41984
    v_exp_f32 v78, v78
    v_exp_f32 v79, v79
    v_mfma_f32_32x32x16_bf16 v[96:111], v[136:139], v[8:11], 0
    v_exp_f32 v80, v80
    v_exp_f32 v81, v81
    v_exp_f32 v82, v82
    v_mfma_f32_32x32x16_bf16 v[96:111], v[140:143], v[12:15], v[96:111]
    s_waitcnt lgkmcnt(1)
    v_exp_f32 v83, v83
    v_exp_f32 v84, v84
    v_exp_f32 v85, v85
    v_smfmac_f32_32x32x32_bf16 v[160:175], v[144:147], v[64:71], v204
    s_waitcnt lgkmcnt(0)
    v_exp_f32 v86, v86
    v_exp_f32 v87, v87
    v_exp_f32 v88, v88
    v_smfmac_f32_16x16x64_bf16 v[192:195], v[200:203], v[64:71], v204
    ds_read_b128 v[128:131], v24 offset:36864
    v_exp_f32 v89, v89
    v_exp_f32 v90, v90
    v_smfmac_f32_32x32x32_bf16 v[160:175], v[148:151], v[72:79], v204
    v_exp_f32 v91, v91
    v_exp_f32 v92, v92
    v_exp_f32 v93, v93
    v_smfmac_f32_16x16x64_bf16 v[192:195], v[200:203], v[72:79], v204
    ds_read_b128 v[132:135], v24 offset:37888
    v_exp_f32 v94, v94
    v_exp_f32 v95, v95
    v_mfma_f32_32x32x16_bf16 v[112:127], v[136:139], v[16:19], 0
    v_exp_f32 v96, v96
    v_exp_f32 v97, v97
    v_exp_f32 v98, v98
    v_mfma_f32_32x32x16_bf16 v[112:127], v[140:143], v[20:23], v[112:127]
    v_exp_f32 v99, v99
    v_exp_f32 v100, v100
    v_exp_f32 v101, v101
    v_smfmac_f32_32x32x32_bf16 v[176:191], v[144:147], v[80:87], v204
    s_waitcnt lgkmcnt(0)
    v_exp_f32 v102, v102
    v_exp_f32 v103, v103
    v_exp_f32 v104, v104
    v_smfmac_f32_16x16x64_bf16 v[196:199], v[200:203], v[80:87], v204
    ds_read_b128 v[152:155], v24 offset:43008
    v_exp_f32 v105, v105
    v_exp_f32 v106, v106
    v_smfmac_f32_32x32x32_bf16 v[176:191], v[148:151], v[88:95], v204
    v_exp_f32 v107, v107
    v_exp_f32 v108, v108
    v_exp_f32 v109, v109
    v_smfmac_f32_16x16x64_bf16 v[196:199], v[200:203], v[88:95], v204
    ds_read_b128 v[156:159], v24 offset:44032
    v_exp_f32 v110, v110
    v_exp_f32 v111, v111
    v_mfma_f32_32x32x16_bf16 v[64:79], v[128:131], v[8:11], 0
    v_exp_f32 v112, v112
    v_exp_f32 v113, v113
    v_exp_f32 v114, v114
    v_mfma_f32_32x32x16_bf16 v[64:79], v[132:135], v[12:15], v[64:79]
    s_waitcnt lgkmcnt(1)
    v_exp_f32 v115, v115
    v_exp_f32 v116, v116
    v_exp_f32 v117, v117
    v_smfmac_f32_32x32x32_bf16 v[160:175], v[152:155], v[96:103], v204
    s_waitcnt lgkmcnt(0)
    v_exp_f32 v118, v118
    v_exp_f32 v119, v119
    v_exp_f32 v120, v120
    v_smfmac_f32_16x16x64_bf16 v[192:195], v[200:203], v[96:103], v204
    ds_read_b128 v[136:139], v24 offset:38912
    v_exp_f32 v121, v121
    v_exp_f32 v122, v122
    v_smfmac_f32_32x32x32_bf16 v[160:175], v[156:159], v[104:111], v204
    v_exp_f32 v123, v123
    v_exp_f32 v124, v124
    v_exp_f32 v125, v125
    v_smfmac_f32_16x16x64_bf16 v[192:195], v[200:203], v[104:111], v204
    ds_read_b128 v[140:143], v24 offset:39936
    v_exp_f32 v126, v126
    v_exp_f32 v127, v127
    v_mfma_f32_32x32x16_bf16 v[80:95], v[128:131], v[16:19], 0
    v_exp_f32 v64, v64
    v_exp_f32 v65, v65
    v_exp_f32 v66, v66
    v_mfma_f32_32x32x16_bf16 v[80:95], v[132:135], v[20:23], v[80:95]
    v_exp_f32 v67, v67
    v_exp_f32 v68, v68
    v_exp_f32 v69, v69
    v_smfmac_f32_32x32x32_bf16 v[176:191], v[152:155], v[112:119], v204
    s_waitcnt lgkmcnt(0)
    v_exp_f32 v70, v70
    v_exp_f32 v71, v71
    v_exp_f32 v72, v72
    v_smfmac_f32_16x16x64_bf16 v[196:199], v[200:203], v[112:119], v204
    ds_read_b128 v[144:147], v24 offset:45056
    v_exp_f32 v73, v73
    v_exp_f32 v74, v74
    v_smfmac_f32_32x32x32_bf16 v[176:191], v[156:159], v[120:127], v204
    v_exp_f32 v75, v75
    v_exp_f32 v76, v76
    v_exp_f32 v77, v77
    v_smfmac_f32_16x16x64_bf16 v[196:199], v[200:203], v[120:127], v204
    ds_read_b128 v[148:151], v24 offset:46080
    v_exp_f32 v78, v78
    v_exp_f32 v79, v79
    v_mfma_f32_32x32x16_bf16 v[96:111], v[136:139], v[8:11], 0
    s_barrier
    v_exp_f32 v80, v80
    v_exp_f32 v81, v81
    v_exp_f32 v82, v82
    v_mfma_f32_32x32x16_bf16 v[96:111], v[140:143], v[12:15], v[96:111]
    s_waitcnt lgkmcnt(1)
    v_exp_f32 v83, v83
    v_exp_f32 v84, v84
    v_exp_f32 v85, v85
    v_smfmac_f32_32x32x32_bf16 v[160:175], v[144:147], v[64:71], v204
    s_waitcnt lgkmcnt(0)
    v_exp_f32 v86, v86
    v_exp_f32 v87, v87
    v_exp_f32 v88, v88
    v_smfmac_f32_16x16x64_bf16 v[192:195], v[200:203], v[64:71], v204
    ds_read_b128 v[128:131], v24 offset:49152
    v_exp_f32 v89, v89
    v_exp_f32 v90, v90
    v_smfmac_f32_32x32x32_bf16 v[160:175], v[148:151], v[72:79], v204
    v_exp_f32 v91, v91
    v_exp_f32 v92, v92
    v_exp_f32 v93, v93
    v_smfmac_f32_16x16x64_bf16 v[192:195], v[200:203], v[72:79], v204
    ds_read_b128 v[132:135], v24 offset:50176
    v_exp_f32 v94, v94
    v_exp_f32 v95, v95
    v_mfma_f32_32x32x16_bf16 v[112:127], v[136:139], v[16:19], 0
    v_exp_f32 v96, v96
    v_exp_f32 v97, v97
    v_exp_f32 v98, v98
    v_mfma_f32_32x32x16_bf16 v[112:127], v[140:143], v[20:23], v[112:127]
    v_exp_f32 v99, v99
    v_exp_f32 v100, v100
    v_exp_f32 v101, v101
    v_smfmac_f32_32x32x32_bf16 v[176:191], v[144:147], v[80:87], v204
    s_waitcnt lgkmcnt(0)
    v_exp_f32 v102, v102
    v_exp_f32 v103, v103
    v_exp_f32 v104, v104
    v_smfmac_f32_16x16x64_bf16 v[196:199], v[200:203], v[80:87], v204
    ds_read_b128 v[152:155], v24 offset:47104
    v_exp_f32 v105, v105
    v_exp_f32 v106, v106
    v_smfmac_f32_32x32x32_bf16 v[176:191], v[148:151], v[88:95], v204
    v_exp_f32 v107, v107
    v_exp_f32 v108, v108
    v_exp_f32 v109, v109
    v_smfmac_f32_16x16x64_bf16 v[196:199], v[200:203], v[88:95], v204
    ds_read_b128 v[156:159], v24 offset:48128
    v_exp_f32 v110, v110
    v_exp_f32 v111, v111
    v_mfma_f32_32x32x16_bf16 v[64:79], v[128:131], v[8:11], 0
    v_exp_f32 v112, v112
    v_exp_f32 v113, v113
    v_exp_f32 v114, v114
    v_mfma_f32_32x32x16_bf16 v[64:79], v[132:135], v[12:15], v[64:79]
    s_waitcnt lgkmcnt(1)
    v_exp_f32 v115, v115
    v_exp_f32 v116, v116
    v_exp_f32 v117, v117
    v_smfmac_f32_32x32x32_bf16 v[160:175], v[152:155], v[96:103], v204
    s_waitcnt lgkmcnt(0)
    v_exp_f32 v118, v118
    v_exp_f32 v119, v119
    v_exp_f32 v120, v120
    v_smfmac_f32_16x16x64_bf16 v[192:195], v[200:203], v[96:103], v204
    ds_read_b128 v[136:139], v24 offset:51200
    v_exp_f32 v121, v121
    v_exp_f32 v122, v122
    v_smfmac_f32_32x32x32_bf16 v[160:175], v[156:159], v[104:111], v204
    v_exp_f32 v123, v123
    v_exp_f32 v124, v124
    v_exp_f32 v125, v125
    v_smfmac_f32_16x16x64_bf16 v[192:195], v[200:203], v[104:111], v204
    ds_read_b128 v[140:143], v24 offset:52224
    v_exp_f32 v126, v126
    v_exp_f32 v127, v127
    v_mfma_f32_32x32x16_bf16 v[80:95], v[128:131], v[16:19], 0
    v_exp_f32 v64, v64
    v_exp_f32 v65, v65
    v_exp_f32 v66, v66
    v_mfma_f32_32x32x16_bf16 v[80:95], v[132:135], v[20:23], v[80:95]
    v_exp_f32 v67, v67
    v_exp_f32 v68, v68
    v_exp_f32 v69, v69
    v_smfmac_f32_32x32x32_bf16 v[176:191], v[152:155], v[112:119], v204
    s_waitcnt lgkmcnt(0)
    v_exp_f32 v70, v70
    v_exp_f32 v71, v71
    v_exp_f32 v72, v72
    v_smfmac_f32_16x16x64_bf16 v[196:199], v[200:203], v[112:119], v204
    ds_read_b128 v[144:147], v24 offset:57344
    v_exp_f32 v73, v73
    v_exp_f32 v74, v74
    v_smfmac_f32_32x32x32_bf16 v[176:191], v[156:159], v[120:127], v204
    v_exp_f32 v75, v75
    v_exp_f32 v76, v76
    v_exp_f32 v77, v77
    v_smfmac_f32_16x16x64_bf16 v[196:199], v[200:203], v[120:127], v204
    ds_read_b128 v[148:151], v24 offset:58368
    v_exp_f32 v78, v78
    v_exp_f32 v79, v79
    v_mfma_f32_32x32x16_bf16 v[96:111], v[136:139], v[8:11], 0
    v_exp_f32 v80, v80
    v_exp_f32 v81, v81
    v_exp_f32 v82, v82
    v_mfma_f32_32x32x16_bf16 v[96:111], v[140:143], v[12:15], v[96:111]
    s_waitcnt lgkmcnt(1)
    v_exp_f32 v83, v83
    v_exp_f32 v84, v84
    v_exp_f32 v85, v85
    v_smfmac_f32_32x32x32_bf16 v[160:175], v[144:147], v[64:71], v204
    s_waitcnt lgkmcnt(0)
    v_exp_f32 v86, v86
    v_exp_f32 v87, v87
    v_exp_f32 v88, v88
    v_smfmac_f32_16x16x64_bf16 v[192:195], v[200:203], v[64:71], v204
    ds_read_b128 v[128:131], v24 offset:53248
    v_exp_f32 v89, v89
    v_exp_f32 v90, v90
    v_smfmac_f32_32x32x32_bf16 v[160:175], v[148:151], v[72:79], v204
    v_exp_f32 v91, v91
    v_exp_f32 v92, v92
    v_exp_f32 v93, v93
    v_smfmac_f32_16x16x64_bf16 v[192:195], v[200:203], v[72:79], v204
    ds_read_b128 v[132:135], v24 offset:54272
    v_exp_f32 v94, v94
    v_exp_f32 v95, v95
    v_mfma_f32_32x32x16_bf16 v[112:127], v[136:139], v[16:19], 0
    v_exp_f32 v96, v96
    v_exp_f32 v97, v97
    v_exp_f32 v98, v98
    v_mfma_f32_32x32x16_bf16 v[112:127], v[140:143], v[20:23], v[112:127]
    v_exp_f32 v99, v99
    v_exp_f32 v100, v100
    v_exp_f32 v101, v101
    v_smfmac_f32_32x32x32_bf16 v[176:191], v[144:147], v[80:87], v204
    s_waitcnt lgkmcnt(0)
    v_exp_f32 v102, v102
    v_exp_f32 v103, v103
    v_exp_f32 v104, v104
    v_smfmac_f32_16x16x64_bf16 v[196:199], v[200:203], v[80:87], v204
    ds_read_b128 v[152:155], v24 offset:59392
    v_exp_f32 v105, v105
    v_exp_f32 v106, v106
    v_smfmac_f32_32x32x32_bf16 v[176:191], v[148:151], v[88:95], v204
    v_exp_f32 v107, v107
    v_exp_f32 v108, v108
    v_exp_f32 v109, v109
    v_smfmac_f32_16x16x64_bf16 v[196:199], v[200:203], v[88:95], v204
    ds_read_b128 v[156:159], v24 offset:60416
    v_exp_f32 v110, v110
    v_exp_f32 v111, v111
    v_mfma_f32_32x32x16_bf16 v[64:79], v[128:131], v[8:11], 0
    v_exp_f32 v112, v112
    v_exp_f32 v113, v113
    v_exp_f32 v114, v114
    v_mfma_f32_32x32x16_bf16 v[64:79], v[132:135], v[12:15], v[64:79]
    s_waitcnt lgkmcnt(1)
    v_exp_f32 v115, v115
    v_exp_f32 v116, v116
    v_exp_f32 v117, v117
    v_smfmac_f32_32x32x32_bf16 v[160:175], v[152:155], v[96:103], v204
    s_waitcnt lgkmcnt(0)
    v_exp_f32 v118, v118
    v_exp_f32 v119, v119
    v_exp_f32 v120, v120
    v_smfmac_f32_16x16x64_bf16 v[192:195], v[200:203], v[96:103], v204
    ds_read_b128 v[136:139], v24 offset:55296
    v_exp_f32 v121, v121
    v_exp_f32 v122, v122
    v_smfmac_f32_32x32x32_bf16 v[160:175], v[156:159], v[104:111], v204
    v_exp_f32 v123, v123
    v_exp_f32 v124, v124
    v_exp_f32 v125, v125
    v_smfmac_f32_16x16x64_bf16 v[192:195], v[200:203], v[104:111], v204
    ds_read_b128 v[140:143], v24 offset:56320
    v_exp_f32 v126, v126
    v_exp_f32 v127, v127
    v_mfma_f32_32x32x16_bf16 v[80:95], v[128:131], v[16:19], 0
    v_exp_f32 v64, v64
    v_exp_f32 v65, v65
    v_exp_f32 v66, v66
    v_mfma_f32_32x32x16_bf16 v[80:95], v[132:135], v[20:23], v[80:95]
    v_exp_f32 v67, v67
    v_exp_f32 v68, v68
    v_exp_f32 v69, v69
    v_smfmac_f32_32x32x32_bf16 v[176:191], v[152:155], v[112:119], v204
    s_waitcnt lgkmcnt(0)
    v_exp_f32 v70, v70
    v_exp_f32 v71, v71
    v_exp_f32 v72, v72
    v_smfmac_f32_16x16x64_bf16 v[196:199], v[200:203], v[112:119], v204
    ds_read_b128 v[144:147], v24 offset:61440
    v_exp_f32 v73, v73
    v_exp_f32 v74, v74
    v_smfmac_f32_32x32x32_bf16 v[176:191], v[156:159], v[120:127], v204
    v_exp_f32 v75, v75
    v_exp_f32 v76, v76
    v_exp_f32 v77, v77
    v_smfmac_f32_16x16x64_bf16 v[196:199], v[200:203], v[120:127], v204
    ds_read_b128 v[148:151], v24 offset:62464
    v_exp_f32 v78, v78
    v_exp_f32 v79, v79
    v_mfma_f32_32x32x16_bf16 v[96:111], v[136:139], v[8:11], 0
    s_barrier
    v_exp_f32 v80, v80
    v_exp_f32 v81, v81
    v_exp_f32 v82, v82
    v_mfma_f32_32x32x16_bf16 v[96:111], v[140:143], v[12:15], v[96:111]
    s_waitcnt lgkmcnt(1)
    v_exp_f32 v83, v83
    v_exp_f32 v84, v84
    v_exp_f32 v85, v85
    v_smfmac_f32_32x32x32_bf16 v[160:175], v[144:147], v[64:71], v204
    s_waitcnt lgkmcnt(0)
    v_exp_f32 v86, v86
    v_exp_f32 v87, v87
    v_exp_f32 v88, v88
    v_smfmac_f32_16x16x64_bf16 v[192:195], v[200:203], v[64:71], v204
    ds_read_b128 v[128:131], v24 offset:0
    v_exp_f32 v89, v89
    v_exp_f32 v90, v90
    v_smfmac_f32_32x32x32_bf16 v[160:175], v[148:151], v[72:79], v204
    v_exp_f32 v91, v91
    v_exp_f32 v92, v92
    v_exp_f32 v93, v93
    v_smfmac_f32_16x16x64_bf16 v[192:195], v[200:203], v[72:79], v204
    ds_read_b128 v[132:135], v24 offset:1024
    v_exp_f32 v94, v94
    v_exp_f32 v95, v95
    v_mfma_f32_32x32x16_bf16 v[112:127], v[136:139], v[16:19], 0
    v_exp_f32 v96, v96
    v_exp_f32 v97, v97
    v_exp_f32 v98, v98
    v_mfma_f32_32x32x16_bf16 v[112:127], v[140:143], v[20:23], v[112:127]
    v_exp_f32 v99, v99
    v_exp_f32 v100, v100
    v_exp_f32 v101, v101
    v_smfmac_f32_32x32x32_bf16 v[176:191], v[144:147], v[80:87], v204
    s_waitcnt lgkmcnt(0)
    v_exp_f32 v102, v102
    v_exp_f32 v103, v103
    v_exp_f32 v104, v104
    v_smfmac_f32_16x16x64_bf16 v[196:199], v[200:203], v[80:87], v204
    ds_read_b128 v[152:155], v24 offset:63488
    v_exp_f32 v105, v105
    v_exp_f32 v106, v106
    v_smfmac_f32_32x32x32_bf16 v[176:191], v[148:151], v[88:95], v204
    v_exp_f32 v107, v107
    v_exp_f32 v108, v108
    v_exp_f32 v109, v109
    v_smfmac_f32_16x16x64_bf16 v[196:199], v[200:203], v[88:95], v204
    ds_read_b128 v[156:159], v24 offset:64512
    v_exp_f32 v110, v110
    v_exp_f32 v111, v111
    v_mfma_f32_32x32x16_bf16 v[64:79], v[128:131], v[8:11], 0
    s_sub_u32 s54, s54, 1
    v_exp_f32 v112, v112
    v_exp_f32 v113, v113
    v_exp_f32 v114, v114
    v_mfma_f32_32x32x16_bf16 v[64:79], v[132:135], v[12:15], v[64:79]
    s_waitcnt lgkmcnt(1)
    v_exp_f32 v115, v115
    v_exp_f32 v116, v116
    v_exp_f32 v117, v117
    v_smfmac_f32_32x32x32_bf16 v[160:175], v[152:155], v[96:103], v204
    s_waitcnt lgkmcnt(0)
    v_exp_f32 v118, v118
    v_exp_f32 v119, v119
    v_exp_f32 v120, v120
    v_smfmac_f32_16x16x64_bf16 v[192:195], v[200:203], v[96:103], v204
    ds_read_b128 v[136:139], v24 offset:2048
    v_exp_f32 v121, v121
    v_exp_f32 v122, v122
    v_smfmac_f32_32x32x32_bf16 v[160:175], v[156:159], v[104:111], v204
    s_cmp_lg_u32 s54, 0
    v_exp_f32 v123, v123
    v_exp_f32 v124, v124
    v_exp_f32 v125, v125
    v_smfmac_f32_16x16x64_bf16 v[192:195], v[200:203], v[104:111], v204
    ds_read_b128 v[140:143], v24 offset:3072
    v_exp_f32 v126, v126
    v_exp_f32 v127, v127
    s_cbranch_scc1 c_attn_loop
    v_smfmac_f32_16x16x64_bf16 v[196:199], v[200:203], v[112:119], v204
    v_smfmac_f32_16x16x64_bf16 v[196:199], v[200:203], v[120:127], v204
    v_smfmac_f32_32x32x32_bf16 v[176:191], v[152:155], v[112:119], v204
    v_smfmac_f32_32x32x32_bf16 v[176:191], v[156:159], v[120:127], v204
    v_mov_b32 v28, 0x5f000000
    v_mov_b32 v29, 0x2b800000
    v_cmp_lt_f32 s[56:57], v192, v28
    v_cmp_gt_f32 vcc, v192, v29
    s_and_b64 s[56:57], s[56:57], vcc
    s_nop 0
    v_cmp_lt_f32 vcc, v196, v28
    s_and_b64 s[56:57], s[56:57], vcc
    v_cmp_gt_f32 vcc, v196, v29
    s_and_b64 s[56:57], s[56:57], vcc
    s_cmp_lg_u64 s[56:57], -1
    s_cbranch_scc1 c_attn_slow
c_attn_fin:
    s_lshl_b32 s3, s48, 17
    s_lshl_b32 s55, s7, 12
    s_add_u32 s3, s3, s55
    s_and_b32 s55, s6, 1
    s_lshl_b32 s55, s55, 11
    s_add_u32 s3, s3, s55
    s_lshl_b32 s55, s9, 22
    s_add_u32 s3, s3, s55
    s_add_u32 s3, s3, 16777216
    v_rcp_f32 v192, v192
    s_nop 0
    v_pk_mul_f32 v[160:161], v[192:193], v[160:161] op_sel_hi:[0,1]
    v_pk_mul_f32 v[162:163], v[192:193], v[162:163] op_sel_hi:[0,1]
    v_pk_mul_f32 v[164:165], v[192:193], v[164:165] op_sel_hi:[0,1]
    v_pk_mul_f32 v[166:167], v[192:193], v[166:167] op_sel_hi:[0,1]
    v_pk_mul_f32 v[168:169], v[192:193], v[168:169] op_sel_hi:[0,1]
    v_pk_mul_f32 v[170:171], v[192:193], v[170:171] op_sel_hi:[0,1]
    v_pk_mul_f32 v[172:173], v[192:193], v[172:173] op_sel_hi:[0,1]
    v_pk_mul_f32 v[174:175], v[192:193], v[174:175] op_sel_hi:[0,1]
    v_cvt_pk_bf16_f32 v160, v160, v161
    v_cvt_pk_bf16_f32 v161, v162, v163
    v_cvt_pk_bf16_f32 v162, v164, v165
    v_cvt_pk_bf16_f32 v163, v166, v167
    v_cvt_pk_bf16_f32 v164, v168, v169
    v_cvt_pk_bf16_f32 v165, v170, v171
    v_cvt_pk_bf16_f32 v166, v172, v173
    v_cvt_pk_bf16_f32 v167, v174, v175
    buffer_store_dwordx4 v[160:163], v5, s[12:15], s3 offen offset:0 sc1
    buffer_store_dwordx4 v[164:167], v5, s[12:15], s3 offen offset:1024 sc1
    s_add_u32 s3, s3, 65536
    v_rcp_f32 v196, v196
    s_nop 0
    v_pk_mul_f32 v[176:177], v[196:197], v[176:177] op_sel_hi:[0,1]
    v_pk_mul_f32 v[178:179], v[196:197], v[178:179] op_sel_hi:[0,1]
    v_pk_mul_f32 v[180:181], v[196:197], v[180:181] op_sel_hi:[0,1]
    v_pk_mul_f32 v[182:183], v[196:197], v[182:183] op_sel_hi:[0,1]
    v_pk_mul_f32 v[184:185], v[196:197], v[184:185] op_sel_hi:[0,1]
    v_pk_mul_f32 v[186:187], v[196:197], v[186:187] op_sel_hi:[0,1]
    v_pk_mul_f32 v[188:189], v[196:197], v[188:189] op_sel_hi:[0,1]
    v_pk_mul_f32 v[190:191], v[196:197], v[190:191] op_sel_hi:[0,1]
    v_cvt_pk_bf16_f32 v176, v176, v177
    v_cvt_pk_bf16_f32 v177, v178, v179
    v_cvt_pk_bf16_f32 v178, v180, v181
    v_cvt_pk_bf16_f32 v179, v182, v183
    v_cvt_pk_bf16_f32 v180, v184, v185
    v_cvt_pk_bf16_f32 v181, v186, v187
    v_cvt_pk_bf16_f32 v182, v188, v189
    v_cvt_pk_bf16_f32 v183, v190, v191
    buffer_store_dwordx4 v[176:179], v5, s[12:15], s3 offen offset:0 sc1
    buffer_store_dwordx4 v[180:183], v5, s[12:15], s3 offen offset:1024 sc1
    s_add_u32 s3, s3, 65536
    s_mul_i32 s55, s9, 786432
    s_add_u32 s55, s55, 65798144
    v_and_b32 v28, 63, v0
    s_and_b32 s56, s11, 0xe0
    v_lshrrev_b32 v29, 5, v28
    v_add_u32 v28, s56, v28
    v_and_b32 v28, 255, v28
    v_lshlrev_b32 v28, 10, v28
    v_lshl_add_u32 v28, v29, 8, v28
    s_bfe_u32 s56, s11, 0x20003
    s_and_b32 s57, s11, 7
    s_lshl_b32 s56, s56, 7
    s_lshl_b32 s57, s57, 2
    s_add_u32 s55, s55, s56
    s_add_u32 s55, s55, s57
    v_mov_b32 v29, 159488
    v_mov_b32 v30, 1
    v_mov_b32 v31, s10
    s_mov_b64 exec, 1
    s_waitcnt vmcnt(0)
    ds_add_rtn_u32 v30, v29, v30
    s_waitcnt lgkmcnt(0)
    v_readfirstlane_b32 s56, v30
    s_and_b32 s56, s56, 3
    s_cmp_lg_u32 s56, 3
    s_cbranch_scc1 pub_7
    s_mov_b32 exec_lo, -1
    buffer_store_dword v31, v28, s[12:15], s55 offen sc1
pub_7:
    s_mov_b64 exec, -1
    s_branch c_wo
.p2align 6
h_first:
    s_memrealtime s[50:51]
    s_cmp_lg_u32 s2, 0
    s_cbranch_scc1 h_first_nonon
    s_mov_b32 s16, s46
    s_mov_b32 s17, s47
    s_mov_b32 s18, 256
    s_mov_b32 s19, 0x00020000
    v_lshlrev_b32 v14, 6, v1
    s_waitcnt lgkmcnt(0)
    s_or_b32 s50, s50, 1
    v_mov_b32 v13, s50
    buffer_store_dword v13, v14, s[16:19], 0 offen sc1
h_first_nonon:
    v_mov_b32 v8, 0
    v_mov_b32 v9, 0
    v_mov_b32 v10, 159488
    ds_write_b64 v10, v[8:9]
    ds_write_b32 v10, v8 offset:8
    s_waitcnt lgkmcnt(0)
    s_barrier
    s_barrier
    s_sub_u32 s50, s50, 8000
    s_load_dword s10, s[46:47], 0
    s_waitcnt lgkmcnt(0)
    s_sub_u32 s51, s10, s50
    s_and_b32 s3, s10, 1
    s_cselect_b32 s51, s51, -1
    s_cmp_ge_i32 s51, 0
    s_cbranch_scc1 h_first_non_ok
    s_load_dword s10, s[46:47], 128
    s_waitcnt lgkmcnt(0)
    s_sub_u32 s51, s10, s50
    s_and_b32 s3, s10, 1
    s_cselect_b32 s51, s51, -1
    s_cmp_ge_i32 s51, 0
    s_cbranch_scc1 h_first_non_ok
    s_load_dword s10, s[46:47], 64
    s_waitcnt lgkmcnt(0)
    s_sub_u32 s51, s10, s50
    s_and_b32 s3, s10, 1
    s_cselect_b32 s51, s51, -1
    s_cmp_ge_i32 s51, 0
    s_cbranch_scc1 h_first_non_ok
    s_load_dword s10, s[46:47], 192
    s_waitcnt lgkmcnt(0)
    s_sub_u32 s51, s10, s50
    s_and_b32 s3, s10, 1
    s_cselect_b32 s51, s51, -1
    s_cmp_ge_i32 s51, 0
    s_cbranch_scc1 h_first_non_ok
    s_mov_b32 s58, 0
    s_and_b32 s57, s2, 0xc0
h_first_non:
    s_load_dword s10, s[46:47], s57 glc
    s_waitcnt lgkmcnt(0)
    s_sub_u32 s51, s10, s50
    s_and_b32 s3, s10, 1
    s_cselect_b32 s51, s51, -1
    s_cmp_ge_i32 s51, 0
    s_cbranch_scc1 h_first_non_ok
    s_add_u32 s58, s58, 1
    s_cmp_gt_u32 s58, 100
    s_cselect_b32 s50, s10, s50
    s_cmp_lt_u32 s58, 0x8000
    s_cbranch_scc1 h_first_non
    s_mov_b32 s10, 1
h_first_non_ok:
    v_mov_b32 v12, s10
    ds_write_b32 v10, v12 offset:4
    s_waitcnt vmcnt(0)
    v_lshlrev_b32 v13, 7, v1
    s_lshl_b32 s50, s2, 13
    s_mov_b32 s28, s36
    s_mov_b32 s29, s37
    s_mov_b32 s30, 2097152
    s_mov_b32 s31, 0x00020000
    buffer_load_dword v14, v13, s[28:31], s50 offen
    s_mov_b32 s9, 0
h_qkvA:
    s_mul_i32 s98, s9, 786432
    s_add_u32 s98, s98, 65273856
    s_lshl_b32 s99, s11, 10
    s_add_u32 s98, s98, s99
    s_add_u32 s96, s4, s98
    s_addc_u32 s97, s5, 0
    s_mov_b32 s98, s10
    s_mov_b32 s99, s10
    v_and_b32 v1, 63, v0
    v_lshlrev_b32 v5, 4, v1
    v_and_b32 v20, 15, v1
    v_lshrrev_b32 v11, 4, v1
    v_min_u32 v11, 2, v11
    v_lshlrev_b32 v21, 3, v20
    v_lshl_add_u32 v12, v11, 7, v21
    v_add_u32 v12, 155648, v12
    v_lshl_add_u32 v11, v11, 16, v21
    v_mov_b32 v10, 159496
    s_add_u32 s3, s9, 1
    v_mov_b32 v13, s3
    s_and_b32 s3, s6, 14
    s_lshl_b32 s3, s3, 2
    s_sub_u32 s3, s3, 1
    s_max_i32 s3, s3, 0
    s_lshl_b32 s3, s3, 16
    s_lshl_b32 s48, s9, 22
    s_add_u32 s3, s3, s48
    s_add_u32 s20, s4, s3
    s_addc_u32 s21, s5, 0
    s_mov_b32 s22, 65536
    s_mov_b32 s23, 0x00020000
    v_bfe_u32 v21, v1, 4, 1
    v_lshl_add_u32 v6, v21, 5, v20
    v_lshlrev_b32 v6, 4, v6
    v_lshrrev_b32 v21, 5, v1
    v_lshl_add_u32 v6, v21, 10, v6
    v_add_u32 v6, 256, v6
    s_mov_b32 s3, 0x20000
poll_8:
    s_load_dwordx8 s[80:87], s[96:97], 512 glc
    s_load_dwordx8 s[88:95], s[96:97], 640 glc
    s_sub_u32 s3, s3, 1
    s_cbranch_scc1 poll_8_ok
    s_waitcnt lgkmcnt(0)
    s_xor_b64 s[100:101], s[80:81], s[98:99]
    s_xor_b64 s[80:81], s[82:83], s[98:99]
    s_or_b64 s[100:101], s[100:101], s[80:81]
    s_xor_b64 s[80:81], s[84:85], s[98:99]
    s_or_b64 s[100:101], s[100:101], s[80:81]
    s_xor_b64 s[80:81], s[86:87], s[98:99]
    s_or_b64 s[100:101], s[100:101], s[80:81]
    s_xor_b64 s[80:81], s[88:89], s[98:99]
    s_or_b64 s[100:101], s[100:101], s[80:81]
    s_xor_b64 s[80:81], s[90:91], s[98:99]
    s_or_b64 s[100:101], s[100:101], s[80:81]
    s_xor_b64 s[80:81], s[92:93], s[98:99]
    s_or_b64 s[100:101], s[100:101], s[80:81]
    s_xor_b64 s[80:81], s[94:95], s[98:99]
    s_or_b64 s[100:101], s[100:101], s[80:81]
    s_cbranch_scc1 poll_8
poll_8_ok:
    s_waitcnt lgkmcnt(0)
    ds_write_b32 v10, v13
    s_mov_b32 m0, 147456
    s_mov_b32 s48, 0
    buffer_load_dwordx4 v6, s[20:23], s48 offen sc1 lds
    s_mov_b32 m0, 148480
    s_mov_b32 s48, 2048
    buffer_load_dwordx4 v6, s[20:23], s48 offen sc1 lds
    s_mov_b32 m0, 149504
    s_mov_b32 s48, 4096
    buffer_load_dwordx4 v6, s[20:23], s48 offen sc1 lds
    s_mov_b32 m0, 150528
    s_mov_b32 s48, 6144
    buffer_load_dwordx4 v6, s[20:23], s48 offen sc1 lds
    s_barrier
    s_mov_b32 m0, 151552
    s_mov_b32 s48, 8192
    buffer_load_dwordx4 v6, s[20:23], s48 offen sc1 lds
    s_mov_b32 m0, 152576
    s_mov_b32 s48, 10240
    buffer_load_dwordx4 v6, s[20:23], s48 offen sc1 lds
    s_mov_b32 m0, 153600
    s_mov_b32 s48, 12288
    buffer_load_dwordx4 v6, s[20:23], s48 offen sc1 lds
    s_mov_b32 m0, 154624
    s_mov_b32 s48, 14336
    buffer_load_dwordx4 v6, s[20:23], s48 offen sc1 lds
    s_lshl_b32 s56, s7, 12
    s_and_b32 s57, s6, 1
    s_lshl_b32 s57, s57, 7
    s_add_u32 s56, s56, s57
    s_add_u32 s56, s56, 63963136
    v_lshlrev_b32 v15, 7, v1
    s_lshr_b32 s59, s2, 3
    s_mul_i32 s59, s59, 3
    s_lshr_b32 s59, s59, 5
    s_lshl_b32 s3, s9, 4
    s_add_u32 s59, s59, s3
    s_and_b32 s58, s6, 14
    s_lshl_b32 s58, s58, 18
    s_lshl_b32 s57, s9, 22
    s_add_u32 s58, s58, s57
    s_and_b32 s57, s7, 3
    s_lshl_b32 s57, s57, 11
    s_add_u32 s58, s58, s57
    s_waitcnt vmcnt(4)
    s_barrier
    s_waitcnt vmcnt(0)
    s_barrier
    s_mov_b32 m0, 147456
    s_mov_b32 s48, 16384
    buffer_load_dwordx4 v6, s[20:23], s48 offen sc1 lds
    s_mov_b32 m0, 148480
    s_mov_b32 s48, 18432
    buffer_load_dwordx4 v6, s[20:23], s48 offen sc1 lds
    s_mov_b32 m0, 149504
    s_mov_b32 s48, 20480
    buffer_load_dwordx4 v6, s[20:23], s48 offen sc1 lds
    s_mov_b32 m0, 150528
    s_mov_b32 s48, 22528
    buffer_load_dwordx4 v6, s[20:23], s48 offen sc1 lds
    s_waitcnt vmcnt(0)
    s_barrier
    s_mov_b32 m0, 151552
    s_mov_b32 s48, 24576
    buffer_load_dwordx4 v6, s[20:23], s48 offen sc1 lds
    s_mov_b32 m0, 152576
    s_mov_b32 s48, 26624
    buffer_load_dwordx4 v6, s[20:23], s48 offen sc1 lds
    s_mov_b32 m0, 153600
    s_mov_b32 s48, 28672
    buffer_load_dwordx4 v6, s[20:23], s48 offen sc1 lds
    s_mov_b32 m0, 154624
    s_mov_b32 s48, 30720
    buffer_load_dwordx4 v6, s[20:23], s48 offen sc1 lds
    buffer_load_dwordx2 v[32:33], v11, s[12:15], s56 offen offset:0 sc1
    buffer_load_dwordx2 v[34:35], v11, s[12:15], s56 offen offset:256 sc1
    buffer_load_dwordx2 v[36:37], v11, s[12:15], s56 offen offset:512 sc1
    buffer_load_dwordx2 v[38:39], v11, s[12:15], s56 offen offset:768 sc1
    buffer_load_dwordx2 v[40:41], v11, s[12:15], s56 offen offset:1024 sc1
    buffer_load_dwordx2 v[42:43], v11, s[12:15], s56 offen offset:1280 sc1
    buffer_load_dwordx2 v[44:45], v11, s[12:15], s56 offen offset:1536 sc1
    buffer_load_dwordx2 v[46:47], v11, s[12:15], s56 offen offset:1792 sc1
    buffer_load_dwordx2 v[48:49], v11, s[12:15], s56 offen offset:2048 sc1
    buffer_load_dwordx2 v[50:51], v11, s[12:15], s56 offen offset:2304 sc1
    buffer_load_dwordx2 v[52:53], v11, s[12:15], s56 offen offset:2560 sc1
    buffer_load_dwordx2 v[54:55], v11, s[12:15], s56 offen offset:2816 sc1
    s_waitcnt vmcnt(12)
    s_barrier
    s_mov_b32 m0, 147456
    s_mov_b32 s48, 32768
    buffer_load_dwordx4 v6, s[20:23], s48 offen sc1 lds
    s_mov_b32 m0, 148480
    s_mov_b32 s48, 34816
    buffer_load_dwordx4 v6, s[20:23], s48 offen sc1 lds
    s_mov_b32 m0, 149504
    s_mov_b32 s48, 36864
    buffer_load_dwordx4 v6, s[20:23], s48 offen sc1 lds
    s_mov_b32 m0, 150528
    s_mov_b32 s48, 38912
    buffer_load_dwordx4 v6, s[20:23], s48 offen sc1 lds
    buffer_load_dwordx2 v[56:57], v11, s[12:15], s56 offen offset:3072 sc1
    buffer_load_dwordx2 v[58:59], v11, s[12:15], s56 offen offset:3328 sc1
    buffer_load_dwordx2 v[60:61], v11, s[12:15], s56 offen offset:3584 sc1
    buffer_load_dwordx2 v[62:63], v11, s[12:15], s56 offen offset:3840 sc1
    s_waitcnt vmcnt(4)
    s_barrier
    s_mov_b32 m0, 151552
    s_mov_b32 s48, 40960
    buffer_load_dwordx4 v6, s[20:23], s48 offen sc1 lds
    s_mov_b32 m0, 152576
    s_mov_b32 s48, 43008
    buffer_load_dwordx4 v6, s[20:23], s48 offen sc1 lds
    s_mov_b32 m0, 153600
    s_mov_b32 s48, 45056
    buffer_load_dwordx4 v6, s[20:23], s48 offen sc1 lds
    s_mov_b32 m0, 154624
    s_mov_b32 s48, 47104
    buffer_load_dwordx4 v6, s[20:23], s48 offen sc1 lds
    s_waitcnt vmcnt(4)
    v_add_f32 v32, v32, v48
    v_add_f32 v33, v33, v49
    v_add_f32 v34, v34, v50
    v_add_f32 v35, v35, v51
    v_add_f32 v36, v36, v52
    v_add_f32 v37, v37, v53
    v_add_f32 v38, v38, v54
    v_add_f32 v39, v39, v55
    v_add_f32 v40, v40, v56
    v_add_f32 v41, v41, v57
    v_add_f32 v42, v42, v58
    v_add_f32 v43, v43, v59
    s_waitcnt vmcnt(0)
    s_barrier
    s_mov_b32 m0, 147456
    s_mov_b32 s48, 49152
    buffer_load_dwordx4 v6, s[20:23], s48 offen sc1 lds
    s_mov_b32 m0, 148480
    s_mov_b32 s48, 51200
    buffer_load_dwordx4 v6, s[20:23], s48 offen sc1 lds
    s_mov_b32 m0, 149504
    s_mov_b32 s48, 53248
    buffer_load_dwordx4 v6, s[20:23], s48 offen sc1 lds
    s_mov_b32 m0, 150528
    s_mov_b32 s48, 55296
    buffer_load_dwordx4 v6, s[20:23], s48 offen sc1 lds
    v_add_f32 v44, v44, v60
    v_add_f32 v45, v45, v61
    v_add_f32 v46, v46, v62
    v_add_f32 v47, v47, v63
    v_add_f32 v32, v32, v40
    v_add_f32 v33, v33, v41
    v_add_f32 v34, v34, v42
    v_add_f32 v35, v35, v43
    v_add_f32 v36, v36, v44
    v_add_f32 v37, v37, v45
    v_add_f32 v38, v38, v46
    v_add_f32 v39, v39, v47
    s_waitcnt vmcnt(0)
    s_barrier
    s_mov_b32 m0, 151552
    s_mov_b32 s48, 57344
    buffer_load_dwordx4 v6, s[20:23], s48 offen sc1 lds
    s_mov_b32 m0, 152576
    s_mov_b32 s48, 59392
    buffer_load_dwordx4 v6, s[20:23], s48 offen sc1 lds
    s_mov_b32 m0, 153600
    s_mov_b32 s48, 61440
    buffer_load_dwordx4 v6, s[20:23], s48 offen sc1 lds
    s_mov_b32 m0, 154624
    s_mov_b32 s48, 63488
    buffer_load_dwordx4 v6, s[20:23], s48 offen sc1 lds
    v_add_f32 v32, v32, v36
    v_add_f32 v33, v33, v37
    v_add_f32 v34, v34, v38
    v_add_f32 v35, v35, v39
    v_add_f32 v32, v32, v34
    v_add_f32 v33, v33, v35
    ds_write_b64 v12, v[32:33]
    s_waitcnt lgkmcnt(0)
    s_waitcnt vmcnt(0)
    s_barrier
    s_barrier
    s_barrier
    s_branch h_wo
h_qkvB:
    s_mul_i32 s98, s9, 786432
    s_add_u32 s98, s98, 65273856
    s_lshl_b32 s99, s11, 10
    s_add_u32 s98, s98, s99
    s_add_u32 s96, s4, s98
    s_addc_u32 s97, s5, 0
    s_mov_b32 s98, s10
    s_mov_b32 s99, s10
    v_and_b32 v1, 63, v0
    v_lshlrev_b32 v5, 4, v1
    v_and_b32 v20, 15, v1
    v_lshrrev_b32 v11, 4, v1
    v_min_u32 v11, 2, v11
    v_lshlrev_b32 v21, 3, v20
    v_lshl_add_u32 v12, v11, 7, v21
    v_add_u32 v12, 156032, v12
    v_lshl_add_u32 v11, v11, 16, v21
    v_mov_b32 v10, 159496
    s_add_u32 s3, s9, 1
    v_mov_b32 v13, s3
    s_mov_b32 s3, 0x20000
poll_9:
    s_load_dwordx8 s[88:95], s[96:97], 0 glc
    s_sub_u32 s3, s3, 1
    s_cbranch_scc1 poll_9_ok
    s_waitcnt lgkmcnt(0)
    s_xor_b64 s[100:101], s[88:89], s[98:99]
    s_xor_b64 s[88:89], s[90:91], s[98:99]
    s_or_b64 s[100:101], s[100:101], s[88:89]
    s_xor_b64 s[88:89], s[92:93], s[98:99]
    s_or_b64 s[100:101], s[100:101], s[88:89]
    s_xor_b64 s[88:89], s[94:95], s[98:99]
    s_or_b64 s[100:101], s[100:101], s[88:89]
    s_cbranch_scc1 poll_9
poll_9_ok:
    s_waitcnt lgkmcnt(0)
    ds_write_b32 v10, v13
    s_barrier
    s_lshl_b32 s56, s7, 12
    s_and_b32 s57, s6, 1
    s_lshl_b32 s57, s57, 7
    s_add_u32 s56, s56, s57
    s_add_u32 s56, s56, 64159744
    s_and_b32 s58, s6, 14
    s_lshl_b32 s58, s58, 18
    s_lshl_b32 s57, s9, 22
    s_add_u32 s58, s58, s57
    s_and_b32 s57, s7, 3
    s_lshl_b32 s57, s57, 11
    s_add_u32 s58, s58, s57
    s_barrier
    s_barrier
    s_barrier
    buffer_load_dwordx2 v[32:33], v11, s[12:15], s56 offen offset:0 sc1
    buffer_load_dwordx2 v[34:35], v11, s[12:15], s56 offen offset:256 sc1
    buffer_load_dwordx2 v[36:37], v11, s[12:15], s56 offen offset:512 sc1
    buffer_load_dwordx2 v[38:39], v11, s[12:15], s56 offen offset:768 sc1
    buffer_load_dwordx2 v[40:41], v11, s[12:15], s56 offen offset:1024 sc1
    buffer_load_dwordx2 v[42:43], v11, s[12:15], s56 offen offset:1280 sc1
    buffer_load_dwordx2 v[44:45], v11, s[12:15], s56 offen offset:1536 sc1
    buffer_load_dwordx2 v[46:47], v11, s[12:15], s56 offen offset:1792 sc1
    buffer_load_dwordx2 v[48:49], v11, s[12:15], s56 offen offset:2048 sc1
    buffer_load_dwordx2 v[50:51], v11, s[12:15], s56 offen offset:2304 sc1
    buffer_load_dwordx2 v[52:53], v11, s[12:15], s56 offen offset:2560 sc1
    buffer_load_dwordx2 v[54:55], v11, s[12:15], s56 offen offset:2816 sc1
    s_barrier
    buffer_load_dwordx2 v[56:57], v11, s[12:15], s56 offen offset:3072 sc1
    buffer_load_dwordx2 v[58:59], v11, s[12:15], s56 offen offset:3328 sc1
    buffer_load_dwordx2 v[60:61], v11, s[12:15], s56 offen offset:3584 sc1
    buffer_load_dwordx2 v[62:63], v11, s[12:15], s56 offen offset:3840 sc1
    s_barrier
    s_waitcnt vmcnt(0)
    v_add_f32 v32, v32, v48
    v_add_f32 v33, v33, v49
    v_add_f32 v34, v34, v50
    v_add_f32 v35, v35, v51
    v_add_f32 v36, v36, v52
    v_add_f32 v37, v37, v53
    v_add_f32 v38, v38, v54
    v_add_f32 v39, v39, v55
    v_add_f32 v40, v40, v56
    v_add_f32 v41, v41, v57
    v_add_f32 v42, v42, v58
    v_add_f32 v43, v43, v59
    s_barrier
    v_add_f32 v44, v44, v60
    v_add_f32 v45, v45, v61
    v_add_f32 v46, v46, v62
    v_add_f32 v47, v47, v63
    v_add_f32 v32, v32, v40
    v_add_f32 v33, v33, v41
    v_add_f32 v34, v34, v42
    v_add_f32 v35, v35, v43
    v_add_f32 v36, v36, v44
    v_add_f32 v37, v37, v45
    v_add_f32 v38, v38, v46
    v_add_f32 v39, v39, v47
    s_barrier
    v_add_f32 v32, v32, v36
    v_add_f32 v33, v33, v37
    v_add_f32 v34, v34, v38
    v_add_f32 v35, v35, v39
    v_add_f32 v32, v32, v34
    v_add_f32 v33, v33, v35
    ds_write_b64 v12, v[32:33]
    s_waitcnt lgkmcnt(0)
    s_barrier
    s_barrier
    s_branch s_attn
.p2align 6
l_first:
    s_sub_u32 s51, s8, 5
    s_lshl_b32 s61, s51, 8
    s_add_u32 s61, s61, s2
    s_and_b32 s62, s61, 15
    s_lshr_b32 s63, s61, 4
    v_lshrrev_b32 v20, 3, v1
    v_mul_u32_u24 v12, 6144, v20
    v_and_b32 v21, 7, v1
    v_lshl_add_u32 v12, v21, 4, v12
    s_mov_b32 s20, s34
    s_mov_b32 s21, s35
    s_mov_b32 s22, 6291456
    s_mov_b32 s23, 0x00020000
    s_mov_b32 s28, s40
    s_mov_b32 s29, s41
    s_mov_b32 s30, 6291456
    s_mov_b32 s31, 0x00020000
    s_mul_i32 s52, s62, 393216
    s_lshl_b32 s56, s63, 7
    s_add_u32 s52, s52, s56
    s_barrier
    s_add_u32 s53, s52, 0
    buffer_load_dwordx4 v[136:139], v12, s[20:23], s53 offen nt
    s_add_u32 s53, s52, 49152
    buffer_load_dwordx4 v[140:143], v12, s[20:23], s53 offen nt
    s_add_u32 s53, s52, 98304
    buffer_load_dwordx4 v[144:147], v12, s[20:23], s53 offen nt
    s_add_u32 s53, s52, 147456
    buffer_load_dwordx4 v[148:151], v12, s[20:23], s53 offen nt
    v_lshlrev_b32 v14, 6, v20
    v_lshrrev_b32 v22, 5, v1
    v_bfe_u32 v23, v1, 1, 1
    v_xor_b32 v22, v22, v23
    v_lshl_add_u32 v14, v22, 5, v14
    v_and_b32 v22, 1, v1
    v_lshl_add_u32 v14, v22, 4, v14
    v_bfe_u32 v23, v1, 2, 1
    v_mul_u32_u24 v23, 196608, v23
    v_add_u32 v14, v14, v23
    v_lshlrev_b32 v22, 4, v22
    v_mov_b32 v23, 0x3f80
    v_lshlrev_b32 v23, v22, v23
    v_bfe_u32 v22, v1, 1, 3
    v_cmp_eq_u32 vcc, 0, v22
    s_nop 1
    v_cndmask_b32 v24, 0, v23, vcc
    v_cmp_eq_u32 vcc, 1, v22
    s_nop 1
    v_cndmask_b32 v25, 0, v23, vcc
    v_cmp_eq_u32 vcc, 2, v22
    s_nop 1
    v_cndmask_b32 v26, 0, v23, vcc
    v_cmp_eq_u32 vcc, 3, v22
    s_nop 1
    v_cndmask_b32 v27, 0, v23, vcc
    v_lshlrev_b32 v15, 5, v21
    v_and_b32 v22, 16, v1
    v_add_u32 v15, v15, v22
    v_lshlrev_b32 v16, 14, v1
    s_mov_b32 s9, 0
    s_lshr_b32 s55, s63, 4
    s_and_b32 s56, s63, 15
    s_mul_i32 s57, s56, 6
    s_add_u32 s57, s57, s55
    s_lshl_b32 s57, s57, 16
    s_lshl_b32 s58, s62, 12
    s_add_u32 s57, s57, s58
    s_add_u32 s57, s57, 50331648
    s_lshl_b32 s54, s61, 8
    s_add_u32 s54, s54, 63963136
    s_lshl_b32 s56, s56, 10
    s_lshl_b32 s55, s55, 7
    s_add_u32 s55, s55, s56
    s_lshl_b32 s56, s62, 2
    s_add_u32 s55, s55, s56
    s_add_u32 s55, s55, 64487424
    s_waitcnt vmcnt(3)
    s_add_u32 s53, s52, 196608
    buffer_load_dwordx4 v[152:155], v12, s[20:23], s53 offen nt
    s_add_u32 s53, s52, 245760
    buffer_load_dwordx4 v[156:159], v12, s[20:23], s53 offen nt
    s_add_u32 s53, s52, 294912
    buffer_load_dwordx4 v[160:163], v12, s[20:23], s53 offen nt
    buffer_store_dwordx4 v[136:139], v14, s[12:15], s57 offen offset:0 sc1
    v_mfma_f32_16x16x32_bf16 v[28:31], v[24:27], v[136:139], 0
    s_barrier
    s_waitcnt vmcnt(6)
    s_add_u32 s53, s52, 344064
    buffer_load_dwordx4 v[164:167], v12, s[20:23], s53 offen nt
    buffer_store_dwordx4 v[140:143], v14, s[12:15], s57 offen offset:512 sc1
    v_mfma_f32_16x16x32_bf16 v[28:31], v[24:27], v[140:143], v[28:31]
    s_waitcnt vmcnt(7)
    buffer_store_dwordx4 v[144:147], v14, s[12:15], s57 offen offset:1024 sc1
    v_mfma_f32_16x16x32_bf16 v[28:31], v[24:27], v[144:147], v[28:31]
    s_waitcnt vmcnt(7)
    buffer_store_dwordx4 v[148:151], v14, s[12:15], s57 offen offset:1536 sc1
    v_mfma_f32_16x16x32_bf16 v[28:31], v[24:27], v[148:151], v[28:31]
    s_waitcnt vmcnt(7)
    buffer_store_dwordx4 v[152:155], v14, s[12:15], s57 offen offset:2048 sc1
    v_mfma_f32_16x16x32_bf16 v[28:31], v[24:27], v[152:155], v[28:31]
    s_waitcnt vmcnt(7)
    buffer_store_dwordx4 v[156:159], v14, s[12:15], s57 offen offset:2560 sc1
    v_mfma_f32_16x16x32_bf16 v[28:31], v[24:27], v[156:159], v[28:31]
    s_waitcnt vmcnt(7)
    buffer_store_dwordx4 v[160:163], v14, s[12:15], s57 offen offset:3072 sc1
    v_mfma_f32_16x16x32_bf16 v[28:31], v[24:27], v[160:163], v[28:31]
    s_waitcnt vmcnt(6)
    buffer_store_dwordx4 v[164:167], v14, s[12:15], s57 offen offset:3584 sc1
    v_mfma_f32_16x16x32_bf16 v[28:31], v[24:27], v[164:167], v[28:31]
    s_nop 7
    v_add_f32_dpp v28, v28, v28 row_ror:8 row_mask:0xf bank_mask:0xf
    v_add_f32_dpp v29, v29, v29 row_ror:8 row_mask:0xf bank_mask:0xf
    v_add_f32_dpp v30, v30, v30 row_ror:8 row_mask:0xf bank_mask:0xf
    v_add_f32_dpp v31, v31, v31 row_ror:8 row_mask:0xf bank_mask:0xf
    s_mov_b64 exec, 0x00ff00ff
    buffer_store_dwordx4 v[28:31], v15, s[12:15], s54 offen sc1
    s_mov_b64 exec, -1
    s_add_u32 s57, s57, 6291456
    s_add_u32 s54, s54, 196608
    s_add_u32 s53, s52, 0
    buffer_load_dwordx4 v[168:171], v12, s[28:31], s53 offen nt
    s_add_u32 s53, s52, 49152
    buffer_load_dwordx4 v[172:175], v12, s[28:31], s53 offen nt
    s_add_u32 s53, s52, 98304
    buffer_load_dwordx4 v[176:179], v12, s[28:31], s53 offen nt
    s_add_u32 s53, s52, 147456
    buffer_load_dwordx4 v[180:183], v12, s[28:31], s53 offen nt
    s_add_u32 s53, s52, 196608
    buffer_load_dwordx4 v[184:187], v12, s[28:31], s53 offen nt
    s_add_u32 s53, s52, 245760
    buffer_load_dwordx4 v[188:191], v12, s[28:31], s53 offen nt
    s_add_u32 s53, s52, 294912
    buffer_load_dwordx4 v[192:195], v12, s[28:31], s53 offen nt
    s_add_u32 s53, s52, 344064
    buffer_load_dwordx4 v[196:199], v12, s[28:31], s53 offen nt
    v_mov_b32 v8, 159492
non_10:
    ds_read_b32 v9, v8
    s_waitcnt lgkmcnt(0)
    v_readfirstlane_b32 s10, v9
    s_cmp_eq_u32 s10, 0
    s_cbranch_scc1 non_10
    s_mov_b64 exec, 0xffff
    s_waitcnt vmcnt(8)
    buffer_store_dword v9, v16, s[12:15], s55 offen offset:0 sc1
    s_mov_b64 exec, -1
    s_mov_b32 s58, s52
    s_lshr_b32 s60, s2, 3
    s_mul_i32 s60, s60, 3
    s_lshr_b32 s60, s60, 5
    s_add_u32 s60, s60, 1
    s_branch l_qkv2
l_qkv:
    s_mov_b32 s60, 0
l_qkv2:
    v_and_b32 v1, 63, v0
    v_lshlrev_b32 v5, 4, v1
    s_sub_u32 s51, s8, 5
    s_lshl_b32 s48, s51, 13
    s_and_b32 s53, s9, 1
    s_lshl_b32 s52, s53, 4
    s_add_u32 s49, s7, s52
    s_lshl_b32 s49, s49, 1
    s_and_b32 s52, s6, 1
    s_add_u32 s49, s49, s52
    s_mul_i32 s49, s49, 3
    s_add_u32 s49, s49, s51
    s_lshl_b32 s49, s49, 16
    s_add_u32 s49, s49, 50331648
    v_mov_b32 v13, 159496
    s_cmp_lg_u32 s9, 0
    s_cbranch_scc1 l_qkv_tiled
    s_lshl_b32 s53, s8, 7
    s_lshl_b32 s52, s11, 10
    s_add_u32 s53, s53, s52
    s_add_u32 s53, s53, 64486784
    s_add_u32 s96, s4, s53
    s_addc_u32 s97, s5, 0
    s_mov_b32 s98, s10
    s_mov_b32 s99, s10
    s_mov_b32 s3, 0x20000
poll_11:
    s_load_dwordx16 s[80:95], s[96:97], 0 glc
    s_sub_u32 s3, s3, 1
    s_cbranch_scc1 poll_11_ok
    s_waitcnt lgkmcnt(0)
    s_xor_b64 s[100:101], s[80:81], s[98:99]
    s_xor_b64 s[80:81], s[82:83], s[98:99]
    s_or_b64 s[100:101], s[100:101], s[80:81]
    s_xor_b64 s[80:81], s[84:85], s[98:99]
    s_or_b64 s[100:101], s[100:101], s[80:81]
    s_xor_b64 s[80:81], s[86:87], s[98:99]
    s_or_b64 s[100:101], s[100:101], s[80:81]
    s_xor_b64 s[80:81], s[88:89], s[98:99]
    s_or_b64 s[100:101], s[100:101], s[80:81]
    s_xor_b64 s[80:81], s[90:91], s[98:99]
    s_or_b64 s[100:101], s[100:101], s[80:81]
    s_xor_b64 s[80:81], s[92:93], s[98:99]
    s_or_b64 s[100:101], s[100:101], s[80:81]
    s_xor_b64 s[80:81], s[94:95], s[98:99]
    s_or_b64 s[100:101], s[100:101], s[80:81]
    s_cbranch_scc1 poll_11
poll_11_ok:
    s_waitcnt lgkmcnt(0)
l_qkv_tiled:
    s_mov_b32 s50, 0
    s_mov_b32 m0, s48
    s_add_u32 s50, s50, 1
    buffer_load_dwordx4 v5, s[12:15], s49 offen offset:0 sc1 lds
    buffer_load_dwordx4 v5, s[12:15], s49 offen offset:1024 sc1 lds
    buffer_load_dwordx4 v5, s[12:15], s49 offen offset:2048 sc1 lds
    buffer_load_dwordx4 v5, s[12:15], s49 offen offset:3072 sc1 lds
    s_add_u32 s49, s49, 4096
    s_bitcmp1_b32 s50, 0
    s_cselect_b32 s3, 0, 16384
    s_add_u32 s48, s48, s3
    s_cmp_eq_u32 s50, 12
    s_cselect_b32 s3, 4294819840, 0
    s_add_u32 s48, s48, 4096
    s_add_u32 s48, s48, s3
    s_mov_b32 m0, s48
    s_add_u32 s50, s50, 1
    buffer_load_dwordx4 v5, s[12:15], s49 offen offset:0 sc1 lds
    buffer_load_dwordx4 v5, s[12:15], s49 offen offset:1024 sc1 lds
    buffer_load_dwordx4 v5, s[12:15], s49 offen offset:2048 sc1 lds
    buffer_load_dwordx4 v5, s[12:15], s49 offen offset:3072 sc1 lds
    s_add_u32 s49, s49, 4096
    s_bitcmp1_b32 s50, 0
    s_cselect_b32 s3, 0, 16384
    s_add_u32 s48, s48, s3
    s_cmp_eq_u32 s50, 12
    s_cselect_b32 s3, 4294819840, 0
    s_add_u32 s48, s48, 4096
    s_add_u32 s48, s48, s3
    v_lshrrev_b32 v10, 4, v1
    v_and_b32 v11, 0xff, v5
    v_lshl_add_u32 v10, v10, 12, v11
    s_lshl_b32 s3, s51, 9
    s_add_u32 s3, s3, 155648
    v_lshl_add_u32 v11, v1, 3, s3
    s_and_b32 s59, s6, 14
    s_add_u32 s59, s59, s51
    s_sub_u32 s59, s59, 1
    s_max_i32 s59, s59, 0
    s_lshl_b32 s59, s59, 14
    s_lshl_b32 s3, s9, 18
    s_add_u32 s59, s59, s3
    s_add_u32 s59, s59, 62914560
    s_and_b32 s3, s9, 1
    s_lshl_b32 s3, s3, 3
    s_add_u32 s3, s3, 56
    s_cmp_eq_u32 s51, 0
    s_cselect_b32 s3, s3, 0
    v_cmp_gt_u32 vcc, s3, v1
    v_mov_b32 v20, 0x7ff00000
    s_nop 0
    v_cndmask_b32 v10, v10, v20, vcc
    s_lshl_b32 s3, s7, 7
    v_lshrrev_b32 v20, 3, v1
    v_lshlrev_b32 v21, 11, v20
    v_lshrrev_b32 v22, 2, v1
    v_lshrrev_b32 v23, 4, v1
    v_xor_b32 v22, v22, v23
    v_and_b32 v22, 1, v22
    v_lshl_add_u32 v21, v22, 6, v21
    v_and_b32 v22, 3, v1
    v_lshl_add_u32 v21, v22, 4, v21
    v_add_u32 v17, s3, v21
    s_add_u32 s52, s9, 1
    s_mov_b32 m0, s48
    s_add_u32 s50, s50, 1
    buffer_load_dwordx4 v5, s[12:15], s49 offen offset:0 sc1 lds
    s_waitcnt vmcnt(10)
    buffer_load_dwordx4 v5, s[12:15], s49 offen offset:1024 sc1 lds
    s_waitcnt vmcnt(10)
    buffer_load_dwordx4 v5, s[12:15], s49 offen offset:2048 sc1 lds
    s_waitcnt vmcnt(10)
    buffer_load_dwordx4 v5, s[12:15], s49 offen offset:3072 sc1 lds
    s_waitcnt vmcnt(10)
    s_add_u32 s49, s49, 4096
    s_bitcmp1_b32 s50, 0
    s_cselect_b32 s3, 0, 16384
    s_add_u32 s48, s48, s3
    s_cmp_eq_u32 s50, 12
    s_cselect_b32 s3, 4294819840, 0
    s_add_u32 s48, s48, 4096
    s_add_u32 s48, s48, s3
l_qkv_pre:
    s_mov_b32 m0, s48
    s_add_u32 s50, s50, 1
    buffer_load_dwordx4 v5, s[12:15], s49 offen offset:0 sc1 lds
    s_waitcnt vmcnt(10)
    buffer_load_dwordx4 v5, s[12:15], s49 offen offset:1024 sc1 lds
    s_waitcnt vmcnt(10)
    buffer_load_dwordx4 v5, s[12:15], s49 offen offset:2048 sc1 lds
    s_waitcnt vmcnt(10)
    buffer_load_dwordx4 v5, s[12:15], s49 offen offset:3072 sc1 lds
    s_waitcnt vmcnt(10)
    s_add_u32 s49, s49, 4096
    s_bitcmp1_b32 s50, 0
    s_cselect_b32 s3, 0, 16384
    s_add_u32 s48, s48, s3
    s_cmp_eq_u32 s50, 12
    s_cselect_b32 s3, 4294819840, 0
    s_add_u32 s48, s48, 4096
    s_add_u32 s48, s48, s3
    ds_read_b32 v8, v13
    s_cmp_ge_u32 s50, 12
    s_cbranch_scc1 l_qkv_go
    s_waitcnt lgkmcnt(0)
    v_readfirstlane_b32 s3, v8
    s_cmp_lg_u32 s3, s52
    s_cbranch_scc1 l_qkv_pre
    s_cmp_ge_u32 s50, 5
    s_cbranch_scc1 l_qkv_go
    s_waitcnt vmcnt(8)
l_qkv_go:
    s_waitcnt lgkmcnt(0)
    s_barrier
    s_barrier
    s_bitcmp0_b32 s50, 0
    s_cbranch_scc1 l_qkv_even
    s_mov_b32 m0, s48
    s_add_u32 s50, s50, 1
    buffer_load_dwordx4 v5, s[12:15], s49 offen offset:0 sc1 lds
    buffer_load_dwordx4 v5, s[12:15], s49 offen offset:1024 sc1 lds
    buffer_load_dwordx4 v5, s[12:15], s49 offen offset:2048 sc1 lds
    buffer_load_dwordx4 v5, s[12:15], s49 offen offset:3072 sc1 lds
    s_add_u32 s49, s49, 4096
    s_bitcmp1_b32 s50, 0
    s_cselect_b32 s3, 0, 16384
    s_add_u32 s48, s48, s3
    s_cmp_eq_u32 s50, 12
    s_cselect_b32 s3, 4294819840, 0
    s_add_u32 s48, s48, 4096
    s_add_u32 s48, s48, s3
l_qkv_even:
    s_cmp_gt_u32 s50, 10
    s_cbranch_scc1 stg_12
    s_mov_b32 m0, s48
    s_add_u32 s50, s50, 1
    buffer_load_dwordx4 v5, s[12:15], s49 offen offset:0 sc1 lds
    buffer_load_dwordx4 v5, s[12:15], s49 offen offset:1024 sc1 lds
    buffer_load_dwordx4 v5, s[12:15], s49 offen offset:2048 sc1 lds
    buffer_load_dwordx4 v5, s[12:15], s49 offen offset:3072 sc1 lds
    s_add_u32 s49, s49, 4096
    s_bitcmp1_b32 s50, 0
    s_cselect_b32 s3, 0, 16384
    s_add_u32 s48, s48, s3
    s_cmp_eq_u32 s50, 12
    s_cselect_b32 s3, 4294819840, 0
    s_add_u32 s48, s48, 4096
    s_add_u32 s48, s48, s3
    s_mov_b32 m0, s48
    s_add_u32 s50, s50, 1
    buffer_load_dwordx4 v5, s[12:15], s49 offen offset:0 sc1 lds
    buffer_load_dwordx4 v5, s[12:15], s49 offen offset:1024 sc1 lds
    buffer_load_dwordx4 v5, s[12:15], s49 offen offset:2048 sc1 lds
    buffer_load_dwordx4 v5, s[12:15], s49 offen offset:3072 sc1 lds
    s_add_u32 s49, s49, 4096
    s_bitcmp1_b32 s50, 0
    s_cselect_b32 s3, 0, 16384
    s_add_u32 s48, s48, s3
    s_cmp_eq_u32 s50, 12
    s_cselect_b32 s3, 4294819840, 0
    s_add_u32 s48, s48, 4096
    s_add_u32 s48, s48, s3
stg_12:
    s_waitcnt vmcnt(8)
    s_barrier
    s_cmp_gt_u32 s50, 12
    s_cbranch_scc1 stg_13
    s_mov_b32 m0, s48
    s_add_u32 s50, s50, 1
    buffer_load_dwordx4 v5, s[12:15], s49 offen offset:0 sc1 lds
    buffer_load_dwordx4 v5, s[12:15], s49 offen offset:1024 sc1 lds
    buffer_load_dwordx4 v5, s[12:15], s49 offen offset:2048 sc1 lds
    buffer_load_dwordx4 v5, s[12:15], s49 offen offset:3072 sc1 lds
    s_add_u32 s49, s49, 4096
    s_bitcmp1_b32 s50, 0
    s_cselect_b32 s3, 0, 16384
    s_add_u32 s48, s48, s3
    s_cmp_eq_u32 s50, 12
    s_cselect_b32 s3, 4294819840, 0
    s_add_u32 s48, s48, 4096
    s_add_u32 s48, s48, s3
    s_mov_b32 m0, s48
    s_add_u32 s50, s50, 1
    buffer_load_dwordx4 v5, s[12:15], s49 offen offset:0 sc1 lds
    buffer_load_dwordx4 v5, s[12:15], s49 offen offset:1024 sc1 lds
    buffer_load_dwordx4 v5, s[12:15], s49 offen offset:2048 sc1 lds
    buffer_load_dwordx4 v5, s[12:15], s49 offen offset:3072 sc1 lds
    s_add_u32 s49, s49, 4096
    s_bitcmp1_b32 s50, 0
    s_cselect_b32 s3, 0, 16384
    s_add_u32 s48, s48, s3
    s_cmp_eq_u32 s50, 12
    s_cselect_b32 s3, 4294819840, 0
    s_add_u32 s48, s48, 4096
    s_add_u32 s48, s48, s3
stg_13:
    s_cmp_eq_u32 s60, 0
    s_cbranch_scc1 ub_14
    buffer_store_dwordx4 v[168:171], v14, s[12:15], s57 offen offset:0 sc1
    v_mfma_f32_16x16x32_bf16 v[28:31], v[24:27], v[168:171], 0
    buffer_store_dwordx4 v[172:175], v14, s[12:15], s57 offen offset:512 sc1
    v_mfma_f32_16x16x32_bf16 v[28:31], v[24:27], v[172:175], v[28:31]
ub_14:
    s_waitcnt vmcnt(8)
    s_barrier
    s_cmp_gt_u32 s50, 14
    s_cbranch_scc1 stg_15
    s_mov_b32 m0, s48
    s_add_u32 s50, s50, 1
    buffer_load_dwordx4 v5, s[12:15], s49 offen offset:0 sc1 lds
    buffer_load_dwordx4 v5, s[12:15], s49 offen offset:1024 sc1 lds
    buffer_load_dwordx4 v5, s[12:15], s49 offen offset:2048 sc1 lds
    buffer_load_dwordx4 v5, s[12:15], s49 offen offset:3072 sc1 lds
    s_add_u32 s49, s49, 4096
    s_bitcmp1_b32 s50, 0
    s_cselect_b32 s3, 0, 16384
    s_add_u32 s48, s48, s3
    s_cmp_eq_u32 s50, 12
    s_cselect_b32 s3, 4294819840, 0
    s_add_u32 s48, s48, 4096
    s_add_u32 s48, s48, s3
    s_mov_b32 m0, s48
    s_add_u32 s50, s50, 1
    buffer_load_dwordx4 v5, s[12:15], s49 offen offset:0 sc1 lds
    buffer_load_dwordx4 v5, s[12:15], s49 offen offset:1024 sc1 lds
    buffer_load_dwordx4 v5, s[12:15], s49 offen offset:2048 sc1 lds
    buffer_load_dwordx4 v5, s[12:15], s49 offen offset:3072 sc1 lds
    s_add_u32 s49, s49, 4096
    s_bitcmp1_b32 s50, 0
    s_cselect_b32 s3, 0, 16384
    s_add_u32 s48, s48, s3
    s_cmp_eq_u32 s50, 12
    s_cselect_b32 s3, 4294819840, 0
    s_add_u32 s48, s48, 4096
    s_add_u32 s48, s48, s3
stg_15:
    s_cmp_eq_u32 s60, 0
    s_cbranch_scc1 ub_16
    buffer_store_dwordx4 v[176:179], v14, s[12:15], s57 offen offset:1024 sc1
    v_mfma_f32_16x16x32_bf16 v[28:31], v[24:27], v[176:179], v[28:31]
    buffer_store_dwordx4 v[180:183], v14, s[12:15], s57 offen offset:1536 sc1
    v_mfma_f32_16x16x32_bf16 v[28:31], v[24:27], v[180:183], v[28:31]
ub_16:
    s_waitcnt vmcnt(8)
    s_barrier
    s_cmp_gt_u32 s50, 14
    s_cbranch_scc1 stg_17
    s_mov_b32 m0, s48
    s_add_u32 s50, s50, 1
    buffer_load_dwordx4 v5, s[12:15], s49 offen offset:0 sc1 lds
    buffer_load_dwordx4 v5, s[12:15], s49 offen offset:1024 sc1 lds
    buffer_load_dwordx4 v5, s[12:15], s49 offen offset:2048 sc1 lds
    buffer_load_dwordx4 v5, s[12:15], s49 offen offset:3072 sc1 lds
    s_add_u32 s49, s49, 4096
    s_bitcmp1_b32 s50, 0
    s_cselect_b32 s3, 0, 16384
    s_add_u32 s48, s48, s3
    s_cmp_eq_u32 s50, 12
    s_cselect_b32 s3, 4294819840, 0
    s_add_u32 s48, s48, 4096
    s_add_u32 s48, s48, s3
    s_mov_b32 m0, s48
    s_add_u32 s50, s50, 1
    buffer_load_dwordx4 v5, s[12:15], s49 offen offset:0 sc1 lds
    buffer_load_dwordx4 v5, s[12:15], s49 offen offset:1024 sc1 lds
    buffer_load_dwordx4 v5, s[12:15], s49 offen offset:2048 sc1 lds
    buffer_load_dwordx4 v5, s[12:15], s49 offen offset:3072 sc1 lds
    s_add_u32 s49, s49, 4096
    s_bitcmp1_b32 s50, 0
    s_cselect_b32 s3, 0, 16384
    s_add_u32 s48, s48, s3
    s_cmp_eq_u32 s50, 12
    s_cselect_b32 s3, 4294819840, 0
    s_add_u32 s48, s48, 4096
    s_add_u32 s48, s48, s3
stg_17:
    s_cmp_eq_u32 s60, 0
    s_cbranch_scc1 ub_18
    buffer_store_dwordx4 v[184:187], v14, s[12:15], s57 offen offset:2048 sc1
    v_mfma_f32_16x16x32_bf16 v[28:31], v[24:27], v[184:187], v[28:31]
    buffer_store_dwordx4 v[188:191], v14, s[12:15], s57 offen offset:2560 sc1
    v_mfma_f32_16x16x32_bf16 v[28:31], v[24:27], v[188:191], v[28:31]
ub_18:
    buffer_load_dwordx4 v[72:75], v10, s[12:15], s59 offen offset:0 sc1
    buffer_load_dwordx4 v[76:79], v10, s[12:15], s59 offen offset:256 sc1
    buffer_load_dwordx4 v[80:83], v10, s[12:15], s59 offen offset:512 sc1
    buffer_load_dwordx4 v[84:87], v10, s[12:15], s59 offen offset:768 sc1
    buffer_load_dwordx4 v[88:91], v10, s[12:15], s59 offen offset:1024 sc1
    s_waitcnt vmcnt(8)
    s_barrier
    s_waitcnt vmcnt(0)
    s_cmp_gt_u32 s50, 14
    s_cbranch_scc1 stg_19
    s_mov_b32 m0, s48
    s_add_u32 s50, s50, 1
    buffer_load_dwordx4 v5, s[12:15], s49 offen offset:0 sc1 lds
    buffer_load_dwordx4 v5, s[12:15], s49 offen offset:1024 sc1 lds
    buffer_load_dwordx4 v5, s[12:15], s49 offen offset:2048 sc1 lds
    buffer_load_dwordx4 v5, s[12:15], s49 offen offset:3072 sc1 lds
    s_add_u32 s49, s49, 4096
    s_bitcmp1_b32 s50, 0
    s_cselect_b32 s3, 0, 16384
    s_add_u32 s48, s48, s3
    s_cmp_eq_u32 s50, 12
    s_cselect_b32 s3, 4294819840, 0
    s_add_u32 s48, s48, 4096
    s_add_u32 s48, s48, s3
    s_mov_b32 m0, s48
    s_add_u32 s50, s50, 1
    buffer_load_dwordx4 v5, s[12:15], s49 offen offset:0 sc1 lds
    buffer_load_dwordx4 v5, s[12:15], s49 offen offset:1024 sc1 lds
    buffer_load_dwordx4 v5, s[12:15], s49 offen offset:2048 sc1 lds
    buffer_load_dwordx4 v5, s[12:15], s49 offen offset:3072 sc1 lds
    s_add_u32 s49, s49, 4096
    s_bitcmp1_b32 s50, 0
    s_cselect_b32 s3, 0, 16384
    s_add_u32 s48, s48, s3
    s_cmp_eq_u32 s50, 12
    s_cselect_b32 s3, 4294819840, 0
    s_add_u32 s48, s48, 4096
    s_add_u32 s48, s48, s3
stg_19:
    s_cmp_eq_u32 s60, 0
    s_cbranch_scc1 ub_20
    buffer_store_dwordx4 v[192:195], v14, s[12:15], s57 offen offset:3072 sc1
    v_mfma_f32_16x16x32_bf16 v[28:31], v[24:27], v[192:195], v[28:31]
    buffer_store_dwordx4 v[196:199], v14, s[12:15], s57 offen offset:3584 sc1
    v_mfma_f32_16x16x32_bf16 v[28:31], v[24:27], v[196:199], v[28:31]
ub_20:
    buffer_load_dwordx4 v[92:95], v10, s[12:15], s59 offen offset:1280 sc1
    buffer_load_dwordx4 v[96:99], v10, s[12:15], s59 offen offset:1536 sc1
    buffer_load_dwordx4 v[100:103], v10, s[12:15], s59 offen offset:1792 sc1
    buffer_load_dwordx4 v[104:107], v10, s[12:15], s59 offen offset:2048 sc1
    buffer_load_dwordx4 v[108:111], v10, s[12:15], s59 offen offset:2304 sc1
    v_add_f32 v72, v72, v76
    v_add_f32 v73, v73, v77
    v_add_f32 v74, v74, v78
    v_add_f32 v75, v75, v79
    v_add_f32 v72, v72, v80
    v_add_f32 v73, v73, v81
    v_add_f32 v74, v74, v82
    v_add_f32 v75, v75, v83
    v_add_f32 v72, v72, v84
    v_add_f32 v73, v73, v85
    v_add_f32 v74, v74, v86
    v_add_f32 v75, v75, v87
    v_add_f32 v72, v72, v88
    v_add_f32 v73, v73, v89
    v_add_f32 v74, v74, v90
    v_add_f32 v75, v75, v91
    s_waitcnt vmcnt(8)
    s_barrier
    s_waitcnt vmcnt(0)
    s_cmp_gt_u32 s50, 14
    s_cbranch_scc1 stg_21
    s_mov_b32 m0, s48
    s_add_u32 s50, s50, 1
    buffer_load_dwordx4 v5, s[12:15], s49 offen offset:0 sc1 lds
    buffer_load_dwordx4 v5, s[12:15], s49 offen offset:1024 sc1 lds
    buffer_load_dwordx4 v5, s[12:15], s49 offen offset:2048 sc1 lds
    buffer_load_dwordx4 v5, s[12:15], s49 offen offset:3072 sc1 lds
    s_add_u32 s49, s49, 4096
    s_bitcmp1_b32 s50, 0
    s_cselect_b32 s3, 0, 16384
    s_add_u32 s48, s48, s3
    s_cmp_eq_u32 s50, 12
    s_cselect_b32 s3, 4294819840, 0
    s_add_u32 s48, s48, 4096
    s_add_u32 s48, s48, s3
    s_mov_b32 m0, s48
    s_add_u32 s50, s50, 1
    buffer_load_dwordx4 v5, s[12:15], s49 offen offset:0 sc1 lds
    buffer_load_dwordx4 v5, s[12:15], s49 offen offset:1024 sc1 lds
    buffer_load_dwordx4 v5, s[12:15], s49 offen offset:2048 sc1 lds
    buffer_load_dwordx4 v5, s[12:15], s49 offen offset:3072 sc1 lds
    s_add_u32 s49, s49, 4096
    s_bitcmp1_b32 s50, 0
    s_cselect_b32 s3, 0, 16384
    s_add_u32 s48, s48, s3
    s_cmp_eq_u32 s50, 12
    s_cselect_b32 s3, 4294819840, 0
    s_add_u32 s48, s48, 4096
    s_add_u32 s48, s48, s3
stg_21:
    s_cmp_eq_u32 s60, 0
    s_cbranch_scc1 ub_22
    v_add_f32_dpp v28, v28, v28 row_ror:8 row_mask:0xf bank_mask:0xf
    v_add_f32_dpp v29, v29, v29 row_ror:8 row_mask:0xf bank_mask:0xf
    v_add_f32_dpp v30, v30, v30 row_ror:8 row_mask:0xf bank_mask:0xf
    v_add_f32_dpp v31, v31, v31 row_ror:8 row_mask:0xf bank_mask:0xf
    s_mov_b64 exec, 0x00ff00ff
    buffer_store_dwordx4 v[28:31], v15, s[12:15], s54 offen sc1
    s_mov_b64 exec, -1
ub_22:
    buffer_load_dwordx4 v[112:115], v10, s[12:15], s59 offen offset:2560 sc1
    buffer_load_dwordx4 v[116:119], v10, s[12:15], s59 offen offset:2816 sc1
    buffer_load_dwordx4 v[120:123], v10, s[12:15], s59 offen offset:3072 sc1
    buffer_load_dwordx4 v[124:127], v10, s[12:15], s59 offen offset:3328 sc1
    buffer_load_dwordx4 v[128:131], v10, s[12:15], s59 offen offset:3584 sc1
    buffer_load_dwordx4 v[132:135], v10, s[12:15], s59 offen offset:3840 sc1
    v_add_f32 v72, v72, v92
    v_add_f32 v73, v73, v93
    v_add_f32 v74, v74, v94
    v_add_f32 v75, v75, v95
    v_add_f32 v72, v72, v96
    v_add_f32 v73, v73, v97
    v_add_f32 v74, v74, v98
    v_add_f32 v75, v75, v99
    v_add_f32 v72, v72, v100
    v_add_f32 v73, v73, v101
    v_add_f32 v74, v74, v102
    v_add_f32 v75, v75, v103
    v_add_f32 v72, v72, v104
    v_add_f32 v73, v73, v105
    v_add_f32 v74, v74, v106
    v_add_f32 v75, v75, v107
    v_add_f32 v72, v72, v108
    v_add_f32 v73, v73, v109
    v_add_f32 v74, v74, v110
    v_add_f32 v75, v75, v111
    s_waitcnt vmcnt(8)
    s_barrier
    s_waitcnt vmcnt(0)
    v_add_f32 v72, v72, v112
    v_add_f32 v73, v73, v113
    v_add_f32 v74, v74, v114
    v_add_f32 v75, v75, v115
    v_add_f32 v72, v72, v116
    v_add_f32 v73, v73, v117
    v_add_f32 v74, v74, v118
    v_add_f32 v75, v75, v119
    v_add_f32 v72, v72, v120
    v_add_f32 v73, v73, v121
    v_add_f32 v74, v74, v122
    v_add_f32 v75, v75, v123
    v_add_f32 v72, v72, v124
    v_add_f32 v73, v73, v125
    v_add_f32 v74, v74, v126
    v_add_f32 v75, v75, v127
    v_add_f32 v72, v72, v128
    v_add_f32 v73, v73, v129
    v_add_f32 v74, v74, v130
    v_add_f32 v75, v75, v131
    v_add_f32 v72, v72, v132
    v_add_f32 v73, v73, v133
    v_add_f32 v74, v74, v134
    v_add_f32 v75, v75, v135
    v_mul_f32 v72, 0x3a800000, v72
    v_mul_f32 v74, 0x3a800000, v74
    v_mul_f32 v73, 0x3a800000, v73
    v_mul_f32 v75, 0x3a800000, v75
    v_fma_f32 v73, -v72, v72, v73
    v_fma_f32 v75, -v74, v74, v75
    v_max_f32 v73, 0, v73
    v_max_f32 v75, 0, v75
    v_add_f32 v73, 0x3727c5ac, v73
    v_add_f32 v75, 0x3727c5ac, v75
    v_rsq_f32 v73, v73
    v_rsq_f32 v75, v75
    v_swap_b32 v73, v74
    ds_write_b64 v11, v[72:73] offset:768
    ds_write_b64 v11, v[74:75] offset:2304
    s_waitcnt lgkmcnt(0)
    s_waitcnt vmcnt(0)
    s_barrier
    s_cmp_eq_u32 s60, 0
    s_cbranch_scc1 ub_23
    s_mov_b64 exec, 0xffff
    buffer_store_dword v9, v16, s[12:15], s55 offen offset:384 sc1
    s_mov_b64 exec, -1
ub_23:
    s_add_u32 s60, s51, 48
    s_bitcmp1_b32 s9, 0
    s_cbranch_scc1 l_qkv_now6
    s_mov_b32 s24, s36
    s_mov_b32 s25, s37
    s_mov_b32 s26, 2097152
    s_mov_b32 s27, 0x00020000
wop_24:
    s_lshl_b32 m0, s60, 10
    s_lshl_b32 s3, s60, 14
    buffer_load_dwordx4 v17, s[24:27], s3 offen lds
    s_add_u32 s60, s60, 3
    s_waitcnt vmcnt(7)
    s_cmp_lt_u32 s60, 96
    s_cbranch_scc1 wop_24
l_qkv_now6:
    s_barrier
    s_bitcmp1_b32 s9, 0
    s_cbranch_scc1 s_attn
    s_mov_b32 s24, s36
    s_mov_b32 s25, s37
    s_mov_b32 s26, 2097152
    s_mov_b32 s27, 0x00020000
wop_25:
    s_lshl_b32 m0, s60, 10
    s_lshl_b32 s3, s60, 14
    buffer_load_dwordx4 v17, s[24:27], s3 offen lds
    s_add_u32 s60, s60, 3
    s_waitcnt vmcnt(7)
    s_cmp_lt_u32 s60, 128
    s_cbranch_scc1 wop_25
    s_mov_b32 s60, s51
wop_26:
    s_lshl_b32 m0, s60, 10
    s_lshl_b32 s3, s60, 14
    buffer_load_dwordx4 v17, s[24:27], s3 offen lds
    s_add_u32 s60, s60, 3
    s_waitcnt vmcnt(7)
    s_cmp_lt_u32 s60, 12
    s_cbranch_scc1 wop_26
    s_barrier
wop_27:
    s_lshl_b32 m0, s60, 10
    s_lshl_b32 s3, s60, 14
    buffer_load_dwordx4 v17, s[24:27], s3 offen lds
    s_add_u32 s60, s60, 3
    s_waitcnt vmcnt(7)
    s_cmp_lt_u32 s60, 48
    s_cbranch_scc1 wop_27
    s_branch l_wo
.p2align 6
h_wo:
l_wo:
    s_waitcnt vmcnt(0)
    s_barrier
    s_cmp_eq_u32 s8, 4
    s_cbranch_scc1 l_wo_end
    s_cmp_lg_u32 s9, 0
    s_cbranch_scc1 l_wo_end
    s_lshl_b32 s53, s8, 7
    s_lshl_b32 s52, s11, 10
    s_add_u32 s53, s53, s52
    s_add_u32 s53, s53, 64487168
    s_add_u32 s96, s4, s53
    s_addc_u32 s97, s5, 0
    s_mov_b32 s98, s10
    s_mov_b32 s99, s10
    s_mov_b32 s3, 0x20000
poll_28:
    s_load_dwordx16 s[80:95], s[96:97], 0 glc
    s_sub_u32 s3, s3, 1
    s_cbranch_scc1 poll_28_ok
    s_waitcnt lgkmcnt(0)
    s_xor_b64 s[100:101], s[80:81], s[98:99]
    s_xor_b64 s[80:81], s[82:83], s[98:99]
    s_or_b64 s[100:101], s[100:101], s[80:81]
    s_xor_b64 s[80:81], s[84:85], s[98:99]
    s_or_b64 s[100:101], s[100:101], s[80:81]
    s_xor_b64 s[80:81], s[86:87], s[98:99]
    s_or_b64 s[100:101], s[100:101], s[80:81]
    s_xor_b64 s[80:81], s[88:89], s[98:99]
    s_or_b64 s[100:101], s[100:101], s[80:81]
    s_xor_b64 s[80:81], s[90:91], s[98:99]
    s_or_b64 s[100:101], s[100:101], s[80:81]
    s_xor_b64 s[80:81], s[92:93], s[98:99]
    s_or_b64 s[100:101], s[100:101], s[80:81]
    s_xor_b64 s[80:81], s[94:95], s[98:99]
    s_or_b64 s[100:101], s[100:101], s[80:81]
    s_cbranch_scc1 poll_28
poll_28_ok:
    s_waitcnt lgkmcnt(0)
l_wo_end:
    s_barrier
    s_add_u32 s9, s9, 1
    s_cmp_eq_u32 s9, 4
    s_cbranch_scc1 k_exit
    s_cmp_lg_u32 s8, 4
    s_cbranch_scc1 l_qkv
    s_cmp_eq_u32 s9, 2
    s_cbranch_scc1 h_qkvA
    s_branch h_qkvB
.p2align 6
s_attn:
    s_sub_u32 s48, s8, 4
    s_lshl_b32 s3, s7, 7
    v_lshrrev_b32 v20, 3, v1
    v_lshlrev_b32 v21, 11, v20
    v_lshrrev_b32 v22, 2, v1
    v_lshrrev_b32 v23, 4, v1
    v_xor_b32 v22, v22, v23
    v_and_b32 v22, 1, v22
    v_lshl_add_u32 v21, v22, 6, v21
    v_and_b32 v22, 3, v1
    v_lshl_add_u32 v21, v22, 4, v21
    v_add_u32 v7, s3, v21
    s_mov_b32 s24, s42
    s_mov_b32 s25, s43
    s_mov_b32 s26, 2097152
    s_mov_b32 s27, 0x00020000
    s_lshr_b32 s49, s9, 1
    s_lshl_b32 s49, s49, 23
    s_lshl_b32 s52, s7, 19
    s_add_u32 s49, s49, s52
    s_and_b32 s52, s6, 1
    s_lshl_b32 s52, s52, 18
    s_add_u32 s49, s49, s52
    s_add_u32 s49, s49, 33554432
    s_lshr_b32 s61, s6, 1
    s_lshl_b32 s52, s48, 13
    s_add_u32 s53, s52, 81920
    v_add_u32 v8, s53, v5
    s_lshl_b32 s53, s61, 15
    s_add_u32 s52, s52, s53
    s_add_u32 s62, s52, s49
    s_add_u32 s63, s62, 4096
    s_mul_i32 s59, s9, 786432
    s_add_u32 s59, s59, 66322432
    s_and_b32 s52, s11, 31
    s_lshl_b32 s52, s52, 10
    s_add_u32 s59, s59, s52
    s_lshr_b32 s52, s61, 1
    s_lshl_b32 s52, s52, 7
    s_add_u32 s59, s59, s52
    s_and_b32 s52, s61, 1
    s_lshl_b32 s52, s52, 2
    s_add_u32 s52, s52, s48
    s_lshl_b32 s52, s52, 2
    s_add_u32 s59, s59, s52
    v_lshlrev_b32 v20, 15, v1
    v_mov_b32 v21, s10
    s_mul_i32 s54, s9, 786432
    s_add_u32 s54, s54, 66322432
    s_lshl_b32 s55, s11, 10
    s_add_u32 s54, s54, s55
    s_add_u32 s52, s4, s54
    s_addc_u32 s53, s5, 0
    s_mov_b32 s54, s10
    s_mov_b32 s55, s10
    s_lshl_b32 s51, s48, 11
    s_add_u32 s49, s49, s51
    s_add_u32 s51, s51, 81920
    s_mov_b32 s60, s48
    s_setprio 3
    s_barrier
    ds_read_b128 v[32:35], v8 offset:0
    ds_read_b128 v[36:39], v8 offset:1024
    ds_read_b128 v[40:43], v8 offset:2048
    ds_read_b128 v[44:47], v8 offset:3072
    ds_read_b128 v[48:51], v8 offset:4096
    ds_read_b128 v[52:55], v8 offset:5120
    ds_read_b128 v[56:59], v8 offset:6144
    ds_read_b128 v[60:63], v8 offset:7168
    s_waitcnt lgkmcnt(7)
    buffer_store_dwordx4 v[32:35], v5, s[12:15], s62 offen offset:0 sc1
    s_waitcnt lgkmcnt(6)
    buffer_store_dwordx4 v[36:39], v5, s[12:15], s62 offen offset:1024 sc1
    s_waitcnt lgkmcnt(5)
    buffer_store_dwordx4 v[40:43], v5, s[12:15], s62 offen offset:2048 sc1
    s_waitcnt lgkmcnt(4)
    buffer_store_dwordx4 v[44:47], v5, s[12:15], s62 offen offset:3072 sc1
    s_waitcnt lgkmcnt(3)
    buffer_store_dwordx4 v[48:51], v5, s[12:15], s63 offen offset:0 sc1
    s_waitcnt lgkmcnt(2)
    buffer_store_dwordx4 v[52:55], v5, s[12:15], s63 offen offset:1024 sc1
    s_waitcnt lgkmcnt(1)
    buffer_store_dwordx4 v[56:59], v5, s[12:15], s63 offen offset:2048 sc1
    s_waitcnt lgkmcnt(0)
    buffer_store_dwordx4 v[60:63], v5, s[12:15], s63 offen offset:3072 sc1
    s_mov_b64 exec, 0xff
    s_waitcnt vmcnt(0)
    buffer_store_dword v21, v20, s[12:15], s59 offen sc1
    s_mov_b64 exec, -1
    s_lshl_b32 s58, 1, s61
    s_mov_b32 s57, 0
    s_add_u32 s62, s61, 1
    s_and_b32 s62, s62, 7
    s_lshl_b32 s50, s62, 15
    s_add_u32 s50, s50, s49
    s_lshr_b32 s63, s62, 1
    s_lshl_b32 s63, s63, 7
    s_and_b32 s62, s62, 1
    s_lshl_b32 s62, s62, 4
    s_add_u32 s62, s62, s63
    s_mov_b32 s58, 0x20000
need_29:
    s_load_dwordx4 s[64:67], s[52:53], s62 glc
    s_sub_u32 s58, s58, 1
    s_cbranch_scc1 need_29_ok
    s_waitcnt lgkmcnt(0)
    s_xor_b64 s[64:65], s[64:65], s[54:55]
    s_xor_b64 s[66:67], s[66:67], s[54:55]
    s_or_b64 s[64:65], s[64:65], s[66:67]
    s_cbranch_scc1 need_29
need_29_ok:
    s_waitcnt lgkmcnt(0)
    s_add_u32 m0, s51, 32768
    s_nop 0
    buffer_load_dwordx4 v5, s[12:15], s50 offen offset:0 sc1 lds
    buffer_load_dwordx4 v5, s[12:15], s50 offen offset:1024 sc1 lds
    s_add_u32 s50, s50, 8192
    s_add_u32 m0, s51, 40960
    s_nop 0
    buffer_load_dwordx4 v5, s[12:15], s50 offen offset:0 sc1 lds
    buffer_load_dwordx4 v5, s[12:15], s50 offen offset:1024 sc1 lds
    s_add_u32 s50, s50, 8192
    s_add_u32 m0, s51, 49152
    s_nop 0
    buffer_load_dwordx4 v5, s[12:15], s50 offen offset:0 sc1 lds
    buffer_load_dwordx4 v5, s[12:15], s50 offen offset:1024 sc1 lds
    s_add_u32 s50, s50, 8192
    s_add_u32 m0, s51, 57344
    s_nop 0
    buffer_load_dwordx4 v5, s[12:15], s50 offen offset:0 sc1 lds
    buffer_load_dwordx4 v5, s[12:15], s50 offen offset:1024 sc1 lds
    s_add_u32 s50, s50, 8192
    s_waitcnt vmcnt(4)
    s_barrier
    s_add_u32 s62, s61, 2
    s_and_b32 s62, s62, 7
    s_lshl_b32 s50, s62, 15
    s_add_u32 s50, s50, s49
    s_lshr_b32 s63, s62, 1
    s_lshl_b32 s63, s63, 7
    s_and_b32 s62, s62, 1
    s_lshl_b32 s62, s62, 4
    s_add_u32 s62, s62, s63
    s_mov_b32 s58, 0x20000
need_30:
    s_load_dwordx4 s[64:67], s[52:53], s62 glc
    s_sub_u32 s58, s58, 1
    s_cbranch_scc1 need_30_ok
    s_waitcnt lgkmcnt(0)
    s_xor_b64 s[64:65], s[64:65], s[54:55]
    s_xor_b64 s[66:67], s[66:67], s[54:55]
    s_or_b64 s[64:65], s[64:65], s[66:67]
    s_cbranch_scc1 need_30
need_30_ok:
    s_waitcnt lgkmcnt(0)
    s_add_u32 m0, s51, 0
    s_nop 0
    buffer_load_dwordx4 v5, s[12:15], s50 offen offset:0 sc1 lds
    buffer_load_dwordx4 v5, s[12:15], s50 offen offset:1024 sc1 lds
    s_add_u32 s50, s50, 8192
    s_add_u32 m0, s51, 8192
    s_nop 0
    buffer_load_dwordx4 v5, s[12:15], s50 offen offset:0 sc1 lds
    buffer_load_dwordx4 v5, s[12:15], s50 offen offset:1024 sc1 lds
    s_add_u32 s50, s50, 8192
    s_waitcnt vmcnt(4)
    s_barrier
    s_add_u32 m0, s51, 16384
    s_nop 0
    buffer_load_dwordx4 v5, s[12:15], s50 offen offset:0 sc1 lds
    buffer_load_dwordx4 v5, s[12:15], s50 offen offset:1024 sc1 lds
    s_add_u32 s50, s50, 8192
    s_add_u32 m0, s51, 24576
    s_nop 0
    buffer_load_dwordx4 v5, s[12:15], s50 offen offset:0 sc1 lds
    buffer_load_dwordx4 v5, s[12:15], s50 offen offset:1024 sc1 lds
    s_add_u32 s50, s50, 8192
    s_waitcnt vmcnt(4)
    s_barrier
    s_add_u32 s62, s61, 3
    s_and_b32 s62, s62, 7
    s_lshl_b32 s50, s62, 15
    s_add_u32 s50, s50, s49
    s_lshr_b32 s63, s62, 1
    s_lshl_b32 s63, s63, 7
    s_and_b32 s62, s62, 1
    s_lshl_b32 s62, s62, 4
    s_add_u32 s62, s62, s63
    s_mov_b32 s58, 0x20000
need_31:
    s_load_dwordx4 s[64:67], s[52:53], s62 glc
    s_sub_u32 s58, s58, 1
    s_cbranch_scc1 need_31_ok
    s_waitcnt lgkmcnt(0)
    s_xor_b64 s[64:65], s[64:65], s[54:55]
    s_xor_b64 s[66:67], s[66:67], s[54:55]
    s_or_b64 s[64:65], s[64:65], s[66:67]
    s_cbranch_scc1 need_31
need_31_ok:
    s_waitcnt lgkmcnt(0)
    s_add_u32 m0, s51, 32768
    s_nop 0
    buffer_load_dwordx4 v5, s[12:15], s50 offen offset:0 sc1 lds
    buffer_load_dwordx4 v5, s[12:15], s50 offen offset:1024 sc1 lds
    s_add_u32 s50, s50, 8192
    s_add_u32 m0, s51, 40960
    s_nop 0
    buffer_load_dwordx4 v5, s[12:15], s50 offen offset:0 sc1 lds
    buffer_load_dwordx4 v5, s[12:15], s50 offen offset:1024 sc1 lds
    s_add_u32 s50, s50, 8192
    s_lshl_b32 m0, s60, 10
    s_lshl_b32 s3, s60, 14
    buffer_load_dwordx4 v7, s[24:27], s3 offen lds
    s_add_u32 s60, s60, 4
    s_lshl_b32 m0, s60, 10
    s_lshl_b32 s3, s60, 14
    buffer_load_dwordx4 v7, s[24:27], s3 offen lds
    s_add_u32 s60, s60, 4
    s_waitcnt vmcnt(6)
    s_barrier
    s_add_u32 m0, s51, 49152
    s_nop 0
    buffer_load_dwordx4 v5, s[12:15], s50 offen offset:0 sc1 lds
    buffer_load_dwordx4 v5, s[12:15], s50 offen offset:1024 sc1 lds
    s_add_u32 s50, s50, 8192
    s_add_u32 m0, s51, 57344
    s_nop 0
    buffer_load_dwordx4 v5, s[12:15], s50 offen offset:0 sc1 lds
    buffer_load_dwordx4 v5, s[12:15], s50 offen offset:1024 sc1 lds
    s_add_u32 s50, s50, 8192
    s_lshl_b32 m0, s60, 10
    s_lshl_b32 s3, s60, 14
    buffer_load_dwordx4 v7, s[24:27], s3 offen lds
    s_add_u32 s60, s60, 4
    s_lshl_b32 m0, s60, 10
    s_lshl_b32 s3, s60, 14
    buffer_load_dwordx4 v7, s[24:27], s3 offen lds
    s_add_u32 s60, s60, 4
    s_waitcnt vmcnt(8)
    s_barrier
    s_add_u32 s62, s61, 4
    s_and_b32 s62, s62, 7
    s_lshl_b32 s50, s62, 15
    s_add_u32 s50, s50, s49
    s_lshr_b32 s63, s62, 1
    s_lshl_b32 s63, s63, 7
    s_and_b32 s62, s62, 1
    s_lshl_b32 s62, s62, 4
    s_add_u32 s62, s62, s63
    s_mov_b32 s58, 0x20000
need_32:
    s_load_dwordx4 s[64:67], s[52:53], s62 glc
    s_sub_u32 s58, s58, 1
    s_cbranch_scc1 need_32_ok
    s_waitcnt lgkmcnt(0)
    s_xor_b64 s[64:65], s[64:65], s[54:55]
    s_xor_b64 s[66:67], s[66:67], s[54:55]
    s_or_b64 s[64:65], s[64:65], s[66:67]
    s_cbranch_scc1 need_32
need_32_ok:
    s_waitcnt lgkmcnt(0)
    s_add_u32 m0, s51, 0
    s_nop 0
    buffer_load_dwordx4 v5, s[12:15], s50 offen offset:0 sc1 lds
    buffer_load_dwordx4 v5, s[12:15], s50 offen offset:1024 sc1 lds
    s_add_u32 s50, s50, 8192
    s_add_u32 m0, s51, 8192
    s_nop 0
    buffer_load_dwordx4 v5, s[12:15], s50 offen offset:0 sc1 lds
    buffer_load_dwordx4 v5, s[12:15], s50 offen offset:1024 sc1 lds
    s_add_u32 s50, s50, 8192
    s_lshl_b32 m0, s60, 10
    s_lshl_b32 s3, s60, 14
    buffer_load_dwordx4 v7, s[24:27], s3 offen lds
    s_add_u32 s60, s60, 4
    s_lshl_b32 m0, s60, 10
    s_lshl_b32 s3, s60, 14
    buffer_load_dwordx4 v7, s[24:27], s3 offen lds
    s_add_u32 s60, s60, 4
    s_waitcnt vmcnt(8)
    s_barrier
    s_add_u32 m0, s51, 16384
    s_nop 0
    buffer_load_dwordx4 v5, s[12:15], s50 offen offset:0 sc1 lds
    buffer_load_dwordx4 v5, s[12:15], s50 offen offset:1024 sc1 lds
    s_add_u32 s50, s50, 8192
    s_add_u32 m0, s51, 24576
    s_nop 0
    buffer_load_dwordx4 v5, s[12:15], s50 offen offset:0 sc1 lds
    buffer_load_dwordx4 v5, s[12:15], s50 offen offset:1024 sc1 lds
    s_add_u32 s50, s50, 8192
    s_lshl_b32 m0, s60, 10
    s_lshl_b32 s3, s60, 14
    buffer_load_dwordx4 v7, s[24:27], s3 offen lds
    s_add_u32 s60, s60, 4
    s_lshl_b32 m0, s60, 10
    s_lshl_b32 s3, s60, 14
    buffer_load_dwordx4 v7, s[24:27], s3 offen lds
    s_add_u32 s60, s60, 4
    s_waitcnt vmcnt(8)
    s_barrier
    s_add_u32 s62, s61, 5
    s_and_b32 s62, s62, 7
    s_lshl_b32 s50, s62, 15
    s_add_u32 s50, s50, s49
    s_lshr_b32 s63, s62, 1
    s_lshl_b32 s63, s63, 7
    s_and_b32 s62, s62, 1
    s_lshl_b32 s62, s62, 4
    s_add_u32 s62, s62, s63
    s_mov_b32 s58, 0x20000
need_33:
    s_load_dwordx4 s[64:67], s[52:53], s62 glc
    s_sub_u32 s58, s58, 1
    s_cbranch_scc1 need_33_ok
    s_waitcnt lgkmcnt(0)
    s_xor_b64 s[64:65], s[64:65], s[54:55]
    s_xor_b64 s[66:67], s[66:67], s[54:55]
    s_or_b64 s[64:65], s[64:65], s[66:67]
    s_cbranch_scc1 need_33
need_33_ok:
    s_waitcnt lgkmcnt(0)
    s_add_u32 m0, s51, 32768
    s_nop 0
    buffer_load_dwordx4 v5, s[12:15], s50 offen offset:0 sc1 lds
    buffer_load_dwordx4 v5, s[12:15], s50 offen offset:1024 sc1 lds
    s_add_u32 s50, s50, 8192
    s_add_u32 m0, s51, 40960
    s_nop 0
    buffer_load_dwordx4 v5, s[12:15], s50 offen offset:0 sc1 lds
    buffer_load_dwordx4 v5, s[12:15], s50 offen offset:1024 sc1 lds
    s_add_u32 s50, s50, 8192
    s_lshl_b32 m0, s60, 10
    s_lshl_b32 s3, s60, 14
    buffer_load_dwordx4 v7, s[24:27], s3 offen lds
    s_add_u32 s60, s60, 4
    s_lshl_b32 m0, s60, 10
    s_lshl_b32 s3, s60, 14
    buffer_load_dwordx4 v7, s[24:27], s3 offen lds
    s_add_u32 s60, s60, 4
    s_waitcnt vmcnt(8)
    s_barrier
    s_add_u32 m0, s51, 49152
    s_nop 0
    buffer_load_dwordx4 v5, s[12:15], s50 offen offset:0 sc1 lds
    buffer_load_dwordx4 v5, s[12:15], s50 offen offset:1024 sc1 lds
    s_add_u32 s50, s50, 8192
    s_add_u32 m0, s51, 57344
    s_nop 0
    buffer_load_dwordx4 v5, s[12:15], s50 offen offset:0 sc1 lds
    buffer_load_dwordx4 v5, s[12:15], s50 offen offset:1024 sc1 lds
    s_add_u32 s50, s50, 8192
    s_lshl_b32 m0, s60, 10
    s_lshl_b32 s3, s60, 14
    buffer_load_dwordx4 v7, s[24:27], s3 offen lds
    s_add_u32 s60, s60, 4
    s_lshl_b32 m0, s60, 10
    s_lshl_b32 s3, s60, 14
    buffer_load_dwordx4 v7, s[24:27], s3 offen lds
    s_add_u32 s60, s60, 4
    s_waitcnt vmcnt(8)
    s_barrier
    s_add_u32 s62, s61, 6
    s_and_b32 s62, s62, 7
    s_lshl_b32 s50, s62, 15
    s_add_u32 s50, s50, s49
    s_lshr_b32 s63, s62, 1
    s_lshl_b32 s63, s63, 7
    s_and_b32 s62, s62, 1
    s_lshl_b32 s62, s62, 4
    s_add_u32 s62, s62, s63
    s_mov_b32 s58, 0x20000
need_34:
    s_load_dwordx4 s[64:67], s[52:53], s62 glc
    s_sub_u32 s58, s58, 1
    s_cbranch_scc1 need_34_ok
    s_waitcnt lgkmcnt(0)
    s_xor_b64 s[64:65], s[64:65], s[54:55]
    s_xor_b64 s[66:67], s[66:67], s[54:55]
    s_or_b64 s[64:65], s[64:65], s[66:67]
    s_cbranch_scc1 need_34
need_34_ok:
    s_waitcnt lgkmcnt(0)
    s_add_u32 m0, s51, 0
    s_nop 0
    buffer_load_dwordx4 v5, s[12:15], s50 offen offset:0 sc1 lds
    buffer_load_dwordx4 v5, s[12:15], s50 offen offset:1024 sc1 lds
    s_add_u32 s50, s50, 8192
    s_add_u32 m0, s51, 8192
    s_nop 0
    buffer_load_dwordx4 v5, s[12:15], s50 offen offset:0 sc1 lds
    buffer_load_dwordx4 v5, s[12:15], s50 offen offset:1024 sc1 lds
    s_add_u32 s50, s50, 8192
    s_lshl_b32 m0, s60, 10
    s_lshl_b32 s3, s60, 14
    buffer_load_dwordx4 v7, s[24:27], s3 offen lds
    s_add_u32 s60, s60, 4
    s_lshl_b32 m0, s60, 10
    s_lshl_b32 s3, s60, 14
    buffer_load_dwordx4 v7, s[24:27], s3 offen lds
    s_add_u32 s60, s60, 4
    s_waitcnt vmcnt(8)
    s_barrier
    s_add_u32 m0, s51, 16384
    s_nop 0
    buffer_load_dwordx4 v5, s[12:15], s50 offen offset:0 sc1 lds
    buffer_load_dwordx4 v5, s[12:15], s50 offen offset:1024 sc1 lds
    s_add_u32 s50, s50, 8192
    s_add_u32 m0, s51, 24576
    s_nop 0
    buffer_load_dwordx4 v5, s[12:15], s50 offen offset:0 sc1 lds
    buffer_load_dwordx4 v5, s[12:15], s50 offen offset:1024 sc1 lds
    s_add_u32 s50, s50, 8192
    s_lshl_b32 m0, s60, 10
    s_lshl_b32 s3, s60, 14
    buffer_load_dwordx4 v7, s[24:27], s3 offen lds
    s_add_u32 s60, s60, 4
    s_lshl_b32 m0, s60, 10
    s_lshl_b32 s3, s60, 14
    buffer_load_dwordx4 v7, s[24:27], s3 offen lds
    s_add_u32 s60, s60, 4
    s_waitcnt vmcnt(8)
    s_barrier
    s_add_u32 s62, s61, 7
    s_and_b32 s62, s62, 7
    s_lshl_b32 s50, s62, 15
    s_add_u32 s50, s50, s49
    s_lshr_b32 s63, s62, 1
    s_lshl_b32 s63, s63, 7
    s_and_b32 s62, s62, 1
    s_lshl_b32 s62, s62, 4
    s_add_u32 s62, s62, s63
    s_mov_b32 s58, 0x20000
need_35:
    s_load_dwordx4 s[64:67], s[52:53], s62 glc
    s_sub_u32 s58, s58, 1
    s_cbranch_scc1 need_35_ok
    s_waitcnt lgkmcnt(0)
    s_xor_b64 s[64:65], s[64:65], s[54:55]
    s_xor_b64 s[66:67], s[66:67], s[54:55]
    s_or_b64 s[64:65], s[64:65], s[66:67]
    s_cbranch_scc1 need_35
need_35_ok:
    s_waitcnt lgkmcnt(0)
    s_add_u32 m0, s51, 32768
    s_nop 0
    buffer_load_dwordx4 v5, s[12:15], s50 offen offset:0 sc1 lds
    buffer_load_dwordx4 v5, s[12:15], s50 offen offset:1024 sc1 lds
    s_add_u32 s50, s50, 8192
    s_add_u32 m0, s51, 40960
    s_nop 0
    buffer_load_dwordx4 v5, s[12:15], s50 offen offset:0 sc1 lds
    buffer_load_dwordx4 v5, s[12:15], s50 offen offset:1024 sc1 lds
    s_add_u32 s50, s50, 8192
    s_lshl_b32 m0, s60, 10
    s_lshl_b32 s3, s60, 14
    buffer_load_dwordx4 v7, s[24:27], s3 offen lds
    s_add_u32 s60, s60, 4
    s_lshl_b32 m0, s60, 10
    s_lshl_b32 s3, s60, 14
    buffer_load_dwordx4 v7, s[24:27], s3 offen lds
    s_add_u32 s60, s60, 4
    s_waitcnt vmcnt(8)
    s_barrier
    s_add_u32 m0, s51, 49152
    s_nop 0
    buffer_load_dwordx4 v5, s[12:15], s50 offen offset:0 sc1 lds
    buffer_load_dwordx4 v5, s[12:15], s50 offen offset:1024 sc1 lds
    s_add_u32 s50, s50, 8192
    s_add_u32 m0, s51, 57344
    s_nop 0
    buffer_load_dwordx4 v5, s[12:15], s50 offen offset:0 sc1 lds
    buffer_load_dwordx4 v5, s[12:15], s50 offen offset:1024 sc1 lds
    s_add_u32 s50, s50, 8192
    s_lshl_b32 m0, s60, 10
    s_lshl_b32 s3, s60, 14
    buffer_load_dwordx4 v7, s[24:27], s3 offen lds
    s_add_u32 s60, s60, 4
    s_lshl_b32 m0, s60, 10
    s_lshl_b32 s3, s60, 14
    buffer_load_dwordx4 v7, s[24:27], s3 offen lds
    s_add_u32 s60, s60, 4
    s_waitcnt vmcnt(8)
    s_barrier
    s_lshl_b32 m0, s60, 10
    s_lshl_b32 s3, s60, 14
    buffer_load_dwordx4 v7, s[24:27], s3 offen lds
    s_add_u32 s60, s60, 4
    s_lshl_b32 m0, s60, 10
    s_lshl_b32 s3, s60, 14
    buffer_load_dwordx4 v7, s[24:27], s3 offen lds
    s_add_u32 s60, s60, 4
    s_lshl_b32 m0, s60, 10
    s_lshl_b32 s3, s60, 14
    buffer_load_dwordx4 v7, s[24:27], s3 offen lds
    s_add_u32 s60, s60, 4
    s_lshl_b32 m0, s60, 10
    s_lshl_b32 s3, s60, 14
    buffer_load_dwordx4 v7, s[24:27], s3 offen lds
    s_add_u32 s60, s60, 4
    s_waitcnt vmcnt(6)
    s_barrier
    s_lshl_b32 m0, s60, 10
    s_lshl_b32 s3, s60, 14
    buffer_load_dwordx4 v7, s[24:27], s3 offen lds
    s_add_u32 s60, s60, 4
    s_lshl_b32 m0, s60, 10
    s_lshl_b32 s3, s60, 14
    buffer_load_dwordx4 v7, s[24:27], s3 offen lds
    s_add_u32 s60, s60, 4
    s_lshl_b32 m0, s60, 10
    s_lshl_b32 s3, s60, 14
    buffer_load_dwordx4 v7, s[24:27], s3 offen lds
    s_add_u32 s60, s60, 4
    s_lshl_b32 m0, s60, 10
    s_lshl_b32 s3, s60, 14
    buffer_load_dwordx4 v7, s[24:27], s3 offen lds
    s_add_u32 s60, s60, 4
    s_barrier
    s_lshl_b32 m0, s60, 10
    s_lshl_b32 s3, s60, 14
    buffer_load_dwordx4 v7, s[24:27], s3 offen lds
    s_add_u32 s60, s60, 4
    s_lshl_b32 m0, s60, 10
    s_lshl_b32 s3, s60, 14
    buffer_load_dwordx4 v7, s[24:27], s3 offen lds
    s_add_u32 s60, s60, 4
    s_lshl_b32 m0, s60, 10
    s_lshl_b32 s3, s60, 14
    buffer_load_dwordx4 v7, s[24:27], s3 offen lds
    s_add_u32 s60, s60, 4
    s_lshl_b32 m0, s60, 10
    s_lshl_b32 s3, s60, 14
    buffer_load_dwordx4 v7, s[24:27], s3 offen lds
    s_add_u32 s60, s60, 4
    s_setprio 0
    s_cmp_eq_u32 s8, 4
    s_cbranch_scc1 h_wo
    s_branch l_wo
.p2align 6
c_attn_slow:
    s_waitcnt lgkmcnt(0)
    s_lshr_b32 s56, s9, 1
    s_lshl_b32 s56, s56, 23
    s_lshl_b32 s55, s7, 19
    s_add_u32 s56, s56, s55
    s_and_b32 s55, s6, 1
    s_lshl_b32 s55, s55, 18
    s_add_u32 s56, s56, s55
    s_add_u32 s56, s56, 33554432
    v_mov_b32 v28, 0xff800000
    v_mov_b32 v30, 0xff800000
    s_mov_b32 s57, 0
c_attn_slow1:
    s_lshr_b32 s55, s57, 2
    s_lshl_b32 s55, s55, 14
    s_and_b32 s58, s57, 3
    s_lshl_b32 s58, s58, 11
    s_add_u32 s55, s55, s58
    s_add_u32 s55, s55, s56
    buffer_load_dwordx4 v[128:131], v5, s[12:15], s55 offen offset:0 sc1
    buffer_load_dwordx4 v[132:135], v5, s[12:15], s55 offen offset:1024 sc1
    s_waitcnt vmcnt(0)
    v_mfma_f32_32x32x16_bf16 v[64:79], v[128:131], v[8:11], 0
    v_mfma_f32_32x32x16_bf16 v[80:95], v[128:131], v[16:19], 0
    v_mfma_f32_32x32x16_bf16 v[64:79], v[132:135], v[12:15], v[64:79]
    v_mfma_f32_32x32x16_bf16 v[80:95], v[132:135], v[20:23], v[80:95]
    s_nop 10
    v_max3_f32 v28, v28, v64, v65
    v_max3_f32 v28, v28, v66, v67
    v_max3_f32 v28, v28, v68, v69
    v_max3_f32 v28, v28, v70, v71
    v_max3_f32 v28, v28, v72, v73
    v_max3_f32 v28, v28, v74, v75
    v_max3_f32 v28, v28, v76, v77
    v_max3_f32 v28, v28, v78, v79
    v_max3_f32 v30, v30, v80, v81
    v_max3_f32 v30, v30, v82, v83
    v_max3_f32 v30, v30, v84, v85
    v_max3_f32 v30, v30, v86, v87
    v_max3_f32 v30, v30, v88, v89
    v_max3_f32 v30, v30, v90, v91
    v_max3_f32 v30, v30, v92, v93
    v_max3_f32 v30, v30, v94, v95
    s_add_u32 s57, s57, 1
    s_cmp_lt_u32 s57, 64
    s_cbranch_scc1 c_attn_slow1
    v_mov_b32 v29, v28
    s_nop 1
    v_permlane32_swap_b32 v28, v29
    v_max_f32 v28, v28, v29
    v_sub_f32 v96, 0, v28
    v_sub_f32 v97, 0, v28
    v_sub_f32 v98, 0, v28
    v_sub_f32 v99, 0, v28
    v_sub_f32 v100, 0, v28
    v_sub_f32 v101, 0, v28
    v_sub_f32 v102, 0, v28
    v_sub_f32 v103, 0, v28
    v_sub_f32 v104, 0, v28
    v_sub_f32 v105, 0, v28
    v_sub_f32 v106, 0, v28
    v_sub_f32 v107, 0, v28
    v_sub_f32 v108, 0, v28
    v_sub_f32 v109, 0, v28
    v_sub_f32 v110, 0, v28
    v_sub_f32 v111, 0, v28
    v_mov_b32 v160, 0
    v_mov_b32 v161, 0
    v_mov_b32 v162, 0
    v_mov_b32 v163, 0
    v_mov_b32 v164, 0
    v_mov_b32 v165, 0
    v_mov_b32 v166, 0
    v_mov_b32 v167, 0
    v_mov_b32 v168, 0
    v_mov_b32 v169, 0
    v_mov_b32 v170, 0
    v_mov_b32 v171, 0
    v_mov_b32 v172, 0
    v_mov_b32 v173, 0
    v_mov_b32 v174, 0
    v_mov_b32 v175, 0
    v_mov_b32 v192, 0
    v_mov_b32 v193, 0
    v_mov_b32 v194, 0
    v_mov_b32 v195, 0
    v_mov_b32 v31, v30
    s_nop 1
    v_permlane32_swap_b32 v30, v31
    v_max_f32 v30, v30, v31
    v_sub_f32 v112, 0, v30
    v_sub_f32 v113, 0, v30
    v_sub_f32 v114, 0, v30
    v_sub_f32 v115, 0, v30
    v_sub_f32 v116, 0, v30
    v_sub_f32 v117, 0, v30
    v_sub_f32 v118, 0, v30
    v_sub_f32 v119, 0, v30
    v_sub_f32 v120, 0, v30
    v_sub_f32 v121, 0, v30
    v_sub_f32 v122, 0, v30
    v_sub_f32 v123, 0, v30
    v_sub_f32 v124, 0, v30
    v_sub_f32 v125, 0, v30
    v_sub_f32 v126, 0, v30
    v_sub_f32 v127, 0, v30
    v_mov_b32 v176, 0
    v_mov_b32 v177, 0
    v_mov_b32 v178, 0
    v_mov_b32 v179, 0
    v_mov_b32 v180, 0
    v_mov_b32 v181, 0
    v_mov_b32 v182, 0
    v_mov_b32 v183, 0
    v_mov_b32 v184, 0
    v_mov_b32 v185, 0
    v_mov_b32 v186, 0
    v_mov_b32 v187, 0
    v_mov_b32 v188, 0
    v_mov_b32 v189, 0
    v_mov_b32 v190, 0
    v_mov_b32 v191, 0
    v_mov_b32 v196, 0
    v_mov_b32 v197, 0
    v_mov_b32 v198, 0
    v_mov_b32 v199, 0
    s_mov_b32 s57, 0
c_attn_slow2:
    s_lshr_b32 s55, s57, 2
    s_lshl_b32 s55, s55, 14
    s_and_b32 s58, s57, 3
    s_lshl_b32 s58, s58, 11
    s_add_u32 s55, s55, s58
    s_add_u32 s55, s55, s56
    buffer_load_dwordx4 v[128:131], v5, s[12:15], s55 offen offset:0 sc1
    buffer_load_dwordx4 v[132:135], v5, s[12:15], s55 offen offset:1024 sc1
    s_add_u32 s55, s55, 8192
    buffer_load_dwordx4 v[144:147], v5, s[12:15], s55 offen offset:0 sc1
    buffer_load_dwordx4 v[148:151], v5, s[12:15], s55 offen offset:1024 sc1
    s_waitcnt vmcnt(0)
    v_mfma_f32_32x32x16_bf16 v[64:79], v[128:131], v[8:11], v[96:111]
    v_mfma_f32_32x32x16_bf16 v[80:95], v[128:131], v[16:19], v[112:127]
    v_mfma_f32_32x32x16_bf16 v[64:79], v[132:135], v[12:15], v[64:79]
    v_mfma_f32_32x32x16_bf16 v[80:95], v[132:135], v[20:23], v[80:95]
    s_nop 10
    v_exp_f32 v64, v64
    v_exp_f32 v65, v65
    v_exp_f32 v66, v66
    v_exp_f32 v67, v67
    v_exp_f32 v68, v68
    v_exp_f32 v69, v69
    v_exp_f32 v70, v70
    v_exp_f32 v71, v71
    v_exp_f32 v72, v72
    v_exp_f32 v73, v73
    v_exp_f32 v74, v74
    v_exp_f32 v75, v75
    v_exp_f32 v76, v76
    v_exp_f32 v77, v77
    v_exp_f32 v78, v78
    v_exp_f32 v79, v79
    v_exp_f32 v80, v80
    v_exp_f32 v81, v81
    v_exp_f32 v82, v82
    v_exp_f32 v83, v83
    v_exp_f32 v84, v84
    v_exp_f32 v85, v85
    v_exp_f32 v86, v86
    v_exp_f32 v87, v87
    v_exp_f32 v88, v88
    v_exp_f32 v89, v89
    v_exp_f32 v90, v90
    v_exp_f32 v91, v91
    v_exp_f32 v92, v92
    v_exp_f32 v93, v93
    v_exp_f32 v94, v94
    v_exp_f32 v95, v95
    v_smfmac_f32_32x32x32_bf16 v[160:175], v[144:147], v[64:71], v204
    v_smfmac_f32_16x16x64_bf16 v[192:195], v[200:203], v[64:71], v204
    v_smfmac_f32_32x32x32_bf16 v[160:175], v[148:151], v[72:79], v204
    v_smfmac_f32_16x16x64_bf16 v[192:195], v[200:203], v[72:79], v204
    v_smfmac_f32_32x32x32_bf16 v[176:191], v[144:147], v[80:87], v204
    v_smfmac_f32_16x16x64_bf16 v[196:199], v[200:203], v[80:87], v204
    v_smfmac_f32_32x32x32_bf16 v[176:191], v[148:151], v[88:95], v204
    v_smfmac_f32_16x16x64_bf16 v[196:199], v[200:203], v[88:95], v204
    s_add_u32 s57, s57, 1
    s_cmp_lt_u32 s57, 64
    s_nop 15
    s_cbranch_scc1 c_attn_slow2
    s_branch c_attn_fin
    s_endpgm
.section .rodata,"a"
.p2align 6
.amdhsa_kernel interleave_layers__sliding_local_dilated__softmax_full_mha__prompt_kernel
  .amdhsa_next_free_vgpr 256
  .amdhsa_next_free_sgpr 102
  .amdhsa_accum_offset 224
  .amdhsa_group_segment_fixed_size 0
  .amdhsa_kernarg_size 72
  .amdhsa_user_sgpr_count 2
  .amdhsa_user_sgpr_kernarg_segment_ptr 1
  .amdhsa_system_sgpr_workgroup_id_x 1
.end_amdhsa_kernel
```

```asm
; @launch grid=(256,1,1) block=(512,1,1) lds=159744
.amdgcn_target "amdgcn-amd-amdhsa--gfx950"
.text
.globl interleave_layers__sliding_local_dilated__softmax_full_mha__prompt_kernel
.type interleave_layers__sliding_local_dilated__softmax_full_mha__prompt_kernel,@function
.p2align 8
interleave_layers__sliding_local_dilated__softmax_full_mha__prompt_kernel:
    s_cmp_ge_u32 s2, 256
    s_cbranch_scc1 k_exit2
    s_load_dwordx16 s[32:47], s[0:1], 0
    s_load_dwordx2 s[4:5], s[0:1], 64
    v_lshrrev_b32 v2, 6, v0
    v_and_b32 v1, 63, v0
    v_mov_b32 v12, 0
    v_mov_b32 v14, 0
    v_mov_b32 v15, 0
    v_mov_b32 v16, 0
    v_readfirstlane_b32 s8, v2
    s_and_b32 s3, s2, 1
    s_lshl_b32 s3, s3, 3
    s_bfe_u32 s6, s2, 0x30003
    s_add_u32 s6, s3, s6
    s_bfe_u32 s3, s2, 0x20001
    s_lshl_b32 s3, s3, 2
    s_lshr_b32 s7, s2, 6
    s_add_u32 s7, s3, s7
    s_lshl_b32 s11, s6, 4
    s_add_u32 s11, s11, s7
    s_mov_b32 s9, -1
    s_mov_b32 s96, 0
    s_mov_b32 s10, 0
    s_waitcnt lgkmcnt(0)
    s_mov_b32 s12, s4
    s_mov_b32 s13, s5
    s_mov_b32 s14, 71303168
    s_mov_b32 s15, 0x00020000
    s_cmp_lt_u32 s8, 4
    s_cbranch_scc1 c_prep
    s_cmp_eq_u32 s8, 4
    s_cbranch_scc1 h_first
    s_branch l_first
k_exit:
k_exit2:
    s_endpgm
.p2align 6
c_qkvA:
    v_and_b32 v1, 63, v0
    v_lshrrev_b32 v2, 6, v0
    v_lshlrev_b32 v5, 4, v1
    v_lshrrev_b32 v3, 5, v1
    v_and_b32 v4, 15, v0
    v_bfe_u32 v7, v1, 4, 1
    v_lshl_add_u32 v6, v7, 5, v4
    v_lshlrev_b32 v6, 4, v6
    v_lshl_add_u32 v6, v3, 10, v6
    s_lshr_b32 s48, s6, 1
    s_lshl_b32 s48, s48, 2
    s_add_u32 s48, s48, s8
    s_lshl_b32 s55, s48, 17
    s_lshl_b32 s56, s9, 22
    s_add_u32 s55, s55, s56
    s_add_u32 s16, s4, s55
    s_addc_u32 s17, s5, 0
    s_mov_b32 s18, 65536
    s_mov_b32 s19, 0x00020000
    s_add_u32 s56, s55, 65536
    s_add_u32 s20, s4, s56
    s_addc_u32 s21, s5, 0
    s_mov_b32 s22, 65536
    s_mov_b32 s23, 0x00020000
    s_lshl_b32 s49, s7, 12
    s_add_u32 s49, s49, s55
    s_and_b32 s56, s6, 1
    s_lshl_b32 s56, s56, 11
    s_add_u32 s49, s49, s56
    s_add_u32 s49, s49, 16777216
    s_movk_i32 s54, 4096
    v_lshrrev_b32 v16, 2, v4
    v_lshl_add_u32 v18, v7, 2, v16
    v_lshl_add_u32 v18, v3, 4, v18
    v_lshlrev_b32 v18, 6, v18
    v_and_b32 v17, 3, v4
    v_lshl_add_u32 v18, v17, 3, v18
    v_lshl_add_u32 v26, v7, 5, v18
    v_xor_b32 v27, 32, v26
    v_mov_b32 v24, v26
    v_mov_b32 v25, v27
    v_and_b32 v18, 0x30, v1
    v_add_u32 v10, 155648, v18
    v_lshlrev_b32 v11, 2, v4
    v_add_u32 v11, 155648, v11
    v_lshl_add_u32 v8, v2, 8, v11
    v_lshl_add_u32 v9, v2, 8, v10
    s_lshr_b32 s3, s8, 1
    s_and_b32 s55, s8, 1
    s_lshl_b32 s56, s55, 5
    v_xor_b32 v29, s56, v26
    s_lshl_b32 s56, s3, 13
    s_add_u32 s56, s56, 8192
    v_add_u32 v29, s56, v29
    v_mov_b32 v28, v29
    v_add_u32 v30, 147456, v5
    v_lshl_add_u32 v14, v2, 6, v10
    v_lshl_add_u32 v12, v2, 11, v5
    v_add_u32 v12, 131072, v12
    v_lshlrev_b32 v16, 8, v16
    v_lshl_add_u32 v16, v18, 2, v16
    v_lshl_add_u32 v16, v17, 1, v16
    v_add_u32 v16, 1024, v16
    v_cmp_gt_u32 vcc, 2, v2
    s_nop 1
    v_cndmask_b32 v13, v16, v5, vcc
    s_lshl_b32 s56, s55, 3
    s_add_u32 s56, s56, 131072
    v_add_u32 v13, s56, v13
    v_lshrrev_b32 v18, 2, v18
    v_sub_u32 v18, v4, v18
    v_mov_b32 v19, 0xf149f2ca
    v_add_u32 v16, 0x0, v18
    v_and_b32 v16, 0xfffffff1, v16
    v_cmp_eq_u32 vcc, 0, v16
    s_nop 1
    v_cndmask_b32 v196, v19, 0, vcc
    v_add_u32 v16, 0xffffffff, v18
    v_and_b32 v16, 0xfffffff1, v16
    v_cmp_eq_u32 vcc, 0, v16
    s_nop 1
    v_cndmask_b32 v197, v19, 0, vcc
    v_add_u32 v16, 0xfffffffe, v18
    v_and_b32 v16, 0xfffffff1, v16
    v_cmp_eq_u32 vcc, 0, v16
    s_nop 1
    v_cndmask_b32 v198, v19, 0, vcc
    v_add_u32 v16, 0xfffffffd, v18
    v_and_b32 v16, 0xfffffff1, v16
    v_cmp_eq_u32 vcc, 0, v16
    s_nop 1
    v_cndmask_b32 v199, v19, 0, vcc
    v_add_u32 v16, 0x10, v18
    v_and_b32 v16, 0xfffffff1, v16
    v_cmp_eq_u32 vcc, 0, v16
    s_nop 1
    v_cndmask_b32 v200, v19, 0, vcc
    v_add_u32 v16, 0xf, v18
    v_and_b32 v16, 0xfffffff1, v16
    v_cmp_eq_u32 vcc, 0, v16
    s_nop 1
    v_cndmask_b32 v201, v19, 0, vcc
    v_add_u32 v16, 0xe, v18
    v_and_b32 v16, 0xfffffff1, v16
    v_cmp_eq_u32 vcc, 0, v16
    s_nop 1
    v_cndmask_b32 v202, v19, 0, vcc
    v_add_u32 v16, 0xd, v18
    v_and_b32 v16, 0xfffffff1, v16
    v_cmp_eq_u32 vcc, 0, v16
    s_nop 1
    v_cndmask_b32 v203, v19, 0, vcc
    s_cmp_eq_u32 s48, 0
    s_cselect_b64 vcc, -1, 0
    v_cndmask_b32 v204, v200, v19, vcc
    v_cndmask_b32 v205, v201, v19, vcc
    v_cndmask_b32 v206, v202, v19, vcc
    v_cndmask_b32 v207, v203, v19, vcc
    v_mov_b32 v208, 0x3f803f80
    v_mov_b32 v209, 0x3f803f80
    v_mov_b32 v210, 0x3f803f80
    v_mov_b32 v211, 0x3f803f80
    v_mov_b32 v184, 0
    v_mov_b32 v185, 0
    v_mov_b32 v186, 0
    v_mov_b32 v187, 0
    v_mov_b32 v188, 0
    v_mov_b32 v189, 0
    v_mov_b32 v190, 0
    v_mov_b32 v191, 0
    v_mov_b32 v192, 0
    v_mov_b32 v193, 0
    v_mov_b32 v194, 0
    v_mov_b32 v195, 0
    v_mov_b32 v32, 0
    v_mov_b32 v33, 0
    v_mov_b32 v34, 0
    v_mov_b32 v35, 0
    v_mov_b32 v36, 0
    v_mov_b32 v37, 0
    v_mov_b32 v38, 0
    v_mov_b32 v39, 0
    v_mov_b32 v40, 0
    v_mov_b32 v41, 0
    v_mov_b32 v42, 0
    v_mov_b32 v43, 0
    v_mov_b32 v44, 0
    v_mov_b32 v45, 0
    v_mov_b32 v46, 0
    v_mov_b32 v47, 0
    v_mov_b32 v48, 0
    v_mov_b32 v49, 0
    v_mov_b32 v50, 0
    v_mov_b32 v51, 0
    v_mov_b32 v52, 0
    v_mov_b32 v53, 0
    v_mov_b32 v54, 0
    v_mov_b32 v55, 0
    v_mov_b32 v56, 0
    v_mov_b32 v57, 0
    v_mov_b32 v58, 0
    v_mov_b32 v59, 0
    v_mov_b32 v60, 0
    v_mov_b32 v61, 0
    v_mov_b32 v62, 0
    v_mov_b32 v63, 0
    v_mov_b32 v64, 0
    v_mov_b32 v65, 0
    v_mov_b32 v66, 0
    v_mov_b32 v67, 0
    v_mov_b32 v68, 0
    v_mov_b32 v69, 0
    v_mov_b32 v70, 0
    v_mov_b32 v71, 0
    v_mov_b32 v72, 0
    v_mov_b32 v73, 0
    v_mov_b32 v74, 0
    v_mov_b32 v75, 0
    v_mov_b32 v76, 0
    v_mov_b32 v77, 0
    v_mov_b32 v78, 0
    v_mov_b32 v79, 0
    v_mov_b32 v80, 0
    v_mov_b32 v81, 0
    v_mov_b32 v82, 0
    v_mov_b32 v83, 0
    v_mov_b32 v84, 0
    v_mov_b32 v85, 0
    v_mov_b32 v86, 0
    v_mov_b32 v87, 0
    v_mov_b32 v88, 0
    v_mov_b32 v89, 0
    v_mov_b32 v90, 0
    v_mov_b32 v91, 0
    v_mov_b32 v92, 0
    v_mov_b32 v93, 0
    v_mov_b32 v94, 0
    v_mov_b32 v95, 0
    v_mov_b32 v96, 0
    v_mov_b32 v97, 0
    v_mov_b32 v98, 0
    v_mov_b32 v99, 0
    v_mov_b32 v100, 0
    v_mov_b32 v101, 0
    v_mov_b32 v102, 0
    v_mov_b32 v103, 0
    v_mov_b32 v104, 0
    v_mov_b32 v105, 0
    v_mov_b32 v106, 0
    v_mov_b32 v107, 0
    v_mov_b32 v108, 0
    v_mov_b32 v109, 0
    v_mov_b32 v110, 0
    v_mov_b32 v111, 0
    v_mov_b32 v112, 0
    v_mov_b32 v113, 0
    v_mov_b32 v114, 0
    v_mov_b32 v115, 0
    v_mov_b32 v116, 0
    v_mov_b32 v117, 0
    v_mov_b32 v118, 0
    v_mov_b32 v119, 0
    v_mov_b32 v120, 0
    v_mov_b32 v121, 0
    v_mov_b32 v122, 0
    v_mov_b32 v123, 0
    v_mov_b32 v124, 0
    v_mov_b32 v125, 0
    v_mov_b32 v126, 0
    v_mov_b32 v127, 0
    s_mov_b32 s50, 8192
    s_mov_b32 s58, 6144
    s_mov_b32 s51, 12288
    s_mov_b32 s59, 10240
    s_mov_b32 s52, 0
    s_mul_i32 s60, s9, 786432
    s_add_u32 s60, s60, 65273856
    s_lshl_b32 s61, s11, 10
    s_add_u32 s60, s60, s61
    s_lshl_b32 s61, s8, 7
    s_add_u32 s60, s60, s61
    s_mov_b32 s98, s10
    s_mov_b32 s99, s10
    s_mov_b32 s3, 0x100000
cp_1:
    s_load_dwordx8 s[24:31], s[4:5], s60 glc
    s_sub_u32 s3, s3, 1
    s_cbranch_scc1 cp_1_ok
    s_waitcnt lgkmcnt(0)
    s_xor_b64 s[24:25], s[24:25], s[98:99]
    s_xor_b64 s[26:27], s[26:27], s[98:99]
    s_xor_b64 s[28:29], s[28:29], s[98:99]
    s_xor_b64 s[30:31], s[30:31], s[98:99]
    s_or_b64 s[24:25], s[24:25], s[26:27]
    s_or_b64 s[28:29], s[28:29], s[30:31]
    s_or_b64 s[24:25], s[24:25], s[28:29]
    s_cbranch_scc1 cp_1
cp_1_ok:
    s_waitcnt lgkmcnt(0)
    s_barrier
    buffer_load_dwordx4 v[152:155], v6, s[16:19], 0 offen offset:0 sc1
    buffer_load_dwordx4 v[156:159], v6, s[16:19], 0 offen offset:256 sc1
    buffer_load_dwordx4 v[160:163], v6, s[20:23], 0 offen offset:0 sc1
    buffer_load_dwordx4 v[164:167], v6, s[20:23], 0 offen offset:256 sc1
    ds_read_b64_tr_b16 v[128:129], v24 offset:0
    ds_read_b64_tr_b16 v[130:131], v24 offset:512
    ds_read_b64_tr_b16 v[132:133], v25 offset:0
    ds_read_b64_tr_b16 v[134:135], v25 offset:512
    ds_read_b64_tr_b16 v[136:137], v24 offset:8192
    ds_read_b64_tr_b16 v[138:139], v24 offset:8704
    ds_read_b64_tr_b16 v[140:141], v25 offset:8192
    ds_read_b64_tr_b16 v[142:143], v25 offset:8704
    ds_read_b64_tr_b16 v[144:145], v24 offset:16384
    ds_read_b64_tr_b16 v[146:147], v24 offset:16896
    buffer_load_dwordx4 v[168:171], v6, s[16:19], 0 offen offset:2048 sc1
    buffer_load_dwordx4 v[172:175], v6, s[16:19], 0 offen offset:2304 sc1
    buffer_load_dwordx4 v[176:179], v6, s[20:23], 0 offen offset:2048 sc1
    buffer_load_dwordx4 v[180:183], v6, s[20:23], 0 offen offset:2304 sc1
    buffer_load_dwordx4 a[0:3], v6, s[16:19], s54 offen offset:0 sc1
    buffer_load_dwordx4 a[4:7], v6, s[16:19], s54 offen offset:256 sc1
    buffer_load_dwordx4 a[8:11], v6, s[20:23], s54 offen offset:0 sc1
    buffer_load_dwordx4 a[12:15], v6, s[20:23], s54 offen offset:256 sc1
    buffer_load_dwordx4 a[16:19], v6, s[16:19], s54 offen offset:2048 sc1
    buffer_load_dwordx4 a[20:23], v6, s[16:19], s54 offen offset:2304 sc1
    s_mov_b32 s54, 7
    s_waitcnt vmcnt(12)
    s_barrier
.p2align 3
c_qkvA_loop:
    s_waitcnt vmcnt(12) lgkmcnt(8)
    v_mfma_f32_16x16x32_bf16 v[184:187], v[188:191], v[192:195], v[184:187]
    v_mfma_f32_16x16x32_bf16 v[32:35], v[128:131], v[152:155], v[32:35]
    ds_read_b64_tr_b16 v[148:149], v25 offset:16384
    buffer_load_dwordx4 a[24:27], v6, s[20:23], s58 offen offset:0 sc1
    v_mfma_f32_16x16x32_bf16 v[36:39], v[128:131], v[156:159], v[36:39]
    ds_read_b64_tr_b16 v[150:151], v25 offset:16896
    s_waitcnt lgkmcnt(8)
    v_mfma_f32_16x16x32_bf16 v[52:55], v[132:135], v[156:159], v[52:55]
    v_mfma_f32_16x16x32_bf16 v[48:51], v[132:135], v[152:155], v[48:51]
    ds_read_b64_tr_b16 v[188:189], v28 offset:0
    s_waitcnt lgkmcnt(7)
    v_mfma_f32_16x16x32_bf16 v[64:67], v[136:139], v[152:155], v[64:67]
    v_mfma_f32_16x16x32_bf16 v[68:71], v[136:139], v[156:159], v[68:71]
    ds_read_b64_tr_b16 v[190:191], v28 offset:512
    s_waitcnt lgkmcnt(6)
    v_mfma_f32_16x16x32_bf16 v[84:87], v[140:143], v[156:159], v[84:87]
    buffer_load_dwordx4 a[28:31], v6, s[20:23], s58 offen offset:256 sc1
    v_mfma_f32_16x16x32_bf16 v[80:83], v[140:143], v[152:155], v[80:83]
    ds_read_b128 v[192:195], v30 offset:0
    s_waitcnt lgkmcnt(5)
    v_mfma_f32_16x16x32_bf16 v[96:99], v[152:155], v[144:147], v[96:99]
    v_mfma_f32_16x16x32_bf16 v[100:103], v[156:159], v[144:147], v[100:103]
    s_waitcnt lgkmcnt(3)
    v_mfma_f32_16x16x32_bf16 v[116:119], v[156:159], v[148:151], v[116:119]
    v_mfma_f32_16x16x32_bf16 v[112:115], v[152:155], v[148:151], v[112:115]
    s_waitcnt vmcnt(12)
    v_mfma_f32_16x16x32_bf16 v[40:43], v[128:131], v[160:163], v[40:43]
    buffer_load_dwordx4 v[152:155], v6, s[16:19], s50 offen offset:0 sc1
    v_mfma_f32_16x16x32_bf16 v[44:47], v[128:131], v[164:167], v[44:47]
    v_mfma_f32_16x16x32_bf16 v[60:63], v[132:135], v[164:167], v[60:63]
    ds_read_b64_tr_b16 v[128:129], v24 offset:2048
    v_mfma_f32_16x16x32_bf16 v[56:59], v[132:135], v[160:163], v[56:59]
    ds_read_b64_tr_b16 v[130:131], v24 offset:2560
    v_mfma_f32_16x16x32_bf16 v[72:75], v[136:139], v[160:163], v[72:75]
    ds_read_b64_tr_b16 v[132:133], v25 offset:2048
    v_mfma_f32_16x16x32_bf16 v[76:79], v[136:139], v[164:167], v[76:79]
    ds_read_b64_tr_b16 v[134:135], v25 offset:2560
    v_mfma_f32_16x16x32_bf16 v[92:95], v[140:143], v[164:167], v[92:95]
    ds_read_b64_tr_b16 v[136:137], v24 offset:10240
    buffer_load_dwordx4 v[156:159], v6, s[16:19], s50 offen offset:256 sc1
    v_mfma_f32_16x16x32_bf16 v[88:91], v[140:143], v[160:163], v[88:91]
    ds_read_b64_tr_b16 v[138:139], v24 offset:10752
    v_mfma_f32_16x16x32_bf16 v[104:107], v[160:163], v[144:147], v[104:107]
    ds_read_b64_tr_b16 v[140:141], v25 offset:10240
    v_mfma_f32_16x16x32_bf16 v[108:111], v[164:167], v[144:147], v[108:111]
    ds_read_b64_tr_b16 v[142:143], v25 offset:10752
    v_mfma_f32_16x16x32_bf16 v[124:127], v[164:167], v[148:151], v[124:127]
    ds_read_b64_tr_b16 v[144:145], v24 offset:18432
    v_mfma_f32_16x16x32_bf16 v[120:123], v[160:163], v[148:151], v[120:123]
    ds_read_b64_tr_b16 v[146:147], v24 offset:18944
    s_waitcnt vmcnt(12) lgkmcnt(8)
    v_mfma_f32_16x16x32_bf16 v[184:187], v[188:191], v[192:195], v[184:187]
    v_mfma_f32_16x16x32_bf16 v[32:35], v[128:131], v[168:171], v[32:35]
    ds_read_b64_tr_b16 v[148:149], v25 offset:18432
    buffer_load_dwordx4 v[160:163], v6, s[20:23], s58 offen offset:2048 sc1
    v_mfma_f32_16x16x32_bf16 v[36:39], v[128:131], v[172:175], v[36:39]
    ds_read_b64_tr_b16 v[150:151], v25 offset:18944
    s_waitcnt lgkmcnt(8)
    v_mfma_f32_16x16x32_bf16 v[52:55], v[132:135], v[172:175], v[52:55]
    v_mfma_f32_16x16x32_bf16 v[48:51], v[132:135], v[168:171], v[48:51]
    ds_read_b64_tr_b16 v[188:189], v28 offset:2048
    s_waitcnt lgkmcnt(7)
    v_mfma_f32_16x16x32_bf16 v[64:67], v[136:139], v[168:171], v[64:67]
    v_mfma_f32_16x16x32_bf16 v[68:71], v[136:139], v[172:175], v[68:71]
    ds_read_b64_tr_b16 v[190:191], v28 offset:2560
    s_waitcnt lgkmcnt(6)
    v_mfma_f32_16x16x32_bf16 v[84:87], v[140:143], v[172:175], v[84:87]
    buffer_load_dwordx4 v[164:167], v6, s[20:23], s58 offen offset:2304 sc1
    v_mfma_f32_16x16x32_bf16 v[80:83], v[140:143], v[168:171], v[80:83]
    ds_read_b128 v[192:195], v30 offset:1024
    s_waitcnt lgkmcnt(5)
    v_mfma_f32_16x16x32_bf16 v[96:99], v[168:171], v[144:147], v[96:99]
    v_mfma_f32_16x16x32_bf16 v[100:103], v[172:175], v[144:147], v[100:103]
    s_waitcnt lgkmcnt(3)
    v_mfma_f32_16x16x32_bf16 v[116:119], v[172:175], v[148:151], v[116:119]
    v_mfma_f32_16x16x32_bf16 v[112:115], v[168:171], v[148:151], v[112:115]
    s_waitcnt vmcnt(12)
    v_mfma_f32_16x16x32_bf16 v[40:43], v[128:131], v[176:179], v[40:43]
    buffer_load_dwordx4 v[168:171], v6, s[16:19], s50 offen offset:2048 sc1
    v_mfma_f32_16x16x32_bf16 v[44:47], v[128:131], v[180:183], v[44:47]
    v_mfma_f32_16x16x32_bf16 v[60:63], v[132:135], v[180:183], v[60:63]
    ds_read_b64_tr_b16 v[128:129], v24 offset:4096
    v_mfma_f32_16x16x32_bf16 v[56:59], v[132:135], v[176:179], v[56:59]
    ds_read_b64_tr_b16 v[130:131], v24 offset:4608
    v_mfma_f32_16x16x32_bf16 v[72:75], v[136:139], v[176:179], v[72:75]
    ds_read_b64_tr_b16 v[132:133], v25 offset:4096
    v_mfma_f32_16x16x32_bf16 v[76:79], v[136:139], v[180:183], v[76:79]
    ds_read_b64_tr_b16 v[134:135], v25 offset:4608
    v_mfma_f32_16x16x32_bf16 v[92:95], v[140:143], v[180:183], v[92:95]
    ds_read_b64_tr_b16 v[136:137], v24 offset:12288
    buffer_load_dwordx4 v[172:175], v6, s[16:19], s50 offen offset:2304 sc1
    v_mfma_f32_16x16x32_bf16 v[88:91], v[140:143], v[176:179], v[88:91]
    ds_read_b64_tr_b16 v[138:139], v24 offset:12800
    v_mfma_f32_16x16x32_bf16 v[104:107], v[176:179], v[144:147], v[104:107]
    ds_read_b64_tr_b16 v[140:141], v25 offset:12288
    v_mfma_f32_16x16x32_bf16 v[108:111], v[180:183], v[144:147], v[108:111]
    ds_read_b64_tr_b16 v[142:143], v25 offset:12800
    v_mfma_f32_16x16x32_bf16 v[124:127], v[180:183], v[148:151], v[124:127]
    ds_read_b64_tr_b16 v[144:145], v24 offset:20480
    v_mfma_f32_16x16x32_bf16 v[120:123], v[176:179], v[148:151], v[120:123]
    ds_read_b64_tr_b16 v[146:147], v24 offset:20992
    s_waitcnt vmcnt(12) lgkmcnt(8)
    v_mfma_f32_16x16x32_bf16 v[184:187], v[188:191], v[192:195], v[184:187]
    v_mfma_f32_16x16x32_bf16 v[32:35], v[128:131], a[0:3], v[32:35]
    ds_read_b64_tr_b16 v[148:149], v25 offset:20480
    buffer_load_dwordx4 v[176:179], v6, s[20:23], s59 offen offset:0 sc1
    v_mfma_f32_16x16x32_bf16 v[36:39], v[128:131], a[4:7], v[36:39]
    ds_read_b64_tr_b16 v[150:151], v25 offset:20992
    s_waitcnt lgkmcnt(8)
    v_mfma_f32_16x16x32_bf16 v[52:55], v[132:135], a[4:7], v[52:55]
    v_mfma_f32_16x16x32_bf16 v[48:51], v[132:135], a[0:3], v[48:51]
    ds_read_b64_tr_b16 v[188:189], v28 offset:4096
    s_waitcnt lgkmcnt(7)
    v_mfma_f32_16x16x32_bf16 v[64:67], v[136:139], a[0:3], v[64:67]
    v_mfma_f32_16x16x32_bf16 v[68:71], v[136:139], a[4:7], v[68:71]
    ds_read_b64_tr_b16 v[190:191], v28 offset:4608
    s_waitcnt lgkmcnt(6)
    v_mfma_f32_16x16x32_bf16 v[84:87], v[140:143], a[4:7], v[84:87]
    buffer_load_dwordx4 v[180:183], v6, s[20:23], s59 offen offset:256 sc1
    v_mfma_f32_16x16x32_bf16 v[80:83], v[140:143], a[0:3], v[80:83]
    ds_read_b128 v[192:195], v30 offset:2048
    s_waitcnt lgkmcnt(5)
    v_mfma_f32_16x16x32_bf16 v[96:99], a[0:3], v[144:147], v[96:99]
    v_mfma_f32_16x16x32_bf16 v[100:103], a[4:7], v[144:147], v[100:103]
    s_waitcnt lgkmcnt(3)
    v_mfma_f32_16x16x32_bf16 v[116:119], a[4:7], v[148:151], v[116:119]
    v_mfma_f32_16x16x32_bf16 v[112:115], a[0:3], v[148:151], v[112:115]
    s_waitcnt vmcnt(12)
    v_mfma_f32_16x16x32_bf16 v[40:43], v[128:131], a[8:11], v[40:43]
    buffer_load_dwordx4 a[0:3], v6, s[16:19], s51 offen offset:0 sc1
    v_mfma_f32_16x16x32_bf16 v[44:47], v[128:131], a[12:15], v[44:47]
    v_mfma_f32_16x16x32_bf16 v[60:63], v[132:135], a[12:15], v[60:63]
    ds_read_b64_tr_b16 v[128:129], v24 offset:6144
    v_mfma_f32_16x16x32_bf16 v[56:59], v[132:135], a[8:11], v[56:59]
    ds_read_b64_tr_b16 v[130:131], v24 offset:6656
    v_mfma_f32_16x16x32_bf16 v[72:75], v[136:139], a[8:11], v[72:75]
    ds_read_b64_tr_b16 v[132:133], v25 offset:6144
    v_mfma_f32_16x16x32_bf16 v[76:79], v[136:139], a[12:15], v[76:79]
    ds_read_b64_tr_b16 v[134:135], v25 offset:6656
    v_mfma_f32_16x16x32_bf16 v[92:95], v[140:143], a[12:15], v[92:95]
    ds_read_b64_tr_b16 v[136:137], v24 offset:14336
    buffer_load_dwordx4 a[4:7], v6, s[16:19], s51 offen offset:256 sc1
    v_mfma_f32_16x16x32_bf16 v[88:91], v[140:143], a[8:11], v[88:91]
    ds_read_b64_tr_b16 v[138:139], v24 offset:14848
    v_mfma_f32_16x16x32_bf16 v[104:107], a[8:11], v[144:147], v[104:107]
    ds_read_b64_tr_b16 v[140:141], v25 offset:14336
    v_mfma_f32_16x16x32_bf16 v[108:111], a[12:15], v[144:147], v[108:111]
    ds_read_b64_tr_b16 v[142:143], v25 offset:14848
    v_mfma_f32_16x16x32_bf16 v[124:127], a[12:15], v[148:151], v[124:127]
    ds_read_b64_tr_b16 v[144:145], v24 offset:22528
    v_mfma_f32_16x16x32_bf16 v[120:123], a[8:11], v[148:151], v[120:123]
    ds_read_b64_tr_b16 v[146:147], v24 offset:23040
    s_waitcnt vmcnt(12) lgkmcnt(8)
    v_mfma_f32_16x16x32_bf16 v[184:187], v[188:191], v[192:195], v[184:187]
    v_mfma_f32_16x16x32_bf16 v[32:35], v[128:131], a[16:19], v[32:35]
    ds_read_b64_tr_b16 v[148:149], v25 offset:22528
    buffer_load_dwordx4 a[8:11], v6, s[20:23], s59 offen offset:2048 sc1
    v_mfma_f32_16x16x32_bf16 v[36:39], v[128:131], a[20:23], v[36:39]
    ds_read_b64_tr_b16 v[150:151], v25 offset:23040
    s_waitcnt lgkmcnt(8)
    v_mfma_f32_16x16x32_bf16 v[52:55], v[132:135], a[20:23], v[52:55]
    v_mfma_f32_16x16x32_bf16 v[48:51], v[132:135], a[16:19], v[48:51]
    ds_read_b64_tr_b16 v[188:189], v28 offset:6144
    s_waitcnt lgkmcnt(7)
    v_mfma_f32_16x16x32_bf16 v[64:67], v[136:139], a[16:19], v[64:67]
    v_mfma_f32_16x16x32_bf16 v[68:71], v[136:139], a[20:23], v[68:71]
    ds_read_b64_tr_b16 v[190:191], v28 offset:6656
    s_waitcnt lgkmcnt(6)
    v_mfma_f32_16x16x32_bf16 v[84:87], v[140:143], a[20:23], v[84:87]
    buffer_load_dwordx4 a[12:15], v6, s[20:23], s59 offen offset:2304 sc1
    v_mfma_f32_16x16x32_bf16 v[80:83], v[140:143], a[16:19], v[80:83]
    ds_read_b128 v[192:195], v30 offset:3072
    s_waitcnt lgkmcnt(5)
    v_mfma_f32_16x16x32_bf16 v[96:99], a[16:19], v[144:147], v[96:99]
    s_add_u32 s52, s52, 24576
    v_mfma_f32_16x16x32_bf16 v[100:103], a[20:23], v[144:147], v[100:103]
    s_cmp_eq_u32 s52, 147456
    s_waitcnt lgkmcnt(3)
    v_mfma_f32_16x16x32_bf16 v[116:119], a[20:23], v[148:151], v[116:119]
    s_cselect_b32 s52, 0, s52
    v_mfma_f32_16x16x32_bf16 v[112:115], a[16:19], v[148:151], v[112:115]
    s_add_u32 s58, s58, 8192
    s_add_u32 s59, s59, 8192
    s_waitcnt vmcnt(12) lgkmcnt(0)
    v_mfma_f32_16x16x32_bf16 v[40:43], v[128:131], a[24:27], v[40:43]
    buffer_load_dwordx4 a[16:19], v6, s[16:19], s51 offen offset:2048 sc1
    s_barrier
    v_add_u32 v24, s52, v26
    v_mfma_f32_16x16x32_bf16 v[44:47], v[128:131], a[28:31], v[44:47]
    v_add_u32 v25, s52, v27
    v_add_u32 v28, s52, v29
    v_mfma_f32_16x16x32_bf16 v[60:63], v[132:135], a[28:31], v[60:63]
    ds_read_b64_tr_b16 v[128:129], v24 offset:0
    v_mfma_f32_16x16x32_bf16 v[56:59], v[132:135], a[24:27], v[56:59]
    ds_read_b64_tr_b16 v[130:131], v24 offset:512
    v_mfma_f32_16x16x32_bf16 v[72:75], v[136:139], a[24:27], v[72:75]
    ds_read_b64_tr_b16 v[132:133], v25 offset:0
    v_mfma_f32_16x16x32_bf16 v[76:79], v[136:139], a[28:31], v[76:79]
    ds_read_b64_tr_b16 v[134:135], v25 offset:512
    v_xor_b32 v30, 4096, v30
    v_mfma_f32_16x16x32_bf16 v[92:95], v[140:143], a[28:31], v[92:95]
    ds_read_b64_tr_b16 v[136:137], v24 offset:8192
    buffer_load_dwordx4 a[20:23], v6, s[16:19], s51 offen offset:2304 sc1
    v_mfma_f32_16x16x32_bf16 v[88:91], v[140:143], a[24:27], v[88:91]
    ds_read_b64_tr_b16 v[138:139], v24 offset:8704
    v_mfma_f32_16x16x32_bf16 v[104:107], a[24:27], v[144:147], v[104:107]
    ds_read_b64_tr_b16 v[140:141], v25 offset:8192
    s_add_u32 s50, s50, 8192
    v_mfma_f32_16x16x32_bf16 v[108:111], a[28:31], v[144:147], v[108:111]
    ds_read_b64_tr_b16 v[142:143], v25 offset:8704
    s_add_u32 s51, s51, 8192
    v_mfma_f32_16x16x32_bf16 v[124:127], a[28:31], v[148:151], v[124:127]
    ds_read_b64_tr_b16 v[144:145], v24 offset:16384
    s_sub_u32 s54, s54, 1
    v_mfma_f32_16x16x32_bf16 v[120:123], a[24:27], v[148:151], v[120:123]
    ds_read_b64_tr_b16 v[146:147], v24 offset:16896
    s_cmp_lg_u32 s54, 0
    s_cbranch_scc1 c_qkvA_loop
    s_waitcnt vmcnt(12) lgkmcnt(8)
    v_mfma_f32_16x16x32_bf16 v[184:187], v[188:191], v[192:195], v[184:187]
    v_mfma_f32_16x16x32_bf16 v[32:35], v[128:131], v[152:155], v[32:35]
    ds_read_b64_tr_b16 v[148:149], v25 offset:16384
    buffer_load_dwordx4 a[24:27], v6, s[20:23], s58 offen offset:0 sc1
    v_mfma_f32_16x16x32_bf16 v[36:39], v[128:131], v[156:159], v[36:39]
    ds_read_b64_tr_b16 v[150:151], v25 offset:16896
    s_waitcnt lgkmcnt(8)
    v_mfma_f32_16x16x32_bf16 v[52:55], v[132:135], v[156:159], v[52:55]
    ds_read_b32 v16, v8 offset:1280
    v_mfma_f32_16x16x32_bf16 v[48:51], v[132:135], v[152:155], v[48:51]
    ds_read_b64_tr_b16 v[188:189], v28 offset:0
    ds_read_b32 v18, v8 offset:1344
    s_waitcnt lgkmcnt(9)
    v_mfma_f32_16x16x32_bf16 v[64:67], v[136:139], v[152:155], v[64:67]
    ds_read_b32 v20, v8 offset:1408
    v_mfma_f32_16x16x32_bf16 v[68:71], v[136:139], v[156:159], v[68:71]
    ds_read_b64_tr_b16 v[190:191], v28 offset:512
    s_waitcnt lgkmcnt(9)
    v_mfma_f32_16x16x32_bf16 v[84:87], v[140:143], v[156:159], v[84:87]
    buffer_load_dwordx4 a[28:31], v6, s[20:23], s58 offen offset:256 sc1
    ds_read_b32 v22, v8 offset:1472
    v_mfma_f32_16x16x32_bf16 v[80:83], v[140:143], v[152:155], v[80:83]
    ds_read_b128 v[192:195], v30 offset:0
    ds_read_b128 v[212:215], v10 offset:128
    s_waitcnt lgkmcnt(10)
    v_mfma_f32_16x16x32_bf16 v[96:99], v[152:155], v[144:147], v[96:99]
    ds_read_b128 v[216:219], v10 offset:192
    v_mfma_f32_16x16x32_bf16 v[100:103], v[156:159], v[144:147], v[100:103]
    s_waitcnt lgkmcnt(9)
    v_mfma_f32_16x16x32_bf16 v[116:119], v[156:159], v[148:151], v[116:119]
    v_mfma_f32_16x16x32_bf16 v[112:115], v[152:155], v[148:151], v[112:115]
    s_waitcnt vmcnt(12)
    v_mfma_f32_16x16x32_bf16 v[40:43], v[128:131], v[160:163], v[40:43]
    s_waitcnt lgkmcnt(0)
    v_fma_f32 v64, -v16, v212, v64
    v_fma_f32 v65, -v16, v213, v65
    v_mfma_f32_16x16x32_bf16 v[44:47], v[128:131], v[164:167], v[44:47]
    v_fma_f32 v66, -v16, v214, v66
    v_mfma_f32_16x16x32_bf16 v[60:63], v[132:135], v[164:167], v[60:63]
    ds_read_b64_tr_b16 v[128:129], v24 offset:2048
    v_fma_f32 v67, -v16, v215, v67
    v_mfma_f32_16x16x32_bf16 v[56:59], v[132:135], v[160:163], v[56:59]
    ds_read_b64_tr_b16 v[130:131], v24 offset:2560
    v_fma_f32 v68, -v18, v212, v68
    v_fma_f32 v69, -v18, v213, v69
    v_mfma_f32_16x16x32_bf16 v[72:75], v[136:139], v[160:163], v[72:75]
    ds_read_b64_tr_b16 v[132:133], v25 offset:2048
    v_fma_f32 v70, -v18, v214, v70
    v_mfma_f32_16x16x32_bf16 v[76:79], v[136:139], v[164:167], v[76:79]
    ds_read_b64_tr_b16 v[134:135], v25 offset:2560
    v_fma_f32 v71, -v18, v215, v71
    v_mfma_f32_16x16x32_bf16 v[92:95], v[140:143], v[164:167], v[92:95]
    ds_read_b64_tr_b16 v[136:137], v24 offset:10240
    v_fma_f32 v80, -v16, v216, v80
    v_fma_f32 v81, -v16, v217, v81
    v_mfma_f32_16x16x32_bf16 v[88:91], v[140:143], v[160:163], v[88:91]
    ds_read_b64_tr_b16 v[138:139], v24 offset:10752
    v_fma_f32 v82, -v16, v218, v82
    v_mfma_f32_16x16x32_bf16 v[104:107], v[160:163], v[144:147], v[104:107]
    ds_read_b64_tr_b16 v[140:141], v25 offset:10240
    v_fma_f32 v83, -v16, v219, v83
    v_mfma_f32_16x16x32_bf16 v[108:111], v[164:167], v[144:147], v[108:111]
    ds_read_b64_tr_b16 v[142:143], v25 offset:10752
    v_fma_f32 v84, -v18, v216, v84
    v_fma_f32 v85, -v18, v217, v85
    v_mfma_f32_16x16x32_bf16 v[124:127], v[164:167], v[148:151], v[124:127]
    ds_read_b64_tr_b16 v[144:145], v24 offset:18432
    v_fma_f32 v86, -v18, v218, v86
    v_mfma_f32_16x16x32_bf16 v[120:123], v[160:163], v[148:151], v[120:123]
    ds_read_b64_tr_b16 v[146:147], v24 offset:18944
    v_fma_f32 v87, -v18, v219, v87
    s_waitcnt vmcnt(10) lgkmcnt(8)
    v_mfma_f32_16x16x32_bf16 v[184:187], v[188:191], v[192:195], v[184:187]
    v_mfma_f32_16x16x32_bf16 v[32:35], v[128:131], v[168:171], v[32:35]
    ds_read_b64_tr_b16 v[148:149], v25 offset:18432
    v_fma_f32 v72, -v20, v212, v72
    v_fma_f32 v73, -v20, v213, v73
    v_mfma_f32_16x16x32_bf16 v[36:39], v[128:131], v[172:175], v[36:39]
    ds_read_b64_tr_b16 v[150:151], v25 offset:18944
    v_fma_f32 v74, -v20, v214, v74
    s_waitcnt lgkmcnt(8)
    v_mfma_f32_16x16x32_bf16 v[52:55], v[132:135], v[172:175], v[52:55]
    v_fma_f32 v75, -v20, v215, v75
    ds_read_b128 v[152:155], v10 offset:0
    v_mfma_f32_16x16x32_bf16 v[48:51], v[132:135], v[168:171], v[48:51]
    ds_read_b64_tr_b16 v[188:189], v28 offset:2048
    v_fma_f32 v76, -v22, v212, v76
    v_fma_f32 v77, -v22, v213, v77
    ds_read_b128 v[156:159], v10 offset:64
    s_waitcnt lgkmcnt(9)
    v_mfma_f32_16x16x32_bf16 v[64:67], v[136:139], v[168:171], v[64:67]
    v_fma_f32 v78, -v22, v214, v78
    ds_read_b32 v17, v8 offset:2816
    v_mfma_f32_16x16x32_bf16 v[68:71], v[136:139], v[172:175], v[68:71]
    ds_read_b64_tr_b16 v[190:191], v28 offset:2560
    v_fma_f32 v79, -v22, v215, v79
    s_waitcnt lgkmcnt(9)
    v_mfma_f32_16x16x32_bf16 v[84:87], v[140:143], v[172:175], v[84:87]
    v_fma_f32 v88, -v20, v216, v88
    v_fma_f32 v89, -v20, v217, v89
    ds_read_b32 v19, v8 offset:2880
    v_mfma_f32_16x16x32_bf16 v[80:83], v[140:143], v[168:171], v[80:83]
    ds_read_b128 v[192:195], v30 offset:1024
    v_fma_f32 v90, -v20, v218, v90
    ds_read_b32 v21, v8 offset:2944
    s_waitcnt lgkmcnt(10)
    v_mfma_f32_16x16x32_bf16 v[96:99], v[168:171], v[144:147], v[96:99]
    v_fma_f32 v91, -v20, v219, v91
    ds_read_b32 v23, v8 offset:3008
    v_mfma_f32_16x16x32_bf16 v[100:103], v[172:175], v[144:147], v[100:103]
    v_fma_f32 v92, -v22, v216, v92
    v_fma_f32 v93, -v22, v217, v93
    s_waitcnt lgkmcnt(9)
    v_mfma_f32_16x16x32_bf16 v[116:119], v[172:175], v[148:151], v[116:119]
    v_fma_f32 v94, -v22, v218, v94
    v_mfma_f32_16x16x32_bf16 v[112:115], v[168:171], v[148:151], v[112:115]
    v_fma_f32 v95, -v22, v219, v95
    s_waitcnt vmcnt(8)
    v_mfma_f32_16x16x32_bf16 v[40:43], v[128:131], v[176:179], v[40:43]
    s_waitcnt lgkmcnt(0)
    v_fma_f32 v32, -v16, v152, v32
    v_fma_f32 v33, -v16, v153, v33
    v_mfma_f32_16x16x32_bf16 v[44:47], v[128:131], v[180:183], v[44:47]
    v_fma_f32 v34, -v16, v154, v34
    v_mfma_f32_16x16x32_bf16 v[60:63], v[132:135], v[180:183], v[60:63]
    ds_read_b64_tr_b16 v[128:129], v24 offset:4096
    v_fma_f32 v35, -v16, v155, v35
    v_fma_f32 v36, -v18, v152, v36
    v_mfma_f32_16x16x32_bf16 v[56:59], v[132:135], v[176:179], v[56:59]
    ds_read_b64_tr_b16 v[130:131], v24 offset:4608
    v_fma_f32 v37, -v18, v153, v37
    v_mfma_f32_16x16x32_bf16 v[72:75], v[136:139], v[176:179], v[72:75]
    ds_read_b64_tr_b16 v[132:133], v25 offset:4096
    v_fma_f32 v38, -v18, v154, v38
    v_fma_f32 v39, -v18, v155, v39
    v_mfma_f32_16x16x32_bf16 v[76:79], v[136:139], v[180:183], v[76:79]
    ds_read_b64_tr_b16 v[134:135], v25 offset:4608
    v_fma_f32 v48, -v16, v156, v48
    v_mfma_f32_16x16x32_bf16 v[92:95], v[140:143], v[180:183], v[92:95]
    ds_read_b64_tr_b16 v[136:137], v24 offset:12288
    v_fma_f32 v49, -v16, v157, v49
    v_fma_f32 v50, -v16, v158, v50
    v_mfma_f32_16x16x32_bf16 v[88:91], v[140:143], v[176:179], v[88:91]
    ds_read_b64_tr_b16 v[138:139], v24 offset:12800
    v_fma_f32 v51, -v16, v159, v51
    v_mfma_f32_16x16x32_bf16 v[104:107], v[176:179], v[144:147], v[104:107]
    ds_read_b64_tr_b16 v[140:141], v25 offset:12288
    v_fma_f32 v52, -v18, v156, v52
    v_fma_f32 v53, -v18, v157, v53
    v_mfma_f32_16x16x32_bf16 v[108:111], v[180:183], v[144:147], v[108:111]
    ds_read_b64_tr_b16 v[142:143], v25 offset:12800
    v_fma_f32 v54, -v18, v158, v54
    v_mfma_f32_16x16x32_bf16 v[124:127], v[180:183], v[148:151], v[124:127]
    ds_read_b64_tr_b16 v[144:145], v24 offset:20480
    v_fma_f32 v55, -v18, v159, v55
    v_mfma_f32_16x16x32_bf16 v[120:123], v[176:179], v[148:151], v[120:123]
    ds_read_b64_tr_b16 v[146:147], v24 offset:20992
    s_waitcnt vmcnt(6) lgkmcnt(8)
    v_mfma_f32_16x16x32_bf16 v[184:187], v[188:191], v[192:195], v[184:187]
    v_mfma_f32_16x16x32_bf16 v[32:35], v[128:131], a[0:3], v[32:35]
    ds_read_b64_tr_b16 v[148:149], v25 offset:20480
    v_fma_f32 v40, -v20, v152, v40
    v_fma_f32 v41, -v20, v153, v41
    v_mfma_f32_16x16x32_bf16 v[36:39], v[128:131], a[4:7], v[36:39]
    ds_read_b64_tr_b16 v[150:151], v25 offset:20992
    v_fma_f32 v42, -v20, v154, v42
    s_waitcnt lgkmcnt(8)
    v_mfma_f32_16x16x32_bf16 v[52:55], v[132:135], a[4:7], v[52:55]
    v_fma_f32 v43, -v20, v155, v43
    v_fma_f32 v44, -v22, v152, v44
    ds_read_b128 v[168:171], v9 offset:1280
    v_mfma_f32_16x16x32_bf16 v[48:51], v[132:135], a[0:3], v[48:51]
    ds_read_b64_tr_b16 v[188:189], v28 offset:4096
    v_fma_f32 v45, -v22, v153, v45
    ds_read_b128 v[172:175], v9 offset:1344
    s_waitcnt lgkmcnt(9)
    v_mfma_f32_16x16x32_bf16 v[64:67], v[136:139], a[0:3], v[64:67]
    v_fma_f32 v46, -v22, v154, v46
    v_fma_f32 v47, -v22, v155, v47
    v_mfma_f32_16x16x32_bf16 v[68:71], v[136:139], a[4:7], v[68:71]
    ds_read_b64_tr_b16 v[190:191], v28 offset:4608
    v_fma_f32 v56, -v20, v156, v56
    ds_read_b128 v[176:179], v9 offset:1408
    s_waitcnt lgkmcnt(9)
    v_mfma_f32_16x16x32_bf16 v[84:87], v[140:143], a[4:7], v[84:87]
    v_fma_f32 v57, -v20, v157, v57
    v_fma_f32 v58, -v20, v158, v58
    ds_read_b128 v[180:183], v9 offset:1472
    v_mfma_f32_16x16x32_bf16 v[80:83], v[140:143], a[0:3], v[80:83]
    ds_read_b128 v[192:195], v30 offset:2048
    v_fma_f32 v59, -v20, v159, v59
    s_waitcnt lgkmcnt(9)
    v_mfma_f32_16x16x32_bf16 v[96:99], a[0:3], v[144:147], v[96:99]
    v_fma_f32 v60, -v22, v156, v60
    v_fma_f32 v61, -v22, v157, v61
    ds_read2_b32 v[220:221], v11 offset0:64 offset1:80
    v_mfma_f32_16x16x32_bf16 v[100:103], a[4:7], v[144:147], v[100:103]
    v_fma_f32 v62, -v22, v158, v62
    s_waitcnt lgkmcnt(8)
    v_mfma_f32_16x16x32_bf16 v[116:119], a[4:7], v[148:151], v[116:119]
    v_fma_f32 v63, -v22, v159, v63
    v_mfma_f32_16x16x32_bf16 v[112:115], a[0:3], v[148:151], v[112:115]
    s_waitcnt vmcnt(4)
    v_mfma_f32_16x16x32_bf16 v[40:43], v[128:131], a[8:11], v[40:43]
    v_mfma_f32_16x16x32_bf16 v[44:47], v[128:131], a[12:15], v[44:47]
    s_waitcnt lgkmcnt(0)
    v_fma_f32 v96, -v168, v220, v96
    v_fma_f32 v97, -v169, v220, v97
    v_mfma_f32_16x16x32_bf16 v[60:63], v[132:135], a[12:15], v[60:63]
    ds_read_b64_tr_b16 v[128:129], v24 offset:6144
    v_fma_f32 v98, -v170, v220, v98
    v_mfma_f32_16x16x32_bf16 v[56:59], v[132:135], a[8:11], v[56:59]
    ds_read_b64_tr_b16 v[130:131], v24 offset:6656
    v_fma_f32 v99, -v171, v220, v99
    v_fma_f32 v100, -v172, v220, v100
    v_mfma_f32_16x16x32_bf16 v[72:75], v[136:139], a[8:11], v[72:75]
    ds_read_b64_tr_b16 v[132:133], v25 offset:6144
    v_fma_f32 v101, -v173, v220, v101
    v_mfma_f32_16x16x32_bf16 v[76:79], v[136:139], a[12:15], v[76:79]
    ds_read_b64_tr_b16 v[134:135], v25 offset:6656
    v_fma_f32 v102, -v174, v220, v102
    v_fma_f32 v103, -v175, v220, v103
    v_mfma_f32_16x16x32_bf16 v[92:95], v[140:143], a[12:15], v[92:95]
    ds_read_b64_tr_b16 v[136:137], v24 offset:14336
    v_fma_f32 v112, -v168, v221, v112
    v_mfma_f32_16x16x32_bf16 v[88:91], v[140:143], a[8:11], v[88:91]
    ds_read_b64_tr_b16 v[138:139], v24 offset:14848
    v_fma_f32 v113, -v169, v221, v113
    v_fma_f32 v114, -v170, v221, v114
    v_mfma_f32_16x16x32_bf16 v[104:107], a[8:11], v[144:147], v[104:107]
    ds_read_b64_tr_b16 v[140:141], v25 offset:14336
    v_fma_f32 v115, -v171, v221, v115
    v_mfma_f32_16x16x32_bf16 v[108:111], a[12:15], v[144:147], v[108:111]
    ds_read_b64_tr_b16 v[142:143], v25 offset:14848
    v_fma_f32 v116, -v172, v221, v116
    v_fma_f32 v117, -v173, v221, v117
    v_mfma_f32_16x16x32_bf16 v[124:127], a[12:15], v[148:151], v[124:127]
    ds_read_b64_tr_b16 v[144:145], v24 offset:22528
    v_fma_f32 v118, -v174, v221, v118
    v_mfma_f32_16x16x32_bf16 v[120:123], a[8:11], v[148:151], v[120:123]
    ds_read_b64_tr_b16 v[146:147], v24 offset:23040
    v_fma_f32 v119, -v175, v221, v119
    s_waitcnt vmcnt(2) lgkmcnt(8)
    v_mfma_f32_16x16x32_bf16 v[184:187], v[188:191], v[192:195], v[184:187]
    v_mfma_f32_16x16x32_bf16 v[32:35], v[128:131], a[16:19], v[32:35]
    ds_read_b64_tr_b16 v[148:149], v25 offset:22528
    v_mfma_f32_16x16x32_bf16 v[36:39], v[128:131], a[20:23], v[36:39]
    ds_read_b64_tr_b16 v[150:151], v25 offset:23040
    v_fma_f32 v104, -v176, v220, v104
    v_fma_f32 v105, -v177, v220, v105
    s_waitcnt lgkmcnt(8)
    v_mfma_f32_16x16x32_bf16 v[52:55], v[132:135], a[20:23], v[52:55]
    v_fma_f32 v106, -v178, v220, v106
    ds_read_b128 v[152:155], v9 offset:2816
    v_mfma_f32_16x16x32_bf16 v[48:51], v[132:135], a[16:19], v[48:51]
    ds_read_b64_tr_b16 v[188:189], v28 offset:6144
    v_fma_f32 v107, -v179, v220, v107
    v_fma_f32 v108, -v180, v220, v108
    ds_read_b128 v[156:159], v9 offset:2880
    s_waitcnt lgkmcnt(9)
    v_mfma_f32_16x16x32_bf16 v[64:67], v[136:139], a[16:19], v[64:67]
    v_fma_f32 v109, -v181, v220, v109
    ds_read_b128 v[160:163], v9 offset:2944
    v_mfma_f32_16x16x32_bf16 v[68:71], v[136:139], a[20:23], v[68:71]
    ds_read_b64_tr_b16 v[190:191], v28 offset:6656
    v_fma_f32 v110, -v182, v220, v110
    v_fma_f32 v111, -v183, v220, v111
    ds_read_b128 v[164:167], v9 offset:3008
    s_waitcnt lgkmcnt(10)
    v_mfma_f32_16x16x32_bf16 v[84:87], v[140:143], a[20:23], v[84:87]
    v_fma_f32 v120, -v176, v221, v120
    ds_read_b128 v[212:215], v14 offset:128
    v_mfma_f32_16x16x32_bf16 v[80:83], v[140:143], a[16:19], v[80:83]
    ds_read_b128 v[192:195], v30 offset:3072
    v_fma_f32 v121, -v177, v221, v121
    v_fma_f32 v122, -v178, v221, v122
    ds_read_b32 v222, v11 offset:1216
    s_waitcnt lgkmcnt(11)
    v_mfma_f32_16x16x32_bf16 v[96:99], a[16:19], v[144:147], v[96:99]
    v_fma_f32 v123, -v179, v221, v123
    ds_read_b32 v223, v11 offset:2752
    v_mfma_f32_16x16x32_bf16 v[100:103], a[20:23], v[144:147], v[100:103]
    v_fma_f32 v124, -v180, v221, v124
    v_fma_f32 v125, -v181, v221, v125
    s_waitcnt lgkmcnt(10)
    v_mfma_f32_16x16x32_bf16 v[116:119], a[20:23], v[148:151], v[116:119]
    v_fma_f32 v126, -v182, v221, v126
    v_mfma_f32_16x16x32_bf16 v[112:115], a[16:19], v[148:151], v[112:115]
    v_fma_f32 v127, -v183, v221, v127
    s_waitcnt vmcnt(0) lgkmcnt(2)
    v_mfma_f32_16x16x32_bf16 v[40:43], v[128:131], a[24:27], v[40:43]
    v_mul_f32 v64, v17, v64
    v_mul_f32 v65, v17, v65
    s_barrier
    v_mfma_f32_16x16x32_bf16 v[44:47], v[128:131], a[28:31], v[44:47]
    v_mul_f32 v66, v17, v66
    v_mul_f32 v67, v17, v67
    v_mfma_f32_16x16x32_bf16 v[60:63], v[132:135], a[28:31], v[60:63]
    v_mul_f32 v80, v17, v80
    v_mul_f32 v81, v17, v81
    v_mfma_f32_16x16x32_bf16 v[56:59], v[132:135], a[24:27], v[56:59]
    v_mul_f32 v82, v17, v82
    v_mul_f32 v83, v17, v83
    v_mfma_f32_16x16x32_bf16 v[72:75], v[136:139], a[24:27], v[72:75]
    v_cvt_pk_bf16_f32 v64, v64, v65
    v_cvt_pk_bf16_f32 v65, v66, v67
    v_mfma_f32_16x16x32_bf16 v[76:79], v[136:139], a[28:31], v[76:79]
    v_cvt_pk_bf16_f32 v66, v80, v81
    v_cvt_pk_bf16_f32 v67, v82, v83
    v_mfma_f32_16x16x32_bf16 v[92:95], v[140:143], a[28:31], v[92:95]
    v_mul_f32 v68, v19, v68
    v_mul_f32 v69, v19, v69
    v_mfma_f32_16x16x32_bf16 v[88:91], v[140:143], a[24:27], v[88:91]
    v_mul_f32 v70, v19, v70
    v_mul_f32 v71, v19, v71
    v_mfma_f32_16x16x32_bf16 v[104:107], a[24:27], v[144:147], v[104:107]
    v_mul_f32 v84, v19, v84
    v_mul_f32 v85, v19, v85
    v_mfma_f32_16x16x32_bf16 v[108:111], a[28:31], v[144:147], v[108:111]
    v_mul_f32 v86, v19, v86
    v_mul_f32 v87, v19, v87
    v_mfma_f32_16x16x32_bf16 v[124:127], a[28:31], v[148:151], v[124:127]
    v_cvt_pk_bf16_f32 v68, v68, v69
    v_cvt_pk_bf16_f32 v69, v70, v71
    v_mfma_f32_16x16x32_bf16 v[120:123], a[24:27], v[148:151], v[120:123]
    v_cvt_pk_bf16_f32 v70, v84, v85
    v_cvt_pk_bf16_f32 v71, v86, v87
    v_mfma_f32_16x16x32_bf16 v[184:187], v[188:191], v[192:195], v[184:187]
    v_pk_mul_f32 v[72:73], v[20:21], v[72:73] op_sel:[1,0] op_sel_hi:[1,1]
    v_pk_mul_f32 v[74:75], v[20:21], v[74:75] op_sel:[1,0] op_sel_hi:[1,1]
    v_pk_mul_f32 v[88:89], v[20:21], v[88:89] op_sel:[1,0] op_sel_hi:[1,1]
    v_pk_mul_f32 v[90:91], v[20:21], v[90:91] op_sel:[1,0] op_sel_hi:[1,1]
    v_cvt_pk_bf16_f32 v72, v72, v73
    v_cvt_pk_bf16_f32 v73, v74, v75
    v_cvt_pk_bf16_f32 v74, v88, v89
    v_cvt_pk_bf16_f32 v75, v90, v91
    v_pk_mul_f32 v[76:77], v[22:23], v[76:77] op_sel:[1,0] op_sel_hi:[1,1]
    v_pk_mul_f32 v[78:79], v[22:23], v[78:79] op_sel:[1,0] op_sel_hi:[1,1]
    v_pk_mul_f32 v[92:93], v[22:23], v[92:93] op_sel:[1,0] op_sel_hi:[1,1]
    v_pk_mul_f32 v[94:95], v[22:23], v[94:95] op_sel:[1,0] op_sel_hi:[1,1]
    v_cvt_pk_bf16_f32 v76, v76, v77
    v_cvt_pk_bf16_f32 v77, v78, v79
    v_cvt_pk_bf16_f32 v78, v92, v93
    v_cvt_pk_bf16_f32 v79, v94, v95
    ds_write_b128 v12, v[76:79] offset:2048
    s_waitcnt lgkmcnt(1)
    v_pk_mul_f32 v[96:97], v[152:153], v[96:97]
    v_pk_mul_f32 v[98:99], v[154:155], v[98:99]
    v_pk_mul_f32 v[112:113], v[152:153], v[112:113]
    v_pk_mul_f32 v[114:115], v[154:155], v[114:115]
    v_cvt_pk_bf16_f32 v99, v98, v99
    v_cvt_pk_bf16_f32 v98, v96, v97
    v_cvt_pk_bf16_f32 v115, v114, v115
    v_cvt_pk_bf16_f32 v114, v112, v113
    v_pk_mul_f32 v[100:101], v[156:157], v[100:101]
    v_pk_mul_f32 v[102:103], v[158:159], v[102:103]
    v_pk_mul_f32 v[116:117], v[156:157], v[116:117]
    v_pk_mul_f32 v[118:119], v[158:159], v[118:119]
    v_cvt_pk_bf16_f32 v100, v100, v101
    v_cvt_pk_bf16_f32 v101, v102, v103
    v_cvt_pk_bf16_f32 v116, v116, v117
    v_cvt_pk_bf16_f32 v117, v118, v119
    v_pk_mul_f32 v[104:105], v[160:161], v[104:105]
    v_pk_mul_f32 v[106:107], v[162:163], v[106:107]
    v_pk_mul_f32 v[120:121], v[160:161], v[120:121]
    v_pk_mul_f32 v[122:123], v[162:163], v[122:123]
    v_cvt_pk_bf16_f32 v102, v104, v105
    v_cvt_pk_bf16_f32 v103, v106, v107
    v_cvt_pk_bf16_f32 v118, v120, v121
    v_cvt_pk_bf16_f32 v119, v122, v123
    v_pk_mul_f32 v[108:109], v[164:165], v[108:109]
    v_pk_mul_f32 v[110:111], v[166:167], v[110:111]
    v_pk_mul_f32 v[124:125], v[164:165], v[124:125]
    v_pk_mul_f32 v[126:127], v[166:167], v[126:127]
    v_cvt_pk_bf16_f32 v104, v108, v109
    v_cvt_pk_bf16_f32 v105, v110, v111
    v_cvt_pk_bf16_f32 v120, v124, v125
    v_cvt_pk_bf16_f32 v121, v126, v127
    ds_write_b64 v12, v[104:105] offset:3072
    ds_write_b64 v12, v[120:121] offset:3080
    v_pk_fma_f32 v[184:185], v[222:223], v[212:213], v[184:185] op_sel_hi:[0,1,1] neg_lo:[1,0,0] neg_hi:[1,0,0]
    v_pk_fma_f32 v[186:187], v[222:223], v[214:215], v[186:187] op_sel_hi:[0,1,1] neg_lo:[1,0,0] neg_hi:[1,0,0]
    v_pk_mul_f32 v[184:185], v[222:223], v[184:185] op_sel:[1,0] op_sel_hi:[1,1]
    v_pk_mul_f32 v[186:187], v[222:223], v[186:187] op_sel:[1,0] op_sel_hi:[1,1]
    v_cvt_pk_bf16_f32 v184, v184, v185
    v_cvt_pk_bf16_f32 v185, v186, v187
    s_cmp_ge_u32 s8, 2
    s_cbranch_scc1 c_qkvA_hv
    ds_write_b64 v13, v[184:185]
    s_branch c_qkvA_hd
c_qkvA_hv:
    ds_write_b16 v13, v184 offset:0
    ds_write_b16_d16_hi v13, v184 offset:16
    ds_write_b16 v13, v185 offset:32
    ds_write_b16_d16_hi v13, v185 offset:48
c_qkvA_hd:
    v_cvt_pk_bf16_f32 v44, v44, v45
    v_cvt_pk_bf16_f32 v45, v46, v47
    v_cvt_pk_bf16_f32 v46, v60, v61
    v_cvt_pk_bf16_f32 v47, v62, v63
    v_mul_f32 v23, 0x3e8293ee, v23
    v_cvt_pk_bf16_f32 v40, v40, v41
    v_cvt_pk_bf16_f32 v41, v42, v43
    v_cvt_pk_bf16_f32 v42, v56, v57
    v_cvt_pk_bf16_f32 v43, v58, v59
    v_mul_f32 v21, 0x3e8293ee, v21
    s_waitcnt lgkmcnt(0)
    s_barrier
    ds_read_b128 v[172:175], v12
    ds_read_b64 v[96:97], v12 offset:1024
    ds_read_b64 v[112:113], v12 offset:1032
    v_mfma_f32_16x16x32_bf16 v[156:159], v[76:79], v[44:47], v[196:199]
    v_mfma_f32_16x16x32_bf16 v[152:155], v[72:75], v[44:47], v[200:203]
    v_cvt_pk_bf16_f32 v36, v36, v37
    v_cvt_pk_bf16_f32 v37, v38, v39
    v_cvt_pk_bf16_f32 v38, v52, v53
    v_cvt_pk_bf16_f32 v39, v54, v55
    v_mul_f32 v19, 0x3e8293ee, v19
    v_mfma_f32_16x16x32_bf16 v[148:151], v[72:75], v[40:43], v[196:199]
    v_mfma_f32_16x16x32_bf16 v[144:147], v[68:71], v[40:43], v[200:203]
    v_cvt_pk_bf16_f32 v32, v32, v33
    v_cvt_pk_bf16_f32 v33, v34, v35
    v_cvt_pk_bf16_f32 v34, v48, v49
    v_cvt_pk_bf16_f32 v35, v50, v51
    v_mul_f32 v17, 0x3e8293ee, v17
    v_mfma_f32_16x16x32_bf16 v[140:143], v[68:71], v[36:39], v[196:199]
    v_mfma_f32_16x16x32_bf16 v[136:139], v[64:67], v[36:39], v[200:203]
    s_waitcnt lgkmcnt(2)
    v_mfma_f32_16x16x32_bf16 v[132:135], v[64:67], v[32:35], v[196:199]
    v_mfma_f32_16x16x32_bf16 v[128:131], v[172:175], v[32:35], v[204:207]
    v_max3_f32 v179, v152, v153, v154
    v_max3_f32 v183, v155, v156, v157
    v_max3_f32 v179, v179, v158, v159
    v_max_f32 v179, v179, v183
    v_max3_f32 v178, v144, v145, v146
    v_max3_f32 v182, v147, v148, v149
    v_max3_f32 v178, v178, v150, v151
    v_max_f32 v178, v178, v182
    v_max3_f32 v177, v136, v137, v138
    v_max3_f32 v181, v139, v140, v141
    v_max3_f32 v177, v177, v142, v143
    v_max_f32 v177, v177, v181
    v_max3_f32 v176, v128, v129, v130
    v_max3_f32 v180, v131, v132, v133
    v_max3_f32 v176, v176, v134, v135
    v_max_f32 v176, v176, v180
    v_mov_b32 v183, v179
    v_mov_b32 v182, v178
    v_mov_b32 v181, v177
    v_mov_b32 v180, v176
    v_permlane32_swap_b32 v179, v183
    v_permlane32_swap_b32 v178, v182
    v_permlane32_swap_b32 v177, v181
    v_permlane32_swap_b32 v176, v180
    v_max_f32 v179, v179, v183
    v_max_f32 v178, v178, v182
    v_max_f32 v177, v177, v181
    v_max_f32 v176, v176, v180
    v_mov_b32 v183, v179
    v_mov_b32 v182, v178
    v_mov_b32 v181, v177
    v_mov_b32 v180, v176
    v_permlane16_swap_b32 v179, v183
    v_permlane16_swap_b32 v178, v182
    v_permlane16_swap_b32 v177, v181
    v_permlane16_swap_b32 v176, v180
    v_max_f32 v179, v179, v183
    v_max_f32 v178, v178, v182
    v_max_f32 v177, v177, v181
    v_max_f32 v176, v176, v180
    v_mul_f32_e64 v22, -v179, v23
    v_mul_f32_e64 v20, -v178, v21
    v_mul_f32_e64 v18, -v177, v19
    v_mul_f32_e64 v16, -v176, v17
    s_waitcnt lgkmcnt(0)
    s_add_u32 s51, s49, 65536
    v_pk_fma_f32 v[152:153], v[152:153], v[22:23], v[22:23] op_sel:[0,1,0] op_sel_hi:[1,1,0]
    v_pk_fma_f32 v[154:155], v[154:155], v[22:23], v[22:23] op_sel:[0,1,0] op_sel_hi:[1,1,0]
    v_pk_fma_f32 v[156:157], v[156:157], v[22:23], v[22:23] op_sel:[0,1,0] op_sel_hi:[1,1,0]
    v_pk_fma_f32 v[158:159], v[158:159], v[22:23], v[22:23] op_sel:[0,1,0] op_sel_hi:[1,1,0]
    v_exp_f32 v152, v152
    v_exp_f32 v153, v153
    v_exp_f32 v154, v154
    v_exp_f32 v155, v155
    v_exp_f32 v156, v156
    v_exp_f32 v157, v157
    v_exp_f32 v158, v158
    v_exp_f32 v159, v159
    v_cvt_pk_bf16_f32 v172, v152, v153
    v_cvt_pk_bf16_f32 v173, v154, v155
    v_cvt_pk_bf16_f32 v174, v156, v157
    v_cvt_pk_bf16_f32 v175, v158, v159
    s_nop 1
    v_mfma_f32_16x16x32_bf16 v[92:95], v[208:211], v[172:175], 0
    v_mfma_f32_16x16x32_bf16 v[60:63], v[102:105], v[172:175], 0
    v_mfma_f32_16x16x32_bf16 v[76:79], v[118:121], v[172:175], 0
    v_pk_fma_f32 v[144:145], v[144:145], v[20:21], v[20:21] op_sel:[0,1,0] op_sel_hi:[1,1,0]
    v_pk_fma_f32 v[146:147], v[146:147], v[20:21], v[20:21] op_sel:[0,1,0] op_sel_hi:[1,1,0]
    v_pk_fma_f32 v[148:149], v[148:149], v[20:21], v[20:21] op_sel:[0,1,0] op_sel_hi:[1,1,0]
    v_pk_fma_f32 v[150:151], v[150:151], v[20:21], v[20:21] op_sel:[0,1,0] op_sel_hi:[1,1,0]
    v_exp_f32 v144, v144
    v_exp_f32 v145, v145
    v_exp_f32 v146, v146
    v_exp_f32 v147, v147
    v_exp_f32 v148, v148
    v_exp_f32 v149, v149
    v_exp_f32 v150, v150
    v_exp_f32 v151, v151
    v_cvt_pk_bf16_f32 v168, v144, v145
    v_cvt_pk_bf16_f32 v169, v146, v147
    v_cvt_pk_bf16_f32 v170, v148, v149
    v_cvt_pk_bf16_f32 v171, v150, v151
    v_rcp_f32 v92, v92
    s_nop 0
    v_pk_mul_f32 v[60:61], v[92:93], v[60:61] op_sel_hi:[0,1]
    v_pk_mul_f32 v[62:63], v[92:93], v[62:63] op_sel_hi:[0,1]
    v_pk_mul_f32 v[76:77], v[92:93], v[76:77] op_sel_hi:[0,1]
    v_pk_mul_f32 v[78:79], v[92:93], v[78:79] op_sel_hi:[0,1]
    v_cvt_pk_bf16_f32 v60, v60, v61
    v_cvt_pk_bf16_f32 v61, v62, v63
    v_cvt_pk_bf16_f32 v62, v76, v77
    v_cvt_pk_bf16_f32 v63, v78, v79
    s_nop 0
    v_permlane32_swap_b32 v60, v62
    v_permlane32_swap_b32 v61, v63
    buffer_store_dwordx4 v[60:63], v6, s[12:15], s51 offen offset:256 sc1
    v_mfma_f32_16x16x32_bf16 v[88:91], v[208:211], v[168:171], 0
    v_mfma_f32_16x16x32_bf16 v[56:59], v[100:103], v[168:171], 0
    v_mfma_f32_16x16x32_bf16 v[72:75], v[116:119], v[168:171], 0
    v_pk_fma_f32 v[136:137], v[136:137], v[18:19], v[18:19] op_sel:[0,1,0] op_sel_hi:[1,1,0]
    v_pk_fma_f32 v[138:139], v[138:139], v[18:19], v[18:19] op_sel:[0,1,0] op_sel_hi:[1,1,0]
    v_pk_fma_f32 v[140:141], v[140:141], v[18:19], v[18:19] op_sel:[0,1,0] op_sel_hi:[1,1,0]
    v_pk_fma_f32 v[142:143], v[142:143], v[18:19], v[18:19] op_sel:[0,1,0] op_sel_hi:[1,1,0]
    v_exp_f32 v136, v136
    v_exp_f32 v137, v137
    v_exp_f32 v138, v138
    v_exp_f32 v139, v139
    v_exp_f32 v140, v140
    v_exp_f32 v141, v141
    v_exp_f32 v142, v142
    v_exp_f32 v143, v143
    v_cvt_pk_bf16_f32 v164, v136, v137
    v_cvt_pk_bf16_f32 v165, v138, v139
    v_cvt_pk_bf16_f32 v166, v140, v141
    v_cvt_pk_bf16_f32 v167, v142, v143
    v_rcp_f32 v88, v88
    s_nop 0
    v_pk_mul_f32 v[56:57], v[88:89], v[56:57] op_sel_hi:[0,1]
    v_pk_mul_f32 v[58:59], v[88:89], v[58:59] op_sel_hi:[0,1]
    v_pk_mul_f32 v[72:73], v[88:89], v[72:73] op_sel_hi:[0,1]
    v_pk_mul_f32 v[74:75], v[88:89], v[74:75] op_sel_hi:[0,1]
    v_cvt_pk_bf16_f32 v56, v56, v57
    v_cvt_pk_bf16_f32 v57, v58, v59
    v_cvt_pk_bf16_f32 v58, v72, v73
    v_cvt_pk_bf16_f32 v59, v74, v75
    s_nop 0
    v_permlane32_swap_b32 v56, v58
    v_permlane32_swap_b32 v57, v59
    buffer_store_dwordx4 v[56:59], v6, s[12:15], s51 offen offset:0 sc1
    v_mfma_f32_16x16x32_bf16 v[84:87], v[208:211], v[164:167], 0
    v_mfma_f32_16x16x32_bf16 v[52:55], v[98:101], v[164:167], 0
    v_mfma_f32_16x16x32_bf16 v[68:71], v[114:117], v[164:167], 0
    v_pk_fma_f32 v[128:129], v[128:129], v[16:17], v[16:17] op_sel:[0,1,0] op_sel_hi:[1,1,0]
    v_pk_fma_f32 v[130:131], v[130:131], v[16:17], v[16:17] op_sel:[0,1,0] op_sel_hi:[1,1,0]
    v_pk_fma_f32 v[132:133], v[132:133], v[16:17], v[16:17] op_sel:[0,1,0] op_sel_hi:[1,1,0]
    v_pk_fma_f32 v[134:135], v[134:135], v[16:17], v[16:17] op_sel:[0,1,0] op_sel_hi:[1,1,0]
    v_exp_f32 v128, v128
    v_exp_f32 v129, v129
    v_exp_f32 v130, v130
    v_exp_f32 v131, v131
    v_exp_f32 v132, v132
    v_exp_f32 v133, v133
    v_exp_f32 v134, v134
    v_exp_f32 v135, v135
    v_cvt_pk_bf16_f32 v160, v128, v129
    v_cvt_pk_bf16_f32 v161, v130, v131
    v_cvt_pk_bf16_f32 v162, v132, v133
    v_cvt_pk_bf16_f32 v163, v134, v135
    v_rcp_f32 v84, v84
    s_nop 0
    v_pk_mul_f32 v[52:53], v[84:85], v[52:53] op_sel_hi:[0,1]
    v_pk_mul_f32 v[54:55], v[84:85], v[54:55] op_sel_hi:[0,1]
    v_pk_mul_f32 v[68:69], v[84:85], v[68:69] op_sel_hi:[0,1]
    v_pk_mul_f32 v[70:71], v[84:85], v[70:71] op_sel_hi:[0,1]
    v_cvt_pk_bf16_f32 v52, v52, v53
    v_cvt_pk_bf16_f32 v53, v54, v55
    v_cvt_pk_bf16_f32 v54, v68, v69
    v_cvt_pk_bf16_f32 v55, v70, v71
    s_nop 0
    v_permlane32_swap_b32 v52, v54
    v_permlane32_swap_b32 v53, v55
    buffer_store_dwordx4 v[52:55], v6, s[12:15], s49 offen offset:256 sc1
    v_mfma_f32_16x16x32_bf16 v[80:83], v[208:211], v[160:163], 0
    v_mfma_f32_16x16x32_bf16 v[48:51], v[96:99], v[160:163], 0
    v_mfma_f32_16x16x32_bf16 v[64:67], v[112:115], v[160:163], 0
    s_nop 5
    v_rcp_f32 v80, v80
    s_nop 0
    v_pk_mul_f32 v[48:49], v[80:81], v[48:49] op_sel_hi:[0,1]
    v_pk_mul_f32 v[50:51], v[80:81], v[50:51] op_sel_hi:[0,1]
    v_pk_mul_f32 v[64:65], v[80:81], v[64:65] op_sel_hi:[0,1]
    v_pk_mul_f32 v[66:67], v[80:81], v[66:67] op_sel_hi:[0,1]
    v_cvt_pk_bf16_f32 v48, v48, v49
    v_cvt_pk_bf16_f32 v49, v50, v51
    v_cvt_pk_bf16_f32 v50, v64, v65
    v_cvt_pk_bf16_f32 v51, v66, v67
    s_nop 0
    v_permlane32_swap_b32 v48, v50
    v_permlane32_swap_b32 v49, v51
    buffer_store_dwordx4 v[48:51], v6, s[12:15], s49 offen offset:0 sc1
    s_branch c_wo
.p2align 6
c_wo:
    v_and_b32 v1, 63, v0
    v_lshrrev_b32 v2, 6, v0
    v_lshlrev_b32 v5, 4, v1
    v_lshrrev_b32 v3, 5, v1
    s_lshl_b32 s48, s6, 2
    s_add_u32 s48, s48, s8
    s_lshl_b32 s55, s48, 16
    s_lshl_b32 s56, s9, 22
    s_add_u32 s55, s55, s56
    s_lshl_b32 s56, s7, 12
    s_add_u32 s58, s55, s56
    s_add_u32 s55, s55, 16777216
    s_add_u32 s16, s4, s55
    s_addc_u32 s17, s5, 0
    s_mov_b32 s18, 65536
    s_mov_b32 s19, 0x00020000
    s_lshl_b32 s60, s9, 2
    s_add_u32 s60, s60, 159504
    v_mov_b32 v28, s60
    s_mul_i32 s55, s9, 786432
    s_add_u32 s55, s55, 65798144
    v_and_b32 v24, 63, v0
    s_and_b32 s56, s11, 0xe0
    v_lshrrev_b32 v25, 5, v24
    v_add_u32 v24, s56, v24
    v_and_b32 v24, 255, v24
    v_lshlrev_b32 v24, 10, v24
    v_lshl_add_u32 v24, v25, 8, v24
    s_bfe_u32 s56, s11, 0x20003
    s_and_b32 s57, s11, 7
    s_lshl_b32 s56, s56, 7
    s_lshl_b32 s57, s57, 2
    s_add_u32 s55, s55, s56
    s_add_u32 s55, s55, s57
    v_mov_b32 v25, 159488
    v_mov_b32 v26, 1
    v_mov_b32 v27, s10
    v_and_b32 v4, 15, v0
    v_lshrrev_b32 v16, 2, v4
    v_lshl_add_u32 v16, v3, 2, v16
    v_lshlrev_b32 v16, 7, v16
    v_bfe_u32 v17, v1, 4, 1
    v_lshl_add_u32 v16, v17, 5, v16
    v_and_b32 v17, 3, v4
    v_lshl_add_u32 v16, v17, 3, v16
    v_lshrrev_b32 v17, 3, v4
    v_lshlrev_b32 v18, 6, v17
    v_add_u32 v12, v16, v18
    v_sub_u32 v13, v16, v18
    ds_read_b32 v29, v28
    buffer_load_dwordx4 v[96:99], v5, s[12:15], s58 offen offset:0 sc1
    buffer_load_dwordx4 v[100:103], v5, s[12:15], s58 offen offset:1024 sc1
    buffer_load_dwordx4 v[104:107], v5, s[12:15], s58 offen offset:2048 sc1
    buffer_load_dwordx4 v[108:111], v5, s[12:15], s58 offen offset:3072 sc1
    s_waitcnt lgkmcnt(0)
    v_readfirstlane_b32 s60, v29
    s_lshr_b32 s51, s60, 2
    s_and_b32 s51, s51, s60
    s_and_b32 s51, s51, 3
    s_cmp_eq_u32 s51, 0
    s_cbranch_scc1 c_wo_late
    s_and_b32 s52, s51, 1
    s_xor_b32 s52, s52, 1
    s_lshl_b32 s50, s52, 15
    buffer_load_dwordx4 v[112:115], v5, s[16:19], s50 offen offset:0 sc1
    buffer_load_dwordx4 v[116:119], v5, s[16:19], s50 offen offset:1024 sc1
    buffer_load_dwordx4 v[120:123], v5, s[16:19], s50 offen offset:2048 sc1
    buffer_load_dwordx4 v[124:127], v5, s[16:19], s50 offen offset:3072 sc1
    s_add_u32 s50, s50, 4096
    buffer_load_dwordx4 v[128:131], v5, s[16:19], s50 offen offset:0 sc1
    s_mov_b64 exec, 1
    s_waitcnt vmcnt(9)
    ds_add_rtn_u32 v26, v25, v26
    s_waitcnt lgkmcnt(0)
    v_readfirstlane_b32 s56, v26
    s_and_b32 s56, s56, 3
    s_cmp_lg_u32 s56, 3
    s_cbranch_scc1 pub_2
    s_mov_b32 exec_lo, -1
    buffer_store_dword v27, v24, s[12:15], s55 offen sc1
pub_2:
    s_mov_b64 exec, -1
    s_branch c_wo_run
c_wo_late:
    s_mov_b64 exec, 1
    s_waitcnt vmcnt(4)
    ds_add_rtn_u32 v26, v25, v26
    s_waitcnt lgkmcnt(0)
    v_readfirstlane_b32 s56, v26
    s_and_b32 s56, s56, 3
    s_cmp_lg_u32 s56, 3
    s_cbranch_scc1 pub_3
    s_mov_b32 exec_lo, -1
    buffer_store_dword v27, v24, s[12:15], s55 offen sc1
pub_3:
    s_mov_b64 exec, -1
    s_branch wp_4_t
wp_4:
    ds_read_b32 v29, v28
    s_waitcnt lgkmcnt(0)
    v_readfirstlane_b32 s60, v29
    s_lshr_b32 s51, s60, 2
    s_and_b32 s51, s51, s60
    s_and_b32 s51, s51, 3
wp_4_t:
    s_cmp_lg_u32 s51, 0
    s_cbranch_scc0 wp_4
    s_and_b32 s52, s51, 1
    s_xor_b32 s52, s52, 1
    s_lshl_b32 s50, s52, 15
    buffer_load_dwordx4 v[112:115], v5, s[16:19], s50 offen offset:0 sc1
    buffer_load_dwordx4 v[116:119], v5, s[16:19], s50 offen offset:1024 sc1
    buffer_load_dwordx4 v[120:123], v5, s[16:19], s50 offen offset:2048 sc1
    buffer_load_dwordx4 v[124:127], v5, s[16:19], s50 offen offset:3072 sc1
    s_add_u32 s50, s50, 4096
    buffer_load_dwordx4 v[128:131], v5, s[16:19], s50 offen offset:0 sc1
c_wo_run:
    buffer_load_dwordx4 v[132:135], v5, s[16:19], s50 offen offset:1024 sc1
    buffer_load_dwordx4 v[136:139], v5, s[16:19], s50 offen offset:2048 sc1
    buffer_load_dwordx4 v[140:143], v5, s[16:19], s50 offen offset:3072 sc1
    s_add_u32 s50, s50, 4096
    s_lshl_b32 s3, s52, 16
    v_add_u32 v12, s3, v12
    v_add_u32 v13, s3, v13
    v_xor_b32 v14, 0x10000, v12
    v_xor_b32 v15, 0x10000, v13
    s_cmp_eq_u32 s52, 0
    s_mov_b32 s3, 0x0c0c0c0c
    s_cselect_b32 s53, 0x01000c0c, s3
    s_cselect_b32 s54, 0x03020c0c, s3
    s_cselect_b32 s59, s3, 0x01000c0c
    s_cselect_b32 s97, s3, 0x03020c0c
    s_branch wp_5_t
wp_5:
    ds_read_b32 v29, v28
    s_waitcnt lgkmcnt(0)
    v_readfirstlane_b32 s60, v29
    s_lshr_b32 s51, s60, 2
    s_and_b32 s51, s51, s60
    s_and_b32 s51, s51, 3
wp_5_t:
    s_cmp_ge_u32 s60, 0xf0
    s_cbranch_scc0 wp_5
    ds_read_b64_tr_b16 v[64:65], v12 offset:0
    ds_read_b64_tr_b16 v[66:67], v12 offset:1024
    ds_read_b64_tr_b16 v[68:69], v13 offset:64
    ds_read_b64_tr_b16 v[70:71], v13 offset:1088
    ds_read_b64_tr_b16 v[72:73], v12 offset:2048
    ds_read_b64_tr_b16 v[74:75], v12 offset:3072
    ds_read_b64_tr_b16 v[76:77], v13 offset:2112
    ds_read_b64_tr_b16 v[78:79], v13 offset:3136
    ds_read_b64_tr_b16 v[80:81], v12 offset:4096
    ds_read_b64_tr_b16 v[82:83], v12 offset:5120
    ds_read_b64_tr_b16 v[84:85], v13 offset:4160
    ds_read_b64_tr_b16 v[86:87], v13 offset:5184
    s_waitcnt vmcnt(8)
    v_perm_b32 v32, v96, v96, s53
    v_perm_b32 v33, v96, v96, s54
    v_perm_b32 v34, v97, v97, s53
    v_perm_b32 v35, v97, v97, s54
    v_perm_b32 v36, v98, v98, s53
    v_perm_b32 v37, v98, v98, s54
    v_perm_b32 v38, v99, v99, s53
    v_perm_b32 v39, v99, v99, s54
    v_perm_b32 v40, v100, v100, s53
    v_perm_b32 v41, v100, v100, s54
    v_perm_b32 v42, v101, v101, s53
    v_perm_b32 v43, v101, v101, s54
    v_perm_b32 v44, v102, v102, s53
    v_perm_b32 v45, v102, v102, s54
    v_perm_b32 v46, v103, v103, s53
    v_perm_b32 v47, v103, v103, s54
    v_perm_b32 v48, v104, v104, s53
    v_perm_b32 v49, v104, v104, s54
    v_perm_b32 v50, v105, v105, s53
    v_perm_b32 v51, v105, v105, s54
    v_perm_b32 v52, v106, v106, s53
    v_perm_b32 v53, v106, v106, s54
    v_perm_b32 v54, v107, v107, s53
    v_perm_b32 v55, v107, v107, s54
    v_perm_b32 v56, v108, v108, s53
    v_perm_b32 v57, v108, v108, s54
    v_perm_b32 v58, v109, v109, s53
    v_perm_b32 v59, v109, v109, s54
    v_perm_b32 v60, v110, v110, s53
    v_perm_b32 v61, v110, v110, s54
    v_perm_b32 v62, v111, v111, s53
    v_perm_b32 v63, v111, v111, s54
    buffer_load_dwordx4 v[144:147], v5, s[16:19], s50 offen offset:0 sc1
    buffer_load_dwordx4 v[148:151], v5, s[16:19], s50 offen offset:1024 sc1
    buffer_load_dwordx4 v[152:155], v5, s[16:19], s50 offen offset:2048 sc1
    buffer_load_dwordx4 v[156:159], v5, s[16:19], s50 offen offset:3072 sc1
    s_add_u32 s50, s50, 4096
    buffer_load_dwordx4 v[160:163], v5, s[16:19], s50 offen offset:0 sc1
    buffer_load_dwordx4 v[164:167], v5, s[16:19], s50 offen offset:1024 sc1
    buffer_load_dwordx4 v[168:171], v5, s[16:19], s50 offen offset:2048 sc1
    s_waitcnt vmcnt(14) lgkmcnt(8)
    v_mfma_f32_32x32x16_bf16 v[32:47], v[64:67], v[112:115], v[32:47]
    ds_read_b64_tr_b16 v[88:89], v12 offset:6144
    ds_read_b64_tr_b16 v[90:91], v12 offset:7168
    buffer_load_dwordx4 v[172:175], v5, s[16:19], s50 offen offset:3072 sc1
    s_add_u32 s50, s50, 4096
    v_perm_b32 v176, v96, v96, s59
    v_mfma_f32_32x32x16_bf16 v[48:63], v[68:71], v[112:115], v[48:63]
    ds_read_b64_tr_b16 v[92:93], v13 offset:6208
    ds_read_b64_tr_b16 v[94:95], v13 offset:7232
    v_perm_b32 v177, v96, v96, s97
    s_waitcnt vmcnt(14) lgkmcnt(8)
    v_mfma_f32_32x32x16_bf16 v[32:47], v[72:75], v[116:119], v[32:47]
    ds_read_b64_tr_b16 v[64:65], v12 offset:8192
    ds_read_b64_tr_b16 v[66:67], v12 offset:9216
    buffer_load_dwordx4 v[112:115], v5, s[16:19], s50 offen offset:0 sc1
    v_perm_b32 v178, v97, v97, s59
    v_mfma_f32_32x32x16_bf16 v[48:63], v[76:79], v[116:119], v[48:63]
    ds_read_b64_tr_b16 v[68:69], v13 offset:8256
    ds_read_b64_tr_b16 v[70:71], v13 offset:9280
    v_perm_b32 v179, v97, v97, s97
    s_waitcnt vmcnt(14) lgkmcnt(8)
    v_mfma_f32_32x32x16_bf16 v[32:47], v[80:83], v[120:123], v[32:47]
    ds_read_b64_tr_b16 v[72:73], v12 offset:10240
    ds_read_b64_tr_b16 v[74:75], v12 offset:11264
    buffer_load_dwordx4 v[116:119], v5, s[16:19], s50 offen offset:1024 sc1
    v_perm_b32 v180, v98, v98, s59
    v_mfma_f32_32x32x16_bf16 v[48:63], v[84:87], v[120:123], v[48:63]
    ds_read_b64_tr_b16 v[76:77], v13 offset:10304
    ds_read_b64_tr_b16 v[78:79], v13 offset:11328
    v_perm_b32 v181, v98, v98, s97
    s_waitcnt vmcnt(14) lgkmcnt(8)
    v_mfma_f32_32x32x16_bf16 v[32:47], v[88:91], v[124:127], v[32:47]
    ds_read_b64_tr_b16 v[80:81], v12 offset:12288
    ds_read_b64_tr_b16 v[82:83], v12 offset:13312
    buffer_load_dwordx4 v[120:123], v5, s[16:19], s50 offen offset:2048 sc1
    v_perm_b32 v182, v99, v99, s59
    v_mfma_f32_32x32x16_bf16 v[48:63], v[92:95], v[124:127], v[48:63]
    ds_read_b64_tr_b16 v[84:85], v13 offset:12352
    ds_read_b64_tr_b16 v[86:87], v13 offset:13376
    v_perm_b32 v183, v99, v99, s97
    s_waitcnt vmcnt(14) lgkmcnt(8)
    v_mfma_f32_32x32x16_bf16 v[32:47], v[64:67], v[128:131], v[32:47]
    ds_read_b64_tr_b16 v[88:89], v12 offset:14336
    ds_read_b64_tr_b16 v[90:91], v12 offset:15360
    buffer_load_dwordx4 v[124:127], v5, s[16:19], s50 offen offset:3072 sc1
    s_add_u32 s50, s50, 4096
    v_perm_b32 v184, v100, v100, s59
    v_mfma_f32_32x32x16_bf16 v[48:63], v[68:71], v[128:131], v[48:63]
    ds_read_b64_tr_b16 v[92:93], v13 offset:14400
    ds_read_b64_tr_b16 v[94:95], v13 offset:15424
    v_perm_b32 v185, v100, v100, s97
    s_waitcnt vmcnt(14) lgkmcnt(8)
    v_mfma_f32_32x32x16_bf16 v[32:47], v[72:75], v[132:135], v[32:47]
    ds_read_b64_tr_b16 v[64:65], v12 offset:16384
    ds_read_b64_tr_b16 v[66:67], v12 offset:17408
    buffer_load_dwordx4 v[128:131], v5, s[16:19], s50 offen offset:0 sc1
    v_perm_b32 v186, v101, v101, s59
    v_mfma_f32_32x32x16_bf16 v[48:63], v[76:79], v[132:135], v[48:63]
    ds_read_b64_tr_b16 v[68:69], v13 offset:16448
    ds_read_b64_tr_b16 v[70:71], v13 offset:17472
    v_perm_b32 v187, v101, v101, s97
    s_waitcnt vmcnt(14) lgkmcnt(8)
    v_mfma_f32_32x32x16_bf16 v[32:47], v[80:83], v[136:139], v[32:47]
    ds_read_b64_tr_b16 v[72:73], v12 offset:18432
    ds_read_b64_tr_b16 v[74:75], v12 offset:19456
    buffer_load_dwordx4 v[132:135], v5, s[16:19], s50 offen offset:1024 sc1
    v_perm_b32 v188, v102, v102, s59
    v_mfma_f32_32x32x16_bf16 v[48:63], v[84:87], v[136:139], v[48:63]
    ds_read_b64_tr_b16 v[76:77], v13 offset:18496
    ds_read_b64_tr_b16 v[78:79], v13 offset:19520
    v_perm_b32 v189, v102, v102, s97
    s_waitcnt vmcnt(14) lgkmcnt(8)
    v_mfma_f32_32x32x16_bf16 v[32:47], v[88:91], v[140:143], v[32:47]
    ds_read_b64_tr_b16 v[80:81], v12 offset:20480
    ds_read_b64_tr_b16 v[82:83], v12 offset:21504
    buffer_load_dwordx4 v[136:139], v5, s[16:19], s50 offen offset:2048 sc1
    v_perm_b32 v190, v103, v103, s59
    v_mfma_f32_32x32x16_bf16 v[48:63], v[92:95], v[140:143], v[48:63]
    ds_read_b64_tr_b16 v[84:85], v13 offset:20544
    ds_read_b64_tr_b16 v[86:87], v13 offset:21568
    v_perm_b32 v191, v103, v103, s97
    s_waitcnt vmcnt(14) lgkmcnt(8)
    v_mfma_f32_32x32x16_bf16 v[32:47], v[64:67], v[144:147], v[32:47]
    ds_read_b64_tr_b16 v[88:89], v12 offset:22528
    ds_read_b64_tr_b16 v[90:91], v12 offset:23552
    buffer_load_dwordx4 v[140:143], v5, s[16:19], s50 offen offset:3072 sc1
    s_add_u32 s50, s50, 4096
    v_perm_b32 v192, v104, v104, s59
    v_mfma_f32_32x32x16_bf16 v[48:63], v[68:71], v[144:147], v[48:63]
    ds_read_b64_tr_b16 v[92:93], v13 offset:22592
    ds_read_b64_tr_b16 v[94:95], v13 offset:23616
    v_perm_b32 v193, v104, v104, s97
    s_waitcnt vmcnt(14) lgkmcnt(8)
    v_mfma_f32_32x32x16_bf16 v[32:47], v[72:75], v[148:151], v[32:47]
    ds_read_b64_tr_b16 v[64:65], v12 offset:24576
    ds_read_b64_tr_b16 v[66:67], v12 offset:25600
    buffer_load_dwordx4 v[144:147], v5, s[16:19], s50 offen offset:0 sc1
    v_perm_b32 v194, v105, v105, s59
    v_mfma_f32_32x32x16_bf16 v[48:63], v[76:79], v[148:151], v[48:63]
    ds_read_b64_tr_b16 v[68:69], v13 offset:24640
    ds_read_b64_tr_b16 v[70:71], v13 offset:25664
    v_perm_b32 v195, v105, v105, s97
    s_waitcnt vmcnt(14) lgkmcnt(8)
    v_mfma_f32_32x32x16_bf16 v[32:47], v[80:83], v[152:155], v[32:47]
    ds_read_b64_tr_b16 v[72:73], v12 offset:26624
    ds_read_b64_tr_b16 v[74:75], v12 offset:27648
    buffer_load_dwordx4 v[148:151], v5, s[16:19], s50 offen offset:1024 sc1
    v_perm_b32 v196, v106, v106, s59
    v_mfma_f32_32x32x16_bf16 v[48:63], v[84:87], v[152:155], v[48:63]
    ds_read_b64_tr_b16 v[76:77], v13 offset:26688
    ds_read_b64_tr_b16 v[78:79], v13 offset:27712
    v_perm_b32 v197, v106, v106, s97
    s_waitcnt vmcnt(14) lgkmcnt(8)
    v_mfma_f32_32x32x16_bf16 v[32:47], v[88:91], v[156:159], v[32:47]
    ds_read_b64_tr_b16 v[80:81], v12 offset:28672
    ds_read_b64_tr_b16 v[82:83], v12 offset:29696
    buffer_load_dwordx4 v[152:155], v5, s[16:19], s50 offen offset:2048 sc1
    v_perm_b32 v198, v107, v107, s59
    v_mfma_f32_32x32x16_bf16 v[48:63], v[92:95], v[156:159], v[48:63]
    ds_read_b64_tr_b16 v[84:85], v13 offset:28736
    ds_read_b64_tr_b16 v[86:87], v13 offset:29760
    v_perm_b32 v199, v107, v107, s97
    s_waitcnt vmcnt(14) lgkmcnt(8)
    v_mfma_f32_32x32x16_bf16 v[32:47], v[64:67], v[160:163], v[32:47]
    ds_read_b64_tr_b16 v[88:89], v12 offset:30720
    ds_read_b64_tr_b16 v[90:91], v12 offset:31744
    buffer_load_dwordx4 v[156:159], v5, s[16:19], s50 offen offset:3072 sc1
    s_add_u32 s50, s50, 4096
    v_perm_b32 v200, v108, v108, s59
    v_mfma_f32_32x32x16_bf16 v[48:63], v[68:71], v[160:163], v[48:63]
    ds_read_b64_tr_b16 v[92:93], v13 offset:30784
    ds_read_b64_tr_b16 v[94:95], v13 offset:31808
    v_perm_b32 v201, v108, v108, s97
    s_waitcnt vmcnt(14) lgkmcnt(8)
    v_mfma_f32_32x32x16_bf16 v[32:47], v[72:75], v[164:167], v[32:47]
    ds_read_b64_tr_b16 v[64:65], v12 offset:32768
    ds_read_b64_tr_b16 v[66:67], v12 offset:33792
    buffer_load_dwordx4 v[160:163], v5, s[16:19], s50 offen offset:0 sc1
    v_perm_b32 v202, v109, v109, s59
    v_mfma_f32_32x32x16_bf16 v[48:63], v[76:79], v[164:167], v[48:63]
    ds_read_b64_tr_b16 v[68:69], v13 offset:32832
    ds_read_b64_tr_b16 v[70:71], v13 offset:33856
    v_perm_b32 v203, v109, v109, s97
    s_waitcnt vmcnt(14) lgkmcnt(8)
    v_mfma_f32_32x32x16_bf16 v[32:47], v[80:83], v[168:171], v[32:47]
    ds_read_b64_tr_b16 v[72:73], v12 offset:34816
    ds_read_b64_tr_b16 v[74:75], v12 offset:35840
    buffer_load_dwordx4 v[164:167], v5, s[16:19], s50 offen offset:1024 sc1
    v_perm_b32 v204, v110, v110, s59
    v_mfma_f32_32x32x16_bf16 v[48:63], v[84:87], v[168:171], v[48:63]
    ds_read_b64_tr_b16 v[76:77], v13 offset:34880
    ds_read_b64_tr_b16 v[78:79], v13 offset:35904
    v_perm_b32 v205, v110, v110, s97
    s_waitcnt vmcnt(14) lgkmcnt(8)
    v_mfma_f32_32x32x16_bf16 v[32:47], v[88:91], v[172:175], v[32:47]
    ds_read_b64_tr_b16 v[80:81], v12 offset:36864
    ds_read_b64_tr_b16 v[82:83], v12 offset:37888
    buffer_load_dwordx4 v[168:171], v5, s[16:19], s50 offen offset:2048 sc1
    v_perm_b32 v206, v111, v111, s59
    v_mfma_f32_32x32x16_bf16 v[48:63], v[92:95], v[172:175], v[48:63]
    ds_read_b64_tr_b16 v[84:85], v13 offset:36928
    ds_read_b64_tr_b16 v[86:87], v13 offset:37952
    v_perm_b32 v207, v111, v111, s97
    s_waitcnt vmcnt(14) lgkmcnt(8)
    v_mfma_f32_32x32x16_bf16 v[32:47], v[64:67], v[112:115], v[32:47]
    ds_read_b64_tr_b16 v[88:89], v12 offset:38912
    ds_read_b64_tr_b16 v[90:91], v12 offset:39936
    buffer_load_dwordx4 v[172:175], v5, s[16:19], s50 offen offset:3072 sc1
    s_add_u32 s50, s50, 4096
    v_mfma_f32_32x32x16_bf16 v[48:63], v[68:71], v[112:115], v[48:63]
    ds_read_b64_tr_b16 v[92:93], v13 offset:38976
    ds_read_b64_tr_b16 v[94:95], v13 offset:40000
    s_waitcnt vmcnt(14) lgkmcnt(8)
    v_mfma_f32_32x32x16_bf16 v[32:47], v[72:75], v[116:119], v[32:47]
    ds_read_b64_tr_b16 v[64:65], v12 offset:40960
    ds_read_b64_tr_b16 v[66:67], v12 offset:41984
    s_branch wp_6_t
wp_6:
    ds_read_b32 v29, v28
    s_waitcnt lgkmcnt(0)
    v_readfirstlane_b32 s60, v29
    s_lshr_b32 s51, s60, 2
    s_and_b32 s51, s51, s60
    s_and_b32 s51, s51, 3
wp_6_t:
    s_cmp_eq_u32 s51, 3
    s_cbranch_scc0 wp_6
    s_lshl_b32 s50, s52, 15
    s_xor_b32 s50, s50, 32768
    buffer_load_dwordx4 v[112:115], v5, s[16:19], s50 offen offset:0 sc1
    v_mfma_f32_32x32x16_bf16 v[48:63], v[76:79], v[116:119], v[48:63]
    ds_read_b64_tr_b16 v[68:69], v13 offset:41024
    ds_read_b64_tr_b16 v[70:71], v13 offset:42048
    s_waitcnt vmcnt(14) lgkmcnt(8)
    v_mfma_f32_32x32x16_bf16 v[32:47], v[80:83], v[120:123], v[32:47]
    ds_read_b64_tr_b16 v[72:73], v12 offset:43008
    ds_read_b64_tr_b16 v[74:75], v12 offset:44032
    buffer_load_dwordx4 v[116:119], v5, s[16:19], s50 offen offset:1024 sc1
    v_mfma_f32_32x32x16_bf16 v[48:63], v[84:87], v[120:123], v[48:63]
    ds_read_b64_tr_b16 v[76:77], v13 offset:43072
    ds_read_b64_tr_b16 v[78:79], v13 offset:44096
    s_waitcnt vmcnt(14) lgkmcnt(8)
    v_mfma_f32_32x32x16_bf16 v[32:47], v[88:91], v[124:127], v[32:47]
    ds_read_b64_tr_b16 v[80:81], v12 offset:45056
    ds_read_b64_tr_b16 v[82:83], v12 offset:46080
    buffer_load_dwordx4 v[120:123], v5, s[16:19], s50 offen offset:2048 sc1
    v_mfma_f32_32x32x16_bf16 v[48:63], v[92:95], v[124:127], v[48:63]
    ds_read_b64_tr_b16 v[84:85], v13 offset:45120
    ds_read_b64_tr_b16 v[86:87], v13 offset:46144
    s_waitcnt vmcnt(14) lgkmcnt(8)
    v_mfma_f32_32x32x16_bf16 v[32:47], v[64:67], v[128:131], v[32:47]
    ds_read_b64_tr_b16 v[88:89], v12 offset:47104
    ds_read_b64_tr_b16 v[90:91], v12 offset:48128
    buffer_load_dwordx4 v[124:127], v5, s[16:19], s50 offen offset:3072 sc1
    s_add_u32 s50, s50, 4096
    v_mfma_f32_32x32x16_bf16 v[48:63], v[68:71], v[128:131], v[48:63]
    ds_read_b64_tr_b16 v[92:93], v13 offset:47168
    ds_read_b64_tr_b16 v[94:95], v13 offset:48192
    s_waitcnt vmcnt(14) lgkmcnt(8)
    v_mfma_f32_32x32x16_bf16 v[32:47], v[72:75], v[132:135], v[32:47]
    ds_read_b64_tr_b16 v[64:65], v12 offset:49152
    ds_read_b64_tr_b16 v[66:67], v12 offset:50176
    buffer_load_dwordx4 v[128:131], v5, s[16:19], s50 offen offset:0 sc1
    v_mfma_f32_32x32x16_bf16 v[48:63], v[76:79], v[132:135], v[48:63]
    ds_read_b64_tr_b16 v[68:69], v13 offset:49216
    ds_read_b64_tr_b16 v[70:71], v13 offset:50240
    s_waitcnt vmcnt(14) lgkmcnt(8)
    v_mfma_f32_32x32x16_bf16 v[32:47], v[80:83], v[136:139], v[32:47]
    ds_read_b64_tr_b16 v[72:73], v12 offset:51200
    ds_read_b64_tr_b16 v[74:75], v12 offset:52224
    buffer_load_dwordx4 v[132:135], v5, s[16:19], s50 offen offset:1024 sc1
    v_mfma_f32_32x32x16_bf16 v[48:63], v[84:87], v[136:139], v[48:63]
    ds_read_b64_tr_b16 v[76:77], v13 offset:51264
    ds_read_b64_tr_b16 v[78:79], v13 offset:52288
    s_waitcnt vmcnt(14) lgkmcnt(8)
    v_mfma_f32_32x32x16_bf16 v[32:47], v[88:91], v[140:143], v[32:47]
    ds_read_b64_tr_b16 v[80:81], v12 offset:53248
    ds_read_b64_tr_b16 v[82:83], v12 offset:54272
    buffer_load_dwordx4 v[136:139], v5, s[16:19], s50 offen offset:2048 sc1
    v_mfma_f32_32x32x16_bf16 v[48:63], v[92:95], v[140:143], v[48:63]
    ds_read_b64_tr_b16 v[84:85], v13 offset:53312
    ds_read_b64_tr_b16 v[86:87], v13 offset:54336
    s_waitcnt vmcnt(14) lgkmcnt(8)
    v_mfma_f32_32x32x16_bf16 v[32:47], v[64:67], v[144:147], v[32:47]
    ds_read_b64_tr_b16 v[88:89], v12 offset:55296
    ds_read_b64_tr_b16 v[90:91], v12 offset:56320
    buffer_load_dwordx4 v[140:143], v5, s[16:19], s50 offen offset:3072 sc1
    s_add_u32 s50, s50, 4096
    v_mfma_f32_32x32x16_bf16 v[48:63], v[68:71], v[144:147], v[48:63]
    ds_read_b64_tr_b16 v[92:93], v13 offset:55360
    ds_read_b64_tr_b16 v[94:95], v13 offset:56384
    s_waitcnt vmcnt(14) lgkmcnt(8)
    v_mfma_f32_32x32x16_bf16 v[32:47], v[72:75], v[148:151], v[32:47]
    ds_read_b64_tr_b16 v[64:65], v12 offset:57344
    ds_read_b64_tr_b16 v[66:67], v12 offset:58368
    buffer_load_dwordx4 v[144:147], v5, s[16:19], s50 offen offset:0 sc1
    v_mfma_f32_32x32x16_bf16 v[48:63], v[76:79], v[148:151], v[48:63]
    ds_read_b64_tr_b16 v[68:69], v13 offset:57408
    ds_read_b64_tr_b16 v[70:71], v13 offset:58432
    s_waitcnt vmcnt(14) lgkmcnt(8)
    v_mfma_f32_32x32x16_bf16 v[32:47], v[80:83], v[152:155], v[32:47]
    ds_read_b64_tr_b16 v[72:73], v12 offset:59392
    ds_read_b64_tr_b16 v[74:75], v12 offset:60416
    buffer_load_dwordx4 v[148:151], v5, s[16:19], s50 offen offset:1024 sc1
    v_mfma_f32_32x32x16_bf16 v[48:63], v[84:87], v[152:155], v[48:63]
    ds_read_b64_tr_b16 v[76:77], v13 offset:59456
    ds_read_b64_tr_b16 v[78:79], v13 offset:60480
    s_waitcnt vmcnt(14) lgkmcnt(8)
    v_mfma_f32_32x32x16_bf16 v[32:47], v[88:91], v[156:159], v[32:47]
    ds_read_b64_tr_b16 v[80:81], v12 offset:61440
    ds_read_b64_tr_b16 v[82:83], v12 offset:62464
    buffer_load_dwordx4 v[152:155], v5, s[16:19], s50 offen offset:2048 sc1
    v_mfma_f32_32x32x16_bf16 v[48:63], v[92:95], v[156:159], v[48:63]
    ds_read_b64_tr_b16 v[84:85], v13 offset:61504
    ds_read_b64_tr_b16 v[86:87], v13 offset:62528
    s_waitcnt vmcnt(14) lgkmcnt(8)
    v_mfma_f32_32x32x16_bf16 v[32:47], v[64:67], v[160:163], v[32:47]
    ds_read_b64_tr_b16 v[88:89], v12 offset:63488
    ds_read_b64_tr_b16 v[90:91], v12 offset:64512
    buffer_load_dwordx4 v[156:159], v5, s[16:19], s50 offen offset:3072 sc1
    s_add_u32 s50, s50, 4096
    v_mfma_f32_32x32x16_bf16 v[48:63], v[68:71], v[160:163], v[48:63]
    ds_read_b64_tr_b16 v[92:93], v13 offset:63552
    ds_read_b64_tr_b16 v[94:95], v13 offset:64576
    s_waitcnt vmcnt(14) lgkmcnt(8)
    v_mfma_f32_32x32x16_bf16 v[32:47], v[72:75], v[164:167], v[32:47]
    ds_read_b64_tr_b16 v[64:65], v14 offset:0
    ds_read_b64_tr_b16 v[66:67], v14 offset:1024
    buffer_load_dwordx4 v[160:163], v5, s[16:19], s50 offen offset:0 sc1
    v_mfma_f32_32x32x16_bf16 v[48:63], v[76:79], v[164:167], v[48:63]
    ds_read_b64_tr_b16 v[68:69], v15 offset:64
    ds_read_b64_tr_b16 v[70:71], v15 offset:1088
    s_waitcnt vmcnt(14) lgkmcnt(8)
    v_mfma_f32_32x32x16_bf16 v[32:47], v[80:83], v[168:171], v[32:47]
    ds_read_b64_tr_b16 v[72:73], v14 offset:2048
    ds_read_b64_tr_b16 v[74:75], v14 offset:3072
    buffer_load_dwordx4 v[164:167], v5, s[16:19], s50 offen offset:1024 sc1
    v_mfma_f32_32x32x16_bf16 v[48:63], v[84:87], v[168:171], v[48:63]
    ds_read_b64_tr_b16 v[76:77], v15 offset:2112
    ds_read_b64_tr_b16 v[78:79], v15 offset:3136
    s_waitcnt vmcnt(14) lgkmcnt(8)
    v_mfma_f32_32x32x16_bf16 v[32:47], v[88:91], v[172:175], v[32:47]
    ds_read_b64_tr_b16 v[80:81], v14 offset:4096
    ds_read_b64_tr_b16 v[82:83], v14 offset:5120
    buffer_load_dwordx4 v[168:171], v5, s[16:19], s50 offen offset:2048 sc1
    v_mfma_f32_32x32x16_bf16 v[48:63], v[92:95], v[172:175], v[48:63]
    ds_read_b64_tr_b16 v[84:85], v15 offset:4160
    ds_read_b64_tr_b16 v[86:87], v15 offset:5184
    s_waitcnt vmcnt(14) lgkmcnt(8)
    v_mfma_f32_32x32x16_bf16 v[176:191], v[64:67], v[112:115], v[176:191]
    ds_read_b64_tr_b16 v[88:89], v14 offset:6144
    ds_read_b64_tr_b16 v[90:91], v14 offset:7168
    buffer_load_dwordx4 v[172:175], v5, s[16:19], s50 offen offset:3072 sc1
    s_add_u32 s50, s50, 4096
    v_mfma_f32_32x32x16_bf16 v[192:207], v[68:71], v[112:115], v[192:207]
    ds_read_b64_tr_b16 v[92:93], v15 offset:6208
    ds_read_b64_tr_b16 v[94:95], v15 offset:7232
    s_waitcnt vmcnt(14) lgkmcnt(8)
    v_mfma_f32_32x32x16_bf16 v[176:191], v[72:75], v[116:119], v[176:191]
    ds_read_b64_tr_b16 v[64:65], v14 offset:8192
    ds_read_b64_tr_b16 v[66:67], v14 offset:9216
    buffer_load_dwordx4 v[112:115], v5, s[16:19], s50 offen offset:0 sc1
    v_mfma_f32_32x32x16_bf16 v[192:207], v[76:79], v[116:119], v[192:207]
    ds_read_b64_tr_b16 v[68:69], v15 offset:8256
    ds_read_b64_tr_b16 v[70:71], v15 offset:9280
    s_waitcnt vmcnt(14) lgkmcnt(8)
    v_mfma_f32_32x32x16_bf16 v[176:191], v[80:83], v[120:123], v[176:191]
    ds_read_b64_tr_b16 v[72:73], v14 offset:10240
    ds_read_b64_tr_b16 v[74:75], v14 offset:11264
    buffer_load_dwordx4 v[116:119], v5, s[16:19], s50 offen offset:1024 sc1
    v_mfma_f32_32x32x16_bf16 v[192:207], v[84:87], v[120:123], v[192:207]
    ds_read_b64_tr_b16 v[76:77], v15 offset:10304
    ds_read_b64_tr_b16 v[78:79], v15 offset:11328
    s_waitcnt vmcnt(14) lgkmcnt(8)
    v_mfma_f32_32x32x16_bf16 v[176:191], v[88:91], v[124:127], v[176:191]
    ds_read_b64_tr_b16 v[80:81], v14 offset:12288
    ds_read_b64_tr_b16 v[82:83], v14 offset:13312
    buffer_load_dwordx4 v[120:123], v5, s[16:19], s50 offen offset:2048 sc1
    v_mfma_f32_32x32x16_bf16 v[192:207], v[92:95], v[124:127], v[192:207]
    ds_read_b64_tr_b16 v[84:85], v15 offset:12352
    ds_read_b64_tr_b16 v[86:87], v15 offset:13376
    s_waitcnt vmcnt(14) lgkmcnt(8)
    v_mfma_f32_32x32x16_bf16 v[176:191], v[64:67], v[128:131], v[176:191]
    ds_read_b64_tr_b16 v[88:89], v14 offset:14336
    ds_read_b64_tr_b16 v[90:91], v14 offset:15360
    buffer_load_dwordx4 v[124:127], v5, s[16:19], s50 offen offset:3072 sc1
    s_add_u32 s50, s50, 4096
    v_mfma_f32_32x32x16_bf16 v[192:207], v[68:71], v[128:131], v[192:207]
    ds_read_b64_tr_b16 v[92:93], v15 offset:14400
    ds_read_b64_tr_b16 v[94:95], v15 offset:15424
    s_waitcnt vmcnt(14) lgkmcnt(8)
    v_mfma_f32_32x32x16_bf16 v[176:191], v[72:75], v[132:135], v[176:191]
    ds_read_b64_tr_b16 v[64:65], v14 offset:16384
    ds_read_b64_tr_b16 v[66:67], v14 offset:17408
    buffer_load_dwordx4 v[128:131], v5, s[16:19], s50 offen offset:0 sc1
    v_mfma_f32_32x32x16_bf16 v[192:207], v[76:79], v[132:135], v[192:207]
    ds_read_b64_tr_b16 v[68:69], v15 offset:16448
    ds_read_b64_tr_b16 v[70:71], v15 offset:17472
    s_waitcnt vmcnt(14) lgkmcnt(8)
    v_mfma_f32_32x32x16_bf16 v[176:191], v[80:83], v[136:139], v[176:191]
    ds_read_b64_tr_b16 v[72:73], v14 offset:18432
    ds_read_b64_tr_b16 v[74:75], v14 offset:19456
    buffer_load_dwordx4 v[132:135], v5, s[16:19], s50 offen offset:1024 sc1
    v_mfma_f32_32x32x16_bf16 v[192:207], v[84:87], v[136:139], v[192:207]
    ds_read_b64_tr_b16 v[76:77], v15 offset:18496
    ds_read_b64_tr_b16 v[78:79], v15 offset:19520
    s_waitcnt vmcnt(14) lgkmcnt(8)
    v_mfma_f32_32x32x16_bf16 v[176:191], v[88:91], v[140:143], v[176:191]
    ds_read_b64_tr_b16 v[80:81], v14 offset:20480
    ds_read_b64_tr_b16 v[82:83], v14 offset:21504
    buffer_load_dwordx4 v[136:139], v5, s[16:19], s50 offen offset:2048 sc1
    v_mfma_f32_32x32x16_bf16 v[192:207], v[92:95], v[140:143], v[192:207]
    ds_read_b64_tr_b16 v[84:85], v15 offset:20544
    ds_read_b64_tr_b16 v[86:87], v15 offset:21568
    s_waitcnt vmcnt(14) lgkmcnt(8)
    v_mfma_f32_32x32x16_bf16 v[176:191], v[64:67], v[144:147], v[176:191]
    ds_read_b64_tr_b16 v[88:89], v14 offset:22528
    ds_read_b64_tr_b16 v[90:91], v14 offset:23552
    buffer_load_dwordx4 v[140:143], v5, s[16:19], s50 offen offset:3072 sc1
    s_add_u32 s50, s50, 4096
    v_mfma_f32_32x32x16_bf16 v[192:207], v[68:71], v[144:147], v[192:207]
    ds_read_b64_tr_b16 v[92:93], v15 offset:22592
    ds_read_b64_tr_b16 v[94:95], v15 offset:23616
    s_waitcnt vmcnt(14) lgkmcnt(8)
    v_mfma_f32_32x32x16_bf16 v[176:191], v[72:75], v[148:151], v[176:191]
    ds_read_b64_tr_b16 v[64:65], v14 offset:24576
    ds_read_b64_tr_b16 v[66:67], v14 offset:25600
    buffer_load_dwordx4 v[144:147], v5, s[16:19], s50 offen offset:0 sc1
    v_mfma_f32_32x32x16_bf16 v[192:207], v[76:79], v[148:151], v[192:207]
    ds_read_b64_tr_b16 v[68:69], v15 offset:24640
    ds_read_b64_tr_b16 v[70:71], v15 offset:25664
    s_waitcnt vmcnt(14) lgkmcnt(8)
    v_mfma_f32_32x32x16_bf16 v[176:191], v[80:83], v[152:155], v[176:191]
    ds_read_b64_tr_b16 v[72:73], v14 offset:26624
    ds_read_b64_tr_b16 v[74:75], v14 offset:27648
    buffer_load_dwordx4 v[148:151], v5, s[16:19], s50 offen offset:1024 sc1
    v_mfma_f32_32x32x16_bf16 v[192:207], v[84:87], v[152:155], v[192:207]
    ds_read_b64_tr_b16 v[76:77], v15 offset:26688
    ds_read_b64_tr_b16 v[78:79], v15 offset:27712
    s_waitcnt vmcnt(14) lgkmcnt(8)
    v_mfma_f32_32x32x16_bf16 v[176:191], v[88:91], v[156:159], v[176:191]
    ds_read_b64_tr_b16 v[80:81], v14 offset:28672
    ds_read_b64_tr_b16 v[82:83], v14 offset:29696
    buffer_load_dwordx4 v[152:155], v5, s[16:19], s50 offen offset:2048 sc1
    v_mfma_f32_32x32x16_bf16 v[192:207], v[92:95], v[156:159], v[192:207]
    ds_read_b64_tr_b16 v[84:85], v15 offset:28736
    ds_read_b64_tr_b16 v[86:87], v15 offset:29760
    s_waitcnt vmcnt(14) lgkmcnt(8)
    v_mfma_f32_32x32x16_bf16 v[176:191], v[64:67], v[160:163], v[176:191]
    ds_read_b64_tr_b16 v[88:89], v14 offset:30720
    ds_read_b64_tr_b16 v[90:91], v14 offset:31744
    buffer_load_dwordx4 v[156:159], v5, s[16:19], s50 offen offset:3072 sc1
    s_add_u32 s50, s50, 4096
    v_mfma_f32_32x32x16_bf16 v[192:207], v[68:71], v[160:163], v[192:207]
    ds_read_b64_tr_b16 v[92:93], v15 offset:30784
    ds_read_b64_tr_b16 v[94:95], v15 offset:31808
    s_waitcnt vmcnt(14) lgkmcnt(8)
    v_mfma_f32_32x32x16_bf16 v[176:191], v[72:75], v[164:167], v[176:191]
    ds_read_b64_tr_b16 v[64:65], v14 offset:32768
    ds_read_b64_tr_b16 v[66:67], v14 offset:33792
    buffer_load_dwordx4 v[160:163], v5, s[16:19], s50 offen offset:0 sc1
    v_mfma_f32_32x32x16_bf16 v[192:207], v[76:79], v[164:167], v[192:207]
    ds_read_b64_tr_b16 v[68:69], v15 offset:32832
    ds_read_b64_tr_b16 v[70:71], v15 offset:33856
    s_waitcnt vmcnt(14) lgkmcnt(8)
    v_mfma_f32_32x32x16_bf16 v[176:191], v[80:83], v[168:171], v[176:191]
    ds_read_b64_tr_b16 v[72:73], v14 offset:34816
    ds_read_b64_tr_b16 v[74:75], v14 offset:35840
    buffer_load_dwordx4 v[164:167], v5, s[16:19], s50 offen offset:1024 sc1
    v_mfma_f32_32x32x16_bf16 v[192:207], v[84:87], v[168:171], v[192:207]
    ds_read_b64_tr_b16 v[76:77], v15 offset:34880
    ds_read_b64_tr_b16 v[78:79], v15 offset:35904
    s_waitcnt vmcnt(14) lgkmcnt(8)
    v_mfma_f32_32x32x16_bf16 v[176:191], v[88:91], v[172:175], v[176:191]
    ds_read_b64_tr_b16 v[80:81], v14 offset:36864
    ds_read_b64_tr_b16 v[82:83], v14 offset:37888
    buffer_load_dwordx4 v[168:171], v5, s[16:19], s50 offen offset:2048 sc1
    v_mfma_f32_32x32x16_bf16 v[192:207], v[92:95], v[172:175], v[192:207]
    ds_read_b64_tr_b16 v[84:85], v15 offset:36928
    ds_read_b64_tr_b16 v[86:87], v15 offset:37952
    s_waitcnt vmcnt(14) lgkmcnt(8)
    v_mfma_f32_32x32x16_bf16 v[176:191], v[64:67], v[112:115], v[176:191]
    ds_read_b64_tr_b16 v[88:89], v14 offset:38912
    ds_read_b64_tr_b16 v[90:91], v14 offset:39936
    buffer_load_dwordx4 v[172:175], v5, s[16:19], s50 offen offset:3072 sc1
    s_add_u32 s50, s50, 4096
    v_mfma_f32_32x32x16_bf16 v[192:207], v[68:71], v[112:115], v[192:207]
    ds_read_b64_tr_b16 v[92:93], v15 offset:38976
    ds_read_b64_tr_b16 v[94:95], v15 offset:40000
    s_waitcnt vmcnt(14) lgkmcnt(8)
    v_mfma_f32_32x32x16_bf16 v[176:191], v[72:75], v[116:119], v[176:191]
    ds_read_b64_tr_b16 v[64:65], v14 offset:40960
    ds_read_b64_tr_b16 v[66:67], v14 offset:41984
    v_mfma_f32_32x32x16_bf16 v[192:207], v[76:79], v[116:119], v[192:207]
    ds_read_b64_tr_b16 v[68:69], v15 offset:41024
    ds_read_b64_tr_b16 v[70:71], v15 offset:42048
    s_waitcnt vmcnt(13) lgkmcnt(8)
    v_mfma_f32_32x32x16_bf16 v[176:191], v[80:83], v[120:123], v[176:191]
    ds_read_b64_tr_b16 v[72:73], v14 offset:43008
    ds_read_b64_tr_b16 v[74:75], v14 offset:44032
    v_mfma_f32_32x32x16_bf16 v[192:207], v[84:87], v[120:123], v[192:207]
    ds_read_b64_tr_b16 v[76:77], v15 offset:43072
    ds_read_b64_tr_b16 v[78:79], v15 offset:44096
    s_waitcnt vmcnt(12) lgkmcnt(8)
    v_mfma_f32_32x32x16_bf16 v[176:191], v[88:91], v[124:127], v[176:191]
    ds_read_b64_tr_b16 v[80:81], v14 offset:45056
    ds_read_b64_tr_b16 v[82:83], v14 offset:46080
    v_mfma_f32_32x32x16_bf16 v[192:207], v[92:95], v[124:127], v[192:207]
    ds_read_b64_tr_b16 v[84:85], v15 offset:45120
    ds_read_b64_tr_b16 v[86:87], v15 offset:46144
    s_waitcnt vmcnt(11) lgkmcnt(8)
    v_mfma_f32_32x32x16_bf16 v[176:191], v[64:67], v[128:131], v[176:191]
    ds_read_b64_tr_b16 v[88:89], v14 offset:47104
    ds_read_b64_tr_b16 v[90:91], v14 offset:48128
    v_mfma_f32_32x32x16_bf16 v[192:207], v[68:71], v[128:131], v[192:207]
    ds_read_b64_tr_b16 v[92:93], v15 offset:47168
    ds_read_b64_tr_b16 v[94:95], v15 offset:48192
    s_waitcnt vmcnt(10) lgkmcnt(8)
    v_mfma_f32_32x32x16_bf16 v[176:191], v[72:75], v[132:135], v[176:191]
    ds_read_b64_tr_b16 v[64:65], v14 offset:49152
    ds_read_b64_tr_b16 v[66:67], v14 offset:50176
    v_mfma_f32_32x32x16_bf16 v[192:207], v[76:79], v[132:135], v[192:207]
    ds_read_b64_tr_b16 v[68:69], v15 offset:49216
    ds_read_b64_tr_b16 v[70:71], v15 offset:50240
    s_waitcnt vmcnt(9) lgkmcnt(8)
    v_mfma_f32_32x32x16_bf16 v[176:191], v[80:83], v[136:139], v[176:191]
    ds_read_b64_tr_b16 v[72:73], v14 offset:51200
    ds_read_b64_tr_b16 v[74:75], v14 offset:52224
    v_mfma_f32_32x32x16_bf16 v[192:207], v[84:87], v[136:139], v[192:207]
    ds_read_b64_tr_b16 v[76:77], v15 offset:51264
    ds_read_b64_tr_b16 v[78:79], v15 offset:52288
    s_waitcnt vmcnt(8) lgkmcnt(8)
    v_mfma_f32_32x32x16_bf16 v[176:191], v[88:91], v[140:143], v[176:191]
    ds_read_b64_tr_b16 v[80:81], v14 offset:53248
    ds_read_b64_tr_b16 v[82:83], v14 offset:54272
    v_mfma_f32_32x32x16_bf16 v[192:207], v[92:95], v[140:143], v[192:207]
    ds_read_b64_tr_b16 v[84:85], v15 offset:53312
    ds_read_b64_tr_b16 v[86:87], v15 offset:54336
    s_waitcnt vmcnt(7) lgkmcnt(8)
    v_mfma_f32_32x32x16_bf16 v[176:191], v[64:67], v[144:147], v[176:191]
    ds_read_b64_tr_b16 v[88:89], v14 offset:55296
    ds_read_b64_tr_b16 v[90:91], v14 offset:56320
    v_mfma_f32_32x32x16_bf16 v[192:207], v[68:71], v[144:147], v[192:207]
    ds_read_b64_tr_b16 v[92:93], v15 offset:55360
    ds_read_b64_tr_b16 v[94:95], v15 offset:56384
    s_waitcnt vmcnt(6) lgkmcnt(8)
    v_mfma_f32_32x32x16_bf16 v[176:191], v[72:75], v[148:151], v[176:191]
    ds_read_b64_tr_b16 v[64:65], v14 offset:57344
    ds_read_b64_tr_b16 v[66:67], v14 offset:58368
    v_mfma_f32_32x32x16_bf16 v[192:207], v[76:79], v[148:151], v[192:207]
    ds_read_b64_tr_b16 v[68:69], v15 offset:57408
    ds_read_b64_tr_b16 v[70:71], v15 offset:58432
    s_waitcnt vmcnt(5) lgkmcnt(8)
    v_mfma_f32_32x32x16_bf16 v[176:191], v[80:83], v[152:155], v[176:191]
    ds_read_b64_tr_b16 v[72:73], v14 offset:59392
    ds_read_b64_tr_b16 v[74:75], v14 offset:60416
    v_mfma_f32_32x32x16_bf16 v[192:207], v[84:87], v[152:155], v[192:207]
    ds_read_b64_tr_b16 v[76:77], v15 offset:59456
    ds_read_b64_tr_b16 v[78:79], v15 offset:60480
    s_waitcnt vmcnt(4) lgkmcnt(8)
    v_mfma_f32_32x32x16_bf16 v[176:191], v[88:91], v[156:159], v[176:191]
    ds_read_b64_tr_b16 v[80:81], v14 offset:61440
    ds_read_b64_tr_b16 v[82:83], v14 offset:62464
    v_mfma_f32_32x32x16_bf16 v[192:207], v[92:95], v[156:159], v[192:207]
    ds_read_b64_tr_b16 v[84:85], v15 offset:61504
    ds_read_b64_tr_b16 v[86:87], v15 offset:62528
    s_waitcnt vmcnt(3) lgkmcnt(8)
    v_mfma_f32_32x32x16_bf16 v[176:191], v[64:67], v[160:163], v[176:191]
    ds_read_b64_tr_b16 v[88:89], v14 offset:63488
    ds_read_b64_tr_b16 v[90:91], v14 offset:64512
    v_mfma_f32_32x32x16_bf16 v[192:207], v[68:71], v[160:163], v[192:207]
    ds_read_b64_tr_b16 v[92:93], v15 offset:63552
    ds_read_b64_tr_b16 v[94:95], v15 offset:64576
    s_waitcnt vmcnt(2) lgkmcnt(8)
    v_mfma_f32_32x32x16_bf16 v[176:191], v[72:75], v[164:167], v[176:191]
    v_mfma_f32_32x32x16_bf16 v[192:207], v[76:79], v[164:167], v[192:207]
    s_waitcnt vmcnt(1) lgkmcnt(4)
    v_mfma_f32_32x32x16_bf16 v[176:191], v[80:83], v[168:171], v[176:191]
    v_mfma_f32_32x32x16_bf16 v[192:207], v[84:87], v[168:171], v[192:207]
    s_waitcnt vmcnt(0) lgkmcnt(0)
    v_mfma_f32_32x32x16_bf16 v[176:191], v[88:91], v[172:175], v[176:191]
    v_mfma_f32_32x32x16_bf16 v[192:207], v[92:95], v[172:175], v[192:207]
    s_cmp_eq_u32 s9, 3
    s_nop 7
    s_cbranch_scc1 c_wo_fin
    s_add_u32 s58, s58, 4194304
    s_nop 7
    v_pk_add_f32 v[32:33], v[32:33], v[176:177]
    v_pk_add_f32 v[34:35], v[34:35], v[178:179]
    v_pk_add_f32 v[36:37], v[36:37], v[180:181]
    v_pk_add_f32 v[38:39], v[38:39], v[182:183]
    v_cvt_pk_bf16_f32 v96, v32, v33
    v_cvt_pk_bf16_f32 v97, v34, v35
    v_cvt_pk_bf16_f32 v98, v36, v37
    v_cvt_pk_bf16_f32 v99, v38, v39
    buffer_store_dwordx4 v[96:99], v5, s[12:15], s58 offen offset:0 sc1
    v_pk_add_f32 v[40:41], v[40:41], v[184:185]
    v_pk_add_f32 v[42:43], v[42:43], v[186:187]
    v_pk_add_f32 v[44:45], v[44:45], v[188:189]
    v_pk_add_f32 v[46:47], v[46:47], v[190:191]
    v_cvt_pk_bf16_f32 v100, v40, v41
    v_cvt_pk_bf16_f32 v101, v42, v43
    v_cvt_pk_bf16_f32 v102, v44, v45
    v_cvt_pk_bf16_f32 v103, v46, v47
    buffer_store_dwordx4 v[100:103], v5, s[12:15], s58 offen offset:1024 sc1
    v_pk_add_f32 v[48:49], v[48:49], v[192:193]
    v_pk_add_f32 v[50:51], v[50:51], v[194:195]
    v_pk_add_f32 v[52:53], v[52:53], v[196:197]
    v_pk_add_f32 v[54:55], v[54:55], v[198:199]
    v_cvt_pk_bf16_f32 v104, v48, v49
    v_cvt_pk_bf16_f32 v105, v50, v51
    v_cvt_pk_bf16_f32 v106, v52, v53
    v_cvt_pk_bf16_f32 v107, v54, v55
    buffer_store_dwordx4 v[104:107], v5, s[12:15], s58 offen offset:2048 sc1
    v_pk_add_f32 v[56:57], v[56:57], v[200:201]
    v_pk_add_f32 v[58:59], v[58:59], v[202:203]
    v_pk_add_f32 v[60:61], v[60:61], v[204:205]
    v_pk_add_f32 v[62:63], v[62:63], v[206:207]
    v_cvt_pk_bf16_f32 v108, v56, v57
    v_cvt_pk_bf16_f32 v109, v58, v59
    v_cvt_pk_bf16_f32 v110, v60, v61
    v_cvt_pk_bf16_f32 v111, v62, v63
    buffer_store_dwordx4 v[108:111], v5, s[12:15], s58 offen offset:3072 sc1
c_wo_stat:
    s_mov_b32 s55, 0x3f803f80
    v_dot2_f32_bf16 v18, v96, s55, 0
    v_dot2_f32_bf16 v19, v96, v96, 0
    v_dot2_f32_bf16 v20, v97, s55, 0
    v_dot2_f32_bf16 v21, v97, v97, 0
    v_dot2_f32_bf16 v18, v98, s55, v18
    v_dot2_f32_bf16 v19, v98, v98, v19
    v_dot2_f32_bf16 v20, v99, s55, v20
    v_dot2_f32_bf16 v21, v99, v99, v21
    v_dot2_f32_bf16 v18, v100, s55, v18
    v_dot2_f32_bf16 v19, v100, v100, v19
    v_dot2_f32_bf16 v20, v101, s55, v20
    v_dot2_f32_bf16 v21, v101, v101, v21
    v_dot2_f32_bf16 v18, v102, s55, v18
    v_dot2_f32_bf16 v19, v102, v102, v19
    v_dot2_f32_bf16 v20, v103, s55, v20
    v_dot2_f32_bf16 v21, v103, v103, v21
    v_dot2_f32_bf16 v18, v104, s55, v18
    v_dot2_f32_bf16 v19, v104, v104, v19
    v_dot2_f32_bf16 v20, v105, s55, v20
    v_dot2_f32_bf16 v21, v105, v105, v21
    v_dot2_f32_bf16 v18, v106, s55, v18
    v_dot2_f32_bf16 v19, v106, v106, v19
    v_dot2_f32_bf16 v20, v107, s55, v20
    v_dot2_f32_bf16 v21, v107, v107, v21
    v_dot2_f32_bf16 v18, v108, s55, v18
    v_dot2_f32_bf16 v19, v108, v108, v19
    v_dot2_f32_bf16 v20, v109, s55, v20
    v_dot2_f32_bf16 v21, v109, v109, v21
    v_dot2_f32_bf16 v18, v110, s55, v18
    v_dot2_f32_bf16 v19, v110, v110, v19
    v_dot2_f32_bf16 v20, v111, s55, v20
    v_dot2_f32_bf16 v21, v111, v111, v21
    v_lshlrev_b32 v16, 3, v1
    s_lshl_b32 s3, s48, 12
    s_lshl_b32 s55, s7, 8
    s_add_u32 s3, s3, s55
    v_permlane32_swap_b32 v18, v20
    v_permlane32_swap_b32 v19, v21
    s_lshl_b32 s55, s9, 18
    v_pk_add_f32 v[18:19], v[18:19], v[20:21]
    s_add_u32 s3, s3, s55
    s_add_u32 s3, s3, 63176704
    v_permlane32_swap_b32 v18, v20
    v_permlane32_swap_b32 v19, v21
    v_pk_add_f32 v[18:19], v[18:19], v[20:21]
    s_mov_b32 exec_hi, 0
    buffer_store_dwordx2 v[18:19], v16, s[12:15], s3 offen sc1
    s_mov_b64 exec, -1
    s_cmp_lg_u32 s9, -1
    s_cbranch_scc1 c_wo_pub
    s_barrier
    v_mov_b32 v24, 159492
non_7:
    ds_read_b32 v25, v24
    s_waitcnt lgkmcnt(0)
    v_readfirstlane_b32 s10, v25
    s_cmp_eq_u32 s10, 0
    s_cbranch_scc1 non_7
c_wo_pub:
    s_mul_i32 s55, s9, 786432
    s_add_u32 s55, s55, 66060288
    v_and_b32 v24, 63, v0
    s_and_b32 s56, s11, 0xe0
    v_lshrrev_b32 v25, 5, v24
    v_add_u32 v24, s56, v24
    v_and_b32 v24, 255, v24
    v_lshlrev_b32 v24, 10, v24
    v_lshl_add_u32 v24, v25, 8, v24
    s_bfe_u32 s56, s11, 0x20003
    s_and_b32 s57, s11, 7
    s_lshl_b32 s56, s56, 7
    s_lshl_b32 s57, s57, 2
    s_add_u32 s55, s55, s56
    s_add_u32 s55, s55, s57
    s_and_b32 s57, s6, s9
    s_bfe_i32 s57, s57, 0x10000
    v_mov_b32 v25, 159488
    v_mov_b32 v26, 1
    v_mov_b32 v27, s10
    s_mov_b64 exec, 1
    s_waitcnt vmcnt(0)
    ds_add_rtn_u32 v26, v25, v26
    s_waitcnt lgkmcnt(0)
    v_readfirstlane_b32 s56, v26
    s_and_b32 s56, s56, 3
    s_cmp_lg_u32 s56, 3
    s_cbranch_scc1 pub_8
    s_mov_b32 exec_lo, -1
    s_mov_b32 exec_hi, s57
    buffer_store_dword v27, v24, s[12:15], s55 offen sc1
pub_8:
    s_mov_b64 exec, -1
    s_cmp_eq_u32 s9, -1
    s_cbranch_scc1 c_wo_pub3
    s_barrier
c_wo_pub3:
    s_add_u32 s9, s9, 1
    s_bitcmp1_b32 s9, 0
    s_cbranch_scc1 c_qkvB
    s_branch c_qkvA
c_wo_fin:
    s_barrier
    v_pk_add_f32 v[32:33], v[32:33], v[176:177]
    v_pk_add_f32 v[34:35], v[34:35], v[178:179]
    v_pk_add_f32 v[36:37], v[36:37], v[180:181]
    v_pk_add_f32 v[38:39], v[38:39], v[182:183]
    v_pk_add_f32 v[40:41], v[40:41], v[184:185]
    v_pk_add_f32 v[42:43], v[42:43], v[186:187]
    v_pk_add_f32 v[44:45], v[44:45], v[188:189]
    v_pk_add_f32 v[46:47], v[46:47], v[190:191]
    v_pk_add_f32 v[48:49], v[48:49], v[192:193]
    v_pk_add_f32 v[50:51], v[50:51], v[194:195]
    v_pk_add_f32 v[52:53], v[52:53], v[196:197]
    v_pk_add_f32 v[54:55], v[54:55], v[198:199]
    v_pk_add_f32 v[56:57], v[56:57], v[200:201]
    v_pk_add_f32 v[58:59], v[58:59], v[202:203]
    v_pk_add_f32 v[60:61], v[60:61], v[204:205]
    v_pk_add_f32 v[62:63], v[62:63], v[206:207]
    v_cvt_pk_bf16_f32 v96, v32, v33
    v_cvt_pk_bf16_f32 v97, v34, v35
    v_cvt_pk_bf16_f32 v98, v36, v37
    v_cvt_pk_bf16_f32 v99, v38, v39
    v_cvt_pk_bf16_f32 v100, v40, v41
    v_cvt_pk_bf16_f32 v101, v42, v43
    v_cvt_pk_bf16_f32 v102, v44, v45
    v_cvt_pk_bf16_f32 v103, v46, v47
    v_cvt_pk_bf16_f32 v104, v48, v49
    v_cvt_pk_bf16_f32 v105, v50, v51
    v_cvt_pk_bf16_f32 v106, v52, v53
    v_cvt_pk_bf16_f32 v107, v54, v55
    v_cvt_pk_bf16_f32 v108, v56, v57
    v_cvt_pk_bf16_f32 v109, v58, v59
    v_cvt_pk_bf16_f32 v110, v60, v61
    v_cvt_pk_bf16_f32 v111, v62, v63
    s_mov_b32 s28, s44
    s_mov_b32 s29, s45
    s_mov_b32 s30, 4194304
    s_mov_b32 s31, 0x00020000
    v_and_b32 v16, 31, v1
    v_mul_u32_u24 v16, 144, v16
    v_lshl_add_u32 v16, v3, 3, v16
    v_mul_u32_u24 v17, 4608, v2
    v_add_u32 v16, v16, v17
    ds_write_b64 v16, v[96:97] offset:0
    ds_write_b64 v16, v[98:99] offset:16
    ds_write_b64 v16, v[100:101] offset:32
    ds_write_b64 v16, v[102:103] offset:48
    ds_write_b64 v16, v[104:105] offset:64
    ds_write_b64 v16, v[106:107] offset:80
    ds_write_b64 v16, v[108:109] offset:96
    ds_write_b64 v16, v[110:111] offset:112
    v_lshrrev_b32 v18, 3, v1
    v_and_b32 v19, 7, v1
    v_mul_u32_u24 v20, 144, v18
    v_lshl_add_u32 v20, v19, 4, v20
    v_add_u32 v20, v20, v17
    v_lshlrev_b32 v21, 11, v18
    v_lshl_add_u32 v21, v19, 4, v21
    s_lshl_b32 s3, s48, 16
    s_lshl_b32 s55, s7, 7
    s_add_u32 s3, s3, s55
    s_waitcnt lgkmcnt(0)
    ds_read_b128 v[32:35], v20 offset:0
    ds_read_b128 v[36:39], v20 offset:1152
    ds_read_b128 v[40:43], v20 offset:2304
    ds_read_b128 v[44:47], v20 offset:3456
    s_waitcnt lgkmcnt(3)
    buffer_store_dwordx4 v[32:35], v21, s[28:31], s3 offen sc1
    s_add_u32 s3, s3, 16384
    s_waitcnt lgkmcnt(2)
    buffer_store_dwordx4 v[36:39], v21, s[28:31], s3 offen sc1
    s_add_u32 s3, s3, 16384
    s_waitcnt lgkmcnt(1)
    buffer_store_dwordx4 v[40:43], v21, s[28:31], s3 offen sc1
    s_add_u32 s3, s3, 16384
    s_waitcnt lgkmcnt(0)
    buffer_store_dwordx4 v[44:47], v21, s[28:31], s3 offen sc1
    s_add_u32 s3, s3, 16384
    s_branch k_exit
c_prep:
    s_mov_b32 s28, s32
    s_mov_b32 s29, s33
    s_mov_b32 s30, 4194304
    s_mov_b32 s31, 0x00020000
    s_lshl_b32 s48, s6, 2
    s_add_u32 s48, s48, s8
    v_lshrrev_b32 v16, 3, v1
    v_and_b32 v17, 7, v1
    v_lshlrev_b32 v18, 11, v16
    v_lshl_add_u32 v18, v17, 4, v18
    s_lshl_b32 s55, s48, 16
    s_lshl_b32 s56, s7, 7
    s_add_u32 s3, s55, s56
    buffer_load_dwordx4 v[32:35], v18, s[28:31], s3 offen nt
    s_add_u32 s3, s3, 16384
    buffer_load_dwordx4 v[36:39], v18, s[28:31], s3 offen nt
    s_add_u32 s3, s3, 16384
    buffer_load_dwordx4 v[40:43], v18, s[28:31], s3 offen nt
    s_add_u32 s3, s3, 16384
    buffer_load_dwordx4 v[44:47], v18, s[28:31], s3 offen nt
    s_add_u32 s3, s3, 16384
    s_barrier
    s_lshl_b32 s56, s7, 12
    s_add_u32 s58, s55, s56
    v_lshlrev_b32 v5, 4, v1
    s_lshl_b32 s3, s8, 12
    s_add_u32 s3, s3, 131072
    v_lshrrev_b32 v18, 1, v17
    v_lshlrev_b32 v18, 10, v18
    v_lshl_add_u32 v18, v16, 4, v18
    v_and_b32 v17, 1, v17
    v_lshl_add_u32 v18, v17, 3, v18
    v_add_u32 v18, s3, v18
    v_add_u32 v19, s3, v5
    s_waitcnt vmcnt(3)
    ds_write_b64 v18, v[32:33] offset:0
    ds_write_b64 v18, v[34:35] offset:512
    s_waitcnt vmcnt(2)
    ds_write_b64 v18, v[36:37] offset:128
    ds_write_b64 v18, v[38:39] offset:640
    s_waitcnt vmcnt(1)
    ds_write_b64 v18, v[40:41] offset:256
    ds_write_b64 v18, v[42:43] offset:768
    s_waitcnt vmcnt(0)
    ds_write_b64 v18, v[44:45] offset:384
    ds_write_b64 v18, v[46:47] offset:896
    s_waitcnt lgkmcnt(0)
    ds_read_b128 v[96:99], v19 offset:0
    ds_read_b128 v[100:103], v19 offset:1024
    ds_read_b128 v[104:107], v19 offset:2048
    ds_read_b128 v[108:111], v19 offset:3072
    s_waitcnt lgkmcnt(3)
    buffer_store_dwordx4 v[96:99], v5, s[12:15], s58 offen offset:0 sc1
    s_waitcnt lgkmcnt(2)
    buffer_store_dwordx4 v[100:103], v5, s[12:15], s58 offen offset:1024 sc1
    s_waitcnt lgkmcnt(1)
    buffer_store_dwordx4 v[104:107], v5, s[12:15], s58 offen offset:2048 sc1
    s_waitcnt lgkmcnt(0)
    buffer_store_dwordx4 v[108:111], v5, s[12:15], s58 offen offset:3072 sc1
    s_branch c_wo_stat
.p2align 6
c_qkvB:
    v_and_b32 v1, 63, v0
    v_lshrrev_b32 v2, 6, v0
    v_lshlrev_b32 v5, 4, v1
    v_lshrrev_b32 v3, 5, v1
    v_and_b32 v4, 15, v0
    v_bfe_u32 v7, v1, 4, 1
    v_lshl_add_u32 v6, v7, 5, v4
    v_lshlrev_b32 v6, 4, v6
    v_lshl_add_u32 v6, v3, 10, v6
    s_lshr_b32 s48, s6, 1
    s_lshl_b32 s48, s48, 2
    s_add_u32 s48, s48, s8
    s_lshl_b32 s55, s48, 17
    s_lshl_b32 s56, s9, 22
    s_add_u32 s55, s55, s56
    s_add_u32 s16, s4, s55
    s_addc_u32 s17, s5, 0
    s_mov_b32 s18, 65536
    s_mov_b32 s19, 0x00020000
    s_add_u32 s56, s55, 65536
    s_add_u32 s20, s4, s56
    s_addc_u32 s21, s5, 0
    s_mov_b32 s22, 65536
    s_mov_b32 s23, 0x00020000
    s_lshl_b32 s49, s7, 12
    s_add_u32 s49, s49, s55
    s_and_b32 s56, s6, 1
    s_lshl_b32 s56, s56, 11
    s_add_u32 s49, s49, s56
    s_add_u32 s49, s49, 16777216
    s_movk_i32 s54, 4096
    v_lshrrev_b32 v16, 2, v4
    v_lshl_add_u32 v18, v7, 2, v16
    v_lshl_add_u32 v18, v3, 4, v18
    v_lshlrev_b32 v18, 6, v18
    v_and_b32 v17, 3, v4
    v_lshl_add_u32 v18, v17, 3, v18
    v_lshl_add_u32 v26, v7, 5, v18
    v_xor_b32 v27, 32, v26
    v_mov_b32 v24, v26
    v_mov_b32 v25, v27
    v_and_b32 v18, 0x30, v1
    v_add_u32 v10, 155648, v18
    v_lshlrev_b32 v11, 2, v4
    v_add_u32 v11, 155648, v11
    v_lshl_add_u32 v8, v2, 8, v11
    v_lshl_add_u32 v9, v2, 8, v10
    s_lshr_b32 s3, s8, 1
    s_and_b32 s55, s8, 1
    s_lshl_b32 s3, s3, 14
    s_lshl_b32 s55, s55, 12
    s_add_u32 s3, s3, s55
    s_add_u32 s3, s3, 81920
    v_lshl_add_u32 v12, v3, 5, v4
    v_lshlrev_b32 v12, 4, v12
    v_lshl_add_u32 v12, v7, 10, v12
    v_add_u32 v12, s3, v12
    v_add_u32 v13, s3, v5
    v_mov_b32 v32, 0
    v_mov_b32 v33, 0
    v_mov_b32 v34, 0
    v_mov_b32 v35, 0
    v_mov_b32 v36, 0
    v_mov_b32 v37, 0
    v_mov_b32 v38, 0
    v_mov_b32 v39, 0
    v_mov_b32 v40, 0
    v_mov_b32 v41, 0
    v_mov_b32 v42, 0
    v_mov_b32 v43, 0
    v_mov_b32 v44, 0
    v_mov_b32 v45, 0
    v_mov_b32 v46, 0
    v_mov_b32 v47, 0
    v_mov_b32 v48, 0
    v_mov_b32 v49, 0
    v_mov_b32 v50, 0
    v_mov_b32 v51, 0
    v_mov_b32 v52, 0
    v_mov_b32 v53, 0
    v_mov_b32 v54, 0
    v_mov_b32 v55, 0
    v_mov_b32 v56, 0
    v_mov_b32 v57, 0
    v_mov_b32 v58, 0
    v_mov_b32 v59, 0
    v_mov_b32 v60, 0
    v_mov_b32 v61, 0
    v_mov_b32 v62, 0
    v_mov_b32 v63, 0
    v_mov_b32 v64, 0
    v_mov_b32 v65, 0
    v_mov_b32 v66, 0
    v_mov_b32 v67, 0
    v_mov_b32 v68, 0
    v_mov_b32 v69, 0
    v_mov_b32 v70, 0
    v_mov_b32 v71, 0
    v_mov_b32 v72, 0
    v_mov_b32 v73, 0
    v_mov_b32 v74, 0
    v_mov_b32 v75, 0
    v_mov_b32 v76, 0
    v_mov_b32 v77, 0
    v_mov_b32 v78, 0
    v_mov_b32 v79, 0
    v_mov_b32 v80, 0
    v_mov_b32 v81, 0
    v_mov_b32 v82, 0
    v_mov_b32 v83, 0
    v_mov_b32 v84, 0
    v_mov_b32 v85, 0
    v_mov_b32 v86, 0
    v_mov_b32 v87, 0
    v_mov_b32 v88, 0
    v_mov_b32 v89, 0
    v_mov_b32 v90, 0
    v_mov_b32 v91, 0
    v_mov_b32 v92, 0
    v_mov_b32 v93, 0
    v_mov_b32 v94, 0
    v_mov_b32 v95, 0
    v_mov_b32 v96, 0
    v_mov_b32 v97, 0
    v_mov_b32 v98, 0
    v_mov_b32 v99, 0
    v_mov_b32 v100, 0
    v_mov_b32 v101, 0
    v_mov_b32 v102, 0
    v_mov_b32 v103, 0
    v_mov_b32 v104, 0
    v_mov_b32 v105, 0
    v_mov_b32 v106, 0
    v_mov_b32 v107, 0
    v_mov_b32 v108, 0
    v_mov_b32 v109, 0
    v_mov_b32 v110, 0
    v_mov_b32 v111, 0
    v_mov_b32 v112, 0
    v_mov_b32 v113, 0
    v_mov_b32 v114, 0
    v_mov_b32 v115, 0
    v_mov_b32 v116, 0
    v_mov_b32 v117, 0
    v_mov_b32 v118, 0
    v_mov_b32 v119, 0
    v_mov_b32 v120, 0
    v_mov_b32 v121, 0
    v_mov_b32 v122, 0
    v_mov_b32 v123, 0
    v_mov_b32 v124, 0
    v_mov_b32 v125, 0
    v_mov_b32 v126, 0
    v_mov_b32 v127, 0
    s_mov_b32 s50, 8192
    s_mov_b32 s58, 6144
    s_mov_b32 s51, 12288
    s_mov_b32 s59, 10240
    s_mov_b32 s52, 0
    s_mul_i32 s60, s9, 786432
    s_add_u32 s60, s60, 65273856
    s_lshl_b32 s61, s11, 10
    s_add_u32 s60, s60, s61
    s_lshl_b32 s61, s8, 7
    s_add_u32 s60, s60, s61
    s_mov_b32 s98, s10
    s_mov_b32 s99, s10
    s_mov_b32 s3, 0x100000
cp_9:
    s_load_dwordx8 s[24:31], s[4:5], s60 glc
    s_sub_u32 s3, s3, 1
    s_cbranch_scc1 cp_9_ok
    s_waitcnt lgkmcnt(0)
    s_xor_b64 s[24:25], s[24:25], s[98:99]
    s_xor_b64 s[26:27], s[26:27], s[98:99]
    s_xor_b64 s[28:29], s[28:29], s[98:99]
    s_xor_b64 s[30:31], s[30:31], s[98:99]
    s_or_b64 s[24:25], s[24:25], s[26:27]
    s_or_b64 s[28:29], s[28:29], s[30:31]
    s_or_b64 s[24:25], s[24:25], s[28:29]
    s_cbranch_scc1 cp_9
cp_9_ok:
    s_waitcnt lgkmcnt(0)
    s_barrier
    buffer_load_dwordx4 v[152:155], v6, s[16:19], 0 offen offset:0 sc1
    buffer_load_dwordx4 v[156:159], v6, s[16:19], 0 offen offset:256 sc1
    buffer_load_dwordx4 v[160:163], v6, s[20:23], 0 offen offset:0 sc1
    buffer_load_dwordx4 v[164:167], v6, s[20:23], 0 offen offset:256 sc1
    ds_read_b64_tr_b16 v[128:129], v24 offset:0
    ds_read_b64_tr_b16 v[130:131], v24 offset:512
    ds_read_b64_tr_b16 v[132:133], v25 offset:0
    ds_read_b64_tr_b16 v[134:135], v25 offset:512
    ds_read_b64_tr_b16 v[136:137], v24 offset:8192
    ds_read_b64_tr_b16 v[138:139], v24 offset:8704
    ds_read_b64_tr_b16 v[140:141], v25 offset:8192
    ds_read_b64_tr_b16 v[142:143], v25 offset:8704
    ds_read_b64_tr_b16 v[144:145], v24 offset:16384
    ds_read_b64_tr_b16 v[146:147], v24 offset:16896
    buffer_load_dwordx4 v[168:171], v6, s[16:19], 0 offen offset:2048 sc1
    buffer_load_dwordx4 v[172:175], v6, s[16:19], 0 offen offset:2304 sc1
    buffer_load_dwordx4 v[176:179], v6, s[20:23], 0 offen offset:2048 sc1
    buffer_load_dwordx4 v[180:183], v6, s[20:23], 0 offen offset:2304 sc1
    buffer_load_dwordx4 a[0:3], v6, s[16:19], s54 offen offset:0 sc1
    buffer_load_dwordx4 a[4:7], v6, s[16:19], s54 offen offset:256 sc1
    buffer_load_dwordx4 a[8:11], v6, s[20:23], s54 offen offset:0 sc1
    buffer_load_dwordx4 a[12:15], v6, s[20:23], s54 offen offset:256 sc1
    buffer_load_dwordx4 a[16:19], v6, s[16:19], s54 offen offset:2048 sc1
    buffer_load_dwordx4 a[20:23], v6, s[16:19], s54 offen offset:2304 sc1
    s_mov_b32 s54, 7
    s_waitcnt vmcnt(12)
    s_barrier
.p2align 3
c_qkvB_loop:
    s_waitcnt vmcnt(12) lgkmcnt(8)
    v_mfma_f32_16x16x32_bf16 v[32:35], v[128:131], v[152:155], v[32:35]
    ds_read_b64_tr_b16 v[148:149], v25 offset:16384
    buffer_load_dwordx4 a[24:27], v6, s[20:23], s58 offen offset:0 sc1
    v_mfma_f32_16x16x32_bf16 v[36:39], v[128:131], v[156:159], v[36:39]
    ds_read_b64_tr_b16 v[150:151], v25 offset:16896
    s_waitcnt lgkmcnt(8)
    v_mfma_f32_16x16x32_bf16 v[52:55], v[132:135], v[156:159], v[52:55]
    v_mfma_f32_16x16x32_bf16 v[48:51], v[132:135], v[152:155], v[48:51]
    s_waitcnt lgkmcnt(6)
    v_mfma_f32_16x16x32_bf16 v[64:67], v[136:139], v[152:155], v[64:67]
    v_mfma_f32_16x16x32_bf16 v[68:71], v[136:139], v[156:159], v[68:71]
    s_waitcnt lgkmcnt(4)
    v_mfma_f32_16x16x32_bf16 v[84:87], v[140:143], v[156:159], v[84:87]
    buffer_load_dwordx4 a[28:31], v6, s[20:23], s58 offen offset:256 sc1
    v_mfma_f32_16x16x32_bf16 v[80:83], v[140:143], v[152:155], v[80:83]
    s_waitcnt lgkmcnt(2)
    v_mfma_f32_16x16x32_bf16 v[96:99], v[152:155], v[144:147], v[96:99]
    v_mfma_f32_16x16x32_bf16 v[100:103], v[156:159], v[144:147], v[100:103]
    s_waitcnt lgkmcnt(0)
    v_mfma_f32_16x16x32_bf16 v[116:119], v[156:159], v[148:151], v[116:119]
    v_mfma_f32_16x16x32_bf16 v[112:115], v[152:155], v[148:151], v[112:115]
    s_waitcnt vmcnt(12)
    v_mfma_f32_16x16x32_bf16 v[40:43], v[128:131], v[160:163], v[40:43]
    buffer_load_dwordx4 v[152:155], v6, s[16:19], s50 offen offset:0 sc1
    v_mfma_f32_16x16x32_bf16 v[44:47], v[128:131], v[164:167], v[44:47]
    v_mfma_f32_16x16x32_bf16 v[60:63], v[132:135], v[164:167], v[60:63]
    ds_read_b64_tr_b16 v[128:129], v24 offset:2048
    v_mfma_f32_16x16x32_bf16 v[56:59], v[132:135], v[160:163], v[56:59]
    ds_read_b64_tr_b16 v[130:131], v24 offset:2560
    v_mfma_f32_16x16x32_bf16 v[72:75], v[136:139], v[160:163], v[72:75]
    ds_read_b64_tr_b16 v[132:133], v25 offset:2048
    v_mfma_f32_16x16x32_bf16 v[76:79], v[136:139], v[164:167], v[76:79]
    ds_read_b64_tr_b16 v[134:135], v25 offset:2560
    v_mfma_f32_16x16x32_bf16 v[92:95], v[140:143], v[164:167], v[92:95]
    ds_read_b64_tr_b16 v[136:137], v24 offset:10240
    buffer_load_dwordx4 v[156:159], v6, s[16:19], s50 offen offset:256 sc1
    v_mfma_f32_16x16x32_bf16 v[88:91], v[140:143], v[160:163], v[88:91]
    ds_read_b64_tr_b16 v[138:139], v24 offset:10752
    v_mfma_f32_16x16x32_bf16 v[104:107], v[160:163], v[144:147], v[104:107]
    ds_read_b64_tr_b16 v[140:141], v25 offset:10240
    v_mfma_f32_16x16x32_bf16 v[108:111], v[164:167], v[144:147], v[108:111]
    ds_read_b64_tr_b16 v[142:143], v25 offset:10752
    v_mfma_f32_16x16x32_bf16 v[124:127], v[164:167], v[148:151], v[124:127]
    ds_read_b64_tr_b16 v[144:145], v24 offset:18432
    v_mfma_f32_16x16x32_bf16 v[120:123], v[160:163], v[148:151], v[120:123]
    ds_read_b64_tr_b16 v[146:147], v24 offset:18944
    s_waitcnt vmcnt(12) lgkmcnt(8)
    v_mfma_f32_16x16x32_bf16 v[32:35], v[128:131], v[168:171], v[32:35]
    ds_read_b64_tr_b16 v[148:149], v25 offset:18432
    buffer_load_dwordx4 v[160:163], v6, s[20:23], s58 offen offset:2048 sc1
    v_mfma_f32_16x16x32_bf16 v[36:39], v[128:131], v[172:175], v[36:39]
    ds_read_b64_tr_b16 v[150:151], v25 offset:18944
    s_waitcnt lgkmcnt(8)
    v_mfma_f32_16x16x32_bf16 v[52:55], v[132:135], v[172:175], v[52:55]
    v_mfma_f32_16x16x32_bf16 v[48:51], v[132:135], v[168:171], v[48:51]
    s_waitcnt lgkmcnt(6)
    v_mfma_f32_16x16x32_bf16 v[64:67], v[136:139], v[168:171], v[64:67]
    v_mfma_f32_16x16x32_bf16 v[68:71], v[136:139], v[172:175], v[68:71]
    s_waitcnt lgkmcnt(4)
    v_mfma_f32_16x16x32_bf16 v[84:87], v[140:143], v[172:175], v[84:87]
    buffer_load_dwordx4 v[164:167], v6, s[20:23], s58 offen offset:2304 sc1
    v_mfma_f32_16x16x32_bf16 v[80:83], v[140:143], v[168:171], v[80:83]
    s_waitcnt lgkmcnt(2)
    v_mfma_f32_16x16x32_bf16 v[96:99], v[168:171], v[144:147], v[96:99]
    v_mfma_f32_16x16x32_bf16 v[100:103], v[172:175], v[144:147], v[100:103]
    s_waitcnt lgkmcnt(0)
    v_mfma_f32_16x16x32_bf16 v[116:119], v[172:175], v[148:151], v[116:119]
    v_mfma_f32_16x16x32_bf16 v[112:115], v[168:171], v[148:151], v[112:115]
    s_waitcnt vmcnt(12)
    v_mfma_f32_16x16x32_bf16 v[40:43], v[128:131], v[176:179], v[40:43]
    buffer_load_dwordx4 v[168:171], v6, s[16:19], s50 offen offset:2048 sc1
    v_mfma_f32_16x16x32_bf16 v[44:47], v[128:131], v[180:183], v[44:47]
    v_mfma_f32_16x16x32_bf16 v[60:63], v[132:135], v[180:183], v[60:63]
    ds_read_b64_tr_b16 v[128:129], v24 offset:4096
    v_mfma_f32_16x16x32_bf16 v[56:59], v[132:135], v[176:179], v[56:59]
    ds_read_b64_tr_b16 v[130:131], v24 offset:4608
    v_mfma_f32_16x16x32_bf16 v[72:75], v[136:139], v[176:179], v[72:75]
    ds_read_b64_tr_b16 v[132:133], v25 offset:4096
    v_mfma_f32_16x16x32_bf16 v[76:79], v[136:139], v[180:183], v[76:79]
    ds_read_b64_tr_b16 v[134:135], v25 offset:4608
    v_mfma_f32_16x16x32_bf16 v[92:95], v[140:143], v[180:183], v[92:95]
    ds_read_b64_tr_b16 v[136:137], v24 offset:12288
    buffer_load_dwordx4 v[172:175], v6, s[16:19], s50 offen offset:2304 sc1
    v_mfma_f32_16x16x32_bf16 v[88:91], v[140:143], v[176:179], v[88:91]
    ds_read_b64_tr_b16 v[138:139], v24 offset:12800
    v_mfma_f32_16x16x32_bf16 v[104:107], v[176:179], v[144:147], v[104:107]
    ds_read_b64_tr_b16 v[140:141], v25 offset:12288
    v_mfma_f32_16x16x32_bf16 v[108:111], v[180:183], v[144:147], v[108:111]
    ds_read_b64_tr_b16 v[142:143], v25 offset:12800
    v_mfma_f32_16x16x32_bf16 v[124:127], v[180:183], v[148:151], v[124:127]
    ds_read_b64_tr_b16 v[144:145], v24 offset:20480
    v_mfma_f32_16x16x32_bf16 v[120:123], v[176:179], v[148:151], v[120:123]
    ds_read_b64_tr_b16 v[146:147], v24 offset:20992
    s_waitcnt vmcnt(12) lgkmcnt(8)
    v_mfma_f32_16x16x32_bf16 v[32:35], v[128:131], a[0:3], v[32:35]
    ds_read_b64_tr_b16 v[148:149], v25 offset:20480
    buffer_load_dwordx4 v[176:179], v6, s[20:23], s59 offen offset:0 sc1
    v_mfma_f32_16x16x32_bf16 v[36:39], v[128:131], a[4:7], v[36:39]
    ds_read_b64_tr_b16 v[150:151], v25 offset:20992
    s_waitcnt lgkmcnt(8)
    v_mfma_f32_16x16x32_bf16 v[52:55], v[132:135], a[4:7], v[52:55]
    v_mfma_f32_16x16x32_bf16 v[48:51], v[132:135], a[0:3], v[48:51]
    s_waitcnt lgkmcnt(6)
    v_mfma_f32_16x16x32_bf16 v[64:67], v[136:139], a[0:3], v[64:67]
    v_mfma_f32_16x16x32_bf16 v[68:71], v[136:139], a[4:7], v[68:71]
    s_waitcnt lgkmcnt(4)
    v_mfma_f32_16x16x32_bf16 v[84:87], v[140:143], a[4:7], v[84:87]
    buffer_load_dwordx4 v[180:183], v6, s[20:23], s59 offen offset:256 sc1
    v_mfma_f32_16x16x32_bf16 v[80:83], v[140:143], a[0:3], v[80:83]
    s_waitcnt lgkmcnt(2)
    v_mfma_f32_16x16x32_bf16 v[96:99], a[0:3], v[144:147], v[96:99]
    v_mfma_f32_16x16x32_bf16 v[100:103], a[4:7], v[144:147], v[100:103]
    s_waitcnt lgkmcnt(0)
    v_mfma_f32_16x16x32_bf16 v[116:119], a[4:7], v[148:151], v[116:119]
    v_mfma_f32_16x16x32_bf16 v[112:115], a[0:3], v[148:151], v[112:115]
    s_waitcnt vmcnt(12)
    v_mfma_f32_16x16x32_bf16 v[40:43], v[128:131], a[8:11], v[40:43]
    buffer_load_dwordx4 a[0:3], v6, s[16:19], s51 offen offset:0 sc1
    v_mfma_f32_16x16x32_bf16 v[44:47], v[128:131], a[12:15], v[44:47]
    v_mfma_f32_16x16x32_bf16 v[60:63], v[132:135], a[12:15], v[60:63]
    ds_read_b64_tr_b16 v[128:129], v24 offset:6144
    v_mfma_f32_16x16x32_bf16 v[56:59], v[132:135], a[8:11], v[56:59]
    ds_read_b64_tr_b16 v[130:131], v24 offset:6656
    v_mfma_f32_16x16x32_bf16 v[72:75], v[136:139], a[8:11], v[72:75]
    ds_read_b64_tr_b16 v[132:133], v25 offset:6144
    v_mfma_f32_16x16x32_bf16 v[76:79], v[136:139], a[12:15], v[76:79]
    ds_read_b64_tr_b16 v[134:135], v25 offset:6656
    v_mfma_f32_16x16x32_bf16 v[92:95], v[140:143], a[12:15], v[92:95]
    ds_read_b64_tr_b16 v[136:137], v24 offset:14336
    buffer_load_dwordx4 a[4:7], v6, s[16:19], s51 offen offset:256 sc1
    v_mfma_f32_16x16x32_bf16 v[88:91], v[140:143], a[8:11], v[88:91]
    ds_read_b64_tr_b16 v[138:139], v24 offset:14848
    v_mfma_f32_16x16x32_bf16 v[104:107], a[8:11], v[144:147], v[104:107]
    ds_read_b64_tr_b16 v[140:141], v25 offset:14336
    v_mfma_f32_16x16x32_bf16 v[108:111], a[12:15], v[144:147], v[108:111]
    ds_read_b64_tr_b16 v[142:143], v25 offset:14848
    v_mfma_f32_16x16x32_bf16 v[124:127], a[12:15], v[148:151], v[124:127]
    ds_read_b64_tr_b16 v[144:145], v24 offset:22528
    v_mfma_f32_16x16x32_bf16 v[120:123], a[8:11], v[148:151], v[120:123]
    ds_read_b64_tr_b16 v[146:147], v24 offset:23040
    s_waitcnt vmcnt(12) lgkmcnt(8)
    v_mfma_f32_16x16x32_bf16 v[32:35], v[128:131], a[16:19], v[32:35]
    ds_read_b64_tr_b16 v[148:149], v25 offset:22528
    buffer_load_dwordx4 a[8:11], v6, s[20:23], s59 offen offset:2048 sc1
    v_mfma_f32_16x16x32_bf16 v[36:39], v[128:131], a[20:23], v[36:39]
    ds_read_b64_tr_b16 v[150:151], v25 offset:23040
    s_waitcnt lgkmcnt(8)
    v_mfma_f32_16x16x32_bf16 v[52:55], v[132:135], a[20:23], v[52:55]
    v_mfma_f32_16x16x32_bf16 v[48:51], v[132:135], a[16:19], v[48:51]
    s_waitcnt lgkmcnt(6)
    v_mfma_f32_16x16x32_bf16 v[64:67], v[136:139], a[16:19], v[64:67]
    v_mfma_f32_16x16x32_bf16 v[68:71], v[136:139], a[20:23], v[68:71]
    s_waitcnt lgkmcnt(4)
    v_mfma_f32_16x16x32_bf16 v[84:87], v[140:143], a[20:23], v[84:87]
    buffer_load_dwordx4 a[12:15], v6, s[20:23], s59 offen offset:2304 sc1
    v_mfma_f32_16x16x32_bf16 v[80:83], v[140:143], a[16:19], v[80:83]
    s_waitcnt lgkmcnt(2)
    v_mfma_f32_16x16x32_bf16 v[96:99], a[16:19], v[144:147], v[96:99]
    s_add_u32 s52, s52, 24576
    v_mfma_f32_16x16x32_bf16 v[100:103], a[20:23], v[144:147], v[100:103]
    s_cmp_eq_u32 s52, 147456
    s_waitcnt lgkmcnt(0)
    v_mfma_f32_16x16x32_bf16 v[116:119], a[20:23], v[148:151], v[116:119]
    s_cselect_b32 s52, 0, s52
    v_mfma_f32_16x16x32_bf16 v[112:115], a[16:19], v[148:151], v[112:115]
    s_add_u32 s58, s58, 8192
    s_add_u32 s59, s59, 8192
    s_waitcnt vmcnt(12)
    v_mfma_f32_16x16x32_bf16 v[40:43], v[128:131], a[24:27], v[40:43]
    buffer_load_dwordx4 a[16:19], v6, s[16:19], s51 offen offset:2048 sc1
    s_barrier
    v_add_u32 v24, s52, v26
    v_mfma_f32_16x16x32_bf16 v[44:47], v[128:131], a[28:31], v[44:47]
    v_add_u32 v25, s52, v27
    v_mfma_f32_16x16x32_bf16 v[60:63], v[132:135], a[28:31], v[60:63]
    ds_read_b64_tr_b16 v[128:129], v24 offset:0
    v_mfma_f32_16x16x32_bf16 v[56:59], v[132:135], a[24:27], v[56:59]
    ds_read_b64_tr_b16 v[130:131], v24 offset:512
    v_mfma_f32_16x16x32_bf16 v[72:75], v[136:139], a[24:27], v[72:75]
    ds_read_b64_tr_b16 v[132:133], v25 offset:0
    v_mfma_f32_16x16x32_bf16 v[76:79], v[136:139], a[28:31], v[76:79]
    ds_read_b64_tr_b16 v[134:135], v25 offset:512
    v_mfma_f32_16x16x32_bf16 v[92:95], v[140:143], a[28:31], v[92:95]
    ds_read_b64_tr_b16 v[136:137], v24 offset:8192
    buffer_load_dwordx4 a[20:23], v6, s[16:19], s51 offen offset:2304 sc1
    v_mfma_f32_16x16x32_bf16 v[88:91], v[140:143], a[24:27], v[88:91]
    ds_read_b64_tr_b16 v[138:139], v24 offset:8704
    v_mfma_f32_16x16x32_bf16 v[104:107], a[24:27], v[144:147], v[104:107]
    ds_read_b64_tr_b16 v[140:141], v25 offset:8192
    s_add_u32 s50, s50, 8192
    v_mfma_f32_16x16x32_bf16 v[108:111], a[28:31], v[144:147], v[108:111]
    ds_read_b64_tr_b16 v[142:143], v25 offset:8704
    s_add_u32 s51, s51, 8192
    v_mfma_f32_16x16x32_bf16 v[124:127], a[28:31], v[148:151], v[124:127]
    ds_read_b64_tr_b16 v[144:145], v24 offset:16384
    s_sub_u32 s54, s54, 1
    v_mfma_f32_16x16x32_bf16 v[120:123], a[24:27], v[148:151], v[120:123]
    ds_read_b64_tr_b16 v[146:147], v24 offset:16896
    s_cmp_lg_u32 s54, 0
    s_cbranch_scc1 c_qkvB_loop
    s_waitcnt vmcnt(12) lgkmcnt(8)
    v_mfma_f32_16x16x32_bf16 v[32:35], v[128:131], v[152:155], v[32:35]
    ds_read_b64_tr_b16 v[148:149], v25 offset:16384
    buffer_load_dwordx4 a[24:27], v6, s[20:23], s58 offen offset:0 sc1
    v_mfma_f32_16x16x32_bf16 v[36:39], v[128:131], v[156:159], v[36:39]
    ds_read_b64_tr_b16 v[150:151], v25 offset:16896
    s_waitcnt lgkmcnt(8)
    v_mfma_f32_16x16x32_bf16 v[52:55], v[132:135], v[156:159], v[52:55]
    ds_read_b32 v184, v8 offset:1280
    v_mfma_f32_16x16x32_bf16 v[48:51], v[132:135], v[152:155], v[48:51]
    ds_read_b32 v186, v8 offset:1344
    s_waitcnt lgkmcnt(8)
    v_mfma_f32_16x16x32_bf16 v[64:67], v[136:139], v[152:155], v[64:67]
    ds_read_b32 v188, v8 offset:1408
    v_mfma_f32_16x16x32_bf16 v[68:71], v[136:139], v[156:159], v[68:71]
    s_waitcnt lgkmcnt(7)
    v_mfma_f32_16x16x32_bf16 v[84:87], v[140:143], v[156:159], v[84:87]
    buffer_load_dwordx4 a[28:31], v6, s[20:23], s58 offen offset:256 sc1
    ds_read_b32 v190, v8 offset:1472
    v_mfma_f32_16x16x32_bf16 v[80:83], v[140:143], v[152:155], v[80:83]
    ds_read_b128 v[212:215], v10 offset:512
    s_waitcnt lgkmcnt(7)
    v_mfma_f32_16x16x32_bf16 v[96:99], v[152:155], v[144:147], v[96:99]
    ds_read_b128 v[216:219], v10 offset:576
    v_mfma_f32_16x16x32_bf16 v[100:103], v[156:159], v[144:147], v[100:103]
    s_waitcnt lgkmcnt(6)
    v_mfma_f32_16x16x32_bf16 v[116:119], v[156:159], v[148:151], v[116:119]
    v_mfma_f32_16x16x32_bf16 v[112:115], v[152:155], v[148:151], v[112:115]
    s_waitcnt vmcnt(12)
    v_mfma_f32_16x16x32_bf16 v[40:43], v[128:131], v[160:163], v[40:43]
    s_waitcnt lgkmcnt(0)
    v_fma_f32 v64, -v184, v212, v64
    v_fma_f32 v65, -v184, v213, v65
    v_mfma_f32_16x16x32_bf16 v[44:47], v[128:131], v[164:167], v[44:47]
    v_fma_f32 v66, -v184, v214, v66
    v_mfma_f32_16x16x32_bf16 v[60:63], v[132:135], v[164:167], v[60:63]
    ds_read_b64_tr_b16 v[128:129], v24 offset:2048
    v_fma_f32 v67, -v184, v215, v67
    v_mfma_f32_16x16x32_bf16 v[56:59], v[132:135], v[160:163], v[56:59]
    ds_read_b64_tr_b16 v[130:131], v24 offset:2560
    v_fma_f32 v68, -v186, v212, v68
    v_fma_f32 v69, -v186, v213, v69
    v_mfma_f32_16x16x32_bf16 v[72:75], v[136:139], v[160:163], v[72:75]
    ds_read_b64_tr_b16 v[132:133], v25 offset:2048
    v_fma_f32 v70, -v186, v214, v70
    v_mfma_f32_16x16x32_bf16 v[76:79], v[136:139], v[164:167], v[76:79]
    ds_read_b64_tr_b16 v[134:135], v25 offset:2560
    v_fma_f32 v71, -v186, v215, v71
    v_mfma_f32_16x16x32_bf16 v[92:95], v[140:143], v[164:167], v[92:95]
    ds_read_b64_tr_b16 v[136:137], v24 offset:10240
    v_fma_f32 v80, -v184, v216, v80
    v_fma_f32 v81, -v184, v217, v81
    v_mfma_f32_16x16x32_bf16 v[88:91], v[140:143], v[160:163], v[88:91]
    ds_read_b64_tr_b16 v[138:139], v24 offset:10752
    v_fma_f32 v82, -v184, v218, v82
    v_mfma_f32_16x16x32_bf16 v[104:107], v[160:163], v[144:147], v[104:107]
    ds_read_b64_tr_b16 v[140:141], v25 offset:10240
    v_fma_f32 v83, -v184, v219, v83
    v_mfma_f32_16x16x32_bf16 v[108:111], v[164:167], v[144:147], v[108:111]
    ds_read_b64_tr_b16 v[142:143], v25 offset:10752
    v_fma_f32 v84, -v186, v216, v84
    v_fma_f32 v85, -v186, v217, v85
    v_mfma_f32_16x16x32_bf16 v[124:127], v[164:167], v[148:151], v[124:127]
    ds_read_b64_tr_b16 v[144:145], v24 offset:18432
    v_fma_f32 v86, -v186, v218, v86
    v_mfma_f32_16x16x32_bf16 v[120:123], v[160:163], v[148:151], v[120:123]
    ds_read_b64_tr_b16 v[146:147], v24 offset:18944
    v_fma_f32 v87, -v186, v219, v87
    s_waitcnt vmcnt(10) lgkmcnt(8)
    v_mfma_f32_16x16x32_bf16 v[32:35], v[128:131], v[168:171], v[32:35]
    ds_read_b64_tr_b16 v[148:149], v25 offset:18432
    v_fma_f32 v72, -v188, v212, v72
    v_fma_f32 v73, -v188, v213, v73
    v_mfma_f32_16x16x32_bf16 v[36:39], v[128:131], v[172:175], v[36:39]
    ds_read_b64_tr_b16 v[150:151], v25 offset:18944
    v_fma_f32 v74, -v188, v214, v74
    s_waitcnt lgkmcnt(8)
    v_mfma_f32_16x16x32_bf16 v[52:55], v[132:135], v[172:175], v[52:55]
    v_fma_f32 v75, -v188, v215, v75
    ds_read_b128 v[152:155], v10 offset:384
    v_mfma_f32_16x16x32_bf16 v[48:51], v[132:135], v[168:171], v[48:51]
    v_fma_f32 v76, -v190, v212, v76
    v_fma_f32 v77, -v190, v213, v77
    ds_read_b128 v[156:159], v10 offset:448
    s_waitcnt lgkmcnt(8)
    v_mfma_f32_16x16x32_bf16 v[64:67], v[136:139], v[168:171], v[64:67]
    v_fma_f32 v78, -v190, v214, v78
    ds_read_b32 v185, v8 offset:2816
    v_mfma_f32_16x16x32_bf16 v[68:71], v[136:139], v[172:175], v[68:71]
    v_fma_f32 v79, -v190, v215, v79
    s_waitcnt lgkmcnt(7)
    v_mfma_f32_16x16x32_bf16 v[84:87], v[140:143], v[172:175], v[84:87]
    v_fma_f32 v88, -v188, v216, v88
    v_fma_f32 v89, -v188, v217, v89
    ds_read_b32 v187, v8 offset:2880
    v_mfma_f32_16x16x32_bf16 v[80:83], v[140:143], v[168:171], v[80:83]
    v_fma_f32 v90, -v188, v218, v90
    ds_read_b32 v189, v8 offset:2944
    s_waitcnt lgkmcnt(7)
    v_mfma_f32_16x16x32_bf16 v[96:99], v[168:171], v[144:147], v[96:99]
    v_fma_f32 v91, -v188, v219, v91
    ds_read_b32 v191, v8 offset:3008
    v_mfma_f32_16x16x32_bf16 v[100:103], v[172:175], v[144:147], v[100:103]
    v_fma_f32 v92, -v190, v216, v92
    v_fma_f32 v93, -v190, v217, v93
    s_waitcnt lgkmcnt(6)
    v_mfma_f32_16x16x32_bf16 v[116:119], v[172:175], v[148:151], v[116:119]
    v_fma_f32 v94, -v190, v218, v94
    v_mfma_f32_16x16x32_bf16 v[112:115], v[168:171], v[148:151], v[112:115]
    v_fma_f32 v95, -v190, v219, v95
    s_waitcnt vmcnt(8)
    v_mfma_f32_16x16x32_bf16 v[40:43], v[128:131], v[176:179], v[40:43]
    s_waitcnt lgkmcnt(0)
    v_fma_f32 v32, -v184, v152, v32
    v_fma_f32 v33, -v184, v153, v33
    v_mfma_f32_16x16x32_bf16 v[44:47], v[128:131], v[180:183], v[44:47]
    v_fma_f32 v34, -v184, v154, v34
    v_mfma_f32_16x16x32_bf16 v[60:63], v[132:135], v[180:183], v[60:63]
    ds_read_b64_tr_b16 v[128:129], v24 offset:4096
    v_fma_f32 v35, -v184, v155, v35
    v_fma_f32 v36, -v186, v152, v36
    v_mfma_f32_16x16x32_bf16 v[56:59], v[132:135], v[176:179], v[56:59]
    ds_read_b64_tr_b16 v[130:131], v24 offset:4608
    v_fma_f32 v37, -v186, v153, v37
    v_mfma_f32_16x16x32_bf16 v[72:75], v[136:139], v[176:179], v[72:75]
    ds_read_b64_tr_b16 v[132:133], v25 offset:4096
    v_fma_f32 v38, -v186, v154, v38
    v_fma_f32 v39, -v186, v155, v39
    v_mfma_f32_16x16x32_bf16 v[76:79], v[136:139], v[180:183], v[76:79]
    ds_read_b64_tr_b16 v[134:135], v25 offset:4608
    v_fma_f32 v48, -v184, v156, v48
    v_mfma_f32_16x16x32_bf16 v[92:95], v[140:143], v[180:183], v[92:95]
    ds_read_b64_tr_b16 v[136:137], v24 offset:12288
    v_fma_f32 v49, -v184, v157, v49
    v_fma_f32 v50, -v184, v158, v50
    v_mfma_f32_16x16x32_bf16 v[88:91], v[140:143], v[176:179], v[88:91]
    ds_read_b64_tr_b16 v[138:139], v24 offset:12800
    v_fma_f32 v51, -v184, v159, v51
    v_mfma_f32_16x16x32_bf16 v[104:107], v[176:179], v[144:147], v[104:107]
    ds_read_b64_tr_b16 v[140:141], v25 offset:12288
    v_fma_f32 v52, -v186, v156, v52
    v_fma_f32 v53, -v186, v157, v53
    v_mfma_f32_16x16x32_bf16 v[108:111], v[180:183], v[144:147], v[108:111]
    ds_read_b64_tr_b16 v[142:143], v25 offset:12800
    v_fma_f32 v54, -v186, v158, v54
    v_mfma_f32_16x16x32_bf16 v[124:127], v[180:183], v[148:151], v[124:127]
    ds_read_b64_tr_b16 v[144:145], v24 offset:20480
    v_fma_f32 v55, -v186, v159, v55
    v_mfma_f32_16x16x32_bf16 v[120:123], v[176:179], v[148:151], v[120:123]
    ds_read_b64_tr_b16 v[146:147], v24 offset:20992
    s_waitcnt vmcnt(6) lgkmcnt(8)
    v_mfma_f32_16x16x32_bf16 v[32:35], v[128:131], a[0:3], v[32:35]
    ds_read_b64_tr_b16 v[148:149], v25 offset:20480
    v_fma_f32 v40, -v188, v152, v40
    v_fma_f32 v41, -v188, v153, v41
    v_mfma_f32_16x16x32_bf16 v[36:39], v[128:131], a[4:7], v[36:39]
    ds_read_b64_tr_b16 v[150:151], v25 offset:20992
    v_fma_f32 v42, -v188, v154, v42
    s_waitcnt lgkmcnt(8)
    v_mfma_f32_16x16x32_bf16 v[52:55], v[132:135], a[4:7], v[52:55]
    v_fma_f32 v43, -v188, v155, v43
    v_fma_f32 v44, -v190, v152, v44
    ds_read_b128 v[168:171], v9 offset:1280
    v_mfma_f32_16x16x32_bf16 v[48:51], v[132:135], a[0:3], v[48:51]
    v_fma_f32 v45, -v190, v153, v45
    ds_read_b128 v[172:175], v9 offset:1344
    s_waitcnt lgkmcnt(8)
    v_mfma_f32_16x16x32_bf16 v[64:67], v[136:139], a[0:3], v[64:67]
    v_fma_f32 v46, -v190, v154, v46
    v_fma_f32 v47, -v190, v155, v47
    v_mfma_f32_16x16x32_bf16 v[68:71], v[136:139], a[4:7], v[68:71]
    v_fma_f32 v56, -v188, v156, v56
    ds_read_b128 v[176:179], v9 offset:1408
    s_waitcnt lgkmcnt(7)
    v_mfma_f32_16x16x32_bf16 v[84:87], v[140:143], a[4:7], v[84:87]
    v_fma_f32 v57, -v188, v157, v57
    v_fma_f32 v58, -v188, v158, v58
    ds_read_b128 v[180:183], v9 offset:1472
    v_mfma_f32_16x16x32_bf16 v[80:83], v[140:143], a[0:3], v[80:83]
    v_fma_f32 v59, -v188, v159, v59
    s_waitcnt lgkmcnt(6)
    v_mfma_f32_16x16x32_bf16 v[96:99], a[0:3], v[144:147], v[96:99]
    v_fma_f32 v60, -v190, v156, v60
    v_fma_f32 v61, -v190, v157, v61
    ds_read2_b32 v[220:221], v11 offset0:160 offset1:176
    v_mfma_f32_16x16x32_bf16 v[100:103], a[4:7], v[144:147], v[100:103]
    v_fma_f32 v62, -v190, v158, v62
    s_waitcnt lgkmcnt(5)
    v_mfma_f32_16x16x32_bf16 v[116:119], a[4:7], v[148:151], v[116:119]
    v_fma_f32 v63, -v190, v159, v63
    v_mfma_f32_16x16x32_bf16 v[112:115], a[0:3], v[148:151], v[112:115]
    s_waitcnt vmcnt(4)
    v_mfma_f32_16x16x32_bf16 v[40:43], v[128:131], a[8:11], v[40:43]
    v_mfma_f32_16x16x32_bf16 v[44:47], v[128:131], a[12:15], v[44:47]
    s_waitcnt lgkmcnt(0)
    v_fma_f32 v96, -v168, v220, v96
    v_fma_f32 v97, -v169, v220, v97
    v_mfma_f32_16x16x32_bf16 v[60:63], v[132:135], a[12:15], v[60:63]
    ds_read_b64_tr_b16 v[128:129], v24 offset:6144
    v_fma_f32 v98, -v170, v220, v98
    v_mfma_f32_16x16x32_bf16 v[56:59], v[132:135], a[8:11], v[56:59]
    ds_read_b64_tr_b16 v[130:131], v24 offset:6656
    v_fma_f32 v99, -v171, v220, v99
    v_fma_f32 v100, -v172, v220, v100
    v_mfma_f32_16x16x32_bf16 v[72:75], v[136:139], a[8:11], v[72:75]
    ds_read_b64_tr_b16 v[132:133], v25 offset:6144
    v_fma_f32 v101, -v173, v220, v101
    v_mfma_f32_16x16x32_bf16 v[76:79], v[136:139], a[12:15], v[76:79]
    ds_read_b64_tr_b16 v[134:135], v25 offset:6656
    v_fma_f32 v102, -v174, v220, v102
    v_fma_f32 v103, -v175, v220, v103
    v_mfma_f32_16x16x32_bf16 v[92:95], v[140:143], a[12:15], v[92:95]
    ds_read_b64_tr_b16 v[136:137], v24 offset:14336
    v_fma_f32 v112, -v168, v221, v112
    v_mfma_f32_16x16x32_bf16 v[88:91], v[140:143], a[8:11], v[88:91]
    ds_read_b64_tr_b16 v[138:139], v24 offset:14848
    v_fma_f32 v113, -v169, v221, v113
    v_fma_f32 v114, -v170, v221, v114
    v_mfma_f32_16x16x32_bf16 v[104:107], a[8:11], v[144:147], v[104:107]
    ds_read_b64_tr_b16 v[140:141], v25 offset:14336
    v_fma_f32 v115, -v171, v221, v115
    v_mfma_f32_16x16x32_bf16 v[108:111], a[12:15], v[144:147], v[108:111]
    ds_read_b64_tr_b16 v[142:143], v25 offset:14848
    v_fma_f32 v116, -v172, v221, v116
    v_fma_f32 v117, -v173, v221, v117
    v_mfma_f32_16x16x32_bf16 v[124:127], a[12:15], v[148:151], v[124:127]
    ds_read_b64_tr_b16 v[144:145], v24 offset:22528
    v_fma_f32 v118, -v174, v221, v118
    v_mfma_f32_16x16x32_bf16 v[120:123], a[8:11], v[148:151], v[120:123]
    ds_read_b64_tr_b16 v[146:147], v24 offset:23040
    v_fma_f32 v119, -v175, v221, v119
    s_waitcnt vmcnt(2) lgkmcnt(8)
    v_mfma_f32_16x16x32_bf16 v[32:35], v[128:131], a[16:19], v[32:35]
    ds_read_b64_tr_b16 v[148:149], v25 offset:22528
    v_mfma_f32_16x16x32_bf16 v[36:39], v[128:131], a[20:23], v[36:39]
    ds_read_b64_tr_b16 v[150:151], v25 offset:23040
    v_fma_f32 v104, -v176, v220, v104
    v_fma_f32 v105, -v177, v220, v105
    s_waitcnt lgkmcnt(8)
    v_mfma_f32_16x16x32_bf16 v[52:55], v[132:135], a[20:23], v[52:55]
    v_fma_f32 v106, -v178, v220, v106
    ds_read_b128 v[152:155], v9 offset:2816
    v_mfma_f32_16x16x32_bf16 v[48:51], v[132:135], a[16:19], v[48:51]
    v_fma_f32 v107, -v179, v220, v107
    v_fma_f32 v108, -v180, v220, v108
    s_waitcnt lgkmcnt(7)
    v_mfma_f32_16x16x32_bf16 v[64:67], v[136:139], a[16:19], v[64:67]
    v_fma_f32 v109, -v181, v220, v109
    ds_read_b128 v[156:159], v9 offset:2880
    v_mfma_f32_16x16x32_bf16 v[68:71], v[136:139], a[20:23], v[68:71]
    v_fma_f32 v110, -v182, v220, v110
    v_fma_f32 v111, -v183, v220, v111
    s_waitcnt lgkmcnt(6)
    v_mfma_f32_16x16x32_bf16 v[84:87], v[140:143], a[20:23], v[84:87]
    v_fma_f32 v120, -v176, v221, v120
    ds_read_b128 v[160:163], v9 offset:2944
    v_mfma_f32_16x16x32_bf16 v[80:83], v[140:143], a[16:19], v[80:83]
    v_fma_f32 v121, -v177, v221, v121
    v_fma_f32 v122, -v178, v221, v122
    s_waitcnt lgkmcnt(5)
    v_mfma_f32_16x16x32_bf16 v[96:99], a[16:19], v[144:147], v[96:99]
    v_fma_f32 v123, -v179, v221, v123
    ds_read_b128 v[164:167], v9 offset:3008
    v_mfma_f32_16x16x32_bf16 v[100:103], a[20:23], v[144:147], v[100:103]
    v_fma_f32 v124, -v180, v221, v124
    v_fma_f32 v125, -v181, v221, v125
    s_waitcnt lgkmcnt(4)
    v_mfma_f32_16x16x32_bf16 v[116:119], a[20:23], v[148:151], v[116:119]
    v_fma_f32 v126, -v182, v221, v126
    v_mfma_f32_16x16x32_bf16 v[112:115], a[16:19], v[148:151], v[112:115]
    v_fma_f32 v127, -v183, v221, v127
    s_waitcnt vmcnt(0)
    v_mfma_f32_16x16x32_bf16 v[40:43], v[128:131], a[24:27], v[40:43]
    v_mul_f32 v64, v185, v64
    v_mul_f32 v65, v185, v65
    s_barrier
    v_mfma_f32_16x16x32_bf16 v[44:47], v[128:131], a[28:31], v[44:47]
    v_mul_f32 v66, v185, v66
    v_mul_f32 v67, v185, v67
    v_mfma_f32_16x16x32_bf16 v[60:63], v[132:135], a[28:31], v[60:63]
    v_mul_f32 v80, v185, v80
    v_mul_f32 v81, v185, v81
    v_mfma_f32_16x16x32_bf16 v[56:59], v[132:135], a[24:27], v[56:59]
    v_mul_f32 v82, v185, v82
    v_mul_f32 v83, v185, v83
    v_mfma_f32_16x16x32_bf16 v[72:75], v[136:139], a[24:27], v[72:75]
    v_cvt_pk_bf16_f32 v64, v64, v65
    v_cvt_pk_bf16_f32 v65, v66, v67
    v_mfma_f32_16x16x32_bf16 v[76:79], v[136:139], a[28:31], v[76:79]
    v_cvt_pk_bf16_f32 v66, v80, v81
    v_cvt_pk_bf16_f32 v67, v82, v83
    v_mfma_f32_16x16x32_bf16 v[92:95], v[140:143], a[28:31], v[92:95]
    v_mul_f32 v68, v187, v68
    v_mul_f32 v69, v187, v69
    v_mfma_f32_16x16x32_bf16 v[88:91], v[140:143], a[24:27], v[88:91]
    v_mul_f32 v70, v187, v70
    v_mul_f32 v71, v187, v71
    v_mfma_f32_16x16x32_bf16 v[104:107], a[24:27], v[144:147], v[104:107]
    v_mul_f32 v84, v187, v84
    v_mul_f32 v85, v187, v85
    v_mfma_f32_16x16x32_bf16 v[108:111], a[28:31], v[144:147], v[108:111]
    v_mul_f32 v86, v187, v86
    v_mul_f32 v87, v187, v87
    v_mfma_f32_16x16x32_bf16 v[124:127], a[28:31], v[148:151], v[124:127]
    v_cvt_pk_bf16_f32 v68, v68, v69
    v_cvt_pk_bf16_f32 v69, v70, v71
    v_mfma_f32_16x16x32_bf16 v[120:123], a[24:27], v[148:151], v[120:123]
    v_cvt_pk_bf16_f32 v70, v84, v85
    v_cvt_pk_bf16_f32 v71, v86, v87
    ds_write_b128 v12, v[64:67] offset:0
    ds_write_b128 v12, v[68:71] offset:256
    v_pk_mul_f32 v[72:73], v[188:189], v[72:73] op_sel:[1,0] op_sel_hi:[1,1]
    v_pk_mul_f32 v[74:75], v[188:189], v[74:75] op_sel:[1,0] op_sel_hi:[1,1]
    v_pk_mul_f32 v[88:89], v[188:189], v[88:89] op_sel:[1,0] op_sel_hi:[1,1]
    v_pk_mul_f32 v[90:91], v[188:189], v[90:91] op_sel:[1,0] op_sel_hi:[1,1]
    v_cvt_pk_bf16_f32 v72, v72, v73
    v_cvt_pk_bf16_f32 v73, v74, v75
    v_cvt_pk_bf16_f32 v74, v88, v89
    v_cvt_pk_bf16_f32 v75, v90, v91
    ds_write_b128 v12, v[72:75] offset:2048
    v_pk_mul_f32 v[76:77], v[190:191], v[76:77] op_sel:[1,0] op_sel_hi:[1,1]
    v_pk_mul_f32 v[78:79], v[190:191], v[78:79] op_sel:[1,0] op_sel_hi:[1,1]
    v_pk_mul_f32 v[92:93], v[190:191], v[92:93] op_sel:[1,0] op_sel_hi:[1,1]
    v_pk_mul_f32 v[94:95], v[190:191], v[94:95] op_sel:[1,0] op_sel_hi:[1,1]
    v_cvt_pk_bf16_f32 v76, v76, v77
    v_cvt_pk_bf16_f32 v77, v78, v79
    v_cvt_pk_bf16_f32 v78, v92, v93
    v_cvt_pk_bf16_f32 v79, v94, v95
    ds_write_b128 v12, v[76:79] offset:2304
    s_waitcnt lgkmcnt(4)
    v_pk_mul_f32 v[96:97], v[152:153], v[96:97]
    v_pk_mul_f32 v[98:99], v[154:155], v[98:99]
    v_pk_mul_f32 v[112:113], v[152:153], v[112:113]
    v_pk_mul_f32 v[114:115], v[154:155], v[114:115]
    v_cvt_pk_bf16_f32 v96, v96, v97
    v_cvt_pk_bf16_f32 v97, v98, v99
    v_cvt_pk_bf16_f32 v98, v112, v113
    v_cvt_pk_bf16_f32 v99, v114, v115
    v_mul_f32 v185, 0x3e8293ee, v185
    v_permlane16_swap_b32 v96, v98
    v_permlane16_swap_b32 v97, v99
    ds_write_b128 v13, v[96:99] offset:8192
    v_pk_mul_f32 v[100:101], v[156:157], v[100:101]
    v_pk_mul_f32 v[102:103], v[158:159], v[102:103]
    v_pk_mul_f32 v[116:117], v[156:157], v[116:117]
    v_pk_mul_f32 v[118:119], v[158:159], v[118:119]
    v_cvt_pk_bf16_f32 v100, v100, v101
    v_cvt_pk_bf16_f32 v101, v102, v103
    v_cvt_pk_bf16_f32 v102, v116, v117
    v_cvt_pk_bf16_f32 v103, v118, v119
    v_mul_f32 v187, 0x3e8293ee, v187
    v_permlane16_swap_b32 v100, v102
    v_permlane16_swap_b32 v101, v103
    ds_write_b128 v13, v[100:103] offset:9216
    v_pk_mul_f32 v[104:105], v[160:161], v[104:105]
    v_pk_mul_f32 v[106:107], v[162:163], v[106:107]
    v_pk_mul_f32 v[120:121], v[160:161], v[120:121]
    v_pk_mul_f32 v[122:123], v[162:163], v[122:123]
    v_cvt_pk_bf16_f32 v104, v104, v105
    v_cvt_pk_bf16_f32 v105, v106, v107
    v_cvt_pk_bf16_f32 v106, v120, v121
    v_cvt_pk_bf16_f32 v107, v122, v123
    v_mul_f32 v189, 0x3e8293ee, v189
    v_permlane16_swap_b32 v104, v106
    v_permlane16_swap_b32 v105, v107
    ds_write_b128 v13, v[104:107] offset:10240
    v_pk_mul_f32 v[108:109], v[164:165], v[108:109]
    v_pk_mul_f32 v[110:111], v[166:167], v[110:111]
    v_pk_mul_f32 v[124:125], v[164:165], v[124:125]
    v_pk_mul_f32 v[126:127], v[166:167], v[126:127]
    v_cvt_pk_bf16_f32 v108, v108, v109
    v_cvt_pk_bf16_f32 v109, v110, v111
    v_cvt_pk_bf16_f32 v110, v124, v125
    v_cvt_pk_bf16_f32 v111, v126, v127
    v_mul_f32 v191, 0x3e8293ee, v191
    v_permlane16_swap_b32 v108, v110
    v_permlane16_swap_b32 v109, v111
    ds_write_b128 v13, v[108:111] offset:11264
    v_add_u32 v24, 81920, v5
    s_waitcnt lgkmcnt(0)
    s_barrier
    ds_read_b128 v[128:131], v24 offset:0
    ds_read_b128 v[132:135], v24 offset:1024
    ds_read_b128 v[136:139], v24 offset:2048
    ds_read_b128 v[140:143], v24 offset:3072
    v_pk_mul_f32 v[32:33], v[184:185], v[32:33] op_sel:[1,0] op_sel_hi:[1,1]
    v_pk_mul_f32 v[34:35], v[184:185], v[34:35] op_sel:[1,0] op_sel_hi:[1,1]
    v_pk_mul_f32 v[48:49], v[184:185], v[48:49] op_sel:[1,0] op_sel_hi:[1,1]
    v_pk_mul_f32 v[50:51], v[184:185], v[50:51] op_sel:[1,0] op_sel_hi:[1,1]
    v_cvt_pk_bf16_f32 v8, v32, v33
    v_cvt_pk_bf16_f32 v9, v34, v35
    v_cvt_pk_bf16_f32 v10, v48, v49
    v_cvt_pk_bf16_f32 v11, v50, v51
    v_pk_mul_f32 v[36:37], v[186:187], v[36:37] op_sel:[1,0] op_sel_hi:[1,1]
    v_pk_mul_f32 v[38:39], v[186:187], v[38:39] op_sel:[1,0] op_sel_hi:[1,1]
    v_pk_mul_f32 v[52:53], v[186:187], v[52:53] op_sel:[1,0] op_sel_hi:[1,1]
    v_pk_mul_f32 v[54:55], v[186:187], v[54:55] op_sel:[1,0] op_sel_hi:[1,1]
    v_cvt_pk_bf16_f32 v12, v36, v37
    v_cvt_pk_bf16_f32 v13, v38, v39
    v_cvt_pk_bf16_f32 v14, v52, v53
    v_cvt_pk_bf16_f32 v15, v54, v55
    v_pk_mul_f32 v[40:41], v[188:189], v[40:41] op_sel:[1,0] op_sel_hi:[1,1]
    v_pk_mul_f32 v[42:43], v[188:189], v[42:43] op_sel:[1,0] op_sel_hi:[1,1]
    v_pk_mul_f32 v[56:57], v[188:189], v[56:57] op_sel:[1,0] op_sel_hi:[1,1]
    v_pk_mul_f32 v[58:59], v[188:189], v[58:59] op_sel:[1,0] op_sel_hi:[1,1]
    v_cvt_pk_bf16_f32 v16, v40, v41
    v_cvt_pk_bf16_f32 v17, v42, v43
    v_cvt_pk_bf16_f32 v18, v56, v57
    v_cvt_pk_bf16_f32 v19, v58, v59
    v_pk_mul_f32 v[44:45], v[190:191], v[44:45] op_sel:[1,0] op_sel_hi:[1,1]
    v_pk_mul_f32 v[46:47], v[190:191], v[46:47] op_sel:[1,0] op_sel_hi:[1,1]
    v_pk_mul_f32 v[60:61], v[190:191], v[60:61] op_sel:[1,0] op_sel_hi:[1,1]
    v_pk_mul_f32 v[62:63], v[190:191], v[62:63] op_sel:[1,0] op_sel_hi:[1,1]
    v_cvt_pk_bf16_f32 v20, v44, v45
    v_cvt_pk_bf16_f32 v21, v46, v47
    v_cvt_pk_bf16_f32 v22, v60, v61
    v_cvt_pk_bf16_f32 v23, v62, v63
    v_permlane16_swap_b32 v8, v12
    v_permlane16_swap_b32 v9, v13
    v_permlane16_swap_b32 v10, v14
    v_permlane16_swap_b32 v11, v15
    v_permlane16_swap_b32 v16, v20
    v_permlane16_swap_b32 v17, v21
    v_permlane16_swap_b32 v18, v22
    v_permlane16_swap_b32 v19, v23
    s_waitcnt lgkmcnt(0)
    v_mfma_f32_32x32x16_bf16 v[64:79], v[128:131], v[8:11], 0
    v_mfma_f32_32x32x16_bf16 v[64:79], v[132:135], v[12:15], v[64:79]
    v_and_b32 v28, 7, v1
    v_mov_b32 v29, 0x3f803f80
    v_cmp_eq_u32 vcc, 0, v28
    s_nop 1
    v_cndmask_b32 v200, 0, v29, vcc
    v_cndmask_b32 v201, 0, v29, vcc
    v_cmp_eq_u32 vcc, 4, v28
    s_nop 1
    v_cndmask_b32 v202, 0, v29, vcc
    v_cndmask_b32 v203, 0, v29, vcc
    v_mov_b32 v204, 0xdddddddd
    v_mov_b32 v160, 0
    v_mov_b32 v161, 0
    v_mov_b32 v162, 0
    v_mov_b32 v163, 0
    v_mov_b32 v164, 0
    v_mov_b32 v165, 0
    v_mov_b32 v166, 0
    v_mov_b32 v167, 0
    v_mov_b32 v168, 0
    v_mov_b32 v169, 0
    v_mov_b32 v170, 0
    v_mov_b32 v171, 0
    v_mov_b32 v172, 0
    v_mov_b32 v173, 0
    v_mov_b32 v174, 0
    v_mov_b32 v175, 0
    v_mov_b32 v192, 0
    v_mov_b32 v193, 0
    v_mov_b32 v194, 0
    v_mov_b32 v195, 0
    v_mov_b32 v176, 0
    v_mov_b32 v177, 0
    v_mov_b32 v178, 0
    v_mov_b32 v179, 0
    v_mov_b32 v180, 0
    v_mov_b32 v181, 0
    v_mov_b32 v182, 0
    v_mov_b32 v183, 0
    v_mov_b32 v184, 0
    v_mov_b32 v185, 0
    v_mov_b32 v186, 0
    v_mov_b32 v187, 0
    v_mov_b32 v188, 0
    v_mov_b32 v189, 0
    v_mov_b32 v190, 0
    v_mov_b32 v191, 0
    v_mov_b32 v196, 0
    v_mov_b32 v197, 0
    v_mov_b32 v198, 0
    v_mov_b32 v199, 0
    v_mov_b32 v112, 0
    v_mov_b32 v113, 0
    v_mov_b32 v114, 0
    v_mov_b32 v115, 0
    v_mov_b32 v116, 0
    v_mov_b32 v117, 0
    v_mov_b32 v118, 0
    v_mov_b32 v119, 0
    v_mov_b32 v120, 0
    v_mov_b32 v121, 0
    v_mov_b32 v122, 0
    v_mov_b32 v123, 0
    v_mov_b32 v124, 0
    v_mov_b32 v125, 0
    v_mov_b32 v126, 0
    v_mov_b32 v127, 0
    v_mov_b32 v152, 0
    v_mov_b32 v153, 0
    v_mov_b32 v154, 0
    v_mov_b32 v155, 0
    v_mov_b32 v156, 0
    v_mov_b32 v157, 0
    v_mov_b32 v158, 0
    v_mov_b32 v159, 0
    s_mov_b32 s54, 4
.p2align 3
c_attn_loop:
    v_mfma_f32_32x32x16_bf16 v[80:95], v[128:131], v[16:19], 0
    v_exp_f32 v64, v64
    v_exp_f32 v65, v65
    v_exp_f32 v66, v66
    v_mfma_f32_32x32x16_bf16 v[80:95], v[132:135], v[20:23], v[80:95]
    v_exp_f32 v67, v67
    v_exp_f32 v68, v68
    v_exp_f32 v69, v69
    v_smfmac_f32_32x32x32_bf16 v[176:191], v[152:155], v[112:119], v204
    s_waitcnt lgkmcnt(0)
    v_exp_f32 v70, v70
    v_exp_f32 v71, v71
    v_exp_f32 v72, v72
    v_smfmac_f32_16x16x64_bf16 v[196:199], v[200:203], v[112:119], v204
    ds_read_b128 v[144:147], v24 offset:8192
    v_exp_f32 v73, v73
    v_exp_f32 v74, v74
    v_smfmac_f32_32x32x32_bf16 v[176:191], v[156:159], v[120:127], v204
    v_exp_f32 v75, v75
    v_exp_f32 v76, v76
    v_exp_f32 v77, v77
    v_smfmac_f32_16x16x64_bf16 v[196:199], v[200:203], v[120:127], v204
    ds_read_b128 v[148:151], v24 offset:9216
    v_exp_f32 v78, v78
    v_exp_f32 v79, v79
    v_mfma_f32_32x32x16_bf16 v[96:111], v[136:139], v[8:11], 0
    v_exp_f32 v80, v80
    v_exp_f32 v81, v81
    v_exp_f32 v82, v82
    v_mfma_f32_32x32x16_bf16 v[96:111], v[140:143], v[12:15], v[96:111]
    s_waitcnt lgkmcnt(1)
    v_exp_f32 v83, v83
    v_exp_f32 v84, v84
    v_exp_f32 v85, v85
    v_smfmac_f32_32x32x32_bf16 v[160:175], v[144:147], v[64:71], v204
    s_waitcnt lgkmcnt(0)
    v_exp_f32 v86, v86
    v_exp_f32 v87, v87
    v_exp_f32 v88, v88
    v_smfmac_f32_16x16x64_bf16 v[192:195], v[200:203], v[64:71], v204
    ds_read_b128 v[128:131], v24 offset:4096
    v_exp_f32 v89, v89
    v_exp_f32 v90, v90
    v_smfmac_f32_32x32x32_bf16 v[160:175], v[148:151], v[72:79], v204
    v_exp_f32 v91, v91
    v_exp_f32 v92, v92
    v_exp_f32 v93, v93
    v_smfmac_f32_16x16x64_bf16 v[192:195], v[200:203], v[72:79], v204
    ds_read_b128 v[132:135], v24 offset:5120
    v_exp_f32 v94, v94
    v_exp_f32 v95, v95
    v_mfma_f32_32x32x16_bf16 v[112:127], v[136:139], v[16:19], 0
    v_exp_f32 v96, v96
    v_exp_f32 v97, v97
    v_exp_f32 v98, v98
    v_mfma_f32_32x32x16_bf16 v[112:127], v[140:143], v[20:23], v[112:127]
    v_exp_f32 v99, v99
    v_exp_f32 v100, v100
    v_exp_f32 v101, v101
    v_smfmac_f32_32x32x32_bf16 v[176:191], v[144:147], v[80:87], v204
    s_waitcnt lgkmcnt(0)
    v_exp_f32 v102, v102
    v_exp_f32 v103, v103
    v_exp_f32 v104, v104
    v_smfmac_f32_16x16x64_bf16 v[196:199], v[200:203], v[80:87], v204
    ds_read_b128 v[152:155], v24 offset:10240
    v_exp_f32 v105, v105
    v_exp_f32 v106, v106
    v_smfmac_f32_32x32x32_bf16 v[176:191], v[148:151], v[88:95], v204
    v_exp_f32 v107, v107
    v_exp_f32 v108, v108
    v_exp_f32 v109, v109
    v_smfmac_f32_16x16x64_bf16 v[196:199], v[200:203], v[88:95], v204
    ds_read_b128 v[156:159], v24 offset:11264
    v_exp_f32 v110, v110
    v_exp_f32 v111, v111
    v_mfma_f32_32x32x16_bf16 v[64:79], v[128:131], v[8:11], 0
    v_exp_f32 v112, v112
    v_exp_f32 v113, v113
    v_exp_f32 v114, v114
    v_mfma_f32_32x32x16_bf16 v[64:79], v[132:135], v[12:15], v[64:79]
    s_waitcnt lgkmcnt(1)
    v_exp_f32 v115, v115
    v_exp_f32 v116, v116
    v_exp_f32 v117, v117
    v_smfmac_f32_32x32x32_bf16 v[160:175], v[152:155], v[96:103], v204
    s_waitcnt lgkmcnt(0)
    v_exp_f32 v118, v118
    v_exp_f32 v119, v119
    v_exp_f32 v120, v120
    v_smfmac_f32_16x16x64_bf16 v[192:195], v[200:203], v[96:103], v204
    ds_read_b128 v[136:139], v24 offset:6144
    v_exp_f32 v121, v121
    v_exp_f32 v122, v122
    v_smfmac_f32_32x32x32_bf16 v[160:175], v[156:159], v[104:111], v204
    v_exp_f32 v123, v123
    v_exp_f32 v124, v124
    v_exp_f32 v125, v125
    v_smfmac_f32_16x16x64_bf16 v[192:195], v[200:203], v[104:111], v204
    ds_read_b128 v[140:143], v24 offset:7168
    v_exp_f32 v126, v126
    v_exp_f32 v127, v127
    v_mfma_f32_32x32x16_bf16 v[80:95], v[128:131], v[16:19], 0
    s_cmp_eq_u32 s54, 4
    v_exp_f32 v64, v64
    v_exp_f32 v65, v65
    v_exp_f32 v66, v66
    v_mfma_f32_32x32x16_bf16 v[80:95], v[132:135], v[20:23], v[80:95]
    v_exp_f32 v67, v67
    v_exp_f32 v68, v68
    v_exp_f32 v69, v69
    v_smfmac_f32_32x32x32_bf16 v[176:191], v[152:155], v[112:119], v204
    s_waitcnt lgkmcnt(0)
    v_exp_f32 v70, v70
    v_exp_f32 v71, v71
    v_exp_f32 v72, v72
    v_smfmac_f32_16x16x64_bf16 v[196:199], v[200:203], v[112:119], v204
    ds_read_b128 v[144:147], v24 offset:12288
    v_exp_f32 v73, v73
    v_exp_f32 v74, v74
    v_smfmac_f32_32x32x32_bf16 v[176:191], v[156:159], v[120:127], v204
    v_exp_f32 v75, v75
    v_exp_f32 v76, v76
    v_exp_f32 v77, v77
    v_smfmac_f32_16x16x64_bf16 v[196:199], v[200:203], v[120:127], v204
    ds_read_b128 v[148:151], v24 offset:13312
    v_exp_f32 v78, v78
    v_exp_f32 v79, v79
    v_mfma_f32_32x32x16_bf16 v[96:111], v[136:139], v[8:11], 0
    s_cbranch_scc1 c_attn_nobar
    s_barrier
c_attn_nobar:
    v_exp_f32 v80, v80
    v_exp_f32 v81, v81
    v_exp_f32 v82, v82
    v_mfma_f32_32x32x16_bf16 v[96:111], v[140:143], v[12:15], v[96:111]
    s_waitcnt lgkmcnt(1)
    v_exp_f32 v83, v83
    v_exp_f32 v84, v84
    v_exp_f32 v85, v85
    v_smfmac_f32_32x32x32_bf16 v[160:175], v[144:147], v[64:71], v204
    s_waitcnt lgkmcnt(0)
    v_exp_f32 v86, v86
    v_exp_f32 v87, v87
    v_exp_f32 v88, v88
    v_smfmac_f32_16x16x64_bf16 v[192:195], v[200:203], v[64:71], v204
    ds_read_b128 v[128:131], v24 offset:16384
    v_exp_f32 v89, v89
    v_exp_f32 v90, v90
    v_smfmac_f32_32x32x32_bf16 v[160:175], v[148:151], v[72:79], v204
    v_exp_f32 v91, v91
    v_exp_f32 v92, v92
    v_exp_f32 v93, v93
    v_smfmac_f32_16x16x64_bf16 v[192:195], v[200:203], v[72:79], v204
    ds_read_b128 v[132:135], v24 offset:17408
    v_exp_f32 v94, v94
    v_exp_f32 v95, v95
    v_mfma_f32_32x32x16_bf16 v[112:127], v[136:139], v[16:19], 0
    v_exp_f32 v96, v96
    v_exp_f32 v97, v97
    v_exp_f32 v98, v98
    v_mfma_f32_32x32x16_bf16 v[112:127], v[140:143], v[20:23], v[112:127]
    v_exp_f32 v99, v99
    v_exp_f32 v100, v100
    v_exp_f32 v101, v101
    v_smfmac_f32_32x32x32_bf16 v[176:191], v[144:147], v[80:87], v204
    s_waitcnt lgkmcnt(0)
    v_exp_f32 v102, v102
    v_exp_f32 v103, v103
    v_exp_f32 v104, v104
    v_smfmac_f32_16x16x64_bf16 v[196:199], v[200:203], v[80:87], v204
    ds_read_b128 v[152:155], v24 offset:14336
    v_exp_f32 v105, v105
    v_exp_f32 v106, v106
    v_smfmac_f32_32x32x32_bf16 v[176:191], v[148:151], v[88:95], v204
    v_exp_f32 v107, v107
    v_exp_f32 v108, v108
    v_exp_f32 v109, v109
    v_smfmac_f32_16x16x64_bf16 v[196:199], v[200:203], v[88:95], v204
    ds_read_b128 v[156:159], v24 offset:15360
    v_exp_f32 v110, v110
    v_exp_f32 v111, v111
    v_mfma_f32_32x32x16_bf16 v[64:79], v[128:131], v[8:11], 0
    v_exp_f32 v112, v112
    v_exp_f32 v113, v113
    v_exp_f32 v114, v114
    v_mfma_f32_32x32x16_bf16 v[64:79], v[132:135], v[12:15], v[64:79]
    s_waitcnt lgkmcnt(1)
    v_exp_f32 v115, v115
    v_exp_f32 v116, v116
    v_exp_f32 v117, v117
    v_smfmac_f32_32x32x32_bf16 v[160:175], v[152:155], v[96:103], v204
    s_waitcnt lgkmcnt(0)
    v_exp_f32 v118, v118
    v_exp_f32 v119, v119
    v_exp_f32 v120, v120
    v_smfmac_f32_16x16x64_bf16 v[192:195], v[200:203], v[96:103], v204
    ds_read_b128 v[136:139], v24 offset:18432
    v_exp_f32 v121, v121
    v_exp_f32 v122, v122
    v_smfmac_f32_32x32x32_bf16 v[160:175], v[156:159], v[104:111], v204
    v_exp_f32 v123, v123
    v_exp_f32 v124, v124
    v_exp_f32 v125, v125
    v_smfmac_f32_16x16x64_bf16 v[192:195], v[200:203], v[104:111], v204
    ds_read_b128 v[140:143], v24 offset:19456
    v_exp_f32 v126, v126
    v_exp_f32 v127, v127
    v_mfma_f32_32x32x16_bf16 v[80:95], v[128:131], v[16:19], 0
    v_exp_f32 v64, v64
    v_exp_f32 v65, v65
    v_exp_f32 v66, v66
    v_mfma_f32_32x32x16_bf16 v[80:95], v[132:135], v[20:23], v[80:95]
    v_exp_f32 v67, v67
    v_exp_f32 v68, v68
    v_exp_f32 v69, v69
    v_smfmac_f32_32x32x32_bf16 v[176:191], v[152:155], v[112:119], v204
    s_waitcnt lgkmcnt(0)
    v_exp_f32 v70, v70
    v_exp_f32 v71, v71
    v_exp_f32 v72, v72
    v_smfmac_f32_16x16x64_bf16 v[196:199], v[200:203], v[112:119], v204
    ds_read_b128 v[144:147], v24 offset:24576
    v_exp_f32 v73, v73
    v_exp_f32 v74, v74
    v_smfmac_f32_32x32x32_bf16 v[176:191], v[156:159], v[120:127], v204
    v_exp_f32 v75, v75
    v_exp_f32 v76, v76
    v_exp_f32 v77, v77
    v_smfmac_f32_16x16x64_bf16 v[196:199], v[200:203], v[120:127], v204
    ds_read_b128 v[148:151], v24 offset:25600
    v_exp_f32 v78, v78
    v_exp_f32 v79, v79
    v_mfma_f32_32x32x16_bf16 v[96:111], v[136:139], v[8:11], 0
    v_exp_f32 v80, v80
    v_exp_f32 v81, v81
    v_exp_f32 v82, v82
    v_mfma_f32_32x32x16_bf16 v[96:111], v[140:143], v[12:15], v[96:111]
    s_waitcnt lgkmcnt(1)
    v_exp_f32 v83, v83
    v_exp_f32 v84, v84
    v_exp_f32 v85, v85
    v_smfmac_f32_32x32x32_bf16 v[160:175], v[144:147], v[64:71], v204
    s_waitcnt lgkmcnt(0)
    v_exp_f32 v86, v86
    v_exp_f32 v87, v87
    v_exp_f32 v88, v88
    v_smfmac_f32_16x16x64_bf16 v[192:195], v[200:203], v[64:71], v204
    ds_read_b128 v[128:131], v24 offset:20480
    v_exp_f32 v89, v89
    v_exp_f32 v90, v90
    v_smfmac_f32_32x32x32_bf16 v[160:175], v[148:151], v[72:79], v204
    v_exp_f32 v91, v91
    v_exp_f32 v92, v92
    v_exp_f32 v93, v93
    v_smfmac_f32_16x16x64_bf16 v[192:195], v[200:203], v[72:79], v204
    ds_read_b128 v[132:135], v24 offset:21504
    v_exp_f32 v94, v94
    v_exp_f32 v95, v95
    v_mfma_f32_32x32x16_bf16 v[112:127], v[136:139], v[16:19], 0
    v_exp_f32 v96, v96
    v_exp_f32 v97, v97
    v_exp_f32 v98, v98
    v_mfma_f32_32x32x16_bf16 v[112:127], v[140:143], v[20:23], v[112:127]
    v_exp_f32 v99, v99
    v_exp_f32 v100, v100
    v_exp_f32 v101, v101
    v_smfmac_f32_32x32x32_bf16 v[176:191], v[144:147], v[80:87], v204
    s_waitcnt lgkmcnt(0)
    v_exp_f32 v102, v102
    v_exp_f32 v103, v103
    v_exp_f32 v104, v104
    v_smfmac_f32_16x16x64_bf16 v[196:199], v[200:203], v[80:87], v204
    ds_read_b128 v[152:155], v24 offset:26624
    v_exp_f32 v105, v105
    v_exp_f32 v106, v106
    v_smfmac_f32_32x32x32_bf16 v[176:191], v[148:151], v[88:95], v204
    v_exp_f32 v107, v107
    v_exp_f32 v108, v108
    v_exp_f32 v109, v109
    v_smfmac_f32_16x16x64_bf16 v[196:199], v[200:203], v[88:95], v204
    ds_read_b128 v[156:159], v24 offset:27648
    v_exp_f32 v110, v110
    v_exp_f32 v111, v111
    v_mfma_f32_32x32x16_bf16 v[64:79], v[128:131], v[8:11], 0
    v_exp_f32 v112, v112
    v_exp_f32 v113, v113
    v_exp_f32 v114, v114
    v_mfma_f32_32x32x16_bf16 v[64:79], v[132:135], v[12:15], v[64:79]
    s_waitcnt lgkmcnt(1)
    v_exp_f32 v115, v115
    v_exp_f32 v116, v116
    v_exp_f32 v117, v117
    v_smfmac_f32_32x32x32_bf16 v[160:175], v[152:155], v[96:103], v204
    s_waitcnt lgkmcnt(0)
    v_exp_f32 v118, v118
    v_exp_f32 v119, v119
    v_exp_f32 v120, v120
    v_smfmac_f32_16x16x64_bf16 v[192:195], v[200:203], v[96:103], v204
    ds_read_b128 v[136:139], v24 offset:22528
    v_exp_f32 v121, v121
    v_exp_f32 v122, v122
    v_smfmac_f32_32x32x32_bf16 v[160:175], v[156:159], v[104:111], v204
    v_exp_f32 v123, v123
    v_exp_f32 v124, v124
    v_exp_f32 v125, v125
    v_smfmac_f32_16x16x64_bf16 v[192:195], v[200:203], v[104:111], v204
    ds_read_b128 v[140:143], v24 offset:23552
    v_exp_f32 v126, v126
    v_exp_f32 v127, v127
    v_mfma_f32_32x32x16_bf16 v[80:95], v[128:131], v[16:19], 0
    v_exp_f32 v64, v64
    v_exp_f32 v65, v65
    v_exp_f32 v66, v66
    v_mfma_f32_32x32x16_bf16 v[80:95], v[132:135], v[20:23], v[80:95]
    v_exp_f32 v67, v67
    v_exp_f32 v68, v68
    v_exp_f32 v69, v69
    v_smfmac_f32_32x32x32_bf16 v[176:191], v[152:155], v[112:119], v204
    s_waitcnt lgkmcnt(0)
    v_exp_f32 v70, v70
    v_exp_f32 v71, v71
    v_exp_f32 v72, v72
    v_smfmac_f32_16x16x64_bf16 v[196:199], v[200:203], v[112:119], v204
    ds_read_b128 v[144:147], v24 offset:28672
    v_exp_f32 v73, v73
    v_exp_f32 v74, v74
    v_smfmac_f32_32x32x32_bf16 v[176:191], v[156:159], v[120:127], v204
    v_exp_f32 v75, v75
    v_exp_f32 v76, v76
    v_exp_f32 v77, v77
    v_smfmac_f32_16x16x64_bf16 v[196:199], v[200:203], v[120:127], v204
    ds_read_b128 v[148:151], v24 offset:29696
    v_exp_f32 v78, v78
    v_exp_f32 v79, v79
    v_mfma_f32_32x32x16_bf16 v[96:111], v[136:139], v[8:11], 0
    s_barrier
    v_exp_f32 v80, v80
    v_exp_f32 v81, v81
    v_exp_f32 v82, v82
    v_mfma_f32_32x32x16_bf16 v[96:111], v[140:143], v[12:15], v[96:111]
    s_waitcnt lgkmcnt(1)
    v_exp_f32 v83, v83
    v_exp_f32 v84, v84
    v_exp_f32 v85, v85
    v_smfmac_f32_32x32x32_bf16 v[160:175], v[144:147], v[64:71], v204
    s_waitcnt lgkmcnt(0)
    v_exp_f32 v86, v86
    v_exp_f32 v87, v87
    v_exp_f32 v88, v88
    v_smfmac_f32_16x16x64_bf16 v[192:195], v[200:203], v[64:71], v204
    ds_read_b128 v[128:131], v24 offset:32768
    v_exp_f32 v89, v89
    v_exp_f32 v90, v90
    v_smfmac_f32_32x32x32_bf16 v[160:175], v[148:151], v[72:79], v204
    v_exp_f32 v91, v91
    v_exp_f32 v92, v92
    v_exp_f32 v93, v93
    v_smfmac_f32_16x16x64_bf16 v[192:195], v[200:203], v[72:79], v204
    ds_read_b128 v[132:135], v24 offset:33792
    v_exp_f32 v94, v94
    v_exp_f32 v95, v95
    v_mfma_f32_32x32x16_bf16 v[112:127], v[136:139], v[16:19], 0
    v_exp_f32 v96, v96
    v_exp_f32 v97, v97
    v_exp_f32 v98, v98
    v_mfma_f32_32x32x16_bf16 v[112:127], v[140:143], v[20:23], v[112:127]
    v_exp_f32 v99, v99
    v_exp_f32 v100, v100
    v_exp_f32 v101, v101
    v_smfmac_f32_32x32x32_bf16 v[176:191], v[144:147], v[80:87], v204
    s_waitcnt lgkmcnt(0)
    v_exp_f32 v102, v102
    v_exp_f32 v103, v103
    v_exp_f32 v104, v104
    v_smfmac_f32_16x16x64_bf16 v[196:199], v[200:203], v[80:87], v204
    ds_read_b128 v[152:155], v24 offset:30720
    v_exp_f32 v105, v105
    v_exp_f32 v106, v106
    v_smfmac_f32_32x32x32_bf16 v[176:191], v[148:151], v[88:95], v204
    v_exp_f32 v107, v107
    v_exp_f32 v108, v108
    v_exp_f32 v109, v109
    v_smfmac_f32_16x16x64_bf16 v[196:199], v[200:203], v[88:95], v204
    ds_read_b128 v[156:159], v24 offset:31744
    v_exp_f32 v110, v110
    v_exp_f32 v111, v111
    v_mfma_f32_32x32x16_bf16 v[64:79], v[128:131], v[8:11], 0
    v_exp_f32 v112, v112
    v_exp_f32 v113, v113
    v_exp_f32 v114, v114
    v_mfma_f32_32x32x16_bf16 v[64:79], v[132:135], v[12:15], v[64:79]
    s_waitcnt lgkmcnt(1)
    v_exp_f32 v115, v115
    v_exp_f32 v116, v116
    v_exp_f32 v117, v117
    v_smfmac_f32_32x32x32_bf16 v[160:175], v[152:155], v[96:103], v204
    s_waitcnt lgkmcnt(0)
    v_exp_f32 v118, v118
    v_exp_f32 v119, v119
    v_exp_f32 v120, v120
    v_smfmac_f32_16x16x64_bf16 v[192:195], v[200:203], v[96:103], v204
    ds_read_b128 v[136:139], v24 offset:34816
    v_exp_f32 v121, v121
    v_exp_f32 v122, v122
    v_smfmac_f32_32x32x32_bf16 v[160:175], v[156:159], v[104:111], v204
    v_exp_f32 v123, v123
    v_exp_f32 v124, v124
    v_exp_f32 v125, v125
    v_smfmac_f32_16x16x64_bf16 v[192:195], v[200:203], v[104:111], v204
    ds_read_b128 v[140:143], v24 offset:35840
    v_exp_f32 v126, v126
    v_exp_f32 v127, v127
    v_mfma_f32_32x32x16_bf16 v[80:95], v[128:131], v[16:19], 0
    v_exp_f32 v64, v64
    v_exp_f32 v65, v65
    v_exp_f32 v66, v66
    v_mfma_f32_32x32x16_bf16 v[80:95], v[132:135], v[20:23], v[80:95]
    v_exp_f32 v67, v67
    v_exp_f32 v68, v68
    v_exp_f32 v69, v69
    v_smfmac_f32_32x32x32_bf16 v[176:191], v[152:155], v[112:119], v204
    s_waitcnt lgkmcnt(0)
    v_exp_f32 v70, v70
    v_exp_f32 v71, v71
    v_exp_f32 v72, v72
    v_smfmac_f32_16x16x64_bf16 v[196:199], v[200:203], v[112:119], v204
    ds_read_b128 v[144:147], v24 offset:40960
    v_exp_f32 v73, v73
    v_exp_f32 v74, v74
    v_smfmac_f32_32x32x32_bf16 v[176:191], v[156:159], v[120:127], v204
    v_exp_f32 v75, v75
    v_exp_f32 v76, v76
    v_exp_f32 v77, v77
    v_smfmac_f32_16x16x64_bf16 v[196:199], v[200:203], v[120:127], v204
    ds_read_b128 v[148:151], v24 offset:41984
    v_exp_f32 v78, v78
    v_exp_f32 v79, v79
    v_mfma_f32_32x32x16_bf16 v[96:111], v[136:139], v[8:11], 0
    v_exp_f32 v80, v80
    v_exp_f32 v81, v81
    v_exp_f32 v82, v82
    v_mfma_f32_32x32x16_bf16 v[96:111], v[140:143], v[12:15], v[96:111]
    s_waitcnt lgkmcnt(1)
    v_exp_f32 v83, v83
    v_exp_f32 v84, v84
    v_exp_f32 v85, v85
    v_smfmac_f32_32x32x32_bf16 v[160:175], v[144:147], v[64:71], v204
    s_waitcnt lgkmcnt(0)
    v_exp_f32 v86, v86
    v_exp_f32 v87, v87
    v_exp_f32 v88, v88
    v_smfmac_f32_16x16x64_bf16 v[192:195], v[200:203], v[64:71], v204
    ds_read_b128 v[128:131], v24 offset:36864
    v_exp_f32 v89, v89
    v_exp_f32 v90, v90
    v_smfmac_f32_32x32x32_bf16 v[160:175], v[148:151], v[72:79], v204
    v_exp_f32 v91, v91
    v_exp_f32 v92, v92
    v_exp_f32 v93, v93
    v_smfmac_f32_16x16x64_bf16 v[192:195], v[200:203], v[72:79], v204
    ds_read_b128 v[132:135], v24 offset:37888
    v_exp_f32 v94, v94
    v_exp_f32 v95, v95
    v_mfma_f32_32x32x16_bf16 v[112:127], v[136:139], v[16:19], 0
    v_exp_f32 v96, v96
    v_exp_f32 v97, v97
    v_exp_f32 v98, v98
    v_mfma_f32_32x32x16_bf16 v[112:127], v[140:143], v[20:23], v[112:127]
    v_exp_f32 v99, v99
    v_exp_f32 v100, v100
    v_exp_f32 v101, v101
    v_smfmac_f32_32x32x32_bf16 v[176:191], v[144:147], v[80:87], v204
    s_waitcnt lgkmcnt(0)
    v_exp_f32 v102, v102
    v_exp_f32 v103, v103
    v_exp_f32 v104, v104
    v_smfmac_f32_16x16x64_bf16 v[196:199], v[200:203], v[80:87], v204
    ds_read_b128 v[152:155], v24 offset:43008
    v_exp_f32 v105, v105
    v_exp_f32 v106, v106
    v_smfmac_f32_32x32x32_bf16 v[176:191], v[148:151], v[88:95], v204
    v_exp_f32 v107, v107
    v_exp_f32 v108, v108
    v_exp_f32 v109, v109
    v_smfmac_f32_16x16x64_bf16 v[196:199], v[200:203], v[88:95], v204
    ds_read_b128 v[156:159], v24 offset:44032
    v_exp_f32 v110, v110
    v_exp_f32 v111, v111
    v_mfma_f32_32x32x16_bf16 v[64:79], v[128:131], v[8:11], 0
    v_exp_f32 v112, v112
    v_exp_f32 v113, v113
    v_exp_f32 v114, v114
    v_mfma_f32_32x32x16_bf16 v[64:79], v[132:135], v[12:15], v[64:79]
    s_waitcnt lgkmcnt(1)
    v_exp_f32 v115, v115
    v_exp_f32 v116, v116
    v_exp_f32 v117, v117
    v_smfmac_f32_32x32x32_bf16 v[160:175], v[152:155], v[96:103], v204
    s_waitcnt lgkmcnt(0)
    v_exp_f32 v118, v118
    v_exp_f32 v119, v119
    v_exp_f32 v120, v120
    v_smfmac_f32_16x16x64_bf16 v[192:195], v[200:203], v[96:103], v204
    ds_read_b128 v[136:139], v24 offset:38912
    v_exp_f32 v121, v121
    v_exp_f32 v122, v122
    v_smfmac_f32_32x32x32_bf16 v[160:175], v[156:159], v[104:111], v204
    v_exp_f32 v123, v123
    v_exp_f32 v124, v124
    v_exp_f32 v125, v125
    v_smfmac_f32_16x16x64_bf16 v[192:195], v[200:203], v[104:111], v204
    ds_read_b128 v[140:143], v24 offset:39936
    v_exp_f32 v126, v126
    v_exp_f32 v127, v127
    v_mfma_f32_32x32x16_bf16 v[80:95], v[128:131], v[16:19], 0
    v_exp_f32 v64, v64
    v_exp_f32 v65, v65
    v_exp_f32 v66, v66
    v_mfma_f32_32x32x16_bf16 v[80:95], v[132:135], v[20:23], v[80:95]
    v_exp_f32 v67, v67
    v_exp_f32 v68, v68
    v_exp_f32 v69, v69
    v_smfmac_f32_32x32x32_bf16 v[176:191], v[152:155], v[112:119], v204
    s_waitcnt lgkmcnt(0)
    v_exp_f32 v70, v70
    v_exp_f32 v71, v71
    v_exp_f32 v72, v72
    v_smfmac_f32_16x16x64_bf16 v[196:199], v[200:203], v[112:119], v204
    ds_read_b128 v[144:147], v24 offset:45056
    v_exp_f32 v73, v73
    v_exp_f32 v74, v74
    v_smfmac_f32_32x32x32_bf16 v[176:191], v[156:159], v[120:127], v204
    v_exp_f32 v75, v75
    v_exp_f32 v76, v76
    v_exp_f32 v77, v77
    v_smfmac_f32_16x16x64_bf16 v[196:199], v[200:203], v[120:127], v204
    ds_read_b128 v[148:151], v24 offset:46080
    v_exp_f32 v78, v78
    v_exp_f32 v79, v79
    v_mfma_f32_32x32x16_bf16 v[96:111], v[136:139], v[8:11], 0
    s_barrier
    v_exp_f32 v80, v80
    v_exp_f32 v81, v81
    v_exp_f32 v82, v82
    v_mfma_f32_32x32x16_bf16 v[96:111], v[140:143], v[12:15], v[96:111]
    s_waitcnt lgkmcnt(1)
    v_exp_f32 v83, v83
    v_exp_f32 v84, v84
    v_exp_f32 v85, v85
    v_smfmac_f32_32x32x32_bf16 v[160:175], v[144:147], v[64:71], v204
    s_waitcnt lgkmcnt(0)
    v_exp_f32 v86, v86
    v_exp_f32 v87, v87
    v_exp_f32 v88, v88
    v_smfmac_f32_16x16x64_bf16 v[192:195], v[200:203], v[64:71], v204
    ds_read_b128 v[128:131], v24 offset:49152
    v_exp_f32 v89, v89
    v_exp_f32 v90, v90
    v_smfmac_f32_32x32x32_bf16 v[160:175], v[148:151], v[72:79], v204
    v_exp_f32 v91, v91
    v_exp_f32 v92, v92
    v_exp_f32 v93, v93
    v_smfmac_f32_16x16x64_bf16 v[192:195], v[200:203], v[72:79], v204
    ds_read_b128 v[132:135], v24 offset:50176
    v_exp_f32 v94, v94
    v_exp_f32 v95, v95
    v_mfma_f32_32x32x16_bf16 v[112:127], v[136:139], v[16:19], 0
    v_exp_f32 v96, v96
    v_exp_f32 v97, v97
    v_exp_f32 v98, v98
    v_mfma_f32_32x32x16_bf16 v[112:127], v[140:143], v[20:23], v[112:127]
    v_exp_f32 v99, v99
    v_exp_f32 v100, v100
    v_exp_f32 v101, v101
    v_smfmac_f32_32x32x32_bf16 v[176:191], v[144:147], v[80:87], v204
    s_waitcnt lgkmcnt(0)
    v_exp_f32 v102, v102
    v_exp_f32 v103, v103
    v_exp_f32 v104, v104
    v_smfmac_f32_16x16x64_bf16 v[196:199], v[200:203], v[80:87], v204
    ds_read_b128 v[152:155], v24 offset:47104
    v_exp_f32 v105, v105
    v_exp_f32 v106, v106
    v_smfmac_f32_32x32x32_bf16 v[176:191], v[148:151], v[88:95], v204
    v_exp_f32 v107, v107
    v_exp_f32 v108, v108
    v_exp_f32 v109, v109
    v_smfmac_f32_16x16x64_bf16 v[196:199], v[200:203], v[88:95], v204
    ds_read_b128 v[156:159], v24 offset:48128
    v_exp_f32 v110, v110
    v_exp_f32 v111, v111
    v_mfma_f32_32x32x16_bf16 v[64:79], v[128:131], v[8:11], 0
    v_exp_f32 v112, v112
    v_exp_f32 v113, v113
    v_exp_f32 v114, v114
    v_mfma_f32_32x32x16_bf16 v[64:79], v[132:135], v[12:15], v[64:79]
    s_waitcnt lgkmcnt(1)
    v_exp_f32 v115, v115
    v_exp_f32 v116, v116
    v_exp_f32 v117, v117
    v_smfmac_f32_32x32x32_bf16 v[160:175], v[152:155], v[96:103], v204
    s_waitcnt lgkmcnt(0)
    v_exp_f32 v118, v118
    v_exp_f32 v119, v119
    v_exp_f32 v120, v120
    v_smfmac_f32_16x16x64_bf16 v[192:195], v[200:203], v[96:103], v204
    ds_read_b128 v[136:139], v24 offset:51200
    v_exp_f32 v121, v121
    v_exp_f32 v122, v122
    v_smfmac_f32_32x32x32_bf16 v[160:175], v[156:159], v[104:111], v204
    v_exp_f32 v123, v123
    v_exp_f32 v124, v124
    v_exp_f32 v125, v125
    v_smfmac_f32_16x16x64_bf16 v[192:195], v[200:203], v[104:111], v204
    ds_read_b128 v[140:143], v24 offset:52224
    v_exp_f32 v126, v126
    v_exp_f32 v127, v127
    v_mfma_f32_32x32x16_bf16 v[80:95], v[128:131], v[16:19], 0
    v_exp_f32 v64, v64
    v_exp_f32 v65, v65
    v_exp_f32 v66, v66
    v_mfma_f32_32x32x16_bf16 v[80:95], v[132:135], v[20:23], v[80:95]
    v_exp_f32 v67, v67
    v_exp_f32 v68, v68
    v_exp_f32 v69, v69
    v_smfmac_f32_32x32x32_bf16 v[176:191], v[152:155], v[112:119], v204
    s_waitcnt lgkmcnt(0)
    v_exp_f32 v70, v70
    v_exp_f32 v71, v71
    v_exp_f32 v72, v72
    v_smfmac_f32_16x16x64_bf16 v[196:199], v[200:203], v[112:119], v204
    ds_read_b128 v[144:147], v24 offset:57344
    v_exp_f32 v73, v73
    v_exp_f32 v74, v74
    v_smfmac_f32_32x32x32_bf16 v[176:191], v[156:159], v[120:127], v204
    v_exp_f32 v75, v75
    v_exp_f32 v76, v76
    v_exp_f32 v77, v77
    v_smfmac_f32_16x16x64_bf16 v[196:199], v[200:203], v[120:127], v204
    ds_read_b128 v[148:151], v24 offset:58368
    v_exp_f32 v78, v78
    v_exp_f32 v79, v79
    v_mfma_f32_32x32x16_bf16 v[96:111], v[136:139], v[8:11], 0
    v_exp_f32 v80, v80
    v_exp_f32 v81, v81
    v_exp_f32 v82, v82
    v_mfma_f32_32x32x16_bf16 v[96:111], v[140:143], v[12:15], v[96:111]
    s_waitcnt lgkmcnt(1)
    v_exp_f32 v83, v83
    v_exp_f32 v84, v84
    v_exp_f32 v85, v85
    v_smfmac_f32_32x32x32_bf16 v[160:175], v[144:147], v[64:71], v204
    s_waitcnt lgkmcnt(0)
    v_exp_f32 v86, v86
    v_exp_f32 v87, v87
    v_exp_f32 v88, v88
    v_smfmac_f32_16x16x64_bf16 v[192:195], v[200:203], v[64:71], v204
    ds_read_b128 v[128:131], v24 offset:53248
    v_exp_f32 v89, v89
    v_exp_f32 v90, v90
    v_smfmac_f32_32x32x32_bf16 v[160:175], v[148:151], v[72:79], v204
    v_exp_f32 v91, v91
    v_exp_f32 v92, v92
    v_exp_f32 v93, v93
    v_smfmac_f32_16x16x64_bf16 v[192:195], v[200:203], v[72:79], v204
    ds_read_b128 v[132:135], v24 offset:54272
    v_exp_f32 v94, v94
    v_exp_f32 v95, v95
    v_mfma_f32_32x32x16_bf16 v[112:127], v[136:139], v[16:19], 0
    v_exp_f32 v96, v96
    v_exp_f32 v97, v97
    v_exp_f32 v98, v98
    v_mfma_f32_32x32x16_bf16 v[112:127], v[140:143], v[20:23], v[112:127]
    v_exp_f32 v99, v99
    v_exp_f32 v100, v100
    v_exp_f32 v101, v101
    v_smfmac_f32_32x32x32_bf16 v[176:191], v[144:147], v[80:87], v204
    s_waitcnt lgkmcnt(0)
    v_exp_f32 v102, v102
    v_exp_f32 v103, v103
    v_exp_f32 v104, v104
    v_smfmac_f32_16x16x64_bf16 v[196:199], v[200:203], v[80:87], v204
    ds_read_b128 v[152:155], v24 offset:59392
    v_exp_f32 v105, v105
    v_exp_f32 v106, v106
    v_smfmac_f32_32x32x32_bf16 v[176:191], v[148:151], v[88:95], v204
    v_exp_f32 v107, v107
    v_exp_f32 v108, v108
    v_exp_f32 v109, v109
    v_smfmac_f32_16x16x64_bf16 v[196:199], v[200:203], v[88:95], v204
    ds_read_b128 v[156:159], v24 offset:60416
    v_exp_f32 v110, v110
    v_exp_f32 v111, v111
    v_mfma_f32_32x32x16_bf16 v[64:79], v[128:131], v[8:11], 0
    v_exp_f32 v112, v112
    v_exp_f32 v113, v113
    v_exp_f32 v114, v114
    v_mfma_f32_32x32x16_bf16 v[64:79], v[132:135], v[12:15], v[64:79]
    s_waitcnt lgkmcnt(1)
    v_exp_f32 v115, v115
    v_exp_f32 v116, v116
    v_exp_f32 v117, v117
    v_smfmac_f32_32x32x32_bf16 v[160:175], v[152:155], v[96:103], v204
    s_waitcnt lgkmcnt(0)
    v_exp_f32 v118, v118
    v_exp_f32 v119, v119
    v_exp_f32 v120, v120
    v_smfmac_f32_16x16x64_bf16 v[192:195], v[200:203], v[96:103], v204
    ds_read_b128 v[136:139], v24 offset:55296
    v_exp_f32 v121, v121
    v_exp_f32 v122, v122
    v_smfmac_f32_32x32x32_bf16 v[160:175], v[156:159], v[104:111], v204
    v_exp_f32 v123, v123
    v_exp_f32 v124, v124
    v_exp_f32 v125, v125
    v_smfmac_f32_16x16x64_bf16 v[192:195], v[200:203], v[104:111], v204
    ds_read_b128 v[140:143], v24 offset:56320
    v_exp_f32 v126, v126
    v_exp_f32 v127, v127
    v_mfma_f32_32x32x16_bf16 v[80:95], v[128:131], v[16:19], 0
    v_exp_f32 v64, v64
    v_exp_f32 v65, v65
    v_exp_f32 v66, v66
    v_mfma_f32_32x32x16_bf16 v[80:95], v[132:135], v[20:23], v[80:95]
    v_exp_f32 v67, v67
    v_exp_f32 v68, v68
    v_exp_f32 v69, v69
    v_smfmac_f32_32x32x32_bf16 v[176:191], v[152:155], v[112:119], v204
    s_waitcnt lgkmcnt(0)
    v_exp_f32 v70, v70
    v_exp_f32 v71, v71
    v_exp_f32 v72, v72
    v_smfmac_f32_16x16x64_bf16 v[196:199], v[200:203], v[112:119], v204
    ds_read_b128 v[144:147], v24 offset:61440
    v_exp_f32 v73, v73
    v_exp_f32 v74, v74
    v_smfmac_f32_32x32x32_bf16 v[176:191], v[156:159], v[120:127], v204
    v_exp_f32 v75, v75
    v_exp_f32 v76, v76
    v_exp_f32 v77, v77
    v_smfmac_f32_16x16x64_bf16 v[196:199], v[200:203], v[120:127], v204
    ds_read_b128 v[148:151], v24 offset:62464
    v_exp_f32 v78, v78
    v_exp_f32 v79, v79
    v_mfma_f32_32x32x16_bf16 v[96:111], v[136:139], v[8:11], 0
    s_barrier
    v_exp_f32 v80, v80
    v_exp_f32 v81, v81
    v_exp_f32 v82, v82
    v_mfma_f32_32x32x16_bf16 v[96:111], v[140:143], v[12:15], v[96:111]
    s_waitcnt lgkmcnt(1)
    v_exp_f32 v83, v83
    v_exp_f32 v84, v84
    v_exp_f32 v85, v85
    v_smfmac_f32_32x32x32_bf16 v[160:175], v[144:147], v[64:71], v204
    s_waitcnt lgkmcnt(0)
    v_exp_f32 v86, v86
    v_exp_f32 v87, v87
    v_exp_f32 v88, v88
    v_smfmac_f32_16x16x64_bf16 v[192:195], v[200:203], v[64:71], v204
    ds_read_b128 v[128:131], v24 offset:0
    v_exp_f32 v89, v89
    v_exp_f32 v90, v90
    v_smfmac_f32_32x32x32_bf16 v[160:175], v[148:151], v[72:79], v204
    v_exp_f32 v91, v91
    v_exp_f32 v92, v92
    v_exp_f32 v93, v93
    v_smfmac_f32_16x16x64_bf16 v[192:195], v[200:203], v[72:79], v204
    ds_read_b128 v[132:135], v24 offset:1024
    v_exp_f32 v94, v94
    v_exp_f32 v95, v95
    v_mfma_f32_32x32x16_bf16 v[112:127], v[136:139], v[16:19], 0
    v_exp_f32 v96, v96
    v_exp_f32 v97, v97
    v_exp_f32 v98, v98
    v_mfma_f32_32x32x16_bf16 v[112:127], v[140:143], v[20:23], v[112:127]
    v_exp_f32 v99, v99
    v_exp_f32 v100, v100
    v_exp_f32 v101, v101
    v_smfmac_f32_32x32x32_bf16 v[176:191], v[144:147], v[80:87], v204
    s_waitcnt lgkmcnt(0)
    v_exp_f32 v102, v102
    v_exp_f32 v103, v103
    v_exp_f32 v104, v104
    v_smfmac_f32_16x16x64_bf16 v[196:199], v[200:203], v[80:87], v204
    ds_read_b128 v[152:155], v24 offset:63488
    v_exp_f32 v105, v105
    v_exp_f32 v106, v106
    v_smfmac_f32_32x32x32_bf16 v[176:191], v[148:151], v[88:95], v204
    v_exp_f32 v107, v107
    v_exp_f32 v108, v108
    v_exp_f32 v109, v109
    v_smfmac_f32_16x16x64_bf16 v[196:199], v[200:203], v[88:95], v204
    ds_read_b128 v[156:159], v24 offset:64512
    v_exp_f32 v110, v110
    v_exp_f32 v111, v111
    v_mfma_f32_32x32x16_bf16 v[64:79], v[128:131], v[8:11], 0
    s_sub_u32 s54, s54, 1
    v_exp_f32 v112, v112
    v_exp_f32 v113, v113
    v_exp_f32 v114, v114
    v_mfma_f32_32x32x16_bf16 v[64:79], v[132:135], v[12:15], v[64:79]
    s_waitcnt lgkmcnt(1)
    v_exp_f32 v115, v115
    v_exp_f32 v116, v116
    v_exp_f32 v117, v117
    v_smfmac_f32_32x32x32_bf16 v[160:175], v[152:155], v[96:103], v204
    s_waitcnt lgkmcnt(0)
    v_exp_f32 v118, v118
    v_exp_f32 v119, v119
    v_exp_f32 v120, v120
    v_smfmac_f32_16x16x64_bf16 v[192:195], v[200:203], v[96:103], v204
    ds_read_b128 v[136:139], v24 offset:2048
    v_exp_f32 v121, v121
    v_exp_f32 v122, v122
    v_smfmac_f32_32x32x32_bf16 v[160:175], v[156:159], v[104:111], v204
    s_cmp_lg_u32 s54, 0
    v_exp_f32 v123, v123
    v_exp_f32 v124, v124
    v_exp_f32 v125, v125
    v_smfmac_f32_16x16x64_bf16 v[192:195], v[200:203], v[104:111], v204
    ds_read_b128 v[140:143], v24 offset:3072
    v_exp_f32 v126, v126
    v_exp_f32 v127, v127
    s_cbranch_scc1 c_attn_loop
    v_smfmac_f32_16x16x64_bf16 v[196:199], v[200:203], v[112:119], v204
    v_smfmac_f32_16x16x64_bf16 v[196:199], v[200:203], v[120:127], v204
    v_smfmac_f32_32x32x32_bf16 v[176:191], v[152:155], v[112:119], v204
    v_smfmac_f32_32x32x32_bf16 v[176:191], v[156:159], v[120:127], v204
    v_mov_b32 v28, 0x5f000000
    v_mov_b32 v29, 0x2b800000
    v_cmp_lt_f32 s[56:57], v192, v28
    v_cmp_gt_f32 vcc, v192, v29
    s_and_b64 s[56:57], s[56:57], vcc
    s_nop 0
    v_cmp_lt_f32 vcc, v196, v28
    s_and_b64 s[56:57], s[56:57], vcc
    v_cmp_gt_f32 vcc, v196, v29
    s_and_b64 s[56:57], s[56:57], vcc
    s_cmp_lg_u64 s[56:57], -1
    s_cbranch_scc1 c_attn_slow
c_attn_fin:
    s_lshl_b32 s3, s48, 17
    s_lshl_b32 s55, s7, 12
    s_add_u32 s3, s3, s55
    s_and_b32 s55, s6, 1
    s_lshl_b32 s55, s55, 11
    s_add_u32 s3, s3, s55
    s_lshl_b32 s55, s9, 22
    s_add_u32 s3, s3, s55
    s_add_u32 s3, s3, 16777216
    v_rcp_f32 v192, v192
    s_nop 0
    v_pk_mul_f32 v[160:161], v[192:193], v[160:161] op_sel_hi:[0,1]
    v_pk_mul_f32 v[162:163], v[192:193], v[162:163] op_sel_hi:[0,1]
    v_pk_mul_f32 v[164:165], v[192:193], v[164:165] op_sel_hi:[0,1]
    v_pk_mul_f32 v[166:167], v[192:193], v[166:167] op_sel_hi:[0,1]
    v_pk_mul_f32 v[168:169], v[192:193], v[168:169] op_sel_hi:[0,1]
    v_pk_mul_f32 v[170:171], v[192:193], v[170:171] op_sel_hi:[0,1]
    v_pk_mul_f32 v[172:173], v[192:193], v[172:173] op_sel_hi:[0,1]
    v_pk_mul_f32 v[174:175], v[192:193], v[174:175] op_sel_hi:[0,1]
    v_cvt_pk_bf16_f32 v160, v160, v161
    v_cvt_pk_bf16_f32 v161, v162, v163
    v_cvt_pk_bf16_f32 v162, v164, v165
    v_cvt_pk_bf16_f32 v163, v166, v167
    v_cvt_pk_bf16_f32 v164, v168, v169
    v_cvt_pk_bf16_f32 v165, v170, v171
    v_cvt_pk_bf16_f32 v166, v172, v173
    v_cvt_pk_bf16_f32 v167, v174, v175
    buffer_store_dwordx4 v[160:163], v5, s[12:15], s3 offen offset:0 sc1
    buffer_store_dwordx4 v[164:167], v5, s[12:15], s3 offen offset:1024 sc1
    s_add_u32 s3, s3, 65536
    v_rcp_f32 v196, v196
    s_nop 0
    v_pk_mul_f32 v[176:177], v[196:197], v[176:177] op_sel_hi:[0,1]
    v_pk_mul_f32 v[178:179], v[196:197], v[178:179] op_sel_hi:[0,1]
    v_pk_mul_f32 v[180:181], v[196:197], v[180:181] op_sel_hi:[0,1]
    v_pk_mul_f32 v[182:183], v[196:197], v[182:183] op_sel_hi:[0,1]
    v_pk_mul_f32 v[184:185], v[196:197], v[184:185] op_sel_hi:[0,1]
    v_pk_mul_f32 v[186:187], v[196:197], v[186:187] op_sel_hi:[0,1]
    v_pk_mul_f32 v[188:189], v[196:197], v[188:189] op_sel_hi:[0,1]
    v_pk_mul_f32 v[190:191], v[196:197], v[190:191] op_sel_hi:[0,1]
    v_cvt_pk_bf16_f32 v176, v176, v177
    v_cvt_pk_bf16_f32 v177, v178, v179
    v_cvt_pk_bf16_f32 v178, v180, v181
    v_cvt_pk_bf16_f32 v179, v182, v183
    v_cvt_pk_bf16_f32 v180, v184, v185
    v_cvt_pk_bf16_f32 v181, v186, v187
    v_cvt_pk_bf16_f32 v182, v188, v189
    v_cvt_pk_bf16_f32 v183, v190, v191
    buffer_store_dwordx4 v[176:179], v5, s[12:15], s3 offen offset:0 sc1
    buffer_store_dwordx4 v[180:183], v5, s[12:15], s3 offen offset:1024 sc1
    s_add_u32 s3, s3, 65536
    s_branch c_wo
.p2align 6
h_first:
    s_memrealtime s[50:51]
    s_cmp_lg_u32 s2, 0
    s_cbranch_scc1 h_first_nonon
    s_mov_b32 s16, s46
    s_mov_b32 s17, s47
    s_mov_b32 s18, 256
    s_mov_b32 s19, 0x00020000
    v_lshlrev_b32 v14, 6, v1
    s_waitcnt lgkmcnt(0)
    s_or_b32 s50, s50, 1
    v_mov_b32 v13, s50
    buffer_store_dword v13, v14, s[16:19], 0 offen sc1
h_first_nonon:
    v_mov_b32 v8, 0
    v_mov_b32 v9, 0
    v_mov_b32 v10, 159488
    ds_write_b64 v10, v[8:9]
    ds_write_b64 v10, v[8:9] offset:8
    ds_write_b64 v10, v[8:9] offset:16
    ds_write_b64 v10, v[8:9] offset:24
    s_waitcnt lgkmcnt(0)
    s_barrier
    s_barrier
    s_sub_u32 s50, s50, 8000
    s_load_dword s10, s[46:47], 0
    s_waitcnt lgkmcnt(0)
    s_sub_u32 s51, s10, s50
    s_and_b32 s3, s10, 1
    s_cselect_b32 s51, s51, -1
    s_cmp_ge_i32 s51, 0
    s_cbranch_scc1 h_first_non_ok
    s_load_dword s10, s[46:47], 128
    s_waitcnt lgkmcnt(0)
    s_sub_u32 s51, s10, s50
    s_and_b32 s3, s10, 1
    s_cselect_b32 s51, s51, -1
    s_cmp_ge_i32 s51, 0
    s_cbranch_scc1 h_first_non_ok
    s_load_dword s10, s[46:47], 64
    s_waitcnt lgkmcnt(0)
    s_sub_u32 s51, s10, s50
    s_and_b32 s3, s10, 1
    s_cselect_b32 s51, s51, -1
    s_cmp_ge_i32 s51, 0
    s_cbranch_scc1 h_first_non_ok
    s_load_dword s10, s[46:47], 192
    s_waitcnt lgkmcnt(0)
    s_sub_u32 s51, s10, s50
    s_and_b32 s3, s10, 1
    s_cselect_b32 s51, s51, -1
    s_cmp_ge_i32 s51, 0
    s_cbranch_scc1 h_first_non_ok
    s_mov_b32 s58, 0
    s_and_b32 s57, s2, 0xc0
h_first_non:
    s_load_dword s10, s[46:47], s57 glc
    s_waitcnt lgkmcnt(0)
    s_sub_u32 s51, s10, s50
    s_and_b32 s3, s10, 1
    s_cselect_b32 s51, s51, -1
    s_cmp_ge_i32 s51, 0
    s_cbranch_scc1 h_first_non_ok
    s_add_u32 s58, s58, 1
    s_cmp_gt_u32 s58, 100
    s_cselect_b32 s50, s10, s50
    s_cmp_lt_u32 s58, 0x100000
    s_cbranch_scc1 h_first_non
    s_mov_b32 s10, 1
h_first_non_ok:
    v_mov_b32 v12, s10
    ds_write_b32 v10, v12 offset:4
    s_waitcnt vmcnt(0)
    v_lshlrev_b32 v13, 7, v1
    s_lshl_b32 s50, s2, 13
    s_mov_b32 s28, s36
    s_mov_b32 s29, s37
    s_mov_b32 s30, 2097152
    s_mov_b32 s31, 0x00020000
    buffer_load_dword v14, v13, s[28:31], s50 offen
    s_mov_b32 s9, 0
h_qkvA:
    s_mul_i32 s98, s9, 786432
    s_add_u32 s98, s98, 65273856
    s_lshl_b32 s99, s11, 10
    s_add_u32 s98, s98, s99
    s_add_u32 s96, s4, s98
    s_addc_u32 s97, s5, 0
    s_mov_b32 s98, s10
    s_mov_b32 s99, s10
    v_and_b32 v1, 63, v0
    v_lshlrev_b32 v5, 4, v1
    v_and_b32 v20, 15, v1
    v_lshrrev_b32 v11, 4, v1
    v_min_u32 v11, 2, v11
    v_lshlrev_b32 v21, 3, v20
    v_lshl_add_u32 v12, v11, 7, v21
    v_add_u32 v12, 155648, v12
    v_lshl_add_u32 v11, v11, 16, v21
    v_mov_b32 v10, 159496
    s_add_u32 s3, s9, 1
    v_mov_b32 v13, s3
    s_and_b32 s3, s6, 14
    s_lshl_b32 s3, s3, 2
    s_sub_u32 s3, s3, 1
    s_max_i32 s3, s3, 0
    s_lshl_b32 s3, s3, 16
    s_lshl_b32 s48, s9, 22
    s_add_u32 s3, s3, s48
    s_add_u32 s20, s4, s3
    s_addc_u32 s21, s5, 0
    s_mov_b32 s22, 65536
    s_mov_b32 s23, 0x00020000
    s_cmp_lt_u32 s6, 2
    s_cselect_b32 s22, 0, s22
    s_cselect_b32 s3, 0, 512
    s_add_u32 s96, s96, s3
    s_addc_u32 s97, s97, 0
    v_bfe_u32 v21, v1, 4, 1
    v_lshl_add_u32 v6, v21, 5, v20
    v_lshlrev_b32 v6, 4, v6
    v_lshrrev_b32 v21, 5, v1
    v_lshl_add_u32 v6, v21, 10, v6
    v_add_u32 v6, 256, v6
    s_mov_b32 s3, 0x100000
poll_10:
    s_load_dwordx8 s[80:87], s[96:97], 0 glc
    s_load_dwordx8 s[88:95], s[96:97], 128 glc
    s_sub_u32 s3, s3, 1
    s_cbranch_scc1 poll_10_ok
    s_waitcnt lgkmcnt(0)
    s_xor_b64 s[100:101], s[80:81], s[98:99]
    s_xor_b64 s[80:81], s[82:83], s[98:99]
    s_or_b64 s[100:101], s[100:101], s[80:81]
    s_xor_b64 s[80:81], s[84:85], s[98:99]
    s_or_b64 s[100:101], s[100:101], s[80:81]
    s_xor_b64 s[80:81], s[86:87], s[98:99]
    s_or_b64 s[100:101], s[100:101], s[80:81]
    s_xor_b64 s[80:81], s[88:89], s[98:99]
    s_or_b64 s[100:101], s[100:101], s[80:81]
    s_xor_b64 s[80:81], s[90:91], s[98:99]
    s_or_b64 s[100:101], s[100:101], s[80:81]
    s_xor_b64 s[80:81], s[92:93], s[98:99]
    s_or_b64 s[100:101], s[100:101], s[80:81]
    s_xor_b64 s[80:81], s[94:95], s[98:99]
    s_or_b64 s[100:101], s[100:101], s[80:81]
    s_cbranch_scc1 poll_10
poll_10_ok:
    s_waitcnt lgkmcnt(0)
    ds_write_b32 v10, v13
    s_mov_b32 m0, 147456
    s_mov_b32 s48, 0
    buffer_load_dwordx4 v6, s[20:23], s48 offen sc1 lds
    s_mov_b32 m0, 148480
    s_mov_b32 s48, 2048
    buffer_load_dwordx4 v6, s[20:23], s48 offen sc1 lds
    s_mov_b32 m0, 149504
    s_mov_b32 s48, 4096
    buffer_load_dwordx4 v6, s[20:23], s48 offen sc1 lds
    s_mov_b32 m0, 150528
    s_mov_b32 s48, 6144
    buffer_load_dwordx4 v6, s[20:23], s48 offen sc1 lds
    s_barrier
    s_mov_b32 m0, 151552
    s_mov_b32 s48, 8192
    buffer_load_dwordx4 v6, s[20:23], s48 offen sc1 lds
    s_mov_b32 m0, 152576
    s_mov_b32 s48, 10240
    buffer_load_dwordx4 v6, s[20:23], s48 offen sc1 lds
    s_mov_b32 m0, 153600
    s_mov_b32 s48, 12288
    buffer_load_dwordx4 v6, s[20:23], s48 offen sc1 lds
    s_mov_b32 m0, 154624
    s_mov_b32 s48, 14336
    buffer_load_dwordx4 v6, s[20:23], s48 offen sc1 lds
    s_lshl_b32 s56, s7, 12
    s_and_b32 s57, s6, 1
    s_lshl_b32 s57, s57, 7
    s_add_u32 s56, s56, s57
    s_add_u32 s56, s56, 63963136
    v_lshlrev_b32 v15, 7, v1
    s_lshr_b32 s59, s2, 3
    s_mul_i32 s59, s59, 3
    s_lshr_b32 s59, s59, 5
    s_lshl_b32 s3, s9, 4
    s_add_u32 s59, s59, s3
    s_and_b32 s58, s6, 14
    s_lshl_b32 s58, s58, 18
    s_lshl_b32 s57, s9, 22
    s_add_u32 s58, s58, s57
    s_and_b32 s57, s7, 3
    s_lshl_b32 s57, s57, 11
    s_add_u32 s58, s58, s57
    s_waitcnt vmcnt(4)
    s_barrier
    s_waitcnt vmcnt(0)
    s_barrier
    s_mov_b32 m0, 147456
    s_mov_b32 s48, 16384
    buffer_load_dwordx4 v6, s[20:23], s48 offen sc1 lds
    s_mov_b32 m0, 148480
    s_mov_b32 s48, 18432
    buffer_load_dwordx4 v6, s[20:23], s48 offen sc1 lds
    s_mov_b32 m0, 149504
    s_mov_b32 s48, 20480
    buffer_load_dwordx4 v6, s[20:23], s48 offen sc1 lds
    s_mov_b32 m0, 150528
    s_mov_b32 s48, 22528
    buffer_load_dwordx4 v6, s[20:23], s48 offen sc1 lds
    s_waitcnt vmcnt(0)
    s_barrier
    s_mov_b32 m0, 151552
    s_mov_b32 s48, 24576
    buffer_load_dwordx4 v6, s[20:23], s48 offen sc1 lds
    s_mov_b32 m0, 152576
    s_mov_b32 s48, 26624
    buffer_load_dwordx4 v6, s[20:23], s48 offen sc1 lds
    s_mov_b32 m0, 153600
    s_mov_b32 s48, 28672
    buffer_load_dwordx4 v6, s[20:23], s48 offen sc1 lds
    s_mov_b32 m0, 154624
    s_mov_b32 s48, 30720
    buffer_load_dwordx4 v6, s[20:23], s48 offen sc1 lds
    buffer_load_dwordx2 v[32:33], v11, s[12:15], s56 offen offset:0 sc1
    buffer_load_dwordx2 v[34:35], v11, s[12:15], s56 offen offset:256 sc1
    buffer_load_dwordx2 v[36:37], v11, s[12:15], s56 offen offset:512 sc1
    buffer_load_dwordx2 v[38:39], v11, s[12:15], s56 offen offset:768 sc1
    buffer_load_dwordx2 v[40:41], v11, s[12:15], s56 offen offset:1024 sc1
    buffer_load_dwordx2 v[42:43], v11, s[12:15], s56 offen offset:1280 sc1
    buffer_load_dwordx2 v[44:45], v11, s[12:15], s56 offen offset:1536 sc1
    buffer_load_dwordx2 v[46:47], v11, s[12:15], s56 offen offset:1792 sc1
    buffer_load_dwordx2 v[48:49], v11, s[12:15], s56 offen offset:2048 sc1
    buffer_load_dwordx2 v[50:51], v11, s[12:15], s56 offen offset:2304 sc1
    buffer_load_dwordx2 v[52:53], v11, s[12:15], s56 offen offset:2560 sc1
    buffer_load_dwordx2 v[54:55], v11, s[12:15], s56 offen offset:2816 sc1
    s_waitcnt vmcnt(12)
    s_barrier
    s_mov_b32 m0, 147456
    s_mov_b32 s48, 32768
    buffer_load_dwordx4 v6, s[20:23], s48 offen sc1 lds
    s_mov_b32 m0, 148480
    s_mov_b32 s48, 34816
    buffer_load_dwordx4 v6, s[20:23], s48 offen sc1 lds
    s_mov_b32 m0, 149504
    s_mov_b32 s48, 36864
    buffer_load_dwordx4 v6, s[20:23], s48 offen sc1 lds
    s_mov_b32 m0, 150528
    s_mov_b32 s48, 38912
    buffer_load_dwordx4 v6, s[20:23], s48 offen sc1 lds
    buffer_load_dwordx2 v[56:57], v11, s[12:15], s56 offen offset:3072 sc1
    buffer_load_dwordx2 v[58:59], v11, s[12:15], s56 offen offset:3328 sc1
    buffer_load_dwordx2 v[60:61], v11, s[12:15], s56 offen offset:3584 sc1
    buffer_load_dwordx2 v[62:63], v11, s[12:15], s56 offen offset:3840 sc1
    s_waitcnt vmcnt(4)
    s_barrier
    s_mov_b32 m0, 151552
    s_mov_b32 s48, 40960
    buffer_load_dwordx4 v6, s[20:23], s48 offen sc1 lds
    s_mov_b32 m0, 152576
    s_mov_b32 s48, 43008
    buffer_load_dwordx4 v6, s[20:23], s48 offen sc1 lds
    s_mov_b32 m0, 153600
    s_mov_b32 s48, 45056
    buffer_load_dwordx4 v6, s[20:23], s48 offen sc1 lds
    s_mov_b32 m0, 154624
    s_mov_b32 s48, 47104
    buffer_load_dwordx4 v6, s[20:23], s48 offen sc1 lds
    s_waitcnt vmcnt(4)
    v_add_f32 v32, v32, v48
    v_add_f32 v33, v33, v49
    v_add_f32 v34, v34, v50
    v_add_f32 v35, v35, v51
    v_add_f32 v36, v36, v52
    v_add_f32 v37, v37, v53
    v_add_f32 v38, v38, v54
    v_add_f32 v39, v39, v55
    v_add_f32 v40, v40, v56
    v_add_f32 v41, v41, v57
    v_add_f32 v42, v42, v58
    v_add_f32 v43, v43, v59
    s_waitcnt vmcnt(0)
    s_barrier
    s_mov_b32 m0, 147456
    s_mov_b32 s48, 49152
    buffer_load_dwordx4 v6, s[20:23], s48 offen sc1 lds
    s_mov_b32 m0, 148480
    s_mov_b32 s48, 51200
    buffer_load_dwordx4 v6, s[20:23], s48 offen sc1 lds
    s_mov_b32 m0, 149504
    s_mov_b32 s48, 53248
    buffer_load_dwordx4 v6, s[20:23], s48 offen sc1 lds
    s_mov_b32 m0, 150528
    s_mov_b32 s48, 55296
    buffer_load_dwordx4 v6, s[20:23], s48 offen sc1 lds
    v_add_f32 v44, v44, v60
    v_add_f32 v45, v45, v61
    v_add_f32 v46, v46, v62
    v_add_f32 v47, v47, v63
    v_add_f32 v32, v32, v40
    v_add_f32 v33, v33, v41
    v_add_f32 v34, v34, v42
    v_add_f32 v35, v35, v43
    v_add_f32 v36, v36, v44
    v_add_f32 v37, v37, v45
    v_add_f32 v38, v38, v46
    v_add_f32 v39, v39, v47
    s_waitcnt vmcnt(0)
    s_barrier
    s_mov_b32 m0, 151552
    s_mov_b32 s48, 57344
    buffer_load_dwordx4 v6, s[20:23], s48 offen sc1 lds
    s_mov_b32 m0, 152576
    s_mov_b32 s48, 59392
    buffer_load_dwordx4 v6, s[20:23], s48 offen sc1 lds
    s_mov_b32 m0, 153600
    s_mov_b32 s48, 61440
    buffer_load_dwordx4 v6, s[20:23], s48 offen sc1 lds
    s_mov_b32 m0, 154624
    s_mov_b32 s48, 63488
    buffer_load_dwordx4 v6, s[20:23], s48 offen sc1 lds
    v_add_f32 v32, v32, v36
    v_add_f32 v33, v33, v37
    v_add_f32 v34, v34, v38
    v_add_f32 v35, v35, v39
    v_add_f32 v32, v32, v34
    v_add_f32 v33, v33, v35
    ds_write_b64 v12, v[32:33]
    s_waitcnt lgkmcnt(0)
    s_waitcnt vmcnt(0)
    s_barrier
    s_barrier
    s_barrier
    s_branch h_wo
h_qkvB:
    s_mul_i32 s98, s9, 786432
    s_add_u32 s98, s98, 65273856
    s_lshl_b32 s99, s11, 10
    s_add_u32 s98, s98, s99
    s_add_u32 s96, s4, s98
    s_addc_u32 s97, s5, 0
    s_mov_b32 s98, s10
    s_mov_b32 s99, s10
    v_and_b32 v1, 63, v0
    v_lshlrev_b32 v5, 4, v1
    v_and_b32 v20, 15, v1
    v_lshrrev_b32 v11, 4, v1
    v_min_u32 v11, 2, v11
    v_lshlrev_b32 v21, 3, v20
    v_lshl_add_u32 v12, v11, 7, v21
    v_add_u32 v12, 156032, v12
    v_lshl_add_u32 v11, v11, 16, v21
    v_mov_b32 v10, 159496
    s_add_u32 s3, s9, 1
    v_mov_b32 v13, s3
    s_mov_b32 s3, 0x100000
poll_11:
    s_load_dwordx8 s[88:95], s[96:97], 0 glc
    s_sub_u32 s3, s3, 1
    s_cbranch_scc1 poll_11_ok
    s_waitcnt lgkmcnt(0)
    s_xor_b64 s[100:101], s[88:89], s[98:99]
    s_xor_b64 s[88:89], s[90:91], s[98:99]
    s_or_b64 s[100:101], s[100:101], s[88:89]
    s_xor_b64 s[88:89], s[92:93], s[98:99]
    s_or_b64 s[100:101], s[100:101], s[88:89]
    s_xor_b64 s[88:89], s[94:95], s[98:99]
    s_or_b64 s[100:101], s[100:101], s[88:89]
    s_cbranch_scc1 poll_11
poll_11_ok:
    s_waitcnt lgkmcnt(0)
    ds_write_b32 v10, v13
    s_barrier
    s_lshl_b32 s56, s7, 12
    s_and_b32 s57, s6, 1
    s_lshl_b32 s57, s57, 7
    s_add_u32 s56, s56, s57
    s_add_u32 s56, s56, 64159744
    s_and_b32 s58, s6, 14
    s_lshl_b32 s58, s58, 18
    s_lshl_b32 s57, s9, 22
    s_add_u32 s58, s58, s57
    s_and_b32 s57, s7, 3
    s_lshl_b32 s57, s57, 11
    s_add_u32 s58, s58, s57
    s_barrier
    s_barrier
    s_barrier
    buffer_load_dwordx2 v[32:33], v11, s[12:15], s56 offen offset:0 sc1
    buffer_load_dwordx2 v[34:35], v11, s[12:15], s56 offen offset:256 sc1
    buffer_load_dwordx2 v[36:37], v11, s[12:15], s56 offen offset:512 sc1
    buffer_load_dwordx2 v[38:39], v11, s[12:15], s56 offen offset:768 sc1
    buffer_load_dwordx2 v[40:41], v11, s[12:15], s56 offen offset:1024 sc1
    buffer_load_dwordx2 v[42:43], v11, s[12:15], s56 offen offset:1280 sc1
    buffer_load_dwordx2 v[44:45], v11, s[12:15], s56 offen offset:1536 sc1
    buffer_load_dwordx2 v[46:47], v11, s[12:15], s56 offen offset:1792 sc1
    buffer_load_dwordx2 v[48:49], v11, s[12:15], s56 offen offset:2048 sc1
    buffer_load_dwordx2 v[50:51], v11, s[12:15], s56 offen offset:2304 sc1
    buffer_load_dwordx2 v[52:53], v11, s[12:15], s56 offen offset:2560 sc1
    buffer_load_dwordx2 v[54:55], v11, s[12:15], s56 offen offset:2816 sc1
    s_barrier
    buffer_load_dwordx2 v[56:57], v11, s[12:15], s56 offen offset:3072 sc1
    buffer_load_dwordx2 v[58:59], v11, s[12:15], s56 offen offset:3328 sc1
    buffer_load_dwordx2 v[60:61], v11, s[12:15], s56 offen offset:3584 sc1
    buffer_load_dwordx2 v[62:63], v11, s[12:15], s56 offen offset:3840 sc1
    s_barrier
    s_waitcnt vmcnt(0)
    v_add_f32 v32, v32, v48
    v_add_f32 v33, v33, v49
    v_add_f32 v34, v34, v50
    v_add_f32 v35, v35, v51
    v_add_f32 v36, v36, v52
    v_add_f32 v37, v37, v53
    v_add_f32 v38, v38, v54
    v_add_f32 v39, v39, v55
    v_add_f32 v40, v40, v56
    v_add_f32 v41, v41, v57
    v_add_f32 v42, v42, v58
    v_add_f32 v43, v43, v59
    s_barrier
    v_add_f32 v44, v44, v60
    v_add_f32 v45, v45, v61
    v_add_f32 v46, v46, v62
    v_add_f32 v47, v47, v63
    v_add_f32 v32, v32, v40
    v_add_f32 v33, v33, v41
    v_add_f32 v34, v34, v42
    v_add_f32 v35, v35, v43
    v_add_f32 v36, v36, v44
    v_add_f32 v37, v37, v45
    v_add_f32 v38, v38, v46
    v_add_f32 v39, v39, v47
    s_barrier
    v_add_f32 v32, v32, v36
    v_add_f32 v33, v33, v37
    v_add_f32 v34, v34, v38
    v_add_f32 v35, v35, v39
    v_add_f32 v32, v32, v34
    v_add_f32 v33, v33, v35
    ds_write_b64 v12, v[32:33]
    s_waitcnt lgkmcnt(0)
    s_barrier
    s_barrier
    s_branch s_attn
.p2align 6
l_first:
    s_sub_u32 s51, s8, 5
    s_lshl_b32 s61, s51, 8
    s_add_u32 s61, s61, s2
    s_and_b32 s62, s61, 15
    s_lshr_b32 s63, s61, 4
    v_lshrrev_b32 v20, 3, v1
    v_mul_u32_u24 v12, 6144, v20
    v_and_b32 v21, 7, v1
    v_lshl_add_u32 v12, v21, 4, v12
    s_mov_b32 s20, s34
    s_mov_b32 s21, s35
    s_mov_b32 s22, 6291456
    s_mov_b32 s23, 0x00020000
    s_mov_b32 s28, s40
    s_mov_b32 s29, s41
    s_mov_b32 s30, 6291456
    s_mov_b32 s31, 0x00020000
    s_mul_i32 s52, s62, 393216
    s_lshl_b32 s56, s63, 7
    s_add_u32 s52, s52, s56
    s_barrier
    s_add_u32 s53, s52, 0
    buffer_load_dwordx4 v[136:139], v12, s[20:23], s53 offen nt
    s_add_u32 s53, s52, 49152
    buffer_load_dwordx4 v[140:143], v12, s[20:23], s53 offen nt
    s_add_u32 s53, s52, 98304
    buffer_load_dwordx4 v[144:147], v12, s[20:23], s53 offen nt
    s_add_u32 s53, s52, 147456
    buffer_load_dwordx4 v[148:151], v12, s[20:23], s53 offen nt
    v_lshlrev_b32 v14, 6, v20
    v_lshrrev_b32 v22, 5, v1
    v_bfe_u32 v23, v1, 1, 1
    v_xor_b32 v22, v22, v23
    v_lshl_add_u32 v14, v22, 5, v14
    v_and_b32 v22, 1, v1
    v_lshl_add_u32 v14, v22, 4, v14
    v_bfe_u32 v23, v1, 2, 1
    v_mul_u32_u24 v23, 196608, v23
    v_add_u32 v14, v14, v23
    v_lshlrev_b32 v22, 4, v22
    v_mov_b32 v23, 0x3f80
    v_lshlrev_b32 v23, v22, v23
    v_bfe_u32 v22, v1, 1, 3
    v_cmp_eq_u32 vcc, 0, v22
    s_nop 1
    v_cndmask_b32 v24, 0, v23, vcc
    v_cmp_eq_u32 vcc, 1, v22
    s_nop 1
    v_cndmask_b32 v25, 0, v23, vcc
    v_cmp_eq_u32 vcc, 2, v22
    s_nop 1
    v_cndmask_b32 v26, 0, v23, vcc
    v_cmp_eq_u32 vcc, 3, v22
    s_nop 1
    v_cndmask_b32 v27, 0, v23, vcc
    v_lshlrev_b32 v15, 5, v21
    v_and_b32 v22, 16, v1
    v_add_u32 v15, v15, v22
    v_lshlrev_b32 v16, 14, v1
    s_mov_b32 s9, 0
    s_lshr_b32 s55, s63, 4
    s_and_b32 s56, s63, 15
    s_mul_i32 s57, s56, 6
    s_add_u32 s57, s57, s55
    s_lshl_b32 s57, s57, 16
    s_lshl_b32 s58, s62, 12
    s_add_u32 s57, s57, s58
    s_add_u32 s57, s57, 50331648
    s_lshl_b32 s54, s61, 8
    s_add_u32 s54, s54, 63963136
    s_lshl_b32 s56, s56, 10
    s_lshl_b32 s55, s55, 7
    s_add_u32 s55, s55, s56
    s_lshl_b32 s56, s62, 2
    s_add_u32 s55, s55, s56
    s_add_u32 s55, s55, 64487424
    s_waitcnt vmcnt(3)
    s_add_u32 s53, s52, 196608
    buffer_load_dwordx4 v[152:155], v12, s[20:23], s53 offen nt
    s_add_u32 s53, s52, 245760
    buffer_load_dwordx4 v[156:159], v12, s[20:23], s53 offen nt
    s_add_u32 s53, s52, 294912
    buffer_load_dwordx4 v[160:163], v12, s[20:23], s53 offen nt
    buffer_store_dwordx4 v[136:139], v14, s[12:15], s57 offen offset:0 sc1
    v_mfma_f32_16x16x32_bf16 v[28:31], v[24:27], v[136:139], 0
    s_barrier
    s_waitcnt vmcnt(6)
    s_add_u32 s53, s52, 344064
    buffer_load_dwordx4 v[164:167], v12, s[20:23], s53 offen nt
    buffer_store_dwordx4 v[140:143], v14, s[12:15], s57 offen offset:512 sc1
    v_mfma_f32_16x16x32_bf16 v[28:31], v[24:27], v[140:143], v[28:31]
    s_waitcnt vmcnt(7)
    buffer_store_dwordx4 v[144:147], v14, s[12:15], s57 offen offset:1024 sc1
    v_mfma_f32_16x16x32_bf16 v[28:31], v[24:27], v[144:147], v[28:31]
    s_waitcnt vmcnt(7)
    buffer_store_dwordx4 v[148:151], v14, s[12:15], s57 offen offset:1536 sc1
    v_mfma_f32_16x16x32_bf16 v[28:31], v[24:27], v[148:151], v[28:31]
    s_waitcnt vmcnt(7)
    buffer_store_dwordx4 v[152:155], v14, s[12:15], s57 offen offset:2048 sc1
    v_mfma_f32_16x16x32_bf16 v[28:31], v[24:27], v[152:155], v[28:31]
    s_waitcnt vmcnt(7)
    buffer_store_dwordx4 v[156:159], v14, s[12:15], s57 offen offset:2560 sc1
    v_mfma_f32_16x16x32_bf16 v[28:31], v[24:27], v[156:159], v[28:31]
    s_waitcnt vmcnt(7)
    buffer_store_dwordx4 v[160:163], v14, s[12:15], s57 offen offset:3072 sc1
    v_mfma_f32_16x16x32_bf16 v[28:31], v[24:27], v[160:163], v[28:31]
    s_waitcnt vmcnt(6)
    buffer_store_dwordx4 v[164:167], v14, s[12:15], s57 offen offset:3584 sc1
    v_mfma_f32_16x16x32_bf16 v[28:31], v[24:27], v[164:167], v[28:31]
    s_nop 7
    v_add_f32_dpp v28, v28, v28 row_ror:8 row_mask:0xf bank_mask:0xf
    v_add_f32_dpp v29, v29, v29 row_ror:8 row_mask:0xf bank_mask:0xf
    v_add_f32_dpp v30, v30, v30 row_ror:8 row_mask:0xf bank_mask:0xf
    v_add_f32_dpp v31, v31, v31 row_ror:8 row_mask:0xf bank_mask:0xf
    s_mov_b64 exec, 0x00ff00ff
    buffer_store_dwordx4 v[28:31], v15, s[12:15], s54 offen sc1
    s_mov_b64 exec, -1
    s_add_u32 s57, s57, 6291456
    s_add_u32 s54, s54, 196608
    s_add_u32 s53, s52, 0
    buffer_load_dwordx4 v[168:171], v12, s[28:31], s53 offen nt
    s_add_u32 s53, s52, 49152
    buffer_load_dwordx4 v[172:175], v12, s[28:31], s53 offen nt
    s_add_u32 s53, s52, 98304
    buffer_load_dwordx4 v[176:179], v12, s[28:31], s53 offen nt
    s_add_u32 s53, s52, 147456
    buffer_load_dwordx4 v[180:183], v12, s[28:31], s53 offen nt
    s_add_u32 s53, s52, 196608
    buffer_load_dwordx4 v[184:187], v12, s[28:31], s53 offen nt
    s_add_u32 s53, s52, 245760
    buffer_load_dwordx4 v[188:191], v12, s[28:31], s53 offen nt
    s_add_u32 s53, s52, 294912
    buffer_load_dwordx4 v[192:195], v12, s[28:31], s53 offen nt
    s_add_u32 s53, s52, 344064
    buffer_load_dwordx4 v[196:199], v12, s[28:31], s53 offen nt
    v_mov_b32 v8, 159492
non_12:
    ds_read_b32 v9, v8
    s_waitcnt lgkmcnt(0)
    v_readfirstlane_b32 s10, v9
    s_cmp_eq_u32 s10, 0
    s_cbranch_scc1 non_12
    s_mov_b64 exec, 0xffff
    s_waitcnt vmcnt(8)
    buffer_store_dword v9, v16, s[12:15], s55 offen offset:0 sc1
    s_mov_b64 exec, -1
    s_mov_b32 s58, s52
    s_lshr_b32 s60, s2, 3
    s_mul_i32 s60, s60, 3
    s_lshr_b32 s60, s60, 5
    s_add_u32 s60, s60, 1
    s_branch l_qkv2
l_qkv:
    s_mov_b32 s60, 0
l_qkv2:
    v_and_b32 v1, 63, v0
    v_lshlrev_b32 v5, 4, v1
    s_sub_u32 s51, s8, 5
    s_lshl_b32 s48, s51, 13
    s_and_b32 s53, s9, 1
    s_lshl_b32 s52, s53, 4
    s_add_u32 s49, s7, s52
    s_lshl_b32 s49, s49, 1
    s_and_b32 s52, s6, 1
    s_add_u32 s49, s49, s52
    s_mul_i32 s49, s49, 3
    s_add_u32 s49, s49, s51
    s_lshl_b32 s49, s49, 16
    s_add_u32 s49, s49, 50331648
    v_mov_b32 v13, 159496
    s_cmp_lg_u32 s9, 0
    s_cbranch_scc1 l_qkv_tiled
    s_lshl_b32 s53, s8, 7
    s_lshl_b32 s52, s11, 10
    s_add_u32 s53, s53, s52
    s_add_u32 s53, s53, 64486784
    s_add_u32 s96, s4, s53
    s_addc_u32 s97, s5, 0
    s_mov_b32 s98, s10
    s_mov_b32 s99, s10
    s_mov_b32 s3, 0x100000
poll_13:
    s_load_dwordx16 s[80:95], s[96:97], 0 glc
    s_sub_u32 s3, s3, 1
    s_cbranch_scc1 poll_13_ok
    s_waitcnt lgkmcnt(0)
    s_xor_b64 s[100:101], s[80:81], s[98:99]
    s_xor_b64 s[80:81], s[82:83], s[98:99]
    s_or_b64 s[100:101], s[100:101], s[80:81]
    s_xor_b64 s[80:81], s[84:85], s[98:99]
    s_or_b64 s[100:101], s[100:101], s[80:81]
    s_xor_b64 s[80:81], s[86:87], s[98:99]
    s_or_b64 s[100:101], s[100:101], s[80:81]
    s_xor_b64 s[80:81], s[88:89], s[98:99]
    s_or_b64 s[100:101], s[100:101], s[80:81]
    s_xor_b64 s[80:81], s[90:91], s[98:99]
    s_or_b64 s[100:101], s[100:101], s[80:81]
    s_xor_b64 s[80:81], s[92:93], s[98:99]
    s_or_b64 s[100:101], s[100:101], s[80:81]
    s_xor_b64 s[80:81], s[94:95], s[98:99]
    s_or_b64 s[100:101], s[100:101], s[80:81]
    s_cbranch_scc1 poll_13
poll_13_ok:
    s_waitcnt lgkmcnt(0)
l_qkv_tiled:
    s_mov_b32 s50, 0
    s_mov_b32 m0, s48
    s_add_u32 s50, s50, 1
    buffer_load_dwordx4 v5, s[12:15], s49 offen offset:0 sc1 lds
    buffer_load_dwordx4 v5, s[12:15], s49 offen offset:1024 sc1 lds
    buffer_load_dwordx4 v5, s[12:15], s49 offen offset:2048 sc1 lds
    buffer_load_dwordx4 v5, s[12:15], s49 offen offset:3072 sc1 lds
    s_add_u32 s49, s49, 4096
    s_bitcmp1_b32 s50, 0
    s_cselect_b32 s3, 0, 16384
    s_add_u32 s48, s48, s3
    s_cmp_eq_u32 s50, 12
    s_cselect_b32 s3, 4294819840, 0
    s_add_u32 s48, s48, 4096
    s_add_u32 s48, s48, s3
    s_mov_b32 m0, s48
    s_add_u32 s50, s50, 1
    buffer_load_dwordx4 v5, s[12:15], s49 offen offset:0 sc1 lds
    buffer_load_dwordx4 v5, s[12:15], s49 offen offset:1024 sc1 lds
    buffer_load_dwordx4 v5, s[12:15], s49 offen offset:2048 sc1 lds
    buffer_load_dwordx4 v5, s[12:15], s49 offen offset:3072 sc1 lds
    s_add_u32 s49, s49, 4096
    s_bitcmp1_b32 s50, 0
    s_cselect_b32 s3, 0, 16384
    s_add_u32 s48, s48, s3
    s_cmp_eq_u32 s50, 12
    s_cselect_b32 s3, 4294819840, 0
    s_add_u32 s48, s48, 4096
    s_add_u32 s48, s48, s3
    v_lshrrev_b32 v10, 4, v1
    v_and_b32 v11, 0xff, v5
    v_lshl_add_u32 v10, v10, 12, v11
    s_lshl_b32 s3, s51, 9
    s_add_u32 s3, s3, 155648
    v_lshl_add_u32 v11, v1, 3, s3
    s_and_b32 s59, s6, 14
    s_add_u32 s59, s59, s51
    s_sub_u32 s59, s59, 1
    s_max_i32 s59, s59, 0
    s_lshl_b32 s59, s59, 14
    s_lshl_b32 s3, s9, 18
    s_add_u32 s59, s59, s3
    s_add_u32 s59, s59, 62914560
    s_and_b32 s3, s9, 1
    s_lshl_b32 s3, s3, 3
    s_add_u32 s3, s3, 56
    s_cmp_lt_u32 s6, 2
    s_cselect_b32 s3, 64, s3
    s_cmp_eq_u32 s51, 0
    s_cselect_b32 s3, s3, 0
    v_cmp_gt_u32 vcc, s3, v1
    v_mov_b32 v20, 0x7ff00000
    s_nop 0
    v_cndmask_b32 v10, v10, v20, vcc
    s_lshl_b32 s3, s7, 7
    v_lshrrev_b32 v20, 3, v1
    v_lshlrev_b32 v21, 11, v20
    v_lshrrev_b32 v22, 2, v1
    v_lshrrev_b32 v23, 4, v1
    v_xor_b32 v22, v22, v23
    v_and_b32 v22, 1, v22
    v_lshl_add_u32 v21, v22, 6, v21
    v_and_b32 v22, 3, v1
    v_lshl_add_u32 v21, v22, 4, v21
    v_add_u32 v17, s3, v21
    s_add_u32 s52, s9, 1
    s_mov_b32 m0, s48
    s_add_u32 s50, s50, 1
    buffer_load_dwordx4 v5, s[12:15], s49 offen offset:0 sc1 lds
    s_waitcnt vmcnt(10)
    buffer_load_dwordx4 v5, s[12:15], s49 offen offset:1024 sc1 lds
    s_waitcnt vmcnt(10)
    buffer_load_dwordx4 v5, s[12:15], s49 offen offset:2048 sc1 lds
    s_waitcnt vmcnt(10)
    buffer_load_dwordx4 v5, s[12:15], s49 offen offset:3072 sc1 lds
    s_waitcnt vmcnt(10)
    s_add_u32 s49, s49, 4096
    s_bitcmp1_b32 s50, 0
    s_cselect_b32 s3, 0, 16384
    s_add_u32 s48, s48, s3
    s_cmp_eq_u32 s50, 12
    s_cselect_b32 s3, 4294819840, 0
    s_add_u32 s48, s48, 4096
    s_add_u32 s48, s48, s3
l_qkv_pre:
    s_mov_b32 m0, s48
    s_add_u32 s50, s50, 1
    buffer_load_dwordx4 v5, s[12:15], s49 offen offset:0 sc1 lds
    s_waitcnt vmcnt(10)
    buffer_load_dwordx4 v5, s[12:15], s49 offen offset:1024 sc1 lds
    s_waitcnt vmcnt(10)
    buffer_load_dwordx4 v5, s[12:15], s49 offen offset:2048 sc1 lds
    s_waitcnt vmcnt(10)
    buffer_load_dwordx4 v5, s[12:15], s49 offen offset:3072 sc1 lds
    s_waitcnt vmcnt(10)
    s_add_u32 s49, s49, 4096
    s_bitcmp1_b32 s50, 0
    s_cselect_b32 s3, 0, 16384
    s_add_u32 s48, s48, s3
    s_cmp_eq_u32 s50, 12
    s_cselect_b32 s3, 4294819840, 0
    s_add_u32 s48, s48, 4096
    s_add_u32 s48, s48, s3
    ds_read_b32 v8, v13
    s_cmp_ge_u32 s50, 12
    s_cbranch_scc1 l_qkv_go
    s_waitcnt lgkmcnt(0)
    v_readfirstlane_b32 s3, v8
    s_cmp_lg_u32 s3, s52
    s_cbranch_scc1 l_qkv_pre
    s_cmp_ge_u32 s50, 5
    s_cbranch_scc1 l_qkv_go
    s_waitcnt vmcnt(8)
l_qkv_go:
    s_waitcnt lgkmcnt(0)
    s_barrier
    s_barrier
    s_bitcmp0_b32 s50, 0
    s_cbranch_scc1 l_qkv_even
    s_mov_b32 m0, s48
    s_add_u32 s50, s50, 1
    buffer_load_dwordx4 v5, s[12:15], s49 offen offset:0 sc1 lds
    buffer_load_dwordx4 v5, s[12:15], s49 offen offset:1024 sc1 lds
    buffer_load_dwordx4 v5, s[12:15], s49 offen offset:2048 sc1 lds
    buffer_load_dwordx4 v5, s[12:15], s49 offen offset:3072 sc1 lds
    s_add_u32 s49, s49, 4096
    s_bitcmp1_b32 s50, 0
    s_cselect_b32 s3, 0, 16384
    s_add_u32 s48, s48, s3
    s_cmp_eq_u32 s50, 12
    s_cselect_b32 s3, 4294819840, 0
    s_add_u32 s48, s48, 4096
    s_add_u32 s48, s48, s3
l_qkv_even:
    s_cmp_gt_u32 s50, 10
    s_cbranch_scc1 stg_14
    s_mov_b32 m0, s48
    s_add_u32 s50, s50, 1
    buffer_load_dwordx4 v5, s[12:15], s49 offen offset:0 sc1 lds
    buffer_load_dwordx4 v5, s[12:15], s49 offen offset:1024 sc1 lds
    buffer_load_dwordx4 v5, s[12:15], s49 offen offset:2048 sc1 lds
    buffer_load_dwordx4 v5, s[12:15], s49 offen offset:3072 sc1 lds
    s_add_u32 s49, s49, 4096
    s_bitcmp1_b32 s50, 0
    s_cselect_b32 s3, 0, 16384
    s_add_u32 s48, s48, s3
    s_cmp_eq_u32 s50, 12
    s_cselect_b32 s3, 4294819840, 0
    s_add_u32 s48, s48, 4096
    s_add_u32 s48, s48, s3
    s_mov_b32 m0, s48
    s_add_u32 s50, s50, 1
    buffer_load_dwordx4 v5, s[12:15], s49 offen offset:0 sc1 lds
    buffer_load_dwordx4 v5, s[12:15], s49 offen offset:1024 sc1 lds
    buffer_load_dwordx4 v5, s[12:15], s49 offen offset:2048 sc1 lds
    buffer_load_dwordx4 v5, s[12:15], s49 offen offset:3072 sc1 lds
    s_add_u32 s49, s49, 4096
    s_bitcmp1_b32 s50, 0
    s_cselect_b32 s3, 0, 16384
    s_add_u32 s48, s48, s3
    s_cmp_eq_u32 s50, 12
    s_cselect_b32 s3, 4294819840, 0
    s_add_u32 s48, s48, 4096
    s_add_u32 s48, s48, s3
stg_14:
    s_waitcnt vmcnt(8)
    s_barrier
    s_cmp_gt_u32 s50, 12
    s_cbranch_scc1 stg_15
    s_mov_b32 m0, s48
    s_add_u32 s50, s50, 1
    buffer_load_dwordx4 v5, s[12:15], s49 offen offset:0 sc1 lds
    buffer_load_dwordx4 v5, s[12:15], s49 offen offset:1024 sc1 lds
    buffer_load_dwordx4 v5, s[12:15], s49 offen offset:2048 sc1 lds
    buffer_load_dwordx4 v5, s[12:15], s49 offen offset:3072 sc1 lds
    s_add_u32 s49, s49, 4096
    s_bitcmp1_b32 s50, 0
    s_cselect_b32 s3, 0, 16384
    s_add_u32 s48, s48, s3
    s_cmp_eq_u32 s50, 12
    s_cselect_b32 s3, 4294819840, 0
    s_add_u32 s48, s48, 4096
    s_add_u32 s48, s48, s3
    s_mov_b32 m0, s48
    s_add_u32 s50, s50, 1
    buffer_load_dwordx4 v5, s[12:15], s49 offen offset:0 sc1 lds
    buffer_load_dwordx4 v5, s[12:15], s49 offen offset:1024 sc1 lds
    buffer_load_dwordx4 v5, s[12:15], s49 offen offset:2048 sc1 lds
    buffer_load_dwordx4 v5, s[12:15], s49 offen offset:3072 sc1 lds
    s_add_u32 s49, s49, 4096
    s_bitcmp1_b32 s50, 0
    s_cselect_b32 s3, 0, 16384
    s_add_u32 s48, s48, s3
    s_cmp_eq_u32 s50, 12
    s_cselect_b32 s3, 4294819840, 0
    s_add_u32 s48, s48, 4096
    s_add_u32 s48, s48, s3
stg_15:
    s_cmp_eq_u32 s60, 0
    s_cbranch_scc1 ub_16
    buffer_store_dwordx4 v[168:171], v14, s[12:15], s57 offen offset:0 sc1
    v_mfma_f32_16x16x32_bf16 v[28:31], v[24:27], v[168:171], 0
    buffer_store_dwordx4 v[172:175], v14, s[12:15], s57 offen offset:512 sc1
    v_mfma_f32_16x16x32_bf16 v[28:31], v[24:27], v[172:175], v[28:31]
ub_16:
    s_waitcnt vmcnt(8)
    s_barrier
    s_cmp_gt_u32 s50, 14
    s_cbranch_scc1 stg_17
    s_mov_b32 m0, s48
    s_add_u32 s50, s50, 1
    buffer_load_dwordx4 v5, s[12:15], s49 offen offset:0 sc1 lds
    buffer_load_dwordx4 v5, s[12:15], s49 offen offset:1024 sc1 lds
    buffer_load_dwordx4 v5, s[12:15], s49 offen offset:2048 sc1 lds
    buffer_load_dwordx4 v5, s[12:15], s49 offen offset:3072 sc1 lds
    s_add_u32 s49, s49, 4096
    s_bitcmp1_b32 s50, 0
    s_cselect_b32 s3, 0, 16384
    s_add_u32 s48, s48, s3
    s_cmp_eq_u32 s50, 12
    s_cselect_b32 s3, 4294819840, 0
    s_add_u32 s48, s48, 4096
    s_add_u32 s48, s48, s3
    s_mov_b32 m0, s48
    s_add_u32 s50, s50, 1
    buffer_load_dwordx4 v5, s[12:15], s49 offen offset:0 sc1 lds
    buffer_load_dwordx4 v5, s[12:15], s49 offen offset:1024 sc1 lds
    buffer_load_dwordx4 v5, s[12:15], s49 offen offset:2048 sc1 lds
    buffer_load_dwordx4 v5, s[12:15], s49 offen offset:3072 sc1 lds
    s_add_u32 s49, s49, 4096
    s_bitcmp1_b32 s50, 0
    s_cselect_b32 s3, 0, 16384
    s_add_u32 s48, s48, s3
    s_cmp_eq_u32 s50, 12
    s_cselect_b32 s3, 4294819840, 0
    s_add_u32 s48, s48, 4096
    s_add_u32 s48, s48, s3
stg_17:
    s_cmp_eq_u32 s60, 0
    s_cbranch_scc1 ub_18
    buffer_store_dwordx4 v[176:179], v14, s[12:15], s57 offen offset:1024 sc1
    v_mfma_f32_16x16x32_bf16 v[28:31], v[24:27], v[176:179], v[28:31]
    buffer_store_dwordx4 v[180:183], v14, s[12:15], s57 offen offset:1536 sc1
    v_mfma_f32_16x16x32_bf16 v[28:31], v[24:27], v[180:183], v[28:31]
ub_18:
    s_waitcnt vmcnt(8)
    s_barrier
    s_cmp_gt_u32 s50, 14
    s_cbranch_scc1 stg_19
    s_mov_b32 m0, s48
    s_add_u32 s50, s50, 1
    buffer_load_dwordx4 v5, s[12:15], s49 offen offset:0 sc1 lds
    buffer_load_dwordx4 v5, s[12:15], s49 offen offset:1024 sc1 lds
    buffer_load_dwordx4 v5, s[12:15], s49 offen offset:2048 sc1 lds
    buffer_load_dwordx4 v5, s[12:15], s49 offen offset:3072 sc1 lds
    s_add_u32 s49, s49, 4096
    s_bitcmp1_b32 s50, 0
    s_cselect_b32 s3, 0, 16384
    s_add_u32 s48, s48, s3
    s_cmp_eq_u32 s50, 12
    s_cselect_b32 s3, 4294819840, 0
    s_add_u32 s48, s48, 4096
    s_add_u32 s48, s48, s3
    s_mov_b32 m0, s48
    s_add_u32 s50, s50, 1
    buffer_load_dwordx4 v5, s[12:15], s49 offen offset:0 sc1 lds
    buffer_load_dwordx4 v5, s[12:15], s49 offen offset:1024 sc1 lds
    buffer_load_dwordx4 v5, s[12:15], s49 offen offset:2048 sc1 lds
    buffer_load_dwordx4 v5, s[12:15], s49 offen offset:3072 sc1 lds
    s_add_u32 s49, s49, 4096
    s_bitcmp1_b32 s50, 0
    s_cselect_b32 s3, 0, 16384
    s_add_u32 s48, s48, s3
    s_cmp_eq_u32 s50, 12
    s_cselect_b32 s3, 4294819840, 0
    s_add_u32 s48, s48, 4096
    s_add_u32 s48, s48, s3
stg_19:
    s_cmp_eq_u32 s60, 0
    s_cbranch_scc1 ub_20
    buffer_store_dwordx4 v[184:187], v14, s[12:15], s57 offen offset:2048 sc1
    v_mfma_f32_16x16x32_bf16 v[28:31], v[24:27], v[184:187], v[28:31]
    buffer_store_dwordx4 v[188:191], v14, s[12:15], s57 offen offset:2560 sc1
    v_mfma_f32_16x16x32_bf16 v[28:31], v[24:27], v[188:191], v[28:31]
ub_20:
    buffer_load_dwordx4 v[72:75], v10, s[12:15], s59 offen offset:0 sc1
    buffer_load_dwordx4 v[76:79], v10, s[12:15], s59 offen offset:256 sc1
    buffer_load_dwordx4 v[80:83], v10, s[12:15], s59 offen offset:512 sc1
    buffer_load_dwordx4 v[84:87], v10, s[12:15], s59 offen offset:768 sc1
    buffer_load_dwordx4 v[88:91], v10, s[12:15], s59 offen offset:1024 sc1
    s_waitcnt vmcnt(8)
    s_barrier
    s_waitcnt vmcnt(0)
    s_cmp_gt_u32 s50, 14
    s_cbranch_scc1 stg_21
    s_mov_b32 m0, s48
    s_add_u32 s50, s50, 1
    buffer_load_dwordx4 v5, s[12:15], s49 offen offset:0 sc1 lds
    buffer_load_dwordx4 v5, s[12:15], s49 offen offset:1024 sc1 lds
    buffer_load_dwordx4 v5, s[12:15], s49 offen offset:2048 sc1 lds
    buffer_load_dwordx4 v5, s[12:15], s49 offen offset:3072 sc1 lds
    s_add_u32 s49, s49, 4096
    s_bitcmp1_b32 s50, 0
    s_cselect_b32 s3, 0, 16384
    s_add_u32 s48, s48, s3
    s_cmp_eq_u32 s50, 12
    s_cselect_b32 s3, 4294819840, 0
    s_add_u32 s48, s48, 4096
    s_add_u32 s48, s48, s3
    s_mov_b32 m0, s48
    s_add_u32 s50, s50, 1
    buffer_load_dwordx4 v5, s[12:15], s49 offen offset:0 sc1 lds
    buffer_load_dwordx4 v5, s[12:15], s49 offen offset:1024 sc1 lds
    buffer_load_dwordx4 v5, s[12:15], s49 offen offset:2048 sc1 lds
    buffer_load_dwordx4 v5, s[12:15], s49 offen offset:3072 sc1 lds
    s_add_u32 s49, s49, 4096
    s_bitcmp1_b32 s50, 0
    s_cselect_b32 s3, 0, 16384
    s_add_u32 s48, s48, s3
    s_cmp_eq_u32 s50, 12
    s_cselect_b32 s3, 4294819840, 0
    s_add_u32 s48, s48, 4096
    s_add_u32 s48, s48, s3
stg_21:
    s_cmp_eq_u32 s60, 0
    s_cbranch_scc1 ub_22
    buffer_store_dwordx4 v[192:195], v14, s[12:15], s57 offen offset:3072 sc1
    v_mfma_f32_16x16x32_bf16 v[28:31], v[24:27], v[192:195], v[28:31]
    buffer_store_dwordx4 v[196:199], v14, s[12:15], s57 offen offset:3584 sc1
    v_mfma_f32_16x16x32_bf16 v[28:31], v[24:27], v[196:199], v[28:31]
ub_22:
    buffer_load_dwordx4 v[92:95], v10, s[12:15], s59 offen offset:1280 sc1
    buffer_load_dwordx4 v[96:99], v10, s[12:15], s59 offen offset:1536 sc1
    buffer_load_dwordx4 v[100:103], v10, s[12:15], s59 offen offset:1792 sc1
    buffer_load_dwordx4 v[104:107], v10, s[12:15], s59 offen offset:2048 sc1
    buffer_load_dwordx4 v[108:111], v10, s[12:15], s59 offen offset:2304 sc1
    v_add_f32 v72, v72, v76
    v_add_f32 v73, v73, v77
    v_add_f32 v74, v74, v78
    v_add_f32 v75, v75, v79
    v_add_f32 v72, v72, v80
    v_add_f32 v73, v73, v81
    v_add_f32 v74, v74, v82
    v_add_f32 v75, v75, v83
    v_add_f32 v72, v72, v84
    v_add_f32 v73, v73, v85
    v_add_f32 v74, v74, v86
    v_add_f32 v75, v75, v87
    v_add_f32 v72, v72, v88
    v_add_f32 v73, v73, v89
    v_add_f32 v74, v74, v90
    v_add_f32 v75, v75, v91
    s_waitcnt vmcnt(8)
    s_barrier
    s_waitcnt vmcnt(0)
    s_cmp_gt_u32 s50, 14
    s_cbranch_scc1 stg_23
    s_mov_b32 m0, s48
    s_add_u32 s50, s50, 1
    buffer_load_dwordx4 v5, s[12:15], s49 offen offset:0 sc1 lds
    buffer_load_dwordx4 v5, s[12:15], s49 offen offset:1024 sc1 lds
    buffer_load_dwordx4 v5, s[12:15], s49 offen offset:2048 sc1 lds
    buffer_load_dwordx4 v5, s[12:15], s49 offen offset:3072 sc1 lds
    s_add_u32 s49, s49, 4096
    s_bitcmp1_b32 s50, 0
    s_cselect_b32 s3, 0, 16384
    s_add_u32 s48, s48, s3
    s_cmp_eq_u32 s50, 12
    s_cselect_b32 s3, 4294819840, 0
    s_add_u32 s48, s48, 4096
    s_add_u32 s48, s48, s3
    s_mov_b32 m0, s48
    s_add_u32 s50, s50, 1
    buffer_load_dwordx4 v5, s[12:15], s49 offen offset:0 sc1 lds
    buffer_load_dwordx4 v5, s[12:15], s49 offen offset:1024 sc1 lds
    buffer_load_dwordx4 v5, s[12:15], s49 offen offset:2048 sc1 lds
    buffer_load_dwordx4 v5, s[12:15], s49 offen offset:3072 sc1 lds
    s_add_u32 s49, s49, 4096
    s_bitcmp1_b32 s50, 0
    s_cselect_b32 s3, 0, 16384
    s_add_u32 s48, s48, s3
    s_cmp_eq_u32 s50, 12
    s_cselect_b32 s3, 4294819840, 0
    s_add_u32 s48, s48, 4096
    s_add_u32 s48, s48, s3
stg_23:
    s_cmp_eq_u32 s60, 0
    s_cbranch_scc1 ub_24
    v_add_f32_dpp v28, v28, v28 row_ror:8 row_mask:0xf bank_mask:0xf
    v_add_f32_dpp v29, v29, v29 row_ror:8 row_mask:0xf bank_mask:0xf
    v_add_f32_dpp v30, v30, v30 row_ror:8 row_mask:0xf bank_mask:0xf
    v_add_f32_dpp v31, v31, v31 row_ror:8 row_mask:0xf bank_mask:0xf
    s_mov_b64 exec, 0x00ff00ff
    buffer_store_dwordx4 v[28:31], v15, s[12:15], s54 offen sc1
    s_mov_b64 exec, -1
ub_24:
    buffer_load_dwordx4 v[112:115], v10, s[12:15], s59 offen offset:2560 sc1
    buffer_load_dwordx4 v[116:119], v10, s[12:15], s59 offen offset:2816 sc1
    buffer_load_dwordx4 v[120:123], v10, s[12:15], s59 offen offset:3072 sc1
    buffer_load_dwordx4 v[124:127], v10, s[12:15], s59 offen offset:3328 sc1
    buffer_load_dwordx4 v[128:131], v10, s[12:15], s59 offen offset:3584 sc1
    buffer_load_dwordx4 v[132:135], v10, s[12:15], s59 offen offset:3840 sc1
    v_add_f32 v72, v72, v92
    v_add_f32 v73, v73, v93
    v_add_f32 v74, v74, v94
    v_add_f32 v75, v75, v95
    v_add_f32 v72, v72, v96
    v_add_f32 v73, v73, v97
    v_add_f32 v74, v74, v98
    v_add_f32 v75, v75, v99
    v_add_f32 v72, v72, v100
    v_add_f32 v73, v73, v101
    v_add_f32 v74, v74, v102
    v_add_f32 v75, v75, v103
    v_add_f32 v72, v72, v104
    v_add_f32 v73, v73, v105
    v_add_f32 v74, v74, v106
    v_add_f32 v75, v75, v107
    v_add_f32 v72, v72, v108
    v_add_f32 v73, v73, v109
    v_add_f32 v74, v74, v110
    v_add_f32 v75, v75, v111
    s_waitcnt vmcnt(8)
    s_barrier
    s_waitcnt vmcnt(0)
    v_add_f32 v72, v72, v112
    v_add_f32 v73, v73, v113
    v_add_f32 v74, v74, v114
    v_add_f32 v75, v75, v115
    v_add_f32 v72, v72, v116
    v_add_f32 v73, v73, v117
    v_add_f32 v74, v74, v118
    v_add_f32 v75, v75, v119
    v_add_f32 v72, v72, v120
    v_add_f32 v73, v73, v121
    v_add_f32 v74, v74, v122
    v_add_f32 v75, v75, v123
    v_add_f32 v72, v72, v124
    v_add_f32 v73, v73, v125
    v_add_f32 v74, v74, v126
    v_add_f32 v75, v75, v127
    v_add_f32 v72, v72, v128
    v_add_f32 v73, v73, v129
    v_add_f32 v74, v74, v130
    v_add_f32 v75, v75, v131
    v_add_f32 v72, v72, v132
    v_add_f32 v73, v73, v133
    v_add_f32 v74, v74, v134
    v_add_f32 v75, v75, v135
    v_mul_f32 v72, 0x3a800000, v72
    v_mul_f32 v74, 0x3a800000, v74
    v_mul_f32 v73, 0x3a800000, v73
    v_mul_f32 v75, 0x3a800000, v75
    v_fma_f32 v73, -v72, v72, v73
    v_fma_f32 v75, -v74, v74, v75
    v_max_f32 v73, 0, v73
    v_max_f32 v75, 0, v75
    v_add_f32 v73, 0x3727c5ac, v73
    v_add_f32 v75, 0x3727c5ac, v75
    v_rsq_f32 v73, v73
    v_rsq_f32 v75, v75
    v_swap_b32 v73, v74
    ds_write_b64 v11, v[72:73] offset:768
    ds_write_b64 v11, v[74:75] offset:2304
    s_waitcnt lgkmcnt(0)
    s_waitcnt vmcnt(0)
    s_barrier
    s_cmp_eq_u32 s60, 0
    s_cbranch_scc1 ub_25
    s_mov_b64 exec, 0xffff
    buffer_store_dword v9, v16, s[12:15], s55 offen offset:384 sc1
    s_mov_b64 exec, -1
ub_25:
    s_add_u32 s60, s51, 48
    s_bitcmp1_b32 s9, 0
    s_cbranch_scc1 l_qkv_now6
    s_mov_b32 s24, s36
    s_mov_b32 s25, s37
    s_mov_b32 s26, 2097152
    s_mov_b32 s27, 0x00020000
wop_26:
    s_lshl_b32 m0, s60, 10
    s_lshl_b32 s3, s60, 14
    buffer_load_dwordx4 v17, s[24:27], s3 offen lds
    s_add_u32 s60, s60, 3
    s_waitcnt vmcnt(7)
    s_cmp_lt_u32 s60, 96
    s_cbranch_scc1 wop_26
l_qkv_now6:
    s_barrier
    s_bitcmp1_b32 s9, 0
    s_cbranch_scc1 s_attn
    s_mov_b32 s24, s36
    s_mov_b32 s25, s37
    s_mov_b32 s26, 2097152
    s_mov_b32 s27, 0x00020000
wop_27:
    s_lshl_b32 m0, s60, 10
    s_lshl_b32 s3, s60, 14
    buffer_load_dwordx4 v17, s[24:27], s3 offen lds
    s_add_u32 s60, s60, 3
    s_waitcnt vmcnt(7)
    s_cmp_lt_u32 s60, 128
    s_cbranch_scc1 wop_27
    s_mov_b32 s60, s51
wop_28:
    s_lshl_b32 m0, s60, 10
    s_lshl_b32 s3, s60, 14
    buffer_load_dwordx4 v17, s[24:27], s3 offen lds
    s_add_u32 s60, s60, 3
    s_waitcnt vmcnt(7)
    s_cmp_lt_u32 s60, 12
    s_cbranch_scc1 wop_28
    s_barrier
wop_29:
    s_lshl_b32 m0, s60, 10
    s_lshl_b32 s3, s60, 14
    buffer_load_dwordx4 v17, s[24:27], s3 offen lds
    s_add_u32 s60, s60, 3
    s_waitcnt vmcnt(7)
    s_cmp_lt_u32 s60, 48
    s_cbranch_scc1 wop_29
    s_branch l_wo
.p2align 6
h_wo:
l_wo:
    s_mul_i32 s98, s9, 786432
    s_add_u32 s98, s98, 65798144
    s_lshl_b32 s99, s11, 10
    s_add_u32 s98, s98, s99
    s_add_u32 s96, s4, s98
    s_addc_u32 s97, s5, 0
    s_mov_b32 s98, s10
    s_mov_b32 s99, s10
    s_sub_u32 s59, s8, 4
    s_lshl_b32 s60, s59, 7
    s_add_u32 s96, s96, s60
    s_addc_u32 s97, s97, 0
    s_lshl_b32 s60, s9, 2
    s_add_u32 s60, s60, 159504
    v_mov_b32 v10, s60
    s_lshl_b32 s60, 1, s59
    v_mov_b32 v11, s60
    v_lshlrev_b32 v13, 4, v11
    s_mov_b64 exec, 1
    s_waitcnt vmcnt(0)
    ds_or_b32 v10, v13
    s_mov_b32 s3, 0x100000
poll_30:
    s_load_dwordx8 s[88:95], s[96:97], 0 glc
    s_sub_u32 s3, s3, 1
    s_cbranch_scc1 poll_30_ok
    s_waitcnt lgkmcnt(0)
    s_xor_b64 s[100:101], s[88:89], s[98:99]
    s_xor_b64 s[88:89], s[90:91], s[98:99]
    s_or_b64 s[100:101], s[100:101], s[88:89]
    s_xor_b64 s[88:89], s[92:93], s[98:99]
    s_or_b64 s[100:101], s[100:101], s[88:89]
    s_xor_b64 s[88:89], s[94:95], s[98:99]
    s_or_b64 s[100:101], s[100:101], s[88:89]
    s_cbranch_scc1 poll_30
poll_30_ok:
    s_waitcnt lgkmcnt(0)
    ds_or_b32 v10, v11
    s_mov_b64 exec, -1
    s_setprio 0
    s_waitcnt lgkmcnt(0)
    s_cmp_eq_u32 s8, 4
    s_cbranch_scc1 l_wo_end
    s_cmp_lg_u32 s9, 0
    s_cbranch_scc1 l_wo_end
    s_lshl_b32 s53, s8, 7
    s_lshl_b32 s52, s11, 10
    s_add_u32 s53, s53, s52
    s_add_u32 s53, s53, 64487168
    s_add_u32 s96, s4, s53
    s_addc_u32 s97, s5, 0
    s_mov_b32 s98, s10
    s_mov_b32 s99, s10
    s_mov_b32 s3, 0x100000
poll_31:
    s_load_dwordx16 s[80:95], s[96:97], 0 glc
    s_sub_u32 s3, s3, 1
    s_cbranch_scc1 poll_31_ok
    s_waitcnt lgkmcnt(0)
    s_xor_b64 s[100:101], s[80:81], s[98:99]
    s_xor_b64 s[80:81], s[82:83], s[98:99]
    s_or_b64 s[100:101], s[100:101], s[80:81]
    s_xor_b64 s[80:81], s[84:85], s[98:99]
    s_or_b64 s[100:101], s[100:101], s[80:81]
    s_xor_b64 s[80:81], s[86:87], s[98:99]
    s_or_b64 s[100:101], s[100:101], s[80:81]
    s_xor_b64 s[80:81], s[88:89], s[98:99]
    s_or_b64 s[100:101], s[100:101], s[80:81]
    s_xor_b64 s[80:81], s[90:91], s[98:99]
    s_or_b64 s[100:101], s[100:101], s[80:81]
    s_xor_b64 s[80:81], s[92:93], s[98:99]
    s_or_b64 s[100:101], s[100:101], s[80:81]
    s_xor_b64 s[80:81], s[94:95], s[98:99]
    s_or_b64 s[100:101], s[100:101], s[80:81]
    s_cbranch_scc1 poll_31
poll_31_ok:
    s_waitcnt lgkmcnt(0)
l_wo_end:
    s_barrier
    s_add_u32 s9, s9, 1
    s_cmp_eq_u32 s9, 4
    s_cbranch_scc1 k_exit
    s_cmp_lg_u32 s8, 4
    s_cbranch_scc1 l_qkv
    s_cmp_eq_u32 s9, 2
    s_cbranch_scc1 h_qkvA
    s_branch h_qkvB
.p2align 6
s_attn:
    s_sub_u32 s48, s8, 4
    s_lshl_b32 s3, s7, 7
    v_lshrrev_b32 v20, 3, v1
    v_lshlrev_b32 v21, 11, v20
    v_lshrrev_b32 v22, 2, v1
    v_lshrrev_b32 v23, 4, v1
    v_xor_b32 v22, v22, v23
    v_and_b32 v22, 1, v22
    v_lshl_add_u32 v21, v22, 6, v21
    v_and_b32 v22, 3, v1
    v_lshl_add_u32 v21, v22, 4, v21
    v_add_u32 v7, s3, v21
    s_mov_b32 s24, s42
    s_mov_b32 s25, s43
    s_mov_b32 s26, 2097152
    s_mov_b32 s27, 0x00020000
    s_lshr_b32 s49, s9, 1
    s_lshl_b32 s49, s49, 23
    s_lshl_b32 s52, s7, 19
    s_add_u32 s49, s49, s52
    s_and_b32 s52, s6, 1
    s_lshl_b32 s52, s52, 18
    s_add_u32 s49, s49, s52
    s_add_u32 s49, s49, 33554432
    s_lshr_b32 s61, s6, 1
    s_lshl_b32 s52, s48, 13
    s_add_u32 s53, s52, 81920
    v_add_u32 v8, s53, v5
    s_lshl_b32 s53, s61, 15
    s_add_u32 s52, s52, s53
    s_add_u32 s62, s52, s49
    s_add_u32 s63, s62, 4096
    s_mul_i32 s59, s9, 786432
    s_add_u32 s59, s59, 66322432
    s_and_b32 s52, s11, 31
    s_lshl_b32 s52, s52, 10
    s_add_u32 s59, s59, s52
    s_lshr_b32 s52, s61, 1
    s_lshl_b32 s52, s52, 7
    s_add_u32 s59, s59, s52
    s_and_b32 s52, s61, 1
    s_lshl_b32 s52, s52, 2
    s_add_u32 s52, s52, s48
    s_lshl_b32 s52, s52, 2
    s_add_u32 s59, s59, s52
    v_lshlrev_b32 v20, 15, v1
    v_mov_b32 v21, s10
    s_mul_i32 s54, s9, 786432
    s_add_u32 s54, s54, 66322432
    s_lshl_b32 s55, s11, 10
    s_add_u32 s54, s54, s55
    s_add_u32 s52, s4, s54
    s_addc_u32 s53, s5, 0
    s_mov_b32 s54, s10
    s_mov_b32 s55, s10
    s_lshl_b32 s51, s48, 11
    s_add_u32 s49, s49, s51
    s_add_u32 s51, s51, 81920
    s_mov_b32 s60, s48
    s_setprio 3
    s_barrier
    ds_read_b128 v[32:35], v8 offset:0
    ds_read_b128 v[36:39], v8 offset:1024
    ds_read_b128 v[40:43], v8 offset:2048
    ds_read_b128 v[44:47], v8 offset:3072
    ds_read_b128 v[48:51], v8 offset:4096
    ds_read_b128 v[52:55], v8 offset:5120
    ds_read_b128 v[56:59], v8 offset:6144
    ds_read_b128 v[60:63], v8 offset:7168
    s_waitcnt lgkmcnt(7)
    buffer_store_dwordx4 v[32:35], v5, s[12:15], s62 offen offset:0 sc1
    s_waitcnt lgkmcnt(6)
    buffer_store_dwordx4 v[36:39], v5, s[12:15], s62 offen offset:1024 sc1
    s_waitcnt lgkmcnt(5)
    buffer_store_dwordx4 v[40:43], v5, s[12:15], s62 offen offset:2048 sc1
    s_waitcnt lgkmcnt(4)
    buffer_store_dwordx4 v[44:47], v5, s[12:15], s62 offen offset:3072 sc1
    s_waitcnt lgkmcnt(3)
    buffer_store_dwordx4 v[48:51], v5, s[12:15], s63 offen offset:0 sc1
    s_waitcnt lgkmcnt(2)
    buffer_store_dwordx4 v[52:55], v5, s[12:15], s63 offen offset:1024 sc1
    s_waitcnt lgkmcnt(1)
    buffer_store_dwordx4 v[56:59], v5, s[12:15], s63 offen offset:2048 sc1
    s_waitcnt lgkmcnt(0)
    buffer_store_dwordx4 v[60:63], v5, s[12:15], s63 offen offset:3072 sc1
    s_mov_b64 exec, 0xff
    s_waitcnt vmcnt(0)
    buffer_store_dword v21, v20, s[12:15], s59 offen sc1
    s_mov_b64 exec, -1
    s_lshl_b32 s58, 1, s61
    s_mov_b32 s57, 0
    s_add_u32 s62, s61, 1
    s_and_b32 s62, s62, 7
    s_lshl_b32 s50, s62, 15
    s_add_u32 s50, s50, s49
    s_lshr_b32 s63, s62, 1
    s_lshl_b32 s63, s63, 7
    s_and_b32 s62, s62, 1
    s_lshl_b32 s62, s62, 4
    s_add_u32 s62, s62, s63
    s_mov_b32 s58, 0x100000
need_32:
    s_load_dwordx4 s[64:67], s[52:53], s62 glc
    s_sub_u32 s58, s58, 1
    s_cbranch_scc1 need_32_ok
    s_waitcnt lgkmcnt(0)
    s_xor_b64 s[64:65], s[64:65], s[54:55]
    s_xor_b64 s[66:67], s[66:67], s[54:55]
    s_or_b64 s[64:65], s[64:65], s[66:67]
    s_cbranch_scc1 need_32
need_32_ok:
    s_waitcnt lgkmcnt(0)
    s_add_u32 m0, s51, 32768
    s_nop 0
    buffer_load_dwordx4 v5, s[12:15], s50 offen offset:0 sc1 lds
    buffer_load_dwordx4 v5, s[12:15], s50 offen offset:1024 sc1 lds
    s_add_u32 s50, s50, 8192
    s_add_u32 m0, s51, 40960
    s_nop 0
    buffer_load_dwordx4 v5, s[12:15], s50 offen offset:0 sc1 lds
    buffer_load_dwordx4 v5, s[12:15], s50 offen offset:1024 sc1 lds
    s_add_u32 s50, s50, 8192
    s_add_u32 m0, s51, 49152
    s_nop 0
    buffer_load_dwordx4 v5, s[12:15], s50 offen offset:0 sc1 lds
    buffer_load_dwordx4 v5, s[12:15], s50 offen offset:1024 sc1 lds
    s_add_u32 s50, s50, 8192
    s_add_u32 m0, s51, 57344
    s_nop 0
    buffer_load_dwordx4 v5, s[12:15], s50 offen offset:0 sc1 lds
    buffer_load_dwordx4 v5, s[12:15], s50 offen offset:1024 sc1 lds
    s_add_u32 s50, s50, 8192
    s_waitcnt vmcnt(4)
    s_barrier
    s_add_u32 s62, s61, 2
    s_and_b32 s62, s62, 7
    s_lshl_b32 s50, s62, 15
    s_add_u32 s50, s50, s49
    s_lshr_b32 s63, s62, 1
    s_lshl_b32 s63, s63, 7
    s_and_b32 s62, s62, 1
    s_lshl_b32 s62, s62, 4
    s_add_u32 s62, s62, s63
    s_mov_b32 s58, 0x100000
need_33:
    s_load_dwordx4 s[64:67], s[52:53], s62 glc
    s_sub_u32 s58, s58, 1
    s_cbranch_scc1 need_33_ok
    s_waitcnt lgkmcnt(0)
    s_xor_b64 s[64:65], s[64:65], s[54:55]
    s_xor_b64 s[66:67], s[66:67], s[54:55]
    s_or_b64 s[64:65], s[64:65], s[66:67]
    s_cbranch_scc1 need_33
need_33_ok:
    s_waitcnt lgkmcnt(0)
    s_add_u32 m0, s51, 0
    s_nop 0
    buffer_load_dwordx4 v5, s[12:15], s50 offen offset:0 sc1 lds
    buffer_load_dwordx4 v5, s[12:15], s50 offen offset:1024 sc1 lds
    s_add_u32 s50, s50, 8192
    s_add_u32 m0, s51, 8192
    s_nop 0
    buffer_load_dwordx4 v5, s[12:15], s50 offen offset:0 sc1 lds
    buffer_load_dwordx4 v5, s[12:15], s50 offen offset:1024 sc1 lds
    s_add_u32 s50, s50, 8192
    s_waitcnt vmcnt(4)
    s_barrier
    s_add_u32 m0, s51, 16384
    s_nop 0
    buffer_load_dwordx4 v5, s[12:15], s50 offen offset:0 sc1 lds
    buffer_load_dwordx4 v5, s[12:15], s50 offen offset:1024 sc1 lds
    s_add_u32 s50, s50, 8192
    s_add_u32 m0, s51, 24576
    s_nop 0
    buffer_load_dwordx4 v5, s[12:15], s50 offen offset:0 sc1 lds
    buffer_load_dwordx4 v5, s[12:15], s50 offen offset:1024 sc1 lds
    s_add_u32 s50, s50, 8192
    s_waitcnt vmcnt(4)
    s_barrier
    s_add_u32 s62, s61, 3
    s_and_b32 s62, s62, 7
    s_lshl_b32 s50, s62, 15
    s_add_u32 s50, s50, s49
    s_lshr_b32 s63, s62, 1
    s_lshl_b32 s63, s63, 7
    s_and_b32 s62, s62, 1
    s_lshl_b32 s62, s62, 4
    s_add_u32 s62, s62, s63
    s_mov_b32 s58, 0x100000
need_34:
    s_load_dwordx4 s[64:67], s[52:53], s62 glc
    s_sub_u32 s58, s58, 1
    s_cbranch_scc1 need_34_ok
    s_waitcnt lgkmcnt(0)
    s_xor_b64 s[64:65], s[64:65], s[54:55]
    s_xor_b64 s[66:67], s[66:67], s[54:55]
    s_or_b64 s[64:65], s[64:65], s[66:67]
    s_cbranch_scc1 need_34
need_34_ok:
    s_waitcnt lgkmcnt(0)
    s_add_u32 m0, s51, 32768
    s_nop 0
    buffer_load_dwordx4 v5, s[12:15], s50 offen offset:0 sc1 lds
    buffer_load_dwordx4 v5, s[12:15], s50 offen offset:1024 sc1 lds
    s_add_u32 s50, s50, 8192
    s_add_u32 m0, s51, 40960
    s_nop 0
    buffer_load_dwordx4 v5, s[12:15], s50 offen offset:0 sc1 lds
    buffer_load_dwordx4 v5, s[12:15], s50 offen offset:1024 sc1 lds
    s_add_u32 s50, s50, 8192
    s_lshl_b32 m0, s60, 10
    s_lshl_b32 s3, s60, 14
    buffer_load_dwordx4 v7, s[24:27], s3 offen lds
    s_add_u32 s60, s60, 4
    s_lshl_b32 m0, s60, 10
    s_lshl_b32 s3, s60, 14
    buffer_load_dwordx4 v7, s[24:27], s3 offen lds
    s_add_u32 s60, s60, 4
    s_waitcnt vmcnt(6)
    s_barrier
    s_add_u32 m0, s51, 49152
    s_nop 0
    buffer_load_dwordx4 v5, s[12:15], s50 offen offset:0 sc1 lds
    buffer_load_dwordx4 v5, s[12:15], s50 offen offset:1024 sc1 lds
    s_add_u32 s50, s50, 8192
    s_add_u32 m0, s51, 57344
    s_nop 0
    buffer_load_dwordx4 v5, s[12:15], s50 offen offset:0 sc1 lds
    buffer_load_dwordx4 v5, s[12:15], s50 offen offset:1024 sc1 lds
    s_add_u32 s50, s50, 8192
    s_lshl_b32 m0, s60, 10
    s_lshl_b32 s3, s60, 14
    buffer_load_dwordx4 v7, s[24:27], s3 offen lds
    s_add_u32 s60, s60, 4
    s_lshl_b32 m0, s60, 10
    s_lshl_b32 s3, s60, 14
    buffer_load_dwordx4 v7, s[24:27], s3 offen lds
    s_add_u32 s60, s60, 4
    s_waitcnt vmcnt(8)
    s_barrier
    s_add_u32 s62, s61, 4
    s_and_b32 s62, s62, 7
    s_lshl_b32 s50, s62, 15
    s_add_u32 s50, s50, s49
    s_lshr_b32 s63, s62, 1
    s_lshl_b32 s63, s63, 7
    s_and_b32 s62, s62, 1
    s_lshl_b32 s62, s62, 4
    s_add_u32 s62, s62, s63
    s_mov_b32 s58, 0x100000
need_35:
    s_load_dwordx4 s[64:67], s[52:53], s62 glc
    s_sub_u32 s58, s58, 1
    s_cbranch_scc1 need_35_ok
    s_waitcnt lgkmcnt(0)
    s_xor_b64 s[64:65], s[64:65], s[54:55]
    s_xor_b64 s[66:67], s[66:67], s[54:55]
    s_or_b64 s[64:65], s[64:65], s[66:67]
    s_cbranch_scc1 need_35
need_35_ok:
    s_waitcnt lgkmcnt(0)
    s_add_u32 m0, s51, 0
    s_nop 0
    buffer_load_dwordx4 v5, s[12:15], s50 offen offset:0 sc1 lds
    buffer_load_dwordx4 v5, s[12:15], s50 offen offset:1024 sc1 lds
    s_add_u32 s50, s50, 8192
    s_add_u32 m0, s51, 8192
    s_nop 0
    buffer_load_dwordx4 v5, s[12:15], s50 offen offset:0 sc1 lds
    buffer_load_dwordx4 v5, s[12:15], s50 offen offset:1024 sc1 lds
    s_add_u32 s50, s50, 8192
    s_lshl_b32 m0, s60, 10
    s_lshl_b32 s3, s60, 14
    buffer_load_dwordx4 v7, s[24:27], s3 offen lds
    s_add_u32 s60, s60, 4
    s_lshl_b32 m0, s60, 10
    s_lshl_b32 s3, s60, 14
    buffer_load_dwordx4 v7, s[24:27], s3 offen lds
    s_add_u32 s60, s60, 4
    s_waitcnt vmcnt(8)
    s_barrier
    s_add_u32 m0, s51, 16384
    s_nop 0
    buffer_load_dwordx4 v5, s[12:15], s50 offen offset:0 sc1 lds
    buffer_load_dwordx4 v5, s[12:15], s50 offen offset:1024 sc1 lds
    s_add_u32 s50, s50, 8192
    s_add_u32 m0, s51, 24576
    s_nop 0
    buffer_load_dwordx4 v5, s[12:15], s50 offen offset:0 sc1 lds
    buffer_load_dwordx4 v5, s[12:15], s50 offen offset:1024 sc1 lds
    s_add_u32 s50, s50, 8192
    s_lshl_b32 m0, s60, 10
    s_lshl_b32 s3, s60, 14
    buffer_load_dwordx4 v7, s[24:27], s3 offen lds
    s_add_u32 s60, s60, 4
    s_lshl_b32 m0, s60, 10
    s_lshl_b32 s3, s60, 14
    buffer_load_dwordx4 v7, s[24:27], s3 offen lds
    s_add_u32 s60, s60, 4
    s_waitcnt vmcnt(8)
    s_barrier
    s_add_u32 s62, s61, 5
    s_and_b32 s62, s62, 7
    s_lshl_b32 s50, s62, 15
    s_add_u32 s50, s50, s49
    s_lshr_b32 s63, s62, 1
    s_lshl_b32 s63, s63, 7
    s_and_b32 s62, s62, 1
    s_lshl_b32 s62, s62, 4
    s_add_u32 s62, s62, s63
    s_mov_b32 s58, 0x100000
need_36:
    s_load_dwordx4 s[64:67], s[52:53], s62 glc
    s_sub_u32 s58, s58, 1
    s_cbranch_scc1 need_36_ok
    s_waitcnt lgkmcnt(0)
    s_xor_b64 s[64:65], s[64:65], s[54:55]
    s_xor_b64 s[66:67], s[66:67], s[54:55]
    s_or_b64 s[64:65], s[64:65], s[66:67]
    s_cbranch_scc1 need_36
need_36_ok:
    s_waitcnt lgkmcnt(0)
    s_add_u32 m0, s51, 32768
    s_nop 0
    buffer_load_dwordx4 v5, s[12:15], s50 offen offset:0 sc1 lds
    buffer_load_dwordx4 v5, s[12:15], s50 offen offset:1024 sc1 lds
    s_add_u32 s50, s50, 8192
    s_add_u32 m0, s51, 40960
    s_nop 0
    buffer_load_dwordx4 v5, s[12:15], s50 offen offset:0 sc1 lds
    buffer_load_dwordx4 v5, s[12:15], s50 offen offset:1024 sc1 lds
    s_add_u32 s50, s50, 8192
    s_lshl_b32 m0, s60, 10
    s_lshl_b32 s3, s60, 14
    buffer_load_dwordx4 v7, s[24:27], s3 offen lds
    s_add_u32 s60, s60, 4
    s_lshl_b32 m0, s60, 10
    s_lshl_b32 s3, s60, 14
    buffer_load_dwordx4 v7, s[24:27], s3 offen lds
    s_add_u32 s60, s60, 4
    s_waitcnt vmcnt(8)
    s_barrier
    s_add_u32 m0, s51, 49152
    s_nop 0
    buffer_load_dwordx4 v5, s[12:15], s50 offen offset:0 sc1 lds
    buffer_load_dwordx4 v5, s[12:15], s50 offen offset:1024 sc1 lds
    s_add_u32 s50, s50, 8192
    s_add_u32 m0, s51, 57344
    s_nop 0
    buffer_load_dwordx4 v5, s[12:15], s50 offen offset:0 sc1 lds
    buffer_load_dwordx4 v5, s[12:15], s50 offen offset:1024 sc1 lds
    s_add_u32 s50, s50, 8192
    s_lshl_b32 m0, s60, 10
    s_lshl_b32 s3, s60, 14
    buffer_load_dwordx4 v7, s[24:27], s3 offen lds
    s_add_u32 s60, s60, 4
    s_lshl_b32 m0, s60, 10
    s_lshl_b32 s3, s60, 14
    buffer_load_dwordx4 v7, s[24:27], s3 offen lds
    s_add_u32 s60, s60, 4
    s_waitcnt vmcnt(8)
    s_barrier
    s_add_u32 s62, s61, 6
    s_and_b32 s62, s62, 7
    s_lshl_b32 s50, s62, 15
    s_add_u32 s50, s50, s49
    s_lshr_b32 s63, s62, 1
    s_lshl_b32 s63, s63, 7
    s_and_b32 s62, s62, 1
    s_lshl_b32 s62, s62, 4
    s_add_u32 s62, s62, s63
    s_mov_b32 s58, 0x100000
need_37:
    s_load_dwordx4 s[64:67], s[52:53], s62 glc
    s_sub_u32 s58, s58, 1
    s_cbranch_scc1 need_37_ok
    s_waitcnt lgkmcnt(0)
    s_xor_b64 s[64:65], s[64:65], s[54:55]
    s_xor_b64 s[66:67], s[66:67], s[54:55]
    s_or_b64 s[64:65], s[64:65], s[66:67]
    s_cbranch_scc1 need_37
need_37_ok:
    s_waitcnt lgkmcnt(0)
    s_add_u32 m0, s51, 0
    s_nop 0
    buffer_load_dwordx4 v5, s[12:15], s50 offen offset:0 sc1 lds
    buffer_load_dwordx4 v5, s[12:15], s50 offen offset:1024 sc1 lds
    s_add_u32 s50, s50, 8192
    s_add_u32 m0, s51, 8192
    s_nop 0
    buffer_load_dwordx4 v5, s[12:15], s50 offen offset:0 sc1 lds
    buffer_load_dwordx4 v5, s[12:15], s50 offen offset:1024 sc1 lds
    s_add_u32 s50, s50, 8192
    s_lshl_b32 m0, s60, 10
    s_lshl_b32 s3, s60, 14
    buffer_load_dwordx4 v7, s[24:27], s3 offen lds
    s_add_u32 s60, s60, 4
    s_lshl_b32 m0, s60, 10
    s_lshl_b32 s3, s60, 14
    buffer_load_dwordx4 v7, s[24:27], s3 offen lds
    s_add_u32 s60, s60, 4
    s_waitcnt vmcnt(8)
    s_barrier
    s_add_u32 m0, s51, 16384
    s_nop 0
    buffer_load_dwordx4 v5, s[12:15], s50 offen offset:0 sc1 lds
    buffer_load_dwordx4 v5, s[12:15], s50 offen offset:1024 sc1 lds
    s_add_u32 s50, s50, 8192
    s_add_u32 m0, s51, 24576
    s_nop 0
    buffer_load_dwordx4 v5, s[12:15], s50 offen offset:0 sc1 lds
    buffer_load_dwordx4 v5, s[12:15], s50 offen offset:1024 sc1 lds
    s_add_u32 s50, s50, 8192
    s_lshl_b32 m0, s60, 10
    s_lshl_b32 s3, s60, 14
    buffer_load_dwordx4 v7, s[24:27], s3 offen lds
    s_add_u32 s60, s60, 4
    s_lshl_b32 m0, s60, 10
    s_lshl_b32 s3, s60, 14
    buffer_load_dwordx4 v7, s[24:27], s3 offen lds
    s_add_u32 s60, s60, 4
    s_waitcnt vmcnt(8)
    s_barrier
    s_add_u32 s62, s61, 7
    s_and_b32 s62, s62, 7
    s_lshl_b32 s50, s62, 15
    s_add_u32 s50, s50, s49
    s_lshr_b32 s63, s62, 1
    s_lshl_b32 s63, s63, 7
    s_and_b32 s62, s62, 1
    s_lshl_b32 s62, s62, 4
    s_add_u32 s62, s62, s63
    s_mov_b32 s58, 0x100000
need_38:
    s_load_dwordx4 s[64:67], s[52:53], s62 glc
    s_sub_u32 s58, s58, 1
    s_cbranch_scc1 need_38_ok
    s_waitcnt lgkmcnt(0)
    s_xor_b64 s[64:65], s[64:65], s[54:55]
    s_xor_b64 s[66:67], s[66:67], s[54:55]
    s_or_b64 s[64:65], s[64:65], s[66:67]
    s_cbranch_scc1 need_38
need_38_ok:
    s_waitcnt lgkmcnt(0)
    s_add_u32 m0, s51, 32768
    s_nop 0
    buffer_load_dwordx4 v5, s[12:15], s50 offen offset:0 sc1 lds
    buffer_load_dwordx4 v5, s[12:15], s50 offen offset:1024 sc1 lds
    s_add_u32 s50, s50, 8192
    s_add_u32 m0, s51, 40960
    s_nop 0
    buffer_load_dwordx4 v5, s[12:15], s50 offen offset:0 sc1 lds
    buffer_load_dwordx4 v5, s[12:15], s50 offen offset:1024 sc1 lds
    s_add_u32 s50, s50, 8192
    s_lshl_b32 m0, s60, 10
    s_lshl_b32 s3, s60, 14
    buffer_load_dwordx4 v7, s[24:27], s3 offen lds
    s_add_u32 s60, s60, 4
    s_lshl_b32 m0, s60, 10
    s_lshl_b32 s3, s60, 14
    buffer_load_dwordx4 v7, s[24:27], s3 offen lds
    s_add_u32 s60, s60, 4
    s_waitcnt vmcnt(8)
    s_barrier
    s_add_u32 m0, s51, 49152
    s_nop 0
    buffer_load_dwordx4 v5, s[12:15], s50 offen offset:0 sc1 lds
    buffer_load_dwordx4 v5, s[12:15], s50 offen offset:1024 sc1 lds
    s_add_u32 s50, s50, 8192
    s_add_u32 m0, s51, 57344
    s_nop 0
    buffer_load_dwordx4 v5, s[12:15], s50 offen offset:0 sc1 lds
    buffer_load_dwordx4 v5, s[12:15], s50 offen offset:1024 sc1 lds
    s_add_u32 s50, s50, 8192
    s_lshl_b32 m0, s60, 10
    s_lshl_b32 s3, s60, 14
    buffer_load_dwordx4 v7, s[24:27], s3 offen lds
    s_add_u32 s60, s60, 4
    s_lshl_b32 m0, s60, 10
    s_lshl_b32 s3, s60, 14
    buffer_load_dwordx4 v7, s[24:27], s3 offen lds
    s_add_u32 s60, s60, 4
    s_waitcnt vmcnt(8)
    s_barrier
    s_lshl_b32 m0, s60, 10
    s_lshl_b32 s3, s60, 14
    buffer_load_dwordx4 v7, s[24:27], s3 offen lds
    s_add_u32 s60, s60, 4
    s_lshl_b32 m0, s60, 10
    s_lshl_b32 s3, s60, 14
    buffer_load_dwordx4 v7, s[24:27], s3 offen lds
    s_add_u32 s60, s60, 4
    s_lshl_b32 m0, s60, 10
    s_lshl_b32 s3, s60, 14
    buffer_load_dwordx4 v7, s[24:27], s3 offen lds
    s_add_u32 s60, s60, 4
    s_lshl_b32 m0, s60, 10
    s_lshl_b32 s3, s60, 14
    buffer_load_dwordx4 v7, s[24:27], s3 offen lds
    s_add_u32 s60, s60, 4
    s_waitcnt vmcnt(6)
    s_barrier
    s_lshl_b32 m0, s60, 10
    s_lshl_b32 s3, s60, 14
    buffer_load_dwordx4 v7, s[24:27], s3 offen lds
    s_add_u32 s60, s60, 4
    s_lshl_b32 m0, s60, 10
    s_lshl_b32 s3, s60, 14
    buffer_load_dwordx4 v7, s[24:27], s3 offen lds
    s_add_u32 s60, s60, 4
    s_lshl_b32 m0, s60, 10
    s_lshl_b32 s3, s60, 14
    buffer_load_dwordx4 v7, s[24:27], s3 offen lds
    s_add_u32 s60, s60, 4
    s_lshl_b32 m0, s60, 10
    s_lshl_b32 s3, s60, 14
    buffer_load_dwordx4 v7, s[24:27], s3 offen lds
    s_add_u32 s60, s60, 4
    s_barrier
    s_lshl_b32 m0, s60, 10
    s_lshl_b32 s3, s60, 14
    buffer_load_dwordx4 v7, s[24:27], s3 offen lds
    s_add_u32 s60, s60, 4
    s_lshl_b32 m0, s60, 10
    s_lshl_b32 s3, s60, 14
    buffer_load_dwordx4 v7, s[24:27], s3 offen lds
    s_add_u32 s60, s60, 4
    s_lshl_b32 m0, s60, 10
    s_lshl_b32 s3, s60, 14
    buffer_load_dwordx4 v7, s[24:27], s3 offen lds
    s_add_u32 s60, s60, 4
    s_lshl_b32 m0, s60, 10
    s_lshl_b32 s3, s60, 14
    buffer_load_dwordx4 v7, s[24:27], s3 offen lds
    s_add_u32 s60, s60, 4
    s_cmp_eq_u32 s8, 4
    s_cbranch_scc1 h_wo
    s_branch l_wo
.p2align 6
c_attn_slow:
    s_waitcnt lgkmcnt(0)
    s_lshr_b32 s56, s9, 1
    s_lshl_b32 s56, s56, 23
    s_lshl_b32 s55, s7, 19
    s_add_u32 s56, s56, s55
    s_and_b32 s55, s6, 1
    s_lshl_b32 s55, s55, 18
    s_add_u32 s56, s56, s55
    s_add_u32 s56, s56, 33554432
    v_mov_b32 v28, 0xff800000
    v_mov_b32 v30, 0xff800000
    s_mov_b32 s57, 0
c_attn_slow1:
    s_lshr_b32 s55, s57, 2
    s_lshl_b32 s55, s55, 14
    s_and_b32 s58, s57, 3
    s_lshl_b32 s58, s58, 11
    s_add_u32 s55, s55, s58
    s_add_u32 s55, s55, s56
    buffer_load_dwordx4 v[128:131], v5, s[12:15], s55 offen offset:0 sc1
    buffer_load_dwordx4 v[132:135], v5, s[12:15], s55 offen offset:1024 sc1
    s_waitcnt vmcnt(0)
    v_mfma_f32_32x32x16_bf16 v[64:79], v[128:131], v[8:11], 0
    v_mfma_f32_32x32x16_bf16 v[80:95], v[128:131], v[16:19], 0
    v_mfma_f32_32x32x16_bf16 v[64:79], v[132:135], v[12:15], v[64:79]
    v_mfma_f32_32x32x16_bf16 v[80:95], v[132:135], v[20:23], v[80:95]
    s_nop 10
    v_max3_f32 v28, v28, v64, v65
    v_max3_f32 v28, v28, v66, v67
    v_max3_f32 v28, v28, v68, v69
    v_max3_f32 v28, v28, v70, v71
    v_max3_f32 v28, v28, v72, v73
    v_max3_f32 v28, v28, v74, v75
    v_max3_f32 v28, v28, v76, v77
    v_max3_f32 v28, v28, v78, v79
    v_max3_f32 v30, v30, v80, v81
    v_max3_f32 v30, v30, v82, v83
    v_max3_f32 v30, v30, v84, v85
    v_max3_f32 v30, v30, v86, v87
    v_max3_f32 v30, v30, v88, v89
    v_max3_f32 v30, v30, v90, v91
    v_max3_f32 v30, v30, v92, v93
    v_max3_f32 v30, v30, v94, v95
    s_add_u32 s57, s57, 1
    s_cmp_lt_u32 s57, 64
    s_cbranch_scc1 c_attn_slow1
    v_mov_b32 v29, v28
    s_nop 1
    v_permlane32_swap_b32 v28, v29
    v_max_f32 v28, v28, v29
    v_sub_f32 v96, 0, v28
    v_sub_f32 v97, 0, v28
    v_sub_f32 v98, 0, v28
    v_sub_f32 v99, 0, v28
    v_sub_f32 v100, 0, v28
    v_sub_f32 v101, 0, v28
    v_sub_f32 v102, 0, v28
    v_sub_f32 v103, 0, v28
    v_sub_f32 v104, 0, v28
    v_sub_f32 v105, 0, v28
    v_sub_f32 v106, 0, v28
    v_sub_f32 v107, 0, v28
    v_sub_f32 v108, 0, v28
    v_sub_f32 v109, 0, v28
    v_sub_f32 v110, 0, v28
    v_sub_f32 v111, 0, v28
    v_mov_b32 v160, 0
    v_mov_b32 v161, 0
    v_mov_b32 v162, 0
    v_mov_b32 v163, 0
    v_mov_b32 v164, 0
    v_mov_b32 v165, 0
    v_mov_b32 v166, 0
    v_mov_b32 v167, 0
    v_mov_b32 v168, 0
    v_mov_b32 v169, 0
    v_mov_b32 v170, 0
    v_mov_b32 v171, 0
    v_mov_b32 v172, 0
    v_mov_b32 v173, 0
    v_mov_b32 v174, 0
    v_mov_b32 v175, 0
    v_mov_b32 v192, 0
    v_mov_b32 v193, 0
    v_mov_b32 v194, 0
    v_mov_b32 v195, 0
    v_mov_b32 v31, v30
    s_nop 1
    v_permlane32_swap_b32 v30, v31
    v_max_f32 v30, v30, v31
    v_sub_f32 v112, 0, v30
    v_sub_f32 v113, 0, v30
    v_sub_f32 v114, 0, v30
    v_sub_f32 v115, 0, v30
    v_sub_f32 v116, 0, v30
    v_sub_f32 v117, 0, v30
    v_sub_f32 v118, 0, v30
    v_sub_f32 v119, 0, v30
    v_sub_f32 v120, 0, v30
    v_sub_f32 v121, 0, v30
    v_sub_f32 v122, 0, v30
    v_sub_f32 v123, 0, v30
    v_sub_f32 v124, 0, v30
    v_sub_f32 v125, 0, v30
    v_sub_f32 v126, 0, v30
    v_sub_f32 v127, 0, v30
    v_mov_b32 v176, 0
    v_mov_b32 v177, 0
    v_mov_b32 v178, 0
    v_mov_b32 v179, 0
    v_mov_b32 v180, 0
    v_mov_b32 v181, 0
    v_mov_b32 v182, 0
    v_mov_b32 v183, 0
    v_mov_b32 v184, 0
    v_mov_b32 v185, 0
    v_mov_b32 v186, 0
    v_mov_b32 v187, 0
    v_mov_b32 v188, 0
    v_mov_b32 v189, 0
    v_mov_b32 v190, 0
    v_mov_b32 v191, 0
    v_mov_b32 v196, 0
    v_mov_b32 v197, 0
    v_mov_b32 v198, 0
    v_mov_b32 v199, 0
    s_mov_b32 s57, 0
c_attn_slow2:
    s_lshr_b32 s55, s57, 2
    s_lshl_b32 s55, s55, 14
    s_and_b32 s58, s57, 3
    s_lshl_b32 s58, s58, 11
    s_add_u32 s55, s55, s58
    s_add_u32 s55, s55, s56
    buffer_load_dwordx4 v[128:131], v5, s[12:15], s55 offen offset:0 sc1
    buffer_load_dwordx4 v[132:135], v5, s[12:15], s55 offen offset:1024 sc1
    s_add_u32 s55, s55, 8192
    buffer_load_dwordx4 v[144:147], v5, s[12:15], s55 offen offset:0 sc1
    buffer_load_dwordx4 v[148:151], v5, s[12:15], s55 offen offset:1024 sc1
    s_waitcnt vmcnt(0)
    v_mfma_f32_32x32x16_bf16 v[64:79], v[128:131], v[8:11], v[96:111]
    v_mfma_f32_32x32x16_bf16 v[80:95], v[128:131], v[16:19], v[112:127]
    v_mfma_f32_32x32x16_bf16 v[64:79], v[132:135], v[12:15], v[64:79]
    v_mfma_f32_32x32x16_bf16 v[80:95], v[132:135], v[20:23], v[80:95]
    s_nop 10
    v_exp_f32 v64, v64
    v_exp_f32 v65, v65
    v_exp_f32 v66, v66
    v_exp_f32 v67, v67
    v_exp_f32 v68, v68
    v_exp_f32 v69, v69
    v_exp_f32 v70, v70
    v_exp_f32 v71, v71
    v_exp_f32 v72, v72
    v_exp_f32 v73, v73
    v_exp_f32 v74, v74
    v_exp_f32 v75, v75
    v_exp_f32 v76, v76
    v_exp_f32 v77, v77
    v_exp_f32 v78, v78
    v_exp_f32 v79, v79
    v_exp_f32 v80, v80
    v_exp_f32 v81, v81
    v_exp_f32 v82, v82
    v_exp_f32 v83, v83
    v_exp_f32 v84, v84
    v_exp_f32 v85, v85
    v_exp_f32 v86, v86
    v_exp_f32 v87, v87
    v_exp_f32 v88, v88
    v_exp_f32 v89, v89
    v_exp_f32 v90, v90
    v_exp_f32 v91, v91
    v_exp_f32 v92, v92
    v_exp_f32 v93, v93
    v_exp_f32 v94, v94
    v_exp_f32 v95, v95
    v_smfmac_f32_32x32x32_bf16 v[160:175], v[144:147], v[64:71], v204
    v_smfmac_f32_16x16x64_bf16 v[192:195], v[200:203], v[64:71], v204
    v_smfmac_f32_32x32x32_bf16 v[160:175], v[148:151], v[72:79], v204
    v_smfmac_f32_16x16x64_bf16 v[192:195], v[200:203], v[72:79], v204
    v_smfmac_f32_32x32x32_bf16 v[176:191], v[144:147], v[80:87], v204
    v_smfmac_f32_16x16x64_bf16 v[196:199], v[200:203], v[80:87], v204
    v_smfmac_f32_32x32x32_bf16 v[176:191], v[148:151], v[88:95], v204
    v_smfmac_f32_16x16x64_bf16 v[196:199], v[200:203], v[88:95], v204
    s_add_u32 s57, s57, 1
    s_cmp_lt_u32 s57, 64
    s_nop 15
    s_cbranch_scc1 c_attn_slow2
    s_branch c_attn_fin
    s_endpgm
.section .rodata,"a"
.p2align 6
.amdhsa_kernel interleave_layers__sliding_local_dilated__softmax_full_mha__prompt_kernel
  .amdhsa_next_free_vgpr 256
  .amdhsa_next_free_sgpr 102
  .amdhsa_accum_offset 224
  .amdhsa_group_segment_fixed_size 0
  .amdhsa_kernarg_size 72
  .amdhsa_user_sgpr_count 2
  .amdhsa_user_sgpr_kernarg_segment_ptr 1
  .amdhsa_system_sgpr_workgroup_id_x 1
.end_amdhsa_kernel
```

```asm
; @launch grid=(256,1,1) block=(512,1,1) lds=159744
.amdgcn_target "amdgcn-amd-amdhsa--gfx950"
.text
.globl interleave_layers__sliding_local_dilated__softmax_full_mha__prompt_kernel
.type interleave_layers__sliding_local_dilated__softmax_full_mha__prompt_kernel,@function
.p2align 8
interleave_layers__sliding_local_dilated__softmax_full_mha__prompt_kernel:
    s_cmp_ge_u32 s2, 256
    s_cbranch_scc1 k_exit2
    s_load_dwordx16 s[32:47], s[0:1], 0
    s_load_dwordx2 s[4:5], s[0:1], 64
    v_lshrrev_b32 v2, 6, v0
    v_and_b32 v1, 63, v0
    v_mov_b32 v12, 0
    v_mov_b32 v14, 0
    v_mov_b32 v15, 0
    v_mov_b32 v16, 0
    v_readfirstlane_b32 s8, v2
    s_and_b32 s3, s2, 1
    s_lshl_b32 s3, s3, 3
    s_bfe_u32 s6, s2, 0x30003
    s_add_u32 s6, s3, s6
    s_bfe_u32 s3, s2, 0x20001
    s_lshl_b32 s3, s3, 2
    s_lshr_b32 s7, s2, 6
    s_add_u32 s7, s3, s7
    s_lshl_b32 s11, s6, 4
    s_add_u32 s11, s11, s7
    s_mov_b32 s9, -1
    s_mov_b32 s96, 0
    s_mov_b32 s10, 0
    s_waitcnt lgkmcnt(0)
    s_mov_b32 s12, s4
    s_mov_b32 s13, s5
    s_mov_b32 s14, 71303168
    s_mov_b32 s15, 0x00020000
    s_cmp_lt_u32 s8, 4
    s_cbranch_scc1 c_prep
    s_cmp_eq_u32 s8, 4
    s_cbranch_scc1 h_first
    s_branch l_first
k_exit:
k_exit2:
    s_endpgm
.p2align 6
c_qkvA:
    v_and_b32 v1, 63, v0
    v_lshrrev_b32 v2, 6, v0
    v_lshlrev_b32 v5, 4, v1
    v_lshrrev_b32 v3, 5, v1
    v_and_b32 v4, 15, v0
    v_bfe_u32 v7, v1, 4, 1
    v_lshl_add_u32 v6, v7, 5, v4
    v_lshlrev_b32 v6, 4, v6
    v_lshl_add_u32 v6, v3, 10, v6
    s_lshr_b32 s48, s6, 1
    s_lshl_b32 s48, s48, 2
    s_add_u32 s48, s48, s8
    s_lshl_b32 s55, s48, 17
    s_lshl_b32 s56, s9, 22
    s_add_u32 s55, s55, s56
    s_add_u32 s16, s4, s55
    s_addc_u32 s17, s5, 0
    s_mov_b32 s18, 65536
    s_mov_b32 s19, 0x00020000
    s_add_u32 s56, s55, 65536
    s_add_u32 s20, s4, s56
    s_addc_u32 s21, s5, 0
    s_mov_b32 s22, 65536
    s_mov_b32 s23, 0x00020000
    s_lshl_b32 s49, s7, 12
    s_add_u32 s49, s49, s55
    s_and_b32 s56, s6, 1
    s_lshl_b32 s56, s56, 11
    s_add_u32 s49, s49, s56
    s_add_u32 s49, s49, 16777216
    s_movk_i32 s54, 4096
    v_lshrrev_b32 v16, 2, v4
    v_lshl_add_u32 v18, v7, 2, v16
    v_lshl_add_u32 v18, v3, 4, v18
    v_lshlrev_b32 v18, 6, v18
    v_and_b32 v17, 3, v4
    v_lshl_add_u32 v18, v17, 3, v18
    v_lshl_add_u32 v26, v7, 5, v18
    v_xor_b32 v27, 32, v26
    v_mov_b32 v24, v26
    v_mov_b32 v25, v27
    v_and_b32 v18, 0x30, v1
    v_add_u32 v10, 155648, v18
    v_lshlrev_b32 v11, 2, v4
    v_add_u32 v11, 155648, v11
    v_lshl_add_u32 v8, v2, 8, v11
    v_lshl_add_u32 v9, v2, 8, v10
    s_lshr_b32 s3, s8, 1
    s_and_b32 s55, s8, 1
    s_lshl_b32 s56, s55, 5
    v_xor_b32 v29, s56, v26
    s_lshl_b32 s56, s3, 13
    s_add_u32 s56, s56, 8192
    v_add_u32 v29, s56, v29
    v_mov_b32 v28, v29
    v_add_u32 v30, 147456, v5
    v_lshl_add_u32 v14, v2, 6, v10
    v_lshl_add_u32 v12, v2, 11, v5
    v_add_u32 v12, 131072, v12
    v_lshlrev_b32 v16, 8, v16
    v_lshl_add_u32 v16, v18, 2, v16
    v_lshl_add_u32 v16, v17, 1, v16
    v_add_u32 v16, 1024, v16
    v_cmp_gt_u32 vcc, 2, v2
    s_nop 1
    v_cndmask_b32 v13, v16, v5, vcc
    s_lshl_b32 s56, s55, 3
    s_add_u32 s56, s56, 131072
    v_add_u32 v13, s56, v13
    v_lshrrev_b32 v18, 2, v18
    v_sub_u32 v18, v4, v18
    v_mov_b32 v19, 0xf149f2ca
    v_add_u32 v16, 0x0, v18
    v_and_b32 v16, 0xfffffff1, v16
    v_cmp_eq_u32 vcc, 0, v16
    s_nop 1
    v_cndmask_b32 v196, v19, 0, vcc
    v_add_u32 v16, 0xffffffff, v18
    v_and_b32 v16, 0xfffffff1, v16
    v_cmp_eq_u32 vcc, 0, v16
    s_nop 1
    v_cndmask_b32 v197, v19, 0, vcc
    v_add_u32 v16, 0xfffffffe, v18
    v_and_b32 v16, 0xfffffff1, v16
    v_cmp_eq_u32 vcc, 0, v16
    s_nop 1
    v_cndmask_b32 v198, v19, 0, vcc
    v_add_u32 v16, 0xfffffffd, v18
    v_and_b32 v16, 0xfffffff1, v16
    v_cmp_eq_u32 vcc, 0, v16
    s_nop 1
    v_cndmask_b32 v199, v19, 0, vcc
    v_add_u32 v16, 0x10, v18
    v_and_b32 v16, 0xfffffff1, v16
    v_cmp_eq_u32 vcc, 0, v16
    s_nop 1
    v_cndmask_b32 v200, v19, 0, vcc
    v_add_u32 v16, 0xf, v18
    v_and_b32 v16, 0xfffffff1, v16
    v_cmp_eq_u32 vcc, 0, v16
    s_nop 1
    v_cndmask_b32 v201, v19, 0, vcc
    v_add_u32 v16, 0xe, v18
    v_and_b32 v16, 0xfffffff1, v16
    v_cmp_eq_u32 vcc, 0, v16
    s_nop 1
    v_cndmask_b32 v202, v19, 0, vcc
    v_add_u32 v16, 0xd, v18
    v_and_b32 v16, 0xfffffff1, v16
    v_cmp_eq_u32 vcc, 0, v16
    s_nop 1
    v_cndmask_b32 v203, v19, 0, vcc
    s_cmp_eq_u32 s48, 0
    s_cselect_b64 vcc, -1, 0
    v_cndmask_b32 v204, v200, v19, vcc
    v_cndmask_b32 v205, v201, v19, vcc
    v_cndmask_b32 v206, v202, v19, vcc
    v_cndmask_b32 v207, v203, v19, vcc
    v_mov_b32 v208, 0x3f803f80
    v_mov_b32 v209, 0x3f803f80
    v_mov_b32 v210, 0x3f803f80
    v_mov_b32 v211, 0x3f803f80
    v_mov_b32 v184, 0
    v_mov_b32 v185, 0
    v_mov_b32 v186, 0
    v_mov_b32 v187, 0
    v_mov_b32 v188, 0
    v_mov_b32 v189, 0
    v_mov_b32 v190, 0
    v_mov_b32 v191, 0
    v_mov_b32 v192, 0
    v_mov_b32 v193, 0
    v_mov_b32 v194, 0
    v_mov_b32 v195, 0
    v_mov_b32 v32, 0
    v_mov_b32 v33, 0
    v_mov_b32 v34, 0
    v_mov_b32 v35, 0
    v_mov_b32 v36, 0
    v_mov_b32 v37, 0
    v_mov_b32 v38, 0
    v_mov_b32 v39, 0
    v_mov_b32 v40, 0
    v_mov_b32 v41, 0
    v_mov_b32 v42, 0
    v_mov_b32 v43, 0
    v_mov_b32 v44, 0
    v_mov_b32 v45, 0
    v_mov_b32 v46, 0
    v_mov_b32 v47, 0
    v_mov_b32 v48, 0
    v_mov_b32 v49, 0
    v_mov_b32 v50, 0
    v_mov_b32 v51, 0
    v_mov_b32 v52, 0
    v_mov_b32 v53, 0
    v_mov_b32 v54, 0
    v_mov_b32 v55, 0
    v_mov_b32 v56, 0
    v_mov_b32 v57, 0
    v_mov_b32 v58, 0
    v_mov_b32 v59, 0
    v_mov_b32 v60, 0
    v_mov_b32 v61, 0
    v_mov_b32 v62, 0
    v_mov_b32 v63, 0
    v_mov_b32 v64, 0
    v_mov_b32 v65, 0
    v_mov_b32 v66, 0
    v_mov_b32 v67, 0
    v_mov_b32 v68, 0
    v_mov_b32 v69, 0
    v_mov_b32 v70, 0
    v_mov_b32 v71, 0
    v_mov_b32 v72, 0
    v_mov_b32 v73, 0
    v_mov_b32 v74, 0
    v_mov_b32 v75, 0
    v_mov_b32 v76, 0
    v_mov_b32 v77, 0
    v_mov_b32 v78, 0
    v_mov_b32 v79, 0
    v_mov_b32 v80, 0
    v_mov_b32 v81, 0
    v_mov_b32 v82, 0
    v_mov_b32 v83, 0
    v_mov_b32 v84, 0
    v_mov_b32 v85, 0
    v_mov_b32 v86, 0
    v_mov_b32 v87, 0
    v_mov_b32 v88, 0
    v_mov_b32 v89, 0
    v_mov_b32 v90, 0
    v_mov_b32 v91, 0
    v_mov_b32 v92, 0
    v_mov_b32 v93, 0
    v_mov_b32 v94, 0
    v_mov_b32 v95, 0
    v_mov_b32 v96, 0
    v_mov_b32 v97, 0
    v_mov_b32 v98, 0
    v_mov_b32 v99, 0
    v_mov_b32 v100, 0
    v_mov_b32 v101, 0
    v_mov_b32 v102, 0
    v_mov_b32 v103, 0
    v_mov_b32 v104, 0
    v_mov_b32 v105, 0
    v_mov_b32 v106, 0
    v_mov_b32 v107, 0
    v_mov_b32 v108, 0
    v_mov_b32 v109, 0
    v_mov_b32 v110, 0
    v_mov_b32 v111, 0
    v_mov_b32 v112, 0
    v_mov_b32 v113, 0
    v_mov_b32 v114, 0
    v_mov_b32 v115, 0
    v_mov_b32 v116, 0
    v_mov_b32 v117, 0
    v_mov_b32 v118, 0
    v_mov_b32 v119, 0
    v_mov_b32 v120, 0
    v_mov_b32 v121, 0
    v_mov_b32 v122, 0
    v_mov_b32 v123, 0
    v_mov_b32 v124, 0
    v_mov_b32 v125, 0
    v_mov_b32 v126, 0
    v_mov_b32 v127, 0
    s_mov_b32 s50, 8192
    s_mov_b32 s58, 6144
    s_mov_b32 s51, 12288
    s_mov_b32 s59, 10240
    s_mov_b32 s52, 0
    s_mul_i32 s60, s9, 786432
    s_add_u32 s60, s60, 65273856
    s_lshl_b32 s61, s11, 10
    s_add_u32 s60, s60, s61
    s_and_b32 s61, s8, 2
    s_lshl_b32 s61, s61, 7
    s_add_u32 s60, s60, s61
    s_add_u32 s61, s60, 128
    s_mov_b32 s98, s10
    s_mov_b32 s99, s10
    s_mov_b32 s3, 0x100000
cp_1:
    s_load_dwordx8 s[64:71], s[4:5], s60 glc
    s_load_dwordx8 s[72:79], s[4:5], s61 glc
    s_sub_u32 s3, s3, 1
    s_cbranch_scc1 cp_1_ok
    s_waitcnt lgkmcnt(0)
    s_xor_b64 s[100:101], s[64:65], s[98:99]
    s_xor_b64 s[64:65], s[66:67], s[98:99]
    s_or_b64 s[100:101], s[100:101], s[64:65]
    s_xor_b64 s[64:65], s[68:69], s[98:99]
    s_or_b64 s[100:101], s[100:101], s[64:65]
    s_xor_b64 s[64:65], s[70:71], s[98:99]
    s_or_b64 s[100:101], s[100:101], s[64:65]
    s_xor_b64 s[64:65], s[72:73], s[98:99]
    s_or_b64 s[100:101], s[100:101], s[64:65]
    s_xor_b64 s[64:65], s[74:75], s[98:99]
    s_or_b64 s[100:101], s[100:101], s[64:65]
    s_xor_b64 s[64:65], s[76:77], s[98:99]
    s_or_b64 s[100:101], s[100:101], s[64:65]
    s_xor_b64 s[64:65], s[78:79], s[98:99]
    s_or_b64 s[100:101], s[100:101], s[64:65]
    s_cbranch_scc1 cp_1
cp_1_ok:
    s_waitcnt lgkmcnt(0)
    buffer_load_dwordx4 v[152:155], v6, s[16:19], 0 offen offset:0 sc1
    buffer_load_dwordx4 v[156:159], v6, s[16:19], 0 offen offset:256 sc1
    buffer_load_dwordx4 v[160:163], v6, s[20:23], 0 offen offset:0 sc1
    buffer_load_dwordx4 v[164:167], v6, s[20:23], 0 offen offset:256 sc1
    buffer_load_dwordx4 v[168:171], v6, s[16:19], 0 offen offset:2048 sc1
    buffer_load_dwordx4 v[172:175], v6, s[16:19], 0 offen offset:2304 sc1
    buffer_load_dwordx4 v[176:179], v6, s[20:23], 0 offen offset:2048 sc1
    buffer_load_dwordx4 v[180:183], v6, s[20:23], 0 offen offset:2304 sc1
    s_barrier
    ds_read_b64_tr_b16 v[128:129], v24 offset:0
    ds_read_b64_tr_b16 v[130:131], v24 offset:512
    ds_read_b64_tr_b16 v[132:133], v25 offset:0
    ds_read_b64_tr_b16 v[134:135], v25 offset:512
    ds_read_b64_tr_b16 v[136:137], v24 offset:8192
    ds_read_b64_tr_b16 v[138:139], v24 offset:8704
    ds_read_b64_tr_b16 v[140:141], v25 offset:8192
    ds_read_b64_tr_b16 v[142:143], v25 offset:8704
    ds_read_b64_tr_b16 v[144:145], v24 offset:16384
    ds_read_b64_tr_b16 v[146:147], v24 offset:16896
    buffer_load_dwordx4 a[0:3], v6, s[16:19], s54 offen offset:0 sc1
    buffer_load_dwordx4 a[4:7], v6, s[16:19], s54 offen offset:256 sc1
    buffer_load_dwordx4 a[8:11], v6, s[20:23], s54 offen offset:0 sc1
    buffer_load_dwordx4 a[12:15], v6, s[20:23], s54 offen offset:256 sc1
    buffer_load_dwordx4 a[16:19], v6, s[16:19], s54 offen offset:2048 sc1
    buffer_load_dwordx4 a[20:23], v6, s[16:19], s54 offen offset:2304 sc1
    s_mov_b32 s54, 7
.p2align 3
c_qkvA_loop:
    s_waitcnt vmcnt(12) lgkmcnt(8)
    v_mfma_f32_16x16x32_bf16 v[184:187], v[188:191], v[192:195], v[184:187]
    v_mfma_f32_16x16x32_bf16 v[32:35], v[128:131], v[152:155], v[32:35]
    ds_read_b64_tr_b16 v[148:149], v25 offset:16384
    buffer_load_dwordx4 a[24:27], v6, s[20:23], s58 offen offset:0 sc1
    v_mfma_f32_16x16x32_bf16 v[36:39], v[128:131], v[156:159], v[36:39]
    ds_read_b64_tr_b16 v[150:151], v25 offset:16896
    s_waitcnt lgkmcnt(8)
    v_mfma_f32_16x16x32_bf16 v[52:55], v[132:135], v[156:159], v[52:55]
    v_mfma_f32_16x16x32_bf16 v[48:51], v[132:135], v[152:155], v[48:51]
    ds_read_b64_tr_b16 v[188:189], v28 offset:0
    s_waitcnt lgkmcnt(7)
    v_mfma_f32_16x16x32_bf16 v[64:67], v[136:139], v[152:155], v[64:67]
    v_mfma_f32_16x16x32_bf16 v[68:71], v[136:139], v[156:159], v[68:71]
    ds_read_b64_tr_b16 v[190:191], v28 offset:512
    s_waitcnt lgkmcnt(6)
    v_mfma_f32_16x16x32_bf16 v[84:87], v[140:143], v[156:159], v[84:87]
    buffer_load_dwordx4 a[28:31], v6, s[20:23], s58 offen offset:256 sc1
    v_mfma_f32_16x16x32_bf16 v[80:83], v[140:143], v[152:155], v[80:83]
    ds_read_b128 v[192:195], v30 offset:0
    s_waitcnt lgkmcnt(5)
    v_mfma_f32_16x16x32_bf16 v[96:99], v[152:155], v[144:147], v[96:99]
    v_mfma_f32_16x16x32_bf16 v[100:103], v[156:159], v[144:147], v[100:103]
    s_waitcnt lgkmcnt(3)
    v_mfma_f32_16x16x32_bf16 v[116:119], v[156:159], v[148:151], v[116:119]
    v_mfma_f32_16x16x32_bf16 v[112:115], v[152:155], v[148:151], v[112:115]
    s_waitcnt vmcnt(12)
    v_mfma_f32_16x16x32_bf16 v[40:43], v[128:131], v[160:163], v[40:43]
    buffer_load_dwordx4 v[152:155], v6, s[16:19], s50 offen offset:0 sc1
    v_mfma_f32_16x16x32_bf16 v[44:47], v[128:131], v[164:167], v[44:47]
    v_mfma_f32_16x16x32_bf16 v[60:63], v[132:135], v[164:167], v[60:63]
    ds_read_b64_tr_b16 v[128:129], v24 offset:2048
    v_mfma_f32_16x16x32_bf16 v[56:59], v[132:135], v[160:163], v[56:59]
    ds_read_b64_tr_b16 v[130:131], v24 offset:2560
    v_mfma_f32_16x16x32_bf16 v[72:75], v[136:139], v[160:163], v[72:75]
    ds_read_b64_tr_b16 v[132:133], v25 offset:2048
    v_mfma_f32_16x16x32_bf16 v[76:79], v[136:139], v[164:167], v[76:79]
    ds_read_b64_tr_b16 v[134:135], v25 offset:2560
    v_mfma_f32_16x16x32_bf16 v[92:95], v[140:143], v[164:167], v[92:95]
    ds_read_b64_tr_b16 v[136:137], v24 offset:10240
    buffer_load_dwordx4 v[156:159], v6, s[16:19], s50 offen offset:256 sc1
    v_mfma_f32_16x16x32_bf16 v[88:91], v[140:143], v[160:163], v[88:91]
    ds_read_b64_tr_b16 v[138:139], v24 offset:10752
    v_mfma_f32_16x16x32_bf16 v[104:107], v[160:163], v[144:147], v[104:107]
    ds_read_b64_tr_b16 v[140:141], v25 offset:10240
    v_mfma_f32_16x16x32_bf16 v[108:111], v[164:167], v[144:147], v[108:111]
    ds_read_b64_tr_b16 v[142:143], v25 offset:10752
    v_mfma_f32_16x16x32_bf16 v[124:127], v[164:167], v[148:151], v[124:127]
    ds_read_b64_tr_b16 v[144:145], v24 offset:18432
    v_mfma_f32_16x16x32_bf16 v[120:123], v[160:163], v[148:151], v[120:123]
    ds_read_b64_tr_b16 v[146:147], v24 offset:18944
    s_waitcnt vmcnt(12) lgkmcnt(8)
    v_mfma_f32_16x16x32_bf16 v[184:187], v[188:191], v[192:195], v[184:187]
    v_mfma_f32_16x16x32_bf16 v[32:35], v[128:131], v[168:171], v[32:35]
    ds_read_b64_tr_b16 v[148:149], v25 offset:18432
    buffer_load_dwordx4 v[160:163], v6, s[20:23], s58 offen offset:2048 sc1
    v_mfma_f32_16x16x32_bf16 v[36:39], v[128:131], v[172:175], v[36:39]
    ds_read_b64_tr_b16 v[150:151], v25 offset:18944
    s_waitcnt lgkmcnt(8)
    v_mfma_f32_16x16x32_bf16 v[52:55], v[132:135], v[172:175], v[52:55]
    v_mfma_f32_16x16x32_bf16 v[48:51], v[132:135], v[168:171], v[48:51]
    ds_read_b64_tr_b16 v[188:189], v28 offset:2048
    s_waitcnt lgkmcnt(7)
    v_mfma_f32_16x16x32_bf16 v[64:67], v[136:139], v[168:171], v[64:67]
    v_mfma_f32_16x16x32_bf16 v[68:71], v[136:139], v[172:175], v[68:71]
    ds_read_b64_tr_b16 v[190:191], v28 offset:2560
    s_waitcnt lgkmcnt(6)
    v_mfma_f32_16x16x32_bf16 v[84:87], v[140:143], v[172:175], v[84:87]
    buffer_load_dwordx4 v[164:167], v6, s[20:23], s58 offen offset:2304 sc1
    v_mfma_f32_16x16x32_bf16 v[80:83], v[140:143], v[168:171], v[80:83]
    ds_read_b128 v[192:195], v30 offset:1024
    s_waitcnt lgkmcnt(5)
    v_mfma_f32_16x16x32_bf16 v[96:99], v[168:171], v[144:147], v[96:99]
    v_mfma_f32_16x16x32_bf16 v[100:103], v[172:175], v[144:147], v[100:103]
    s_waitcnt lgkmcnt(3)
    v_mfma_f32_16x16x32_bf16 v[116:119], v[172:175], v[148:151], v[116:119]
    v_mfma_f32_16x16x32_bf16 v[112:115], v[168:171], v[148:151], v[112:115]
    s_waitcnt vmcnt(12)
    v_mfma_f32_16x16x32_bf16 v[40:43], v[128:131], v[176:179], v[40:43]
    buffer_load_dwordx4 v[168:171], v6, s[16:19], s50 offen offset:2048 sc1
    v_mfma_f32_16x16x32_bf16 v[44:47], v[128:131], v[180:183], v[44:47]
    v_mfma_f32_16x16x32_bf16 v[60:63], v[132:135], v[180:183], v[60:63]
    ds_read_b64_tr_b16 v[128:129], v24 offset:4096
    v_mfma_f32_16x16x32_bf16 v[56:59], v[132:135], v[176:179], v[56:59]
    ds_read_b64_tr_b16 v[130:131], v24 offset:4608
    v_mfma_f32_16x16x32_bf16 v[72:75], v[136:139], v[176:179], v[72:75]
    ds_read_b64_tr_b16 v[132:133], v25 offset:4096
    v_mfma_f32_16x16x32_bf16 v[76:79], v[136:139], v[180:183], v[76:79]
    ds_read_b64_tr_b16 v[134:135], v25 offset:4608
    v_mfma_f32_16x16x32_bf16 v[92:95], v[140:143], v[180:183], v[92:95]
    ds_read_b64_tr_b16 v[136:137], v24 offset:12288
    buffer_load_dwordx4 v[172:175], v6, s[16:19], s50 offen offset:2304 sc1
    v_mfma_f32_16x16x32_bf16 v[88:91], v[140:143], v[176:179], v[88:91]
    ds_read_b64_tr_b16 v[138:139], v24 offset:12800
    v_mfma_f32_16x16x32_bf16 v[104:107], v[176:179], v[144:147], v[104:107]
    ds_read_b64_tr_b16 v[140:141], v25 offset:12288
    v_mfma_f32_16x16x32_bf16 v[108:111], v[180:183], v[144:147], v[108:111]
    ds_read_b64_tr_b16 v[142:143], v25 offset:12800
    v_mfma_f32_16x16x32_bf16 v[124:127], v[180:183], v[148:151], v[124:127]
    ds_read_b64_tr_b16 v[144:145], v24 offset:20480
    v_mfma_f32_16x16x32_bf16 v[120:123], v[176:179], v[148:151], v[120:123]
    ds_read_b64_tr_b16 v[146:147], v24 offset:20992
    s_waitcnt vmcnt(12) lgkmcnt(8)
    v_mfma_f32_16x16x32_bf16 v[184:187], v[188:191], v[192:195], v[184:187]
    v_mfma_f32_16x16x32_bf16 v[32:35], v[128:131], a[0:3], v[32:35]
    ds_read_b64_tr_b16 v[148:149], v25 offset:20480
    buffer_load_dwordx4 v[176:179], v6, s[20:23], s59 offen offset:0 sc1
    v_mfma_f32_16x16x32_bf16 v[36:39], v[128:131], a[4:7], v[36:39]
    ds_read_b64_tr_b16 v[150:151], v25 offset:20992
    s_waitcnt lgkmcnt(8)
    v_mfma_f32_16x16x32_bf16 v[52:55], v[132:135], a[4:7], v[52:55]
    v_mfma_f32_16x16x32_bf16 v[48:51], v[132:135], a[0:3], v[48:51]
    ds_read_b64_tr_b16 v[188:189], v28 offset:4096
    s_waitcnt lgkmcnt(7)
    v_mfma_f32_16x16x32_bf16 v[64:67], v[136:139], a[0:3], v[64:67]
    v_mfma_f32_16x16x32_bf16 v[68:71], v[136:139], a[4:7], v[68:71]
    ds_read_b64_tr_b16 v[190:191], v28 offset:4608
    s_waitcnt lgkmcnt(6)
    v_mfma_f32_16x16x32_bf16 v[84:87], v[140:143], a[4:7], v[84:87]
    buffer_load_dwordx4 v[180:183], v6, s[20:23], s59 offen offset:256 sc1
    v_mfma_f32_16x16x32_bf16 v[80:83], v[140:143], a[0:3], v[80:83]
    ds_read_b128 v[192:195], v30 offset:2048
    s_waitcnt lgkmcnt(5)
    v_mfma_f32_16x16x32_bf16 v[96:99], a[0:3], v[144:147], v[96:99]
    v_mfma_f32_16x16x32_bf16 v[100:103], a[4:7], v[144:147], v[100:103]
    s_waitcnt lgkmcnt(3)
    v_mfma_f32_16x16x32_bf16 v[116:119], a[4:7], v[148:151], v[116:119]
    v_mfma_f32_16x16x32_bf16 v[112:115], a[0:3], v[148:151], v[112:115]
    s_waitcnt vmcnt(12)
    v_mfma_f32_16x16x32_bf16 v[40:43], v[128:131], a[8:11], v[40:43]
    buffer_load_dwordx4 a[0:3], v6, s[16:19], s51 offen offset:0 sc1
    v_mfma_f32_16x16x32_bf16 v[44:47], v[128:131], a[12:15], v[44:47]
    v_mfma_f32_16x16x32_bf16 v[60:63], v[132:135], a[12:15], v[60:63]
    ds_read_b64_tr_b16 v[128:129], v24 offset:6144
    v_mfma_f32_16x16x32_bf16 v[56:59], v[132:135], a[8:11], v[56:59]
    ds_read_b64_tr_b16 v[130:131], v24 offset:6656
    v_mfma_f32_16x16x32_bf16 v[72:75], v[136:139], a[8:11], v[72:75]
    ds_read_b64_tr_b16 v[132:133], v25 offset:6144
    v_mfma_f32_16x16x32_bf16 v[76:79], v[136:139], a[12:15], v[76:79]
    ds_read_b64_tr_b16 v[134:135], v25 offset:6656
    v_mfma_f32_16x16x32_bf16 v[92:95], v[140:143], a[12:15], v[92:95]
    ds_read_b64_tr_b16 v[136:137], v24 offset:14336
    buffer_load_dwordx4 a[4:7], v6, s[16:19], s51 offen offset:256 sc1
    v_mfma_f32_16x16x32_bf16 v[88:91], v[140:143], a[8:11], v[88:91]
    ds_read_b64_tr_b16 v[138:139], v24 offset:14848
    v_mfma_f32_16x16x32_bf16 v[104:107], a[8:11], v[144:147], v[104:107]
    ds_read_b64_tr_b16 v[140:141], v25 offset:14336
    v_mfma_f32_16x16x32_bf16 v[108:111], a[12:15], v[144:147], v[108:111]
    ds_read_b64_tr_b16 v[142:143], v25 offset:14848
    v_mfma_f32_16x16x32_bf16 v[124:127], a[12:15], v[148:151], v[124:127]
    ds_read_b64_tr_b16 v[144:145], v24 offset:22528
    v_mfma_f32_16x16x32_bf16 v[120:123], a[8:11], v[148:151], v[120:123]
    ds_read_b64_tr_b16 v[146:147], v24 offset:23040
    s_waitcnt vmcnt(12) lgkmcnt(8)
    v_mfma_f32_16x16x32_bf16 v[184:187], v[188:191], v[192:195], v[184:187]
    v_mfma_f32_16x16x32_bf16 v[32:35], v[128:131], a[16:19], v[32:35]
    ds_read_b64_tr_b16 v[148:149], v25 offset:22528
    buffer_load_dwordx4 a[8:11], v6, s[20:23], s59 offen offset:2048 sc1
    v_mfma_f32_16x16x32_bf16 v[36:39], v[128:131], a[20:23], v[36:39]
    ds_read_b64_tr_b16 v[150:151], v25 offset:23040
    s_waitcnt lgkmcnt(8)
    v_mfma_f32_16x16x32_bf16 v[52:55], v[132:135], a[20:23], v[52:55]
    v_mfma_f32_16x16x32_bf16 v[48:51], v[132:135], a[16:19], v[48:51]
    ds_read_b64_tr_b16 v[188:189], v28 offset:6144
    s_waitcnt lgkmcnt(7)
    v_mfma_f32_16x16x32_bf16 v[64:67], v[136:139], a[16:19], v[64:67]
    v_mfma_f32_16x16x32_bf16 v[68:71], v[136:139], a[20:23], v[68:71]
    ds_read_b64_tr_b16 v[190:191], v28 offset:6656
    s_waitcnt lgkmcnt(6)
    v_mfma_f32_16x16x32_bf16 v[84:87], v[140:143], a[20:23], v[84:87]
    buffer_load_dwordx4 a[12:15], v6, s[20:23], s59 offen offset:2304 sc1
    v_mfma_f32_16x16x32_bf16 v[80:83], v[140:143], a[16:19], v[80:83]
    ds_read_b128 v[192:195], v30 offset:3072
    s_waitcnt lgkmcnt(5)
    v_mfma_f32_16x16x32_bf16 v[96:99], a[16:19], v[144:147], v[96:99]
    s_add_u32 s52, s52, 24576
    v_mfma_f32_16x16x32_bf16 v[100:103], a[20:23], v[144:147], v[100:103]
    s_cmp_eq_u32 s52, 147456
    s_waitcnt lgkmcnt(3)
    v_mfma_f32_16x16x32_bf16 v[116:119], a[20:23], v[148:151], v[116:119]
    s_cselect_b32 s52, 0, s52
    v_mfma_f32_16x16x32_bf16 v[112:115], a[16:19], v[148:151], v[112:115]
    s_add_u32 s58, s58, 8192
    s_add_u32 s59, s59, 8192
    s_waitcnt vmcnt(12) lgkmcnt(0)
    v_mfma_f32_16x16x32_bf16 v[40:43], v[128:131], a[24:27], v[40:43]
    buffer_load_dwordx4 a[16:19], v6, s[16:19], s51 offen offset:2048 sc1
    s_barrier
    v_add_u32 v24, s52, v26
    v_mfma_f32_16x16x32_bf16 v[44:47], v[128:131], a[28:31], v[44:47]
    v_add_u32 v25, s52, v27
    v_add_u32 v28, s52, v29
    v_mfma_f32_16x16x32_bf16 v[60:63], v[132:135], a[28:31], v[60:63]
    ds_read_b64_tr_b16 v[128:129], v24 offset:0
    v_mfma_f32_16x16x32_bf16 v[56:59], v[132:135], a[24:27], v[56:59]
    ds_read_b64_tr_b16 v[130:131], v24 offset:512
    v_mfma_f32_16x16x32_bf16 v[72:75], v[136:139], a[24:27], v[72:75]
    ds_read_b64_tr_b16 v[132:133], v25 offset:0
    v_mfma_f32_16x16x32_bf16 v[76:79], v[136:139], a[28:31], v[76:79]
    ds_read_b64_tr_b16 v[134:135], v25 offset:512
    v_xor_b32 v30, 4096, v30
    v_mfma_f32_16x16x32_bf16 v[92:95], v[140:143], a[28:31], v[92:95]
    ds_read_b64_tr_b16 v[136:137], v24 offset:8192
    buffer_load_dwordx4 a[20:23], v6, s[16:19], s51 offen offset:2304 sc1
    v_mfma_f32_16x16x32_bf16 v[88:91], v[140:143], a[24:27], v[88:91]
    ds_read_b64_tr_b16 v[138:139], v24 offset:8704
    v_mfma_f32_16x16x32_bf16 v[104:107], a[24:27], v[144:147], v[104:107]
    ds_read_b64_tr_b16 v[140:141], v25 offset:8192
    s_add_u32 s50, s50, 8192
    v_mfma_f32_16x16x32_bf16 v[108:111], a[28:31], v[144:147], v[108:111]
    ds_read_b64_tr_b16 v[142:143], v25 offset:8704
    s_add_u32 s51, s51, 8192
    v_mfma_f32_16x16x32_bf16 v[124:127], a[28:31], v[148:151], v[124:127]
    ds_read_b64_tr_b16 v[144:145], v24 offset:16384
    s_sub_u32 s54, s54, 1
    v_mfma_f32_16x16x32_bf16 v[120:123], a[24:27], v[148:151], v[120:123]
    ds_read_b64_tr_b16 v[146:147], v24 offset:16896
    s_cmp_lg_u32 s54, 0
    s_cbranch_scc1 c_qkvA_loop
    s_waitcnt vmcnt(12) lgkmcnt(8)
    v_mfma_f32_16x16x32_bf16 v[184:187], v[188:191], v[192:195], v[184:187]
    v_mfma_f32_16x16x32_bf16 v[32:35], v[128:131], v[152:155], v[32:35]
    ds_read_b64_tr_b16 v[148:149], v25 offset:16384
    buffer_load_dwordx4 a[24:27], v6, s[20:23], s58 offen offset:0 sc1
    v_mfma_f32_16x16x32_bf16 v[36:39], v[128:131], v[156:159], v[36:39]
    ds_read_b64_tr_b16 v[150:151], v25 offset:16896
    s_waitcnt lgkmcnt(8)
    v_mfma_f32_16x16x32_bf16 v[52:55], v[132:135], v[156:159], v[52:55]
    ds_read_b32 v16, v8 offset:1280
    v_mfma_f32_16x16x32_bf16 v[48:51], v[132:135], v[152:155], v[48:51]
    ds_read_b64_tr_b16 v[188:189], v28 offset:0
    ds_read_b32 v18, v8 offset:1344
    s_waitcnt lgkmcnt(9)
    v_mfma_f32_16x16x32_bf16 v[64:67], v[136:139], v[152:155], v[64:67]
    ds_read_b32 v20, v8 offset:1408
    v_mfma_f32_16x16x32_bf16 v[68:71], v[136:139], v[156:159], v[68:71]
    ds_read_b64_tr_b16 v[190:191], v28 offset:512
    s_waitcnt lgkmcnt(9)
    v_mfma_f32_16x16x32_bf16 v[84:87], v[140:143], v[156:159], v[84:87]
    buffer_load_dwordx4 a[28:31], v6, s[20:23], s58 offen offset:256 sc1
    ds_read_b32 v22, v8 offset:1472
    v_mfma_f32_16x16x32_bf16 v[80:83], v[140:143], v[152:155], v[80:83]
    ds_read_b128 v[192:195], v30 offset:0
    ds_read_b128 v[212:215], v10 offset:128
    s_waitcnt lgkmcnt(10)
    v_mfma_f32_16x16x32_bf16 v[96:99], v[152:155], v[144:147], v[96:99]
    ds_read_b128 v[216:219], v10 offset:192
    v_mfma_f32_16x16x32_bf16 v[100:103], v[156:159], v[144:147], v[100:103]
    s_waitcnt lgkmcnt(9)
    v_mfma_f32_16x16x32_bf16 v[116:119], v[156:159], v[148:151], v[116:119]
    v_mfma_f32_16x16x32_bf16 v[112:115], v[152:155], v[148:151], v[112:115]
    s_waitcnt vmcnt(12)
    v_mfma_f32_16x16x32_bf16 v[40:43], v[128:131], v[160:163], v[40:43]
    s_waitcnt lgkmcnt(0)
    v_fma_f32 v64, -v16, v212, v64
    v_fma_f32 v65, -v16, v213, v65
    v_mfma_f32_16x16x32_bf16 v[44:47], v[128:131], v[164:167], v[44:47]
    v_fma_f32 v66, -v16, v214, v66
    v_mfma_f32_16x16x32_bf16 v[60:63], v[132:135], v[164:167], v[60:63]
    ds_read_b64_tr_b16 v[128:129], v24 offset:2048
    v_fma_f32 v67, -v16, v215, v67
    v_mfma_f32_16x16x32_bf16 v[56:59], v[132:135], v[160:163], v[56:59]
    ds_read_b64_tr_b16 v[130:131], v24 offset:2560
    v_fma_f32 v68, -v18, v212, v68
    v_fma_f32 v69, -v18, v213, v69
    v_mfma_f32_16x16x32_bf16 v[72:75], v[136:139], v[160:163], v[72:75]
    ds_read_b64_tr_b16 v[132:133], v25 offset:2048
    v_fma_f32 v70, -v18, v214, v70
    v_mfma_f32_16x16x32_bf16 v[76:79], v[136:139], v[164:167], v[76:79]
    ds_read_b64_tr_b16 v[134:135], v25 offset:2560
    v_fma_f32 v71, -v18, v215, v71
    v_mfma_f32_16x16x32_bf16 v[92:95], v[140:143], v[164:167], v[92:95]
    ds_read_b64_tr_b16 v[136:137], v24 offset:10240
    v_fma_f32 v80, -v16, v216, v80
    v_fma_f32 v81, -v16, v217, v81
    v_mfma_f32_16x16x32_bf16 v[88:91], v[140:143], v[160:163], v[88:91]
    ds_read_b64_tr_b16 v[138:139], v24 offset:10752
    v_fma_f32 v82, -v16, v218, v82
    v_mfma_f32_16x16x32_bf16 v[104:107], v[160:163], v[144:147], v[104:107]
    ds_read_b64_tr_b16 v[140:141], v25 offset:10240
    v_fma_f32 v83, -v16, v219, v83
    v_mfma_f32_16x16x32_bf16 v[108:111], v[164:167], v[144:147], v[108:111]
    ds_read_b64_tr_b16 v[142:143], v25 offset:10752
    v_fma_f32 v84, -v18, v216, v84
    v_fma_f32 v85, -v18, v217, v85
    v_mfma_f32_16x16x32_bf16 v[124:127], v[164:167], v[148:151], v[124:127]
    ds_read_b64_tr_b16 v[144:145], v24 offset:18432
    v_fma_f32 v86, -v18, v218, v86
    v_mfma_f32_16x16x32_bf16 v[120:123], v[160:163], v[148:151], v[120:123]
    ds_read_b64_tr_b16 v[146:147], v24 offset:18944
    v_fma_f32 v87, -v18, v219, v87
    s_waitcnt vmcnt(10) lgkmcnt(8)
    v_mfma_f32_16x16x32_bf16 v[184:187], v[188:191], v[192:195], v[184:187]
    v_mfma_f32_16x16x32_bf16 v[32:35], v[128:131], v[168:171], v[32:35]
    ds_read_b64_tr_b16 v[148:149], v25 offset:18432
    v_fma_f32 v72, -v20, v212, v72
    v_fma_f32 v73, -v20, v213, v73
    v_mfma_f32_16x16x32_bf16 v[36:39], v[128:131], v[172:175], v[36:39]
    ds_read_b64_tr_b16 v[150:151], v25 offset:18944
    v_fma_f32 v74, -v20, v214, v74
    s_waitcnt lgkmcnt(8)
    v_mfma_f32_16x16x32_bf16 v[52:55], v[132:135], v[172:175], v[52:55]
    v_fma_f32 v75, -v20, v215, v75
    ds_read_b128 v[152:155], v10 offset:0
    v_mfma_f32_16x16x32_bf16 v[48:51], v[132:135], v[168:171], v[48:51]
    ds_read_b64_tr_b16 v[188:189], v28 offset:2048
    v_fma_f32 v76, -v22, v212, v76
    v_fma_f32 v77, -v22, v213, v77
    ds_read_b128 v[156:159], v10 offset:64
    s_waitcnt lgkmcnt(9)
    v_mfma_f32_16x16x32_bf16 v[64:67], v[136:139], v[168:171], v[64:67]
    v_fma_f32 v78, -v22, v214, v78
    ds_read_b32 v17, v8 offset:2816
    v_mfma_f32_16x16x32_bf16 v[68:71], v[136:139], v[172:175], v[68:71]
    ds_read_b64_tr_b16 v[190:191], v28 offset:2560
    v_fma_f32 v79, -v22, v215, v79
    s_waitcnt lgkmcnt(9)
    v_mfma_f32_16x16x32_bf16 v[84:87], v[140:143], v[172:175], v[84:87]
    v_fma_f32 v88, -v20, v216, v88
    v_fma_f32 v89, -v20, v217, v89
    ds_read_b32 v19, v8 offset:2880
    v_mfma_f32_16x16x32_bf16 v[80:83], v[140:143], v[168:171], v[80:83]
    ds_read_b128 v[192:195], v30 offset:1024
    v_fma_f32 v90, -v20, v218, v90
    ds_read_b32 v21, v8 offset:2944
    s_waitcnt lgkmcnt(10)
    v_mfma_f32_16x16x32_bf16 v[96:99], v[168:171], v[144:147], v[96:99]
    v_fma_f32 v91, -v20, v219, v91
    ds_read_b32 v23, v8 offset:3008
    v_mfma_f32_16x16x32_bf16 v[100:103], v[172:175], v[144:147], v[100:103]
    v_fma_f32 v92, -v22, v216, v92
    v_fma_f32 v93, -v22, v217, v93
    s_waitcnt lgkmcnt(9)
    v_mfma_f32_16x16x32_bf16 v[116:119], v[172:175], v[148:151], v[116:119]
    v_fma_f32 v94, -v22, v218, v94
    v_mfma_f32_16x16x32_bf16 v[112:115], v[168:171], v[148:151], v[112:115]
    v_fma_f32 v95, -v22, v219, v95
    s_waitcnt vmcnt(8)
    v_mfma_f32_16x16x32_bf16 v[40:43], v[128:131], v[176:179], v[40:43]
    s_waitcnt lgkmcnt(0)
    v_fma_f32 v32, -v16, v152, v32
    v_fma_f32 v33, -v16, v153, v33
    v_mfma_f32_16x16x32_bf16 v[44:47], v[128:131], v[180:183], v[44:47]
    v_fma_f32 v34, -v16, v154, v34
    v_mfma_f32_16x16x32_bf16 v[60:63], v[132:135], v[180:183], v[60:63]
    ds_read_b64_tr_b16 v[128:129], v24 offset:4096
    v_fma_f32 v35, -v16, v155, v35
    v_fma_f32 v36, -v18, v152, v36
    v_mfma_f32_16x16x32_bf16 v[56:59], v[132:135], v[176:179], v[56:59]
    ds_read_b64_tr_b16 v[130:131], v24 offset:4608
    v_fma_f32 v37, -v18, v153, v37
    v_mfma_f32_16x16x32_bf16 v[72:75], v[136:139], v[176:179], v[72:75]
    ds_read_b64_tr_b16 v[132:133], v25 offset:4096
    v_fma_f32 v38, -v18, v154, v38
    v_fma_f32 v39, -v18, v155, v39
    v_mfma_f32_16x16x32_bf16 v[76:79], v[136:139], v[180:183], v[76:79]
    ds_read_b64_tr_b16 v[134:135], v25 offset:4608
    v_fma_f32 v48, -v16, v156, v48
    v_mfma_f32_16x16x32_bf16 v[92:95], v[140:143], v[180:183], v[92:95]
    ds_read_b64_tr_b16 v[136:137], v24 offset:12288
    v_fma_f32 v49, -v16, v157, v49
    v_fma_f32 v50, -v16, v158, v50
    v_mfma_f32_16x16x32_bf16 v[88:91], v[140:143], v[176:179], v[88:91]
    ds_read_b64_tr_b16 v[138:139], v24 offset:12800
    v_fma_f32 v51, -v16, v159, v51
    v_mfma_f32_16x16x32_bf16 v[104:107], v[176:179], v[144:147], v[104:107]
    ds_read_b64_tr_b16 v[140:141], v25 offset:12288
    v_fma_f32 v52, -v18, v156, v52
    v_fma_f32 v53, -v18, v157, v53
    v_mfma_f32_16x16x32_bf16 v[108:111], v[180:183], v[144:147], v[108:111]
    ds_read_b64_tr_b16 v[142:143], v25 offset:12800
    v_fma_f32 v54, -v18, v158, v54
    v_mfma_f32_16x16x32_bf16 v[124:127], v[180:183], v[148:151], v[124:127]
    ds_read_b64_tr_b16 v[144:145], v24 offset:20480
    v_fma_f32 v55, -v18, v159, v55
    v_mfma_f32_16x16x32_bf16 v[120:123], v[176:179], v[148:151], v[120:123]
    ds_read_b64_tr_b16 v[146:147], v24 offset:20992
    s_waitcnt vmcnt(6) lgkmcnt(8)
    v_mfma_f32_16x16x32_bf16 v[184:187], v[188:191], v[192:195], v[184:187]
    v_mfma_f32_16x16x32_bf16 v[32:35], v[128:131], a[0:3], v[32:35]
    ds_read_b64_tr_b16 v[148:149], v25 offset:20480
    v_fma_f32 v40, -v20, v152, v40
    v_fma_f32 v41, -v20, v153, v41
    v_mfma_f32_16x16x32_bf16 v[36:39], v[128:131], a[4:7], v[36:39]
    ds_read_b64_tr_b16 v[150:151], v25 offset:20992
    v_fma_f32 v42, -v20, v154, v42
    s_waitcnt lgkmcnt(8)
    v_mfma_f32_16x16x32_bf16 v[52:55], v[132:135], a[4:7], v[52:55]
    v_fma_f32 v43, -v20, v155, v43
    v_fma_f32 v44, -v22, v152, v44
    ds_read_b128 v[168:171], v9 offset:1280
    v_mfma_f32_16x16x32_bf16 v[48:51], v[132:135], a[0:3], v[48:51]
    ds_read_b64_tr_b16 v[188:189], v28 offset:4096
    v_fma_f32 v45, -v22, v153, v45
    ds_read_b128 v[172:175], v9 offset:1344
    s_waitcnt lgkmcnt(9)
    v_mfma_f32_16x16x32_bf16 v[64:67], v[136:139], a[0:3], v[64:67]
    v_fma_f32 v46, -v22, v154, v46
    v_fma_f32 v47, -v22, v155, v47
    v_mfma_f32_16x16x32_bf16 v[68:71], v[136:139], a[4:7], v[68:71]
    ds_read_b64_tr_b16 v[190:191], v28 offset:4608
    v_fma_f32 v56, -v20, v156, v56
    ds_read_b128 v[176:179], v9 offset:1408
    s_waitcnt lgkmcnt(9)
    v_mfma_f32_16x16x32_bf16 v[84:87], v[140:143], a[4:7], v[84:87]
    v_fma_f32 v57, -v20, v157, v57
    v_fma_f32 v58, -v20, v158, v58
    ds_read_b128 v[180:183], v9 offset:1472
    v_mfma_f32_16x16x32_bf16 v[80:83], v[140:143], a[0:3], v[80:83]
    ds_read_b128 v[192:195], v30 offset:2048
    v_fma_f32 v59, -v20, v159, v59
    s_waitcnt lgkmcnt(9)
    v_mfma_f32_16x16x32_bf16 v[96:99], a[0:3], v[144:147], v[96:99]
    v_fma_f32 v60, -v22, v156, v60
    v_fma_f32 v61, -v22, v157, v61
    ds_read2_b32 v[220:221], v11 offset0:64 offset1:80
    v_mfma_f32_16x16x32_bf16 v[100:103], a[4:7], v[144:147], v[100:103]
    v_fma_f32 v62, -v22, v158, v62
    s_waitcnt lgkmcnt(8)
    v_mfma_f32_16x16x32_bf16 v[116:119], a[4:7], v[148:151], v[116:119]
    v_fma_f32 v63, -v22, v159, v63
    v_mfma_f32_16x16x32_bf16 v[112:115], a[0:3], v[148:151], v[112:115]
    s_waitcnt vmcnt(4)
    v_mfma_f32_16x16x32_bf16 v[40:43], v[128:131], a[8:11], v[40:43]
    v_mfma_f32_16x16x32_bf16 v[44:47], v[128:131], a[12:15], v[44:47]
    s_waitcnt lgkmcnt(0)
    v_fma_f32 v96, -v168, v220, v96
    v_fma_f32 v97, -v169, v220, v97
    v_mfma_f32_16x16x32_bf16 v[60:63], v[132:135], a[12:15], v[60:63]
    ds_read_b64_tr_b16 v[128:129], v24 offset:6144
    v_fma_f32 v98, -v170, v220, v98
    v_mfma_f32_16x16x32_bf16 v[56:59], v[132:135], a[8:11], v[56:59]
    ds_read_b64_tr_b16 v[130:131], v24 offset:6656
    v_fma_f32 v99, -v171, v220, v99
    v_fma_f32 v100, -v172, v220, v100
    v_mfma_f32_16x16x32_bf16 v[72:75], v[136:139], a[8:11], v[72:75]
    ds_read_b64_tr_b16 v[132:133], v25 offset:6144
    v_fma_f32 v101, -v173, v220, v101
    v_mfma_f32_16x16x32_bf16 v[76:79], v[136:139], a[12:15], v[76:79]
    ds_read_b64_tr_b16 v[134:135], v25 offset:6656
    v_fma_f32 v102, -v174, v220, v102
    v_fma_f32 v103, -v175, v220, v103
    v_mfma_f32_16x16x32_bf16 v[92:95], v[140:143], a[12:15], v[92:95]
    ds_read_b64_tr_b16 v[136:137], v24 offset:14336
    v_fma_f32 v112, -v168, v221, v112
    v_mfma_f32_16x16x32_bf16 v[88:91], v[140:143], a[8:11], v[88:91]
    ds_read_b64_tr_b16 v[138:139], v24 offset:14848
    v_fma_f32 v113, -v169, v221, v113
    v_fma_f32 v114, -v170, v221, v114
    v_mfma_f32_16x16x32_bf16 v[104:107], a[8:11], v[144:147], v[104:107]
    ds_read_b64_tr_b16 v[140:141], v25 offset:14336
    v_fma_f32 v115, -v171, v221, v115
    v_mfma_f32_16x16x32_bf16 v[108:111], a[12:15], v[144:147], v[108:111]
    ds_read_b64_tr_b16 v[142:143], v25 offset:14848
    v_fma_f32 v116, -v172, v221, v116
    v_fma_f32 v117, -v173, v221, v117
    v_mfma_f32_16x16x32_bf16 v[124:127], a[12:15], v[148:151], v[124:127]
    ds_read_b64_tr_b16 v[144:145], v24 offset:22528
    v_fma_f32 v118, -v174, v221, v118
    v_mfma_f32_16x16x32_bf16 v[120:123], a[8:11], v[148:151], v[120:123]
    ds_read_b64_tr_b16 v[146:147], v24 offset:23040
    v_fma_f32 v119, -v175, v221, v119
    s_waitcnt vmcnt(2) lgkmcnt(8)
    v_mfma_f32_16x16x32_bf16 v[184:187], v[188:191], v[192:195], v[184:187]
    v_mfma_f32_16x16x32_bf16 v[32:35], v[128:131], a[16:19], v[32:35]
    ds_read_b64_tr_b16 v[148:149], v25 offset:22528
    v_mfma_f32_16x16x32_bf16 v[36:39], v[128:131], a[20:23], v[36:39]
    ds_read_b64_tr_b16 v[150:151], v25 offset:23040
    v_fma_f32 v104, -v176, v220, v104
    v_fma_f32 v105, -v177, v220, v105
    s_waitcnt lgkmcnt(8)
    v_mfma_f32_16x16x32_bf16 v[52:55], v[132:135], a[20:23], v[52:55]
    v_fma_f32 v106, -v178, v220, v106
    ds_read_b128 v[152:155], v9 offset:2816
    v_mfma_f32_16x16x32_bf16 v[48:51], v[132:135], a[16:19], v[48:51]
    ds_read_b64_tr_b16 v[188:189], v28 offset:6144
    v_fma_f32 v107, -v179, v220, v107
    v_fma_f32 v108, -v180, v220, v108
    ds_read_b128 v[156:159], v9 offset:2880
    s_waitcnt lgkmcnt(9)
    v_mfma_f32_16x16x32_bf16 v[64:67], v[136:139], a[16:19], v[64:67]
    v_fma_f32 v109, -v181, v220, v109
    ds_read_b128 v[160:163], v9 offset:2944
    v_mfma_f32_16x16x32_bf16 v[68:71], v[136:139], a[20:23], v[68:71]
    ds_read_b64_tr_b16 v[190:191], v28 offset:6656
    v_fma_f32 v110, -v182, v220, v110
    v_fma_f32 v111, -v183, v220, v111
    ds_read_b128 v[164:167], v9 offset:3008
    s_waitcnt lgkmcnt(10)
    v_mfma_f32_16x16x32_bf16 v[84:87], v[140:143], a[20:23], v[84:87]
    v_fma_f32 v120, -v176, v221, v120
    ds_read_b128 v[212:215], v14 offset:128
    v_mfma_f32_16x16x32_bf16 v[80:83], v[140:143], a[16:19], v[80:83]
    ds_read_b128 v[192:195], v30 offset:3072
    v_fma_f32 v121, -v177, v221, v121
    v_fma_f32 v122, -v178, v221, v122
    ds_read_b32 v222, v11 offset:1216
    s_waitcnt lgkmcnt(11)
    v_mfma_f32_16x16x32_bf16 v[96:99], a[16:19], v[144:147], v[96:99]
    v_fma_f32 v123, -v179, v221, v123
    ds_read_b32 v223, v11 offset:2752
    v_mfma_f32_16x16x32_bf16 v[100:103], a[20:23], v[144:147], v[100:103]
    v_fma_f32 v124, -v180, v221, v124
    v_fma_f32 v125, -v181, v221, v125
    s_waitcnt lgkmcnt(10)
    v_mfma_f32_16x16x32_bf16 v[116:119], a[20:23], v[148:151], v[116:119]
    v_fma_f32 v126, -v182, v221, v126
    v_mfma_f32_16x16x32_bf16 v[112:115], a[16:19], v[148:151], v[112:115]
    v_fma_f32 v127, -v183, v221, v127
    s_waitcnt vmcnt(0) lgkmcnt(2)
    v_mfma_f32_16x16x32_bf16 v[40:43], v[128:131], a[24:27], v[40:43]
    v_mul_f32 v64, v17, v64
    v_mul_f32 v65, v17, v65
    s_barrier
    v_mfma_f32_16x16x32_bf16 v[44:47], v[128:131], a[28:31], v[44:47]
    v_mul_f32 v66, v17, v66
    v_mul_f32 v67, v17, v67
    v_mfma_f32_16x16x32_bf16 v[60:63], v[132:135], a[28:31], v[60:63]
    v_mul_f32 v80, v17, v80
    v_mul_f32 v81, v17, v81
    v_mfma_f32_16x16x32_bf16 v[56:59], v[132:135], a[24:27], v[56:59]
    v_mul_f32 v82, v17, v82
    v_mul_f32 v83, v17, v83
    v_mfma_f32_16x16x32_bf16 v[72:75], v[136:139], a[24:27], v[72:75]
    v_cvt_pk_bf16_f32 v64, v64, v65
    v_cvt_pk_bf16_f32 v65, v66, v67
    v_mfma_f32_16x16x32_bf16 v[76:79], v[136:139], a[28:31], v[76:79]
    v_cvt_pk_bf16_f32 v66, v80, v81
    v_cvt_pk_bf16_f32 v67, v82, v83
    v_mfma_f32_16x16x32_bf16 v[92:95], v[140:143], a[28:31], v[92:95]
    v_mul_f32 v68, v19, v68
    v_mul_f32 v69, v19, v69
    v_mfma_f32_16x16x32_bf16 v[88:91], v[140:143], a[24:27], v[88:91]
    v_mul_f32 v70, v19, v70
    v_mul_f32 v71, v19, v71
    v_mfma_f32_16x16x32_bf16 v[104:107], a[24:27], v[144:147], v[104:107]
    v_mul_f32 v84, v19, v84
    v_mul_f32 v85, v19, v85
    v_mfma_f32_16x16x32_bf16 v[108:111], a[28:31], v[144:147], v[108:111]
    v_mul_f32 v86, v19, v86
    v_mul_f32 v87, v19, v87
    v_mfma_f32_16x16x32_bf16 v[124:127], a[28:31], v[148:151], v[124:127]
    v_cvt_pk_bf16_f32 v68, v68, v69
    v_cvt_pk_bf16_f32 v69, v70, v71
    v_mfma_f32_16x16x32_bf16 v[120:123], a[24:27], v[148:151], v[120:123]
    v_cvt_pk_bf16_f32 v70, v84, v85
    v_cvt_pk_bf16_f32 v71, v86, v87
    v_mfma_f32_16x16x32_bf16 v[184:187], v[188:191], v[192:195], v[184:187]
    v_pk_mul_f32 v[72:73], v[20:21], v[72:73] op_sel:[1,0] op_sel_hi:[1,1]
    v_pk_mul_f32 v[74:75], v[20:21], v[74:75] op_sel:[1,0] op_sel_hi:[1,1]
    v_pk_mul_f32 v[88:89], v[20:21], v[88:89] op_sel:[1,0] op_sel_hi:[1,1]
    v_pk_mul_f32 v[90:91], v[20:21], v[90:91] op_sel:[1,0] op_sel_hi:[1,1]
    v_cvt_pk_bf16_f32 v72, v72, v73
    v_cvt_pk_bf16_f32 v73, v74, v75
    v_cvt_pk_bf16_f32 v74, v88, v89
    v_cvt_pk_bf16_f32 v75, v90, v91
    v_pk_mul_f32 v[76:77], v[22:23], v[76:77] op_sel:[1,0] op_sel_hi:[1,1]
    v_pk_mul_f32 v[78:79], v[22:23], v[78:79] op_sel:[1,0] op_sel_hi:[1,1]
    v_pk_mul_f32 v[92:93], v[22:23], v[92:93] op_sel:[1,0] op_sel_hi:[1,1]
    v_pk_mul_f32 v[94:95], v[22:23], v[94:95] op_sel:[1,0] op_sel_hi:[1,1]
    v_cvt_pk_bf16_f32 v76, v76, v77
    v_cvt_pk_bf16_f32 v77, v78, v79
    v_cvt_pk_bf16_f32 v78, v92, v93
    v_cvt_pk_bf16_f32 v79, v94, v95
    ds_write_b128 v12, v[76:79] offset:2048
    s_waitcnt lgkmcnt(1)
    v_pk_mul_f32 v[96:97], v[152:153], v[96:97]
    v_pk_mul_f32 v[98:99], v[154:155], v[98:99]
    v_pk_mul_f32 v[112:113], v[152:153], v[112:113]
    v_pk_mul_f32 v[114:115], v[154:155], v[114:115]
    v_cvt_pk_bf16_f32 v99, v98, v99
    v_cvt_pk_bf16_f32 v98, v96, v97
    v_cvt_pk_bf16_f32 v115, v114, v115
    v_cvt_pk_bf16_f32 v114, v112, v113
    v_pk_mul_f32 v[100:101], v[156:157], v[100:101]
    v_pk_mul_f32 v[102:103], v[158:159], v[102:103]
    v_pk_mul_f32 v[116:117], v[156:157], v[116:117]
    v_pk_mul_f32 v[118:119], v[158:159], v[118:119]
    v_cvt_pk_bf16_f32 v100, v100, v101
    v_cvt_pk_bf16_f32 v101, v102, v103
    v_cvt_pk_bf16_f32 v116, v116, v117
    v_cvt_pk_bf16_f32 v117, v118, v119
    v_pk_mul_f32 v[104:105], v[160:161], v[104:105]
    v_pk_mul_f32 v[106:107], v[162:163], v[106:107]
    v_pk_mul_f32 v[120:121], v[160:161], v[120:121]
    v_pk_mul_f32 v[122:123], v[162:163], v[122:123]
    v_cvt_pk_bf16_f32 v102, v104, v105
    v_cvt_pk_bf16_f32 v103, v106, v107
    v_cvt_pk_bf16_f32 v118, v120, v121
    v_cvt_pk_bf16_f32 v119, v122, v123
    v_pk_mul_f32 v[108:109], v[164:165], v[108:109]
    v_pk_mul_f32 v[110:111], v[166:167], v[110:111]
    v_pk_mul_f32 v[124:125], v[164:165], v[124:125]
    v_pk_mul_f32 v[126:127], v[166:167], v[126:127]
    v_cvt_pk_bf16_f32 v104, v108, v109
    v_cvt_pk_bf16_f32 v105, v110, v111
    v_cvt_pk_bf16_f32 v120, v124, v125
    v_cvt_pk_bf16_f32 v121, v126, v127
    ds_write_b64 v12, v[104:105] offset:3072
    ds_write_b64 v12, v[120:121] offset:3080
    v_pk_fma_f32 v[184:185], v[222:223], v[212:213], v[184:185] op_sel_hi:[0,1,1] neg_lo:[1,0,0] neg_hi:[1,0,0]
    v_pk_fma_f32 v[186:187], v[222:223], v[214:215], v[186:187] op_sel_hi:[0,1,1] neg_lo:[1,0,0] neg_hi:[1,0,0]
    v_pk_mul_f32 v[184:185], v[222:223], v[184:185] op_sel:[1,0] op_sel_hi:[1,1]
    v_pk_mul_f32 v[186:187], v[222:223], v[186:187] op_sel:[1,0] op_sel_hi:[1,1]
    v_cvt_pk_bf16_f32 v184, v184, v185
    v_cvt_pk_bf16_f32 v185, v186, v187
    s_cmp_ge_u32 s8, 2
    s_cbranch_scc1 c_qkvA_hv
    ds_write_b64 v13, v[184:185]
    s_branch c_qkvA_hd
c_qkvA_hv:
    ds_write_b16 v13, v184 offset:0
    ds_write_b16_d16_hi v13, v184 offset:16
    ds_write_b16 v13, v185 offset:32
    ds_write_b16_d16_hi v13, v185 offset:48
c_qkvA_hd:
    v_cvt_pk_bf16_f32 v44, v44, v45
    v_cvt_pk_bf16_f32 v45, v46, v47
    v_cvt_pk_bf16_f32 v46, v60, v61
    v_cvt_pk_bf16_f32 v47, v62, v63
    v_mul_f32 v23, 0x3e8293ee, v23
    v_cvt_pk_bf16_f32 v40, v40, v41
    v_cvt_pk_bf16_f32 v41, v42, v43
    v_cvt_pk_bf16_f32 v42, v56, v57
    v_cvt_pk_bf16_f32 v43, v58, v59
    v_mul_f32 v21, 0x3e8293ee, v21
    s_waitcnt lgkmcnt(0)
    s_barrier
    ds_read_b128 v[172:175], v12
    ds_read_b64 v[96:97], v12 offset:1024
    ds_read_b64 v[112:113], v12 offset:1032
    v_mfma_f32_16x16x32_bf16 v[156:159], v[76:79], v[44:47], v[196:199]
    v_mfma_f32_16x16x32_bf16 v[152:155], v[72:75], v[44:47], v[200:203]
    v_cvt_pk_bf16_f32 v36, v36, v37
    v_cvt_pk_bf16_f32 v37, v38, v39
    v_cvt_pk_bf16_f32 v38, v52, v53
    v_cvt_pk_bf16_f32 v39, v54, v55
    v_mul_f32 v19, 0x3e8293ee, v19
    v_mfma_f32_16x16x32_bf16 v[148:151], v[72:75], v[40:43], v[196:199]
    v_mfma_f32_16x16x32_bf16 v[144:147], v[68:71], v[40:43], v[200:203]
    v_cvt_pk_bf16_f32 v32, v32, v33
    v_cvt_pk_bf16_f32 v33, v34, v35
    v_cvt_pk_bf16_f32 v34, v48, v49
    v_cvt_pk_bf16_f32 v35, v50, v51
    v_mul_f32 v17, 0x3e8293ee, v17
    v_mfma_f32_16x16x32_bf16 v[140:143], v[68:71], v[36:39], v[196:199]
    v_mfma_f32_16x16x32_bf16 v[136:139], v[64:67], v[36:39], v[200:203]
    s_waitcnt lgkmcnt(2)
    v_mfma_f32_16x16x32_bf16 v[132:135], v[64:67], v[32:35], v[196:199]
    v_mfma_f32_16x16x32_bf16 v[128:131], v[172:175], v[32:35], v[204:207]
    v_max3_f32 v179, v152, v153, v154
    v_max3_f32 v183, v155, v156, v157
    v_max3_f32 v179, v179, v158, v159
    v_max_f32 v179, v179, v183
    v_max3_f32 v178, v144, v145, v146
    v_max3_f32 v182, v147, v148, v149
    v_max3_f32 v178, v178, v150, v151
    v_max_f32 v178, v178, v182
    v_max3_f32 v177, v136, v137, v138
    v_max3_f32 v181, v139, v140, v141
    v_max3_f32 v177, v177, v142, v143
    v_max_f32 v177, v177, v181
    v_max3_f32 v176, v128, v129, v130
    v_max3_f32 v180, v131, v132, v133
    v_max3_f32 v176, v176, v134, v135
    v_max_f32 v176, v176, v180
    v_mov_b32 v183, v179
    v_mov_b32 v182, v178
    v_mov_b32 v181, v177
    v_mov_b32 v180, v176
    v_permlane32_swap_b32 v179, v183
    v_permlane32_swap_b32 v178, v182
    v_permlane32_swap_b32 v177, v181
    v_permlane32_swap_b32 v176, v180
    v_max_f32 v179, v179, v183
    v_max_f32 v178, v178, v182
    v_max_f32 v177, v177, v181
    v_max_f32 v176, v176, v180
    v_mov_b32 v183, v179
    v_mov_b32 v182, v178
    v_mov_b32 v181, v177
    v_mov_b32 v180, v176
    v_permlane16_swap_b32 v179, v183
    v_permlane16_swap_b32 v178, v182
    v_permlane16_swap_b32 v177, v181
    v_permlane16_swap_b32 v176, v180
    v_max_f32 v179, v179, v183
    v_max_f32 v178, v178, v182
    v_max_f32 v177, v177, v181
    v_max_f32 v176, v176, v180
    v_mul_f32_e64 v22, -v179, v23
    v_mul_f32_e64 v20, -v178, v21
    v_mul_f32_e64 v18, -v177, v19
    v_mul_f32_e64 v16, -v176, v17
    s_waitcnt lgkmcnt(0)
    s_add_u32 s51, s49, 65536
    v_pk_fma_f32 v[152:153], v[152:153], v[22:23], v[22:23] op_sel:[0,1,0] op_sel_hi:[1,1,0]
    v_pk_fma_f32 v[154:155], v[154:155], v[22:23], v[22:23] op_sel:[0,1,0] op_sel_hi:[1,1,0]
    v_pk_fma_f32 v[156:157], v[156:157], v[22:23], v[22:23] op_sel:[0,1,0] op_sel_hi:[1,1,0]
    v_pk_fma_f32 v[158:159], v[158:159], v[22:23], v[22:23] op_sel:[0,1,0] op_sel_hi:[1,1,0]
    v_exp_f32 v152, v152
    v_exp_f32 v153, v153
    v_exp_f32 v154, v154
    v_exp_f32 v155, v155
    v_exp_f32 v156, v156
    v_exp_f32 v157, v157
    v_exp_f32 v158, v158
    v_exp_f32 v159, v159
    v_cvt_pk_bf16_f32 v172, v152, v153
    v_cvt_pk_bf16_f32 v173, v154, v155
    v_cvt_pk_bf16_f32 v174, v156, v157
    v_cvt_pk_bf16_f32 v175, v158, v159
    s_nop 1
    v_mfma_f32_16x16x32_bf16 v[92:95], v[208:211], v[172:175], 0
    v_mfma_f32_16x16x32_bf16 v[60:63], v[102:105], v[172:175], 0
    v_mfma_f32_16x16x32_bf16 v[76:79], v[118:121], v[172:175], 0
    v_pk_fma_f32 v[144:145], v[144:145], v[20:21], v[20:21] op_sel:[0,1,0] op_sel_hi:[1,1,0]
    v_pk_fma_f32 v[146:147], v[146:147], v[20:21], v[20:21] op_sel:[0,1,0] op_sel_hi:[1,1,0]
    v_pk_fma_f32 v[148:149], v[148:149], v[20:21], v[20:21] op_sel:[0,1,0] op_sel_hi:[1,1,0]
    v_pk_fma_f32 v[150:151], v[150:151], v[20:21], v[20:21] op_sel:[0,1,0] op_sel_hi:[1,1,0]
    v_exp_f32 v144, v144
    v_exp_f32 v145, v145
    v_exp_f32 v146, v146
    v_exp_f32 v147, v147
    v_exp_f32 v148, v148
    v_exp_f32 v149, v149
    v_exp_f32 v150, v150
    v_exp_f32 v151, v151
    v_cvt_pk_bf16_f32 v168, v144, v145
    v_cvt_pk_bf16_f32 v169, v146, v147
    v_cvt_pk_bf16_f32 v170, v148, v149
    v_cvt_pk_bf16_f32 v171, v150, v151
    v_rcp_f32 v92, v92
    s_nop 0
    v_pk_mul_f32 v[60:61], v[92:93], v[60:61] op_sel_hi:[0,1]
    v_pk_mul_f32 v[62:63], v[92:93], v[62:63] op_sel_hi:[0,1]
    v_pk_mul_f32 v[76:77], v[92:93], v[76:77] op_sel_hi:[0,1]
    v_pk_mul_f32 v[78:79], v[92:93], v[78:79] op_sel_hi:[0,1]
    v_cvt_pk_bf16_f32 v60, v60, v61
    v_cvt_pk_bf16_f32 v61, v62, v63
    v_cvt_pk_bf16_f32 v62, v76, v77
    v_cvt_pk_bf16_f32 v63, v78, v79
    s_nop 0
    v_permlane32_swap_b32 v60, v62
    v_permlane32_swap_b32 v61, v63
    buffer_store_dwordx4 v[60:63], v6, s[12:15], s51 offen offset:256 sc1
    v_mfma_f32_16x16x32_bf16 v[88:91], v[208:211], v[168:171], 0
    v_mfma_f32_16x16x32_bf16 v[56:59], v[100:103], v[168:171], 0
    v_mfma_f32_16x16x32_bf16 v[72:75], v[116:119], v[168:171], 0
    v_pk_fma_f32 v[136:137], v[136:137], v[18:19], v[18:19] op_sel:[0,1,0] op_sel_hi:[1,1,0]
    v_pk_fma_f32 v[138:139], v[138:139], v[18:19], v[18:19] op_sel:[0,1,0] op_sel_hi:[1,1,0]
    v_pk_fma_f32 v[140:141], v[140:141], v[18:19], v[18:19] op_sel:[0,1,0] op_sel_hi:[1,1,0]
    v_pk_fma_f32 v[142:143], v[142:143], v[18:19], v[18:19] op_sel:[0,1,0] op_sel_hi:[1,1,0]
    v_exp_f32 v136, v136
    v_exp_f32 v137, v137
    v_exp_f32 v138, v138
    v_exp_f32 v139, v139
    v_exp_f32 v140, v140
    v_exp_f32 v141, v141
    v_exp_f32 v142, v142
    v_exp_f32 v143, v143
    v_cvt_pk_bf16_f32 v164, v136, v137
    v_cvt_pk_bf16_f32 v165, v138, v139
    v_cvt_pk_bf16_f32 v166, v140, v141
    v_cvt_pk_bf16_f32 v167, v142, v143
    v_rcp_f32 v88, v88
    s_nop 0
    v_pk_mul_f32 v[56:57], v[88:89], v[56:57] op_sel_hi:[0,1]
    v_pk_mul_f32 v[58:59], v[88:89], v[58:59] op_sel_hi:[0,1]
    v_pk_mul_f32 v[72:73], v[88:89], v[72:73] op_sel_hi:[0,1]
    v_pk_mul_f32 v[74:75], v[88:89], v[74:75] op_sel_hi:[0,1]
    v_cvt_pk_bf16_f32 v56, v56, v57
    v_cvt_pk_bf16_f32 v57, v58, v59
    v_cvt_pk_bf16_f32 v58, v72, v73
    v_cvt_pk_bf16_f32 v59, v74, v75
    s_nop 0
    v_permlane32_swap_b32 v56, v58
    v_permlane32_swap_b32 v57, v59
    buffer_store_dwordx4 v[56:59], v6, s[12:15], s51 offen offset:0 sc1
    v_mfma_f32_16x16x32_bf16 v[84:87], v[208:211], v[164:167], 0
    v_mfma_f32_16x16x32_bf16 v[52:55], v[98:101], v[164:167], 0
    v_mfma_f32_16x16x32_bf16 v[68:71], v[114:117], v[164:167], 0
    v_pk_fma_f32 v[128:129], v[128:129], v[16:17], v[16:17] op_sel:[0,1,0] op_sel_hi:[1,1,0]
    v_pk_fma_f32 v[130:131], v[130:131], v[16:17], v[16:17] op_sel:[0,1,0] op_sel_hi:[1,1,0]
    v_pk_fma_f32 v[132:133], v[132:133], v[16:17], v[16:17] op_sel:[0,1,0] op_sel_hi:[1,1,0]
    v_pk_fma_f32 v[134:135], v[134:135], v[16:17], v[16:17] op_sel:[0,1,0] op_sel_hi:[1,1,0]
    v_exp_f32 v128, v128
    v_exp_f32 v129, v129
    v_exp_f32 v130, v130
    v_exp_f32 v131, v131
    v_exp_f32 v132, v132
    v_exp_f32 v133, v133
    v_exp_f32 v134, v134
    v_exp_f32 v135, v135
    v_cvt_pk_bf16_f32 v160, v128, v129
    v_cvt_pk_bf16_f32 v161, v130, v131
    v_cvt_pk_bf16_f32 v162, v132, v133
    v_cvt_pk_bf16_f32 v163, v134, v135
    v_rcp_f32 v84, v84
    s_nop 0
    v_pk_mul_f32 v[52:53], v[84:85], v[52:53] op_sel_hi:[0,1]
    v_pk_mul_f32 v[54:55], v[84:85], v[54:55] op_sel_hi:[0,1]
    v_pk_mul_f32 v[68:69], v[84:85], v[68:69] op_sel_hi:[0,1]
    v_pk_mul_f32 v[70:71], v[84:85], v[70:71] op_sel_hi:[0,1]
    v_cvt_pk_bf16_f32 v52, v52, v53
    v_cvt_pk_bf16_f32 v53, v54, v55
    v_cvt_pk_bf16_f32 v54, v68, v69
    v_cvt_pk_bf16_f32 v55, v70, v71
    s_nop 0
    v_permlane32_swap_b32 v52, v54
    v_permlane32_swap_b32 v53, v55
    buffer_store_dwordx4 v[52:55], v6, s[12:15], s49 offen offset:256 sc1
    v_mfma_f32_16x16x32_bf16 v[80:83], v[208:211], v[160:163], 0
    v_mfma_f32_16x16x32_bf16 v[48:51], v[96:99], v[160:163], 0
    v_mfma_f32_16x16x32_bf16 v[64:67], v[112:115], v[160:163], 0
    s_nop 5
    v_rcp_f32 v80, v80
    s_nop 0
    v_pk_mul_f32 v[48:49], v[80:81], v[48:49] op_sel_hi:[0,1]
    v_pk_mul_f32 v[50:51], v[80:81], v[50:51] op_sel_hi:[0,1]
    v_pk_mul_f32 v[64:65], v[80:81], v[64:65] op_sel_hi:[0,1]
    v_pk_mul_f32 v[66:67], v[80:81], v[66:67] op_sel_hi:[0,1]
    v_cvt_pk_bf16_f32 v48, v48, v49
    v_cvt_pk_bf16_f32 v49, v50, v51
    v_cvt_pk_bf16_f32 v50, v64, v65
    v_cvt_pk_bf16_f32 v51, v66, v67
    s_nop 0
    v_permlane32_swap_b32 v48, v50
    v_permlane32_swap_b32 v49, v51
    buffer_store_dwordx4 v[48:51], v6, s[12:15], s49 offen offset:0 sc1
    s_branch c_wo
.p2align 6
c_wo:
    v_and_b32 v1, 63, v0
    v_lshrrev_b32 v2, 6, v0
    v_lshlrev_b32 v5, 4, v1
    v_lshrrev_b32 v3, 5, v1
    s_lshl_b32 s48, s6, 2
    s_add_u32 s48, s48, s8
    s_lshl_b32 s55, s48, 16
    s_lshl_b32 s56, s9, 22
    s_add_u32 s55, s55, s56
    s_lshl_b32 s56, s7, 12
    s_add_u32 s58, s55, s56
    s_add_u32 s55, s55, 16777216
    s_add_u32 s16, s4, s55
    s_addc_u32 s17, s5, 0
    s_mov_b32 s18, 65536
    s_mov_b32 s19, 0x00020000
    s_lshl_b32 s60, s9, 2
    s_add_u32 s60, s60, 159504
    v_mov_b32 v28, s60
    s_mul_i32 s55, s9, 786432
    s_add_u32 s55, s55, 65798144
    v_and_b32 v24, 63, v0
    s_and_b32 s56, s11, 0xe0
    v_lshrrev_b32 v25, 5, v24
    v_add_u32 v24, s56, v24
    v_and_b32 v24, 255, v24
    v_lshlrev_b32 v24, 10, v24
    v_lshl_add_u32 v24, v25, 8, v24
    s_bfe_u32 s56, s11, 0x20003
    s_and_b32 s57, s11, 7
    s_lshl_b32 s56, s56, 7
    s_lshl_b32 s57, s57, 2
    s_add_u32 s55, s55, s56
    s_add_u32 s55, s55, s57
    v_mov_b32 v25, 159488
    v_mov_b32 v26, 1
    v_mov_b32 v27, s10
    v_and_b32 v4, 15, v0
    v_lshrrev_b32 v16, 2, v4
    v_lshl_add_u32 v16, v3, 2, v16
    v_lshlrev_b32 v16, 7, v16
    v_bfe_u32 v17, v1, 4, 1
    v_lshl_add_u32 v16, v17, 5, v16
    v_and_b32 v17, 3, v4
    v_lshl_add_u32 v16, v17, 3, v16
    v_lshrrev_b32 v17, 3, v4
    v_lshlrev_b32 v18, 6, v17
    v_add_u32 v12, v16, v18
    v_sub_u32 v13, v16, v18
    ds_read_b32 v29, v28
    buffer_load_dwordx4 v[96:99], v5, s[12:15], s58 offen offset:0 sc1
    buffer_load_dwordx4 v[100:103], v5, s[12:15], s58 offen offset:1024 sc1
    buffer_load_dwordx4 v[104:107], v5, s[12:15], s58 offen offset:2048 sc1
    buffer_load_dwordx4 v[108:111], v5, s[12:15], s58 offen offset:3072 sc1
    s_waitcnt lgkmcnt(0)
    v_readfirstlane_b32 s60, v29
    s_lshr_b32 s51, s60, 2
    s_and_b32 s51, s51, s60
    s_and_b32 s51, s51, 3
    s_cmp_eq_u32 s51, 0
    s_cbranch_scc1 c_wo_late
    s_and_b32 s52, s51, 1
    s_xor_b32 s52, s52, 1
    s_lshl_b32 s50, s52, 15
    buffer_load_dwordx4 v[112:115], v5, s[16:19], s50 offen offset:0 sc1
    buffer_load_dwordx4 v[116:119], v5, s[16:19], s50 offen offset:1024 sc1
    buffer_load_dwordx4 v[120:123], v5, s[16:19], s50 offen offset:2048 sc1
    buffer_load_dwordx4 v[124:127], v5, s[16:19], s50 offen offset:3072 sc1
    s_add_u32 s50, s50, 4096
    buffer_load_dwordx4 v[128:131], v5, s[16:19], s50 offen offset:0 sc1
    s_mov_b64 exec, 1
    s_waitcnt vmcnt(9)
    ds_add_rtn_u32 v26, v25, v26
    s_waitcnt lgkmcnt(0)
    v_readfirstlane_b32 s56, v26
    s_and_b32 s56, s56, 3
    s_cmp_lg_u32 s56, 3
    s_cbranch_scc1 pub_2
    s_mov_b32 exec_lo, -1
    buffer_store_dword v27, v24, s[12:15], s55 offen sc1
pub_2:
    s_mov_b64 exec, -1
    s_branch c_wo_run
c_wo_late:
    s_mov_b64 exec, 1
    s_waitcnt vmcnt(4)
    ds_add_rtn_u32 v26, v25, v26
    s_waitcnt lgkmcnt(0)
    v_readfirstlane_b32 s56, v26
    s_and_b32 s56, s56, 3
    s_cmp_lg_u32 s56, 3
    s_cbranch_scc1 pub_3
    s_mov_b32 exec_lo, -1
    buffer_store_dword v27, v24, s[12:15], s55 offen sc1
pub_3:
    s_mov_b64 exec, -1
    s_branch wp_4_t
wp_4:
    ds_read_b32 v29, v28
    s_waitcnt lgkmcnt(0)
    v_readfirstlane_b32 s60, v29
    s_lshr_b32 s51, s60, 2
    s_and_b32 s51, s51, s60
    s_and_b32 s51, s51, 3
wp_4_t:
    s_cmp_lg_u32 s51, 0
    s_cbranch_scc0 wp_4
    s_and_b32 s52, s51, 1
    s_xor_b32 s52, s52, 1
    s_lshl_b32 s50, s52, 15
    buffer_load_dwordx4 v[112:115], v5, s[16:19], s50 offen offset:0 sc1
    buffer_load_dwordx4 v[116:119], v5, s[16:19], s50 offen offset:1024 sc1
    buffer_load_dwordx4 v[120:123], v5, s[16:19], s50 offen offset:2048 sc1
    buffer_load_dwordx4 v[124:127], v5, s[16:19], s50 offen offset:3072 sc1
    s_add_u32 s50, s50, 4096
    buffer_load_dwordx4 v[128:131], v5, s[16:19], s50 offen offset:0 sc1
c_wo_run:
    buffer_load_dwordx4 v[132:135], v5, s[16:19], s50 offen offset:1024 sc1
    buffer_load_dwordx4 v[136:139], v5, s[16:19], s50 offen offset:2048 sc1
    buffer_load_dwordx4 v[140:143], v5, s[16:19], s50 offen offset:3072 sc1
    s_add_u32 s50, s50, 4096
    s_lshl_b32 s3, s52, 16
    v_add_u32 v12, s3, v12
    v_add_u32 v13, s3, v13
    v_xor_b32 v14, 0x10000, v12
    v_xor_b32 v15, 0x10000, v13
    s_cmp_eq_u32 s52, 0
    s_mov_b32 s3, 0x0c0c0c0c
    s_cselect_b32 s53, 0x01000c0c, s3
    s_cselect_b32 s54, 0x03020c0c, s3
    s_cselect_b32 s59, s3, 0x01000c0c
    s_cselect_b32 s97, s3, 0x03020c0c
    s_branch wp_5_t
wp_5:
    ds_read_b32 v29, v28
    s_waitcnt lgkmcnt(0)
    v_readfirstlane_b32 s60, v29
    s_lshr_b32 s51, s60, 2
    s_and_b32 s51, s51, s60
    s_and_b32 s51, s51, 3
wp_5_t:
    s_cmp_ge_u32 s60, 0xf0
    s_cbranch_scc0 wp_5
    ds_read_b64_tr_b16 v[64:65], v12 offset:0
    ds_read_b64_tr_b16 v[66:67], v12 offset:1024
    ds_read_b64_tr_b16 v[68:69], v13 offset:64
    ds_read_b64_tr_b16 v[70:71], v13 offset:1088
    ds_read_b64_tr_b16 v[72:73], v12 offset:2048
    ds_read_b64_tr_b16 v[74:75], v12 offset:3072
    ds_read_b64_tr_b16 v[76:77], v13 offset:2112
    ds_read_b64_tr_b16 v[78:79], v13 offset:3136
    ds_read_b64_tr_b16 v[80:81], v12 offset:4096
    ds_read_b64_tr_b16 v[82:83], v12 offset:5120
    ds_read_b64_tr_b16 v[84:85], v13 offset:4160
    ds_read_b64_tr_b16 v[86:87], v13 offset:5184
    s_waitcnt vmcnt(8)
    v_perm_b32 v32, v96, v96, s53
    v_perm_b32 v33, v96, v96, s54
    v_perm_b32 v34, v97, v97, s53
    v_perm_b32 v35, v97, v97, s54
    v_perm_b32 v36, v98, v98, s53
    v_perm_b32 v37, v98, v98, s54
    v_perm_b32 v38, v99, v99, s53
    v_perm_b32 v39, v99, v99, s54
    v_perm_b32 v40, v100, v100, s53
    v_perm_b32 v41, v100, v100, s54
    v_perm_b32 v42, v101, v101, s53
    v_perm_b32 v43, v101, v101, s54
    v_perm_b32 v44, v102, v102, s53
    v_perm_b32 v45, v102, v102, s54
    v_perm_b32 v46, v103, v103, s53
    v_perm_b32 v47, v103, v103, s54
    v_perm_b32 v48, v104, v104, s53
    v_perm_b32 v49, v104, v104, s54
    v_perm_b32 v50, v105, v105, s53
    v_perm_b32 v51, v105, v105, s54
    v_perm_b32 v52, v106, v106, s53
    v_perm_b32 v53, v106, v106, s54
    v_perm_b32 v54, v107, v107, s53
    v_perm_b32 v55, v107, v107, s54
    v_perm_b32 v56, v108, v108, s53
    v_perm_b32 v57, v108, v108, s54
    v_perm_b32 v58, v109, v109, s53
    v_perm_b32 v59, v109, v109, s54
    v_perm_b32 v60, v110, v110, s53
    v_perm_b32 v61, v110, v110, s54
    v_perm_b32 v62, v111, v111, s53
    v_perm_b32 v63, v111, v111, s54
    buffer_load_dwordx4 v[144:147], v5, s[16:19], s50 offen offset:0 sc1
    buffer_load_dwordx4 v[148:151], v5, s[16:19], s50 offen offset:1024 sc1
    buffer_load_dwordx4 v[152:155], v5, s[16:19], s50 offen offset:2048 sc1
    buffer_load_dwordx4 v[156:159], v5, s[16:19], s50 offen offset:3072 sc1
    s_add_u32 s50, s50, 4096
    buffer_load_dwordx4 v[160:163], v5, s[16:19], s50 offen offset:0 sc1
    buffer_load_dwordx4 v[164:167], v5, s[16:19], s50 offen offset:1024 sc1
    buffer_load_dwordx4 v[168:171], v5, s[16:19], s50 offen offset:2048 sc1
    s_waitcnt vmcnt(14) lgkmcnt(8)
    v_mfma_f32_32x32x16_bf16 v[32:47], v[64:67], v[112:115], v[32:47]
    ds_read_b64_tr_b16 v[88:89], v12 offset:6144
    ds_read_b64_tr_b16 v[90:91], v12 offset:7168
    buffer_load_dwordx4 v[172:175], v5, s[16:19], s50 offen offset:3072 sc1
    s_add_u32 s50, s50, 4096
    v_perm_b32 v176, v96, v96, s59
    v_mfma_f32_32x32x16_bf16 v[48:63], v[68:71], v[112:115], v[48:63]
    ds_read_b64_tr_b16 v[92:93], v13 offset:6208
    ds_read_b64_tr_b16 v[94:95], v13 offset:7232
    v_perm_b32 v177, v96, v96, s97
    s_waitcnt vmcnt(14) lgkmcnt(8)
    v_mfma_f32_32x32x16_bf16 v[32:47], v[72:75], v[116:119], v[32:47]
    ds_read_b64_tr_b16 v[64:65], v12 offset:8192
    ds_read_b64_tr_b16 v[66:67], v12 offset:9216
    buffer_load_dwordx4 v[112:115], v5, s[16:19], s50 offen offset:0 sc1
    v_perm_b32 v178, v97, v97, s59
    v_mfma_f32_32x32x16_bf16 v[48:63], v[76:79], v[116:119], v[48:63]
    ds_read_b64_tr_b16 v[68:69], v13 offset:8256
    ds_read_b64_tr_b16 v[70:71], v13 offset:9280
    v_perm_b32 v179, v97, v97, s97
    s_waitcnt vmcnt(14) lgkmcnt(8)
    v_mfma_f32_32x32x16_bf16 v[32:47], v[80:83], v[120:123], v[32:47]
    ds_read_b64_tr_b16 v[72:73], v12 offset:10240
    ds_read_b64_tr_b16 v[74:75], v12 offset:11264
    buffer_load_dwordx4 v[116:119], v5, s[16:19], s50 offen offset:1024 sc1
    v_perm_b32 v180, v98, v98, s59
    v_mfma_f32_32x32x16_bf16 v[48:63], v[84:87], v[120:123], v[48:63]
    ds_read_b64_tr_b16 v[76:77], v13 offset:10304
    ds_read_b64_tr_b16 v[78:79], v13 offset:11328
    v_perm_b32 v181, v98, v98, s97
    s_waitcnt vmcnt(14) lgkmcnt(8)
    v_mfma_f32_32x32x16_bf16 v[32:47], v[88:91], v[124:127], v[32:47]
    ds_read_b64_tr_b16 v[80:81], v12 offset:12288
    ds_read_b64_tr_b16 v[82:83], v12 offset:13312
    buffer_load_dwordx4 v[120:123], v5, s[16:19], s50 offen offset:2048 sc1
    v_perm_b32 v182, v99, v99, s59
    v_mfma_f32_32x32x16_bf16 v[48:63], v[92:95], v[124:127], v[48:63]
    ds_read_b64_tr_b16 v[84:85], v13 offset:12352
    ds_read_b64_tr_b16 v[86:87], v13 offset:13376
    v_perm_b32 v183, v99, v99, s97
    s_waitcnt vmcnt(14) lgkmcnt(8)
    v_mfma_f32_32x32x16_bf16 v[32:47], v[64:67], v[128:131], v[32:47]
    ds_read_b64_tr_b16 v[88:89], v12 offset:14336
    ds_read_b64_tr_b16 v[90:91], v12 offset:15360
    buffer_load_dwordx4 v[124:127], v5, s[16:19], s50 offen offset:3072 sc1
    s_add_u32 s50, s50, 4096
    v_perm_b32 v184, v100, v100, s59
    v_mfma_f32_32x32x16_bf16 v[48:63], v[68:71], v[128:131], v[48:63]
    ds_read_b64_tr_b16 v[92:93], v13 offset:14400
    ds_read_b64_tr_b16 v[94:95], v13 offset:15424
    v_perm_b32 v185, v100, v100, s97
    s_waitcnt vmcnt(14) lgkmcnt(8)
    v_mfma_f32_32x32x16_bf16 v[32:47], v[72:75], v[132:135], v[32:47]
    ds_read_b64_tr_b16 v[64:65], v12 offset:16384
    ds_read_b64_tr_b16 v[66:67], v12 offset:17408
    buffer_load_dwordx4 v[128:131], v5, s[16:19], s50 offen offset:0 sc1
    v_perm_b32 v186, v101, v101, s59
    v_mfma_f32_32x32x16_bf16 v[48:63], v[76:79], v[132:135], v[48:63]
    ds_read_b64_tr_b16 v[68:69], v13 offset:16448
    ds_read_b64_tr_b16 v[70:71], v13 offset:17472
    v_perm_b32 v187, v101, v101, s97
    s_waitcnt vmcnt(14) lgkmcnt(8)
    v_mfma_f32_32x32x16_bf16 v[32:47], v[80:83], v[136:139], v[32:47]
    ds_read_b64_tr_b16 v[72:73], v12 offset:18432
    ds_read_b64_tr_b16 v[74:75], v12 offset:19456
    buffer_load_dwordx4 v[132:135], v5, s[16:19], s50 offen offset:1024 sc1
    v_perm_b32 v188, v102, v102, s59
    v_mfma_f32_32x32x16_bf16 v[48:63], v[84:87], v[136:139], v[48:63]
    ds_read_b64_tr_b16 v[76:77], v13 offset:18496
    ds_read_b64_tr_b16 v[78:79], v13 offset:19520
    v_perm_b32 v189, v102, v102, s97
    s_waitcnt vmcnt(14) lgkmcnt(8)
    v_mfma_f32_32x32x16_bf16 v[32:47], v[88:91], v[140:143], v[32:47]
    ds_read_b64_tr_b16 v[80:81], v12 offset:20480
    ds_read_b64_tr_b16 v[82:83], v12 offset:21504
    buffer_load_dwordx4 v[136:139], v5, s[16:19], s50 offen offset:2048 sc1
    v_perm_b32 v190, v103, v103, s59
    v_mfma_f32_32x32x16_bf16 v[48:63], v[92:95], v[140:143], v[48:63]
    ds_read_b64_tr_b16 v[84:85], v13 offset:20544
    ds_read_b64_tr_b16 v[86:87], v13 offset:21568
    v_perm_b32 v191, v103, v103, s97
    s_waitcnt vmcnt(14) lgkmcnt(8)
    v_mfma_f32_32x32x16_bf16 v[32:47], v[64:67], v[144:147], v[32:47]
    ds_read_b64_tr_b16 v[88:89], v12 offset:22528
    ds_read_b64_tr_b16 v[90:91], v12 offset:23552
    buffer_load_dwordx4 v[140:143], v5, s[16:19], s50 offen offset:3072 sc1
    s_add_u32 s50, s50, 4096
    v_perm_b32 v192, v104, v104, s59
    v_mfma_f32_32x32x16_bf16 v[48:63], v[68:71], v[144:147], v[48:63]
    ds_read_b64_tr_b16 v[92:93], v13 offset:22592
    ds_read_b64_tr_b16 v[94:95], v13 offset:23616
    v_perm_b32 v193, v104, v104, s97
    s_waitcnt vmcnt(14) lgkmcnt(8)
    v_mfma_f32_32x32x16_bf16 v[32:47], v[72:75], v[148:151], v[32:47]
    ds_read_b64_tr_b16 v[64:65], v12 offset:24576
    ds_read_b64_tr_b16 v[66:67], v12 offset:25600
    buffer_load_dwordx4 v[144:147], v5, s[16:19], s50 offen offset:0 sc1
    v_perm_b32 v194, v105, v105, s59
    v_mfma_f32_32x32x16_bf16 v[48:63], v[76:79], v[148:151], v[48:63]
    ds_read_b64_tr_b16 v[68:69], v13 offset:24640
    ds_read_b64_tr_b16 v[70:71], v13 offset:25664
    v_perm_b32 v195, v105, v105, s97
    s_waitcnt vmcnt(14) lgkmcnt(8)
    v_mfma_f32_32x32x16_bf16 v[32:47], v[80:83], v[152:155], v[32:47]
    ds_read_b64_tr_b16 v[72:73], v12 offset:26624
    ds_read_b64_tr_b16 v[74:75], v12 offset:27648
    buffer_load_dwordx4 v[148:151], v5, s[16:19], s50 offen offset:1024 sc1
    v_perm_b32 v196, v106, v106, s59
    v_mfma_f32_32x32x16_bf16 v[48:63], v[84:87], v[152:155], v[48:63]
    ds_read_b64_tr_b16 v[76:77], v13 offset:26688
    ds_read_b64_tr_b16 v[78:79], v13 offset:27712
    v_perm_b32 v197, v106, v106, s97
    s_waitcnt vmcnt(14) lgkmcnt(8)
    v_mfma_f32_32x32x16_bf16 v[32:47], v[88:91], v[156:159], v[32:47]
    ds_read_b64_tr_b16 v[80:81], v12 offset:28672
    ds_read_b64_tr_b16 v[82:83], v12 offset:29696
    buffer_load_dwordx4 v[152:155], v5, s[16:19], s50 offen offset:2048 sc1
    v_perm_b32 v198, v107, v107, s59
    v_mfma_f32_32x32x16_bf16 v[48:63], v[92:95], v[156:159], v[48:63]
    ds_read_b64_tr_b16 v[84:85], v13 offset:28736
    ds_read_b64_tr_b16 v[86:87], v13 offset:29760
    v_perm_b32 v199, v107, v107, s97
    s_waitcnt vmcnt(14) lgkmcnt(8)
    v_mfma_f32_32x32x16_bf16 v[32:47], v[64:67], v[160:163], v[32:47]
    ds_read_b64_tr_b16 v[88:89], v12 offset:30720
    ds_read_b64_tr_b16 v[90:91], v12 offset:31744
    buffer_load_dwordx4 v[156:159], v5, s[16:19], s50 offen offset:3072 sc1
    s_add_u32 s50, s50, 4096
    v_perm_b32 v200, v108, v108, s59
    v_mfma_f32_32x32x16_bf16 v[48:63], v[68:71], v[160:163], v[48:63]
    ds_read_b64_tr_b16 v[92:93], v13 offset:30784
    ds_read_b64_tr_b16 v[94:95], v13 offset:31808
    v_perm_b32 v201, v108, v108, s97
    s_waitcnt vmcnt(14) lgkmcnt(8)
    v_mfma_f32_32x32x16_bf16 v[32:47], v[72:75], v[164:167], v[32:47]
    ds_read_b64_tr_b16 v[64:65], v12 offset:32768
    ds_read_b64_tr_b16 v[66:67], v12 offset:33792
    buffer_load_dwordx4 v[160:163], v5, s[16:19], s50 offen offset:0 sc1
    v_perm_b32 v202, v109, v109, s59
    v_mfma_f32_32x32x16_bf16 v[48:63], v[76:79], v[164:167], v[48:63]
    ds_read_b64_tr_b16 v[68:69], v13 offset:32832
    ds_read_b64_tr_b16 v[70:71], v13 offset:33856
    v_perm_b32 v203, v109, v109, s97
    s_waitcnt vmcnt(14) lgkmcnt(8)
    v_mfma_f32_32x32x16_bf16 v[32:47], v[80:83], v[168:171], v[32:47]
    ds_read_b64_tr_b16 v[72:73], v12 offset:34816
    ds_read_b64_tr_b16 v[74:75], v12 offset:35840
    buffer_load_dwordx4 v[164:167], v5, s[16:19], s50 offen offset:1024 sc1
    v_perm_b32 v204, v110, v110, s59
    v_mfma_f32_32x32x16_bf16 v[48:63], v[84:87], v[168:171], v[48:63]
    ds_read_b64_tr_b16 v[76:77], v13 offset:34880
    ds_read_b64_tr_b16 v[78:79], v13 offset:35904
    v_perm_b32 v205, v110, v110, s97
    s_waitcnt vmcnt(14) lgkmcnt(8)
    v_mfma_f32_32x32x16_bf16 v[32:47], v[88:91], v[172:175], v[32:47]
    ds_read_b64_tr_b16 v[80:81], v12 offset:36864
    ds_read_b64_tr_b16 v[82:83], v12 offset:37888
    buffer_load_dwordx4 v[168:171], v5, s[16:19], s50 offen offset:2048 sc1
    v_perm_b32 v206, v111, v111, s59
    v_mfma_f32_32x32x16_bf16 v[48:63], v[92:95], v[172:175], v[48:63]
    ds_read_b64_tr_b16 v[84:85], v13 offset:36928
    ds_read_b64_tr_b16 v[86:87], v13 offset:37952
    v_perm_b32 v207, v111, v111, s97
    s_waitcnt vmcnt(14) lgkmcnt(8)
    v_mfma_f32_32x32x16_bf16 v[32:47], v[64:67], v[112:115], v[32:47]
    ds_read_b64_tr_b16 v[88:89], v12 offset:38912
    ds_read_b64_tr_b16 v[90:91], v12 offset:39936
    buffer_load_dwordx4 v[172:175], v5, s[16:19], s50 offen offset:3072 sc1
    s_add_u32 s50, s50, 4096
    v_mfma_f32_32x32x16_bf16 v[48:63], v[68:71], v[112:115], v[48:63]
    ds_read_b64_tr_b16 v[92:93], v13 offset:38976
    ds_read_b64_tr_b16 v[94:95], v13 offset:40000
    s_waitcnt vmcnt(14) lgkmcnt(8)
    v_mfma_f32_32x32x16_bf16 v[32:47], v[72:75], v[116:119], v[32:47]
    ds_read_b64_tr_b16 v[64:65], v12 offset:40960
    ds_read_b64_tr_b16 v[66:67], v12 offset:41984
    s_branch wp_6_t
wp_6:
    ds_read_b32 v29, v28
    s_waitcnt lgkmcnt(0)
    v_readfirstlane_b32 s60, v29
    s_lshr_b32 s51, s60, 2
    s_and_b32 s51, s51, s60
    s_and_b32 s51, s51, 3
wp_6_t:
    s_cmp_eq_u32 s51, 3
    s_cbranch_scc0 wp_6
    s_lshl_b32 s50, s52, 15
    s_xor_b32 s50, s50, 32768
    buffer_load_dwordx4 v[112:115], v5, s[16:19], s50 offen offset:0 sc1
    v_mfma_f32_32x32x16_bf16 v[48:63], v[76:79], v[116:119], v[48:63]
    ds_read_b64_tr_b16 v[68:69], v13 offset:41024
    ds_read_b64_tr_b16 v[70:71], v13 offset:42048
    s_waitcnt vmcnt(14) lgkmcnt(8)
    v_mfma_f32_32x32x16_bf16 v[32:47], v[80:83], v[120:123], v[32:47]
    ds_read_b64_tr_b16 v[72:73], v12 offset:43008
    ds_read_b64_tr_b16 v[74:75], v12 offset:44032
    buffer_load_dwordx4 v[116:119], v5, s[16:19], s50 offen offset:1024 sc1
    v_mfma_f32_32x32x16_bf16 v[48:63], v[84:87], v[120:123], v[48:63]
    ds_read_b64_tr_b16 v[76:77], v13 offset:43072
    ds_read_b64_tr_b16 v[78:79], v13 offset:44096
    s_waitcnt vmcnt(14) lgkmcnt(8)
    v_mfma_f32_32x32x16_bf16 v[32:47], v[88:91], v[124:127], v[32:47]
    ds_read_b64_tr_b16 v[80:81], v12 offset:45056
    ds_read_b64_tr_b16 v[82:83], v12 offset:46080
    buffer_load_dwordx4 v[120:123], v5, s[16:19], s50 offen offset:2048 sc1
    v_mfma_f32_32x32x16_bf16 v[48:63], v[92:95], v[124:127], v[48:63]
    ds_read_b64_tr_b16 v[84:85], v13 offset:45120
    ds_read_b64_tr_b16 v[86:87], v13 offset:46144
    s_waitcnt vmcnt(14) lgkmcnt(8)
    v_mfma_f32_32x32x16_bf16 v[32:47], v[64:67], v[128:131], v[32:47]
    ds_read_b64_tr_b16 v[88:89], v12 offset:47104
    ds_read_b64_tr_b16 v[90:91], v12 offset:48128
    buffer_load_dwordx4 v[124:127], v5, s[16:19], s50 offen offset:3072 sc1
    s_add_u32 s50, s50, 4096
    v_mfma_f32_32x32x16_bf16 v[48:63], v[68:71], v[128:131], v[48:63]
    ds_read_b64_tr_b16 v[92:93], v13 offset:47168
    ds_read_b64_tr_b16 v[94:95], v13 offset:48192
    s_waitcnt vmcnt(14) lgkmcnt(8)
    v_mfma_f32_32x32x16_bf16 v[32:47], v[72:75], v[132:135], v[32:47]
    ds_read_b64_tr_b16 v[64:65], v12 offset:49152
    ds_read_b64_tr_b16 v[66:67], v12 offset:50176
    buffer_load_dwordx4 v[128:131], v5, s[16:19], s50 offen offset:0 sc1
    v_mfma_f32_32x32x16_bf16 v[48:63], v[76:79], v[132:135], v[48:63]
    ds_read_b64_tr_b16 v[68:69], v13 offset:49216
    ds_read_b64_tr_b16 v[70:71], v13 offset:50240
    s_waitcnt vmcnt(14) lgkmcnt(8)
    v_mfma_f32_32x32x16_bf16 v[32:47], v[80:83], v[136:139], v[32:47]
    ds_read_b64_tr_b16 v[72:73], v12 offset:51200
    ds_read_b64_tr_b16 v[74:75], v12 offset:52224
    buffer_load_dwordx4 v[132:135], v5, s[16:19], s50 offen offset:1024 sc1
    v_mfma_f32_32x32x16_bf16 v[48:63], v[84:87], v[136:139], v[48:63]
    ds_read_b64_tr_b16 v[76:77], v13 offset:51264
    ds_read_b64_tr_b16 v[78:79], v13 offset:52288
    s_waitcnt vmcnt(14) lgkmcnt(8)
    v_mfma_f32_32x32x16_bf16 v[32:47], v[88:91], v[140:143], v[32:47]
    ds_read_b64_tr_b16 v[80:81], v12 offset:53248
    ds_read_b64_tr_b16 v[82:83], v12 offset:54272
    buffer_load_dwordx4 v[136:139], v5, s[16:19], s50 offen offset:2048 sc1
    v_mfma_f32_32x32x16_bf16 v[48:63], v[92:95], v[140:143], v[48:63]
    ds_read_b64_tr_b16 v[84:85], v13 offset:53312
    ds_read_b64_tr_b16 v[86:87], v13 offset:54336
    s_waitcnt vmcnt(14) lgkmcnt(8)
    v_mfma_f32_32x32x16_bf16 v[32:47], v[64:67], v[144:147], v[32:47]
    ds_read_b64_tr_b16 v[88:89], v12 offset:55296
    ds_read_b64_tr_b16 v[90:91], v12 offset:56320
    buffer_load_dwordx4 v[140:143], v5, s[16:19], s50 offen offset:3072 sc1
    s_add_u32 s50, s50, 4096
    v_mfma_f32_32x32x16_bf16 v[48:63], v[68:71], v[144:147], v[48:63]
    ds_read_b64_tr_b16 v[92:93], v13 offset:55360
    ds_read_b64_tr_b16 v[94:95], v13 offset:56384
    s_waitcnt vmcnt(14) lgkmcnt(8)
    v_mfma_f32_32x32x16_bf16 v[32:47], v[72:75], v[148:151], v[32:47]
    ds_read_b64_tr_b16 v[64:65], v12 offset:57344
    ds_read_b64_tr_b16 v[66:67], v12 offset:58368
    buffer_load_dwordx4 v[144:147], v5, s[16:19], s50 offen offset:0 sc1
    v_mfma_f32_32x32x16_bf16 v[48:63], v[76:79], v[148:151], v[48:63]
    ds_read_b64_tr_b16 v[68:69], v13 offset:57408
    ds_read_b64_tr_b16 v[70:71], v13 offset:58432
    s_waitcnt vmcnt(14) lgkmcnt(8)
    v_mfma_f32_32x32x16_bf16 v[32:47], v[80:83], v[152:155], v[32:47]
    ds_read_b64_tr_b16 v[72:73], v12 offset:59392
    ds_read_b64_tr_b16 v[74:75], v12 offset:60416
    buffer_load_dwordx4 v[148:151], v5, s[16:19], s50 offen offset:1024 sc1
    v_mfma_f32_32x32x16_bf16 v[48:63], v[84:87], v[152:155], v[48:63]
    ds_read_b64_tr_b16 v[76:77], v13 offset:59456
    ds_read_b64_tr_b16 v[78:79], v13 offset:60480
    s_waitcnt vmcnt(14) lgkmcnt(8)
    v_mfma_f32_32x32x16_bf16 v[32:47], v[88:91], v[156:159], v[32:47]
    ds_read_b64_tr_b16 v[80:81], v12 offset:61440
    ds_read_b64_tr_b16 v[82:83], v12 offset:62464
    buffer_load_dwordx4 v[152:155], v5, s[16:19], s50 offen offset:2048 sc1
    v_mfma_f32_32x32x16_bf16 v[48:63], v[92:95], v[156:159], v[48:63]
    ds_read_b64_tr_b16 v[84:85], v13 offset:61504
    ds_read_b64_tr_b16 v[86:87], v13 offset:62528
    s_waitcnt vmcnt(14) lgkmcnt(8)
    v_mfma_f32_32x32x16_bf16 v[32:47], v[64:67], v[160:163], v[32:47]
    ds_read_b64_tr_b16 v[88:89], v12 offset:63488
    ds_read_b64_tr_b16 v[90:91], v12 offset:64512
    buffer_load_dwordx4 v[156:159], v5, s[16:19], s50 offen offset:3072 sc1
    s_add_u32 s50, s50, 4096
    v_mfma_f32_32x32x16_bf16 v[48:63], v[68:71], v[160:163], v[48:63]
    ds_read_b64_tr_b16 v[92:93], v13 offset:63552
    ds_read_b64_tr_b16 v[94:95], v13 offset:64576
    s_waitcnt vmcnt(14) lgkmcnt(8)
    v_mfma_f32_32x32x16_bf16 v[32:47], v[72:75], v[164:167], v[32:47]
    ds_read_b64_tr_b16 v[64:65], v14 offset:0
    ds_read_b64_tr_b16 v[66:67], v14 offset:1024
    buffer_load_dwordx4 v[160:163], v5, s[16:19], s50 offen offset:0 sc1
    v_mfma_f32_32x32x16_bf16 v[48:63], v[76:79], v[164:167], v[48:63]
    ds_read_b64_tr_b16 v[68:69], v15 offset:64
    ds_read_b64_tr_b16 v[70:71], v15 offset:1088
    s_waitcnt vmcnt(14) lgkmcnt(8)
    v_mfma_f32_32x32x16_bf16 v[32:47], v[80:83], v[168:171], v[32:47]
    ds_read_b64_tr_b16 v[72:73], v14 offset:2048
    ds_read_b64_tr_b16 v[74:75], v14 offset:3072
    buffer_load_dwordx4 v[164:167], v5, s[16:19], s50 offen offset:1024 sc1
    v_mfma_f32_32x32x16_bf16 v[48:63], v[84:87], v[168:171], v[48:63]
    ds_read_b64_tr_b16 v[76:77], v15 offset:2112
    ds_read_b64_tr_b16 v[78:79], v15 offset:3136
    s_waitcnt vmcnt(14) lgkmcnt(8)
    v_mfma_f32_32x32x16_bf16 v[32:47], v[88:91], v[172:175], v[32:47]
    ds_read_b64_tr_b16 v[80:81], v14 offset:4096
    ds_read_b64_tr_b16 v[82:83], v14 offset:5120
    buffer_load_dwordx4 v[168:171], v5, s[16:19], s50 offen offset:2048 sc1
    v_mfma_f32_32x32x16_bf16 v[48:63], v[92:95], v[172:175], v[48:63]
    ds_read_b64_tr_b16 v[84:85], v15 offset:4160
    ds_read_b64_tr_b16 v[86:87], v15 offset:5184
    s_waitcnt vmcnt(14) lgkmcnt(8)
    v_mfma_f32_32x32x16_bf16 v[176:191], v[64:67], v[112:115], v[176:191]
    ds_read_b64_tr_b16 v[88:89], v14 offset:6144
    ds_read_b64_tr_b16 v[90:91], v14 offset:7168
    buffer_load_dwordx4 v[172:175], v5, s[16:19], s50 offen offset:3072 sc1
    s_add_u32 s50, s50, 4096
    v_mfma_f32_32x32x16_bf16 v[192:207], v[68:71], v[112:115], v[192:207]
    ds_read_b64_tr_b16 v[92:93], v15 offset:6208
    ds_read_b64_tr_b16 v[94:95], v15 offset:7232
    s_waitcnt vmcnt(14) lgkmcnt(8)
    v_mfma_f32_32x32x16_bf16 v[176:191], v[72:75], v[116:119], v[176:191]
    ds_read_b64_tr_b16 v[64:65], v14 offset:8192
    ds_read_b64_tr_b16 v[66:67], v14 offset:9216
    buffer_load_dwordx4 v[112:115], v5, s[16:19], s50 offen offset:0 sc1
    v_mfma_f32_32x32x16_bf16 v[192:207], v[76:79], v[116:119], v[192:207]
    ds_read_b64_tr_b16 v[68:69], v15 offset:8256
    ds_read_b64_tr_b16 v[70:71], v15 offset:9280
    s_waitcnt vmcnt(14) lgkmcnt(8)
    v_mfma_f32_32x32x16_bf16 v[176:191], v[80:83], v[120:123], v[176:191]
    ds_read_b64_tr_b16 v[72:73], v14 offset:10240
    ds_read_b64_tr_b16 v[74:75], v14 offset:11264
    buffer_load_dwordx4 v[116:119], v5, s[16:19], s50 offen offset:1024 sc1
    v_mfma_f32_32x32x16_bf16 v[192:207], v[84:87], v[120:123], v[192:207]
    ds_read_b64_tr_b16 v[76:77], v15 offset:10304
    ds_read_b64_tr_b16 v[78:79], v15 offset:11328
    s_waitcnt vmcnt(14) lgkmcnt(8)
    v_mfma_f32_32x32x16_bf16 v[176:191], v[88:91], v[124:127], v[176:191]
    ds_read_b64_tr_b16 v[80:81], v14 offset:12288
    ds_read_b64_tr_b16 v[82:83], v14 offset:13312
    buffer_load_dwordx4 v[120:123], v5, s[16:19], s50 offen offset:2048 sc1
    v_mfma_f32_32x32x16_bf16 v[192:207], v[92:95], v[124:127], v[192:207]
    ds_read_b64_tr_b16 v[84:85], v15 offset:12352
    ds_read_b64_tr_b16 v[86:87], v15 offset:13376
    s_waitcnt vmcnt(14) lgkmcnt(8)
    v_mfma_f32_32x32x16_bf16 v[176:191], v[64:67], v[128:131], v[176:191]
    ds_read_b64_tr_b16 v[88:89], v14 offset:14336
    ds_read_b64_tr_b16 v[90:91], v14 offset:15360
    buffer_load_dwordx4 v[124:127], v5, s[16:19], s50 offen offset:3072 sc1
    s_add_u32 s50, s50, 4096
    v_mfma_f32_32x32x16_bf16 v[192:207], v[68:71], v[128:131], v[192:207]
    ds_read_b64_tr_b16 v[92:93], v15 offset:14400
    ds_read_b64_tr_b16 v[94:95], v15 offset:15424
    s_waitcnt vmcnt(14) lgkmcnt(8)
    v_mfma_f32_32x32x16_bf16 v[176:191], v[72:75], v[132:135], v[176:191]
    ds_read_b64_tr_b16 v[64:65], v14 offset:16384
    ds_read_b64_tr_b16 v[66:67], v14 offset:17408
    buffer_load_dwordx4 v[128:131], v5, s[16:19], s50 offen offset:0 sc1
    v_mfma_f32_32x32x16_bf16 v[192:207], v[76:79], v[132:135], v[192:207]
    ds_read_b64_tr_b16 v[68:69], v15 offset:16448
    ds_read_b64_tr_b16 v[70:71], v15 offset:17472
    s_waitcnt vmcnt(14) lgkmcnt(8)
    v_mfma_f32_32x32x16_bf16 v[176:191], v[80:83], v[136:139], v[176:191]
    ds_read_b64_tr_b16 v[72:73], v14 offset:18432
    ds_read_b64_tr_b16 v[74:75], v14 offset:19456
    buffer_load_dwordx4 v[132:135], v5, s[16:19], s50 offen offset:1024 sc1
    v_mfma_f32_32x32x16_bf16 v[192:207], v[84:87], v[136:139], v[192:207]
    ds_read_b64_tr_b16 v[76:77], v15 offset:18496
    ds_read_b64_tr_b16 v[78:79], v15 offset:19520
    s_waitcnt vmcnt(14) lgkmcnt(8)
    v_mfma_f32_32x32x16_bf16 v[176:191], v[88:91], v[140:143], v[176:191]
    ds_read_b64_tr_b16 v[80:81], v14 offset:20480
    ds_read_b64_tr_b16 v[82:83], v14 offset:21504
    buffer_load_dwordx4 v[136:139], v5, s[16:19], s50 offen offset:2048 sc1
    v_mfma_f32_32x32x16_bf16 v[192:207], v[92:95], v[140:143], v[192:207]
    ds_read_b64_tr_b16 v[84:85], v15 offset:20544
    ds_read_b64_tr_b16 v[86:87], v15 offset:21568
    s_waitcnt vmcnt(14) lgkmcnt(8)
    v_mfma_f32_32x32x16_bf16 v[176:191], v[64:67], v[144:147], v[176:191]
    ds_read_b64_tr_b16 v[88:89], v14 offset:22528
    ds_read_b64_tr_b16 v[90:91], v14 offset:23552
    buffer_load_dwordx4 v[140:143], v5, s[16:19], s50 offen offset:3072 sc1
    s_add_u32 s50, s50, 4096
    v_mfma_f32_32x32x16_bf16 v[192:207], v[68:71], v[144:147], v[192:207]
    ds_read_b64_tr_b16 v[92:93], v15 offset:22592
    ds_read_b64_tr_b16 v[94:95], v15 offset:23616
    s_waitcnt vmcnt(14) lgkmcnt(8)
    v_mfma_f32_32x32x16_bf16 v[176:191], v[72:75], v[148:151], v[176:191]
    ds_read_b64_tr_b16 v[64:65], v14 offset:24576
    ds_read_b64_tr_b16 v[66:67], v14 offset:25600
    buffer_load_dwordx4 v[144:147], v5, s[16:19], s50 offen offset:0 sc1
    v_mfma_f32_32x32x16_bf16 v[192:207], v[76:79], v[148:151], v[192:207]
    ds_read_b64_tr_b16 v[68:69], v15 offset:24640
    ds_read_b64_tr_b16 v[70:71], v15 offset:25664
    s_waitcnt vmcnt(14) lgkmcnt(8)
    v_mfma_f32_32x32x16_bf16 v[176:191], v[80:83], v[152:155], v[176:191]
    ds_read_b64_tr_b16 v[72:73], v14 offset:26624
    ds_read_b64_tr_b16 v[74:75], v14 offset:27648
    buffer_load_dwordx4 v[148:151], v5, s[16:19], s50 offen offset:1024 sc1
    v_mfma_f32_32x32x16_bf16 v[192:207], v[84:87], v[152:155], v[192:207]
    ds_read_b64_tr_b16 v[76:77], v15 offset:26688
    ds_read_b64_tr_b16 v[78:79], v15 offset:27712
    s_waitcnt vmcnt(14) lgkmcnt(8)
    v_mfma_f32_32x32x16_bf16 v[176:191], v[88:91], v[156:159], v[176:191]
    ds_read_b64_tr_b16 v[80:81], v14 offset:28672
    ds_read_b64_tr_b16 v[82:83], v14 offset:29696
    buffer_load_dwordx4 v[152:155], v5, s[16:19], s50 offen offset:2048 sc1
    v_mfma_f32_32x32x16_bf16 v[192:207], v[92:95], v[156:159], v[192:207]
    ds_read_b64_tr_b16 v[84:85], v15 offset:28736
    ds_read_b64_tr_b16 v[86:87], v15 offset:29760
    s_waitcnt vmcnt(14) lgkmcnt(8)
    v_mfma_f32_32x32x16_bf16 v[176:191], v[64:67], v[160:163], v[176:191]
    ds_read_b64_tr_b16 v[88:89], v14 offset:30720
    ds_read_b64_tr_b16 v[90:91], v14 offset:31744
    buffer_load_dwordx4 v[156:159], v5, s[16:19], s50 offen offset:3072 sc1
    s_add_u32 s50, s50, 4096
    v_mfma_f32_32x32x16_bf16 v[192:207], v[68:71], v[160:163], v[192:207]
    ds_read_b64_tr_b16 v[92:93], v15 offset:30784
    ds_read_b64_tr_b16 v[94:95], v15 offset:31808
    s_waitcnt vmcnt(14) lgkmcnt(8)
    v_mfma_f32_32x32x16_bf16 v[176:191], v[72:75], v[164:167], v[176:191]
    ds_read_b64_tr_b16 v[64:65], v14 offset:32768
    ds_read_b64_tr_b16 v[66:67], v14 offset:33792
    buffer_load_dwordx4 v[160:163], v5, s[16:19], s50 offen offset:0 sc1
    v_mfma_f32_32x32x16_bf16 v[192:207], v[76:79], v[164:167], v[192:207]
    ds_read_b64_tr_b16 v[68:69], v15 offset:32832
    ds_read_b64_tr_b16 v[70:71], v15 offset:33856
    s_waitcnt vmcnt(14) lgkmcnt(8)
    v_mfma_f32_32x32x16_bf16 v[176:191], v[80:83], v[168:171], v[176:191]
    ds_read_b64_tr_b16 v[72:73], v14 offset:34816
    ds_read_b64_tr_b16 v[74:75], v14 offset:35840
    buffer_load_dwordx4 v[164:167], v5, s[16:19], s50 offen offset:1024 sc1
    v_mfma_f32_32x32x16_bf16 v[192:207], v[84:87], v[168:171], v[192:207]
    ds_read_b64_tr_b16 v[76:77], v15 offset:34880
    ds_read_b64_tr_b16 v[78:79], v15 offset:35904
    s_waitcnt vmcnt(14) lgkmcnt(8)
    v_mfma_f32_32x32x16_bf16 v[176:191], v[88:91], v[172:175], v[176:191]
    ds_read_b64_tr_b16 v[80:81], v14 offset:36864
    ds_read_b64_tr_b16 v[82:83], v14 offset:37888
    buffer_load_dwordx4 v[168:171], v5, s[16:19], s50 offen offset:2048 sc1
    v_mfma_f32_32x32x16_bf16 v[192:207], v[92:95], v[172:175], v[192:207]
    ds_read_b64_tr_b16 v[84:85], v15 offset:36928
    ds_read_b64_tr_b16 v[86:87], v15 offset:37952
    s_waitcnt vmcnt(14) lgkmcnt(8)
    v_mfma_f32_32x32x16_bf16 v[176:191], v[64:67], v[112:115], v[176:191]
    ds_read_b64_tr_b16 v[88:89], v14 offset:38912
    ds_read_b64_tr_b16 v[90:91], v14 offset:39936
    buffer_load_dwordx4 v[172:175], v5, s[16:19], s50 offen offset:3072 sc1
    s_add_u32 s50, s50, 4096
    v_mfma_f32_32x32x16_bf16 v[192:207], v[68:71], v[112:115], v[192:207]
    ds_read_b64_tr_b16 v[92:93], v15 offset:38976
    ds_read_b64_tr_b16 v[94:95], v15 offset:40000
    s_waitcnt vmcnt(14) lgkmcnt(8)
    v_mfma_f32_32x32x16_bf16 v[176:191], v[72:75], v[116:119], v[176:191]
    ds_read_b64_tr_b16 v[64:65], v14 offset:40960
    ds_read_b64_tr_b16 v[66:67], v14 offset:41984
    v_mfma_f32_32x32x16_bf16 v[192:207], v[76:79], v[116:119], v[192:207]
    ds_read_b64_tr_b16 v[68:69], v15 offset:41024
    ds_read_b64_tr_b16 v[70:71], v15 offset:42048
    s_waitcnt vmcnt(13) lgkmcnt(8)
    v_mfma_f32_32x32x16_bf16 v[176:191], v[80:83], v[120:123], v[176:191]
    ds_read_b64_tr_b16 v[72:73], v14 offset:43008
    ds_read_b64_tr_b16 v[74:75], v14 offset:44032
    v_mfma_f32_32x32x16_bf16 v[192:207], v[84:87], v[120:123], v[192:207]
    ds_read_b64_tr_b16 v[76:77], v15 offset:43072
    ds_read_b64_tr_b16 v[78:79], v15 offset:44096
    s_waitcnt vmcnt(12) lgkmcnt(8)
    v_mfma_f32_32x32x16_bf16 v[176:191], v[88:91], v[124:127], v[176:191]
    ds_read_b64_tr_b16 v[80:81], v14 offset:45056
    ds_read_b64_tr_b16 v[82:83], v14 offset:46080
    v_mfma_f32_32x32x16_bf16 v[192:207], v[92:95], v[124:127], v[192:207]
    ds_read_b64_tr_b16 v[84:85], v15 offset:45120
    ds_read_b64_tr_b16 v[86:87], v15 offset:46144
    s_waitcnt vmcnt(11) lgkmcnt(8)
    v_mfma_f32_32x32x16_bf16 v[176:191], v[64:67], v[128:131], v[176:191]
    ds_read_b64_tr_b16 v[88:89], v14 offset:47104
    ds_read_b64_tr_b16 v[90:91], v14 offset:48128
    v_mfma_f32_32x32x16_bf16 v[192:207], v[68:71], v[128:131], v[192:207]
    ds_read_b64_tr_b16 v[92:93], v15 offset:47168
    ds_read_b64_tr_b16 v[94:95], v15 offset:48192
    s_waitcnt vmcnt(10) lgkmcnt(8)
    v_mfma_f32_32x32x16_bf16 v[176:191], v[72:75], v[132:135], v[176:191]
    ds_read_b64_tr_b16 v[64:65], v14 offset:49152
    ds_read_b64_tr_b16 v[66:67], v14 offset:50176
    v_mfma_f32_32x32x16_bf16 v[192:207], v[76:79], v[132:135], v[192:207]
    ds_read_b64_tr_b16 v[68:69], v15 offset:49216
    ds_read_b64_tr_b16 v[70:71], v15 offset:50240
    s_waitcnt vmcnt(9) lgkmcnt(8)
    v_mfma_f32_32x32x16_bf16 v[176:191], v[80:83], v[136:139], v[176:191]
    ds_read_b64_tr_b16 v[72:73], v14 offset:51200
    ds_read_b64_tr_b16 v[74:75], v14 offset:52224
    v_mfma_f32_32x32x16_bf16 v[192:207], v[84:87], v[136:139], v[192:207]
    ds_read_b64_tr_b16 v[76:77], v15 offset:51264
    ds_read_b64_tr_b16 v[78:79], v15 offset:52288
    s_waitcnt vmcnt(8) lgkmcnt(8)
    v_mfma_f32_32x32x16_bf16 v[176:191], v[88:91], v[140:143], v[176:191]
    ds_read_b64_tr_b16 v[80:81], v14 offset:53248
    ds_read_b64_tr_b16 v[82:83], v14 offset:54272
    v_mfma_f32_32x32x16_bf16 v[192:207], v[92:95], v[140:143], v[192:207]
    ds_read_b64_tr_b16 v[84:85], v15 offset:53312
    ds_read_b64_tr_b16 v[86:87], v15 offset:54336
    s_waitcnt vmcnt(7) lgkmcnt(8)
    v_mfma_f32_32x32x16_bf16 v[176:191], v[64:67], v[144:147], v[176:191]
    ds_read_b64_tr_b16 v[88:89], v14 offset:55296
    ds_read_b64_tr_b16 v[90:91], v14 offset:56320
    v_mfma_f32_32x32x16_bf16 v[192:207], v[68:71], v[144:147], v[192:207]
    ds_read_b64_tr_b16 v[92:93], v15 offset:55360
    ds_read_b64_tr_b16 v[94:95], v15 offset:56384
    s_waitcnt vmcnt(6) lgkmcnt(8)
    v_mfma_f32_32x32x16_bf16 v[176:191], v[72:75], v[148:151], v[176:191]
    ds_read_b64_tr_b16 v[64:65], v14 offset:57344
    ds_read_b64_tr_b16 v[66:67], v14 offset:58368
    v_mfma_f32_32x32x16_bf16 v[192:207], v[76:79], v[148:151], v[192:207]
    ds_read_b64_tr_b16 v[68:69], v15 offset:57408
    ds_read_b64_tr_b16 v[70:71], v15 offset:58432
    s_waitcnt vmcnt(5) lgkmcnt(8)
    v_mfma_f32_32x32x16_bf16 v[176:191], v[80:83], v[152:155], v[176:191]
    ds_read_b64_tr_b16 v[72:73], v14 offset:59392
    ds_read_b64_tr_b16 v[74:75], v14 offset:60416
    v_mfma_f32_32x32x16_bf16 v[192:207], v[84:87], v[152:155], v[192:207]
    ds_read_b64_tr_b16 v[76:77], v15 offset:59456
    ds_read_b64_tr_b16 v[78:79], v15 offset:60480
    s_waitcnt vmcnt(4) lgkmcnt(8)
    v_mfma_f32_32x32x16_bf16 v[176:191], v[88:91], v[156:159], v[176:191]
    ds_read_b64_tr_b16 v[80:81], v14 offset:61440
    ds_read_b64_tr_b16 v[82:83], v14 offset:62464
    v_mfma_f32_32x32x16_bf16 v[192:207], v[92:95], v[156:159], v[192:207]
    ds_read_b64_tr_b16 v[84:85], v15 offset:61504
    ds_read_b64_tr_b16 v[86:87], v15 offset:62528
    s_waitcnt vmcnt(3) lgkmcnt(8)
    v_mfma_f32_32x32x16_bf16 v[176:191], v[64:67], v[160:163], v[176:191]
    ds_read_b64_tr_b16 v[88:89], v14 offset:63488
    ds_read_b64_tr_b16 v[90:91], v14 offset:64512
    v_mfma_f32_32x32x16_bf16 v[192:207], v[68:71], v[160:163], v[192:207]
    ds_read_b64_tr_b16 v[92:93], v15 offset:63552
    ds_read_b64_tr_b16 v[94:95], v15 offset:64576
    s_waitcnt vmcnt(2) lgkmcnt(8)
    v_mfma_f32_32x32x16_bf16 v[176:191], v[72:75], v[164:167], v[176:191]
    v_mfma_f32_32x32x16_bf16 v[192:207], v[76:79], v[164:167], v[192:207]
    s_waitcnt vmcnt(1) lgkmcnt(4)
    v_mfma_f32_32x32x16_bf16 v[176:191], v[80:83], v[168:171], v[176:191]
    v_mfma_f32_32x32x16_bf16 v[192:207], v[84:87], v[168:171], v[192:207]
    s_waitcnt vmcnt(0) lgkmcnt(0)
    v_mfma_f32_32x32x16_bf16 v[176:191], v[88:91], v[172:175], v[176:191]
    v_mfma_f32_32x32x16_bf16 v[192:207], v[92:95], v[172:175], v[192:207]
    s_cmp_eq_u32 s9, 3
    s_nop 7
    s_cbranch_scc1 c_wo_fin
    s_add_u32 s58, s58, 4194304
    s_nop 7
    v_pk_add_f32 v[32:33], v[32:33], v[176:177]
    v_pk_add_f32 v[34:35], v[34:35], v[178:179]
    v_pk_add_f32 v[36:37], v[36:37], v[180:181]
    v_pk_add_f32 v[38:39], v[38:39], v[182:183]
    v_cvt_pk_bf16_f32 v96, v32, v33
    v_cvt_pk_bf16_f32 v97, v34, v35
    v_cvt_pk_bf16_f32 v98, v36, v37
    v_cvt_pk_bf16_f32 v99, v38, v39
    buffer_store_dwordx4 v[96:99], v5, s[12:15], s58 offen offset:0 sc1
    v_pk_add_f32 v[40:41], v[40:41], v[184:185]
    v_pk_add_f32 v[42:43], v[42:43], v[186:187]
    v_pk_add_f32 v[44:45], v[44:45], v[188:189]
    v_pk_add_f32 v[46:47], v[46:47], v[190:191]
    v_cvt_pk_bf16_f32 v100, v40, v41
    v_cvt_pk_bf16_f32 v101, v42, v43
    v_cvt_pk_bf16_f32 v102, v44, v45
    v_cvt_pk_bf16_f32 v103, v46, v47
    buffer_store_dwordx4 v[100:103], v5, s[12:15], s58 offen offset:1024 sc1
    v_pk_add_f32 v[48:49], v[48:49], v[192:193]
    v_pk_add_f32 v[50:51], v[50:51], v[194:195]
    v_pk_add_f32 v[52:53], v[52:53], v[196:197]
    v_pk_add_f32 v[54:55], v[54:55], v[198:199]
    v_cvt_pk_bf16_f32 v104, v48, v49
    v_cvt_pk_bf16_f32 v105, v50, v51
    v_cvt_pk_bf16_f32 v106, v52, v53
    v_cvt_pk_bf16_f32 v107, v54, v55
    buffer_store_dwordx4 v[104:107], v5, s[12:15], s58 offen offset:2048 sc1
    v_pk_add_f32 v[56:57], v[56:57], v[200:201]
    v_pk_add_f32 v[58:59], v[58:59], v[202:203]
    v_pk_add_f32 v[60:61], v[60:61], v[204:205]
    v_pk_add_f32 v[62:63], v[62:63], v[206:207]
    v_cvt_pk_bf16_f32 v108, v56, v57
    v_cvt_pk_bf16_f32 v109, v58, v59
    v_cvt_pk_bf16_f32 v110, v60, v61
    v_cvt_pk_bf16_f32 v111, v62, v63
    buffer_store_dwordx4 v[108:111], v5, s[12:15], s58 offen offset:3072 sc1
    s_barrier
c_wo_stat:
    s_mov_b32 s55, 0x3f803f80
    v_dot2_f32_bf16 v18, v96, s55, 0
    v_dot2_f32_bf16 v19, v96, v96, 0
    v_dot2_f32_bf16 v20, v97, s55, 0
    v_dot2_f32_bf16 v21, v97, v97, 0
    v_dot2_f32_bf16 v18, v98, s55, v18
    v_dot2_f32_bf16 v19, v98, v98, v19
    v_dot2_f32_bf16 v20, v99, s55, v20
    v_dot2_f32_bf16 v21, v99, v99, v21
    v_dot2_f32_bf16 v18, v100, s55, v18
    v_dot2_f32_bf16 v19, v100, v100, v19
    v_dot2_f32_bf16 v20, v101, s55, v20
    v_dot2_f32_bf16 v21, v101, v101, v21
    v_dot2_f32_bf16 v18, v102, s55, v18
    v_dot2_f32_bf16 v19, v102, v102, v19
    v_dot2_f32_bf16 v20, v103, s55, v20
    v_dot2_f32_bf16 v21, v103, v103, v21
    v_dot2_f32_bf16 v18, v104, s55, v18
    v_dot2_f32_bf16 v19, v104, v104, v19
    v_dot2_f32_bf16 v20, v105, s55, v20
    v_dot2_f32_bf16 v21, v105, v105, v21
    v_dot2_f32_bf16 v18, v106, s55, v18
    v_dot2_f32_bf16 v19, v106, v106, v19
    v_dot2_f32_bf16 v20, v107, s55, v20
    v_dot2_f32_bf16 v21, v107, v107, v21
    v_dot2_f32_bf16 v18, v108, s55, v18
    v_dot2_f32_bf16 v19, v108, v108, v19
    v_dot2_f32_bf16 v20, v109, s55, v20
    v_dot2_f32_bf16 v21, v109, v109, v21
    v_dot2_f32_bf16 v18, v110, s55, v18
    v_dot2_f32_bf16 v19, v110, v110, v19
    v_dot2_f32_bf16 v20, v111, s55, v20
    v_dot2_f32_bf16 v21, v111, v111, v21
    v_lshlrev_b32 v16, 3, v1
    s_lshl_b32 s3, s48, 12
    s_lshl_b32 s55, s7, 8
    s_add_u32 s3, s3, s55
    v_permlane32_swap_b32 v18, v20
    v_permlane32_swap_b32 v19, v21
    s_lshl_b32 s55, s9, 18
    v_pk_add_f32 v[18:19], v[18:19], v[20:21]
    s_add_u32 s3, s3, s55
    s_add_u32 s3, s3, 63176704
    v_permlane32_swap_b32 v18, v20
    v_permlane32_swap_b32 v19, v21
    v_pk_add_f32 v[18:19], v[18:19], v[20:21]
    s_mov_b32 exec_hi, 0
    buffer_store_dwordx2 v[18:19], v16, s[12:15], s3 offen sc1
    s_mov_b64 exec, -1
    s_cmp_lg_u32 s9, -1
    s_cbranch_scc1 c_wo_pub
    s_barrier
    v_mov_b32 v24, 159492
non_7:
    ds_read_b32 v25, v24
    s_waitcnt lgkmcnt(0)
    v_readfirstlane_b32 s10, v25
    s_cmp_eq_u32 s10, 0
    s_cbranch_scc1 non_7
c_wo_pub:
    s_mul_i32 s55, s9, 786432
    s_add_u32 s55, s55, 66060288
    v_and_b32 v24, 63, v0
    s_and_b32 s56, s11, 0xe0
    v_lshrrev_b32 v25, 5, v24
    v_add_u32 v24, s56, v24
    v_and_b32 v24, 255, v24
    v_lshlrev_b32 v24, 10, v24
    v_lshl_add_u32 v24, v25, 8, v24
    s_bfe_u32 s56, s11, 0x20003
    s_and_b32 s57, s11, 7
    s_lshl_b32 s56, s56, 7
    s_lshl_b32 s57, s57, 2
    s_add_u32 s55, s55, s56
    s_add_u32 s55, s55, s57
    s_and_b32 s57, s6, s9
    s_bfe_i32 s57, s57, 0x10000
    v_mov_b32 v25, 159488
    v_mov_b32 v26, 1
    v_mov_b32 v27, s10
    s_mov_b64 exec, 1
    s_waitcnt vmcnt(0)
    ds_add_rtn_u32 v26, v25, v26
    s_waitcnt lgkmcnt(0)
    v_readfirstlane_b32 s56, v26
    s_and_b32 s56, s56, 3
    s_cmp_lg_u32 s56, 3
    s_cbranch_scc1 pub_8
    s_mov_b32 exec_lo, -1
    s_mov_b32 exec_hi, s57
    buffer_store_dword v27, v24, s[12:15], s55 offen sc1
pub_8:
    s_mov_b64 exec, -1
    s_cmp_eq_u32 s9, -1
    s_cbranch_scc1 c_wo_pub3
    s_barrier
c_wo_pub3:
    s_add_u32 s9, s9, 1
    s_bitcmp1_b32 s9, 0
    s_cbranch_scc1 c_qkvB
    s_branch c_qkvA
c_wo_fin:
    s_barrier
    v_pk_add_f32 v[32:33], v[32:33], v[176:177]
    v_pk_add_f32 v[34:35], v[34:35], v[178:179]
    v_pk_add_f32 v[36:37], v[36:37], v[180:181]
    v_pk_add_f32 v[38:39], v[38:39], v[182:183]
    v_pk_add_f32 v[40:41], v[40:41], v[184:185]
    v_pk_add_f32 v[42:43], v[42:43], v[186:187]
    v_pk_add_f32 v[44:45], v[44:45], v[188:189]
    v_pk_add_f32 v[46:47], v[46:47], v[190:191]
    v_pk_add_f32 v[48:49], v[48:49], v[192:193]
    v_pk_add_f32 v[50:51], v[50:51], v[194:195]
    v_pk_add_f32 v[52:53], v[52:53], v[196:197]
    v_pk_add_f32 v[54:55], v[54:55], v[198:199]
    v_pk_add_f32 v[56:57], v[56:57], v[200:201]
    v_pk_add_f32 v[58:59], v[58:59], v[202:203]
    v_pk_add_f32 v[60:61], v[60:61], v[204:205]
    v_pk_add_f32 v[62:63], v[62:63], v[206:207]
    v_cvt_pk_bf16_f32 v96, v32, v33
    v_cvt_pk_bf16_f32 v97, v34, v35
    v_cvt_pk_bf16_f32 v98, v36, v37
    v_cvt_pk_bf16_f32 v99, v38, v39
    v_cvt_pk_bf16_f32 v100, v40, v41
    v_cvt_pk_bf16_f32 v101, v42, v43
    v_cvt_pk_bf16_f32 v102, v44, v45
    v_cvt_pk_bf16_f32 v103, v46, v47
    v_cvt_pk_bf16_f32 v104, v48, v49
    v_cvt_pk_bf16_f32 v105, v50, v51
    v_cvt_pk_bf16_f32 v106, v52, v53
    v_cvt_pk_bf16_f32 v107, v54, v55
    v_cvt_pk_bf16_f32 v108, v56, v57
    v_cvt_pk_bf16_f32 v109, v58, v59
    v_cvt_pk_bf16_f32 v110, v60, v61
    v_cvt_pk_bf16_f32 v111, v62, v63
    s_mov_b32 s28, s44
    s_mov_b32 s29, s45
    s_mov_b32 s30, 4194304
    s_mov_b32 s31, 0x00020000
    v_and_b32 v16, 31, v1
    v_mul_u32_u24 v16, 144, v16
    v_lshl_add_u32 v16, v3, 3, v16
    v_mul_u32_u24 v17, 4608, v2
    v_add_u32 v16, v16, v17
    ds_write_b64 v16, v[96:97] offset:0
    ds_write_b64 v16, v[98:99] offset:16
    ds_write_b64 v16, v[100:101] offset:32
    ds_write_b64 v16, v[102:103] offset:48
    ds_write_b64 v16, v[104:105] offset:64
    ds_write_b64 v16, v[106:107] offset:80
    ds_write_b64 v16, v[108:109] offset:96
    ds_write_b64 v16, v[110:111] offset:112
    v_lshrrev_b32 v18, 3, v1
    v_and_b32 v19, 7, v1
    v_mul_u32_u24 v20, 144, v18
    v_lshl_add_u32 v20, v19, 4, v20
    v_add_u32 v20, v20, v17
    v_lshlrev_b32 v21, 11, v18
    v_lshl_add_u32 v21, v19, 4, v21
    s_lshl_b32 s3, s48, 16
    s_lshl_b32 s55, s7, 7
    s_add_u32 s3, s3, s55
    s_waitcnt lgkmcnt(0)
    ds_read_b128 v[32:35], v20 offset:0
    ds_read_b128 v[36:39], v20 offset:1152
    ds_read_b128 v[40:43], v20 offset:2304
    ds_read_b128 v[44:47], v20 offset:3456
    s_waitcnt lgkmcnt(3)
    buffer_store_dwordx4 v[32:35], v21, s[28:31], s3 offen sc1
    s_add_u32 s3, s3, 16384
    s_waitcnt lgkmcnt(2)
    buffer_store_dwordx4 v[36:39], v21, s[28:31], s3 offen sc1
    s_add_u32 s3, s3, 16384
    s_waitcnt lgkmcnt(1)
    buffer_store_dwordx4 v[40:43], v21, s[28:31], s3 offen sc1
    s_add_u32 s3, s3, 16384
    s_waitcnt lgkmcnt(0)
    buffer_store_dwordx4 v[44:47], v21, s[28:31], s3 offen sc1
    s_add_u32 s3, s3, 16384
    s_branch k_exit
c_prep:
    s_mov_b32 s28, s32
    s_mov_b32 s29, s33
    s_mov_b32 s30, 4194304
    s_mov_b32 s31, 0x00020000
    s_lshl_b32 s48, s6, 2
    s_add_u32 s48, s48, s8
    v_lshrrev_b32 v16, 3, v1
    v_and_b32 v17, 7, v1
    v_lshlrev_b32 v18, 11, v16
    v_lshl_add_u32 v18, v17, 4, v18
    s_lshl_b32 s55, s48, 16
    s_lshl_b32 s56, s7, 7
    s_add_u32 s3, s55, s56
    buffer_load_dwordx4 v[32:35], v18, s[28:31], s3 offen nt
    s_add_u32 s3, s3, 16384
    buffer_load_dwordx4 v[36:39], v18, s[28:31], s3 offen nt
    s_add_u32 s3, s3, 16384
    buffer_load_dwordx4 v[40:43], v18, s[28:31], s3 offen nt
    s_add_u32 s3, s3, 16384
    buffer_load_dwordx4 v[44:47], v18, s[28:31], s3 offen nt
    s_add_u32 s3, s3, 16384
    s_barrier
    s_lshl_b32 s56, s7, 12
    s_add_u32 s58, s55, s56
    v_lshlrev_b32 v5, 4, v1
    s_lshl_b32 s3, s8, 12
    s_add_u32 s3, s3, 131072
    v_lshrrev_b32 v18, 1, v17
    v_lshlrev_b32 v18, 10, v18
    v_lshl_add_u32 v18, v16, 4, v18
    v_and_b32 v17, 1, v17
    v_lshl_add_u32 v18, v17, 3, v18
    v_add_u32 v18, s3, v18
    v_add_u32 v19, s3, v5
    s_waitcnt vmcnt(3)
    ds_write_b64 v18, v[32:33] offset:0
    ds_write_b64 v18, v[34:35] offset:512
    s_waitcnt vmcnt(2)
    ds_write_b64 v18, v[36:37] offset:128
    ds_write_b64 v18, v[38:39] offset:640
    s_waitcnt vmcnt(1)
    ds_write_b64 v18, v[40:41] offset:256
    ds_write_b64 v18, v[42:43] offset:768
    s_waitcnt vmcnt(0)
    ds_write_b64 v18, v[44:45] offset:384
    ds_write_b64 v18, v[46:47] offset:896
    s_waitcnt lgkmcnt(0)
    ds_read_b128 v[96:99], v19 offset:0
    ds_read_b128 v[100:103], v19 offset:1024
    ds_read_b128 v[104:107], v19 offset:2048
    ds_read_b128 v[108:111], v19 offset:3072
    s_waitcnt lgkmcnt(3)
    buffer_store_dwordx4 v[96:99], v5, s[12:15], s58 offen offset:0 sc1
    s_waitcnt lgkmcnt(2)
    buffer_store_dwordx4 v[100:103], v5, s[12:15], s58 offen offset:1024 sc1
    s_waitcnt lgkmcnt(1)
    buffer_store_dwordx4 v[104:107], v5, s[12:15], s58 offen offset:2048 sc1
    s_waitcnt lgkmcnt(0)
    buffer_store_dwordx4 v[108:111], v5, s[12:15], s58 offen offset:3072 sc1
    s_branch c_wo_stat
.p2align 6
c_qkvB:
    v_and_b32 v1, 63, v0
    v_lshrrev_b32 v2, 6, v0
    v_lshlrev_b32 v5, 4, v1
    v_lshrrev_b32 v3, 5, v1
    v_and_b32 v4, 15, v0
    v_bfe_u32 v7, v1, 4, 1
    v_lshl_add_u32 v6, v7, 5, v4
    v_lshlrev_b32 v6, 4, v6
    v_lshl_add_u32 v6, v3, 10, v6
    s_lshr_b32 s48, s6, 1
    s_lshl_b32 s48, s48, 2
    s_add_u32 s48, s48, s8
    s_lshl_b32 s55, s48, 17
    s_lshl_b32 s56, s9, 22
    s_add_u32 s55, s55, s56
    s_add_u32 s16, s4, s55
    s_addc_u32 s17, s5, 0
    s_mov_b32 s18, 65536
    s_mov_b32 s19, 0x00020000
    s_add_u32 s56, s55, 65536
    s_add_u32 s20, s4, s56
    s_addc_u32 s21, s5, 0
    s_mov_b32 s22, 65536
    s_mov_b32 s23, 0x00020000
    s_lshl_b32 s49, s7, 12
    s_add_u32 s49, s49, s55
    s_and_b32 s56, s6, 1
    s_lshl_b32 s56, s56, 11
    s_add_u32 s49, s49, s56
    s_add_u32 s49, s49, 16777216
    s_movk_i32 s54, 4096
    v_lshrrev_b32 v16, 2, v4
    v_lshl_add_u32 v18, v7, 2, v16
    v_lshl_add_u32 v18, v3, 4, v18
    v_lshlrev_b32 v18, 6, v18
    v_and_b32 v17, 3, v4
    v_lshl_add_u32 v18, v17, 3, v18
    v_lshl_add_u32 v26, v7, 5, v18
    v_xor_b32 v27, 32, v26
    v_mov_b32 v24, v26
    v_mov_b32 v25, v27
    v_and_b32 v18, 0x30, v1
    v_add_u32 v10, 155648, v18
    v_lshlrev_b32 v11, 2, v4
    v_add_u32 v11, 155648, v11
    v_lshl_add_u32 v8, v2, 8, v11
    v_lshl_add_u32 v9, v2, 8, v10
    s_lshr_b32 s3, s8, 1
    s_and_b32 s55, s8, 1
    s_lshl_b32 s3, s3, 14
    s_lshl_b32 s55, s55, 12
    s_add_u32 s3, s3, s55
    s_add_u32 s3, s3, 81920
    v_lshl_add_u32 v12, v3, 5, v4
    v_lshlrev_b32 v12, 4, v12
    v_lshl_add_u32 v12, v7, 10, v12
    v_add_u32 v12, s3, v12
    v_add_u32 v13, s3, v5
    s_lshr_b32 s84, s9, 1
    s_lshl_b32 s84, s84, 23
    s_lshl_b32 s3, s7, 19
    s_add_u32 s84, s84, s3
    s_and_b32 s3, s6, 1
    s_lshl_b32 s3, s3, 18
    s_add_u32 s84, s84, s3
    s_add_u32 s84, s84, 33554432
    s_lshr_b32 s86, s6, 1
    s_lshl_b32 s3, s86, 15
    s_add_u32 s84, s84, s3
    s_sub_u32 s84, s84, 81920
    s_add_u32 s85, s84, 8192
    s_mul_i32 s53, s9, 786432
    s_add_u32 s53, s53, 66322432
    s_and_b32 s3, s11, 31
    s_lshl_b32 s3, s3, 10
    s_add_u32 s53, s53, s3
    s_lshr_b32 s3, s86, 1
    s_lshl_b32 s3, s3, 7
    s_add_u32 s53, s53, s3
    s_and_b32 s3, s86, 1
    s_lshl_b32 s3, s3, 2
    s_add_u32 s3, s3, s8
    s_lshl_b32 s3, s3, 2
    s_add_u32 s53, s53, s3
    v_lshlrev_b32 v28, 15, v1
    v_mov_b32 v29, s10
    v_mov_b32 v32, 0
    v_mov_b32 v33, 0
    v_mov_b32 v34, 0
    v_mov_b32 v35, 0
    v_mov_b32 v36, 0
    v_mov_b32 v37, 0
    v_mov_b32 v38, 0
    v_mov_b32 v39, 0
    v_mov_b32 v40, 0
    v_mov_b32 v41, 0
    v_mov_b32 v42, 0
    v_mov_b32 v43, 0
    v_mov_b32 v44, 0
    v_mov_b32 v45, 0
    v_mov_b32 v46, 0
    v_mov_b32 v47, 0
    v_mov_b32 v48, 0
    v_mov_b32 v49, 0
    v_mov_b32 v50, 0
    v_mov_b32 v51, 0
    v_mov_b32 v52, 0
    v_mov_b32 v53, 0
    v_mov_b32 v54, 0
    v_mov_b32 v55, 0
    v_mov_b32 v56, 0
    v_mov_b32 v57, 0
    v_mov_b32 v58, 0
    v_mov_b32 v59, 0
    v_mov_b32 v60, 0
    v_mov_b32 v61, 0
    v_mov_b32 v62, 0
    v_mov_b32 v63, 0
    v_mov_b32 v64, 0
    v_mov_b32 v65, 0
    v_mov_b32 v66, 0
    v_mov_b32 v67, 0
    v_mov_b32 v68, 0
    v_mov_b32 v69, 0
    v_mov_b32 v70, 0
    v_mov_b32 v71, 0
    v_mov_b32 v72, 0
    v_mov_b32 v73, 0
    v_mov_b32 v74, 0
    v_mov_b32 v75, 0
    v_mov_b32 v76, 0
    v_mov_b32 v77, 0
    v_mov_b32 v78, 0
    v_mov_b32 v79, 0
    v_mov_b32 v80, 0
    v_mov_b32 v81, 0
    v_mov_b32 v82, 0
    v_mov_b32 v83, 0
    v_mov_b32 v84, 0
    v_mov_b32 v85, 0
    v_mov_b32 v86, 0
    v_mov_b32 v87, 0
    v_mov_b32 v88, 0
    v_mov_b32 v89, 0
    v_mov_b32 v90, 0
    v_mov_b32 v91, 0
    v_mov_b32 v92, 0
    v_mov_b32 v93, 0
    v_mov_b32 v94, 0
    v_mov_b32 v95, 0
    v_mov_b32 v96, 0
    v_mov_b32 v97, 0
    v_mov_b32 v98, 0
    v_mov_b32 v99, 0
    v_mov_b32 v100, 0
    v_mov_b32 v101, 0
    v_mov_b32 v102, 0
    v_mov_b32 v103, 0
    v_mov_b32 v104, 0
    v_mov_b32 v105, 0
    v_mov_b32 v106, 0
    v_mov_b32 v107, 0
    v_mov_b32 v108, 0
    v_mov_b32 v109, 0
    v_mov_b32 v110, 0
    v_mov_b32 v111, 0
    v_mov_b32 v112, 0
    v_mov_b32 v113, 0
    v_mov_b32 v114, 0
    v_mov_b32 v115, 0
    v_mov_b32 v116, 0
    v_mov_b32 v117, 0
    v_mov_b32 v118, 0
    v_mov_b32 v119, 0
    v_mov_b32 v120, 0
    v_mov_b32 v121, 0
    v_mov_b32 v122, 0
    v_mov_b32 v123, 0
    v_mov_b32 v124, 0
    v_mov_b32 v125, 0
    v_mov_b32 v126, 0
    v_mov_b32 v127, 0
    s_mov_b32 s50, 8192
    s_mov_b32 s58, 6144
    s_mov_b32 s51, 12288
    s_mov_b32 s59, 10240
    s_mov_b32 s52, 0
    s_mul_i32 s60, s9, 786432
    s_add_u32 s60, s60, 65273856
    s_lshl_b32 s61, s11, 10
    s_add_u32 s60, s60, s61
    s_and_b32 s61, s8, 2
    s_lshl_b32 s61, s61, 7
    s_add_u32 s60, s60, s61
    s_add_u32 s61, s60, 128
    s_mov_b32 s98, s10
    s_mov_b32 s99, s10
    s_mov_b32 s3, 0x100000
cp_9:
    s_load_dwordx8 s[64:71], s[4:5], s60 glc
    s_load_dwordx8 s[72:79], s[4:5], s61 glc
    s_sub_u32 s3, s3, 1
    s_cbranch_scc1 cp_9_ok
    s_waitcnt lgkmcnt(0)
    s_xor_b64 s[100:101], s[64:65], s[98:99]
    s_xor_b64 s[64:65], s[66:67], s[98:99]
    s_or_b64 s[100:101], s[100:101], s[64:65]
    s_xor_b64 s[64:65], s[68:69], s[98:99]
    s_or_b64 s[100:101], s[100:101], s[64:65]
    s_xor_b64 s[64:65], s[70:71], s[98:99]
    s_or_b64 s[100:101], s[100:101], s[64:65]
    s_xor_b64 s[64:65], s[72:73], s[98:99]
    s_or_b64 s[100:101], s[100:101], s[64:65]
    s_xor_b64 s[64:65], s[74:75], s[98:99]
    s_or_b64 s[100:101], s[100:101], s[64:65]
    s_xor_b64 s[64:65], s[76:77], s[98:99]
    s_or_b64 s[100:101], s[100:101], s[64:65]
    s_xor_b64 s[64:65], s[78:79], s[98:99]
    s_or_b64 s[100:101], s[100:101], s[64:65]
    s_cbranch_scc1 cp_9
cp_9_ok:
    s_waitcnt lgkmcnt(0)
    buffer_load_dwordx4 v[152:155], v6, s[16:19], 0 offen offset:0 sc1
    buffer_load_dwordx4 v[156:159], v6, s[16:19], 0 offen offset:256 sc1
    buffer_load_dwordx4 v[160:163], v6, s[20:23], 0 offen offset:0 sc1
    buffer_load_dwordx4 v[164:167], v6, s[20:23], 0 offen offset:256 sc1
    buffer_load_dwordx4 v[168:171], v6, s[16:19], 0 offen offset:2048 sc1
    buffer_load_dwordx4 v[172:175], v6, s[16:19], 0 offen offset:2304 sc1
    buffer_load_dwordx4 v[176:179], v6, s[20:23], 0 offen offset:2048 sc1
    buffer_load_dwordx4 v[180:183], v6, s[20:23], 0 offen offset:2304 sc1
    s_barrier
    ds_read_b64_tr_b16 v[128:129], v24 offset:0
    ds_read_b64_tr_b16 v[130:131], v24 offset:512
    ds_read_b64_tr_b16 v[132:133], v25 offset:0
    ds_read_b64_tr_b16 v[134:135], v25 offset:512
    ds_read_b64_tr_b16 v[136:137], v24 offset:8192
    ds_read_b64_tr_b16 v[138:139], v24 offset:8704
    ds_read_b64_tr_b16 v[140:141], v25 offset:8192
    ds_read_b64_tr_b16 v[142:143], v25 offset:8704
    ds_read_b64_tr_b16 v[144:145], v24 offset:16384
    ds_read_b64_tr_b16 v[146:147], v24 offset:16896
    buffer_load_dwordx4 a[0:3], v6, s[16:19], s54 offen offset:0 sc1
    buffer_load_dwordx4 a[4:7], v6, s[16:19], s54 offen offset:256 sc1
    buffer_load_dwordx4 a[8:11], v6, s[20:23], s54 offen offset:0 sc1
    buffer_load_dwordx4 a[12:15], v6, s[20:23], s54 offen offset:256 sc1
    buffer_load_dwordx4 a[16:19], v6, s[16:19], s54 offen offset:2048 sc1
    buffer_load_dwordx4 a[20:23], v6, s[16:19], s54 offen offset:2304 sc1
    s_mov_b32 s54, 7
.p2align 3
c_qkvB_loop:
    s_waitcnt vmcnt(12) lgkmcnt(8)
    v_mfma_f32_16x16x32_bf16 v[32:35], v[128:131], v[152:155], v[32:35]
    ds_read_b64_tr_b16 v[148:149], v25 offset:16384
    buffer_load_dwordx4 a[24:27], v6, s[20:23], s58 offen offset:0 sc1
    v_mfma_f32_16x16x32_bf16 v[36:39], v[128:131], v[156:159], v[36:39]
    ds_read_b64_tr_b16 v[150:151], v25 offset:16896
    s_waitcnt lgkmcnt(8)
    v_mfma_f32_16x16x32_bf16 v[52:55], v[132:135], v[156:159], v[52:55]
    v_mfma_f32_16x16x32_bf16 v[48:51], v[132:135], v[152:155], v[48:51]
    s_waitcnt lgkmcnt(6)
    v_mfma_f32_16x16x32_bf16 v[64:67], v[136:139], v[152:155], v[64:67]
    v_mfma_f32_16x16x32_bf16 v[68:71], v[136:139], v[156:159], v[68:71]
    s_waitcnt lgkmcnt(4)
    v_mfma_f32_16x16x32_bf16 v[84:87], v[140:143], v[156:159], v[84:87]
    buffer_load_dwordx4 a[28:31], v6, s[20:23], s58 offen offset:256 sc1
    v_mfma_f32_16x16x32_bf16 v[80:83], v[140:143], v[152:155], v[80:83]
    s_waitcnt lgkmcnt(2)
    v_mfma_f32_16x16x32_bf16 v[96:99], v[152:155], v[144:147], v[96:99]
    v_mfma_f32_16x16x32_bf16 v[100:103], v[156:159], v[144:147], v[100:103]
    s_waitcnt lgkmcnt(0)
    v_mfma_f32_16x16x32_bf16 v[116:119], v[156:159], v[148:151], v[116:119]
    v_mfma_f32_16x16x32_bf16 v[112:115], v[152:155], v[148:151], v[112:115]
    s_waitcnt vmcnt(12)
    v_mfma_f32_16x16x32_bf16 v[40:43], v[128:131], v[160:163], v[40:43]
    buffer_load_dwordx4 v[152:155], v6, s[16:19], s50 offen offset:0 sc1
    v_mfma_f32_16x16x32_bf16 v[44:47], v[128:131], v[164:167], v[44:47]
    v_mfma_f32_16x16x32_bf16 v[60:63], v[132:135], v[164:167], v[60:63]
    ds_read_b64_tr_b16 v[128:129], v24 offset:2048
    v_mfma_f32_16x16x32_bf16 v[56:59], v[132:135], v[160:163], v[56:59]
    ds_read_b64_tr_b16 v[130:131], v24 offset:2560
    v_mfma_f32_16x16x32_bf16 v[72:75], v[136:139], v[160:163], v[72:75]
    ds_read_b64_tr_b16 v[132:133], v25 offset:2048
    v_mfma_f32_16x16x32_bf16 v[76:79], v[136:139], v[164:167], v[76:79]
    ds_read_b64_tr_b16 v[134:135], v25 offset:2560
    v_mfma_f32_16x16x32_bf16 v[92:95], v[140:143], v[164:167], v[92:95]
    ds_read_b64_tr_b16 v[136:137], v24 offset:10240
    buffer_load_dwordx4 v[156:159], v6, s[16:19], s50 offen offset:256 sc1
    v_mfma_f32_16x16x32_bf16 v[88:91], v[140:143], v[160:163], v[88:91]
    ds_read_b64_tr_b16 v[138:139], v24 offset:10752
    v_mfma_f32_16x16x32_bf16 v[104:107], v[160:163], v[144:147], v[104:107]
    ds_read_b64_tr_b16 v[140:141], v25 offset:10240
    v_mfma_f32_16x16x32_bf16 v[108:111], v[164:167], v[144:147], v[108:111]
    ds_read_b64_tr_b16 v[142:143], v25 offset:10752
    v_mfma_f32_16x16x32_bf16 v[124:127], v[164:167], v[148:151], v[124:127]
    ds_read_b64_tr_b16 v[144:145], v24 offset:18432
    v_mfma_f32_16x16x32_bf16 v[120:123], v[160:163], v[148:151], v[120:123]
    ds_read_b64_tr_b16 v[146:147], v24 offset:18944
    s_waitcnt vmcnt(12) lgkmcnt(8)
    v_mfma_f32_16x16x32_bf16 v[32:35], v[128:131], v[168:171], v[32:35]
    ds_read_b64_tr_b16 v[148:149], v25 offset:18432
    buffer_load_dwordx4 v[160:163], v6, s[20:23], s58 offen offset:2048 sc1
    v_mfma_f32_16x16x32_bf16 v[36:39], v[128:131], v[172:175], v[36:39]
    ds_read_b64_tr_b16 v[150:151], v25 offset:18944
    s_waitcnt lgkmcnt(8)
    v_mfma_f32_16x16x32_bf16 v[52:55], v[132:135], v[172:175], v[52:55]
    v_mfma_f32_16x16x32_bf16 v[48:51], v[132:135], v[168:171], v[48:51]
    s_waitcnt lgkmcnt(6)
    v_mfma_f32_16x16x32_bf16 v[64:67], v[136:139], v[168:171], v[64:67]
    v_mfma_f32_16x16x32_bf16 v[68:71], v[136:139], v[172:175], v[68:71]
    s_waitcnt lgkmcnt(4)
    v_mfma_f32_16x16x32_bf16 v[84:87], v[140:143], v[172:175], v[84:87]
    buffer_load_dwordx4 v[164:167], v6, s[20:23], s58 offen offset:2304 sc1
    v_mfma_f32_16x16x32_bf16 v[80:83], v[140:143], v[168:171], v[80:83]
    s_waitcnt lgkmcnt(2)
    v_mfma_f32_16x16x32_bf16 v[96:99], v[168:171], v[144:147], v[96:99]
    v_mfma_f32_16x16x32_bf16 v[100:103], v[172:175], v[144:147], v[100:103]
    s_waitcnt lgkmcnt(0)
    v_mfma_f32_16x16x32_bf16 v[116:119], v[172:175], v[148:151], v[116:119]
    v_mfma_f32_16x16x32_bf16 v[112:115], v[168:171], v[148:151], v[112:115]
    s_waitcnt vmcnt(12)
    v_mfma_f32_16x16x32_bf16 v[40:43], v[128:131], v[176:179], v[40:43]
    buffer_load_dwordx4 v[168:171], v6, s[16:19], s50 offen offset:2048 sc1
    v_mfma_f32_16x16x32_bf16 v[44:47], v[128:131], v[180:183], v[44:47]
    v_mfma_f32_16x16x32_bf16 v[60:63], v[132:135], v[180:183], v[60:63]
    ds_read_b64_tr_b16 v[128:129], v24 offset:4096
    v_mfma_f32_16x16x32_bf16 v[56:59], v[132:135], v[176:179], v[56:59]
    ds_read_b64_tr_b16 v[130:131], v24 offset:4608
    v_mfma_f32_16x16x32_bf16 v[72:75], v[136:139], v[176:179], v[72:75]
    ds_read_b64_tr_b16 v[132:133], v25 offset:4096
    v_mfma_f32_16x16x32_bf16 v[76:79], v[136:139], v[180:183], v[76:79]
    ds_read_b64_tr_b16 v[134:135], v25 offset:4608
    v_mfma_f32_16x16x32_bf16 v[92:95], v[140:143], v[180:183], v[92:95]
    ds_read_b64_tr_b16 v[136:137], v24 offset:12288
    buffer_load_dwordx4 v[172:175], v6, s[16:19], s50 offen offset:2304 sc1
    v_mfma_f32_16x16x32_bf16 v[88:91], v[140:143], v[176:179], v[88:91]
    ds_read_b64_tr_b16 v[138:139], v24 offset:12800
    v_mfma_f32_16x16x32_bf16 v[104:107], v[176:179], v[144:147], v[104:107]
    ds_read_b64_tr_b16 v[140:141], v25 offset:12288
    v_mfma_f32_16x16x32_bf16 v[108:111], v[180:183], v[144:147], v[108:111]
    ds_read_b64_tr_b16 v[142:143], v25 offset:12800
    v_mfma_f32_16x16x32_bf16 v[124:127], v[180:183], v[148:151], v[124:127]
    ds_read_b64_tr_b16 v[144:145], v24 offset:20480
    v_mfma_f32_16x16x32_bf16 v[120:123], v[176:179], v[148:151], v[120:123]
    ds_read_b64_tr_b16 v[146:147], v24 offset:20992
    s_waitcnt vmcnt(12) lgkmcnt(8)
    v_mfma_f32_16x16x32_bf16 v[32:35], v[128:131], a[0:3], v[32:35]
    ds_read_b64_tr_b16 v[148:149], v25 offset:20480
    buffer_load_dwordx4 v[176:179], v6, s[20:23], s59 offen offset:0 sc1
    v_mfma_f32_16x16x32_bf16 v[36:39], v[128:131], a[4:7], v[36:39]
    ds_read_b64_tr_b16 v[150:151], v25 offset:20992
    s_waitcnt lgkmcnt(8)
    v_mfma_f32_16x16x32_bf16 v[52:55], v[132:135], a[4:7], v[52:55]
    v_mfma_f32_16x16x32_bf16 v[48:51], v[132:135], a[0:3], v[48:51]
    s_waitcnt lgkmcnt(6)
    v_mfma_f32_16x16x32_bf16 v[64:67], v[136:139], a[0:3], v[64:67]
    v_mfma_f32_16x16x32_bf16 v[68:71], v[136:139], a[4:7], v[68:71]
    s_waitcnt lgkmcnt(4)
    v_mfma_f32_16x16x32_bf16 v[84:87], v[140:143], a[4:7], v[84:87]
    buffer_load_dwordx4 v[180:183], v6, s[20:23], s59 offen offset:256 sc1
    v_mfma_f32_16x16x32_bf16 v[80:83], v[140:143], a[0:3], v[80:83]
    s_waitcnt lgkmcnt(2)
    v_mfma_f32_16x16x32_bf16 v[96:99], a[0:3], v[144:147], v[96:99]
    v_mfma_f32_16x16x32_bf16 v[100:103], a[4:7], v[144:147], v[100:103]
    s_waitcnt lgkmcnt(0)
    v_mfma_f32_16x16x32_bf16 v[116:119], a[4:7], v[148:151], v[116:119]
    v_mfma_f32_16x16x32_bf16 v[112:115], a[0:3], v[148:151], v[112:115]
    s_waitcnt vmcnt(12)
    v_mfma_f32_16x16x32_bf16 v[40:43], v[128:131], a[8:11], v[40:43]
    buffer_load_dwordx4 a[0:3], v6, s[16:19], s51 offen offset:0 sc1
    v_mfma_f32_16x16x32_bf16 v[44:47], v[128:131], a[12:15], v[44:47]
    v_mfma_f32_16x16x32_bf16 v[60:63], v[132:135], a[12:15], v[60:63]
    ds_read_b64_tr_b16 v[128:129], v24 offset:6144
    v_mfma_f32_16x16x32_bf16 v[56:59], v[132:135], a[8:11], v[56:59]
    ds_read_b64_tr_b16 v[130:131], v24 offset:6656
    v_mfma_f32_16x16x32_bf16 v[72:75], v[136:139], a[8:11], v[72:75]
    ds_read_b64_tr_b16 v[132:133], v25 offset:6144
    v_mfma_f32_16x16x32_bf16 v[76:79], v[136:139], a[12:15], v[76:79]
    ds_read_b64_tr_b16 v[134:135], v25 offset:6656
    v_mfma_f32_16x16x32_bf16 v[92:95], v[140:143], a[12:15], v[92:95]
    ds_read_b64_tr_b16 v[136:137], v24 offset:14336
    buffer_load_dwordx4 a[4:7], v6, s[16:19], s51 offen offset:256 sc1
    v_mfma_f32_16x16x32_bf16 v[88:91], v[140:143], a[8:11], v[88:91]
    ds_read_b64_tr_b16 v[138:139], v24 offset:14848
    v_mfma_f32_16x16x32_bf16 v[104:107], a[8:11], v[144:147], v[104:107]
    ds_read_b64_tr_b16 v[140:141], v25 offset:14336
    v_mfma_f32_16x16x32_bf16 v[108:111], a[12:15], v[144:147], v[108:111]
    ds_read_b64_tr_b16 v[142:143], v25 offset:14848
    v_mfma_f32_16x16x32_bf16 v[124:127], a[12:15], v[148:151], v[124:127]
    ds_read_b64_tr_b16 v[144:145], v24 offset:22528
    v_mfma_f32_16x16x32_bf16 v[120:123], a[8:11], v[148:151], v[120:123]
    ds_read_b64_tr_b16 v[146:147], v24 offset:23040
    s_waitcnt vmcnt(12) lgkmcnt(8)
    v_mfma_f32_16x16x32_bf16 v[32:35], v[128:131], a[16:19], v[32:35]
    ds_read_b64_tr_b16 v[148:149], v25 offset:22528
    buffer_load_dwordx4 a[8:11], v6, s[20:23], s59 offen offset:2048 sc1
    v_mfma_f32_16x16x32_bf16 v[36:39], v[128:131], a[20:23], v[36:39]
    ds_read_b64_tr_b16 v[150:151], v25 offset:23040
    s_waitcnt lgkmcnt(8)
    v_mfma_f32_16x16x32_bf16 v[52:55], v[132:135], a[20:23], v[52:55]
    v_mfma_f32_16x16x32_bf16 v[48:51], v[132:135], a[16:19], v[48:51]
    s_waitcnt lgkmcnt(6)
    v_mfma_f32_16x16x32_bf16 v[64:67], v[136:139], a[16:19], v[64:67]
    v_mfma_f32_16x16x32_bf16 v[68:71], v[136:139], a[20:23], v[68:71]
    s_waitcnt lgkmcnt(4)
    v_mfma_f32_16x16x32_bf16 v[84:87], v[140:143], a[20:23], v[84:87]
    buffer_load_dwordx4 a[12:15], v6, s[20:23], s59 offen offset:2304 sc1
    v_mfma_f32_16x16x32_bf16 v[80:83], v[140:143], a[16:19], v[80:83]
    s_waitcnt lgkmcnt(2)
    v_mfma_f32_16x16x32_bf16 v[96:99], a[16:19], v[144:147], v[96:99]
    s_add_u32 s52, s52, 24576
    v_mfma_f32_16x16x32_bf16 v[100:103], a[20:23], v[144:147], v[100:103]
    s_cmp_eq_u32 s52, 147456
    s_waitcnt lgkmcnt(0)
    v_mfma_f32_16x16x32_bf16 v[116:119], a[20:23], v[148:151], v[116:119]
    s_cselect_b32 s52, 0, s52
    v_mfma_f32_16x16x32_bf16 v[112:115], a[16:19], v[148:151], v[112:115]
    s_add_u32 s58, s58, 8192
    s_add_u32 s59, s59, 8192
    s_waitcnt vmcnt(12)
    v_mfma_f32_16x16x32_bf16 v[40:43], v[128:131], a[24:27], v[40:43]
    buffer_load_dwordx4 a[16:19], v6, s[16:19], s51 offen offset:2048 sc1
    s_barrier
    v_add_u32 v24, s52, v26
    v_mfma_f32_16x16x32_bf16 v[44:47], v[128:131], a[28:31], v[44:47]
    v_add_u32 v25, s52, v27
    v_mfma_f32_16x16x32_bf16 v[60:63], v[132:135], a[28:31], v[60:63]
    ds_read_b64_tr_b16 v[128:129], v24 offset:0
    v_mfma_f32_16x16x32_bf16 v[56:59], v[132:135], a[24:27], v[56:59]
    ds_read_b64_tr_b16 v[130:131], v24 offset:512
    v_mfma_f32_16x16x32_bf16 v[72:75], v[136:139], a[24:27], v[72:75]
    ds_read_b64_tr_b16 v[132:133], v25 offset:0
    v_mfma_f32_16x16x32_bf16 v[76:79], v[136:139], a[28:31], v[76:79]
    ds_read_b64_tr_b16 v[134:135], v25 offset:512
    v_mfma_f32_16x16x32_bf16 v[92:95], v[140:143], a[28:31], v[92:95]
    ds_read_b64_tr_b16 v[136:137], v24 offset:8192
    buffer_load_dwordx4 a[20:23], v6, s[16:19], s51 offen offset:2304 sc1
    v_mfma_f32_16x16x32_bf16 v[88:91], v[140:143], a[24:27], v[88:91]
    ds_read_b64_tr_b16 v[138:139], v24 offset:8704
    v_mfma_f32_16x16x32_bf16 v[104:107], a[24:27], v[144:147], v[104:107]
    ds_read_b64_tr_b16 v[140:141], v25 offset:8192
    s_add_u32 s50, s50, 8192
    v_mfma_f32_16x16x32_bf16 v[108:111], a[28:31], v[144:147], v[108:111]
    ds_read_b64_tr_b16 v[142:143], v25 offset:8704
    s_add_u32 s51, s51, 8192
    v_mfma_f32_16x16x32_bf16 v[124:127], a[28:31], v[148:151], v[124:127]
    ds_read_b64_tr_b16 v[144:145], v24 offset:16384
    s_sub_u32 s54, s54, 1
    v_mfma_f32_16x16x32_bf16 v[120:123], a[24:27], v[148:151], v[120:123]
    ds_read_b64_tr_b16 v[146:147], v24 offset:16896
    s_cmp_lg_u32 s54, 0
    s_cbranch_scc1 c_qkvB_loop
    s_waitcnt vmcnt(12) lgkmcnt(8)
    v_mfma_f32_16x16x32_bf16 v[32:35], v[128:131], v[152:155], v[32:35]
    ds_read_b64_tr_b16 v[148:149], v25 offset:16384
    buffer_load_dwordx4 a[24:27], v6, s[20:23], s58 offen offset:0 sc1
    v_mfma_f32_16x16x32_bf16 v[36:39], v[128:131], v[156:159], v[36:39]
    ds_read_b64_tr_b16 v[150:151], v25 offset:16896
    s_waitcnt lgkmcnt(8)
    v_mfma_f32_16x16x32_bf16 v[52:55], v[132:135], v[156:159], v[52:55]
    ds_read_b32 v184, v8 offset:1280
    v_mfma_f32_16x16x32_bf16 v[48:51], v[132:135], v[152:155], v[48:51]
    ds_read_b32 v186, v8 offset:1344
    s_waitcnt lgkmcnt(8)
    v_mfma_f32_16x16x32_bf16 v[64:67], v[136:139], v[152:155], v[64:67]
    ds_read_b32 v188, v8 offset:1408
    v_mfma_f32_16x16x32_bf16 v[68:71], v[136:139], v[156:159], v[68:71]
    s_waitcnt lgkmcnt(7)
    v_mfma_f32_16x16x32_bf16 v[84:87], v[140:143], v[156:159], v[84:87]
    buffer_load_dwordx4 a[28:31], v6, s[20:23], s58 offen offset:256 sc1
    ds_read_b32 v190, v8 offset:1472
    v_mfma_f32_16x16x32_bf16 v[80:83], v[140:143], v[152:155], v[80:83]
    ds_read_b128 v[212:215], v10 offset:512
    s_waitcnt lgkmcnt(7)
    v_mfma_f32_16x16x32_bf16 v[96:99], v[152:155], v[144:147], v[96:99]
    ds_read_b128 v[216:219], v10 offset:576
    v_mfma_f32_16x16x32_bf16 v[100:103], v[156:159], v[144:147], v[100:103]
    s_waitcnt lgkmcnt(6)
    v_mfma_f32_16x16x32_bf16 v[116:119], v[156:159], v[148:151], v[116:119]
    v_mfma_f32_16x16x32_bf16 v[112:115], v[152:155], v[148:151], v[112:115]
    s_waitcnt vmcnt(12)
    v_mfma_f32_16x16x32_bf16 v[40:43], v[128:131], v[160:163], v[40:43]
    s_waitcnt lgkmcnt(0)
    v_fma_f32 v64, -v184, v212, v64
    v_fma_f32 v65, -v184, v213, v65
    v_mfma_f32_16x16x32_bf16 v[44:47], v[128:131], v[164:167], v[44:47]
    v_fma_f32 v66, -v184, v214, v66
    v_mfma_f32_16x16x32_bf16 v[60:63], v[132:135], v[164:167], v[60:63]
    ds_read_b64_tr_b16 v[128:129], v24 offset:2048
    v_fma_f32 v67, -v184, v215, v67
    v_mfma_f32_16x16x32_bf16 v[56:59], v[132:135], v[160:163], v[56:59]
    ds_read_b64_tr_b16 v[130:131], v24 offset:2560
    v_fma_f32 v68, -v186, v212, v68
    v_fma_f32 v69, -v186, v213, v69
    v_mfma_f32_16x16x32_bf16 v[72:75], v[136:139], v[160:163], v[72:75]
    ds_read_b64_tr_b16 v[132:133], v25 offset:2048
    v_fma_f32 v70, -v186, v214, v70
    v_mfma_f32_16x16x32_bf16 v[76:79], v[136:139], v[164:167], v[76:79]
    ds_read_b64_tr_b16 v[134:135], v25 offset:2560
    v_fma_f32 v71, -v186, v215, v71
    v_mfma_f32_16x16x32_bf16 v[92:95], v[140:143], v[164:167], v[92:95]
    ds_read_b64_tr_b16 v[136:137], v24 offset:10240
    v_fma_f32 v80, -v184, v216, v80
    v_fma_f32 v81, -v184, v217, v81
    v_mfma_f32_16x16x32_bf16 v[88:91], v[140:143], v[160:163], v[88:91]
    ds_read_b64_tr_b16 v[138:139], v24 offset:10752
    v_fma_f32 v82, -v184, v218, v82
    v_mfma_f32_16x16x32_bf16 v[104:107], v[160:163], v[144:147], v[104:107]
    ds_read_b64_tr_b16 v[140:141], v25 offset:10240
    v_fma_f32 v83, -v184, v219, v83
    v_mfma_f32_16x16x32_bf16 v[108:111], v[164:167], v[144:147], v[108:111]
    ds_read_b64_tr_b16 v[142:143], v25 offset:10752
    v_fma_f32 v84, -v186, v216, v84
    v_fma_f32 v85, -v186, v217, v85
    v_mfma_f32_16x16x32_bf16 v[124:127], v[164:167], v[148:151], v[124:127]
    ds_read_b64_tr_b16 v[144:145], v24 offset:18432
    v_fma_f32 v86, -v186, v218, v86
    v_mfma_f32_16x16x32_bf16 v[120:123], v[160:163], v[148:151], v[120:123]
    ds_read_b64_tr_b16 v[146:147], v24 offset:18944
    v_fma_f32 v87, -v186, v219, v87
    s_waitcnt vmcnt(10) lgkmcnt(8)
    v_mfma_f32_16x16x32_bf16 v[32:35], v[128:131], v[168:171], v[32:35]
    ds_read_b64_tr_b16 v[148:149], v25 offset:18432
    v_fma_f32 v72, -v188, v212, v72
    v_fma_f32 v73, -v188, v213, v73
    v_mfma_f32_16x16x32_bf16 v[36:39], v[128:131], v[172:175], v[36:39]
    ds_read_b64_tr_b16 v[150:151], v25 offset:18944
    v_fma_f32 v74, -v188, v214, v74
    s_waitcnt lgkmcnt(8)
    v_mfma_f32_16x16x32_bf16 v[52:55], v[132:135], v[172:175], v[52:55]
    v_fma_f32 v75, -v188, v215, v75
    ds_read_b128 v[152:155], v10 offset:384
    v_mfma_f32_16x16x32_bf16 v[48:51], v[132:135], v[168:171], v[48:51]
    v_fma_f32 v76, -v190, v212, v76
    v_fma_f32 v77, -v190, v213, v77
    ds_read_b128 v[156:159], v10 offset:448
    s_waitcnt lgkmcnt(8)
    v_mfma_f32_16x16x32_bf16 v[64:67], v[136:139], v[168:171], v[64:67]
    v_fma_f32 v78, -v190, v214, v78
    ds_read_b32 v185, v8 offset:2816
    v_mfma_f32_16x16x32_bf16 v[68:71], v[136:139], v[172:175], v[68:71]
    v_fma_f32 v79, -v190, v215, v79
    s_waitcnt lgkmcnt(7)
    v_mfma_f32_16x16x32_bf16 v[84:87], v[140:143], v[172:175], v[84:87]
    v_fma_f32 v88, -v188, v216, v88
    v_fma_f32 v89, -v188, v217, v89
    ds_read_b32 v187, v8 offset:2880
    v_mfma_f32_16x16x32_bf16 v[80:83], v[140:143], v[168:171], v[80:83]
    v_fma_f32 v90, -v188, v218, v90
    ds_read_b32 v189, v8 offset:2944
    s_waitcnt lgkmcnt(7)
    v_mfma_f32_16x16x32_bf16 v[96:99], v[168:171], v[144:147], v[96:99]
    v_fma_f32 v91, -v188, v219, v91
    ds_read_b32 v191, v8 offset:3008
    v_mfma_f32_16x16x32_bf16 v[100:103], v[172:175], v[144:147], v[100:103]
    v_fma_f32 v92, -v190, v216, v92
    v_fma_f32 v93, -v190, v217, v93
    s_waitcnt lgkmcnt(6)
    v_mfma_f32_16x16x32_bf16 v[116:119], v[172:175], v[148:151], v[116:119]
    v_fma_f32 v94, -v190, v218, v94
    v_mfma_f32_16x16x32_bf16 v[112:115], v[168:171], v[148:151], v[112:115]
    v_fma_f32 v95, -v190, v219, v95
    s_waitcnt vmcnt(8)
    v_mfma_f32_16x16x32_bf16 v[40:43], v[128:131], v[176:179], v[40:43]
    s_waitcnt lgkmcnt(0)
    v_fma_f32 v32, -v184, v152, v32
    v_fma_f32 v33, -v184, v153, v33
    v_mfma_f32_16x16x32_bf16 v[44:47], v[128:131], v[180:183], v[44:47]
    v_fma_f32 v34, -v184, v154, v34
    v_mfma_f32_16x16x32_bf16 v[60:63], v[132:135], v[180:183], v[60:63]
    ds_read_b64_tr_b16 v[128:129], v24 offset:4096
    v_fma_f32 v35, -v184, v155, v35
    v_fma_f32 v36, -v186, v152, v36
    v_mfma_f32_16x16x32_bf16 v[56:59], v[132:135], v[176:179], v[56:59]
    ds_read_b64_tr_b16 v[130:131], v24 offset:4608
    v_fma_f32 v37, -v186, v153, v37
    v_mfma_f32_16x16x32_bf16 v[72:75], v[136:139], v[176:179], v[72:75]
    ds_read_b64_tr_b16 v[132:133], v25 offset:4096
    v_fma_f32 v38, -v186, v154, v38
    v_fma_f32 v39, -v186, v155, v39
    v_mfma_f32_16x16x32_bf16 v[76:79], v[136:139], v[180:183], v[76:79]
    ds_read_b64_tr_b16 v[134:135], v25 offset:4608
    v_fma_f32 v48, -v184, v156, v48
    v_mfma_f32_16x16x32_bf16 v[92:95], v[140:143], v[180:183], v[92:95]
    ds_read_b64_tr_b16 v[136:137], v24 offset:12288
    v_fma_f32 v49, -v184, v157, v49
    v_fma_f32 v50, -v184, v158, v50
    v_mfma_f32_16x16x32_bf16 v[88:91], v[140:143], v[176:179], v[88:91]
    ds_read_b64_tr_b16 v[138:139], v24 offset:12800
    v_fma_f32 v51, -v184, v159, v51
    v_mfma_f32_16x16x32_bf16 v[104:107], v[176:179], v[144:147], v[104:107]
    ds_read_b64_tr_b16 v[140:141], v25 offset:12288
    v_fma_f32 v52, -v186, v156, v52
    v_fma_f32 v53, -v186, v157, v53
    v_mfma_f32_16x16x32_bf16 v[108:111], v[180:183], v[144:147], v[108:111]
    ds_read_b64_tr_b16 v[142:143], v25 offset:12800
    v_fma_f32 v54, -v186, v158, v54
    v_mfma_f32_16x16x32_bf16 v[124:127], v[180:183], v[148:151], v[124:127]
    ds_read_b64_tr_b16 v[144:145], v24 offset:20480
    v_fma_f32 v55, -v186, v159, v55
    v_mfma_f32_16x16x32_bf16 v[120:123], v[176:179], v[148:151], v[120:123]
    ds_read_b64_tr_b16 v[146:147], v24 offset:20992
    s_waitcnt vmcnt(6) lgkmcnt(8)
    v_mfma_f32_16x16x32_bf16 v[32:35], v[128:131], a[0:3], v[32:35]
    ds_read_b64_tr_b16 v[148:149], v25 offset:20480
    v_fma_f32 v40, -v188, v152, v40
    v_fma_f32 v41, -v188, v153, v41
    v_mfma_f32_16x16x32_bf16 v[36:39], v[128:131], a[4:7], v[36:39]
    ds_read_b64_tr_b16 v[150:151], v25 offset:20992
    v_fma_f32 v42, -v188, v154, v42
    s_waitcnt lgkmcnt(8)
    v_mfma_f32_16x16x32_bf16 v[52:55], v[132:135], a[4:7], v[52:55]
    v_fma_f32 v43, -v188, v155, v43
    v_fma_f32 v44, -v190, v152, v44
    ds_read_b128 v[168:171], v9 offset:1280
    v_mfma_f32_16x16x32_bf16 v[48:51], v[132:135], a[0:3], v[48:51]
    v_fma_f32 v45, -v190, v153, v45
    ds_read_b128 v[172:175], v9 offset:1344
    s_waitcnt lgkmcnt(8)
    v_mfma_f32_16x16x32_bf16 v[64:67], v[136:139], a[0:3], v[64:67]
    v_fma_f32 v46, -v190, v154, v46
    v_fma_f32 v47, -v190, v155, v47
    v_mfma_f32_16x16x32_bf16 v[68:71], v[136:139], a[4:7], v[68:71]
    v_fma_f32 v56, -v188, v156, v56
    ds_read_b128 v[176:179], v9 offset:1408
    s_waitcnt lgkmcnt(7)
    v_mfma_f32_16x16x32_bf16 v[84:87], v[140:143], a[4:7], v[84:87]
    v_fma_f32 v57, -v188, v157, v57
    v_fma_f32 v58, -v188, v158, v58
    ds_read_b128 v[180:183], v9 offset:1472
    v_mfma_f32_16x16x32_bf16 v[80:83], v[140:143], a[0:3], v[80:83]
    v_fma_f32 v59, -v188, v159, v59
    s_waitcnt lgkmcnt(6)
    v_mfma_f32_16x16x32_bf16 v[96:99], a[0:3], v[144:147], v[96:99]
    v_fma_f32 v60, -v190, v156, v60
    v_fma_f32 v61, -v190, v157, v61
    ds_read2_b32 v[220:221], v11 offset0:160 offset1:176
    v_mfma_f32_16x16x32_bf16 v[100:103], a[4:7], v[144:147], v[100:103]
    v_fma_f32 v62, -v190, v158, v62
    s_waitcnt lgkmcnt(5)
    v_mfma_f32_16x16x32_bf16 v[116:119], a[4:7], v[148:151], v[116:119]
    v_fma_f32 v63, -v190, v159, v63
    v_mfma_f32_16x16x32_bf16 v[112:115], a[0:3], v[148:151], v[112:115]
    s_waitcnt vmcnt(4)
    v_mfma_f32_16x16x32_bf16 v[40:43], v[128:131], a[8:11], v[40:43]
    v_mfma_f32_16x16x32_bf16 v[44:47], v[128:131], a[12:15], v[44:47]
    s_waitcnt lgkmcnt(0)
    v_fma_f32 v96, -v168, v220, v96
    v_fma_f32 v97, -v169, v220, v97
    v_mfma_f32_16x16x32_bf16 v[60:63], v[132:135], a[12:15], v[60:63]
    ds_read_b64_tr_b16 v[128:129], v24 offset:6144
    v_fma_f32 v98, -v170, v220, v98
    v_mfma_f32_16x16x32_bf16 v[56:59], v[132:135], a[8:11], v[56:59]
    ds_read_b64_tr_b16 v[130:131], v24 offset:6656
    v_fma_f32 v99, -v171, v220, v99
    v_fma_f32 v100, -v172, v220, v100
    v_mfma_f32_16x16x32_bf16 v[72:75], v[136:139], a[8:11], v[72:75]
    ds_read_b64_tr_b16 v[132:133], v25 offset:6144
    v_fma_f32 v101, -v173, v220, v101
    v_mfma_f32_16x16x32_bf16 v[76:79], v[136:139], a[12:15], v[76:79]
    ds_read_b64_tr_b16 v[134:135], v25 offset:6656
    v_fma_f32 v102, -v174, v220, v102
    v_fma_f32 v103, -v175, v220, v103
    v_mfma_f32_16x16x32_bf16 v[92:95], v[140:143], a[12:15], v[92:95]
    ds_read_b64_tr_b16 v[136:137], v24 offset:14336
    v_fma_f32 v112, -v168, v221, v112
    v_mfma_f32_16x16x32_bf16 v[88:91], v[140:143], a[8:11], v[88:91]
    ds_read_b64_tr_b16 v[138:139], v24 offset:14848
    v_fma_f32 v113, -v169, v221, v113
    v_fma_f32 v114, -v170, v221, v114
    v_mfma_f32_16x16x32_bf16 v[104:107], a[8:11], v[144:147], v[104:107]
    ds_read_b64_tr_b16 v[140:141], v25 offset:14336
    v_fma_f32 v115, -v171, v221, v115
    v_mfma_f32_16x16x32_bf16 v[108:111], a[12:15], v[144:147], v[108:111]
    ds_read_b64_tr_b16 v[142:143], v25 offset:14848
    v_fma_f32 v116, -v172, v221, v116
    v_fma_f32 v117, -v173, v221, v117
    v_mfma_f32_16x16x32_bf16 v[124:127], a[12:15], v[148:151], v[124:127]
    ds_read_b64_tr_b16 v[144:145], v24 offset:22528
    v_fma_f32 v118, -v174, v221, v118
    v_mfma_f32_16x16x32_bf16 v[120:123], a[8:11], v[148:151], v[120:123]
    ds_read_b64_tr_b16 v[146:147], v24 offset:23040
    v_fma_f32 v119, -v175, v221, v119
    s_waitcnt vmcnt(2) lgkmcnt(8)
    v_mfma_f32_16x16x32_bf16 v[32:35], v[128:131], a[16:19], v[32:35]
    ds_read_b64_tr_b16 v[148:149], v25 offset:22528
    v_mfma_f32_16x16x32_bf16 v[36:39], v[128:131], a[20:23], v[36:39]
    ds_read_b64_tr_b16 v[150:151], v25 offset:23040
    v_fma_f32 v104, -v176, v220, v104
    v_fma_f32 v105, -v177, v220, v105
    s_waitcnt lgkmcnt(8)
    v_mfma_f32_16x16x32_bf16 v[52:55], v[132:135], a[20:23], v[52:55]
    v_fma_f32 v106, -v178, v220, v106
    ds_read_b128 v[152:155], v9 offset:2816
    v_mfma_f32_16x16x32_bf16 v[48:51], v[132:135], a[16:19], v[48:51]
    v_fma_f32 v107, -v179, v220, v107
    v_fma_f32 v108, -v180, v220, v108
    s_waitcnt lgkmcnt(7)
    v_mfma_f32_16x16x32_bf16 v[64:67], v[136:139], a[16:19], v[64:67]
    v_fma_f32 v109, -v181, v220, v109
    ds_read_b128 v[156:159], v9 offset:2880
    v_mfma_f32_16x16x32_bf16 v[68:71], v[136:139], a[20:23], v[68:71]
    v_fma_f32 v110, -v182, v220, v110
    v_fma_f32 v111, -v183, v220, v111
    s_waitcnt lgkmcnt(6)
    v_mfma_f32_16x16x32_bf16 v[84:87], v[140:143], a[20:23], v[84:87]
    v_fma_f32 v120, -v176, v221, v120
    ds_read_b128 v[160:163], v9 offset:2944
    v_mfma_f32_16x16x32_bf16 v[80:83], v[140:143], a[16:19], v[80:83]
    v_fma_f32 v121, -v177, v221, v121
    v_fma_f32 v122, -v178, v221, v122
    s_waitcnt lgkmcnt(5)
    v_mfma_f32_16x16x32_bf16 v[96:99], a[16:19], v[144:147], v[96:99]
    v_fma_f32 v123, -v179, v221, v123
    ds_read_b128 v[164:167], v9 offset:3008
    v_mfma_f32_16x16x32_bf16 v[100:103], a[20:23], v[144:147], v[100:103]
    v_fma_f32 v124, -v180, v221, v124
    v_fma_f32 v125, -v181, v221, v125
    s_waitcnt lgkmcnt(4)
    v_mfma_f32_16x16x32_bf16 v[116:119], a[20:23], v[148:151], v[116:119]
    v_fma_f32 v126, -v182, v221, v126
    v_mfma_f32_16x16x32_bf16 v[112:115], a[16:19], v[148:151], v[112:115]
    v_fma_f32 v127, -v183, v221, v127
    s_waitcnt vmcnt(0)
    v_mfma_f32_16x16x32_bf16 v[40:43], v[128:131], a[24:27], v[40:43]
    v_mul_f32 v64, v185, v64
    v_mul_f32 v65, v185, v65
    s_barrier
    v_mfma_f32_16x16x32_bf16 v[44:47], v[128:131], a[28:31], v[44:47]
    v_mul_f32 v66, v185, v66
    v_mul_f32 v67, v185, v67
    v_mfma_f32_16x16x32_bf16 v[60:63], v[132:135], a[28:31], v[60:63]
    v_mul_f32 v80, v185, v80
    v_mul_f32 v81, v185, v81
    v_mfma_f32_16x16x32_bf16 v[56:59], v[132:135], a[24:27], v[56:59]
    v_mul_f32 v82, v185, v82
    v_mul_f32 v83, v185, v83
    v_mfma_f32_16x16x32_bf16 v[72:75], v[136:139], a[24:27], v[72:75]
    v_cvt_pk_bf16_f32 v64, v64, v65
    v_cvt_pk_bf16_f32 v65, v66, v67
    v_mfma_f32_16x16x32_bf16 v[76:79], v[136:139], a[28:31], v[76:79]
    v_cvt_pk_bf16_f32 v66, v80, v81
    v_cvt_pk_bf16_f32 v67, v82, v83
    v_mfma_f32_16x16x32_bf16 v[92:95], v[140:143], a[28:31], v[92:95]
    v_mul_f32 v68, v187, v68
    v_mul_f32 v69, v187, v69
    v_mfma_f32_16x16x32_bf16 v[88:91], v[140:143], a[24:27], v[88:91]
    v_mul_f32 v70, v187, v70
    v_mul_f32 v71, v187, v71
    v_mfma_f32_16x16x32_bf16 v[104:107], a[24:27], v[144:147], v[104:107]
    v_mul_f32 v84, v187, v84
    v_mul_f32 v85, v187, v85
    v_mfma_f32_16x16x32_bf16 v[108:111], a[28:31], v[144:147], v[108:111]
    v_mul_f32 v86, v187, v86
    v_mul_f32 v87, v187, v87
    v_mfma_f32_16x16x32_bf16 v[124:127], a[28:31], v[148:151], v[124:127]
    v_cvt_pk_bf16_f32 v68, v68, v69
    v_cvt_pk_bf16_f32 v69, v70, v71
    v_mfma_f32_16x16x32_bf16 v[120:123], a[24:27], v[148:151], v[120:123]
    v_cvt_pk_bf16_f32 v70, v84, v85
    v_cvt_pk_bf16_f32 v71, v86, v87
    buffer_store_dwordx4 v[64:67], v12, s[12:15], s84 offen offset:0 sc1
    ds_write_b128 v12, v[64:67] offset:0
    buffer_store_dwordx4 v[68:71], v12, s[12:15], s84 offen offset:256 sc1
    ds_write_b128 v12, v[68:71] offset:256
    v_pk_mul_f32 v[72:73], v[188:189], v[72:73] op_sel:[1,0] op_sel_hi:[1,1]
    v_pk_mul_f32 v[74:75], v[188:189], v[74:75] op_sel:[1,0] op_sel_hi:[1,1]
    v_pk_mul_f32 v[88:89], v[188:189], v[88:89] op_sel:[1,0] op_sel_hi:[1,1]
    v_pk_mul_f32 v[90:91], v[188:189], v[90:91] op_sel:[1,0] op_sel_hi:[1,1]
    v_cvt_pk_bf16_f32 v72, v72, v73
    v_cvt_pk_bf16_f32 v73, v74, v75
    v_cvt_pk_bf16_f32 v74, v88, v89
    v_cvt_pk_bf16_f32 v75, v90, v91
    buffer_store_dwordx4 v[72:75], v12, s[12:15], s84 offen offset:2048 sc1
    ds_write_b128 v12, v[72:75] offset:2048
    v_pk_mul_f32 v[76:77], v[190:191], v[76:77] op_sel:[1,0] op_sel_hi:[1,1]
    v_pk_mul_f32 v[78:79], v[190:191], v[78:79] op_sel:[1,0] op_sel_hi:[1,1]
    v_pk_mul_f32 v[92:93], v[190:191], v[92:93] op_sel:[1,0] op_sel_hi:[1,1]
    v_pk_mul_f32 v[94:95], v[190:191], v[94:95] op_sel:[1,0] op_sel_hi:[1,1]
    v_cvt_pk_bf16_f32 v76, v76, v77
    v_cvt_pk_bf16_f32 v77, v78, v79
    v_cvt_pk_bf16_f32 v78, v92, v93
    v_cvt_pk_bf16_f32 v79, v94, v95
    buffer_store_dwordx4 v[76:79], v12, s[12:15], s84 offen offset:2304 sc1
    ds_write_b128 v12, v[76:79] offset:2304
    s_waitcnt lgkmcnt(4)
    v_pk_mul_f32 v[96:97], v[152:153], v[96:97]
    v_pk_mul_f32 v[98:99], v[154:155], v[98:99]
    v_pk_mul_f32 v[112:113], v[152:153], v[112:113]
    v_pk_mul_f32 v[114:115], v[154:155], v[114:115]
    v_cvt_pk_bf16_f32 v96, v96, v97
    v_cvt_pk_bf16_f32 v97, v98, v99
    v_cvt_pk_bf16_f32 v98, v112, v113
    v_cvt_pk_bf16_f32 v99, v114, v115
    v_mul_f32 v185, 0x3e8293ee, v185
    v_permlane16_swap_b32 v96, v98
    v_permlane16_swap_b32 v97, v99
    buffer_store_dwordx4 v[96:99], v13, s[12:15], s85 offen offset:0 sc1
    ds_write_b128 v13, v[96:99] offset:8192
    v_pk_mul_f32 v[100:101], v[156:157], v[100:101]
    v_pk_mul_f32 v[102:103], v[158:159], v[102:103]
    v_pk_mul_f32 v[116:117], v[156:157], v[116:117]
    v_pk_mul_f32 v[118:119], v[158:159], v[118:119]
    v_cvt_pk_bf16_f32 v100, v100, v101
    v_cvt_pk_bf16_f32 v101, v102, v103
    v_cvt_pk_bf16_f32 v102, v116, v117
    v_cvt_pk_bf16_f32 v103, v118, v119
    v_mul_f32 v187, 0x3e8293ee, v187
    v_permlane16_swap_b32 v100, v102
    v_permlane16_swap_b32 v101, v103
    buffer_store_dwordx4 v[100:103], v13, s[12:15], s85 offen offset:1024 sc1
    ds_write_b128 v13, v[100:103] offset:9216
    v_pk_mul_f32 v[104:105], v[160:161], v[104:105]
    v_pk_mul_f32 v[106:107], v[162:163], v[106:107]
    v_pk_mul_f32 v[120:121], v[160:161], v[120:121]
    v_pk_mul_f32 v[122:123], v[162:163], v[122:123]
    v_cvt_pk_bf16_f32 v104, v104, v105
    v_cvt_pk_bf16_f32 v105, v106, v107
    v_cvt_pk_bf16_f32 v106, v120, v121
    v_cvt_pk_bf16_f32 v107, v122, v123
    v_mul_f32 v189, 0x3e8293ee, v189
    v_permlane16_swap_b32 v104, v106
    v_permlane16_swap_b32 v105, v107
    buffer_store_dwordx4 v[104:107], v13, s[12:15], s85 offen offset:2048 sc1
    ds_write_b128 v13, v[104:107] offset:10240
    v_pk_mul_f32 v[108:109], v[164:165], v[108:109]
    v_pk_mul_f32 v[110:111], v[166:167], v[110:111]
    v_pk_mul_f32 v[124:125], v[164:165], v[124:125]
    v_pk_mul_f32 v[126:127], v[166:167], v[126:127]
    v_cvt_pk_bf16_f32 v108, v108, v109
    v_cvt_pk_bf16_f32 v109, v110, v111
    v_cvt_pk_bf16_f32 v110, v124, v125
    v_cvt_pk_bf16_f32 v111, v126, v127
    v_mul_f32 v191, 0x3e8293ee, v191
    v_permlane16_swap_b32 v108, v110
    v_permlane16_swap_b32 v109, v111
    buffer_store_dwordx4 v[108:111], v13, s[12:15], s85 offen offset:3072 sc1
    ds_write_b128 v13, v[108:111] offset:11264
    v_add_u32 v24, 81920, v5
    s_waitcnt lgkmcnt(0)
    s_barrier
    ds_read_b128 v[128:131], v24 offset:0
    ds_read_b128 v[132:135], v24 offset:1024
    ds_read_b128 v[136:139], v24 offset:2048
    ds_read_b128 v[140:143], v24 offset:3072
    v_pk_mul_f32 v[32:33], v[184:185], v[32:33] op_sel:[1,0] op_sel_hi:[1,1]
    v_pk_mul_f32 v[34:35], v[184:185], v[34:35] op_sel:[1,0] op_sel_hi:[1,1]
    v_pk_mul_f32 v[48:49], v[184:185], v[48:49] op_sel:[1,0] op_sel_hi:[1,1]
    v_pk_mul_f32 v[50:51], v[184:185], v[50:51] op_sel:[1,0] op_sel_hi:[1,1]
    v_cvt_pk_bf16_f32 v8, v32, v33
    v_cvt_pk_bf16_f32 v9, v34, v35
    v_cvt_pk_bf16_f32 v10, v48, v49
    v_cvt_pk_bf16_f32 v11, v50, v51
    v_pk_mul_f32 v[36:37], v[186:187], v[36:37] op_sel:[1,0] op_sel_hi:[1,1]
    v_pk_mul_f32 v[38:39], v[186:187], v[38:39] op_sel:[1,0] op_sel_hi:[1,1]
    v_pk_mul_f32 v[52:53], v[186:187], v[52:53] op_sel:[1,0] op_sel_hi:[1,1]
    v_pk_mul_f32 v[54:55], v[186:187], v[54:55] op_sel:[1,0] op_sel_hi:[1,1]
    v_cvt_pk_bf16_f32 v12, v36, v37
    v_cvt_pk_bf16_f32 v13, v38, v39
    v_cvt_pk_bf16_f32 v14, v52, v53
    v_cvt_pk_bf16_f32 v15, v54, v55
    v_pk_mul_f32 v[40:41], v[188:189], v[40:41] op_sel:[1,0] op_sel_hi:[1,1]
    v_pk_mul_f32 v[42:43], v[188:189], v[42:43] op_sel:[1,0] op_sel_hi:[1,1]
    v_pk_mul_f32 v[56:57], v[188:189], v[56:57] op_sel:[1,0] op_sel_hi:[1,1]
    v_pk_mul_f32 v[58:59], v[188:189], v[58:59] op_sel:[1,0] op_sel_hi:[1,1]
    v_cvt_pk_bf16_f32 v16, v40, v41
    v_cvt_pk_bf16_f32 v17, v42, v43
    v_cvt_pk_bf16_f32 v18, v56, v57
    v_cvt_pk_bf16_f32 v19, v58, v59
    v_pk_mul_f32 v[44:45], v[190:191], v[44:45] op_sel:[1,0] op_sel_hi:[1,1]
    v_pk_mul_f32 v[46:47], v[190:191], v[46:47] op_sel:[1,0] op_sel_hi:[1,1]
    v_pk_mul_f32 v[60:61], v[190:191], v[60:61] op_sel:[1,0] op_sel_hi:[1,1]
    v_pk_mul_f32 v[62:63], v[190:191], v[62:63] op_sel:[1,0] op_sel_hi:[1,1]
    v_cvt_pk_bf16_f32 v20, v44, v45
    v_cvt_pk_bf16_f32 v21, v46, v47
    v_cvt_pk_bf16_f32 v22, v60, v61
    v_cvt_pk_bf16_f32 v23, v62, v63
    v_permlane16_swap_b32 v8, v12
    v_permlane16_swap_b32 v9, v13
    v_permlane16_swap_b32 v10, v14
    v_permlane16_swap_b32 v11, v15
    v_permlane16_swap_b32 v16, v20
    v_permlane16_swap_b32 v17, v21
    v_permlane16_swap_b32 v18, v22
    v_permlane16_swap_b32 v19, v23
    s_waitcnt lgkmcnt(0)
    v_mfma_f32_32x32x16_bf16 v[64:79], v[128:131], v[8:11], 0
    v_mfma_f32_32x32x16_bf16 v[64:79], v[132:135], v[12:15], v[64:79]
    v_and_b32 v25, 7, v1
    v_mov_b32 v26, 0x3f803f80
    v_cmp_eq_u32 vcc, 0, v25
    s_nop 1
    v_cndmask_b32 v200, 0, v26, vcc
    v_cndmask_b32 v201, 0, v26, vcc
    v_cmp_eq_u32 vcc, 4, v25
    s_nop 1
    v_cndmask_b32 v202, 0, v26, vcc
    v_cndmask_b32 v203, 0, v26, vcc
    v_mov_b32 v204, 0xdddddddd
    v_mov_b32 v160, 0
    v_mov_b32 v161, 0
    v_mov_b32 v162, 0
    v_mov_b32 v163, 0
    v_mov_b32 v164, 0
    v_mov_b32 v165, 0
    v_mov_b32 v166, 0
    v_mov_b32 v167, 0
    v_mov_b32 v168, 0
    v_mov_b32 v169, 0
    v_mov_b32 v170, 0
    v_mov_b32 v171, 0
    v_mov_b32 v172, 0
    v_mov_b32 v173, 0
    v_mov_b32 v174, 0
    v_mov_b32 v175, 0
    v_mov_b32 v192, 0
    v_mov_b32 v193, 0
    v_mov_b32 v194, 0
    v_mov_b32 v195, 0
    v_mov_b32 v176, 0
    v_mov_b32 v177, 0
    v_mov_b32 v178, 0
    v_mov_b32 v179, 0
    v_mov_b32 v180, 0
    v_mov_b32 v181, 0
    v_mov_b32 v182, 0
    v_mov_b32 v183, 0
    v_mov_b32 v184, 0
    v_mov_b32 v185, 0
    v_mov_b32 v186, 0
    v_mov_b32 v187, 0
    v_mov_b32 v188, 0
    v_mov_b32 v189, 0
    v_mov_b32 v190, 0
    v_mov_b32 v191, 0
    v_mov_b32 v196, 0
    v_mov_b32 v197, 0
    v_mov_b32 v198, 0
    v_mov_b32 v199, 0
    v_mov_b32 v112, 0
    v_mov_b32 v113, 0
    v_mov_b32 v114, 0
    v_mov_b32 v115, 0
    v_mov_b32 v116, 0
    v_mov_b32 v117, 0
    v_mov_b32 v118, 0
    v_mov_b32 v119, 0
    v_mov_b32 v120, 0
    v_mov_b32 v121, 0
    v_mov_b32 v122, 0
    v_mov_b32 v123, 0
    v_mov_b32 v124, 0
    v_mov_b32 v125, 0
    v_mov_b32 v126, 0
    v_mov_b32 v127, 0
    v_mov_b32 v152, 0
    v_mov_b32 v153, 0
    v_mov_b32 v154, 0
    v_mov_b32 v155, 0
    v_mov_b32 v156, 0
    v_mov_b32 v157, 0
    v_mov_b32 v158, 0
    v_mov_b32 v159, 0
    s_mov_b32 s54, 4
    s_mov_b64 exec, 0xff
    s_waitcnt vmcnt(0)
    buffer_store_dword v29, v28, s[12:15], s53 offen sc1
    s_mov_b64 exec, -1
.p2align 3
c_attn_loop:
    v_mfma_f32_32x32x16_bf16 v[80:95], v[128:131], v[16:19], 0
    v_exp_f32 v64, v64
    v_exp_f32 v65, v65
    v_exp_f32 v66, v66
    v_mfma_f32_32x32x16_bf16 v[80:95], v[132:135], v[20:23], v[80:95]
    v_exp_f32 v67, v67
    v_exp_f32 v68, v68
    v_exp_f32 v69, v69
    v_smfmac_f32_32x32x32_bf16 v[176:191], v[152:155], v[112:119], v204
    s_waitcnt lgkmcnt(0)
    v_exp_f32 v70, v70
    v_exp_f32 v71, v71
    v_exp_f32 v72, v72
    v_smfmac_f32_16x16x64_bf16 v[196:199], v[200:203], v[112:119], v204
    ds_read_b128 v[144:147], v24 offset:8192
    v_exp_f32 v73, v73
    v_exp_f32 v74, v74
    v_smfmac_f32_32x32x32_bf16 v[176:191], v[156:159], v[120:127], v204
    v_exp_f32 v75, v75
    v_exp_f32 v76, v76
    v_exp_f32 v77, v77
    v_smfmac_f32_16x16x64_bf16 v[196:199], v[200:203], v[120:127], v204
    ds_read_b128 v[148:151], v24 offset:9216
    v_exp_f32 v78, v78
    v_exp_f32 v79, v79
    v_mfma_f32_32x32x16_bf16 v[96:111], v[136:139], v[8:11], 0
    v_exp_f32 v80, v80
    v_exp_f32 v81, v81
    v_exp_f32 v82, v82
    v_mfma_f32_32x32x16_bf16 v[96:111], v[140:143], v[12:15], v[96:111]
    s_waitcnt lgkmcnt(1)
    v_exp_f32 v83, v83
    v_exp_f32 v84, v84
    v_exp_f32 v85, v85
    v_smfmac_f32_32x32x32_bf16 v[160:175], v[144:147], v[64:71], v204
    s_waitcnt lgkmcnt(0)
    v_exp_f32 v86, v86
    v_exp_f32 v87, v87
    v_exp_f32 v88, v88
    v_smfmac_f32_16x16x64_bf16 v[192:195], v[200:203], v[64:71], v204
    ds_read_b128 v[128:131], v24 offset:4096
    v_exp_f32 v89, v89
    v_exp_f32 v90, v90
    v_smfmac_f32_32x32x32_bf16 v[160:175], v[148:151], v[72:79], v204
    v_exp_f32 v91, v91
    v_exp_f32 v92, v92
    v_exp_f32 v93, v93
    v_smfmac_f32_16x16x64_bf16 v[192:195], v[200:203], v[72:79], v204
    ds_read_b128 v[132:135], v24 offset:5120
    v_exp_f32 v94, v94
    v_exp_f32 v95, v95
    v_mfma_f32_32x32x16_bf16 v[112:127], v[136:139], v[16:19], 0
    v_exp_f32 v96, v96
    v_exp_f32 v97, v97
    v_exp_f32 v98, v98
    v_mfma_f32_32x32x16_bf16 v[112:127], v[140:143], v[20:23], v[112:127]
    v_exp_f32 v99, v99
    v_exp_f32 v100, v100
    v_exp_f32 v101, v101
    v_smfmac_f32_32x32x32_bf16 v[176:191], v[144:147], v[80:87], v204
    s_waitcnt lgkmcnt(0)
    v_exp_f32 v102, v102
    v_exp_f32 v103, v103
    v_exp_f32 v104, v104
    v_smfmac_f32_16x16x64_bf16 v[196:199], v[200:203], v[80:87], v204
    ds_read_b128 v[152:155], v24 offset:10240
    v_exp_f32 v105, v105
    v_exp_f32 v106, v106
    v_smfmac_f32_32x32x32_bf16 v[176:191], v[148:151], v[88:95], v204
    v_exp_f32 v107, v107
    v_exp_f32 v108, v108
    v_exp_f32 v109, v109
    v_smfmac_f32_16x16x64_bf16 v[196:199], v[200:203], v[88:95], v204
    ds_read_b128 v[156:159], v24 offset:11264
    v_exp_f32 v110, v110
    v_exp_f32 v111, v111
    v_mfma_f32_32x32x16_bf16 v[64:79], v[128:131], v[8:11], 0
    v_exp_f32 v112, v112
    v_exp_f32 v113, v113
    v_exp_f32 v114, v114
    v_mfma_f32_32x32x16_bf16 v[64:79], v[132:135], v[12:15], v[64:79]
    s_waitcnt lgkmcnt(1)
    v_exp_f32 v115, v115
    v_exp_f32 v116, v116
    v_exp_f32 v117, v117
    v_smfmac_f32_32x32x32_bf16 v[160:175], v[152:155], v[96:103], v204
    s_waitcnt lgkmcnt(0)
    v_exp_f32 v118, v118
    v_exp_f32 v119, v119
    v_exp_f32 v120, v120
    v_smfmac_f32_16x16x64_bf16 v[192:195], v[200:203], v[96:103], v204
    ds_read_b128 v[136:139], v24 offset:6144
    v_exp_f32 v121, v121
    v_exp_f32 v122, v122
    v_smfmac_f32_32x32x32_bf16 v[160:175], v[156:159], v[104:111], v204
    v_exp_f32 v123, v123
    v_exp_f32 v124, v124
    v_exp_f32 v125, v125
    v_smfmac_f32_16x16x64_bf16 v[192:195], v[200:203], v[104:111], v204
    ds_read_b128 v[140:143], v24 offset:7168
    v_exp_f32 v126, v126
    v_exp_f32 v127, v127
    v_mfma_f32_32x32x16_bf16 v[80:95], v[128:131], v[16:19], 0
    s_cmp_eq_u32 s54, 4
    v_exp_f32 v64, v64
    v_exp_f32 v65, v65
    v_exp_f32 v66, v66
    v_mfma_f32_32x32x16_bf16 v[80:95], v[132:135], v[20:23], v[80:95]
    v_exp_f32 v67, v67
    v_exp_f32 v68, v68
    v_exp_f32 v69, v69
    v_smfmac_f32_32x32x32_bf16 v[176:191], v[152:155], v[112:119], v204
    s_waitcnt lgkmcnt(0)
    v_exp_f32 v70, v70
    v_exp_f32 v71, v71
    v_exp_f32 v72, v72
    v_smfmac_f32_16x16x64_bf16 v[196:199], v[200:203], v[112:119], v204
    ds_read_b128 v[144:147], v24 offset:12288
    v_exp_f32 v73, v73
    v_exp_f32 v74, v74
    v_smfmac_f32_32x32x32_bf16 v[176:191], v[156:159], v[120:127], v204
    v_exp_f32 v75, v75
    v_exp_f32 v76, v76
    v_exp_f32 v77, v77
    v_smfmac_f32_16x16x64_bf16 v[196:199], v[200:203], v[120:127], v204
    ds_read_b128 v[148:151], v24 offset:13312
    v_exp_f32 v78, v78
    v_exp_f32 v79, v79
    v_mfma_f32_32x32x16_bf16 v[96:111], v[136:139], v[8:11], 0
    s_cbranch_scc1 c_attn_nobar
    s_barrier
c_attn_nobar:
    v_exp_f32 v80, v80
    v_exp_f32 v81, v81
    v_exp_f32 v82, v82
    v_mfma_f32_32x32x16_bf16 v[96:111], v[140:143], v[12:15], v[96:111]
    s_waitcnt lgkmcnt(1)
    v_exp_f32 v83, v83
    v_exp_f32 v84, v84
    v_exp_f32 v85, v85
    v_smfmac_f32_32x32x32_bf16 v[160:175], v[144:147], v[64:71], v204
    s_waitcnt lgkmcnt(0)
    v_exp_f32 v86, v86
    v_exp_f32 v87, v87
    v_exp_f32 v88, v88
    v_smfmac_f32_16x16x64_bf16 v[192:195], v[200:203], v[64:71], v204
    ds_read_b128 v[128:131], v24 offset:16384
    v_exp_f32 v89, v89
    v_exp_f32 v90, v90
    v_smfmac_f32_32x32x32_bf16 v[160:175], v[148:151], v[72:79], v204
    v_exp_f32 v91, v91
    v_exp_f32 v92, v92
    v_exp_f32 v93, v93
    v_smfmac_f32_16x16x64_bf16 v[192:195], v[200:203], v[72:79], v204
    ds_read_b128 v[132:135], v24 offset:17408
    v_exp_f32 v94, v94
    v_exp_f32 v95, v95
    v_mfma_f32_32x32x16_bf16 v[112:127], v[136:139], v[16:19], 0
    v_exp_f32 v96, v96
    v_exp_f32 v97, v97
    v_exp_f32 v98, v98
    v_mfma_f32_32x32x16_bf16 v[112:127], v[140:143], v[20:23], v[112:127]
    v_exp_f32 v99, v99
    v_exp_f32 v100, v100
    v_exp_f32 v101, v101
    v_smfmac_f32_32x32x32_bf16 v[176:191], v[144:147], v[80:87], v204
    s_waitcnt lgkmcnt(0)
    v_exp_f32 v102, v102
    v_exp_f32 v103, v103
    v_exp_f32 v104, v104
    v_smfmac_f32_16x16x64_bf16 v[196:199], v[200:203], v[80:87], v204
    ds_read_b128 v[152:155], v24 offset:14336
    v_exp_f32 v105, v105
    v_exp_f32 v106, v106
    v_smfmac_f32_32x32x32_bf16 v[176:191], v[148:151], v[88:95], v204
    v_exp_f32 v107, v107
    v_exp_f32 v108, v108
    v_exp_f32 v109, v109
    v_smfmac_f32_16x16x64_bf16 v[196:199], v[200:203], v[88:95], v204
    ds_read_b128 v[156:159], v24 offset:15360
    v_exp_f32 v110, v110
    v_exp_f32 v111, v111
    v_mfma_f32_32x32x16_bf16 v[64:79], v[128:131], v[8:11], 0
    v_exp_f32 v112, v112
    v_exp_f32 v113, v113
    v_exp_f32 v114, v114
    v_mfma_f32_32x32x16_bf16 v[64:79], v[132:135], v[12:15], v[64:79]
    s_waitcnt lgkmcnt(1)
    v_exp_f32 v115, v115
    v_exp_f32 v116, v116
    v_exp_f32 v117, v117
    v_smfmac_f32_32x32x32_bf16 v[160:175], v[152:155], v[96:103], v204
    s_waitcnt lgkmcnt(0)
    v_exp_f32 v118, v118
    v_exp_f32 v119, v119
    v_exp_f32 v120, v120
    v_smfmac_f32_16x16x64_bf16 v[192:195], v[200:203], v[96:103], v204
    ds_read_b128 v[136:139], v24 offset:18432
    v_exp_f32 v121, v121
    v_exp_f32 v122, v122
    v_smfmac_f32_32x32x32_bf16 v[160:175], v[156:159], v[104:111], v204
    v_exp_f32 v123, v123
    v_exp_f32 v124, v124
    v_exp_f32 v125, v125
    v_smfmac_f32_16x16x64_bf16 v[192:195], v[200:203], v[104:111], v204
    ds_read_b128 v[140:143], v24 offset:19456
    v_exp_f32 v126, v126
    v_exp_f32 v127, v127
    v_mfma_f32_32x32x16_bf16 v[80:95], v[128:131], v[16:19], 0
    v_exp_f32 v64, v64
    v_exp_f32 v65, v65
    v_exp_f32 v66, v66
    v_mfma_f32_32x32x16_bf16 v[80:95], v[132:135], v[20:23], v[80:95]
    v_exp_f32 v67, v67
    v_exp_f32 v68, v68
    v_exp_f32 v69, v69
    v_smfmac_f32_32x32x32_bf16 v[176:191], v[152:155], v[112:119], v204
    s_waitcnt lgkmcnt(0)
    v_exp_f32 v70, v70
    v_exp_f32 v71, v71
    v_exp_f32 v72, v72
    v_smfmac_f32_16x16x64_bf16 v[196:199], v[200:203], v[112:119], v204
    ds_read_b128 v[144:147], v24 offset:24576
    v_exp_f32 v73, v73
    v_exp_f32 v74, v74
    v_smfmac_f32_32x32x32_bf16 v[176:191], v[156:159], v[120:127], v204
    v_exp_f32 v75, v75
    v_exp_f32 v76, v76
    v_exp_f32 v77, v77
    v_smfmac_f32_16x16x64_bf16 v[196:199], v[200:203], v[120:127], v204
    ds_read_b128 v[148:151], v24 offset:25600
    v_exp_f32 v78, v78
    v_exp_f32 v79, v79
    v_mfma_f32_32x32x16_bf16 v[96:111], v[136:139], v[8:11], 0
    v_exp_f32 v80, v80
    v_exp_f32 v81, v81
    v_exp_f32 v82, v82
    v_mfma_f32_32x32x16_bf16 v[96:111], v[140:143], v[12:15], v[96:111]
    s_waitcnt lgkmcnt(1)
    v_exp_f32 v83, v83
    v_exp_f32 v84, v84
    v_exp_f32 v85, v85
    v_smfmac_f32_32x32x32_bf16 v[160:175], v[144:147], v[64:71], v204
    s_waitcnt lgkmcnt(0)
    v_exp_f32 v86, v86
    v_exp_f32 v87, v87
    v_exp_f32 v88, v88
    v_smfmac_f32_16x16x64_bf16 v[192:195], v[200:203], v[64:71], v204
    ds_read_b128 v[128:131], v24 offset:20480
    v_exp_f32 v89, v89
    v_exp_f32 v90, v90
    v_smfmac_f32_32x32x32_bf16 v[160:175], v[148:151], v[72:79], v204
    v_exp_f32 v91, v91
    v_exp_f32 v92, v92
    v_exp_f32 v93, v93
    v_smfmac_f32_16x16x64_bf16 v[192:195], v[200:203], v[72:79], v204
    ds_read_b128 v[132:135], v24 offset:21504
    v_exp_f32 v94, v94
    v_exp_f32 v95, v95
    v_mfma_f32_32x32x16_bf16 v[112:127], v[136:139], v[16:19], 0
    v_exp_f32 v96, v96
    v_exp_f32 v97, v97
    v_exp_f32 v98, v98
    v_mfma_f32_32x32x16_bf16 v[112:127], v[140:143], v[20:23], v[112:127]
    v_exp_f32 v99, v99
    v_exp_f32 v100, v100
    v_exp_f32 v101, v101
    v_smfmac_f32_32x32x32_bf16 v[176:191], v[144:147], v[80:87], v204
    s_waitcnt lgkmcnt(0)
    v_exp_f32 v102, v102
    v_exp_f32 v103, v103
    v_exp_f32 v104, v104
    v_smfmac_f32_16x16x64_bf16 v[196:199], v[200:203], v[80:87], v204
    ds_read_b128 v[152:155], v24 offset:26624
    v_exp_f32 v105, v105
    v_exp_f32 v106, v106
    v_smfmac_f32_32x32x32_bf16 v[176:191], v[148:151], v[88:95], v204
    v_exp_f32 v107, v107
    v_exp_f32 v108, v108
    v_exp_f32 v109, v109
    v_smfmac_f32_16x16x64_bf16 v[196:199], v[200:203], v[88:95], v204
    ds_read_b128 v[156:159], v24 offset:27648
    v_exp_f32 v110, v110
    v_exp_f32 v111, v111
    v_mfma_f32_32x32x16_bf16 v[64:79], v[128:131], v[8:11], 0
    v_exp_f32 v112, v112
    v_exp_f32 v113, v113
    v_exp_f32 v114, v114
    v_mfma_f32_32x32x16_bf16 v[64:79], v[132:135], v[12:15], v[64:79]
    s_waitcnt lgkmcnt(1)
    v_exp_f32 v115, v115
    v_exp_f32 v116, v116
    v_exp_f32 v117, v117
    v_smfmac_f32_32x32x32_bf16 v[160:175], v[152:155], v[96:103], v204
    s_waitcnt lgkmcnt(0)
    v_exp_f32 v118, v118
    v_exp_f32 v119, v119
    v_exp_f32 v120, v120
    v_smfmac_f32_16x16x64_bf16 v[192:195], v[200:203], v[96:103], v204
    ds_read_b128 v[136:139], v24 offset:22528
    v_exp_f32 v121, v121
    v_exp_f32 v122, v122
    v_smfmac_f32_32x32x32_bf16 v[160:175], v[156:159], v[104:111], v204
    v_exp_f32 v123, v123
    v_exp_f32 v124, v124
    v_exp_f32 v125, v125
    v_smfmac_f32_16x16x64_bf16 v[192:195], v[200:203], v[104:111], v204
    ds_read_b128 v[140:143], v24 offset:23552
    v_exp_f32 v126, v126
    v_exp_f32 v127, v127
    v_mfma_f32_32x32x16_bf16 v[80:95], v[128:131], v[16:19], 0
    v_exp_f32 v64, v64
    v_exp_f32 v65, v65
    v_exp_f32 v66, v66
    v_mfma_f32_32x32x16_bf16 v[80:95], v[132:135], v[20:23], v[80:95]
    v_exp_f32 v67, v67
    v_exp_f32 v68, v68
    v_exp_f32 v69, v69
    v_smfmac_f32_32x32x32_bf16 v[176:191], v[152:155], v[112:119], v204
    s_waitcnt lgkmcnt(0)
    v_exp_f32 v70, v70
    v_exp_f32 v71, v71
    v_exp_f32 v72, v72
    v_smfmac_f32_16x16x64_bf16 v[196:199], v[200:203], v[112:119], v204
    ds_read_b128 v[144:147], v24 offset:28672
    v_exp_f32 v73, v73
    v_exp_f32 v74, v74
    v_smfmac_f32_32x32x32_bf16 v[176:191], v[156:159], v[120:127], v204
    v_exp_f32 v75, v75
    v_exp_f32 v76, v76
    v_exp_f32 v77, v77
    v_smfmac_f32_16x16x64_bf16 v[196:199], v[200:203], v[120:127], v204
    ds_read_b128 v[148:151], v24 offset:29696
    v_exp_f32 v78, v78
    v_exp_f32 v79, v79
    v_mfma_f32_32x32x16_bf16 v[96:111], v[136:139], v[8:11], 0
    s_barrier
    v_exp_f32 v80, v80
    v_exp_f32 v81, v81
    v_exp_f32 v82, v82
    v_mfma_f32_32x32x16_bf16 v[96:111], v[140:143], v[12:15], v[96:111]
    s_waitcnt lgkmcnt(1)
    v_exp_f32 v83, v83
    v_exp_f32 v84, v84
    v_exp_f32 v85, v85
    v_smfmac_f32_32x32x32_bf16 v[160:175], v[144:147], v[64:71], v204
    s_waitcnt lgkmcnt(0)
    v_exp_f32 v86, v86
    v_exp_f32 v87, v87
    v_exp_f32 v88, v88
    v_smfmac_f32_16x16x64_bf16 v[192:195], v[200:203], v[64:71], v204
    ds_read_b128 v[128:131], v24 offset:32768
    v_exp_f32 v89, v89
    v_exp_f32 v90, v90
    v_smfmac_f32_32x32x32_bf16 v[160:175], v[148:151], v[72:79], v204
    v_exp_f32 v91, v91
    v_exp_f32 v92, v92
    v_exp_f32 v93, v93
    v_smfmac_f32_16x16x64_bf16 v[192:195], v[200:203], v[72:79], v204
    ds_read_b128 v[132:135], v24 offset:33792
    v_exp_f32 v94, v94
    v_exp_f32 v95, v95
    v_mfma_f32_32x32x16_bf16 v[112:127], v[136:139], v[16:19], 0
    v_exp_f32 v96, v96
    v_exp_f32 v97, v97
    v_exp_f32 v98, v98
    v_mfma_f32_32x32x16_bf16 v[112:127], v[140:143], v[20:23], v[112:127]
    v_exp_f32 v99, v99
    v_exp_f32 v100, v100
    v_exp_f32 v101, v101
    v_smfmac_f32_32x32x32_bf16 v[176:191], v[144:147], v[80:87], v204
    s_waitcnt lgkmcnt(0)
    v_exp_f32 v102, v102
    v_exp_f32 v103, v103
    v_exp_f32 v104, v104
    v_smfmac_f32_16x16x64_bf16 v[196:199], v[200:203], v[80:87], v204
    ds_read_b128 v[152:155], v24 offset:30720
    v_exp_f32 v105, v105
    v_exp_f32 v106, v106
    v_smfmac_f32_32x32x32_bf16 v[176:191], v[148:151], v[88:95], v204
    v_exp_f32 v107, v107
    v_exp_f32 v108, v108
    v_exp_f32 v109, v109
    v_smfmac_f32_16x16x64_bf16 v[196:199], v[200:203], v[88:95], v204
    ds_read_b128 v[156:159], v24 offset:31744
    v_exp_f32 v110, v110
    v_exp_f32 v111, v111
    v_mfma_f32_32x32x16_bf16 v[64:79], v[128:131], v[8:11], 0
    v_exp_f32 v112, v112
    v_exp_f32 v113, v113
    v_exp_f32 v114, v114
    v_mfma_f32_32x32x16_bf16 v[64:79], v[132:135], v[12:15], v[64:79]
    s_waitcnt lgkmcnt(1)
    v_exp_f32 v115, v115
    v_exp_f32 v116, v116
    v_exp_f32 v117, v117
    v_smfmac_f32_32x32x32_bf16 v[160:175], v[152:155], v[96:103], v204
    s_waitcnt lgkmcnt(0)
    v_exp_f32 v118, v118
    v_exp_f32 v119, v119
    v_exp_f32 v120, v120
    v_smfmac_f32_16x16x64_bf16 v[192:195], v[200:203], v[96:103], v204
    ds_read_b128 v[136:139], v24 offset:34816
    v_exp_f32 v121, v121
    v_exp_f32 v122, v122
    v_smfmac_f32_32x32x32_bf16 v[160:175], v[156:159], v[104:111], v204
    v_exp_f32 v123, v123
    v_exp_f32 v124, v124
    v_exp_f32 v125, v125
    v_smfmac_f32_16x16x64_bf16 v[192:195], v[200:203], v[104:111], v204
    ds_read_b128 v[140:143], v24 offset:35840
    v_exp_f32 v126, v126
    v_exp_f32 v127, v127
    v_mfma_f32_32x32x16_bf16 v[80:95], v[128:131], v[16:19], 0
    v_exp_f32 v64, v64
    v_exp_f32 v65, v65
    v_exp_f32 v66, v66
    v_mfma_f32_32x32x16_bf16 v[80:95], v[132:135], v[20:23], v[80:95]
    v_exp_f32 v67, v67
    v_exp_f32 v68, v68
    v_exp_f32 v69, v69
    v_smfmac_f32_32x32x32_bf16 v[176:191], v[152:155], v[112:119], v204
    s_waitcnt lgkmcnt(0)
    v_exp_f32 v70, v70
    v_exp_f32 v71, v71
    v_exp_f32 v72, v72
    v_smfmac_f32_16x16x64_bf16 v[196:199], v[200:203], v[112:119], v204
    ds_read_b128 v[144:147], v24 offset:40960
    v_exp_f32 v73, v73
    v_exp_f32 v74, v74
    v_smfmac_f32_32x32x32_bf16 v[176:191], v[156:159], v[120:127], v204
    v_exp_f32 v75, v75
    v_exp_f32 v76, v76
    v_exp_f32 v77, v77
    v_smfmac_f32_16x16x64_bf16 v[196:199], v[200:203], v[120:127], v204
    ds_read_b128 v[148:151], v24 offset:41984
    v_exp_f32 v78, v78
    v_exp_f32 v79, v79
    v_mfma_f32_32x32x16_bf16 v[96:111], v[136:139], v[8:11], 0
    v_exp_f32 v80, v80
    v_exp_f32 v81, v81
    v_exp_f32 v82, v82
    v_mfma_f32_32x32x16_bf16 v[96:111], v[140:143], v[12:15], v[96:111]
    s_waitcnt lgkmcnt(1)
    v_exp_f32 v83, v83
    v_exp_f32 v84, v84
    v_exp_f32 v85, v85
    v_smfmac_f32_32x32x32_bf16 v[160:175], v[144:147], v[64:71], v204
    s_waitcnt lgkmcnt(0)
    v_exp_f32 v86, v86
    v_exp_f32 v87, v87
    v_exp_f32 v88, v88
    v_smfmac_f32_16x16x64_bf16 v[192:195], v[200:203], v[64:71], v204
    ds_read_b128 v[128:131], v24 offset:36864
    v_exp_f32 v89, v89
    v_exp_f32 v90, v90
    v_smfmac_f32_32x32x32_bf16 v[160:175], v[148:151], v[72:79], v204
    v_exp_f32 v91, v91
    v_exp_f32 v92, v92
    v_exp_f32 v93, v93
    v_smfmac_f32_16x16x64_bf16 v[192:195], v[200:203], v[72:79], v204
    ds_read_b128 v[132:135], v24 offset:37888
    v_exp_f32 v94, v94
    v_exp_f32 v95, v95
    v_mfma_f32_32x32x16_bf16 v[112:127], v[136:139], v[16:19], 0
    v_exp_f32 v96, v96
    v_exp_f32 v97, v97
    v_exp_f32 v98, v98
    v_mfma_f32_32x32x16_bf16 v[112:127], v[140:143], v[20:23], v[112:127]
    v_exp_f32 v99, v99
    v_exp_f32 v100, v100
    v_exp_f32 v101, v101
    v_smfmac_f32_32x32x32_bf16 v[176:191], v[144:147], v[80:87], v204
    s_waitcnt lgkmcnt(0)
    v_exp_f32 v102, v102
    v_exp_f32 v103, v103
    v_exp_f32 v104, v104
    v_smfmac_f32_16x16x64_bf16 v[196:199], v[200:203], v[80:87], v204
    ds_read_b128 v[152:155], v24 offset:43008
    v_exp_f32 v105, v105
    v_exp_f32 v106, v106
    v_smfmac_f32_32x32x32_bf16 v[176:191], v[148:151], v[88:95], v204
    v_exp_f32 v107, v107
    v_exp_f32 v108, v108
    v_exp_f32 v109, v109
    v_smfmac_f32_16x16x64_bf16 v[196:199], v[200:203], v[88:95], v204
    ds_read_b128 v[156:159], v24 offset:44032
    v_exp_f32 v110, v110
    v_exp_f32 v111, v111
    v_mfma_f32_32x32x16_bf16 v[64:79], v[128:131], v[8:11], 0
    v_exp_f32 v112, v112
    v_exp_f32 v113, v113
    v_exp_f32 v114, v114
    v_mfma_f32_32x32x16_bf16 v[64:79], v[132:135], v[12:15], v[64:79]
    s_waitcnt lgkmcnt(1)
    v_exp_f32 v115, v115
    v_exp_f32 v116, v116
    v_exp_f32 v117, v117
    v_smfmac_f32_32x32x32_bf16 v[160:175], v[152:155], v[96:103], v204
    s_waitcnt lgkmcnt(0)
    v_exp_f32 v118, v118
    v_exp_f32 v119, v119
    v_exp_f32 v120, v120
    v_smfmac_f32_16x16x64_bf16 v[192:195], v[200:203], v[96:103], v204
    ds_read_b128 v[136:139], v24 offset:38912
    v_exp_f32 v121, v121
    v_exp_f32 v122, v122
    v_smfmac_f32_32x32x32_bf16 v[160:175], v[156:159], v[104:111], v204
    v_exp_f32 v123, v123
    v_exp_f32 v124, v124
    v_exp_f32 v125, v125
    v_smfmac_f32_16x16x64_bf16 v[192:195], v[200:203], v[104:111], v204
    ds_read_b128 v[140:143], v24 offset:39936
    v_exp_f32 v126, v126
    v_exp_f32 v127, v127
    v_mfma_f32_32x32x16_bf16 v[80:95], v[128:131], v[16:19], 0
    v_exp_f32 v64, v64
    v_exp_f32 v65, v65
    v_exp_f32 v66, v66
    v_mfma_f32_32x32x16_bf16 v[80:95], v[132:135], v[20:23], v[80:95]
    v_exp_f32 v67, v67
    v_exp_f32 v68, v68
    v_exp_f32 v69, v69
    v_smfmac_f32_32x32x32_bf16 v[176:191], v[152:155], v[112:119], v204
    s_waitcnt lgkmcnt(0)
    v_exp_f32 v70, v70
    v_exp_f32 v71, v71
    v_exp_f32 v72, v72
    v_smfmac_f32_16x16x64_bf16 v[196:199], v[200:203], v[112:119], v204
    ds_read_b128 v[144:147], v24 offset:45056
    v_exp_f32 v73, v73
    v_exp_f32 v74, v74
    v_smfmac_f32_32x32x32_bf16 v[176:191], v[156:159], v[120:127], v204
    v_exp_f32 v75, v75
    v_exp_f32 v76, v76
    v_exp_f32 v77, v77
    v_smfmac_f32_16x16x64_bf16 v[196:199], v[200:203], v[120:127], v204
    ds_read_b128 v[148:151], v24 offset:46080
    v_exp_f32 v78, v78
    v_exp_f32 v79, v79
    v_mfma_f32_32x32x16_bf16 v[96:111], v[136:139], v[8:11], 0
    s_barrier
    v_exp_f32 v80, v80
    v_exp_f32 v81, v81
    v_exp_f32 v82, v82
    v_mfma_f32_32x32x16_bf16 v[96:111], v[140:143], v[12:15], v[96:111]
    s_waitcnt lgkmcnt(1)
    v_exp_f32 v83, v83
    v_exp_f32 v84, v84
    v_exp_f32 v85, v85
    v_smfmac_f32_32x32x32_bf16 v[160:175], v[144:147], v[64:71], v204
    s_waitcnt lgkmcnt(0)
    v_exp_f32 v86, v86
    v_exp_f32 v87, v87
    v_exp_f32 v88, v88
    v_smfmac_f32_16x16x64_bf16 v[192:195], v[200:203], v[64:71], v204
    ds_read_b128 v[128:131], v24 offset:49152
    v_exp_f32 v89, v89
    v_exp_f32 v90, v90
    v_smfmac_f32_32x32x32_bf16 v[160:175], v[148:151], v[72:79], v204
    v_exp_f32 v91, v91
    v_exp_f32 v92, v92
    v_exp_f32 v93, v93
    v_smfmac_f32_16x16x64_bf16 v[192:195], v[200:203], v[72:79], v204
    ds_read_b128 v[132:135], v24 offset:50176
    v_exp_f32 v94, v94
    v_exp_f32 v95, v95
    v_mfma_f32_32x32x16_bf16 v[112:127], v[136:139], v[16:19], 0
    v_exp_f32 v96, v96
    v_exp_f32 v97, v97
    v_exp_f32 v98, v98
    v_mfma_f32_32x32x16_bf16 v[112:127], v[140:143], v[20:23], v[112:127]
    v_exp_f32 v99, v99
    v_exp_f32 v100, v100
    v_exp_f32 v101, v101
    v_smfmac_f32_32x32x32_bf16 v[176:191], v[144:147], v[80:87], v204
    s_waitcnt lgkmcnt(0)
    v_exp_f32 v102, v102
    v_exp_f32 v103, v103
    v_exp_f32 v104, v104
    v_smfmac_f32_16x16x64_bf16 v[196:199], v[200:203], v[80:87], v204
    ds_read_b128 v[152:155], v24 offset:47104
    v_exp_f32 v105, v105
    v_exp_f32 v106, v106
    v_smfmac_f32_32x32x32_bf16 v[176:191], v[148:151], v[88:95], v204
    v_exp_f32 v107, v107
    v_exp_f32 v108, v108
    v_exp_f32 v109, v109
    v_smfmac_f32_16x16x64_bf16 v[196:199], v[200:203], v[88:95], v204
    ds_read_b128 v[156:159], v24 offset:48128
    v_exp_f32 v110, v110
    v_exp_f32 v111, v111
    v_mfma_f32_32x32x16_bf16 v[64:79], v[128:131], v[8:11], 0
    v_exp_f32 v112, v112
    v_exp_f32 v113, v113
    v_exp_f32 v114, v114
    v_mfma_f32_32x32x16_bf16 v[64:79], v[132:135], v[12:15], v[64:79]
    s_waitcnt lgkmcnt(1)
    v_exp_f32 v115, v115
    v_exp_f32 v116, v116
    v_exp_f32 v117, v117
    v_smfmac_f32_32x32x32_bf16 v[160:175], v[152:155], v[96:103], v204
    s_waitcnt lgkmcnt(0)
    v_exp_f32 v118, v118
    v_exp_f32 v119, v119
    v_exp_f32 v120, v120
    v_smfmac_f32_16x16x64_bf16 v[192:195], v[200:203], v[96:103], v204
    ds_read_b128 v[136:139], v24 offset:51200
    v_exp_f32 v121, v121
    v_exp_f32 v122, v122
    v_smfmac_f32_32x32x32_bf16 v[160:175], v[156:159], v[104:111], v204
    v_exp_f32 v123, v123
    v_exp_f32 v124, v124
    v_exp_f32 v125, v125
    v_smfmac_f32_16x16x64_bf16 v[192:195], v[200:203], v[104:111], v204
    ds_read_b128 v[140:143], v24 offset:52224
    v_exp_f32 v126, v126
    v_exp_f32 v127, v127
    v_mfma_f32_32x32x16_bf16 v[80:95], v[128:131], v[16:19], 0
    v_exp_f32 v64, v64
    v_exp_f32 v65, v65
    v_exp_f32 v66, v66
    v_mfma_f32_32x32x16_bf16 v[80:95], v[132:135], v[20:23], v[80:95]
    v_exp_f32 v67, v67
    v_exp_f32 v68, v68
    v_exp_f32 v69, v69
    v_smfmac_f32_32x32x32_bf16 v[176:191], v[152:155], v[112:119], v204
    s_waitcnt lgkmcnt(0)
    v_exp_f32 v70, v70
    v_exp_f32 v71, v71
    v_exp_f32 v72, v72
    v_smfmac_f32_16x16x64_bf16 v[196:199], v[200:203], v[112:119], v204
    ds_read_b128 v[144:147], v24 offset:57344
    v_exp_f32 v73, v73
    v_exp_f32 v74, v74
    v_smfmac_f32_32x32x32_bf16 v[176:191], v[156:159], v[120:127], v204
    v_exp_f32 v75, v75
    v_exp_f32 v76, v76
    v_exp_f32 v77, v77
    v_smfmac_f32_16x16x64_bf16 v[196:199], v[200:203], v[120:127], v204
    ds_read_b128 v[148:151], v24 offset:58368
    v_exp_f32 v78, v78
    v_exp_f32 v79, v79
    v_mfma_f32_32x32x16_bf16 v[96:111], v[136:139], v[8:11], 0
    v_exp_f32 v80, v80
    v_exp_f32 v81, v81
    v_exp_f32 v82, v82
    v_mfma_f32_32x32x16_bf16 v[96:111], v[140:143], v[12:15], v[96:111]
    s_waitcnt lgkmcnt(1)
    v_exp_f32 v83, v83
    v_exp_f32 v84, v84
    v_exp_f32 v85, v85
    v_smfmac_f32_32x32x32_bf16 v[160:175], v[144:147], v[64:71], v204
    s_waitcnt lgkmcnt(0)
    v_exp_f32 v86, v86
    v_exp_f32 v87, v87
    v_exp_f32 v88, v88
    v_smfmac_f32_16x16x64_bf16 v[192:195], v[200:203], v[64:71], v204
    ds_read_b128 v[128:131], v24 offset:53248
    v_exp_f32 v89, v89
    v_exp_f32 v90, v90
    v_smfmac_f32_32x32x32_bf16 v[160:175], v[148:151], v[72:79], v204
    v_exp_f32 v91, v91
    v_exp_f32 v92, v92
    v_exp_f32 v93, v93
    v_smfmac_f32_16x16x64_bf16 v[192:195], v[200:203], v[72:79], v204
    ds_read_b128 v[132:135], v24 offset:54272
    v_exp_f32 v94, v94
    v_exp_f32 v95, v95
    v_mfma_f32_32x32x16_bf16 v[112:127], v[136:139], v[16:19], 0
    v_exp_f32 v96, v96
    v_exp_f32 v97, v97
    v_exp_f32 v98, v98
    v_mfma_f32_32x32x16_bf16 v[112:127], v[140:143], v[20:23], v[112:127]
    v_exp_f32 v99, v99
    v_exp_f32 v100, v100
    v_exp_f32 v101, v101
    v_smfmac_f32_32x32x32_bf16 v[176:191], v[144:147], v[80:87], v204
    s_waitcnt lgkmcnt(0)
    v_exp_f32 v102, v102
    v_exp_f32 v103, v103
    v_exp_f32 v104, v104
    v_smfmac_f32_16x16x64_bf16 v[196:199], v[200:203], v[80:87], v204
    ds_read_b128 v[152:155], v24 offset:59392
    v_exp_f32 v105, v105
    v_exp_f32 v106, v106
    v_smfmac_f32_32x32x32_bf16 v[176:191], v[148:151], v[88:95], v204
    v_exp_f32 v107, v107
    v_exp_f32 v108, v108
    v_exp_f32 v109, v109
    v_smfmac_f32_16x16x64_bf16 v[196:199], v[200:203], v[88:95], v204
    ds_read_b128 v[156:159], v24 offset:60416
    v_exp_f32 v110, v110
    v_exp_f32 v111, v111
    v_mfma_f32_32x32x16_bf16 v[64:79], v[128:131], v[8:11], 0
    v_exp_f32 v112, v112
    v_exp_f32 v113, v113
    v_exp_f32 v114, v114
    v_mfma_f32_32x32x16_bf16 v[64:79], v[132:135], v[12:15], v[64:79]
    s_waitcnt lgkmcnt(1)
    v_exp_f32 v115, v115
    v_exp_f32 v116, v116
    v_exp_f32 v117, v117
    v_smfmac_f32_32x32x32_bf16 v[160:175], v[152:155], v[96:103], v204
    s_waitcnt lgkmcnt(0)
    v_exp_f32 v118, v118
    v_exp_f32 v119, v119
    v_exp_f32 v120, v120
    v_smfmac_f32_16x16x64_bf16 v[192:195], v[200:203], v[96:103], v204
    ds_read_b128 v[136:139], v24 offset:55296
    v_exp_f32 v121, v121
    v_exp_f32 v122, v122
    v_smfmac_f32_32x32x32_bf16 v[160:175], v[156:159], v[104:111], v204
    v_exp_f32 v123, v123
    v_exp_f32 v124, v124
    v_exp_f32 v125, v125
    v_smfmac_f32_16x16x64_bf16 v[192:195], v[200:203], v[104:111], v204
    ds_read_b128 v[140:143], v24 offset:56320
    v_exp_f32 v126, v126
    v_exp_f32 v127, v127
    v_mfma_f32_32x32x16_bf16 v[80:95], v[128:131], v[16:19], 0
    v_exp_f32 v64, v64
    v_exp_f32 v65, v65
    v_exp_f32 v66, v66
    v_mfma_f32_32x32x16_bf16 v[80:95], v[132:135], v[20:23], v[80:95]
    v_exp_f32 v67, v67
    v_exp_f32 v68, v68
    v_exp_f32 v69, v69
    v_smfmac_f32_32x32x32_bf16 v[176:191], v[152:155], v[112:119], v204
    s_waitcnt lgkmcnt(0)
    v_exp_f32 v70, v70
    v_exp_f32 v71, v71
    v_exp_f32 v72, v72
    v_smfmac_f32_16x16x64_bf16 v[196:199], v[200:203], v[112:119], v204
    ds_read_b128 v[144:147], v24 offset:61440
    v_exp_f32 v73, v73
    v_exp_f32 v74, v74
    v_smfmac_f32_32x32x32_bf16 v[176:191], v[156:159], v[120:127], v204
    v_exp_f32 v75, v75
    v_exp_f32 v76, v76
    v_exp_f32 v77, v77
    v_smfmac_f32_16x16x64_bf16 v[196:199], v[200:203], v[120:127], v204
    ds_read_b128 v[148:151], v24 offset:62464
    v_exp_f32 v78, v78
    v_exp_f32 v79, v79
    v_mfma_f32_32x32x16_bf16 v[96:111], v[136:139], v[8:11], 0
    s_barrier
    v_exp_f32 v80, v80
    v_exp_f32 v81, v81
    v_exp_f32 v82, v82
    v_mfma_f32_32x32x16_bf16 v[96:111], v[140:143], v[12:15], v[96:111]
    s_waitcnt lgkmcnt(1)
    v_exp_f32 v83, v83
    v_exp_f32 v84, v84
    v_exp_f32 v85, v85
    v_smfmac_f32_32x32x32_bf16 v[160:175], v[144:147], v[64:71], v204
    s_waitcnt lgkmcnt(0)
    v_exp_f32 v86, v86
    v_exp_f32 v87, v87
    v_exp_f32 v88, v88
    v_smfmac_f32_16x16x64_bf16 v[192:195], v[200:203], v[64:71], v204
    ds_read_b128 v[128:131], v24 offset:0
    v_exp_f32 v89, v89
    v_exp_f32 v90, v90
    v_smfmac_f32_32x32x32_bf16 v[160:175], v[148:151], v[72:79], v204
    v_exp_f32 v91, v91
    v_exp_f32 v92, v92
    v_exp_f32 v93, v93
    v_smfmac_f32_16x16x64_bf16 v[192:195], v[200:203], v[72:79], v204
    ds_read_b128 v[132:135], v24 offset:1024
    v_exp_f32 v94, v94
    v_exp_f32 v95, v95
    v_mfma_f32_32x32x16_bf16 v[112:127], v[136:139], v[16:19], 0
    v_exp_f32 v96, v96
    v_exp_f32 v97, v97
    v_exp_f32 v98, v98
    v_mfma_f32_32x32x16_bf16 v[112:127], v[140:143], v[20:23], v[112:127]
    v_exp_f32 v99, v99
    v_exp_f32 v100, v100
    v_exp_f32 v101, v101
    v_smfmac_f32_32x32x32_bf16 v[176:191], v[144:147], v[80:87], v204
    s_waitcnt lgkmcnt(0)
    v_exp_f32 v102, v102
    v_exp_f32 v103, v103
    v_exp_f32 v104, v104
    v_smfmac_f32_16x16x64_bf16 v[196:199], v[200:203], v[80:87], v204
    ds_read_b128 v[152:155], v24 offset:63488
    v_exp_f32 v105, v105
    v_exp_f32 v106, v106
    v_smfmac_f32_32x32x32_bf16 v[176:191], v[148:151], v[88:95], v204
    v_exp_f32 v107, v107
    v_exp_f32 v108, v108
    v_exp_f32 v109, v109
    v_smfmac_f32_16x16x64_bf16 v[196:199], v[200:203], v[88:95], v204
    ds_read_b128 v[156:159], v24 offset:64512
    v_exp_f32 v110, v110
    v_exp_f32 v111, v111
    v_mfma_f32_32x32x16_bf16 v[64:79], v[128:131], v[8:11], 0
    s_sub_u32 s54, s54, 1
    v_exp_f32 v112, v112
    v_exp_f32 v113, v113
    v_exp_f32 v114, v114
    v_mfma_f32_32x32x16_bf16 v[64:79], v[132:135], v[12:15], v[64:79]
    s_waitcnt lgkmcnt(1)
    v_exp_f32 v115, v115
    v_exp_f32 v116, v116
    v_exp_f32 v117, v117
    v_smfmac_f32_32x32x32_bf16 v[160:175], v[152:155], v[96:103], v204
    s_waitcnt lgkmcnt(0)
    v_exp_f32 v118, v118
    v_exp_f32 v119, v119
    v_exp_f32 v120, v120
    v_smfmac_f32_16x16x64_bf16 v[192:195], v[200:203], v[96:103], v204
    ds_read_b128 v[136:139], v24 offset:2048
    v_exp_f32 v121, v121
    v_exp_f32 v122, v122
    v_smfmac_f32_32x32x32_bf16 v[160:175], v[156:159], v[104:111], v204
    s_cmp_lg_u32 s54, 0
    v_exp_f32 v123, v123
    v_exp_f32 v124, v124
    v_exp_f32 v125, v125
    v_smfmac_f32_16x16x64_bf16 v[192:195], v[200:203], v[104:111], v204
    ds_read_b128 v[140:143], v24 offset:3072
    v_exp_f32 v126, v126
    v_exp_f32 v127, v127
    s_cbranch_scc1 c_attn_loop
    v_smfmac_f32_16x16x64_bf16 v[196:199], v[200:203], v[112:119], v204
    v_smfmac_f32_16x16x64_bf16 v[196:199], v[200:203], v[120:127], v204
    v_smfmac_f32_32x32x32_bf16 v[176:191], v[152:155], v[112:119], v204
    v_smfmac_f32_32x32x32_bf16 v[176:191], v[156:159], v[120:127], v204
    v_mov_b32 v25, 0x5f000000
    v_mov_b32 v26, 0x2b800000
    v_cmp_lt_f32 s[56:57], v192, v25
    v_cmp_gt_f32 vcc, v192, v26
    s_and_b64 s[56:57], s[56:57], vcc
    s_nop 0
    v_cmp_lt_f32 vcc, v196, v25
    s_and_b64 s[56:57], s[56:57], vcc
    v_cmp_gt_f32 vcc, v196, v26
    s_and_b64 s[56:57], s[56:57], vcc
    s_cmp_lg_u64 s[56:57], -1
    s_cbranch_scc1 c_attn_slow
c_attn_fin:
    s_lshl_b32 s3, s48, 17
    s_lshl_b32 s55, s7, 12
    s_add_u32 s3, s3, s55
    s_and_b32 s55, s6, 1
    s_lshl_b32 s55, s55, 11
    s_add_u32 s3, s3, s55
    s_lshl_b32 s55, s9, 22
    s_add_u32 s3, s3, s55
    s_add_u32 s3, s3, 16777216
    v_rcp_f32 v192, v192
    s_nop 0
    v_pk_mul_f32 v[160:161], v[192:193], v[160:161] op_sel_hi:[0,1]
    v_pk_mul_f32 v[162:163], v[192:193], v[162:163] op_sel_hi:[0,1]
    v_pk_mul_f32 v[164:165], v[192:193], v[164:165] op_sel_hi:[0,1]
    v_pk_mul_f32 v[166:167], v[192:193], v[166:167] op_sel_hi:[0,1]
    v_pk_mul_f32 v[168:169], v[192:193], v[168:169] op_sel_hi:[0,1]
    v_pk_mul_f32 v[170:171], v[192:193], v[170:171] op_sel_hi:[0,1]
    v_pk_mul_f32 v[172:173], v[192:193], v[172:173] op_sel_hi:[0,1]
    v_pk_mul_f32 v[174:175], v[192:193], v[174:175] op_sel_hi:[0,1]
    v_cvt_pk_bf16_f32 v160, v160, v161
    v_cvt_pk_bf16_f32 v161, v162, v163
    v_cvt_pk_bf16_f32 v162, v164, v165
    v_cvt_pk_bf16_f32 v163, v166, v167
    v_cvt_pk_bf16_f32 v164, v168, v169
    v_cvt_pk_bf16_f32 v165, v170, v171
    v_cvt_pk_bf16_f32 v166, v172, v173
    v_cvt_pk_bf16_f32 v167, v174, v175
    buffer_store_dwordx4 v[160:163], v5, s[12:15], s3 offen offset:0 sc1
    buffer_store_dwordx4 v[164:167], v5, s[12:15], s3 offen offset:1024 sc1
    s_add_u32 s3, s3, 65536
    v_rcp_f32 v196, v196
    s_nop 0
    v_pk_mul_f32 v[176:177], v[196:197], v[176:177] op_sel_hi:[0,1]
    v_pk_mul_f32 v[178:179], v[196:197], v[178:179] op_sel_hi:[0,1]
    v_pk_mul_f32 v[180:181], v[196:197], v[180:181] op_sel_hi:[0,1]
    v_pk_mul_f32 v[182:183], v[196:197], v[182:183] op_sel_hi:[0,1]
    v_pk_mul_f32 v[184:185], v[196:197], v[184:185] op_sel_hi:[0,1]
    v_pk_mul_f32 v[186:187], v[196:197], v[186:187] op_sel_hi:[0,1]
    v_pk_mul_f32 v[188:189], v[196:197], v[188:189] op_sel_hi:[0,1]
    v_pk_mul_f32 v[190:191], v[196:197], v[190:191] op_sel_hi:[0,1]
    v_cvt_pk_bf16_f32 v176, v176, v177
    v_cvt_pk_bf16_f32 v177, v178, v179
    v_cvt_pk_bf16_f32 v178, v180, v181
    v_cvt_pk_bf16_f32 v179, v182, v183
    v_cvt_pk_bf16_f32 v180, v184, v185
    v_cvt_pk_bf16_f32 v181, v186, v187
    v_cvt_pk_bf16_f32 v182, v188, v189
    v_cvt_pk_bf16_f32 v183, v190, v191
    buffer_store_dwordx4 v[176:179], v5, s[12:15], s3 offen offset:0 sc1
    buffer_store_dwordx4 v[180:183], v5, s[12:15], s3 offen offset:1024 sc1
    s_add_u32 s3, s3, 65536
    s_branch c_wo
.p2align 6
h_first:
    s_memrealtime s[50:51]
    s_cmp_lg_u32 s2, 0
    s_cbranch_scc1 h_first_nonon
    s_mov_b32 s16, s46
    s_mov_b32 s17, s47
    s_mov_b32 s18, 256
    s_mov_b32 s19, 0x00020000
    v_lshlrev_b32 v14, 6, v1
    s_waitcnt lgkmcnt(0)
    s_or_b32 s50, s50, 1
    v_mov_b32 v13, s50
    buffer_store_dword v13, v14, s[16:19], 0 offen sc1
h_first_nonon:
    v_mov_b32 v8, 0
    v_mov_b32 v9, 0
    v_mov_b32 v10, 159488
    ds_write_b64 v10, v[8:9]
    ds_write_b64 v10, v[8:9] offset:8
    ds_write_b64 v10, v[8:9] offset:16
    ds_write_b64 v10, v[8:9] offset:24
    s_waitcnt lgkmcnt(0)
    s_barrier
    s_barrier
    s_sub_u32 s50, s50, 8000
    s_load_dword s10, s[46:47], 0
    s_waitcnt lgkmcnt(0)
    s_sub_u32 s51, s10, s50
    s_and_b32 s3, s10, 1
    s_cselect_b32 s51, s51, -1
    s_cmp_ge_i32 s51, 0
    s_cbranch_scc1 h_first_non_ok
    s_load_dword s10, s[46:47], 128
    s_waitcnt lgkmcnt(0)
    s_sub_u32 s51, s10, s50
    s_and_b32 s3, s10, 1
    s_cselect_b32 s51, s51, -1
    s_cmp_ge_i32 s51, 0
    s_cbranch_scc1 h_first_non_ok
    s_load_dword s10, s[46:47], 64
    s_waitcnt lgkmcnt(0)
    s_sub_u32 s51, s10, s50
    s_and_b32 s3, s10, 1
    s_cselect_b32 s51, s51, -1
    s_cmp_ge_i32 s51, 0
    s_cbranch_scc1 h_first_non_ok
    s_load_dword s10, s[46:47], 192
    s_waitcnt lgkmcnt(0)
    s_sub_u32 s51, s10, s50
    s_and_b32 s3, s10, 1
    s_cselect_b32 s51, s51, -1
    s_cmp_ge_i32 s51, 0
    s_cbranch_scc1 h_first_non_ok
    s_mov_b32 s58, 0
    s_and_b32 s57, s2, 0xc0
h_first_non:
    s_load_dword s10, s[46:47], s57 glc
    s_waitcnt lgkmcnt(0)
    s_sub_u32 s51, s10, s50
    s_and_b32 s3, s10, 1
    s_cselect_b32 s51, s51, -1
    s_cmp_ge_i32 s51, 0
    s_cbranch_scc1 h_first_non_ok
    s_add_u32 s58, s58, 1
    s_cmp_gt_u32 s58, 100
    s_cselect_b32 s50, s10, s50
    s_cmp_lt_u32 s58, 0x100000
    s_cbranch_scc1 h_first_non
    s_mov_b32 s10, 1
h_first_non_ok:
    v_mov_b32 v12, s10
    ds_write_b32 v10, v12 offset:4
    s_waitcnt vmcnt(0)
    v_lshlrev_b32 v13, 7, v1
    s_lshl_b32 s50, s2, 13
    s_mov_b32 s28, s36
    s_mov_b32 s29, s37
    s_mov_b32 s30, 2097152
    s_mov_b32 s31, 0x00020000
    buffer_load_dword v14, v13, s[28:31], s50 offen
    s_mov_b32 s9, 0
h_qkvA:
    s_mul_i32 s98, s9, 786432
    s_add_u32 s98, s98, 65273856
    s_lshl_b32 s99, s11, 10
    s_add_u32 s98, s98, s99
    s_add_u32 s96, s4, s98
    s_addc_u32 s97, s5, 0
    s_mov_b32 s98, s10
    s_mov_b32 s99, s10
    v_and_b32 v1, 63, v0
    v_lshlrev_b32 v5, 4, v1
    v_and_b32 v20, 15, v1
    v_lshrrev_b32 v11, 4, v1
    v_min_u32 v11, 2, v11
    v_lshlrev_b32 v21, 3, v20
    v_lshl_add_u32 v12, v11, 7, v21
    v_add_u32 v12, 155648, v12
    v_lshl_add_u32 v11, v11, 16, v21
    v_mov_b32 v10, 159496
    s_add_u32 s3, s9, 1
    v_mov_b32 v13, s3
    s_and_b32 s3, s6, 14
    s_lshl_b32 s3, s3, 2
    s_sub_u32 s3, s3, 1
    s_max_i32 s3, s3, 0
    s_lshl_b32 s3, s3, 16
    s_lshl_b32 s48, s9, 22
    s_add_u32 s3, s3, s48
    s_add_u32 s20, s4, s3
    s_addc_u32 s21, s5, 0
    s_mov_b32 s22, 65536
    s_mov_b32 s23, 0x00020000
    s_cmp_lt_u32 s6, 2
    s_cselect_b32 s22, 0, s22
    s_cselect_b32 s3, 0, 512
    s_add_u32 s96, s96, s3
    s_addc_u32 s97, s97, 0
    v_bfe_u32 v21, v1, 4, 1
    v_lshl_add_u32 v6, v21, 5, v20
    v_lshlrev_b32 v6, 4, v6
    v_lshrrev_b32 v21, 5, v1
    v_lshl_add_u32 v6, v21, 10, v6
    v_add_u32 v6, 256, v6
    v_add_u32 v16, 49152, v5
    s_cmp_eq_u32 s9, 0
    s_cbranch_scc1 h_qkvA_noend
    s_barrier
    s_cmp_lt_u32 s9, 2
    s_cbranch_scc1 c4_10
    ds_write_b128 v16, v[64:67] offset:0
    ds_write_b128 v16, v[68:71] offset:1024
    ds_write_b128 v16, v[72:75] offset:2048
    ds_write_b128 v16, v[76:79] offset:3072
    ds_write_b128 v16, v[80:83] offset:4096
    ds_write_b128 v16, v[84:87] offset:5120
    ds_write_b128 v16, v[88:91] offset:6144
    ds_write_b128 v16, v[92:95] offset:7168
    ds_write_b128 v16, v[96:99] offset:8192
    ds_write_b128 v16, v[100:103] offset:9216
    ds_write_b128 v16, v[104:107] offset:10240
    ds_write_b128 v16, v[108:111] offset:11264
    ds_write_b128 v16, v[112:115] offset:12288
    ds_write_b128 v16, v[116:119] offset:13312
    ds_write_b128 v16, v[120:123] offset:14336
    ds_write_b128 v16, v[124:127] offset:15360
    ds_write_b128 v16, v[128:131] offset:16384
    ds_write_b128 v16, v[132:135] offset:17408
    ds_write_b128 v16, v[136:139] offset:18432
    ds_write_b128 v16, v[140:143] offset:19456
    ds_write_b128 v16, v[144:147] offset:20480
    ds_write_b128 v16, v[148:151] offset:21504
    ds_write_b128 v16, v[152:155] offset:22528
    ds_write_b128 v16, v[156:159] offset:23552
    s_waitcnt lgkmcnt(0)
c4_10:
    s_barrier
h_qkvA_noend:
    s_mov_b32 s3, 0x100000
poll_11:
    s_load_dwordx8 s[80:87], s[96:97], 0 glc
    s_load_dwordx8 s[88:95], s[96:97], 128 glc
    s_sub_u32 s3, s3, 1
    s_cbranch_scc1 poll_11_ok
    s_waitcnt lgkmcnt(0)
    s_xor_b64 s[100:101], s[80:81], s[98:99]
    s_xor_b64 s[80:81], s[82:83], s[98:99]
    s_or_b64 s[100:101], s[100:101], s[80:81]
    s_xor_b64 s[80:81], s[84:85], s[98:99]
    s_or_b64 s[100:101], s[100:101], s[80:81]
    s_xor_b64 s[80:81], s[86:87], s[98:99]
    s_or_b64 s[100:101], s[100:101], s[80:81]
    s_xor_b64 s[80:81], s[88:89], s[98:99]
    s_or_b64 s[100:101], s[100:101], s[80:81]
    s_xor_b64 s[80:81], s[90:91], s[98:99]
    s_or_b64 s[100:101], s[100:101], s[80:81]
    s_xor_b64 s[80:81], s[92:93], s[98:99]
    s_or_b64 s[100:101], s[100:101], s[80:81]
    s_xor_b64 s[80:81], s[94:95], s[98:99]
    s_or_b64 s[100:101], s[100:101], s[80:81]
    s_cbranch_scc1 poll_11
poll_11_ok:
    s_waitcnt lgkmcnt(0)
    ds_write_b32 v10, v13
    s_mov_b32 m0, 147456
    s_mov_b32 s48, 0
    buffer_load_dwordx4 v6, s[20:23], s48 offen sc1 lds
    s_mov_b32 m0, 148480
    s_mov_b32 s48, 2048
    buffer_load_dwordx4 v6, s[20:23], s48 offen sc1 lds
    s_mov_b32 m0, 149504
    s_mov_b32 s48, 4096
    buffer_load_dwordx4 v6, s[20:23], s48 offen sc1 lds
    s_mov_b32 m0, 150528
    s_mov_b32 s48, 6144
    buffer_load_dwordx4 v6, s[20:23], s48 offen sc1 lds
    s_mov_b32 m0, 151552
    s_mov_b32 s48, 8192
    buffer_load_dwordx4 v6, s[20:23], s48 offen sc1 lds
    s_mov_b32 m0, 152576
    s_mov_b32 s48, 10240
    buffer_load_dwordx4 v6, s[20:23], s48 offen sc1 lds
    s_mov_b32 m0, 153600
    s_mov_b32 s48, 12288
    buffer_load_dwordx4 v6, s[20:23], s48 offen sc1 lds
    s_mov_b32 m0, 154624
    s_mov_b32 s48, 14336
    buffer_load_dwordx4 v6, s[20:23], s48 offen sc1 lds
    s_lshl_b32 s56, s7, 12
    s_and_b32 s57, s6, 1
    s_lshl_b32 s57, s57, 7
    s_add_u32 s56, s56, s57
    s_add_u32 s56, s56, 63963136
    v_lshlrev_b32 v15, 7, v1
    s_lshr_b32 s59, s2, 3
    s_mul_i32 s59, s59, 3
    s_lshr_b32 s59, s59, 5
    s_lshl_b32 s3, s9, 4
    s_add_u32 s59, s59, s3
    s_waitcnt vmcnt(4)
    s_barrier
    s_waitcnt vmcnt(0)
    s_barrier
    s_mov_b32 m0, 147456
    s_mov_b32 s48, 16384
    buffer_load_dwordx4 v6, s[20:23], s48 offen sc1 lds
    s_mov_b32 m0, 148480
    s_mov_b32 s48, 18432
    buffer_load_dwordx4 v6, s[20:23], s48 offen sc1 lds
    s_mov_b32 m0, 149504
    s_mov_b32 s48, 20480
    buffer_load_dwordx4 v6, s[20:23], s48 offen sc1 lds
    s_mov_b32 m0, 150528
    s_mov_b32 s48, 22528
    buffer_load_dwordx4 v6, s[20:23], s48 offen sc1 lds
    s_waitcnt vmcnt(0)
    s_waitcnt vmcnt(0)
    s_barrier
    s_mov_b32 m0, 151552
    s_mov_b32 s48, 24576
    buffer_load_dwordx4 v6, s[20:23], s48 offen sc1 lds
    s_mov_b32 m0, 152576
    s_mov_b32 s48, 26624
    buffer_load_dwordx4 v6, s[20:23], s48 offen sc1 lds
    s_mov_b32 m0, 153600
    s_mov_b32 s48, 28672
    buffer_load_dwordx4 v6, s[20:23], s48 offen sc1 lds
    s_mov_b32 m0, 154624
    s_mov_b32 s48, 30720
    buffer_load_dwordx4 v6, s[20:23], s48 offen sc1 lds
    s_cmp_ge_u32 s9, 2
    s_cbranch_scc1 cs_13
    buffer_load_dwordx2 v[32:33], v11, s[12:15], s56 offen offset:0 sc1
    buffer_load_dwordx2 v[34:35], v11, s[12:15], s56 offen offset:256 sc1
    buffer_load_dwordx2 v[36:37], v11, s[12:15], s56 offen offset:512 sc1
    buffer_load_dwordx2 v[38:39], v11, s[12:15], s56 offen offset:768 sc1
    buffer_load_dwordx2 v[40:41], v11, s[12:15], s56 offen offset:1024 sc1
    buffer_load_dwordx2 v[42:43], v11, s[12:15], s56 offen offset:1280 sc1
    buffer_load_dwordx2 v[44:45], v11, s[12:15], s56 offen offset:1536 sc1
    buffer_load_dwordx2 v[46:47], v11, s[12:15], s56 offen offset:1792 sc1
    buffer_load_dwordx2 v[48:49], v11, s[12:15], s56 offen offset:2048 sc1
    buffer_load_dwordx2 v[50:51], v11, s[12:15], s56 offen offset:2304 sc1
    buffer_load_dwordx2 v[52:53], v11, s[12:15], s56 offen offset:2560 sc1
    buffer_load_dwordx2 v[54:55], v11, s[12:15], s56 offen offset:2816 sc1
cs_13:
    s_waitcnt vmcnt(0)
    s_waitcnt vmcnt(12)
    s_barrier
    s_mov_b32 m0, 147456
    s_mov_b32 s48, 32768
    buffer_load_dwordx4 v6, s[20:23], s48 offen sc1 lds
    s_mov_b32 m0, 148480
    s_mov_b32 s48, 34816
    buffer_load_dwordx4 v6, s[20:23], s48 offen sc1 lds
    s_mov_b32 m0, 149504
    s_mov_b32 s48, 36864
    buffer_load_dwordx4 v6, s[20:23], s48 offen sc1 lds
    s_mov_b32 m0, 150528
    s_mov_b32 s48, 38912
    buffer_load_dwordx4 v6, s[20:23], s48 offen sc1 lds
    s_cmp_ge_u32 s9, 2
    s_cbranch_scc1 cs_14
    buffer_load_dwordx2 v[56:57], v11, s[12:15], s56 offen offset:3072 sc1
    buffer_load_dwordx2 v[58:59], v11, s[12:15], s56 offen offset:3328 sc1
    buffer_load_dwordx2 v[60:61], v11, s[12:15], s56 offen offset:3584 sc1
    buffer_load_dwordx2 v[62:63], v11, s[12:15], s56 offen offset:3840 sc1
cs_14:
    s_waitcnt vmcnt(0)
    s_waitcnt vmcnt(4)
    s_barrier
    s_mov_b32 m0, 151552
    s_mov_b32 s48, 40960
    buffer_load_dwordx4 v6, s[20:23], s48 offen sc1 lds
    s_mov_b32 m0, 152576
    s_mov_b32 s48, 43008
    buffer_load_dwordx4 v6, s[20:23], s48 offen sc1 lds
    s_mov_b32 m0, 153600
    s_mov_b32 s48, 45056
    buffer_load_dwordx4 v6, s[20:23], s48 offen sc1 lds
    s_mov_b32 m0, 154624
    s_mov_b32 s48, 47104
    buffer_load_dwordx4 v6, s[20:23], s48 offen sc1 lds
    s_cmp_ge_u32 s9, 2
    s_cbranch_scc1 c4_15
    ds_read_b128 v[64:67], v16 offset:0
    ds_read_b128 v[68:71], v16 offset:1024
    ds_read_b128 v[72:75], v16 offset:2048
    ds_read_b128 v[76:79], v16 offset:3072
    ds_read_b128 v[80:83], v16 offset:4096
    ds_read_b128 v[84:87], v16 offset:5120
    ds_read_b128 v[88:91], v16 offset:6144
    ds_read_b128 v[92:95], v16 offset:7168
    ds_read_b128 v[96:99], v16 offset:8192
    ds_read_b128 v[100:103], v16 offset:9216
    ds_read_b128 v[104:107], v16 offset:10240
    ds_read_b128 v[108:111], v16 offset:11264
    ds_read_b128 v[112:115], v16 offset:12288
    ds_read_b128 v[116:119], v16 offset:13312
    ds_read_b128 v[120:123], v16 offset:14336
    ds_read_b128 v[124:127], v16 offset:15360
    ds_read_b128 v[128:131], v16 offset:16384
    ds_read_b128 v[132:135], v16 offset:17408
    ds_read_b128 v[136:139], v16 offset:18432
    ds_read_b128 v[140:143], v16 offset:19456
    ds_read_b128 v[144:147], v16 offset:20480
    ds_read_b128 v[148:151], v16 offset:21504
    ds_read_b128 v[152:155], v16 offset:22528
    ds_read_b128 v[156:159], v16 offset:23552
    s_waitcnt lgkmcnt(0)
c4_15:
    s_cmp_ge_u32 s9, 2
    s_cbranch_scc1 cs_16
    s_waitcnt vmcnt(4)
    v_add_f32 v32, v32, v48
    v_add_f32 v33, v33, v49
    v_add_f32 v34, v34, v50
    v_add_f32 v35, v35, v51
    v_add_f32 v36, v36, v52
    v_add_f32 v37, v37, v53
    v_add_f32 v38, v38, v54
    v_add_f32 v39, v39, v55
    v_add_f32 v40, v40, v56
    v_add_f32 v41, v41, v57
    v_add_f32 v42, v42, v58
    v_add_f32 v43, v43, v59
cs_16:
    s_waitcnt vmcnt(0)
    s_waitcnt vmcnt(0)
    s_barrier
    s_mov_b32 m0, 147456
    s_mov_b32 s48, 49152
    buffer_load_dwordx4 v6, s[20:23], s48 offen sc1 lds
    s_mov_b32 m0, 148480
    s_mov_b32 s48, 51200
    buffer_load_dwordx4 v6, s[20:23], s48 offen sc1 lds
    s_mov_b32 m0, 149504
    s_mov_b32 s48, 53248
    buffer_load_dwordx4 v6, s[20:23], s48 offen sc1 lds
    s_mov_b32 m0, 150528
    s_mov_b32 s48, 55296
    buffer_load_dwordx4 v6, s[20:23], s48 offen sc1 lds
    s_cmp_ge_u32 s9, 2
    s_cbranch_scc1 cs_17
    v_add_f32 v44, v44, v60
    v_add_f32 v45, v45, v61
    v_add_f32 v46, v46, v62
    v_add_f32 v47, v47, v63
    v_add_f32 v32, v32, v40
    v_add_f32 v33, v33, v41
    v_add_f32 v34, v34, v42
    v_add_f32 v35, v35, v43
    v_add_f32 v36, v36, v44
    v_add_f32 v37, v37, v45
    v_add_f32 v38, v38, v46
    v_add_f32 v39, v39, v47
cs_17:
    s_waitcnt vmcnt(0)
    s_waitcnt vmcnt(0)
    s_barrier
    s_mov_b32 m0, 151552
    s_mov_b32 s48, 57344
    buffer_load_dwordx4 v6, s[20:23], s48 offen sc1 lds
    s_mov_b32 m0, 152576
    s_mov_b32 s48, 59392
    buffer_load_dwordx4 v6, s[20:23], s48 offen sc1 lds
    s_mov_b32 m0, 153600
    s_mov_b32 s48, 61440
    buffer_load_dwordx4 v6, s[20:23], s48 offen sc1 lds
    s_mov_b32 m0, 154624
    s_mov_b32 s48, 63488
    buffer_load_dwordx4 v6, s[20:23], s48 offen sc1 lds
    s_cmp_ge_u32 s9, 2
    s_cbranch_scc1 cs_18
    v_add_f32 v32, v32, v36
    v_add_f32 v33, v33, v37
    v_add_f32 v34, v34, v38
    v_add_f32 v35, v35, v39
    v_add_f32 v32, v32, v34
    v_add_f32 v33, v33, v35
    ds_write_b64 v12, v[32:33]
    s_waitcnt lgkmcnt(0)
cs_18:
    s_waitcnt vmcnt(0)
    s_waitcnt vmcnt(0)
    s_barrier
    s_barrier
    s_barrier
    s_branch h_wo
h_qkvB:
    s_mul_i32 s98, s9, 786432
    s_add_u32 s98, s98, 65273856
    s_lshl_b32 s99, s11, 10
    s_add_u32 s98, s98, s99
    s_add_u32 s96, s4, s98
    s_addc_u32 s97, s5, 0
    s_mov_b32 s98, s10
    s_mov_b32 s99, s10
    v_and_b32 v1, 63, v0
    v_lshlrev_b32 v5, 4, v1
    v_and_b32 v20, 15, v1
    v_lshrrev_b32 v11, 4, v1
    v_min_u32 v11, 2, v11
    v_lshlrev_b32 v21, 3, v20
    v_lshl_add_u32 v12, v11, 7, v21
    v_add_u32 v12, 156032, v12
    v_lshl_add_u32 v11, v11, 16, v21
    v_mov_b32 v10, 159496
    s_add_u32 s3, s9, 1
    v_mov_b32 v13, s3
    v_add_u32 v16, 49152, v5
    s_barrier
    s_cmp_lt_u32 s9, 2
    s_cbranch_scc1 c4_21
    ds_write_b128 v16, v[160:163] offset:0
    ds_write_b128 v16, v[164:167] offset:1024
    ds_write_b128 v16, v[168:171] offset:2048
    ds_write_b128 v16, v[172:175] offset:3072
    ds_write_b128 v16, v[176:179] offset:4096
    ds_write_b128 v16, v[180:183] offset:5120
    ds_write_b128 v16, v[184:187] offset:6144
    ds_write_b128 v16, v[188:191] offset:7168
    ds_write_b128 v16, v[192:195] offset:8192
    ds_write_b128 v16, v[196:199] offset:9216
    ds_write_b128 v16, v[200:203] offset:10240
    ds_write_b128 v16, v[204:207] offset:11264
    ds_write_b128 v16, v[208:211] offset:12288
    ds_write_b128 v16, v[212:215] offset:13312
    ds_write_b128 v16, v[216:219] offset:14336
    ds_write_b128 v16, v[220:223] offset:15360
    ds_write_b128 v16, a[0:3] offset:16384
    ds_write_b128 v16, a[4:7] offset:17408
    ds_write_b128 v16, a[8:11] offset:18432
    ds_write_b128 v16, a[12:15] offset:19456
    ds_write_b128 v16, a[16:19] offset:20480
    ds_write_b128 v16, a[20:23] offset:21504
    ds_write_b128 v16, a[24:27] offset:22528
    ds_write_b128 v16, a[28:31] offset:23552
    s_waitcnt lgkmcnt(0)
c4_21:
    s_barrier
    s_mov_b32 s3, 0x100000
poll_22:
    s_load_dwordx8 s[88:95], s[96:97], 0 glc
    s_sub_u32 s3, s3, 1
    s_cbranch_scc1 poll_22_ok
    s_waitcnt lgkmcnt(0)
    s_xor_b64 s[100:101], s[88:89], s[98:99]
    s_xor_b64 s[88:89], s[90:91], s[98:99]
    s_or_b64 s[100:101], s[100:101], s[88:89]
    s_xor_b64 s[88:89], s[92:93], s[98:99]
    s_or_b64 s[100:101], s[100:101], s[88:89]
    s_xor_b64 s[88:89], s[94:95], s[98:99]
    s_or_b64 s[100:101], s[100:101], s[88:89]
    s_cbranch_scc1 poll_22
poll_22_ok:
    s_waitcnt lgkmcnt(0)
    ds_write_b32 v10, v13
    s_lshl_b32 s56, s7, 12
    s_and_b32 s57, s6, 1
    s_lshl_b32 s57, s57, 7
    s_add_u32 s56, s56, s57
    s_add_u32 s56, s56, 64159744
    s_barrier
    s_barrier
    s_barrier
    s_cmp_ge_u32 s9, 2
    s_cbranch_scc1 cs_24
    buffer_load_dwordx2 v[32:33], v11, s[12:15], s56 offen offset:0 sc1
    buffer_load_dwordx2 v[34:35], v11, s[12:15], s56 offen offset:256 sc1
    buffer_load_dwordx2 v[36:37], v11, s[12:15], s56 offen offset:512 sc1
    buffer_load_dwordx2 v[38:39], v11, s[12:15], s56 offen offset:768 sc1
    buffer_load_dwordx2 v[40:41], v11, s[12:15], s56 offen offset:1024 sc1
    buffer_load_dwordx2 v[42:43], v11, s[12:15], s56 offen offset:1280 sc1
    buffer_load_dwordx2 v[44:45], v11, s[12:15], s56 offen offset:1536 sc1
    buffer_load_dwordx2 v[46:47], v11, s[12:15], s56 offen offset:1792 sc1
    buffer_load_dwordx2 v[48:49], v11, s[12:15], s56 offen offset:2048 sc1
    buffer_load_dwordx2 v[50:51], v11, s[12:15], s56 offen offset:2304 sc1
    buffer_load_dwordx2 v[52:53], v11, s[12:15], s56 offen offset:2560 sc1
    buffer_load_dwordx2 v[54:55], v11, s[12:15], s56 offen offset:2816 sc1
cs_24:
    s_barrier
    s_cmp_ge_u32 s9, 2
    s_cbranch_scc1 cs_25
    buffer_load_dwordx2 v[56:57], v11, s[12:15], s56 offen offset:3072 sc1
    buffer_load_dwordx2 v[58:59], v11, s[12:15], s56 offen offset:3328 sc1
    buffer_load_dwordx2 v[60:61], v11, s[12:15], s56 offen offset:3584 sc1
    buffer_load_dwordx2 v[62:63], v11, s[12:15], s56 offen offset:3840 sc1
cs_25:
    s_barrier
    s_cmp_ge_u32 s9, 2
    s_cbranch_scc1 c4_26
    ds_read_b128 v[160:163], v16 offset:0
    ds_read_b128 v[164:167], v16 offset:1024
    ds_read_b128 v[168:171], v16 offset:2048
    ds_read_b128 v[172:175], v16 offset:3072
    ds_read_b128 v[176:179], v16 offset:4096
    ds_read_b128 v[180:183], v16 offset:5120
    ds_read_b128 v[184:187], v16 offset:6144
    ds_read_b128 v[188:191], v16 offset:7168
    ds_read_b128 v[192:195], v16 offset:8192
    ds_read_b128 v[196:199], v16 offset:9216
    ds_read_b128 v[200:203], v16 offset:10240
    ds_read_b128 v[204:207], v16 offset:11264
    ds_read_b128 v[208:211], v16 offset:12288
    ds_read_b128 v[212:215], v16 offset:13312
    ds_read_b128 v[216:219], v16 offset:14336
    ds_read_b128 v[220:223], v16 offset:15360
    ds_read_b128 a[0:3], v16 offset:16384
    ds_read_b128 a[4:7], v16 offset:17408
    ds_read_b128 a[8:11], v16 offset:18432
    ds_read_b128 a[12:15], v16 offset:19456
    ds_read_b128 a[16:19], v16 offset:20480
    ds_read_b128 a[20:23], v16 offset:21504
    ds_read_b128 a[24:27], v16 offset:22528
    ds_read_b128 a[28:31], v16 offset:23552
    s_waitcnt lgkmcnt(0)
c4_26:
    s_cmp_ge_u32 s9, 2
    s_cbranch_scc1 cs_27
    s_waitcnt vmcnt(0)
    v_add_f32 v32, v32, v48
    v_add_f32 v33, v33, v49
    v_add_f32 v34, v34, v50
    v_add_f32 v35, v35, v51
    v_add_f32 v36, v36, v52
    v_add_f32 v37, v37, v53
    v_add_f32 v38, v38, v54
    v_add_f32 v39, v39, v55
    v_add_f32 v40, v40, v56
    v_add_f32 v41, v41, v57
    v_add_f32 v42, v42, v58
    v_add_f32 v43, v43, v59
cs_27:
    s_barrier
    s_cmp_ge_u32 s9, 2
    s_cbranch_scc1 cs_28
    v_add_f32 v44, v44, v60
    v_add_f32 v45, v45, v61
    v_add_f32 v46, v46, v62
    v_add_f32 v47, v47, v63
    v_add_f32 v32, v32, v40
    v_add_f32 v33, v33, v41
    v_add_f32 v34, v34, v42
    v_add_f32 v35, v35, v43
    v_add_f32 v36, v36, v44
    v_add_f32 v37, v37, v45
    v_add_f32 v38, v38, v46
    v_add_f32 v39, v39, v47
cs_28:
    s_barrier
    s_cmp_ge_u32 s9, 2
    s_cbranch_scc1 cs_29
    v_add_f32 v32, v32, v36
    v_add_f32 v33, v33, v37
    v_add_f32 v34, v34, v38
    v_add_f32 v35, v35, v39
    v_add_f32 v32, v32, v34
    v_add_f32 v33, v33, v35
    ds_write_b64 v12, v[32:33]
    s_waitcnt lgkmcnt(0)
cs_29:
    s_barrier
    s_barrier
    s_branch s_attn
.p2align 6
l_first:
    s_sub_u32 s51, s8, 5
    s_lshl_b32 s61, s51, 8
    s_add_u32 s61, s61, s2
    s_and_b32 s62, s61, 15
    s_lshr_b32 s63, s61, 4
    v_lshrrev_b32 v20, 3, v1
    v_mul_u32_u24 v12, 6144, v20
    v_and_b32 v21, 7, v1
    v_lshl_add_u32 v12, v21, 4, v12
    s_mov_b32 s20, s34
    s_mov_b32 s21, s35
    s_mov_b32 s22, 6291456
    s_mov_b32 s23, 0x00020000
    s_mov_b32 s28, s40
    s_mov_b32 s29, s41
    s_mov_b32 s30, 6291456
    s_mov_b32 s31, 0x00020000
    s_mul_i32 s52, s62, 393216
    s_lshl_b32 s56, s63, 7
    s_add_u32 s52, s52, s56
    s_barrier
    s_add_u32 s53, s52, 0
    buffer_load_dwordx4 v[160:163], v12, s[20:23], s53 offen nt
    s_add_u32 s53, s52, 49152
    buffer_load_dwordx4 v[164:167], v12, s[20:23], s53 offen nt
    s_add_u32 s53, s52, 98304
    buffer_load_dwordx4 v[168:171], v12, s[20:23], s53 offen nt
    s_add_u32 s53, s52, 147456
    buffer_load_dwordx4 v[172:175], v12, s[20:23], s53 offen nt
    v_lshlrev_b32 v14, 6, v20
    v_lshrrev_b32 v22, 5, v1
    v_bfe_u32 v23, v1, 1, 1
    v_xor_b32 v22, v22, v23
    v_lshl_add_u32 v14, v22, 5, v14
    v_and_b32 v22, 1, v1
    v_lshl_add_u32 v14, v22, 4, v14
    v_bfe_u32 v23, v1, 2, 1
    v_mul_u32_u24 v23, 196608, v23
    v_add_u32 v14, v14, v23
    v_lshlrev_b32 v22, 4, v22
    v_mov_b32 v23, 0x3f80
    v_lshlrev_b32 v23, v22, v23
    v_bfe_u32 v22, v1, 1, 3
    v_cmp_eq_u32 vcc, 0, v22
    s_nop 1
    v_cndmask_b32 v24, 0, v23, vcc
    v_cmp_eq_u32 vcc, 1, v22
    s_nop 1
    v_cndmask_b32 v25, 0, v23, vcc
    v_cmp_eq_u32 vcc, 2, v22
    s_nop 1
    v_cndmask_b32 v26, 0, v23, vcc
    v_cmp_eq_u32 vcc, 3, v22
    s_nop 1
    v_cndmask_b32 v27, 0, v23, vcc
    v_lshlrev_b32 v15, 5, v21
    v_and_b32 v22, 16, v1
    v_add_u32 v15, v15, v22
    v_lshlrev_b32 v16, 14, v1
    s_mov_b32 s9, 0
    s_lshr_b32 s55, s63, 4
    s_and_b32 s56, s63, 15
    s_lshl_b32 s57, s56, 4
    s_lshr_b32 s58, s62, 1
    s_add_u32 s57, s57, s58
    s_mul_i32 s57, s57, 3
    s_add_u32 s57, s57, s55
    s_lshl_b32 s57, s57, 13
    s_and_b32 s58, s62, 1
    s_lshl_b32 s58, s58, 12
    s_add_u32 s57, s57, s58
    s_add_u32 s57, s57, 50331648
    s_lshl_b32 s54, s61, 8
    s_add_u32 s54, s54, 63963136
    s_lshl_b32 s56, s56, 10
    s_lshl_b32 s55, s55, 7
    s_add_u32 s55, s55, s56
    s_lshl_b32 s56, s62, 2
    s_add_u32 s55, s55, s56
    s_add_u32 s55, s55, 64487424
    s_waitcnt vmcnt(3)
    s_add_u32 s53, s52, 196608
    buffer_load_dwordx4 v[176:179], v12, s[20:23], s53 offen nt
    s_add_u32 s53, s52, 245760
    buffer_load_dwordx4 v[180:183], v12, s[20:23], s53 offen nt
    s_add_u32 s53, s52, 294912
    buffer_load_dwordx4 v[184:187], v12, s[20:23], s53 offen nt
    buffer_store_dwordx4 v[160:163], v14, s[12:15], s57 offen offset:0 sc1
    v_mfma_f32_16x16x32_bf16 v[28:31], v[24:27], v[160:163], 0
    s_barrier
    s_waitcnt vmcnt(6)
    s_add_u32 s53, s52, 344064
    buffer_load_dwordx4 v[188:191], v12, s[20:23], s53 offen nt
    buffer_store_dwordx4 v[164:167], v14, s[12:15], s57 offen offset:512 sc1
    v_mfma_f32_16x16x32_bf16 v[28:31], v[24:27], v[164:167], v[28:31]
    s_waitcnt vmcnt(7)
    buffer_store_dwordx4 v[168:171], v14, s[12:15], s57 offen offset:1024 sc1
    v_mfma_f32_16x16x32_bf16 v[28:31], v[24:27], v[168:171], v[28:31]
    s_waitcnt vmcnt(7)
    buffer_store_dwordx4 v[172:175], v14, s[12:15], s57 offen offset:1536 sc1
    v_mfma_f32_16x16x32_bf16 v[28:31], v[24:27], v[172:175], v[28:31]
    s_waitcnt vmcnt(7)
    buffer_store_dwordx4 v[176:179], v14, s[12:15], s57 offen offset:2048 sc1
    v_mfma_f32_16x16x32_bf16 v[28:31], v[24:27], v[176:179], v[28:31]
    s_waitcnt vmcnt(7)
    buffer_store_dwordx4 v[180:183], v14, s[12:15], s57 offen offset:2560 sc1
    v_mfma_f32_16x16x32_bf16 v[28:31], v[24:27], v[180:183], v[28:31]
    s_waitcnt vmcnt(7)
    buffer_store_dwordx4 v[184:187], v14, s[12:15], s57 offen offset:3072 sc1
    v_mfma_f32_16x16x32_bf16 v[28:31], v[24:27], v[184:187], v[28:31]
    s_waitcnt vmcnt(6)
    buffer_store_dwordx4 v[188:191], v14, s[12:15], s57 offen offset:3584 sc1
    v_mfma_f32_16x16x32_bf16 v[28:31], v[24:27], v[188:191], v[28:31]
    s_nop 7
    v_add_f32_dpp v28, v28, v28 row_ror:8 row_mask:0xf bank_mask:0xf
    v_add_f32_dpp v29, v29, v29 row_ror:8 row_mask:0xf bank_mask:0xf
    v_add_f32_dpp v30, v30, v30 row_ror:8 row_mask:0xf bank_mask:0xf
    v_add_f32_dpp v31, v31, v31 row_ror:8 row_mask:0xf bank_mask:0xf
    s_mov_b64 exec, 0x00ff00ff
    buffer_store_dwordx4 v[28:31], v15, s[12:15], s54 offen sc1
    s_mov_b64 exec, -1
    s_add_u32 s57, s57, 6291456
    s_add_u32 s54, s54, 196608
    s_add_u32 s53, s52, 0
    buffer_load_dwordx4 v[192:195], v12, s[28:31], s53 offen nt
    s_add_u32 s53, s52, 49152
    buffer_load_dwordx4 v[196:199], v12, s[28:31], s53 offen nt
    s_add_u32 s53, s52, 98304
    buffer_load_dwordx4 v[200:203], v12, s[28:31], s53 offen nt
    s_add_u32 s53, s52, 147456
    buffer_load_dwordx4 v[204:207], v12, s[28:31], s53 offen nt
    s_add_u32 s53, s52, 196608
    buffer_load_dwordx4 v[208:211], v12, s[28:31], s53 offen nt
    s_add_u32 s53, s52, 245760
    buffer_load_dwordx4 v[212:215], v12, s[28:31], s53 offen nt
    s_add_u32 s53, s52, 294912
    buffer_load_dwordx4 v[216:219], v12, s[28:31], s53 offen nt
    s_add_u32 s53, s52, 344064
    buffer_load_dwordx4 v[220:223], v12, s[28:31], s53 offen nt
    v_mov_b32 v8, 159492
non_32:
    ds_read_b32 v9, v8
    s_waitcnt lgkmcnt(0)
    v_readfirstlane_b32 s10, v9
    s_cmp_eq_u32 s10, 0
    s_cbranch_scc1 non_32
    s_mov_b64 exec, 0xffff
    s_waitcnt vmcnt(8)
    buffer_store_dword v9, v16, s[12:15], s55 offen offset:0 sc1
    s_mov_b64 exec, -1
    s_mov_b32 s58, s52
    s_lshr_b32 s60, s2, 3
    s_mul_i32 s60, s60, 3
    s_lshr_b32 s60, s60, 5
    s_add_u32 s60, s60, 1
    s_branch l_qkv2
l_qkv:
    s_mov_b32 s60, 0
l_qkv2:
    v_and_b32 v1, 63, v0
    v_lshlrev_b32 v5, 4, v1
    s_sub_u32 s51, s8, 5
    s_lshl_b32 s48, s51, 13
    s_and_b32 s53, s9, 1
    s_lshl_b32 s52, s53, 4
    s_add_u32 s49, s7, s52
    s_lshl_b32 s49, s49, 1
    s_and_b32 s52, s6, 1
    s_add_u32 s49, s49, s52
    s_mul_i32 s49, s49, 196608
    s_add_u32 s49, s49, s48
    s_add_u32 s49, s49, 50331648
    v_mov_b32 v13, 159496
    s_mov_b32 s50, 0
    v_lshrrev_b32 v10, 2, v1
    v_and_b32 v11, 3, v1
    v_lshlrev_b32 v10, 8, v10
    v_lshl_add_u32 v10, v11, 4, v10
    v_lshlrev_b32 v7, 5, v11
    v_lshlrev_b32 v11, 2, v1
    v_add_u32 v11, 155648, v11
    s_lshr_b32 s59, s11, 2
    s_lshl_b32 s59, s59, 12
    s_and_b32 s3, s11, 3
    s_lshl_b32 s3, s3, 6
    s_add_u32 s59, s59, s3
    s_lshl_b32 s3, s9, 18
    s_add_u32 s59, s59, s3
    s_add_u32 s59, s59, 62914560
    s_lshl_b32 s56, s9, 15
    s_add_u32 s56, s56, 64749568
    v_mov_b32 v41, s10
    v_mov_b32 v43, s10
    v_mov_b32 v45, s10
    v_mov_b32 v47, s10
    v_and_b32 v6, 0xff, v5
    s_lshl_b32 s3, s7, 7
    v_lshrrev_b32 v20, 3, v1
    v_lshlrev_b32 v21, 11, v20
    v_lshrrev_b32 v22, 2, v1
    v_lshrrev_b32 v23, 4, v1
    v_xor_b32 v22, v22, v23
    v_and_b32 v22, 1, v22
    v_lshl_add_u32 v21, v22, 6, v21
    v_and_b32 v22, 3, v1
    v_lshl_add_u32 v21, v22, 4, v21
    v_add_u32 v17, s3, v21
    s_lshl_b32 s3, s51, 13
    s_add_u32 s3, s3, 73728
    v_add_u32 v3, s3, v5
    s_cmp_lg_u32 s9, 0
    s_cbranch_scc1 l_qkv_tiled
    s_lshl_b32 s53, s8, 7
    s_lshl_b32 s52, s11, 10
    s_add_u32 s53, s53, s52
    s_add_u32 s53, s53, 64486784
    s_add_u32 s96, s4, s53
    s_addc_u32 s97, s5, 0
    s_mov_b32 s98, s10
    s_mov_b32 s99, s10
    s_mov_b32 s3, 0x100000
poll_33:
    s_load_dwordx16 s[80:95], s[96:97], 0 glc
    s_sub_u32 s3, s3, 1
    s_cbranch_scc1 poll_33_ok
    s_waitcnt lgkmcnt(0)
    s_xor_b64 s[100:101], s[80:81], s[98:99]
    s_xor_b64 s[80:81], s[82:83], s[98:99]
    s_or_b64 s[100:101], s[100:101], s[80:81]
    s_xor_b64 s[80:81], s[84:85], s[98:99]
    s_or_b64 s[100:101], s[100:101], s[80:81]
    s_xor_b64 s[80:81], s[86:87], s[98:99]
    s_or_b64 s[100:101], s[100:101], s[80:81]
    s_xor_b64 s[80:81], s[88:89], s[98:99]
    s_or_b64 s[100:101], s[100:101], s[80:81]
    s_xor_b64 s[80:81], s[90:91], s[98:99]
    s_or_b64 s[100:101], s[100:101], s[80:81]
    s_xor_b64 s[80:81], s[92:93], s[98:99]
    s_or_b64 s[100:101], s[100:101], s[80:81]
    s_xor_b64 s[80:81], s[94:95], s[98:99]
    s_or_b64 s[100:101], s[100:101], s[80:81]
    s_cbranch_scc1 poll_33
poll_33_ok:
    s_waitcnt lgkmcnt(0)
    s_branch l_qkv_fill
l_qkv_tiled:
    s_barrier
    s_cmp_lt_u32 s9, 2
    s_cbranch_scc1 l_qkv_nocache
    s_bitcmp1_b32 s9, 0
    s_cbranch_scc1 l_qkv_c_b
    ds_write_b128 v3, v[64:67] offset:0
    ds_write_b128 v3, v[68:71] offset:1024
    ds_write_b128 v3, v[72:75] offset:2048
    ds_write_b128 v3, v[76:79] offset:3072
    ds_write_b128 v3, v[80:83] offset:4096
    ds_write_b128 v3, v[84:87] offset:5120
    ds_write_b128 v3, v[88:91] offset:6144
    ds_write_b128 v3, v[92:95] offset:7168
    ds_write_b128 v3, v[96:99] offset:24576
    ds_write_b128 v3, v[100:103] offset:25600
    ds_write_b128 v3, v[104:107] offset:26624
    ds_write_b128 v3, v[108:111] offset:27648
    ds_write_b128 v3, v[112:115] offset:28672
    ds_write_b128 v3, v[116:119] offset:29696
    ds_write_b128 v3, v[120:123] offset:30720
    ds_write_b128 v3, v[124:127] offset:31744
    ds_write_b128 v3, v[128:131] offset:49152
    ds_write_b128 v3, v[132:135] offset:50176
    ds_write_b128 v3, v[136:139] offset:51200
    ds_write_b128 v3, v[140:143] offset:52224
    ds_write_b128 v3, v[144:147] offset:53248
    ds_write_b128 v3, v[148:151] offset:54272
    ds_write_b128 v3, v[152:155] offset:55296
    ds_write_b128 v3, v[156:159] offset:56320
    s_branch l_qkv_c_w
l_qkv_c_b:
    ds_write_b128 v3, v[160:163] offset:0
    ds_write_b128 v3, v[164:167] offset:1024
    ds_write_b128 v3, v[168:171] offset:2048
    ds_write_b128 v3, v[172:175] offset:3072
    ds_write_b128 v3, v[176:179] offset:4096
    ds_write_b128 v3, v[180:183] offset:5120
    ds_write_b128 v3, v[184:187] offset:6144
    ds_write_b128 v3, v[188:191] offset:7168
    ds_write_b128 v3, v[192:195] offset:24576
    ds_write_b128 v3, v[196:199] offset:25600
    ds_write_b128 v3, v[200:203] offset:26624
    ds_write_b128 v3, v[204:207] offset:27648
    ds_write_b128 v3, v[208:211] offset:28672
    ds_write_b128 v3, v[212:215] offset:29696
    ds_write_b128 v3, v[216:219] offset:30720
    ds_write_b128 v3, v[220:223] offset:31744
    ds_write_b128 v3, a[0:3] offset:49152
    ds_write_b128 v3, a[4:7] offset:50176
    ds_write_b128 v3, a[8:11] offset:51200
    ds_write_b128 v3, a[12:15] offset:52224
    ds_write_b128 v3, a[16:19] offset:53248
    ds_write_b128 v3, a[20:23] offset:54272
    ds_write_b128 v3, a[24:27] offset:55296
    ds_write_b128 v3, a[28:31] offset:56320
l_qkv_c_w:
    s_waitcnt lgkmcnt(0)
    s_barrier
    s_mov_b32 m0, s48
    s_add_u32 s50, s50, 1
    buffer_load_dwordx4 v5, s[12:15], s49 offen offset:0 sc1 lds
    buffer_load_dwordx4 v5, s[12:15], s49 offen offset:1024 sc1 lds
    buffer_load_dwordx4 v5, s[12:15], s49 offen offset:2048 sc1 lds
    buffer_load_dwordx4 v5, s[12:15], s49 offen offset:3072 sc1 lds
    s_add_u32 s49, s49, 4096
    s_bitcmp1_b32 s50, 0
    s_cselect_b32 s3, 0, 16384
    s_add_u32 s48, s48, s3
    s_add_u32 s49, s49, s3
    s_cmp_eq_u32 s50, 12
    s_cselect_b32 s3, 4294819840, 0
    s_add_u32 s48, s48, 4096
    s_add_u32 s48, s48, s3
    s_mov_b32 m0, s48
    s_add_u32 s50, s50, 1
    buffer_load_dwordx4 v5, s[12:15], s49 offen offset:0 sc1 lds
    buffer_load_dwordx4 v5, s[12:15], s49 offen offset:1024 sc1 lds
    buffer_load_dwordx4 v5, s[12:15], s49 offen offset:2048 sc1 lds
    buffer_load_dwordx4 v5, s[12:15], s49 offen offset:3072 sc1 lds
    s_add_u32 s49, s49, 4096
    s_bitcmp1_b32 s50, 0
    s_cselect_b32 s3, 0, 16384
    s_add_u32 s48, s48, s3
    s_add_u32 s49, s49, s3
    s_cmp_eq_u32 s50, 12
    s_cselect_b32 s3, 4294819840, 0
    s_add_u32 s48, s48, 4096
    s_add_u32 s48, s48, s3
    s_mov_b32 m0, s48
    s_add_u32 s50, s50, 1
    buffer_load_dwordx4 v5, s[12:15], s49 offen offset:0 sc1 lds
    buffer_load_dwordx4 v5, s[12:15], s49 offen offset:1024 sc1 lds
    buffer_load_dwordx4 v5, s[12:15], s49 offen offset:2048 sc1 lds
    buffer_load_dwordx4 v5, s[12:15], s49 offen offset:3072 sc1 lds
    s_add_u32 s49, s49, 4096
    s_bitcmp1_b32 s50, 0
    s_cselect_b32 s3, 0, 16384
    s_add_u32 s48, s48, s3
    s_add_u32 s49, s49, s3
    s_cmp_eq_u32 s50, 12
    s_cselect_b32 s3, 4294819840, 0
    s_add_u32 s48, s48, 4096
    s_add_u32 s48, s48, s3
    s_mov_b32 m0, s48
    s_add_u32 s50, s50, 1
    buffer_load_dwordx4 v5, s[12:15], s49 offen offset:0 sc1 lds
    buffer_load_dwordx4 v5, s[12:15], s49 offen offset:1024 sc1 lds
    buffer_load_dwordx4 v5, s[12:15], s49 offen offset:2048 sc1 lds
    buffer_load_dwordx4 v5, s[12:15], s49 offen offset:3072 sc1 lds
    s_add_u32 s49, s49, 4096
    s_bitcmp1_b32 s50, 0
    s_cselect_b32 s3, 0, 16384
    s_add_u32 s48, s48, s3
    s_add_u32 s49, s49, s3
    s_cmp_eq_u32 s50, 12
    s_cselect_b32 s3, 4294819840, 0
    s_add_u32 s48, s48, 4096
    s_add_u32 s48, s48, s3
    s_mov_b32 s50, 12
    s_add_u32 s49, s49, 98304
    s_lshl_b32 s48, s51, 13
    s_waitcnt vmcnt(8)
    s_barrier
    s_waitcnt vmcnt(0)
    s_branch l_qkv_gone
l_qkv_nocache:
    s_barrier
l_qkv_fill:
    s_mov_b32 m0, s48
    s_add_u32 s50, s50, 1
    buffer_load_dwordx4 v5, s[12:15], s49 offen offset:0 sc1 lds
    buffer_load_dwordx4 v5, s[12:15], s49 offen offset:1024 sc1 lds
    buffer_load_dwordx4 v5, s[12:15], s49 offen offset:2048 sc1 lds
    buffer_load_dwordx4 v5, s[12:15], s49 offen offset:3072 sc1 lds
    s_add_u32 s49, s49, 4096
    s_bitcmp1_b32 s50, 0
    s_cselect_b32 s3, 0, 16384
    s_add_u32 s48, s48, s3
    s_add_u32 s49, s49, s3
    s_cmp_eq_u32 s50, 12
    s_cselect_b32 s3, 4294819840, 0
    s_add_u32 s48, s48, 4096
    s_add_u32 s48, s48, s3
l_qkv_fill1:
    s_mov_b32 m0, s48
    s_add_u32 s50, s50, 1
    buffer_load_dwordx4 v5, s[12:15], s49 offen offset:0 sc1 lds
    buffer_load_dwordx4 v5, s[12:15], s49 offen offset:1024 sc1 lds
    buffer_load_dwordx4 v5, s[12:15], s49 offen offset:2048 sc1 lds
    buffer_load_dwordx4 v5, s[12:15], s49 offen offset:3072 sc1 lds
    s_add_u32 s49, s49, 4096
    s_bitcmp1_b32 s50, 0
    s_cselect_b32 s3, 0, 16384
    s_add_u32 s48, s48, s3
    s_add_u32 s49, s49, s3
    s_cmp_eq_u32 s50, 12
    s_cselect_b32 s3, 4294819840, 0
    s_add_u32 s48, s48, 4096
    s_add_u32 s48, s48, s3
l_qkv_fill2:
    s_add_u32 s52, s9, 1
    s_mov_b32 m0, s48
    s_add_u32 s50, s50, 1
    buffer_load_dwordx4 v5, s[12:15], s49 offen offset:0 sc1 lds
    s_waitcnt vmcnt(10)
    buffer_load_dwordx4 v5, s[12:15], s49 offen offset:1024 sc1 lds
    s_waitcnt vmcnt(10)
    buffer_load_dwordx4 v5, s[12:15], s49 offen offset:2048 sc1 lds
    s_waitcnt vmcnt(10)
    buffer_load_dwordx4 v5, s[12:15], s49 offen offset:3072 sc1 lds
    s_waitcnt vmcnt(10)
    s_add_u32 s49, s49, 4096
    s_bitcmp1_b32 s50, 0
    s_cselect_b32 s3, 0, 16384
    s_add_u32 s48, s48, s3
    s_add_u32 s49, s49, s3
    s_cmp_eq_u32 s50, 12
    s_cselect_b32 s3, 4294819840, 0
    s_add_u32 s48, s48, 4096
    s_add_u32 s48, s48, s3
l_qkv_pre:
    s_mov_b32 m0, s48
    s_add_u32 s50, s50, 1
    buffer_load_dwordx4 v5, s[12:15], s49 offen offset:0 sc1 lds
    s_waitcnt vmcnt(10)
    buffer_load_dwordx4 v5, s[12:15], s49 offen offset:1024 sc1 lds
    s_waitcnt vmcnt(10)
    buffer_load_dwordx4 v5, s[12:15], s49 offen offset:2048 sc1 lds
    s_waitcnt vmcnt(10)
    buffer_load_dwordx4 v5, s[12:15], s49 offen offset:3072 sc1 lds
    s_waitcnt vmcnt(10)
    s_add_u32 s49, s49, 4096
    s_bitcmp1_b32 s50, 0
    s_cselect_b32 s3, 0, 16384
    s_add_u32 s48, s48, s3
    s_add_u32 s49, s49, s3
    s_cmp_eq_u32 s50, 12
    s_cselect_b32 s3, 4294819840, 0
    s_add_u32 s48, s48, 4096
    s_add_u32 s48, s48, s3
    ds_read_b32 v8, v13
    s_cmp_ge_u32 s50, 12
    s_cbranch_scc1 l_qkv_go
    s_waitcnt lgkmcnt(0)
    v_readfirstlane_b32 s3, v8
    s_cmp_lg_u32 s3, s52
    s_cbranch_scc1 l_qkv_pre
    s_cmp_ge_u32 s50, 5
    s_cbranch_scc1 l_qkv_go
    s_waitcnt vmcnt(8)
l_qkv_go:
    s_waitcnt lgkmcnt(0)
    s_barrier
l_qkv_gone:
    s_bitcmp0_b32 s50, 0
    s_cbranch_scc1 l_qkv_even
    s_mov_b32 m0, s48
    s_add_u32 s50, s50, 1
    buffer_load_dwordx4 v5, s[12:15], s49 offen offset:0 sc1 lds
    buffer_load_dwordx4 v5, s[12:15], s49 offen offset:1024 sc1 lds
    buffer_load_dwordx4 v5, s[12:15], s49 offen offset:2048 sc1 lds
    buffer_load_dwordx4 v5, s[12:15], s49 offen offset:3072 sc1 lds
    s_add_u32 s49, s49, 4096
    s_bitcmp1_b32 s50, 0
    s_cselect_b32 s3, 0, 16384
    s_add_u32 s48, s48, s3
    s_add_u32 s49, s49, s3
    s_cmp_eq_u32 s50, 12
    s_cselect_b32 s3, 4294819840, 0
    s_add_u32 s48, s48, 4096
    s_add_u32 s48, s48, s3
l_qkv_even:
    s_cmp_gt_u32 s50, 10
    s_cbranch_scc1 stg_34
    s_mov_b32 m0, s48
    s_add_u32 s50, s50, 1
    buffer_load_dwordx4 v5, s[12:15], s49 offen offset:0 sc1 lds
    buffer_load_dwordx4 v5, s[12:15], s49 offen offset:1024 sc1 lds
    buffer_load_dwordx4 v5, s[12:15], s49 offen offset:2048 sc1 lds
    buffer_load_dwordx4 v5, s[12:15], s49 offen offset:3072 sc1 lds
    s_add_u32 s49, s49, 4096
    s_bitcmp1_b32 s50, 0
    s_cselect_b32 s3, 0, 16384
    s_add_u32 s48, s48, s3
    s_add_u32 s49, s49, s3
    s_cmp_eq_u32 s50, 12
    s_cselect_b32 s3, 4294819840, 0
    s_add_u32 s48, s48, 4096
    s_add_u32 s48, s48, s3
    s_mov_b32 m0, s48
    s_add_u32 s50, s50, 1
    buffer_load_dwordx4 v5, s[12:15], s49 offen offset:0 sc1 lds
    buffer_load_dwordx4 v5, s[12:15], s49 offen offset:1024 sc1 lds
    buffer_load_dwordx4 v5, s[12:15], s49 offen offset:2048 sc1 lds
    buffer_load_dwordx4 v5, s[12:15], s49 offen offset:3072 sc1 lds
    s_add_u32 s49, s49, 4096
    s_bitcmp1_b32 s50, 0
    s_cselect_b32 s3, 0, 16384
    s_add_u32 s48, s48, s3
    s_add_u32 s49, s49, s3
    s_cmp_eq_u32 s50, 12
    s_cselect_b32 s3, 4294819840, 0
    s_add_u32 s48, s48, 4096
    s_add_u32 s48, s48, s3
stg_34:
    s_cmp_lg_u32 s51, 0
    s_cbranch_scc1 role_35
    buffer_load_dwordx4 v[32:35], v10, s[12:15], s59 offen sc1
role_35:
    s_waitcnt vmcnt(8)
    s_barrier
    s_waitcnt vmcnt(0)
    s_cmp_gt_u32 s50, 12
    s_cbranch_scc1 stg_36
    s_mov_b32 m0, s48
    s_add_u32 s50, s50, 1
    buffer_load_dwordx4 v5, s[12:15], s49 offen offset:0 sc1 lds
    buffer_load_dwordx4 v5, s[12:15], s49 offen offset:1024 sc1 lds
    buffer_load_dwordx4 v5, s[12:15], s49 offen offset:2048 sc1 lds
    buffer_load_dwordx4 v5, s[12:15], s49 offen offset:3072 sc1 lds
    s_add_u32 s49, s49, 4096
    s_bitcmp1_b32 s50, 0
    s_cselect_b32 s3, 0, 16384
    s_add_u32 s48, s48, s3
    s_add_u32 s49, s49, s3
    s_cmp_eq_u32 s50, 12
    s_cselect_b32 s3, 4294819840, 0
    s_add_u32 s48, s48, 4096
    s_add_u32 s48, s48, s3
    s_mov_b32 m0, s48
    s_add_u32 s50, s50, 1
    buffer_load_dwordx4 v5, s[12:15], s49 offen offset:0 sc1 lds
    buffer_load_dwordx4 v5, s[12:15], s49 offen offset:1024 sc1 lds
    buffer_load_dwordx4 v5, s[12:15], s49 offen offset:2048 sc1 lds
    buffer_load_dwordx4 v5, s[12:15], s49 offen offset:3072 sc1 lds
    s_add_u32 s49, s49, 4096
    s_bitcmp1_b32 s50, 0
    s_cselect_b32 s3, 0, 16384
    s_add_u32 s48, s48, s3
    s_add_u32 s49, s49, s3
    s_cmp_eq_u32 s50, 12
    s_cselect_b32 s3, 4294819840, 0
    s_add_u32 s48, s48, 4096
    s_add_u32 s48, s48, s3
stg_36:
    s_cmp_eq_u32 s60, 0
    s_cbranch_scc1 ub_37
    buffer_store_dwordx4 v[192:195], v14, s[12:15], s57 offen offset:0 sc1
    v_mfma_f32_16x16x32_bf16 v[28:31], v[24:27], v[192:195], 0
    buffer_store_dwordx4 v[196:199], v14, s[12:15], s57 offen offset:512 sc1
    v_mfma_f32_16x16x32_bf16 v[28:31], v[24:27], v[196:199], v[28:31]
ub_37:
    s_cmp_lg_u32 s51, 0
    s_cbranch_scc1 role_38
    v_add_f32_dpp v32, v32, v32 row_ror:4 row_mask:0xf bank_mask:0xf
    v_add_f32_dpp v33, v33, v33 row_ror:4 row_mask:0xf bank_mask:0xf
    v_add_f32_dpp v34, v34, v34 row_ror:4 row_mask:0xf bank_mask:0xf
    v_add_f32_dpp v35, v35, v35 row_ror:4 row_mask:0xf bank_mask:0xf
    v_add_f32_dpp v32, v32, v32 row_ror:8 row_mask:0xf bank_mask:0xf
    v_add_f32_dpp v33, v33, v33 row_ror:8 row_mask:0xf bank_mask:0xf
    v_add_f32_dpp v34, v34, v34 row_ror:8 row_mask:0xf bank_mask:0xf
    v_add_f32_dpp v35, v35, v35 row_ror:8 row_mask:0xf bank_mask:0xf
    v_mov_b32 v36, v32
    v_mov_b32 v37, v33
    v_mov_b32 v38, v34
    v_mov_b32 v39, v35
    v_permlane16_swap_b32 v32, v36
    v_permlane16_swap_b32 v33, v37
    v_permlane16_swap_b32 v34, v38
    v_permlane16_swap_b32 v35, v39
    v_add_f32 v32, v32, v36
    v_add_f32 v33, v33, v37
    v_add_f32 v34, v34, v38
    v_add_f32 v35, v35, v39
    v_mov_b32 v36, v32
    v_mov_b32 v37, v33
    v_mov_b32 v38, v34
    v_mov_b32 v39, v35
    v_permlane32_swap_b32 v32, v36
    v_permlane32_swap_b32 v33, v37
    v_permlane32_swap_b32 v34, v38
    v_permlane32_swap_b32 v35, v39
    v_add_f32 v40, v32, v36
    v_add_f32 v42, v33, v37
    v_add_f32 v44, v34, v38
    v_add_f32 v46, v35, v39
role_38:
    s_waitcnt vmcnt(8)
    s_barrier
    s_cmp_gt_u32 s50, 14
    s_cbranch_scc1 stg_39
    s_mov_b32 m0, s48
    s_add_u32 s50, s50, 1
    buffer_load_dwordx4 v5, s[12:15], s49 offen offset:0 sc1 lds
    buffer_load_dwordx4 v5, s[12:15], s49 offen offset:1024 sc1 lds
    buffer_load_dwordx4 v5, s[12:15], s49 offen offset:2048 sc1 lds
    buffer_load_dwordx4 v5, s[12:15], s49 offen offset:3072 sc1 lds
    s_add_u32 s49, s49, 4096
    s_bitcmp1_b32 s50, 0
    s_cselect_b32 s3, 0, 16384
    s_add_u32 s48, s48, s3
    s_add_u32 s49, s49, s3
    s_cmp_eq_u32 s50, 12
    s_cselect_b32 s3, 4294819840, 0
    s_add_u32 s48, s48, 4096
    s_add_u32 s48, s48, s3
    s_mov_b32 m0, s48
    s_add_u32 s50, s50, 1
    buffer_load_dwordx4 v5, s[12:15], s49 offen offset:0 sc1 lds
    buffer_load_dwordx4 v5, s[12:15], s49 offen offset:1024 sc1 lds
    buffer_load_dwordx4 v5, s[12:15], s49 offen offset:2048 sc1 lds
    buffer_load_dwordx4 v5, s[12:15], s49 offen offset:3072 sc1 lds
    s_add_u32 s49, s49, 4096
    s_bitcmp1_b32 s50, 0
    s_cselect_b32 s3, 0, 16384
    s_add_u32 s48, s48, s3
    s_add_u32 s49, s49, s3
    s_cmp_eq_u32 s50, 12
    s_cselect_b32 s3, 4294819840, 0
    s_add_u32 s48, s48, 4096
    s_add_u32 s48, s48, s3
stg_39:
    s_cmp_eq_u32 s60, 0
    s_cbranch_scc1 ub_40
    buffer_store_dwordx4 v[200:203], v14, s[12:15], s57 offen offset:1024 sc1
    v_mfma_f32_16x16x32_bf16 v[28:31], v[24:27], v[200:203], v[28:31]
    buffer_store_dwordx4 v[204:207], v14, s[12:15], s57 offen offset:1536 sc1
    v_mfma_f32_16x16x32_bf16 v[28:31], v[24:27], v[204:207], v[28:31]
ub_40:
    s_cmp_lg_u32 s51, 0
    s_cbranch_scc1 role_41
    v_mul_f32 v40, 0x3a800000, v40
    v_mul_f32 v44, 0x3a800000, v44
    v_mul_f32 v42, 0x3a800000, v42
    v_mul_f32 v46, 0x3a800000, v46
    v_fma_f32 v42, -v40, v40, v42
    v_fma_f32 v46, -v44, v44, v46
    v_max_f32 v42, 0, v42
    v_max_f32 v46, 0, v46
    v_add_f32 v42, 0x3727c5ac, v42
    v_add_f32 v46, 0x3727c5ac, v46
    v_rsq_f32 v42, v42
    v_rsq_f32 v46, v46
    s_lshl_b32 s3, s11, 7
    s_add_u32 s3, s3, s56
    s_mov_b64 exec, 0xf
    buffer_store_dwordx4 v[40:43], v7, s[12:15], s3 offen offset:0 sc1
    buffer_store_dwordx4 v[44:47], v7, s[12:15], s3 offen offset:16 sc1
    s_mov_b64 exec, -1
role_41:
    s_waitcnt vmcnt(8)
    s_barrier
    s_cmp_gt_u32 s50, 14
    s_cbranch_scc1 stg_42
    s_mov_b32 m0, s48
    s_add_u32 s50, s50, 1
    buffer_load_dwordx4 v5, s[12:15], s49 offen offset:0 sc1 lds
    buffer_load_dwordx4 v5, s[12:15], s49 offen offset:1024 sc1 lds
    buffer_load_dwordx4 v5, s[12:15], s49 offen offset:2048 sc1 lds
    buffer_load_dwordx4 v5, s[12:15], s49 offen offset:3072 sc1 lds
    s_add_u32 s49, s49, 4096
    s_bitcmp1_b32 s50, 0
    s_cselect_b32 s3, 0, 16384
    s_add_u32 s48, s48, s3
    s_add_u32 s49, s49, s3
    s_cmp_eq_u32 s50, 12
    s_cselect_b32 s3, 4294819840, 0
    s_add_u32 s48, s48, 4096
    s_add_u32 s48, s48, s3
    s_mov_b32 m0, s48
    s_add_u32 s50, s50, 1
    buffer_load_dwordx4 v5, s[12:15], s49 offen offset:0 sc1 lds
    buffer_load_dwordx4 v5, s[12:15], s49 offen offset:1024 sc1 lds
    buffer_load_dwordx4 v5, s[12:15], s49 offen offset:2048 sc1 lds
    buffer_load_dwordx4 v5, s[12:15], s49 offen offset:3072 sc1 lds
    s_add_u32 s49, s49, 4096
    s_bitcmp1_b32 s50, 0
    s_cselect_b32 s3, 0, 16384
    s_add_u32 s48, s48, s3
    s_add_u32 s49, s49, s3
    s_cmp_eq_u32 s50, 12
    s_cselect_b32 s3, 4294819840, 0
    s_add_u32 s48, s48, 4096
    s_add_u32 s48, s48, s3
stg_42:
    s_cmp_eq_u32 s60, 0
    s_cbranch_scc1 ub_43
    buffer_store_dwordx4 v[208:211], v14, s[12:15], s57 offen offset:2048 sc1
    v_mfma_f32_16x16x32_bf16 v[28:31], v[24:27], v[208:211], v[28:31]
    buffer_store_dwordx4 v[212:215], v14, s[12:15], s57 offen offset:2560 sc1
    v_mfma_f32_16x16x32_bf16 v[28:31], v[24:27], v[212:215], v[28:31]
ub_43:
    s_waitcnt vmcnt(8)
    s_barrier
    s_cmp_gt_u32 s50, 14
    s_cbranch_scc1 stg_44
    s_mov_b32 m0, s48
    s_add_u32 s50, s50, 1
    buffer_load_dwordx4 v5, s[12:15], s49 offen offset:0 sc1 lds
    buffer_load_dwordx4 v5, s[12:15], s49 offen offset:1024 sc1 lds
    buffer_load_dwordx4 v5, s[12:15], s49 offen offset:2048 sc1 lds
    buffer_load_dwordx4 v5, s[12:15], s49 offen offset:3072 sc1 lds
    s_add_u32 s49, s49, 4096
    s_bitcmp1_b32 s50, 0
    s_cselect_b32 s3, 0, 16384
    s_add_u32 s48, s48, s3
    s_add_u32 s49, s49, s3
    s_cmp_eq_u32 s50, 12
    s_cselect_b32 s3, 4294819840, 0
    s_add_u32 s48, s48, 4096
    s_add_u32 s48, s48, s3
    s_mov_b32 m0, s48
    s_add_u32 s50, s50, 1
    buffer_load_dwordx4 v5, s[12:15], s49 offen offset:0 sc1 lds
    buffer_load_dwordx4 v5, s[12:15], s49 offen offset:1024 sc1 lds
    buffer_load_dwordx4 v5, s[12:15], s49 offen offset:2048 sc1 lds
    buffer_load_dwordx4 v5, s[12:15], s49 offen offset:3072 sc1 lds
    s_add_u32 s49, s49, 4096
    s_bitcmp1_b32 s50, 0
    s_cselect_b32 s3, 0, 16384
    s_add_u32 s48, s48, s3
    s_add_u32 s49, s49, s3
    s_cmp_eq_u32 s50, 12
    s_cselect_b32 s3, 4294819840, 0
    s_add_u32 s48, s48, 4096
    s_add_u32 s48, s48, s3
stg_44:
    s_cmp_eq_u32 s60, 0
    s_cbranch_scc1 ub_45
    buffer_store_dwordx4 v[216:219], v14, s[12:15], s57 offen offset:3072 sc1
    v_mfma_f32_16x16x32_bf16 v[28:31], v[24:27], v[216:219], v[28:31]
    buffer_store_dwordx4 v[220:223], v14, s[12:15], s57 offen offset:3584 sc1
    v_mfma_f32_16x16x32_bf16 v[28:31], v[24:27], v[220:223], v[28:31]
ub_45:
    s_cmp_ge_u32 s9, 2
    s_cbranch_scc1 wc_46
    s_bitcmp1_b32 s9, 0
    s_cbranch_scc1 wc_46_b
    ds_read_b128 v[64:67], v3 offset:0
    ds_read_b128 v[68:71], v3 offset:1024
    ds_read_b128 v[72:75], v3 offset:2048
    ds_read_b128 v[76:79], v3 offset:3072
    ds_read_b128 v[80:83], v3 offset:4096
    ds_read_b128 v[84:87], v3 offset:5120
    ds_read_b128 v[88:91], v3 offset:6144
    ds_read_b128 v[92:95], v3 offset:7168
    s_branch wc_46_w
wc_46_b:
    ds_read_b128 v[160:163], v3 offset:0
    ds_read_b128 v[164:167], v3 offset:1024
    ds_read_b128 v[168:171], v3 offset:2048
    ds_read_b128 v[172:175], v3 offset:3072
    ds_read_b128 v[176:179], v3 offset:4096
    ds_read_b128 v[180:183], v3 offset:5120
    ds_read_b128 v[184:187], v3 offset:6144
    ds_read_b128 v[188:191], v3 offset:7168
wc_46_w:
    s_waitcnt lgkmcnt(0)
wc_46:
    s_cmp_lg_u32 s51, 1
    s_cbranch_scc1 role_47
    s_and_b32 s52, s11, 0xe0
    s_lshl_b32 s52, s52, 7
    s_add_u32 s52, s52, s56
    s_lshr_b32 s3, s6, 1
    s_min_u32 s3, s3, 1
    s_andn2_b32 s3, s3, s9
    s_lshl_b32 s3, s3, 8
    s_sub_u32 s53, s52, s3
    buffer_load_dwordx4 v[32:35], v5, s[12:15], s52 offen offset:0 sc1
    buffer_load_dwordx4 v[36:39], v5, s[12:15], s52 offen offset:1024 sc1
    buffer_load_dwordx4 v[40:43], v5, s[12:15], s52 offen offset:2048 sc1
    buffer_load_dwordx4 v[44:47], v5, s[12:15], s52 offen offset:3072 sc1
    buffer_load_dwordx4 v[48:51], v6, s[12:15], s53 offen sc1
role_47:
    s_waitcnt vmcnt(8)
    s_barrier
    s_waitcnt vmcnt(0)
    s_cmp_gt_u32 s50, 14
    s_cbranch_scc1 stg_48
    s_mov_b32 m0, s48
    s_add_u32 s50, s50, 1
    buffer_load_dwordx4 v5, s[12:15], s49 offen offset:0 sc1 lds
    buffer_load_dwordx4 v5, s[12:15], s49 offen offset:1024 sc1 lds
    buffer_load_dwordx4 v5, s[12:15], s49 offen offset:2048 sc1 lds
    buffer_load_dwordx4 v5, s[12:15], s49 offen offset:3072 sc1 lds
    s_add_u32 s49, s49, 4096
    s_bitcmp1_b32 s50, 0
    s_cselect_b32 s3, 0, 16384
    s_add_u32 s48, s48, s3
    s_add_u32 s49, s49, s3
    s_cmp_eq_u32 s50, 12
    s_cselect_b32 s3, 4294819840, 0
    s_add_u32 s48, s48, 4096
    s_add_u32 s48, s48, s3
    s_mov_b32 m0, s48
    s_add_u32 s50, s50, 1
    buffer_load_dwordx4 v5, s[12:15], s49 offen offset:0 sc1 lds
    buffer_load_dwordx4 v5, s[12:15], s49 offen offset:1024 sc1 lds
    buffer_load_dwordx4 v5, s[12:15], s49 offen offset:2048 sc1 lds
    buffer_load_dwordx4 v5, s[12:15], s49 offen offset:3072 sc1 lds
    s_add_u32 s49, s49, 4096
    s_bitcmp1_b32 s50, 0
    s_cselect_b32 s3, 0, 16384
    s_add_u32 s48, s48, s3
    s_add_u32 s49, s49, s3
    s_cmp_eq_u32 s50, 12
    s_cselect_b32 s3, 4294819840, 0
    s_add_u32 s48, s48, 4096
    s_add_u32 s48, s48, s3
stg_48:
    s_cmp_eq_u32 s60, 0
    s_cbranch_scc1 ub_49
    v_add_f32_dpp v28, v28, v28 row_ror:8 row_mask:0xf bank_mask:0xf
    v_add_f32_dpp v29, v29, v29 row_ror:8 row_mask:0xf bank_mask:0xf
    v_add_f32_dpp v30, v30, v30 row_ror:8 row_mask:0xf bank_mask:0xf
    v_add_f32_dpp v31, v31, v31 row_ror:8 row_mask:0xf bank_mask:0xf
    s_mov_b64 exec, 0x00ff00ff
    buffer_store_dwordx4 v[28:31], v15, s[12:15], s54 offen sc1
    s_mov_b64 exec, -1
ub_49:
    s_cmp_ge_u32 s9, 2
    s_cbranch_scc1 wc_50
    s_bitcmp1_b32 s9, 0
    s_cbranch_scc1 wc_50_b
    ds_read_b128 v[96:99], v3 offset:24576
    ds_read_b128 v[100:103], v3 offset:25600
    ds_read_b128 v[104:107], v3 offset:26624
    ds_read_b128 v[108:111], v3 offset:27648
    ds_read_b128 v[112:115], v3 offset:28672
    ds_read_b128 v[116:119], v3 offset:29696
    ds_read_b128 v[120:123], v3 offset:30720
    ds_read_b128 v[124:127], v3 offset:31744
    s_branch wc_50_w
wc_50_b:
    ds_read_b128 v[192:195], v3 offset:24576
    ds_read_b128 v[196:199], v3 offset:25600
    ds_read_b128 v[200:203], v3 offset:26624
    ds_read_b128 v[204:207], v3 offset:27648
    ds_read_b128 v[208:211], v3 offset:28672
    ds_read_b128 v[212:215], v3 offset:29696
    ds_read_b128 v[216:219], v3 offset:30720
    ds_read_b128 v[220:223], v3 offset:31744
wc_50_w:
    s_waitcnt lgkmcnt(0)
wc_50:
    s_cmp_lg_u32 s51, 1
    s_cbranch_scc1 role_51
    s_mov_b32 s3, 0x100000
l_st_chk:
    v_cmp_ne_u32 s[64:65], s10, v33
    v_cmp_ne_u32 vcc, s10, v35
    s_or_b64 s[64:65], s[64:65], vcc
    v_cmp_ne_u32 vcc, s10, v37
    s_or_b64 s[64:65], s[64:65], vcc
    v_cmp_ne_u32 vcc, s10, v39
    s_or_b64 s[64:65], s[64:65], vcc
    v_cmp_ne_u32 vcc, s10, v41
    s_or_b64 s[64:65], s[64:65], vcc
    v_cmp_ne_u32 vcc, s10, v43
    s_or_b64 s[64:65], s[64:65], vcc
    v_cmp_ne_u32 vcc, s10, v45
    s_or_b64 s[64:65], s[64:65], vcc
    v_cmp_ne_u32 vcc, s10, v47
    s_or_b64 s[64:65], s[64:65], vcc
    v_cmp_ne_u32 vcc, s10, v49
    s_or_b64 s[64:65], s[64:65], vcc
    v_cmp_ne_u32 vcc, s10, v51
    s_or_b64 s[64:65], s[64:65], vcc
    s_cbranch_scc0 l_st_ok
    s_sub_u32 s3, s3, 1
    s_cbranch_scc0 l_st_again
l_st_ok:
    ds_write_b32 v11, v32 offset:1280
    ds_write_b32 v11, v34 offset:2816
    ds_write_b32 v11, v36 offset:1536
    ds_write_b32 v11, v38 offset:3072
    ds_write_b32 v11, v40 offset:1792
    ds_write_b32 v11, v42 offset:3328
    ds_write_b32 v11, v44 offset:2048
    ds_write_b32 v11, v46 offset:3584
    s_mov_b64 exec, 0xffff
    ds_write_b32 v11, v48 offset:1216
    ds_write_b32 v11, v50 offset:2752
    s_mov_b64 exec, -1
    s_waitcnt lgkmcnt(0)
role_51:
    s_waitcnt vmcnt(8)
    s_barrier
    s_cmp_eq_u32 s60, 0
    s_cbranch_scc1 ub_52
    s_waitcnt vmcnt(0)
    s_mov_b64 exec, 0xffff
    buffer_store_dword v9, v16, s[12:15], s55 offen offset:384 sc1
    s_mov_b64 exec, -1
ub_52:
    s_cmp_ge_u32 s9, 2
    s_cbranch_scc1 wc_53
    s_bitcmp1_b32 s9, 0
    s_cbranch_scc1 wc_53_b
    ds_read_b128 v[128:131], v3 offset:49152
    ds_read_b128 v[132:135], v3 offset:50176
    ds_read_b128 v[136:139], v3 offset:51200
    ds_read_b128 v[140:143], v3 offset:52224
    ds_read_b128 v[144:147], v3 offset:53248
    ds_read_b128 v[148:151], v3 offset:54272
    ds_read_b128 v[152:155], v3 offset:55296
    ds_read_b128 v[156:159], v3 offset:56320
    s_branch wc_53_w
wc_53_b:
    ds_read_b128 a[0:3], v3 offset:49152
    ds_read_b128 a[4:7], v3 offset:50176
    ds_read_b128 a[8:11], v3 offset:51200
    ds_read_b128 a[12:15], v3 offset:52224
    ds_read_b128 a[16:19], v3 offset:53248
    ds_read_b128 a[20:23], v3 offset:54272
    ds_read_b128 a[24:27], v3 offset:55296
    ds_read_b128 a[28:31], v3 offset:56320
wc_53_w:
    s_waitcnt lgkmcnt(0)
wc_53:
    s_waitcnt vmcnt(0)
    s_barrier
    s_add_u32 s60, s51, 48
    s_bitcmp1_b32 s9, 0
    s_cbranch_scc1 l_qkv_now6
    s_mov_b32 s24, s36
    s_mov_b32 s25, s37
    s_mov_b32 s26, 2097152
    s_mov_b32 s27, 0x00020000
wop_54:
    s_lshl_b32 m0, s60, 10
    s_lshl_b32 s3, s60, 14
    buffer_load_dwordx4 v17, s[24:27], s3 offen lds
    s_add_u32 s60, s60, 3
    s_waitcnt vmcnt(7)
    s_cmp_lt_u32 s60, 96
    s_cbranch_scc1 wop_54
l_qkv_now6:
    s_barrier
    s_bitcmp1_b32 s9, 0
    s_cbranch_scc1 s_attn
    s_mov_b32 s24, s36
    s_mov_b32 s25, s37
    s_mov_b32 s26, 2097152
    s_mov_b32 s27, 0x00020000
wop_55:
    s_lshl_b32 m0, s60, 10
    s_lshl_b32 s3, s60, 14
    buffer_load_dwordx4 v17, s[24:27], s3 offen lds
    s_add_u32 s60, s60, 3
    s_waitcnt vmcnt(7)
    s_cmp_lt_u32 s60, 128
    s_cbranch_scc1 wop_55
    s_mov_b32 s60, s51
wop_56:
    s_lshl_b32 m0, s60, 10
    s_lshl_b32 s3, s60, 14
    buffer_load_dwordx4 v17, s[24:27], s3 offen lds
    s_add_u32 s60, s60, 3
    s_waitcnt vmcnt(7)
    s_cmp_lt_u32 s60, 12
    s_cbranch_scc1 wop_56
    s_barrier
wop_57:
    s_lshl_b32 m0, s60, 10
    s_lshl_b32 s3, s60, 14
    buffer_load_dwordx4 v17, s[24:27], s3 offen lds
    s_add_u32 s60, s60, 3
    s_waitcnt vmcnt(7)
    s_cmp_lt_u32 s60, 48
    s_cbranch_scc1 wop_57
    s_branch l_wo
l_st_again:
    buffer_load_dwordx4 v[32:35], v5, s[12:15], s52 offen offset:0 sc1
    buffer_load_dwordx4 v[36:39], v5, s[12:15], s52 offen offset:1024 sc1
    buffer_load_dwordx4 v[40:43], v5, s[12:15], s52 offen offset:2048 sc1
    buffer_load_dwordx4 v[44:47], v5, s[12:15], s52 offen offset:3072 sc1
    buffer_load_dwordx4 v[48:51], v6, s[12:15], s53 offen sc1
    s_waitcnt vmcnt(0)
    s_branch l_st_chk
.p2align 6
h_wo:
l_wo:
    s_mul_i32 s98, s9, 786432
    s_add_u32 s98, s98, 65798144
    s_lshl_b32 s99, s11, 10
    s_add_u32 s98, s98, s99
    s_add_u32 s96, s4, s98
    s_addc_u32 s97, s5, 0
    s_mov_b32 s98, s10
    s_mov_b32 s99, s10
    s_sub_u32 s59, s8, 4
    s_lshl_b32 s60, s59, 7
    s_add_u32 s96, s96, s60
    s_addc_u32 s97, s97, 0
    s_lshl_b32 s60, s9, 2
    s_add_u32 s60, s60, 159504
    v_mov_b32 v10, s60
    s_lshl_b32 s60, 1, s59
    v_mov_b32 v11, s60
    v_lshlrev_b32 v13, 4, v11
    s_mov_b64 exec, 1
    s_waitcnt vmcnt(0)
    ds_or_b32 v10, v13
    s_mov_b32 s3, 0x100000
poll_58:
    s_load_dwordx8 s[88:95], s[96:97], 0 glc
    s_sub_u32 s3, s3, 1
    s_cbranch_scc1 poll_58_ok
    s_waitcnt lgkmcnt(0)
    s_xor_b64 s[100:101], s[88:89], s[98:99]
    s_xor_b64 s[88:89], s[90:91], s[98:99]
    s_or_b64 s[100:101], s[100:101], s[88:89]
    s_xor_b64 s[88:89], s[92:93], s[98:99]
    s_or_b64 s[100:101], s[100:101], s[88:89]
    s_xor_b64 s[88:89], s[94:95], s[98:99]
    s_or_b64 s[100:101], s[100:101], s[88:89]
    s_cbranch_scc1 poll_58
poll_58_ok:
    s_waitcnt lgkmcnt(0)
    ds_or_b32 v10, v11
    s_mov_b64 exec, -1
    s_setprio 0
    s_waitcnt lgkmcnt(0)
    s_cmp_eq_u32 s8, 4
    s_cbranch_scc1 l_wo_end
    s_cmp_lg_u32 s9, 0
    s_cbranch_scc1 l_wo_end
    s_lshl_b32 s53, s8, 7
    s_lshl_b32 s52, s11, 10
    s_add_u32 s53, s53, s52
    s_add_u32 s53, s53, 64487168
    s_add_u32 s96, s4, s53
    s_addc_u32 s97, s5, 0
    s_mov_b32 s98, s10
    s_mov_b32 s99, s10
    s_mov_b32 s3, 0x100000
poll_59:
    s_load_dwordx16 s[80:95], s[96:97], 0 glc
    s_sub_u32 s3, s3, 1
    s_cbranch_scc1 poll_59_ok
    s_waitcnt lgkmcnt(0)
    s_xor_b64 s[100:101], s[80:81], s[98:99]
    s_xor_b64 s[80:81], s[82:83], s[98:99]
    s_or_b64 s[100:101], s[100:101], s[80:81]
    s_xor_b64 s[80:81], s[84:85], s[98:99]
    s_or_b64 s[100:101], s[100:101], s[80:81]
    s_xor_b64 s[80:81], s[86:87], s[98:99]
    s_or_b64 s[100:101], s[100:101], s[80:81]
    s_xor_b64 s[80:81], s[88:89], s[98:99]
    s_or_b64 s[100:101], s[100:101], s[80:81]
    s_xor_b64 s[80:81], s[90:91], s[98:99]
    s_or_b64 s[100:101], s[100:101], s[80:81]
    s_xor_b64 s[80:81], s[92:93], s[98:99]
    s_or_b64 s[100:101], s[100:101], s[80:81]
    s_xor_b64 s[80:81], s[94:95], s[98:99]
    s_or_b64 s[100:101], s[100:101], s[80:81]
    s_cbranch_scc1 poll_59
poll_59_ok:
    s_waitcnt lgkmcnt(0)
l_wo_end:
    s_add_u32 s9, s9, 1
    s_cmp_lg_u32 s9, 4
    s_cbranch_scc1 l_wo_next
    s_barrier
    s_branch k_exit
l_wo_next:
    s_cmp_lg_u32 s8, 4
    s_cbranch_scc1 l_qkv
    s_cmp_eq_u32 s9, 2
    s_cbranch_scc1 h_qkvA
    s_branch h_qkvB
.p2align 6
s_attn:
    s_sub_u32 s48, s8, 4
    s_lshl_b32 s3, s7, 7
    v_lshrrev_b32 v20, 3, v1
    v_lshlrev_b32 v21, 11, v20
    v_lshrrev_b32 v22, 2, v1
    v_lshrrev_b32 v23, 4, v1
    v_xor_b32 v22, v22, v23
    v_and_b32 v22, 1, v22
    v_lshl_add_u32 v21, v22, 6, v21
    v_and_b32 v22, 3, v1
    v_lshl_add_u32 v21, v22, 4, v21
    v_add_u32 v7, s3, v21
    s_mov_b32 s24, s42
    s_mov_b32 s25, s43
    s_mov_b32 s26, 2097152
    s_mov_b32 s27, 0x00020000
    s_lshr_b32 s49, s9, 1
    s_lshl_b32 s49, s49, 23
    s_lshl_b32 s52, s7, 19
    s_add_u32 s49, s49, s52
    s_and_b32 s52, s6, 1
    s_lshl_b32 s52, s52, 18
    s_add_u32 s49, s49, s52
    s_add_u32 s49, s49, 33554432
    s_lshr_b32 s61, s6, 1
    s_mul_i32 s54, s9, 786432
    s_add_u32 s54, s54, 66322432
    s_lshl_b32 s55, s11, 10
    s_add_u32 s54, s54, s55
    s_add_u32 s52, s4, s54
    s_addc_u32 s53, s5, 0
    s_mov_b32 s54, s10
    s_mov_b32 s55, s10
    s_lshl_b32 s51, s48, 11
    s_add_u32 s49, s49, s51
    s_add_u32 s51, s51, 81920
    s_mov_b32 s60, s48
    s_setprio 3
    s_barrier
    s_lshl_b32 s58, 1, s61
    s_mov_b32 s57, 0
    s_add_u32 s62, s61, 1
    s_and_b32 s62, s62, 7
    s_lshl_b32 s50, s62, 15
    s_add_u32 s50, s50, s49
    s_lshr_b32 s63, s62, 1
    s_lshl_b32 s63, s63, 7
    s_and_b32 s62, s62, 1
    s_lshl_b32 s62, s62, 4
    s_add_u32 s62, s62, s63
    s_mov_b32 s58, 0x100000
need_60:
    s_load_dwordx4 s[64:67], s[52:53], s62 glc
    s_sub_u32 s58, s58, 1
    s_cbranch_scc1 need_60_ok
    s_waitcnt lgkmcnt(0)
need_60_t:
    s_cmp_ge_u32 s48, 2
    s_cselect_b32 s63, s65, s64
    s_cmp_lg_u32 s63, s10
    s_cbranch_scc1 need_60
need_60_ok:
    s_waitcnt lgkmcnt(0)
    s_add_u32 m0, s51, 32768
    s_nop 0
    buffer_load_dwordx4 v5, s[12:15], s50 offen offset:0 sc1 lds
    buffer_load_dwordx4 v5, s[12:15], s50 offen offset:1024 sc1 lds
    s_add_u32 s50, s50, 8192
    s_add_u32 m0, s51, 40960
    s_nop 0
    buffer_load_dwordx4 v5, s[12:15], s50 offen offset:0 sc1 lds
    buffer_load_dwordx4 v5, s[12:15], s50 offen offset:1024 sc1 lds
    s_add_u32 s50, s50, 8192
    s_branch need_61_t
need_61:
    s_load_dwordx4 s[64:67], s[52:53], s62 glc
    s_sub_u32 s58, s58, 1
    s_cbranch_scc1 need_61_ok
    s_waitcnt lgkmcnt(0)
need_61_t:
    s_cmp_ge_u32 s48, 2
    s_cselect_b32 s63, s67, s66
    s_cmp_lg_u32 s63, s10
    s_cbranch_scc1 need_61
need_61_ok:
    s_waitcnt lgkmcnt(0)
    s_add_u32 m0, s51, 49152
    s_nop 0
    buffer_load_dwordx4 v5, s[12:15], s50 offen offset:0 sc1 lds
    buffer_load_dwordx4 v5, s[12:15], s50 offen offset:1024 sc1 lds
    s_add_u32 s50, s50, 8192
    s_add_u32 m0, s51, 57344
    s_nop 0
    buffer_load_dwordx4 v5, s[12:15], s50 offen offset:0 sc1 lds
    buffer_load_dwordx4 v5, s[12:15], s50 offen offset:1024 sc1 lds
    s_add_u32 s50, s50, 8192
    s_waitcnt vmcnt(4)
    s_barrier
    s_add_u32 s62, s61, 2
    s_and_b32 s62, s62, 7
    s_lshl_b32 s50, s62, 15
    s_add_u32 s50, s50, s49
    s_lshr_b32 s63, s62, 1
    s_lshl_b32 s63, s63, 7
    s_and_b32 s62, s62, 1
    s_lshl_b32 s62, s62, 4
    s_add_u32 s62, s62, s63
    s_mov_b32 s58, 0x100000
need_62:
    s_load_dwordx4 s[64:67], s[52:53], s62 glc
    s_sub_u32 s58, s58, 1
    s_cbranch_scc1 need_62_ok
    s_waitcnt lgkmcnt(0)
need_62_t:
    s_cmp_ge_u32 s48, 2
    s_cselect_b32 s63, s65, s64
    s_cmp_lg_u32 s63, s10
    s_cbranch_scc1 need_62
need_62_ok:
    s_waitcnt lgkmcnt(0)
    s_add_u32 m0, s51, 0
    s_nop 0
    buffer_load_dwordx4 v5, s[12:15], s50 offen offset:0 sc1 lds
    buffer_load_dwordx4 v5, s[12:15], s50 offen offset:1024 sc1 lds
    s_add_u32 s50, s50, 8192
    s_add_u32 m0, s51, 8192
    s_nop 0
    buffer_load_dwordx4 v5, s[12:15], s50 offen offset:0 sc1 lds
    buffer_load_dwordx4 v5, s[12:15], s50 offen offset:1024 sc1 lds
    s_add_u32 s50, s50, 8192
    s_waitcnt vmcnt(4)
    s_barrier
    s_branch need_63_t
need_63:
    s_load_dwordx4 s[64:67], s[52:53], s62 glc
    s_sub_u32 s58, s58, 1
    s_cbranch_scc1 need_63_ok
    s_waitcnt lgkmcnt(0)
need_63_t:
    s_cmp_ge_u32 s48, 2
    s_cselect_b32 s63, s67, s66
    s_cmp_lg_u32 s63, s10
    s_cbranch_scc1 need_63
need_63_ok:
    s_waitcnt lgkmcnt(0)
    s_add_u32 m0, s51, 16384
    s_nop 0
    buffer_load_dwordx4 v5, s[12:15], s50 offen offset:0 sc1 lds
    buffer_load_dwordx4 v5, s[12:15], s50 offen offset:1024 sc1 lds
    s_add_u32 s50, s50, 8192
    s_add_u32 m0, s51, 24576
    s_nop 0
    buffer_load_dwordx4 v5, s[12:15], s50 offen offset:0 sc1 lds
    buffer_load_dwordx4 v5, s[12:15], s50 offen offset:1024 sc1 lds
    s_add_u32 s50, s50, 8192
    s_waitcnt vmcnt(4)
    s_barrier
    s_add_u32 s62, s61, 3
    s_and_b32 s62, s62, 7
    s_lshl_b32 s50, s62, 15
    s_add_u32 s50, s50, s49
    s_lshr_b32 s63, s62, 1
    s_lshl_b32 s63, s63, 7
    s_and_b32 s62, s62, 1
    s_lshl_b32 s62, s62, 4
    s_add_u32 s62, s62, s63
    s_mov_b32 s58, 0x100000
need_64:
    s_load_dwordx4 s[64:67], s[52:53], s62 glc
    s_sub_u32 s58, s58, 1
    s_cbranch_scc1 need_64_ok
    s_waitcnt lgkmcnt(0)
need_64_t:
    s_cmp_ge_u32 s48, 2
    s_cselect_b32 s63, s65, s64
    s_cmp_lg_u32 s63, s10
    s_cbranch_scc1 need_64
need_64_ok:
    s_waitcnt lgkmcnt(0)
    s_add_u32 m0, s51, 32768
    s_nop 0
    buffer_load_dwordx4 v5, s[12:15], s50 offen offset:0 sc1 lds
    buffer_load_dwordx4 v5, s[12:15], s50 offen offset:1024 sc1 lds
    s_add_u32 s50, s50, 8192
    s_add_u32 m0, s51, 40960
    s_nop 0
    buffer_load_dwordx4 v5, s[12:15], s50 offen offset:0 sc1 lds
    buffer_load_dwordx4 v5, s[12:15], s50 offen offset:1024 sc1 lds
    s_add_u32 s50, s50, 8192
    s_lshl_b32 m0, s60, 10
    s_lshl_b32 s3, s60, 14
    buffer_load_dwordx4 v7, s[24:27], s3 offen lds
    s_add_u32 s60, s60, 4
    s_lshl_b32 m0, s60, 10
    s_lshl_b32 s3, s60, 14
    buffer_load_dwordx4 v7, s[24:27], s3 offen lds
    s_add_u32 s60, s60, 4
    s_waitcnt vmcnt(6)
    s_barrier
    s_branch need_65_t
need_65:
    s_load_dwordx4 s[64:67], s[52:53], s62 glc
    s_sub_u32 s58, s58, 1
    s_cbranch_scc1 need_65_ok
    s_waitcnt lgkmcnt(0)
need_65_t:
    s_cmp_ge_u32 s48, 2
    s_cselect_b32 s63, s67, s66
    s_cmp_lg_u32 s63, s10
    s_cbranch_scc1 need_65
need_65_ok:
    s_waitcnt lgkmcnt(0)
    s_add_u32 m0, s51, 49152
    s_nop 0
    buffer_load_dwordx4 v5, s[12:15], s50 offen offset:0 sc1 lds
    buffer_load_dwordx4 v5, s[12:15], s50 offen offset:1024 sc1 lds
    s_add_u32 s50, s50, 8192
    s_add_u32 m0, s51, 57344
    s_nop 0
    buffer_load_dwordx4 v5, s[12:15], s50 offen offset:0 sc1 lds
    buffer_load_dwordx4 v5, s[12:15], s50 offen offset:1024 sc1 lds
    s_add_u32 s50, s50, 8192
    s_lshl_b32 m0, s60, 10
    s_lshl_b32 s3, s60, 14
    buffer_load_dwordx4 v7, s[24:27], s3 offen lds
    s_add_u32 s60, s60, 4
    s_lshl_b32 m0, s60, 10
    s_lshl_b32 s3, s60, 14
    buffer_load_dwordx4 v7, s[24:27], s3 offen lds
    s_add_u32 s60, s60, 4
    s_waitcnt vmcnt(8)
    s_barrier
    s_add_u32 s62, s61, 4
    s_and_b32 s62, s62, 7
    s_lshl_b32 s50, s62, 15
    s_add_u32 s50, s50, s49
    s_lshr_b32 s63, s62, 1
    s_lshl_b32 s63, s63, 7
    s_and_b32 s62, s62, 1
    s_lshl_b32 s62, s62, 4
    s_add_u32 s62, s62, s63
    s_mov_b32 s58, 0x100000
need_66:
    s_load_dwordx4 s[64:67], s[52:53], s62 glc
    s_sub_u32 s58, s58, 1
    s_cbranch_scc1 need_66_ok
    s_waitcnt lgkmcnt(0)
need_66_t:
    s_cmp_ge_u32 s48, 2
    s_cselect_b32 s63, s65, s64
    s_cmp_lg_u32 s63, s10
    s_cbranch_scc1 need_66
need_66_ok:
    s_waitcnt lgkmcnt(0)
    s_add_u32 m0, s51, 0
    s_nop 0
    buffer_load_dwordx4 v5, s[12:15], s50 offen offset:0 sc1 lds
    buffer_load_dwordx4 v5, s[12:15], s50 offen offset:1024 sc1 lds
    s_add_u32 s50, s50, 8192
    s_add_u32 m0, s51, 8192
    s_nop 0
    buffer_load_dwordx4 v5, s[12:15], s50 offen offset:0 sc1 lds
    buffer_load_dwordx4 v5, s[12:15], s50 offen offset:1024 sc1 lds
    s_add_u32 s50, s50, 8192
    s_lshl_b32 m0, s60, 10
    s_lshl_b32 s3, s60, 14
    buffer_load_dwordx4 v7, s[24:27], s3 offen lds
    s_add_u32 s60, s60, 4
    s_lshl_b32 m0, s60, 10
    s_lshl_b32 s3, s60, 14
    buffer_load_dwordx4 v7, s[24:27], s3 offen lds
    s_add_u32 s60, s60, 4
    s_waitcnt vmcnt(8)
    s_barrier
    s_branch need_67_t
need_67:
    s_load_dwordx4 s[64:67], s[52:53], s62 glc
    s_sub_u32 s58, s58, 1
    s_cbranch_scc1 need_67_ok
    s_waitcnt lgkmcnt(0)
need_67_t:
    s_cmp_ge_u32 s48, 2
    s_cselect_b32 s63, s67, s66
    s_cmp_lg_u32 s63, s10
    s_cbranch_scc1 need_67
need_67_ok:
    s_waitcnt lgkmcnt(0)
    s_add_u32 m0, s51, 16384
    s_nop 0
    buffer_load_dwordx4 v5, s[12:15], s50 offen offset:0 sc1 lds
    buffer_load_dwordx4 v5, s[12:15], s50 offen offset:1024 sc1 lds
    s_add_u32 s50, s50, 8192
    s_add_u32 m0, s51, 24576
    s_nop 0
    buffer_load_dwordx4 v5, s[12:15], s50 offen offset:0 sc1 lds
    buffer_load_dwordx4 v5, s[12:15], s50 offen offset:1024 sc1 lds
    s_add_u32 s50, s50, 8192
    s_lshl_b32 m0, s60, 10
    s_lshl_b32 s3, s60, 14
    buffer_load_dwordx4 v7, s[24:27], s3 offen lds
    s_add_u32 s60, s60, 4
    s_lshl_b32 m0, s60, 10
    s_lshl_b32 s3, s60, 14
    buffer_load_dwordx4 v7, s[24:27], s3 offen lds
    s_add_u32 s60, s60, 4
    s_waitcnt vmcnt(8)
    s_barrier
    s_add_u32 s62, s61, 5
    s_and_b32 s62, s62, 7
    s_lshl_b32 s50, s62, 15
    s_add_u32 s50, s50, s49
    s_lshr_b32 s63, s62, 1
    s_lshl_b32 s63, s63, 7
    s_and_b32 s62, s62, 1
    s_lshl_b32 s62, s62, 4
    s_add_u32 s62, s62, s63
    s_mov_b32 s58, 0x100000
need_68:
    s_load_dwordx4 s[64:67], s[52:53], s62 glc
    s_sub_u32 s58, s58, 1
    s_cbranch_scc1 need_68_ok
    s_waitcnt lgkmcnt(0)
need_68_t:
    s_cmp_ge_u32 s48, 2
    s_cselect_b32 s63, s65, s64
    s_cmp_lg_u32 s63, s10
    s_cbranch_scc1 need_68
need_68_ok:
    s_waitcnt lgkmcnt(0)
    s_add_u32 m0, s51, 32768
    s_nop 0
    buffer_load_dwordx4 v5, s[12:15], s50 offen offset:0 sc1 lds
    buffer_load_dwordx4 v5, s[12:15], s50 offen offset:1024 sc1 lds
    s_add_u32 s50, s50, 8192
    s_add_u32 m0, s51, 40960
    s_nop 0
    buffer_load_dwordx4 v5, s[12:15], s50 offen offset:0 sc1 lds
    buffer_load_dwordx4 v5, s[12:15], s50 offen offset:1024 sc1 lds
    s_add_u32 s50, s50, 8192
    s_lshl_b32 m0, s60, 10
    s_lshl_b32 s3, s60, 14
    buffer_load_dwordx4 v7, s[24:27], s3 offen lds
    s_add_u32 s60, s60, 4
    s_lshl_b32 m0, s60, 10
    s_lshl_b32 s3, s60, 14
    buffer_load_dwordx4 v7, s[24:27], s3 offen lds
    s_add_u32 s60, s60, 4
    s_waitcnt vmcnt(8)
    s_barrier
    s_branch need_69_t
need_69:
    s_load_dwordx4 s[64:67], s[52:53], s62 glc
    s_sub_u32 s58, s58, 1
    s_cbranch_scc1 need_69_ok
    s_waitcnt lgkmcnt(0)
need_69_t:
    s_cmp_ge_u32 s48, 2
    s_cselect_b32 s63, s67, s66
    s_cmp_lg_u32 s63, s10
    s_cbranch_scc1 need_69
need_69_ok:
    s_waitcnt lgkmcnt(0)
    s_add_u32 m0, s51, 49152
    s_nop 0
    buffer_load_dwordx4 v5, s[12:15], s50 offen offset:0 sc1 lds
    buffer_load_dwordx4 v5, s[12:15], s50 offen offset:1024 sc1 lds
    s_add_u32 s50, s50, 8192
    s_add_u32 m0, s51, 57344
    s_nop 0
    buffer_load_dwordx4 v5, s[12:15], s50 offen offset:0 sc1 lds
    buffer_load_dwordx4 v5, s[12:15], s50 offen offset:1024 sc1 lds
    s_add_u32 s50, s50, 8192
    s_lshl_b32 m0, s60, 10
    s_lshl_b32 s3, s60, 14
    buffer_load_dwordx4 v7, s[24:27], s3 offen lds
    s_add_u32 s60, s60, 4
    s_lshl_b32 m0, s60, 10
    s_lshl_b32 s3, s60, 14
    buffer_load_dwordx4 v7, s[24:27], s3 offen lds
    s_add_u32 s60, s60, 4
    s_waitcnt vmcnt(8)
    s_barrier
    s_add_u32 s62, s61, 6
    s_and_b32 s62, s62, 7
    s_lshl_b32 s50, s62, 15
    s_add_u32 s50, s50, s49
    s_lshr_b32 s63, s62, 1
    s_lshl_b32 s63, s63, 7
    s_and_b32 s62, s62, 1
    s_lshl_b32 s62, s62, 4
    s_add_u32 s62, s62, s63
    s_mov_b32 s58, 0x100000
need_70:
    s_load_dwordx4 s[64:67], s[52:53], s62 glc
    s_sub_u32 s58, s58, 1
    s_cbranch_scc1 need_70_ok
    s_waitcnt lgkmcnt(0)
need_70_t:
    s_cmp_ge_u32 s48, 2
    s_cselect_b32 s63, s65, s64
    s_cmp_lg_u32 s63, s10
    s_cbranch_scc1 need_70
need_70_ok:
    s_waitcnt lgkmcnt(0)
    s_add_u32 m0, s51, 0
    s_nop 0
    buffer_load_dwordx4 v5, s[12:15], s50 offen offset:0 sc1 lds
    buffer_load_dwordx4 v5, s[12:15], s50 offen offset:1024 sc1 lds
    s_add_u32 s50, s50, 8192
    s_add_u32 m0, s51, 8192
    s_nop 0
    buffer_load_dwordx4 v5, s[12:15], s50 offen offset:0 sc1 lds
    buffer_load_dwordx4 v5, s[12:15], s50 offen offset:1024 sc1 lds
    s_add_u32 s50, s50, 8192
    s_lshl_b32 m0, s60, 10
    s_lshl_b32 s3, s60, 14
    buffer_load_dwordx4 v7, s[24:27], s3 offen lds
    s_add_u32 s60, s60, 4
    s_lshl_b32 m0, s60, 10
    s_lshl_b32 s3, s60, 14
    buffer_load_dwordx4 v7, s[24:27], s3 offen lds
    s_add_u32 s60, s60, 4
    s_waitcnt vmcnt(8)
    s_barrier
    s_branch need_71_t
need_71:
    s_load_dwordx4 s[64:67], s[52:53], s62 glc
    s_sub_u32 s58, s58, 1
    s_cbranch_scc1 need_71_ok
    s_waitcnt lgkmcnt(0)
need_71_t:
    s_cmp_ge_u32 s48, 2
    s_cselect_b32 s63, s67, s66
    s_cmp_lg_u32 s63, s10
    s_cbranch_scc1 need_71
need_71_ok:
    s_waitcnt lgkmcnt(0)
    s_add_u32 m0, s51, 16384
    s_nop 0
    buffer_load_dwordx4 v5, s[12:15], s50 offen offset:0 sc1 lds
    buffer_load_dwordx4 v5, s[12:15], s50 offen offset:1024 sc1 lds
    s_add_u32 s50, s50, 8192
    s_add_u32 m0, s51, 24576
    s_nop 0
    buffer_load_dwordx4 v5, s[12:15], s50 offen offset:0 sc1 lds
    buffer_load_dwordx4 v5, s[12:15], s50 offen offset:1024 sc1 lds
    s_add_u32 s50, s50, 8192
    s_lshl_b32 m0, s60, 10
    s_lshl_b32 s3, s60, 14
    buffer_load_dwordx4 v7, s[24:27], s3 offen lds
    s_add_u32 s60, s60, 4
    s_lshl_b32 m0, s60, 10
    s_lshl_b32 s3, s60, 14
    buffer_load_dwordx4 v7, s[24:27], s3 offen lds
    s_add_u32 s60, s60, 4
    s_waitcnt vmcnt(8)
    s_barrier
    s_add_u32 s62, s61, 7
    s_and_b32 s62, s62, 7
    s_lshl_b32 s50, s62, 15
    s_add_u32 s50, s50, s49
    s_lshr_b32 s63, s62, 1
    s_lshl_b32 s63, s63, 7
    s_and_b32 s62, s62, 1
    s_lshl_b32 s62, s62, 4
    s_add_u32 s62, s62, s63
    s_mov_b32 s58, 0x100000
need_72:
    s_load_dwordx4 s[64:67], s[52:53], s62 glc
    s_sub_u32 s58, s58, 1
    s_cbranch_scc1 need_72_ok
    s_waitcnt lgkmcnt(0)
need_72_t:
    s_cmp_ge_u32 s48, 2
    s_cselect_b32 s63, s65, s64
    s_cmp_lg_u32 s63, s10
    s_cbranch_scc1 need_72
need_72_ok:
    s_waitcnt lgkmcnt(0)
    s_add_u32 m0, s51, 32768
    s_nop 0
    buffer_load_dwordx4 v5, s[12:15], s50 offen offset:0 sc1 lds
    buffer_load_dwordx4 v5, s[12:15], s50 offen offset:1024 sc1 lds
    s_add_u32 s50, s50, 8192
    s_add_u32 m0, s51, 40960
    s_nop 0
    buffer_load_dwordx4 v5, s[12:15], s50 offen offset:0 sc1 lds
    buffer_load_dwordx4 v5, s[12:15], s50 offen offset:1024 sc1 lds
    s_add_u32 s50, s50, 8192
    s_lshl_b32 m0, s60, 10
    s_lshl_b32 s3, s60, 14
    buffer_load_dwordx4 v7, s[24:27], s3 offen lds
    s_add_u32 s60, s60, 4
    s_lshl_b32 m0, s60, 10
    s_lshl_b32 s3, s60, 14
    buffer_load_dwordx4 v7, s[24:27], s3 offen lds
    s_add_u32 s60, s60, 4
    s_waitcnt vmcnt(8)
    s_barrier
    s_branch need_73_t
need_73:
    s_load_dwordx4 s[64:67], s[52:53], s62 glc
    s_sub_u32 s58, s58, 1
    s_cbranch_scc1 need_73_ok
    s_waitcnt lgkmcnt(0)
need_73_t:
    s_cmp_ge_u32 s48, 2
    s_cselect_b32 s63, s67, s66
    s_cmp_lg_u32 s63, s10
    s_cbranch_scc1 need_73
need_73_ok:
    s_waitcnt lgkmcnt(0)
    s_add_u32 m0, s51, 49152
    s_nop 0
    buffer_load_dwordx4 v5, s[12:15], s50 offen offset:0 sc1 lds
    buffer_load_dwordx4 v5, s[12:15], s50 offen offset:1024 sc1 lds
    s_add_u32 s50, s50, 8192
    s_add_u32 m0, s51, 57344
    s_nop 0
    buffer_load_dwordx4 v5, s[12:15], s50 offen offset:0 sc1 lds
    buffer_load_dwordx4 v5, s[12:15], s50 offen offset:1024 sc1 lds
    s_add_u32 s50, s50, 8192
    s_lshl_b32 m0, s60, 10
    s_lshl_b32 s3, s60, 14
    buffer_load_dwordx4 v7, s[24:27], s3 offen lds
    s_add_u32 s60, s60, 4
    s_lshl_b32 m0, s60, 10
    s_lshl_b32 s3, s60, 14
    buffer_load_dwordx4 v7, s[24:27], s3 offen lds
    s_add_u32 s60, s60, 4
    s_waitcnt vmcnt(8)
    s_barrier
    s_lshl_b32 m0, s60, 10
    s_lshl_b32 s3, s60, 14
    buffer_load_dwordx4 v7, s[24:27], s3 offen lds
    s_add_u32 s60, s60, 4
    s_lshl_b32 m0, s60, 10
    s_lshl_b32 s3, s60, 14
    buffer_load_dwordx4 v7, s[24:27], s3 offen lds
    s_add_u32 s60, s60, 4
    s_lshl_b32 m0, s60, 10
    s_lshl_b32 s3, s60, 14
    buffer_load_dwordx4 v7, s[24:27], s3 offen lds
    s_add_u32 s60, s60, 4
    s_lshl_b32 m0, s60, 10
    s_lshl_b32 s3, s60, 14
    buffer_load_dwordx4 v7, s[24:27], s3 offen lds
    s_add_u32 s60, s60, 4
    s_waitcnt vmcnt(6)
    s_barrier
    s_lshl_b32 m0, s60, 10
    s_lshl_b32 s3, s60, 14
    buffer_load_dwordx4 v7, s[24:27], s3 offen lds
    s_add_u32 s60, s60, 4
    s_lshl_b32 m0, s60, 10
    s_lshl_b32 s3, s60, 14
    buffer_load_dwordx4 v7, s[24:27], s3 offen lds
    s_add_u32 s60, s60, 4
    s_lshl_b32 m0, s60, 10
    s_lshl_b32 s3, s60, 14
    buffer_load_dwordx4 v7, s[24:27], s3 offen lds
    s_add_u32 s60, s60, 4
    s_lshl_b32 m0, s60, 10
    s_lshl_b32 s3, s60, 14
    buffer_load_dwordx4 v7, s[24:27], s3 offen lds
    s_add_u32 s60, s60, 4
    s_barrier
    s_lshl_b32 m0, s60, 10
    s_lshl_b32 s3, s60, 14
    buffer_load_dwordx4 v7, s[24:27], s3 offen lds
    s_add_u32 s60, s60, 4
    s_lshl_b32 m0, s60, 10
    s_lshl_b32 s3, s60, 14
    buffer_load_dwordx4 v7, s[24:27], s3 offen lds
    s_add_u32 s60, s60, 4
    s_lshl_b32 m0, s60, 10
    s_lshl_b32 s3, s60, 14
    buffer_load_dwordx4 v7, s[24:27], s3 offen lds
    s_add_u32 s60, s60, 4
    s_lshl_b32 m0, s60, 10
    s_lshl_b32 s3, s60, 14
    buffer_load_dwordx4 v7, s[24:27], s3 offen lds
    s_add_u32 s60, s60, 4
    s_cmp_eq_u32 s8, 4
    s_cbranch_scc1 h_wo
    s_branch l_wo
.p2align 6
c_attn_slow:
    s_waitcnt lgkmcnt(0)
    s_lshr_b32 s56, s9, 1
    s_lshl_b32 s56, s56, 23
    s_lshl_b32 s55, s7, 19
    s_add_u32 s56, s56, s55
    s_and_b32 s55, s6, 1
    s_lshl_b32 s55, s55, 18
    s_add_u32 s56, s56, s55
    s_add_u32 s56, s56, 33554432
    v_mov_b32 v28, 0xff800000
    v_mov_b32 v30, 0xff800000
    s_mov_b32 s57, 0
c_attn_slow1:
    s_lshr_b32 s55, s57, 2
    s_lshl_b32 s55, s55, 14
    s_and_b32 s58, s57, 3
    s_lshl_b32 s58, s58, 11
    s_add_u32 s55, s55, s58
    s_add_u32 s55, s55, s56
    buffer_load_dwordx4 v[128:131], v5, s[12:15], s55 offen offset:0 sc1
    buffer_load_dwordx4 v[132:135], v5, s[12:15], s55 offen offset:1024 sc1
    s_waitcnt vmcnt(0)
    v_mfma_f32_32x32x16_bf16 v[64:79], v[128:131], v[8:11], 0
    v_mfma_f32_32x32x16_bf16 v[80:95], v[128:131], v[16:19], 0
    v_mfma_f32_32x32x16_bf16 v[64:79], v[132:135], v[12:15], v[64:79]
    v_mfma_f32_32x32x16_bf16 v[80:95], v[132:135], v[20:23], v[80:95]
    s_nop 10
    v_max3_f32 v28, v28, v64, v65
    v_max3_f32 v28, v28, v66, v67
    v_max3_f32 v28, v28, v68, v69
    v_max3_f32 v28, v28, v70, v71
    v_max3_f32 v28, v28, v72, v73
    v_max3_f32 v28, v28, v74, v75
    v_max3_f32 v28, v28, v76, v77
    v_max3_f32 v28, v28, v78, v79
    v_max3_f32 v30, v30, v80, v81
    v_max3_f32 v30, v30, v82, v83
    v_max3_f32 v30, v30, v84, v85
    v_max3_f32 v30, v30, v86, v87
    v_max3_f32 v30, v30, v88, v89
    v_max3_f32 v30, v30, v90, v91
    v_max3_f32 v30, v30, v92, v93
    v_max3_f32 v30, v30, v94, v95
    s_add_u32 s57, s57, 1
    s_cmp_lt_u32 s57, 64
    s_cbranch_scc1 c_attn_slow1
    v_mov_b32 v29, v28
    s_nop 1
    v_permlane32_swap_b32 v28, v29
    v_max_f32 v28, v28, v29
    v_sub_f32 v96, 0, v28
    v_sub_f32 v97, 0, v28
    v_sub_f32 v98, 0, v28
    v_sub_f32 v99, 0, v28
    v_sub_f32 v100, 0, v28
    v_sub_f32 v101, 0, v28
    v_sub_f32 v102, 0, v28
    v_sub_f32 v103, 0, v28
    v_sub_f32 v104, 0, v28
    v_sub_f32 v105, 0, v28
    v_sub_f32 v106, 0, v28
    v_sub_f32 v107, 0, v28
    v_sub_f32 v108, 0, v28
    v_sub_f32 v109, 0, v28
    v_sub_f32 v110, 0, v28
    v_sub_f32 v111, 0, v28
    v_mov_b32 v160, 0
    v_mov_b32 v161, 0
    v_mov_b32 v162, 0
    v_mov_b32 v163, 0
    v_mov_b32 v164, 0
    v_mov_b32 v165, 0
    v_mov_b32 v166, 0
    v_mov_b32 v167, 0
    v_mov_b32 v168, 0
    v_mov_b32 v169, 0
    v_mov_b32 v170, 0
    v_mov_b32 v171, 0
    v_mov_b32 v172, 0
    v_mov_b32 v173, 0
    v_mov_b32 v174, 0
    v_mov_b32 v175, 0
    v_mov_b32 v192, 0
    v_mov_b32 v193, 0
    v_mov_b32 v194, 0
    v_mov_b32 v195, 0
    v_mov_b32 v31, v30
    s_nop 1
    v_permlane32_swap_b32 v30, v31
    v_max_f32 v30, v30, v31
    v_sub_f32 v112, 0, v30
    v_sub_f32 v113, 0, v30
    v_sub_f32 v114, 0, v30
    v_sub_f32 v115, 0, v30
    v_sub_f32 v116, 0, v30
    v_sub_f32 v117, 0, v30
    v_sub_f32 v118, 0, v30
    v_sub_f32 v119, 0, v30
    v_sub_f32 v120, 0, v30
    v_sub_f32 v121, 0, v30
    v_sub_f32 v122, 0, v30
    v_sub_f32 v123, 0, v30
    v_sub_f32 v124, 0, v30
    v_sub_f32 v125, 0, v30
    v_sub_f32 v126, 0, v30
    v_sub_f32 v127, 0, v30
    v_mov_b32 v176, 0
    v_mov_b32 v177, 0
    v_mov_b32 v178, 0
    v_mov_b32 v179, 0
    v_mov_b32 v180, 0
    v_mov_b32 v181, 0
    v_mov_b32 v182, 0
    v_mov_b32 v183, 0
    v_mov_b32 v184, 0
    v_mov_b32 v185, 0
    v_mov_b32 v186, 0
    v_mov_b32 v187, 0
    v_mov_b32 v188, 0
    v_mov_b32 v189, 0
    v_mov_b32 v190, 0
    v_mov_b32 v191, 0
    v_mov_b32 v196, 0
    v_mov_b32 v197, 0
    v_mov_b32 v198, 0
    v_mov_b32 v199, 0
    s_mov_b32 s57, 0
c_attn_slow2:
    s_lshr_b32 s55, s57, 2
    s_lshl_b32 s55, s55, 14
    s_and_b32 s58, s57, 3
    s_lshl_b32 s58, s58, 11
    s_add_u32 s55, s55, s58
    s_add_u32 s55, s55, s56
    buffer_load_dwordx4 v[128:131], v5, s[12:15], s55 offen offset:0 sc1
    buffer_load_dwordx4 v[132:135], v5, s[12:15], s55 offen offset:1024 sc1
    s_add_u32 s55, s55, 8192
    buffer_load_dwordx4 v[144:147], v5, s[12:15], s55 offen offset:0 sc1
    buffer_load_dwordx4 v[148:151], v5, s[12:15], s55 offen offset:1024 sc1
    s_waitcnt vmcnt(0)
    v_mfma_f32_32x32x16_bf16 v[64:79], v[128:131], v[8:11], v[96:111]
    v_mfma_f32_32x32x16_bf16 v[80:95], v[128:131], v[16:19], v[112:127]
    v_mfma_f32_32x32x16_bf16 v[64:79], v[132:135], v[12:15], v[64:79]
    v_mfma_f32_32x32x16_bf16 v[80:95], v[132:135], v[20:23], v[80:95]
    s_nop 10
    v_exp_f32 v64, v64
    v_exp_f32 v65, v65
    v_exp_f32 v66, v66
    v_exp_f32 v67, v67
    v_exp_f32 v68, v68
    v_exp_f32 v69, v69
    v_exp_f32 v70, v70
    v_exp_f32 v71, v71
    v_exp_f32 v72, v72
    v_exp_f32 v73, v73
    v_exp_f32 v74, v74
    v_exp_f32 v75, v75
    v_exp_f32 v76, v76
    v_exp_f32 v77, v77
    v_exp_f32 v78, v78
    v_exp_f32 v79, v79
    v_exp_f32 v80, v80
    v_exp_f32 v81, v81
    v_exp_f32 v82, v82
    v_exp_f32 v83, v83
    v_exp_f32 v84, v84
    v_exp_f32 v85, v85
    v_exp_f32 v86, v86
    v_exp_f32 v87, v87
    v_exp_f32 v88, v88
    v_exp_f32 v89, v89
    v_exp_f32 v90, v90
    v_exp_f32 v91, v91
    v_exp_f32 v92, v92
    v_exp_f32 v93, v93
    v_exp_f32 v94, v94
    v_exp_f32 v95, v95
    v_smfmac_f32_32x32x32_bf16 v[160:175], v[144:147], v[64:71], v204
    v_smfmac_f32_16x16x64_bf16 v[192:195], v[200:203], v[64:71], v204
    v_smfmac_f32_32x32x32_bf16 v[160:175], v[148:151], v[72:79], v204
    v_smfmac_f32_16x16x64_bf16 v[192:195], v[200:203], v[72:79], v204
    v_smfmac_f32_32x32x32_bf16 v[176:191], v[144:147], v[80:87], v204
    v_smfmac_f32_16x16x64_bf16 v[196:199], v[200:203], v[80:87], v204
    v_smfmac_f32_32x32x32_bf16 v[176:191], v[148:151], v[88:95], v204
    v_smfmac_f32_16x16x64_bf16 v[196:199], v[200:203], v[88:95], v204
    s_add_u32 s57, s57, 1
    s_cmp_lt_u32 s57, 64
    s_nop 15
    s_cbranch_scc1 c_attn_slow2
    s_branch c_attn_fin
    s_endpgm
.section .rodata,"a"
.p2align 6
.amdhsa_kernel interleave_layers__sliding_local_dilated__softmax_full_mha__prompt_kernel
  .amdhsa_next_free_vgpr 256
  .amdhsa_next_free_sgpr 102
  .amdhsa_accum_offset 224
  .amdhsa_group_segment_fixed_size 0
  .amdhsa_kernarg_size 72
  .amdhsa_user_sgpr_count 2
  .amdhsa_user_sgpr_kernarg_segment_ptr 1
  .amdhsa_system_sgpr_workgroup_id_x 1
.end_amdhsa_kernel
```

```asm
; @launch grid=(256,1,1) block=(512,1,1) lds=159744
.amdgcn_target "amdgcn-amd-amdhsa--gfx950"
.text
.globl interleave_layers__sliding_local_dilated__softmax_full_mha__prompt_kernel
.type interleave_layers__sliding_local_dilated__softmax_full_mha__prompt_kernel,@function
.p2align 8
interleave_layers__sliding_local_dilated__softmax_full_mha__prompt_kernel:
    s_cmp_ge_u32 s2, 256
    s_cbranch_scc1 k_exit2
    s_load_dwordx16 s[32:47], s[0:1], 0
    s_load_dwordx2 s[4:5], s[0:1], 64
    v_lshrrev_b32 v2, 6, v0
    v_and_b32 v1, 63, v0
    v_mov_b32 v12, 0
    v_mov_b32 v14, 0
    v_mov_b32 v15, 0
    v_mov_b32 v16, 0
    v_readfirstlane_b32 s8, v2
    s_and_b32 s3, s2, 1
    s_lshl_b32 s3, s3, 3
    s_bfe_u32 s6, s2, 0x30003
    s_add_u32 s6, s3, s6
    s_bfe_u32 s3, s2, 0x20001
    s_lshl_b32 s3, s3, 2
    s_lshr_b32 s7, s2, 6
    s_add_u32 s7, s3, s7
    s_lshl_b32 s11, s6, 4
    s_add_u32 s11, s11, s7
    s_mov_b32 s9, -1
    s_mov_b32 s96, 0
    s_mov_b32 s10, 0
    s_waitcnt lgkmcnt(0)
    s_mov_b32 s12, s4
    s_mov_b32 s13, s5
    s_mov_b32 s14, 71303168
    s_mov_b32 s15, 0x00020000
    s_cmp_lt_u32 s8, 4
    s_cbranch_scc1 c_prep
    s_cmp_eq_u32 s8, 4
    s_cbranch_scc1 h_first
    s_branch l_first
k_exit:
k_exit2:
    s_endpgm
.p2align 6
c_qkvA:
    v_and_b32 v1, 63, v0
    v_lshrrev_b32 v2, 6, v0
    v_lshlrev_b32 v5, 4, v1
    v_lshrrev_b32 v3, 5, v1
    v_and_b32 v4, 15, v0
    v_bfe_u32 v7, v1, 4, 1
    v_lshl_add_u32 v6, v7, 5, v4
    v_lshlrev_b32 v6, 4, v6
    v_lshl_add_u32 v6, v3, 10, v6
    s_lshr_b32 s48, s6, 1
    s_lshl_b32 s48, s48, 2
    s_add_u32 s48, s48, s8
    s_lshl_b32 s55, s48, 17
    s_lshl_b32 s56, s9, 22
    s_add_u32 s55, s55, s56
    s_add_u32 s16, s4, s55
    s_addc_u32 s17, s5, 0
    s_mov_b32 s18, 65536
    s_mov_b32 s19, 0x00020000
    s_add_u32 s56, s55, 65536
    s_add_u32 s20, s4, s56
    s_addc_u32 s21, s5, 0
    s_mov_b32 s22, 65536
    s_mov_b32 s23, 0x00020000
    s_lshl_b32 s49, s7, 12
    s_add_u32 s49, s49, s55
    s_and_b32 s56, s6, 1
    s_lshl_b32 s56, s56, 11
    s_add_u32 s49, s49, s56
    s_add_u32 s49, s49, 16777216
    s_movk_i32 s54, 4096
    v_lshrrev_b32 v16, 2, v4
    v_lshl_add_u32 v18, v7, 2, v16
    v_lshl_add_u32 v18, v3, 4, v18
    v_lshlrev_b32 v18, 6, v18
    v_and_b32 v17, 3, v4
    v_lshl_add_u32 v18, v17, 3, v18
    v_lshl_add_u32 v26, v7, 5, v18
    v_xor_b32 v27, 32, v26
    v_mov_b32 v24, v26
    v_mov_b32 v25, v27
    v_and_b32 v18, 0x30, v1
    v_add_u32 v10, 155648, v18
    v_lshlrev_b32 v11, 2, v4
    v_add_u32 v11, 155648, v11
    v_lshl_add_u32 v8, v2, 8, v11
    v_lshl_add_u32 v9, v2, 8, v10
    s_lshr_b32 s3, s8, 1
    s_and_b32 s55, s8, 1
    s_lshl_b32 s56, s55, 5
    v_xor_b32 v29, s56, v26
    s_lshl_b32 s56, s3, 13
    s_add_u32 s56, s56, 8192
    v_add_u32 v29, s56, v29
    v_mov_b32 v28, v29
    v_add_u32 v30, 147456, v5
    v_lshl_add_u32 v14, v2, 6, v10
    v_lshl_add_u32 v12, v2, 11, v5
    v_add_u32 v12, 131072, v12
    v_lshlrev_b32 v16, 8, v16
    v_lshl_add_u32 v16, v18, 2, v16
    v_lshl_add_u32 v16, v17, 1, v16
    v_add_u32 v16, 1024, v16
    v_cmp_gt_u32 vcc, 2, v2
    s_nop 1
    v_cndmask_b32 v13, v16, v5, vcc
    s_lshl_b32 s56, s55, 3
    s_add_u32 s56, s56, 131072
    v_add_u32 v13, s56, v13
    v_lshrrev_b32 v18, 2, v18
    v_sub_u32 v18, v4, v18
    v_mov_b32 v19, 0xf149f2ca
    v_add_u32 v16, 0x0, v18
    v_and_b32 v16, 0xfffffff1, v16
    v_cmp_eq_u32 vcc, 0, v16
    s_nop 1
    v_cndmask_b32 v196, v19, 0, vcc
    v_add_u32 v16, 0xffffffff, v18
    v_and_b32 v16, 0xfffffff1, v16
    v_cmp_eq_u32 vcc, 0, v16
    s_nop 1
    v_cndmask_b32 v197, v19, 0, vcc
    v_add_u32 v16, 0xfffffffe, v18
    v_and_b32 v16, 0xfffffff1, v16
    v_cmp_eq_u32 vcc, 0, v16
    s_nop 1
    v_cndmask_b32 v198, v19, 0, vcc
    v_add_u32 v16, 0xfffffffd, v18
    v_and_b32 v16, 0xfffffff1, v16
    v_cmp_eq_u32 vcc, 0, v16
    s_nop 1
    v_cndmask_b32 v199, v19, 0, vcc
    v_add_u32 v16, 0x10, v18
    v_and_b32 v16, 0xfffffff1, v16
    v_cmp_eq_u32 vcc, 0, v16
    s_nop 1
    v_cndmask_b32 v200, v19, 0, vcc
    v_add_u32 v16, 0xf, v18
    v_and_b32 v16, 0xfffffff1, v16
    v_cmp_eq_u32 vcc, 0, v16
    s_nop 1
    v_cndmask_b32 v201, v19, 0, vcc
    v_add_u32 v16, 0xe, v18
    v_and_b32 v16, 0xfffffff1, v16
    v_cmp_eq_u32 vcc, 0, v16
    s_nop 1
    v_cndmask_b32 v202, v19, 0, vcc
    v_add_u32 v16, 0xd, v18
    v_and_b32 v16, 0xfffffff1, v16
    v_cmp_eq_u32 vcc, 0, v16
    s_nop 1
    v_cndmask_b32 v203, v19, 0, vcc
    s_cmp_eq_u32 s48, 0
    s_cselect_b64 vcc, -1, 0
    v_cndmask_b32 v204, v200, v19, vcc
    v_cndmask_b32 v205, v201, v19, vcc
    v_cndmask_b32 v206, v202, v19, vcc
    v_cndmask_b32 v207, v203, v19, vcc
    v_mov_b32 v208, 0x3f803f80
    v_mov_b32 v209, 0x3f803f80
    v_mov_b32 v210, 0x3f803f80
    v_mov_b32 v211, 0x3f803f80
    v_mov_b32 v184, 0
    v_mov_b32 v185, 0
    v_mov_b32 v186, 0
    v_mov_b32 v187, 0
    v_mov_b32 v188, 0
    v_mov_b32 v189, 0
    v_mov_b32 v190, 0
    v_mov_b32 v191, 0
    v_mov_b32 v192, 0
    v_mov_b32 v193, 0
    v_mov_b32 v194, 0
    v_mov_b32 v195, 0
    v_mov_b32 v32, 0
    v_mov_b32 v33, 0
    v_mov_b32 v34, 0
    v_mov_b32 v35, 0
    v_mov_b32 v36, 0
    v_mov_b32 v37, 0
    v_mov_b32 v38, 0
    v_mov_b32 v39, 0
    v_mov_b32 v40, 0
    v_mov_b32 v41, 0
    v_mov_b32 v42, 0
    v_mov_b32 v43, 0
    v_mov_b32 v44, 0
    v_mov_b32 v45, 0
    v_mov_b32 v46, 0
    v_mov_b32 v47, 0
    v_mov_b32 v48, 0
    v_mov_b32 v49, 0
    v_mov_b32 v50, 0
    v_mov_b32 v51, 0
    v_mov_b32 v52, 0
    v_mov_b32 v53, 0
    v_mov_b32 v54, 0
    v_mov_b32 v55, 0
    v_mov_b32 v56, 0
    v_mov_b32 v57, 0
    v_mov_b32 v58, 0
    v_mov_b32 v59, 0
    v_mov_b32 v60, 0
    v_mov_b32 v61, 0
    v_mov_b32 v62, 0
    v_mov_b32 v63, 0
    v_mov_b32 v64, 0
    v_mov_b32 v65, 0
    v_mov_b32 v66, 0
    v_mov_b32 v67, 0
    v_mov_b32 v68, 0
    v_mov_b32 v69, 0
    v_mov_b32 v70, 0
    v_mov_b32 v71, 0
    v_mov_b32 v72, 0
    v_mov_b32 v73, 0
    v_mov_b32 v74, 0
    v_mov_b32 v75, 0
    v_mov_b32 v76, 0
    v_mov_b32 v77, 0
    v_mov_b32 v78, 0
    v_mov_b32 v79, 0
    v_mov_b32 v80, 0
    v_mov_b32 v81, 0
    v_mov_b32 v82, 0
    v_mov_b32 v83, 0
    v_mov_b32 v84, 0
    v_mov_b32 v85, 0
    v_mov_b32 v86, 0
    v_mov_b32 v87, 0
    v_mov_b32 v88, 0
    v_mov_b32 v89, 0
    v_mov_b32 v90, 0
    v_mov_b32 v91, 0
    v_mov_b32 v92, 0
    v_mov_b32 v93, 0
    v_mov_b32 v94, 0
    v_mov_b32 v95, 0
    v_mov_b32 v96, 0
    v_mov_b32 v97, 0
    v_mov_b32 v98, 0
    v_mov_b32 v99, 0
    v_mov_b32 v100, 0
    v_mov_b32 v101, 0
    v_mov_b32 v102, 0
    v_mov_b32 v103, 0
    v_mov_b32 v104, 0
    v_mov_b32 v105, 0
    v_mov_b32 v106, 0
    v_mov_b32 v107, 0
    v_mov_b32 v108, 0
    v_mov_b32 v109, 0
    v_mov_b32 v110, 0
    v_mov_b32 v111, 0
    v_mov_b32 v112, 0
    v_mov_b32 v113, 0
    v_mov_b32 v114, 0
    v_mov_b32 v115, 0
    v_mov_b32 v116, 0
    v_mov_b32 v117, 0
    v_mov_b32 v118, 0
    v_mov_b32 v119, 0
    v_mov_b32 v120, 0
    v_mov_b32 v121, 0
    v_mov_b32 v122, 0
    v_mov_b32 v123, 0
    v_mov_b32 v124, 0
    v_mov_b32 v125, 0
    v_mov_b32 v126, 0
    v_mov_b32 v127, 0
    s_mov_b32 s50, 8192
    s_mov_b32 s58, 6144
    s_mov_b32 s51, 12288
    s_mov_b32 s59, 10240
    s_mov_b32 s52, 0
    s_mul_i32 s60, s9, 786432
    s_add_u32 s60, s60, 65273856
    s_lshl_b32 s61, s11, 10
    s_add_u32 s60, s60, s61
    s_and_b32 s61, s8, 2
    s_lshl_b32 s61, s61, 7
    s_add_u32 s60, s60, s61
    s_add_u32 s61, s60, 128
    s_mov_b32 s98, s10
    s_mov_b32 s99, s10
    s_mov_b32 s3, 0x100000
cp_1:
    s_load_dwordx8 s[64:71], s[4:5], s60 glc
    s_load_dwordx8 s[72:79], s[4:5], s61 glc
    s_sub_u32 s3, s3, 1
    s_cbranch_scc1 cp_1_ok
    s_waitcnt lgkmcnt(0)
    s_xor_b64 s[100:101], s[64:65], s[98:99]
    s_xor_b64 s[64:65], s[66:67], s[98:99]
    s_or_b64 s[100:101], s[100:101], s[64:65]
    s_xor_b64 s[64:65], s[68:69], s[98:99]
    s_or_b64 s[100:101], s[100:101], s[64:65]
    s_xor_b64 s[64:65], s[70:71], s[98:99]
    s_or_b64 s[100:101], s[100:101], s[64:65]
    s_xor_b64 s[64:65], s[72:73], s[98:99]
    s_or_b64 s[100:101], s[100:101], s[64:65]
    s_xor_b64 s[64:65], s[74:75], s[98:99]
    s_or_b64 s[100:101], s[100:101], s[64:65]
    s_xor_b64 s[64:65], s[76:77], s[98:99]
    s_or_b64 s[100:101], s[100:101], s[64:65]
    s_xor_b64 s[64:65], s[78:79], s[98:99]
    s_or_b64 s[100:101], s[100:101], s[64:65]
    s_cbranch_scc1 cp_1
cp_1_ok:
    s_waitcnt lgkmcnt(0)
    buffer_load_dwordx4 v[152:155], v6, s[16:19], 0 offen offset:0 sc1
    buffer_load_dwordx4 v[156:159], v6, s[16:19], 0 offen offset:256 sc1
    buffer_load_dwordx4 v[160:163], v6, s[20:23], 0 offen offset:0 sc1
    buffer_load_dwordx4 v[164:167], v6, s[20:23], 0 offen offset:256 sc1
    buffer_load_dwordx4 v[168:171], v6, s[16:19], 0 offen offset:2048 sc1
    buffer_load_dwordx4 v[172:175], v6, s[16:19], 0 offen offset:2304 sc1
    buffer_load_dwordx4 v[176:179], v6, s[20:23], 0 offen offset:2048 sc1
    buffer_load_dwordx4 v[180:183], v6, s[20:23], 0 offen offset:2304 sc1
    s_barrier
    ds_read_b64_tr_b16 v[128:129], v24 offset:0
    ds_read_b64_tr_b16 v[130:131], v24 offset:512
    ds_read_b64_tr_b16 v[132:133], v25 offset:0
    ds_read_b64_tr_b16 v[134:135], v25 offset:512
    ds_read_b64_tr_b16 v[136:137], v24 offset:8192
    ds_read_b64_tr_b16 v[138:139], v24 offset:8704
    ds_read_b64_tr_b16 v[140:141], v25 offset:8192
    ds_read_b64_tr_b16 v[142:143], v25 offset:8704
    ds_read_b64_tr_b16 v[144:145], v24 offset:16384
    ds_read_b64_tr_b16 v[146:147], v24 offset:16896
    buffer_load_dwordx4 a[0:3], v6, s[16:19], s54 offen offset:0 sc1
    buffer_load_dwordx4 a[4:7], v6, s[16:19], s54 offen offset:256 sc1
    buffer_load_dwordx4 a[8:11], v6, s[20:23], s54 offen offset:0 sc1
    buffer_load_dwordx4 a[12:15], v6, s[20:23], s54 offen offset:256 sc1
    buffer_load_dwordx4 a[16:19], v6, s[16:19], s54 offen offset:2048 sc1
    buffer_load_dwordx4 a[20:23], v6, s[16:19], s54 offen offset:2304 sc1
    s_mov_b32 s54, 7
.p2align 3
c_qkvA_loop:
    s_waitcnt vmcnt(12) lgkmcnt(8)
    v_mfma_f32_16x16x32_bf16 v[184:187], v[188:191], v[192:195], v[184:187]
    v_mfma_f32_16x16x32_bf16 v[32:35], v[128:131], v[152:155], v[32:35]
    ds_read_b64_tr_b16 v[148:149], v25 offset:16384
    buffer_load_dwordx4 a[24:27], v6, s[20:23], s58 offen offset:0 sc1
    v_mfma_f32_16x16x32_bf16 v[36:39], v[128:131], v[156:159], v[36:39]
    ds_read_b64_tr_b16 v[150:151], v25 offset:16896
    s_waitcnt lgkmcnt(8)
    v_mfma_f32_16x16x32_bf16 v[52:55], v[132:135], v[156:159], v[52:55]
    v_mfma_f32_16x16x32_bf16 v[48:51], v[132:135], v[152:155], v[48:51]
    ds_read_b64_tr_b16 v[188:189], v28 offset:0
    s_waitcnt lgkmcnt(7)
    v_mfma_f32_16x16x32_bf16 v[64:67], v[136:139], v[152:155], v[64:67]
    v_mfma_f32_16x16x32_bf16 v[68:71], v[136:139], v[156:159], v[68:71]
    ds_read_b64_tr_b16 v[190:191], v28 offset:512
    s_waitcnt lgkmcnt(6)
    v_mfma_f32_16x16x32_bf16 v[84:87], v[140:143], v[156:159], v[84:87]
    buffer_load_dwordx4 a[28:31], v6, s[20:23], s58 offen offset:256 sc1
    v_mfma_f32_16x16x32_bf16 v[80:83], v[140:143], v[152:155], v[80:83]
    ds_read_b128 v[192:195], v30 offset:0
    s_waitcnt lgkmcnt(5)
    v_mfma_f32_16x16x32_bf16 v[96:99], v[152:155], v[144:147], v[96:99]
    v_mfma_f32_16x16x32_bf16 v[100:103], v[156:159], v[144:147], v[100:103]
    s_waitcnt lgkmcnt(3)
    v_mfma_f32_16x16x32_bf16 v[116:119], v[156:159], v[148:151], v[116:119]
    v_mfma_f32_16x16x32_bf16 v[112:115], v[152:155], v[148:151], v[112:115]
    s_waitcnt vmcnt(12)
    v_mfma_f32_16x16x32_bf16 v[40:43], v[128:131], v[160:163], v[40:43]
    buffer_load_dwordx4 v[152:155], v6, s[16:19], s50 offen offset:0 sc1
    v_mfma_f32_16x16x32_bf16 v[44:47], v[128:131], v[164:167], v[44:47]
    v_mfma_f32_16x16x32_bf16 v[60:63], v[132:135], v[164:167], v[60:63]
    ds_read_b64_tr_b16 v[128:129], v24 offset:2048
    v_mfma_f32_16x16x32_bf16 v[56:59], v[132:135], v[160:163], v[56:59]
    ds_read_b64_tr_b16 v[130:131], v24 offset:2560
    v_mfma_f32_16x16x32_bf16 v[72:75], v[136:139], v[160:163], v[72:75]
    ds_read_b64_tr_b16 v[132:133], v25 offset:2048
    v_mfma_f32_16x16x32_bf16 v[76:79], v[136:139], v[164:167], v[76:79]
    ds_read_b64_tr_b16 v[134:135], v25 offset:2560
    v_mfma_f32_16x16x32_bf16 v[92:95], v[140:143], v[164:167], v[92:95]
    ds_read_b64_tr_b16 v[136:137], v24 offset:10240
    buffer_load_dwordx4 v[156:159], v6, s[16:19], s50 offen offset:256 sc1
    v_mfma_f32_16x16x32_bf16 v[88:91], v[140:143], v[160:163], v[88:91]
    ds_read_b64_tr_b16 v[138:139], v24 offset:10752
    v_mfma_f32_16x16x32_bf16 v[104:107], v[160:163], v[144:147], v[104:107]
    ds_read_b64_tr_b16 v[140:141], v25 offset:10240
    v_mfma_f32_16x16x32_bf16 v[108:111], v[164:167], v[144:147], v[108:111]
    ds_read_b64_tr_b16 v[142:143], v25 offset:10752
    v_mfma_f32_16x16x32_bf16 v[124:127], v[164:167], v[148:151], v[124:127]
    ds_read_b64_tr_b16 v[144:145], v24 offset:18432
    v_mfma_f32_16x16x32_bf16 v[120:123], v[160:163], v[148:151], v[120:123]
    ds_read_b64_tr_b16 v[146:147], v24 offset:18944
    s_waitcnt vmcnt(12) lgkmcnt(8)
    v_mfma_f32_16x16x32_bf16 v[184:187], v[188:191], v[192:195], v[184:187]
    v_mfma_f32_16x16x32_bf16 v[32:35], v[128:131], v[168:171], v[32:35]
    ds_read_b64_tr_b16 v[148:149], v25 offset:18432
    buffer_load_dwordx4 v[160:163], v6, s[20:23], s58 offen offset:2048 sc1
    v_mfma_f32_16x16x32_bf16 v[36:39], v[128:131], v[172:175], v[36:39]
    ds_read_b64_tr_b16 v[150:151], v25 offset:18944
    s_waitcnt lgkmcnt(8)
    v_mfma_f32_16x16x32_bf16 v[52:55], v[132:135], v[172:175], v[52:55]
    v_mfma_f32_16x16x32_bf16 v[48:51], v[132:135], v[168:171], v[48:51]
    ds_read_b64_tr_b16 v[188:189], v28 offset:2048
    s_waitcnt lgkmcnt(7)
    v_mfma_f32_16x16x32_bf16 v[64:67], v[136:139], v[168:171], v[64:67]
    v_mfma_f32_16x16x32_bf16 v[68:71], v[136:139], v[172:175], v[68:71]
    ds_read_b64_tr_b16 v[190:191], v28 offset:2560
    s_waitcnt lgkmcnt(6)
    v_mfma_f32_16x16x32_bf16 v[84:87], v[140:143], v[172:175], v[84:87]
    buffer_load_dwordx4 v[164:167], v6, s[20:23], s58 offen offset:2304 sc1
    v_mfma_f32_16x16x32_bf16 v[80:83], v[140:143], v[168:171], v[80:83]
    ds_read_b128 v[192:195], v30 offset:1024
    s_waitcnt lgkmcnt(5)
    v_mfma_f32_16x16x32_bf16 v[96:99], v[168:171], v[144:147], v[96:99]
    v_mfma_f32_16x16x32_bf16 v[100:103], v[172:175], v[144:147], v[100:103]
    s_waitcnt lgkmcnt(3)
    v_mfma_f32_16x16x32_bf16 v[116:119], v[172:175], v[148:151], v[116:119]
    v_mfma_f32_16x16x32_bf16 v[112:115], v[168:171], v[148:151], v[112:115]
    s_waitcnt vmcnt(12)
    v_mfma_f32_16x16x32_bf16 v[40:43], v[128:131], v[176:179], v[40:43]
    buffer_load_dwordx4 v[168:171], v6, s[16:19], s50 offen offset:2048 sc1
    v_mfma_f32_16x16x32_bf16 v[44:47], v[128:131], v[180:183], v[44:47]
    v_mfma_f32_16x16x32_bf16 v[60:63], v[132:135], v[180:183], v[60:63]
    ds_read_b64_tr_b16 v[128:129], v24 offset:4096
    v_mfma_f32_16x16x32_bf16 v[56:59], v[132:135], v[176:179], v[56:59]
    ds_read_b64_tr_b16 v[130:131], v24 offset:4608
    v_mfma_f32_16x16x32_bf16 v[72:75], v[136:139], v[176:179], v[72:75]
    ds_read_b64_tr_b16 v[132:133], v25 offset:4096
    v_mfma_f32_16x16x32_bf16 v[76:79], v[136:139], v[180:183], v[76:79]
    ds_read_b64_tr_b16 v[134:135], v25 offset:4608
    v_mfma_f32_16x16x32_bf16 v[92:95], v[140:143], v[180:183], v[92:95]
    ds_read_b64_tr_b16 v[136:137], v24 offset:12288
    buffer_load_dwordx4 v[172:175], v6, s[16:19], s50 offen offset:2304 sc1
    v_mfma_f32_16x16x32_bf16 v[88:91], v[140:143], v[176:179], v[88:91]
    ds_read_b64_tr_b16 v[138:139], v24 offset:12800
    v_mfma_f32_16x16x32_bf16 v[104:107], v[176:179], v[144:147], v[104:107]
    ds_read_b64_tr_b16 v[140:141], v25 offset:12288
    v_mfma_f32_16x16x32_bf16 v[108:111], v[180:183], v[144:147], v[108:111]
    ds_read_b64_tr_b16 v[142:143], v25 offset:12800
    v_mfma_f32_16x16x32_bf16 v[124:127], v[180:183], v[148:151], v[124:127]
    ds_read_b64_tr_b16 v[144:145], v24 offset:20480
    v_mfma_f32_16x16x32_bf16 v[120:123], v[176:179], v[148:151], v[120:123]
    ds_read_b64_tr_b16 v[146:147], v24 offset:20992
    s_waitcnt vmcnt(12) lgkmcnt(8)
    v_mfma_f32_16x16x32_bf16 v[184:187], v[188:191], v[192:195], v[184:187]
    v_mfma_f32_16x16x32_bf16 v[32:35], v[128:131], a[0:3], v[32:35]
    ds_read_b64_tr_b16 v[148:149], v25 offset:20480
    buffer_load_dwordx4 v[176:179], v6, s[20:23], s59 offen offset:0 sc1
    v_mfma_f32_16x16x32_bf16 v[36:39], v[128:131], a[4:7], v[36:39]
    ds_read_b64_tr_b16 v[150:151], v25 offset:20992
    s_waitcnt lgkmcnt(8)
    v_mfma_f32_16x16x32_bf16 v[52:55], v[132:135], a[4:7], v[52:55]
    s_add_u32 s58, s58, 8192
    v_mfma_f32_16x16x32_bf16 v[48:51], v[132:135], a[0:3], v[48:51]
    ds_read_b64_tr_b16 v[188:189], v28 offset:4096
    s_waitcnt lgkmcnt(7)
    v_mfma_f32_16x16x32_bf16 v[64:67], v[136:139], a[0:3], v[64:67]
    s_add_u32 s50, s50, 8192
    v_mfma_f32_16x16x32_bf16 v[68:71], v[136:139], a[4:7], v[68:71]
    ds_read_b64_tr_b16 v[190:191], v28 offset:4608
    s_waitcnt lgkmcnt(6)
    v_mfma_f32_16x16x32_bf16 v[84:87], v[140:143], a[4:7], v[84:87]
    buffer_load_dwordx4 v[180:183], v6, s[20:23], s59 offen offset:256 sc1
    v_mfma_f32_16x16x32_bf16 v[80:83], v[140:143], a[0:3], v[80:83]
    ds_read_b128 v[192:195], v30 offset:2048
    s_waitcnt lgkmcnt(5)
    v_mfma_f32_16x16x32_bf16 v[96:99], a[0:3], v[144:147], v[96:99]
    s_add_u32 s52, s52, 24576
    v_mfma_f32_16x16x32_bf16 v[100:103], a[4:7], v[144:147], v[100:103]
    s_cmp_eq_u32 s52, 147456
    s_waitcnt lgkmcnt(3)
    v_mfma_f32_16x16x32_bf16 v[116:119], a[4:7], v[148:151], v[116:119]
    s_cselect_b32 s52, 0, s52
    v_mfma_f32_16x16x32_bf16 v[112:115], a[0:3], v[148:151], v[112:115]
    s_waitcnt vmcnt(12)
    v_mfma_f32_16x16x32_bf16 v[40:43], v[128:131], a[8:11], v[40:43]
    buffer_load_dwordx4 a[0:3], v6, s[16:19], s51 offen offset:0 sc1
    v_mfma_f32_16x16x32_bf16 v[44:47], v[128:131], a[12:15], v[44:47]
    s_sub_u32 s54, s54, 1
    v_mfma_f32_16x16x32_bf16 v[60:63], v[132:135], a[12:15], v[60:63]
    ds_read_b64_tr_b16 v[128:129], v24 offset:6144
    v_mfma_f32_16x16x32_bf16 v[56:59], v[132:135], a[8:11], v[56:59]
    ds_read_b64_tr_b16 v[130:131], v24 offset:6656
    v_mfma_f32_16x16x32_bf16 v[72:75], v[136:139], a[8:11], v[72:75]
    ds_read_b64_tr_b16 v[132:133], v25 offset:6144
    v_mfma_f32_16x16x32_bf16 v[76:79], v[136:139], a[12:15], v[76:79]
    ds_read_b64_tr_b16 v[134:135], v25 offset:6656
    v_mfma_f32_16x16x32_bf16 v[92:95], v[140:143], a[12:15], v[92:95]
    ds_read_b64_tr_b16 v[136:137], v24 offset:14336
    buffer_load_dwordx4 a[4:7], v6, s[16:19], s51 offen offset:256 sc1
    v_mfma_f32_16x16x32_bf16 v[88:91], v[140:143], a[8:11], v[88:91]
    ds_read_b64_tr_b16 v[138:139], v24 offset:14848
    v_mfma_f32_16x16x32_bf16 v[104:107], a[8:11], v[144:147], v[104:107]
    ds_read_b64_tr_b16 v[140:141], v25 offset:14336
    v_mfma_f32_16x16x32_bf16 v[108:111], a[12:15], v[144:147], v[108:111]
    ds_read_b64_tr_b16 v[142:143], v25 offset:14848
    v_mfma_f32_16x16x32_bf16 v[124:127], a[12:15], v[148:151], v[124:127]
    ds_read_b64_tr_b16 v[144:145], v24 offset:22528
    v_mfma_f32_16x16x32_bf16 v[120:123], a[8:11], v[148:151], v[120:123]
    ds_read_b64_tr_b16 v[146:147], v24 offset:23040
    s_waitcnt vmcnt(12) lgkmcnt(8)
    v_mfma_f32_16x16x32_bf16 v[184:187], v[188:191], v[192:195], v[184:187]
    v_mfma_f32_16x16x32_bf16 v[32:35], v[128:131], a[16:19], v[32:35]
    ds_read_b64_tr_b16 v[148:149], v25 offset:22528
    buffer_load_dwordx4 a[8:11], v6, s[20:23], s59 offen offset:2048 sc1
    v_mfma_f32_16x16x32_bf16 v[36:39], v[128:131], a[20:23], v[36:39]
    ds_read_b64_tr_b16 v[150:151], v25 offset:23040
    s_waitcnt lgkmcnt(8)
    v_mfma_f32_16x16x32_bf16 v[52:55], v[132:135], a[20:23], v[52:55]
    v_add_u32 v24, s52, v26
    v_mfma_f32_16x16x32_bf16 v[48:51], v[132:135], a[16:19], v[48:51]
    ds_read_b64_tr_b16 v[188:189], v28 offset:6144
    s_waitcnt lgkmcnt(7)
    v_mfma_f32_16x16x32_bf16 v[64:67], v[136:139], a[16:19], v[64:67]
    v_add_u32 v25, s52, v27
    v_mfma_f32_16x16x32_bf16 v[68:71], v[136:139], a[20:23], v[68:71]
    ds_read_b64_tr_b16 v[190:191], v28 offset:6656
    s_waitcnt lgkmcnt(6)
    v_mfma_f32_16x16x32_bf16 v[84:87], v[140:143], a[20:23], v[84:87]
    buffer_load_dwordx4 a[12:15], v6, s[20:23], s59 offen offset:2304 sc1
    v_mfma_f32_16x16x32_bf16 v[80:83], v[140:143], a[16:19], v[80:83]
    ds_read_b128 v[192:195], v30 offset:3072
    s_waitcnt lgkmcnt(5)
    v_mfma_f32_16x16x32_bf16 v[96:99], a[16:19], v[144:147], v[96:99]
    s_add_u32 s59, s59, 8192
    v_mfma_f32_16x16x32_bf16 v[100:103], a[20:23], v[144:147], v[100:103]
    v_add_u32 v28, s52, v29
    s_waitcnt lgkmcnt(3)
    v_mfma_f32_16x16x32_bf16 v[116:119], a[20:23], v[148:151], v[116:119]
    s_waitcnt lgkmcnt(0)
    v_mfma_f32_16x16x32_bf16 v[112:115], a[16:19], v[148:151], v[112:115]
    s_barrier
    s_waitcnt vmcnt(12)
    v_mfma_f32_16x16x32_bf16 v[40:43], v[128:131], a[24:27], v[40:43]
    buffer_load_dwordx4 a[16:19], v6, s[16:19], s51 offen offset:2048 sc1
    v_mfma_f32_16x16x32_bf16 v[44:47], v[128:131], a[28:31], v[44:47]
    v_xor_b32 v30, 4096, v30
    v_mfma_f32_16x16x32_bf16 v[60:63], v[132:135], a[28:31], v[60:63]
    ds_read_b64_tr_b16 v[128:129], v24 offset:0
    v_mfma_f32_16x16x32_bf16 v[56:59], v[132:135], a[24:27], v[56:59]
    ds_read_b64_tr_b16 v[130:131], v24 offset:512
    v_mfma_f32_16x16x32_bf16 v[72:75], v[136:139], a[24:27], v[72:75]
    ds_read_b64_tr_b16 v[132:133], v25 offset:0
    v_mfma_f32_16x16x32_bf16 v[76:79], v[136:139], a[28:31], v[76:79]
    ds_read_b64_tr_b16 v[134:135], v25 offset:512
    v_mfma_f32_16x16x32_bf16 v[92:95], v[140:143], a[28:31], v[92:95]
    ds_read_b64_tr_b16 v[136:137], v24 offset:8192
    buffer_load_dwordx4 a[20:23], v6, s[16:19], s51 offen offset:2304 sc1
    v_mfma_f32_16x16x32_bf16 v[88:91], v[140:143], a[24:27], v[88:91]
    ds_read_b64_tr_b16 v[138:139], v24 offset:8704
    v_mfma_f32_16x16x32_bf16 v[104:107], a[24:27], v[144:147], v[104:107]
    ds_read_b64_tr_b16 v[140:141], v25 offset:8192
    s_add_u32 s51, s51, 8192
    v_mfma_f32_16x16x32_bf16 v[108:111], a[28:31], v[144:147], v[108:111]
    ds_read_b64_tr_b16 v[142:143], v25 offset:8704
    v_mfma_f32_16x16x32_bf16 v[124:127], a[28:31], v[148:151], v[124:127]
    ds_read_b64_tr_b16 v[144:145], v24 offset:16384
    s_cmp_lg_u32 s54, 0
    v_mfma_f32_16x16x32_bf16 v[120:123], a[24:27], v[148:151], v[120:123]
    ds_read_b64_tr_b16 v[146:147], v24 offset:16896
    s_cbranch_scc1 c_qkvA_loop
    s_waitcnt vmcnt(12) lgkmcnt(8)
    v_mfma_f32_16x16x32_bf16 v[184:187], v[188:191], v[192:195], v[184:187]
    v_mfma_f32_16x16x32_bf16 v[32:35], v[128:131], v[152:155], v[32:35]
    ds_read_b64_tr_b16 v[148:149], v25 offset:16384
    buffer_load_dwordx4 a[24:27], v6, s[20:23], s58 offen offset:0 sc1
    v_mfma_f32_16x16x32_bf16 v[36:39], v[128:131], v[156:159], v[36:39]
    ds_read_b64_tr_b16 v[150:151], v25 offset:16896
    s_waitcnt lgkmcnt(8)
    v_mfma_f32_16x16x32_bf16 v[52:55], v[132:135], v[156:159], v[52:55]
    ds_read_b32 v16, v8 offset:1280
    v_mfma_f32_16x16x32_bf16 v[48:51], v[132:135], v[152:155], v[48:51]
    ds_read_b64_tr_b16 v[188:189], v28 offset:0
    ds_read_b32 v18, v8 offset:1344
    s_waitcnt lgkmcnt(9)
    v_mfma_f32_16x16x32_bf16 v[64:67], v[136:139], v[152:155], v[64:67]
    ds_read_b32 v20, v8 offset:1408
    v_mfma_f32_16x16x32_bf16 v[68:71], v[136:139], v[156:159], v[68:71]
    ds_read_b64_tr_b16 v[190:191], v28 offset:512
    s_waitcnt lgkmcnt(9)
    v_mfma_f32_16x16x32_bf16 v[84:87], v[140:143], v[156:159], v[84:87]
    buffer_load_dwordx4 a[28:31], v6, s[20:23], s58 offen offset:256 sc1
    ds_read_b32 v22, v8 offset:1472
    v_mfma_f32_16x16x32_bf16 v[80:83], v[140:143], v[152:155], v[80:83]
    ds_read_b128 v[192:195], v30 offset:0
    ds_read_b128 v[212:215], v10 offset:128
    s_waitcnt lgkmcnt(10)
    v_mfma_f32_16x16x32_bf16 v[96:99], v[152:155], v[144:147], v[96:99]
    ds_read_b128 v[216:219], v10 offset:192
    v_mfma_f32_16x16x32_bf16 v[100:103], v[156:159], v[144:147], v[100:103]
    s_waitcnt lgkmcnt(9)
    v_mfma_f32_16x16x32_bf16 v[116:119], v[156:159], v[148:151], v[116:119]
    v_mfma_f32_16x16x32_bf16 v[112:115], v[152:155], v[148:151], v[112:115]
    s_waitcnt vmcnt(12)
    v_mfma_f32_16x16x32_bf16 v[40:43], v[128:131], v[160:163], v[40:43]
    s_waitcnt lgkmcnt(0)
    v_fma_f32 v64, -v16, v212, v64
    v_fma_f32 v65, -v16, v213, v65
    v_mfma_f32_16x16x32_bf16 v[44:47], v[128:131], v[164:167], v[44:47]
    v_fma_f32 v66, -v16, v214, v66
    v_mfma_f32_16x16x32_bf16 v[60:63], v[132:135], v[164:167], v[60:63]
    ds_read_b64_tr_b16 v[128:129], v24 offset:2048
    v_fma_f32 v67, -v16, v215, v67
    v_mfma_f32_16x16x32_bf16 v[56:59], v[132:135], v[160:163], v[56:59]
    ds_read_b64_tr_b16 v[130:131], v24 offset:2560
    v_fma_f32 v68, -v18, v212, v68
    v_fma_f32 v69, -v18, v213, v69
    v_mfma_f32_16x16x32_bf16 v[72:75], v[136:139], v[160:163], v[72:75]
    ds_read_b64_tr_b16 v[132:133], v25 offset:2048
    v_fma_f32 v70, -v18, v214, v70
    v_mfma_f32_16x16x32_bf16 v[76:79], v[136:139], v[164:167], v[76:79]
    ds_read_b64_tr_b16 v[134:135], v25 offset:2560
    v_fma_f32 v71, -v18, v215, v71
    v_mfma_f32_16x16x32_bf16 v[92:95], v[140:143], v[164:167], v[92:95]
    ds_read_b64_tr_b16 v[136:137], v24 offset:10240
    v_fma_f32 v80, -v16, v216, v80
    v_fma_f32 v81, -v16, v217, v81
    v_mfma_f32_16x16x32_bf16 v[88:91], v[140:143], v[160:163], v[88:91]
    ds_read_b64_tr_b16 v[138:139], v24 offset:10752
    v_fma_f32 v82, -v16, v218, v82
    v_mfma_f32_16x16x32_bf16 v[104:107], v[160:163], v[144:147], v[104:107]
    ds_read_b64_tr_b16 v[140:141], v25 offset:10240
    v_fma_f32 v83, -v16, v219, v83
    v_mfma_f32_16x16x32_bf16 v[108:111], v[164:167], v[144:147], v[108:111]
    ds_read_b64_tr_b16 v[142:143], v25 offset:10752
    v_fma_f32 v84, -v18, v216, v84
    v_fma_f32 v85, -v18, v217, v85
    v_mfma_f32_16x16x32_bf16 v[124:127], v[164:167], v[148:151], v[124:127]
    ds_read_b64_tr_b16 v[144:145], v24 offset:18432
    v_fma_f32 v86, -v18, v218, v86
    v_mfma_f32_16x16x32_bf16 v[120:123], v[160:163], v[148:151], v[120:123]
    ds_read_b64_tr_b16 v[146:147], v24 offset:18944
    v_fma_f32 v87, -v18, v219, v87
    s_waitcnt vmcnt(10) lgkmcnt(8)
    v_mfma_f32_16x16x32_bf16 v[184:187], v[188:191], v[192:195], v[184:187]
    v_mfma_f32_16x16x32_bf16 v[32:35], v[128:131], v[168:171], v[32:35]
    ds_read_b64_tr_b16 v[148:149], v25 offset:18432
    v_fma_f32 v72, -v20, v212, v72
    v_fma_f32 v73, -v20, v213, v73
    v_mfma_f32_16x16x32_bf16 v[36:39], v[128:131], v[172:175], v[36:39]
    ds_read_b64_tr_b16 v[150:151], v25 offset:18944
    v_fma_f32 v74, -v20, v214, v74
    s_waitcnt lgkmcnt(8)
    v_mfma_f32_16x16x32_bf16 v[52:55], v[132:135], v[172:175], v[52:55]
    v_fma_f32 v75, -v20, v215, v75
    ds_read_b128 v[152:155], v10 offset:0
    v_mfma_f32_16x16x32_bf16 v[48:51], v[132:135], v[168:171], v[48:51]
    ds_read_b64_tr_b16 v[188:189], v28 offset:2048
    v_fma_f32 v76, -v22, v212, v76
    v_fma_f32 v77, -v22, v213, v77
    ds_read_b128 v[156:159], v10 offset:64
    s_waitcnt lgkmcnt(9)
    v_mfma_f32_16x16x32_bf16 v[64:67], v[136:139], v[168:171], v[64:67]
    v_fma_f32 v78, -v22, v214, v78
    ds_read_b32 v17, v8 offset:2816
    v_mfma_f32_16x16x32_bf16 v[68:71], v[136:139], v[172:175], v[68:71]
    ds_read_b64_tr_b16 v[190:191], v28 offset:2560
    v_fma_f32 v79, -v22, v215, v79
    s_waitcnt lgkmcnt(9)
    v_mfma_f32_16x16x32_bf16 v[84:87], v[140:143], v[172:175], v[84:87]
    v_fma_f32 v88, -v20, v216, v88
    v_fma_f32 v89, -v20, v217, v89
    ds_read_b32 v19, v8 offset:2880
    v_mfma_f32_16x16x32_bf16 v[80:83], v[140:143], v[168:171], v[80:83]
    ds_read_b128 v[192:195], v30 offset:1024
    v_fma_f32 v90, -v20, v218, v90
    ds_read_b32 v21, v8 offset:2944
    s_waitcnt lgkmcnt(10)
    v_mfma_f32_16x16x32_bf16 v[96:99], v[168:171], v[144:147], v[96:99]
    v_fma_f32 v91, -v20, v219, v91
    ds_read_b32 v23, v8 offset:3008
    v_mfma_f32_16x16x32_bf16 v[100:103], v[172:175], v[144:147], v[100:103]
    v_fma_f32 v92, -v22, v216, v92
    v_fma_f32 v93, -v22, v217, v93
    s_waitcnt lgkmcnt(9)
    v_mfma_f32_16x16x32_bf16 v[116:119], v[172:175], v[148:151], v[116:119]
    v_fma_f32 v94, -v22, v218, v94
    v_mfma_f32_16x16x32_bf16 v[112:115], v[168:171], v[148:151], v[112:115]
    v_fma_f32 v95, -v22, v219, v95
    s_waitcnt vmcnt(8)
    v_mfma_f32_16x16x32_bf16 v[40:43], v[128:131], v[176:179], v[40:43]
    s_waitcnt lgkmcnt(0)
    v_fma_f32 v32, -v16, v152, v32
    v_fma_f32 v33, -v16, v153, v33
    v_mfma_f32_16x16x32_bf16 v[44:47], v[128:131], v[180:183], v[44:47]
    v_fma_f32 v34, -v16, v154, v34
    v_mfma_f32_16x16x32_bf16 v[60:63], v[132:135], v[180:183], v[60:63]
    ds_read_b64_tr_b16 v[128:129], v24 offset:4096
    v_fma_f32 v35, -v16, v155, v35
    v_fma_f32 v36, -v18, v152, v36
    v_mfma_f32_16x16x32_bf16 v[56:59], v[132:135], v[176:179], v[56:59]
    ds_read_b64_tr_b16 v[130:131], v24 offset:4608
    v_fma_f32 v37, -v18, v153, v37
    v_mfma_f32_16x16x32_bf16 v[72:75], v[136:139], v[176:179], v[72:75]
    ds_read_b64_tr_b16 v[132:133], v25 offset:4096
    v_fma_f32 v38, -v18, v154, v38
    v_fma_f32 v39, -v18, v155, v39
    v_mfma_f32_16x16x32_bf16 v[76:79], v[136:139], v[180:183], v[76:79]
    ds_read_b64_tr_b16 v[134:135], v25 offset:4608
    v_fma_f32 v48, -v16, v156, v48
    v_mfma_f32_16x16x32_bf16 v[92:95], v[140:143], v[180:183], v[92:95]
    ds_read_b64_tr_b16 v[136:137], v24 offset:12288
    v_fma_f32 v49, -v16, v157, v49
    v_fma_f32 v50, -v16, v158, v50
    v_mfma_f32_16x16x32_bf16 v[88:91], v[140:143], v[176:179], v[88:91]
    ds_read_b64_tr_b16 v[138:139], v24 offset:12800
    v_fma_f32 v51, -v16, v159, v51
    v_mfma_f32_16x16x32_bf16 v[104:107], v[176:179], v[144:147], v[104:107]
    ds_read_b64_tr_b16 v[140:141], v25 offset:12288
    v_fma_f32 v52, -v18, v156, v52
    v_fma_f32 v53, -v18, v157, v53
    v_mfma_f32_16x16x32_bf16 v[108:111], v[180:183], v[144:147], v[108:111]
    ds_read_b64_tr_b16 v[142:143], v25 offset:12800
    v_fma_f32 v54, -v18, v158, v54
    v_mfma_f32_16x16x32_bf16 v[124:127], v[180:183], v[148:151], v[124:127]
    ds_read_b64_tr_b16 v[144:145], v24 offset:20480
    v_fma_f32 v55, -v18, v159, v55
    v_mfma_f32_16x16x32_bf16 v[120:123], v[176:179], v[148:151], v[120:123]
    ds_read_b64_tr_b16 v[146:147], v24 offset:20992
    s_waitcnt vmcnt(6) lgkmcnt(8)
    v_mfma_f32_16x16x32_bf16 v[184:187], v[188:191], v[192:195], v[184:187]
    v_mfma_f32_16x16x32_bf16 v[32:35], v[128:131], a[0:3], v[32:35]
    ds_read_b64_tr_b16 v[148:149], v25 offset:20480
    v_fma_f32 v40, -v20, v152, v40
    v_fma_f32 v41, -v20, v153, v41
    v_mfma_f32_16x16x32_bf16 v[36:39], v[128:131], a[4:7], v[36:39]
    ds_read_b64_tr_b16 v[150:151], v25 offset:20992
    v_fma_f32 v42, -v20, v154, v42
    s_waitcnt lgkmcnt(8)
    v_mfma_f32_16x16x32_bf16 v[52:55], v[132:135], a[4:7], v[52:55]
    v_fma_f32 v43, -v20, v155, v43
    v_fma_f32 v44, -v22, v152, v44
    ds_read_b128 v[168:171], v9 offset:1280
    v_mfma_f32_16x16x32_bf16 v[48:51], v[132:135], a[0:3], v[48:51]
    ds_read_b64_tr_b16 v[188:189], v28 offset:4096
    v_fma_f32 v45, -v22, v153, v45
    ds_read_b128 v[172:175], v9 offset:1344
    s_waitcnt lgkmcnt(9)
    v_mfma_f32_16x16x32_bf16 v[64:67], v[136:139], a[0:3], v[64:67]
    v_fma_f32 v46, -v22, v154, v46
    v_fma_f32 v47, -v22, v155, v47
    v_mfma_f32_16x16x32_bf16 v[68:71], v[136:139], a[4:7], v[68:71]
    ds_read_b64_tr_b16 v[190:191], v28 offset:4608
    v_fma_f32 v56, -v20, v156, v56
    ds_read_b128 v[176:179], v9 offset:1408
    s_waitcnt lgkmcnt(9)
    v_mfma_f32_16x16x32_bf16 v[84:87], v[140:143], a[4:7], v[84:87]
    v_fma_f32 v57, -v20, v157, v57
    v_fma_f32 v58, -v20, v158, v58
    ds_read_b128 v[180:183], v9 offset:1472
    v_mfma_f32_16x16x32_bf16 v[80:83], v[140:143], a[0:3], v[80:83]
    ds_read_b128 v[192:195], v30 offset:2048
    v_fma_f32 v59, -v20, v159, v59
    s_waitcnt lgkmcnt(9)
    v_mfma_f32_16x16x32_bf16 v[96:99], a[0:3], v[144:147], v[96:99]
    v_fma_f32 v60, -v22, v156, v60
    v_fma_f32 v61, -v22, v157, v61
    ds_read2_b32 v[220:221], v11 offset0:64 offset1:80
    v_mfma_f32_16x16x32_bf16 v[100:103], a[4:7], v[144:147], v[100:103]
    v_fma_f32 v62, -v22, v158, v62
    s_waitcnt lgkmcnt(8)
    v_mfma_f32_16x16x32_bf16 v[116:119], a[4:7], v[148:151], v[116:119]
    v_fma_f32 v63, -v22, v159, v63
    v_mfma_f32_16x16x32_bf16 v[112:115], a[0:3], v[148:151], v[112:115]
    s_waitcnt vmcnt(4)
    v_mfma_f32_16x16x32_bf16 v[40:43], v[128:131], a[8:11], v[40:43]
    v_mfma_f32_16x16x32_bf16 v[44:47], v[128:131], a[12:15], v[44:47]
    s_waitcnt lgkmcnt(0)
    v_fma_f32 v96, -v168, v220, v96
    v_fma_f32 v97, -v169, v220, v97
    v_mfma_f32_16x16x32_bf16 v[60:63], v[132:135], a[12:15], v[60:63]
    ds_read_b64_tr_b16 v[128:129], v24 offset:6144
    v_fma_f32 v98, -v170, v220, v98
    v_mfma_f32_16x16x32_bf16 v[56:59], v[132:135], a[8:11], v[56:59]
    ds_read_b64_tr_b16 v[130:131], v24 offset:6656
    v_fma_f32 v99, -v171, v220, v99
    v_fma_f32 v100, -v172, v220, v100
    v_mfma_f32_16x16x32_bf16 v[72:75], v[136:139], a[8:11], v[72:75]
    ds_read_b64_tr_b16 v[132:133], v25 offset:6144
    v_fma_f32 v101, -v173, v220, v101
    v_mfma_f32_16x16x32_bf16 v[76:79], v[136:139], a[12:15], v[76:79]
    ds_read_b64_tr_b16 v[134:135], v25 offset:6656
    v_fma_f32 v102, -v174, v220, v102
    v_fma_f32 v103, -v175, v220, v103
    v_mfma_f32_16x16x32_bf16 v[92:95], v[140:143], a[12:15], v[92:95]
    ds_read_b64_tr_b16 v[136:137], v24 offset:14336
    v_fma_f32 v112, -v168, v221, v112
    v_mfma_f32_16x16x32_bf16 v[88:91], v[140:143], a[8:11], v[88:91]
    ds_read_b64_tr_b16 v[138:139], v24 offset:14848
    v_fma_f32 v113, -v169, v221, v113
    v_fma_f32 v114, -v170, v221, v114
    v_mfma_f32_16x16x32_bf16 v[104:107], a[8:11], v[144:147], v[104:107]
    ds_read_b64_tr_b16 v[140:141], v25 offset:14336
    v_fma_f32 v115, -v171, v221, v115
    v_mfma_f32_16x16x32_bf16 v[108:111], a[12:15], v[144:147], v[108:111]
    ds_read_b64_tr_b16 v[142:143], v25 offset:14848
    v_fma_f32 v116, -v172, v221, v116
    v_fma_f32 v117, -v173, v221, v117
    v_mfma_f32_16x16x32_bf16 v[124:127], a[12:15], v[148:151], v[124:127]
    ds_read_b64_tr_b16 v[144:145], v24 offset:22528
    v_fma_f32 v118, -v174, v221, v118
    v_mfma_f32_16x16x32_bf16 v[120:123], a[8:11], v[148:151], v[120:123]
    ds_read_b64_tr_b16 v[146:147], v24 offset:23040
    v_fma_f32 v119, -v175, v221, v119
    s_waitcnt vmcnt(2) lgkmcnt(8)
    v_mfma_f32_16x16x32_bf16 v[184:187], v[188:191], v[192:195], v[184:187]
    v_mfma_f32_16x16x32_bf16 v[32:35], v[128:131], a[16:19], v[32:35]
    ds_read_b64_tr_b16 v[148:149], v25 offset:22528
    v_mfma_f32_16x16x32_bf16 v[36:39], v[128:131], a[20:23], v[36:39]
    ds_read_b64_tr_b16 v[150:151], v25 offset:23040
    v_fma_f32 v104, -v176, v220, v104
    v_fma_f32 v105, -v177, v220, v105
    s_waitcnt lgkmcnt(8)
    v_mfma_f32_16x16x32_bf16 v[52:55], v[132:135], a[20:23], v[52:55]
    v_fma_f32 v106, -v178, v220, v106
    ds_read_b128 v[152:155], v9 offset:2816
    v_mfma_f32_16x16x32_bf16 v[48:51], v[132:135], a[16:19], v[48:51]
    ds_read_b64_tr_b16 v[188:189], v28 offset:6144
    v_fma_f32 v107, -v179, v220, v107
    v_fma_f32 v108, -v180, v220, v108
    ds_read_b128 v[156:159], v9 offset:2880
    s_waitcnt lgkmcnt(9)
    v_mfma_f32_16x16x32_bf16 v[64:67], v[136:139], a[16:19], v[64:67]
    v_fma_f32 v109, -v181, v220, v109
    ds_read_b128 v[160:163], v9 offset:2944
    v_mfma_f32_16x16x32_bf16 v[68:71], v[136:139], a[20:23], v[68:71]
    ds_read_b64_tr_b16 v[190:191], v28 offset:6656
    v_fma_f32 v110, -v182, v220, v110
    v_fma_f32 v111, -v183, v220, v111
    ds_read_b128 v[164:167], v9 offset:3008
    s_waitcnt lgkmcnt(10)
    v_mfma_f32_16x16x32_bf16 v[84:87], v[140:143], a[20:23], v[84:87]
    v_fma_f32 v120, -v176, v221, v120
    ds_read_b128 v[212:215], v14 offset:128
    v_mfma_f32_16x16x32_bf16 v[80:83], v[140:143], a[16:19], v[80:83]
    ds_read_b128 v[192:195], v30 offset:3072
    v_fma_f32 v121, -v177, v221, v121
    v_fma_f32 v122, -v178, v221, v122
    ds_read_b32 v222, v11 offset:1216
    s_waitcnt lgkmcnt(11)
    v_mfma_f32_16x16x32_bf16 v[96:99], a[16:19], v[144:147], v[96:99]
    v_fma_f32 v123, -v179, v221, v123
    ds_read_b32 v223, v11 offset:2752
    v_mfma_f32_16x16x32_bf16 v[100:103], a[20:23], v[144:147], v[100:103]
    v_fma_f32 v124, -v180, v221, v124
    v_fma_f32 v125, -v181, v221, v125
    s_waitcnt lgkmcnt(10)
    v_mfma_f32_16x16x32_bf16 v[116:119], a[20:23], v[148:151], v[116:119]
    v_fma_f32 v126, -v182, v221, v126
    s_waitcnt lgkmcnt(2)
    v_mfma_f32_16x16x32_bf16 v[112:115], a[16:19], v[148:151], v[112:115]
    v_fma_f32 v127, -v183, v221, v127
    s_barrier
    s_waitcnt vmcnt(0)
    v_mfma_f32_16x16x32_bf16 v[40:43], v[128:131], a[24:27], v[40:43]
    v_mul_f32 v64, v17, v64
    v_mul_f32 v65, v17, v65
    v_mfma_f32_16x16x32_bf16 v[44:47], v[128:131], a[28:31], v[44:47]
    v_mul_f32 v66, v17, v66
    v_mul_f32 v67, v17, v67
    v_mfma_f32_16x16x32_bf16 v[60:63], v[132:135], a[28:31], v[60:63]
    v_mul_f32 v80, v17, v80
    v_mul_f32 v81, v17, v81
    v_mfma_f32_16x16x32_bf16 v[56:59], v[132:135], a[24:27], v[56:59]
    v_mul_f32 v82, v17, v82
    v_mul_f32 v83, v17, v83
    v_mfma_f32_16x16x32_bf16 v[72:75], v[136:139], a[24:27], v[72:75]
    v_cvt_pk_bf16_f32 v64, v64, v65
    v_cvt_pk_bf16_f32 v65, v66, v67
    v_mfma_f32_16x16x32_bf16 v[76:79], v[136:139], a[28:31], v[76:79]
    v_cvt_pk_bf16_f32 v66, v80, v81
    v_cvt_pk_bf16_f32 v67, v82, v83
    v_mfma_f32_16x16x32_bf16 v[92:95], v[140:143], a[28:31], v[92:95]
    v_mul_f32 v68, v19, v68
    v_mul_f32 v69, v19, v69
    v_mfma_f32_16x16x32_bf16 v[88:91], v[140:143], a[24:27], v[88:91]
    v_mul_f32 v70, v19, v70
    v_mul_f32 v71, v19, v71
    v_mfma_f32_16x16x32_bf16 v[104:107], a[24:27], v[144:147], v[104:107]
    v_mul_f32 v84, v19, v84
    v_mul_f32 v85, v19, v85
    v_mfma_f32_16x16x32_bf16 v[108:111], a[28:31], v[144:147], v[108:111]
    v_mul_f32 v86, v19, v86
    v_mul_f32 v87, v19, v87
    v_mfma_f32_16x16x32_bf16 v[124:127], a[28:31], v[148:151], v[124:127]
    v_cvt_pk_bf16_f32 v68, v68, v69
    v_cvt_pk_bf16_f32 v69, v70, v71
    v_mfma_f32_16x16x32_bf16 v[120:123], a[24:27], v[148:151], v[120:123]
    v_cvt_pk_bf16_f32 v70, v84, v85
    v_cvt_pk_bf16_f32 v71, v86, v87
    v_mfma_f32_16x16x32_bf16 v[184:187], v[188:191], v[192:195], v[184:187]
    v_pk_mul_f32 v[72:73], v[20:21], v[72:73] op_sel:[1,0] op_sel_hi:[1,1]
    v_pk_mul_f32 v[74:75], v[20:21], v[74:75] op_sel:[1,0] op_sel_hi:[1,1]
    v_pk_mul_f32 v[88:89], v[20:21], v[88:89] op_sel:[1,0] op_sel_hi:[1,1]
    v_pk_mul_f32 v[90:91], v[20:21], v[90:91] op_sel:[1,0] op_sel_hi:[1,1]
    v_cvt_pk_bf16_f32 v72, v72, v73
    v_cvt_pk_bf16_f32 v73, v74, v75
    v_cvt_pk_bf16_f32 v74, v88, v89
    v_cvt_pk_bf16_f32 v75, v90, v91
    v_pk_mul_f32 v[76:77], v[22:23], v[76:77] op_sel:[1,0] op_sel_hi:[1,1]
    v_pk_mul_f32 v[78:79], v[22:23], v[78:79] op_sel:[1,0] op_sel_hi:[1,1]
    v_pk_mul_f32 v[92:93], v[22:23], v[92:93] op_sel:[1,0] op_sel_hi:[1,1]
    v_pk_mul_f32 v[94:95], v[22:23], v[94:95] op_sel:[1,0] op_sel_hi:[1,1]
    v_cvt_pk_bf16_f32 v76, v76, v77
    v_cvt_pk_bf16_f32 v77, v78, v79
    v_cvt_pk_bf16_f32 v78, v92, v93
    v_cvt_pk_bf16_f32 v79, v94, v95
    ds_write_b128 v12, v[76:79] offset:2048
    s_waitcnt lgkmcnt(1)
    v_pk_mul_f32 v[96:97], v[152:153], v[96:97]
    v_pk_mul_f32 v[98:99], v[154:155], v[98:99]
    v_pk_mul_f32 v[112:113], v[152:153], v[112:113]
    v_pk_mul_f32 v[114:115], v[154:155], v[114:115]
    v_cvt_pk_bf16_f32 v99, v98, v99
    v_cvt_pk_bf16_f32 v98, v96, v97
    v_cvt_pk_bf16_f32 v115, v114, v115
    v_cvt_pk_bf16_f32 v114, v112, v113
    v_pk_mul_f32 v[100:101], v[156:157], v[100:101]
    v_pk_mul_f32 v[102:103], v[158:159], v[102:103]
    v_pk_mul_f32 v[116:117], v[156:157], v[116:117]
    v_pk_mul_f32 v[118:119], v[158:159], v[118:119]
    v_cvt_pk_bf16_f32 v100, v100, v101
    v_cvt_pk_bf16_f32 v101, v102, v103
    v_cvt_pk_bf16_f32 v116, v116, v117
    v_cvt_pk_bf16_f32 v117, v118, v119
    v_pk_mul_f32 v[104:105], v[160:161], v[104:105]
    v_pk_mul_f32 v[106:107], v[162:163], v[106:107]
    v_pk_mul_f32 v[120:121], v[160:161], v[120:121]
    v_pk_mul_f32 v[122:123], v[162:163], v[122:123]
    v_cvt_pk_bf16_f32 v102, v104, v105
    v_cvt_pk_bf16_f32 v103, v106, v107
    v_cvt_pk_bf16_f32 v118, v120, v121
    v_cvt_pk_bf16_f32 v119, v122, v123
    v_pk_mul_f32 v[108:109], v[164:165], v[108:109]
    v_pk_mul_f32 v[110:111], v[166:167], v[110:111]
    v_pk_mul_f32 v[124:125], v[164:165], v[124:125]
    v_pk_mul_f32 v[126:127], v[166:167], v[126:127]
    v_cvt_pk_bf16_f32 v104, v108, v109
    v_cvt_pk_bf16_f32 v105, v110, v111
    v_cvt_pk_bf16_f32 v120, v124, v125
    v_cvt_pk_bf16_f32 v121, v126, v127
    ds_write_b64 v12, v[104:105] offset:3072
    ds_write_b64 v12, v[120:121] offset:3080
    v_pk_fma_f32 v[184:185], v[222:223], v[212:213], v[184:185] op_sel_hi:[0,1,1] neg_lo:[1,0,0] neg_hi:[1,0,0]
    v_pk_fma_f32 v[186:187], v[222:223], v[214:215], v[186:187] op_sel_hi:[0,1,1] neg_lo:[1,0,0] neg_hi:[1,0,0]
    v_pk_mul_f32 v[184:185], v[222:223], v[184:185] op_sel:[1,0] op_sel_hi:[1,1]
    v_pk_mul_f32 v[186:187], v[222:223], v[186:187] op_sel:[1,0] op_sel_hi:[1,1]
    v_cvt_pk_bf16_f32 v184, v184, v185
    v_cvt_pk_bf16_f32 v185, v186, v187
    s_cmp_ge_u32 s8, 2
    s_cbranch_scc1 c_qkvA_hv
    ds_write_b64 v13, v[184:185]
    s_branch c_qkvA_hd
c_qkvA_hv:
    ds_write_b16 v13, v184 offset:0
    ds_write_b16_d16_hi v13, v184 offset:16
    ds_write_b16 v13, v185 offset:32
    ds_write_b16_d16_hi v13, v185 offset:48
c_qkvA_hd:
    v_cvt_pk_bf16_f32 v44, v44, v45
    v_cvt_pk_bf16_f32 v45, v46, v47
    v_cvt_pk_bf16_f32 v46, v60, v61
    v_cvt_pk_bf16_f32 v47, v62, v63
    v_mul_f32 v23, 0x3e8293ee, v23
    v_cvt_pk_bf16_f32 v40, v40, v41
    v_mfma_f32_16x16x32_bf16 v[156:159], v[76:79], v[44:47], v[196:199]
    v_cvt_pk_bf16_f32 v41, v42, v43
    v_cvt_pk_bf16_f32 v42, v56, v57
    v_mfma_f32_16x16x32_bf16 v[152:155], v[72:75], v[44:47], v[200:203]
    v_cvt_pk_bf16_f32 v43, v58, v59
    v_mul_f32 v21, 0x3e8293ee, v21
    s_waitcnt lgkmcnt(0)
    s_barrier
    ds_read_b128 v[172:175], v12
    ds_read_b64 v[96:97], v12 offset:1024
    ds_read_b64 v[112:113], v12 offset:1032
    v_mfma_f32_16x16x32_bf16 v[148:151], v[72:75], v[40:43], v[196:199]
    v_cvt_pk_bf16_f32 v36, v36, v37
    v_cvt_pk_bf16_f32 v37, v38, v39
    v_mfma_f32_16x16x32_bf16 v[144:147], v[68:71], v[40:43], v[200:203]
    v_cvt_pk_bf16_f32 v38, v52, v53
    v_cvt_pk_bf16_f32 v39, v54, v55
    v_mul_f32 v19, 0x3e8293ee, v19
    v_cvt_pk_bf16_f32 v32, v32, v33
    v_mfma_f32_16x16x32_bf16 v[140:143], v[68:71], v[36:39], v[196:199]
    v_cvt_pk_bf16_f32 v33, v34, v35
    v_cvt_pk_bf16_f32 v34, v48, v49
    v_mfma_f32_16x16x32_bf16 v[136:139], v[64:67], v[36:39], v[200:203]
    v_cvt_pk_bf16_f32 v35, v50, v51
    v_mul_f32 v17, 0x3e8293ee, v17
    v_max3_f32 v179, v152, v153, v154
    s_waitcnt lgkmcnt(2)
    v_mfma_f32_16x16x32_bf16 v[132:135], v[64:67], v[32:35], v[196:199]
    v_max3_f32 v179, v179, v155, v156
    v_max3_f32 v179, v179, v157, v158
    v_mfma_f32_16x16x32_bf16 v[128:131], v[172:175], v[32:35], v[204:207]
    v_max_f32 v179, v179, v159
    v_mov_b32 v183, v179
    v_max3_f32 v178, v144, v145, v146
    v_max3_f32 v178, v178, v147, v148
    v_max3_f32 v178, v178, v149, v150
    v_max_f32 v178, v178, v151
    v_mov_b32 v182, v178
    v_max3_f32 v177, v136, v137, v138
    v_max3_f32 v177, v177, v139, v140
    v_max3_f32 v177, v177, v141, v142
    v_max_f32 v177, v177, v143
    v_mov_b32 v181, v177
    v_permlane32_swap_b32 v179, v183
    v_permlane32_swap_b32 v178, v182
    v_permlane32_swap_b32 v177, v181
    v_max3_f32 v176, v128, v129, v130
    v_max3_f32 v176, v176, v131, v132
    v_max3_f32 v176, v176, v133, v134
    v_max_f32 v176, v176, v135
    v_mov_b32 v180, v176
    v_max_f32 v179, v179, v183
    v_max_f32 v178, v178, v182
    v_max_f32 v177, v177, v181
    v_permlane32_swap_b32 v176, v180
    v_mov_b32 v183, v179
    v_mov_b32 v182, v178
    v_mov_b32 v181, v177
    v_max_f32 v176, v176, v180
    v_mov_b32 v180, v176
    v_permlane16_swap_b32 v179, v183
    v_permlane16_swap_b32 v178, v182
    v_permlane16_swap_b32 v177, v181
    v_permlane16_swap_b32 v176, v180
    v_max_f32 v179, v179, v183
    v_max_f32 v178, v178, v182
    v_max_f32 v177, v177, v181
    v_max_f32 v176, v176, v180
    v_mul_f32_e64 v22, -v179, v23
    v_mul_f32_e64 v20, -v178, v21
    v_mul_f32_e64 v18, -v177, v19
    v_mul_f32_e64 v16, -v176, v17
    s_waitcnt lgkmcnt(0)
    s_add_u32 s51, s49, 65536
    v_pk_fma_f32 v[152:153], v[152:153], v[22:23], v[22:23] op_sel:[0,1,0] op_sel_hi:[1,1,0]
    v_pk_fma_f32 v[154:155], v[154:155], v[22:23], v[22:23] op_sel:[0,1,0] op_sel_hi:[1,1,0]
    v_pk_fma_f32 v[156:157], v[156:157], v[22:23], v[22:23] op_sel:[0,1,0] op_sel_hi:[1,1,0]
    v_pk_fma_f32 v[158:159], v[158:159], v[22:23], v[22:23] op_sel:[0,1,0] op_sel_hi:[1,1,0]
    v_pk_fma_f32 v[144:145], v[144:145], v[20:21], v[20:21] op_sel:[0,1,0] op_sel_hi:[1,1,0]
    v_pk_fma_f32 v[146:147], v[146:147], v[20:21], v[20:21] op_sel:[0,1,0] op_sel_hi:[1,1,0]
    v_pk_fma_f32 v[148:149], v[148:149], v[20:21], v[20:21] op_sel:[0,1,0] op_sel_hi:[1,1,0]
    v_pk_fma_f32 v[150:151], v[150:151], v[20:21], v[20:21] op_sel:[0,1,0] op_sel_hi:[1,1,0]
    v_pk_fma_f32 v[136:137], v[136:137], v[18:19], v[18:19] op_sel:[0,1,0] op_sel_hi:[1,1,0]
    v_pk_fma_f32 v[138:139], v[138:139], v[18:19], v[18:19] op_sel:[0,1,0] op_sel_hi:[1,1,0]
    v_pk_fma_f32 v[140:141], v[140:141], v[18:19], v[18:19] op_sel:[0,1,0] op_sel_hi:[1,1,0]
    v_pk_fma_f32 v[142:143], v[142:143], v[18:19], v[18:19] op_sel:[0,1,0] op_sel_hi:[1,1,0]
    v_pk_fma_f32 v[128:129], v[128:129], v[16:17], v[16:17] op_sel:[0,1,0] op_sel_hi:[1,1,0]
    v_pk_fma_f32 v[130:131], v[130:131], v[16:17], v[16:17] op_sel:[0,1,0] op_sel_hi:[1,1,0]
    v_pk_fma_f32 v[132:133], v[132:133], v[16:17], v[16:17] op_sel:[0,1,0] op_sel_hi:[1,1,0]
    v_pk_fma_f32 v[134:135], v[134:135], v[16:17], v[16:17] op_sel:[0,1,0] op_sel_hi:[1,1,0]
    v_exp_f32 v152, v152
    v_exp_f32 v153, v153
    v_exp_f32 v154, v154
    v_exp_f32 v155, v155
    v_exp_f32 v156, v156
    v_exp_f32 v157, v157
    v_exp_f32 v158, v158
    v_exp_f32 v159, v159
    v_cvt_pk_bf16_f32 v172, v152, v153
    v_cvt_pk_bf16_f32 v173, v154, v155
    v_cvt_pk_bf16_f32 v174, v156, v157
    v_cvt_pk_bf16_f32 v175, v158, v159
    v_exp_f32 v144, v144
    v_exp_f32 v145, v145
    v_mfma_f32_16x16x32_bf16 v[92:95], v[208:211], v[172:175], 0
    v_exp_f32 v146, v146
    v_mfma_f32_16x16x32_bf16 v[60:63], v[102:105], v[172:175], 0
    v_exp_f32 v147, v147
    v_mfma_f32_16x16x32_bf16 v[76:79], v[118:121], v[172:175], 0
    v_exp_f32 v148, v148
    v_exp_f32 v149, v149
    v_exp_f32 v150, v150
    v_exp_f32 v151, v151
    v_rcp_f32 v92, v92
    v_cvt_pk_bf16_f32 v168, v144, v145
    v_cvt_pk_bf16_f32 v169, v146, v147
    v_cvt_pk_bf16_f32 v170, v148, v149
    v_cvt_pk_bf16_f32 v171, v150, v151
    v_pk_mul_f32 v[60:61], v[92:93], v[60:61] op_sel_hi:[0,1]
    v_pk_mul_f32 v[62:63], v[92:93], v[62:63] op_sel_hi:[0,1]
    v_pk_mul_f32 v[76:77], v[92:93], v[76:77] op_sel_hi:[0,1]
    v_pk_mul_f32 v[78:79], v[92:93], v[78:79] op_sel_hi:[0,1]
    v_cvt_pk_bf16_f32 v60, v60, v61
    v_cvt_pk_bf16_f32 v61, v62, v63
    v_cvt_pk_bf16_f32 v62, v76, v77
    v_cvt_pk_bf16_f32 v63, v78, v79
    buffer_store_dwordx4 v[60:63], v6, s[12:15], s51 offen offset:256 sc1
    v_exp_f32 v136, v136
    v_exp_f32 v137, v137
    v_mfma_f32_16x16x32_bf16 v[88:91], v[208:211], v[168:171], 0
    v_exp_f32 v138, v138
    v_mfma_f32_16x16x32_bf16 v[56:59], v[100:103], v[168:171], 0
    v_exp_f32 v139, v139
    v_mfma_f32_16x16x32_bf16 v[72:75], v[116:119], v[168:171], 0
    v_exp_f32 v140, v140
    v_exp_f32 v141, v141
    v_exp_f32 v142, v142
    v_exp_f32 v143, v143
    v_rcp_f32 v88, v88
    v_cvt_pk_bf16_f32 v164, v136, v137
    v_cvt_pk_bf16_f32 v165, v138, v139
    v_cvt_pk_bf16_f32 v166, v140, v141
    v_cvt_pk_bf16_f32 v167, v142, v143
    v_pk_mul_f32 v[56:57], v[88:89], v[56:57] op_sel_hi:[0,1]
    v_pk_mul_f32 v[58:59], v[88:89], v[58:59] op_sel_hi:[0,1]
    v_pk_mul_f32 v[72:73], v[88:89], v[72:73] op_sel_hi:[0,1]
    v_pk_mul_f32 v[74:75], v[88:89], v[74:75] op_sel_hi:[0,1]
    v_cvt_pk_bf16_f32 v56, v56, v57
    v_cvt_pk_bf16_f32 v57, v58, v59
    v_cvt_pk_bf16_f32 v58, v72, v73
    v_cvt_pk_bf16_f32 v59, v74, v75
    buffer_store_dwordx4 v[56:59], v6, s[12:15], s51 offen offset:0 sc1
    v_exp_f32 v128, v128
    v_exp_f32 v129, v129
    v_mfma_f32_16x16x32_bf16 v[84:87], v[208:211], v[164:167], 0
    v_exp_f32 v130, v130
    v_mfma_f32_16x16x32_bf16 v[52:55], v[98:101], v[164:167], 0
    v_exp_f32 v131, v131
    v_mfma_f32_16x16x32_bf16 v[68:71], v[114:117], v[164:167], 0
    v_exp_f32 v132, v132
    v_exp_f32 v133, v133
    v_exp_f32 v134, v134
    v_exp_f32 v135, v135
    v_rcp_f32 v84, v84
    v_cvt_pk_bf16_f32 v160, v128, v129
    v_cvt_pk_bf16_f32 v161, v130, v131
    v_cvt_pk_bf16_f32 v162, v132, v133
    v_cvt_pk_bf16_f32 v163, v134, v135
    v_pk_mul_f32 v[52:53], v[84:85], v[52:53] op_sel_hi:[0,1]
    v_pk_mul_f32 v[54:55], v[84:85], v[54:55] op_sel_hi:[0,1]
    v_mfma_f32_16x16x32_bf16 v[80:83], v[208:211], v[160:163], 0
    v_pk_mul_f32 v[68:69], v[84:85], v[68:69] op_sel_hi:[0,1]
    v_pk_mul_f32 v[70:71], v[84:85], v[70:71] op_sel_hi:[0,1]
    v_mfma_f32_16x16x32_bf16 v[48:51], v[96:99], v[160:163], 0
    v_cvt_pk_bf16_f32 v52, v52, v53
    v_cvt_pk_bf16_f32 v53, v54, v55
    v_mfma_f32_16x16x32_bf16 v[64:67], v[112:115], v[160:163], 0
    v_cvt_pk_bf16_f32 v54, v68, v69
    v_cvt_pk_bf16_f32 v55, v70, v71
    buffer_store_dwordx4 v[52:55], v6, s[12:15], s49 offen offset:256 sc1
    v_rcp_f32 v80, v80
    s_nop 0
    v_pk_mul_f32 v[48:49], v[80:81], v[48:49] op_sel_hi:[0,1]
    v_pk_mul_f32 v[50:51], v[80:81], v[50:51] op_sel_hi:[0,1]
    s_nop 0
    v_pk_mul_f32 v[64:65], v[80:81], v[64:65] op_sel_hi:[0,1]
    v_pk_mul_f32 v[66:67], v[80:81], v[66:67] op_sel_hi:[0,1]
    v_cvt_pk_bf16_f32 v48, v48, v49
    v_cvt_pk_bf16_f32 v49, v50, v51
    v_cvt_pk_bf16_f32 v50, v64, v65
    v_cvt_pk_bf16_f32 v51, v66, v67
    buffer_store_dwordx4 v[48:51], v6, s[12:15], s49 offen offset:0 sc1
    s_branch c_wo
.p2align 6
c_wo:
    v_and_b32 v1, 63, v0
    v_lshrrev_b32 v2, 6, v0
    v_lshlrev_b32 v5, 4, v1
    v_lshrrev_b32 v3, 5, v1
    s_lshl_b32 s48, s6, 2
    s_add_u32 s48, s48, s8
    s_lshl_b32 s55, s48, 16
    s_lshl_b32 s56, s9, 22
    s_add_u32 s55, s55, s56
    s_lshl_b32 s56, s7, 12
    s_add_u32 s58, s55, s56
    s_add_u32 s55, s55, 16777216
    s_add_u32 s16, s4, s55
    s_addc_u32 s17, s5, 0
    s_mov_b32 s18, 65536
    s_mov_b32 s19, 0x00020000
    s_lshl_b32 s60, s9, 2
    s_add_u32 s60, s60, 159504
    v_mov_b32 v28, s60
    s_mul_i32 s55, s9, 786432
    s_add_u32 s55, s55, 65798144
    v_and_b32 v24, 63, v0
    s_and_b32 s56, s11, 0xe0
    v_lshrrev_b32 v25, 5, v24
    v_add_u32 v24, s56, v24
    v_and_b32 v24, 255, v24
    v_lshlrev_b32 v24, 10, v24
    v_lshl_add_u32 v24, v25, 8, v24
    s_bfe_u32 s56, s11, 0x20003
    s_and_b32 s57, s11, 7
    s_lshl_b32 s56, s56, 7
    s_lshl_b32 s57, s57, 2
    s_add_u32 s55, s55, s56
    s_add_u32 s55, s55, s57
    v_mov_b32 v25, 159488
    v_mov_b32 v26, 1
    v_mov_b32 v27, s10
    v_and_b32 v4, 15, v0
    v_lshrrev_b32 v16, 2, v4
    v_lshl_add_u32 v16, v3, 2, v16
    v_lshlrev_b32 v16, 7, v16
    v_bfe_u32 v17, v1, 4, 1
    v_lshl_add_u32 v16, v17, 5, v16
    v_and_b32 v17, 3, v4
    v_lshl_add_u32 v16, v17, 3, v16
    v_lshrrev_b32 v17, 3, v4
    v_lshlrev_b32 v18, 6, v17
    v_add_u32 v12, v16, v18
    v_sub_u32 v13, v16, v18
    ds_read_b32 v29, v28
    buffer_load_dwordx4 v[96:99], v5, s[12:15], s58 offen offset:0 sc1
    buffer_load_dwordx4 v[100:103], v5, s[12:15], s58 offen offset:1024 sc1
    buffer_load_dwordx4 v[104:107], v5, s[12:15], s58 offen offset:2048 sc1
    buffer_load_dwordx4 v[108:111], v5, s[12:15], s58 offen offset:3072 sc1
    s_waitcnt lgkmcnt(0)
    v_readfirstlane_b32 s60, v29
    s_lshr_b32 s51, s60, 2
    s_and_b32 s51, s51, s60
    s_and_b32 s51, s51, 3
    s_cmp_eq_u32 s51, 0
    s_cbranch_scc1 c_wo_late
    s_and_b32 s52, s51, 1
    s_xor_b32 s52, s52, 1
    s_lshl_b32 s50, s52, 15
    buffer_load_dwordx4 v[112:115], v5, s[16:19], s50 offen offset:0 sc1
    buffer_load_dwordx4 v[116:119], v5, s[16:19], s50 offen offset:1024 sc1
    buffer_load_dwordx4 v[120:123], v5, s[16:19], s50 offen offset:2048 sc1
    buffer_load_dwordx4 v[124:127], v5, s[16:19], s50 offen offset:3072 sc1
    s_add_u32 s50, s50, 4096
    buffer_load_dwordx4 v[128:131], v5, s[16:19], s50 offen offset:0 sc1
    s_mov_b64 exec, 1
    s_waitcnt vmcnt(9)
    ds_add_rtn_u32 v26, v25, v26
    s_waitcnt lgkmcnt(0)
    v_readfirstlane_b32 s56, v26
    s_and_b32 s56, s56, 3
    s_cmp_lg_u32 s56, 3
    s_cbranch_scc1 pub_2
    s_mov_b32 exec_lo, -1
    buffer_store_dword v27, v24, s[12:15], s55 offen sc1
pub_2:
    s_mov_b64 exec, -1
    s_branch c_wo_run
c_wo_late:
    s_mov_b64 exec, 1
    s_waitcnt vmcnt(4)
    ds_add_rtn_u32 v26, v25, v26
    s_waitcnt lgkmcnt(0)
    v_readfirstlane_b32 s56, v26
    s_and_b32 s56, s56, 3
    s_cmp_lg_u32 s56, 3
    s_cbranch_scc1 pub_3
    s_mov_b32 exec_lo, -1
    buffer_store_dword v27, v24, s[12:15], s55 offen sc1
pub_3:
    s_mov_b64 exec, -1
    s_branch wp_4_t
wp_4:
    ds_read_b32 v29, v28
    s_waitcnt lgkmcnt(0)
    v_readfirstlane_b32 s60, v29
    s_lshr_b32 s51, s60, 2
    s_and_b32 s51, s51, s60
    s_and_b32 s51, s51, 3
wp_4_t:
    s_cmp_lg_u32 s51, 0
    s_cbranch_scc0 wp_4
    s_and_b32 s52, s51, 1
    s_xor_b32 s52, s52, 1
    s_lshl_b32 s50, s52, 15
    buffer_load_dwordx4 v[112:115], v5, s[16:19], s50 offen offset:0 sc1
    buffer_load_dwordx4 v[116:119], v5, s[16:19], s50 offen offset:1024 sc1
    buffer_load_dwordx4 v[120:123], v5, s[16:19], s50 offen offset:2048 sc1
    buffer_load_dwordx4 v[124:127], v5, s[16:19], s50 offen offset:3072 sc1
    s_add_u32 s50, s50, 4096
    buffer_load_dwordx4 v[128:131], v5, s[16:19], s50 offen offset:0 sc1
c_wo_run:
    buffer_load_dwordx4 v[132:135], v5, s[16:19], s50 offen offset:1024 sc1
    buffer_load_dwordx4 v[136:139], v5, s[16:19], s50 offen offset:2048 sc1
    buffer_load_dwordx4 v[140:143], v5, s[16:19], s50 offen offset:3072 sc1
    s_add_u32 s50, s50, 4096
    s_lshl_b32 s3, s52, 16
    v_add_u32 v12, s3, v12
    v_add_u32 v13, s3, v13
    v_xor_b32 v14, 0x10000, v12
    v_xor_b32 v15, 0x10000, v13
    s_cmp_eq_u32 s52, 0
    s_mov_b32 s3, 0x0c0c0c0c
    s_cselect_b32 s53, 0x01000c0c, s3
    s_cselect_b32 s54, 0x03020c0c, s3
    s_cselect_b32 s59, s3, 0x01000c0c
    s_cselect_b32 s97, s3, 0x03020c0c
    s_branch wp_5_t
wp_5:
    ds_read_b32 v29, v28
    s_waitcnt lgkmcnt(0)
    v_readfirstlane_b32 s60, v29
    s_lshr_b32 s51, s60, 2
    s_and_b32 s51, s51, s60
    s_and_b32 s51, s51, 3
wp_5_t:
    s_cmp_ge_u32 s60, 0xf0
    s_cbranch_scc0 wp_5
    ds_read_b64_tr_b16 v[64:65], v12 offset:0
    ds_read_b64_tr_b16 v[66:67], v12 offset:1024
    ds_read_b64_tr_b16 v[68:69], v13 offset:64
    ds_read_b64_tr_b16 v[70:71], v13 offset:1088
    ds_read_b64_tr_b16 v[72:73], v12 offset:2048
    ds_read_b64_tr_b16 v[74:75], v12 offset:3072
    ds_read_b64_tr_b16 v[76:77], v13 offset:2112
    ds_read_b64_tr_b16 v[78:79], v13 offset:3136
    ds_read_b64_tr_b16 v[80:81], v12 offset:4096
    ds_read_b64_tr_b16 v[82:83], v12 offset:5120
    ds_read_b64_tr_b16 v[84:85], v13 offset:4160
    ds_read_b64_tr_b16 v[86:87], v13 offset:5184
    s_waitcnt vmcnt(8)
    v_perm_b32 v32, v96, v96, s53
    v_perm_b32 v33, v96, v96, s54
    v_perm_b32 v34, v97, v97, s53
    v_perm_b32 v35, v97, v97, s54
    v_perm_b32 v36, v98, v98, s53
    v_perm_b32 v37, v98, v98, s54
    v_perm_b32 v38, v99, v99, s53
    v_perm_b32 v39, v99, v99, s54
    v_perm_b32 v40, v100, v100, s53
    v_perm_b32 v41, v100, v100, s54
    v_perm_b32 v42, v101, v101, s53
    v_perm_b32 v43, v101, v101, s54
    v_perm_b32 v44, v102, v102, s53
    v_perm_b32 v45, v102, v102, s54
    v_perm_b32 v46, v103, v103, s53
    v_perm_b32 v47, v103, v103, s54
    v_perm_b32 v48, v104, v104, s53
    v_perm_b32 v49, v104, v104, s54
    v_perm_b32 v50, v105, v105, s53
    v_perm_b32 v51, v105, v105, s54
    v_perm_b32 v52, v106, v106, s53
    v_perm_b32 v53, v106, v106, s54
    v_perm_b32 v54, v107, v107, s53
    v_perm_b32 v55, v107, v107, s54
    v_perm_b32 v56, v108, v108, s53
    v_perm_b32 v57, v108, v108, s54
    v_perm_b32 v58, v109, v109, s53
    v_perm_b32 v59, v109, v109, s54
    v_perm_b32 v60, v110, v110, s53
    v_perm_b32 v61, v110, v110, s54
    v_perm_b32 v62, v111, v111, s53
    v_perm_b32 v63, v111, v111, s54
    buffer_load_dwordx4 v[144:147], v5, s[16:19], s50 offen offset:0 sc1
    buffer_load_dwordx4 v[148:151], v5, s[16:19], s50 offen offset:1024 sc1
    buffer_load_dwordx4 v[152:155], v5, s[16:19], s50 offen offset:2048 sc1
    buffer_load_dwordx4 v[156:159], v5, s[16:19], s50 offen offset:3072 sc1
    s_add_u32 s50, s50, 4096
    buffer_load_dwordx4 v[160:163], v5, s[16:19], s50 offen offset:0 sc1
    buffer_load_dwordx4 v[164:167], v5, s[16:19], s50 offen offset:1024 sc1
    buffer_load_dwordx4 v[168:171], v5, s[16:19], s50 offen offset:2048 sc1
    s_waitcnt vmcnt(14) lgkmcnt(8)
    v_mfma_f32_32x32x16_bf16 v[32:47], v[64:67], v[112:115], v[32:47]
    ds_read_b64_tr_b16 v[88:89], v12 offset:6144
    ds_read_b64_tr_b16 v[90:91], v12 offset:7168
    buffer_load_dwordx4 v[172:175], v5, s[16:19], s50 offen offset:3072 sc1
    s_add_u32 s50, s50, 4096
    v_perm_b32 v176, v96, v96, s59
    v_mfma_f32_32x32x16_bf16 v[48:63], v[68:71], v[112:115], v[48:63]
    ds_read_b64_tr_b16 v[92:93], v13 offset:6208
    ds_read_b64_tr_b16 v[94:95], v13 offset:7232
    v_perm_b32 v177, v96, v96, s97
    s_waitcnt vmcnt(14) lgkmcnt(8)
    v_mfma_f32_32x32x16_bf16 v[32:47], v[72:75], v[116:119], v[32:47]
    ds_read_b64_tr_b16 v[64:65], v12 offset:8192
    ds_read_b64_tr_b16 v[66:67], v12 offset:9216
    buffer_load_dwordx4 v[112:115], v5, s[16:19], s50 offen offset:0 sc1
    v_perm_b32 v178, v97, v97, s59
    v_mfma_f32_32x32x16_bf16 v[48:63], v[76:79], v[116:119], v[48:63]
    ds_read_b64_tr_b16 v[68:69], v13 offset:8256
    ds_read_b64_tr_b16 v[70:71], v13 offset:9280
    v_perm_b32 v179, v97, v97, s97
    s_waitcnt vmcnt(14) lgkmcnt(8)
    v_mfma_f32_32x32x16_bf16 v[32:47], v[80:83], v[120:123], v[32:47]
    ds_read_b64_tr_b16 v[72:73], v12 offset:10240
    ds_read_b64_tr_b16 v[74:75], v12 offset:11264
    buffer_load_dwordx4 v[116:119], v5, s[16:19], s50 offen offset:1024 sc1
    v_perm_b32 v180, v98, v98, s59
    v_mfma_f32_32x32x16_bf16 v[48:63], v[84:87], v[120:123], v[48:63]
    ds_read_b64_tr_b16 v[76:77], v13 offset:10304
    ds_read_b64_tr_b16 v[78:79], v13 offset:11328
    v_perm_b32 v181, v98, v98, s97
    s_waitcnt vmcnt(14) lgkmcnt(8)
    v_mfma_f32_32x32x16_bf16 v[32:47], v[88:91], v[124:127], v[32:47]
    ds_read_b64_tr_b16 v[80:81], v12 offset:12288
    ds_read_b64_tr_b16 v[82:83], v12 offset:13312
    buffer_load_dwordx4 v[120:123], v5, s[16:19], s50 offen offset:2048 sc1
    v_perm_b32 v182, v99, v99, s59
    v_mfma_f32_32x32x16_bf16 v[48:63], v[92:95], v[124:127], v[48:63]
    ds_read_b64_tr_b16 v[84:85], v13 offset:12352
    ds_read_b64_tr_b16 v[86:87], v13 offset:13376
    v_perm_b32 v183, v99, v99, s97
    s_waitcnt vmcnt(14) lgkmcnt(8)
    v_mfma_f32_32x32x16_bf16 v[32:47], v[64:67], v[128:131], v[32:47]
    ds_read_b64_tr_b16 v[88:89], v12 offset:14336
    ds_read_b64_tr_b16 v[90:91], v12 offset:15360
    buffer_load_dwordx4 v[124:127], v5, s[16:19], s50 offen offset:3072 sc1
    s_add_u32 s50, s50, 4096
    v_perm_b32 v184, v100, v100, s59
    v_mfma_f32_32x32x16_bf16 v[48:63], v[68:71], v[128:131], v[48:63]
    ds_read_b64_tr_b16 v[92:93], v13 offset:14400
    ds_read_b64_tr_b16 v[94:95], v13 offset:15424
    v_perm_b32 v185, v100, v100, s97
    s_waitcnt vmcnt(14) lgkmcnt(8)
    v_mfma_f32_32x32x16_bf16 v[32:47], v[72:75], v[132:135], v[32:47]
    ds_read_b64_tr_b16 v[64:65], v12 offset:16384
    ds_read_b64_tr_b16 v[66:67], v12 offset:17408
    buffer_load_dwordx4 v[128:131], v5, s[16:19], s50 offen offset:0 sc1
    v_perm_b32 v186, v101, v101, s59
    v_mfma_f32_32x32x16_bf16 v[48:63], v[76:79], v[132:135], v[48:63]
    ds_read_b64_tr_b16 v[68:69], v13 offset:16448
    ds_read_b64_tr_b16 v[70:71], v13 offset:17472
    v_perm_b32 v187, v101, v101, s97
    s_waitcnt vmcnt(14) lgkmcnt(8)
    v_mfma_f32_32x32x16_bf16 v[32:47], v[80:83], v[136:139], v[32:47]
    ds_read_b64_tr_b16 v[72:73], v12 offset:18432
    ds_read_b64_tr_b16 v[74:75], v12 offset:19456
    buffer_load_dwordx4 v[132:135], v5, s[16:19], s50 offen offset:1024 sc1
    v_perm_b32 v188, v102, v102, s59
    v_mfma_f32_32x32x16_bf16 v[48:63], v[84:87], v[136:139], v[48:63]
    ds_read_b64_tr_b16 v[76:77], v13 offset:18496
    ds_read_b64_tr_b16 v[78:79], v13 offset:19520
    v_perm_b32 v189, v102, v102, s97
    s_waitcnt vmcnt(14) lgkmcnt(8)
    v_mfma_f32_32x32x16_bf16 v[32:47], v[88:91], v[140:143], v[32:47]
    ds_read_b64_tr_b16 v[80:81], v12 offset:20480
    ds_read_b64_tr_b16 v[82:83], v12 offset:21504
    buffer_load_dwordx4 v[136:139], v5, s[16:19], s50 offen offset:2048 sc1
    v_perm_b32 v190, v103, v103, s59
    v_mfma_f32_32x32x16_bf16 v[48:63], v[92:95], v[140:143], v[48:63]
    ds_read_b64_tr_b16 v[84:85], v13 offset:20544
    ds_read_b64_tr_b16 v[86:87], v13 offset:21568
    v_perm_b32 v191, v103, v103, s97
    s_waitcnt vmcnt(14) lgkmcnt(8)
    v_mfma_f32_32x32x16_bf16 v[32:47], v[64:67], v[144:147], v[32:47]
    ds_read_b64_tr_b16 v[88:89], v12 offset:22528
    ds_read_b64_tr_b16 v[90:91], v12 offset:23552
    buffer_load_dwordx4 v[140:143], v5, s[16:19], s50 offen offset:3072 sc1
    s_add_u32 s50, s50, 4096
    v_perm_b32 v192, v104, v104, s59
    v_mfma_f32_32x32x16_bf16 v[48:63], v[68:71], v[144:147], v[48:63]
    ds_read_b64_tr_b16 v[92:93], v13 offset:22592
    ds_read_b64_tr_b16 v[94:95], v13 offset:23616
    v_perm_b32 v193, v104, v104, s97
    s_waitcnt vmcnt(14) lgkmcnt(8)
    v_mfma_f32_32x32x16_bf16 v[32:47], v[72:75], v[148:151], v[32:47]
    ds_read_b64_tr_b16 v[64:65], v12 offset:24576
    ds_read_b64_tr_b16 v[66:67], v12 offset:25600
    buffer_load_dwordx4 v[144:147], v5, s[16:19], s50 offen offset:0 sc1
    v_perm_b32 v194, v105, v105, s59
    v_mfma_f32_32x32x16_bf16 v[48:63], v[76:79], v[148:151], v[48:63]
    ds_read_b64_tr_b16 v[68:69], v13 offset:24640
    ds_read_b64_tr_b16 v[70:71], v13 offset:25664
    v_perm_b32 v195, v105, v105, s97
    s_waitcnt vmcnt(14) lgkmcnt(8)
    v_mfma_f32_32x32x16_bf16 v[32:47], v[80:83], v[152:155], v[32:47]
    ds_read_b64_tr_b16 v[72:73], v12 offset:26624
    ds_read_b64_tr_b16 v[74:75], v12 offset:27648
    buffer_load_dwordx4 v[148:151], v5, s[16:19], s50 offen offset:1024 sc1
    v_perm_b32 v196, v106, v106, s59
    v_mfma_f32_32x32x16_bf16 v[48:63], v[84:87], v[152:155], v[48:63]
    ds_read_b64_tr_b16 v[76:77], v13 offset:26688
    ds_read_b64_tr_b16 v[78:79], v13 offset:27712
    v_perm_b32 v197, v106, v106, s97
    s_waitcnt vmcnt(14) lgkmcnt(8)
    v_mfma_f32_32x32x16_bf16 v[32:47], v[88:91], v[156:159], v[32:47]
    ds_read_b64_tr_b16 v[80:81], v12 offset:28672
    ds_read_b64_tr_b16 v[82:83], v12 offset:29696
    buffer_load_dwordx4 v[152:155], v5, s[16:19], s50 offen offset:2048 sc1
    v_perm_b32 v198, v107, v107, s59
    v_mfma_f32_32x32x16_bf16 v[48:63], v[92:95], v[156:159], v[48:63]
    ds_read_b64_tr_b16 v[84:85], v13 offset:28736
    ds_read_b64_tr_b16 v[86:87], v13 offset:29760
    v_perm_b32 v199, v107, v107, s97
    s_waitcnt vmcnt(14) lgkmcnt(8)
    v_mfma_f32_32x32x16_bf16 v[32:47], v[64:67], v[160:163], v[32:47]
    ds_read_b64_tr_b16 v[88:89], v12 offset:30720
    ds_read_b64_tr_b16 v[90:91], v12 offset:31744
    buffer_load_dwordx4 v[156:159], v5, s[16:19], s50 offen offset:3072 sc1
    s_add_u32 s50, s50, 4096
    v_perm_b32 v200, v108, v108, s59
    v_mfma_f32_32x32x16_bf16 v[48:63], v[68:71], v[160:163], v[48:63]
    ds_read_b64_tr_b16 v[92:93], v13 offset:30784
    ds_read_b64_tr_b16 v[94:95], v13 offset:31808
    v_perm_b32 v201, v108, v108, s97
    s_waitcnt vmcnt(14) lgkmcnt(8)
    v_mfma_f32_32x32x16_bf16 v[32:47], v[72:75], v[164:167], v[32:47]
    ds_read_b64_tr_b16 v[64:65], v12 offset:32768
    ds_read_b64_tr_b16 v[66:67], v12 offset:33792
    buffer_load_dwordx4 v[160:163], v5, s[16:19], s50 offen offset:0 sc1
    v_perm_b32 v202, v109, v109, s59
    v_mfma_f32_32x32x16_bf16 v[48:63], v[76:79], v[164:167], v[48:63]
    ds_read_b64_tr_b16 v[68:69], v13 offset:32832
    ds_read_b64_tr_b16 v[70:71], v13 offset:33856
    v_perm_b32 v203, v109, v109, s97
    s_waitcnt vmcnt(14) lgkmcnt(8)
    v_mfma_f32_32x32x16_bf16 v[32:47], v[80:83], v[168:171], v[32:47]
    ds_read_b64_tr_b16 v[72:73], v12 offset:34816
    ds_read_b64_tr_b16 v[74:75], v12 offset:35840
    buffer_load_dwordx4 v[164:167], v5, s[16:19], s50 offen offset:1024 sc1
    v_perm_b32 v204, v110, v110, s59
    v_mfma_f32_32x32x16_bf16 v[48:63], v[84:87], v[168:171], v[48:63]
    ds_read_b64_tr_b16 v[76:77], v13 offset:34880
    ds_read_b64_tr_b16 v[78:79], v13 offset:35904
    v_perm_b32 v205, v110, v110, s97
    s_waitcnt vmcnt(14) lgkmcnt(8)
    v_mfma_f32_32x32x16_bf16 v[32:47], v[88:91], v[172:175], v[32:47]
    ds_read_b64_tr_b16 v[80:81], v12 offset:36864
    ds_read_b64_tr_b16 v[82:83], v12 offset:37888
    buffer_load_dwordx4 v[168:171], v5, s[16:19], s50 offen offset:2048 sc1
    v_perm_b32 v206, v111, v111, s59
    v_mfma_f32_32x32x16_bf16 v[48:63], v[92:95], v[172:175], v[48:63]
    ds_read_b64_tr_b16 v[84:85], v13 offset:36928
    ds_read_b64_tr_b16 v[86:87], v13 offset:37952
    v_perm_b32 v207, v111, v111, s97
    s_waitcnt vmcnt(14) lgkmcnt(8)
    v_mfma_f32_32x32x16_bf16 v[32:47], v[64:67], v[112:115], v[32:47]
    ds_read_b64_tr_b16 v[88:89], v12 offset:38912
    ds_read_b64_tr_b16 v[90:91], v12 offset:39936
    buffer_load_dwordx4 v[172:175], v5, s[16:19], s50 offen offset:3072 sc1
    s_add_u32 s50, s50, 4096
    v_mfma_f32_32x32x16_bf16 v[48:63], v[68:71], v[112:115], v[48:63]
    ds_read_b64_tr_b16 v[92:93], v13 offset:38976
    ds_read_b64_tr_b16 v[94:95], v13 offset:40000
    s_waitcnt vmcnt(14) lgkmcnt(8)
    v_mfma_f32_32x32x16_bf16 v[32:47], v[72:75], v[116:119], v[32:47]
    ds_read_b64_tr_b16 v[64:65], v12 offset:40960
    ds_read_b64_tr_b16 v[66:67], v12 offset:41984
    s_branch wp_6_t
wp_6:
    ds_read_b32 v29, v28
    s_waitcnt lgkmcnt(0)
    v_readfirstlane_b32 s60, v29
    s_lshr_b32 s51, s60, 2
    s_and_b32 s51, s51, s60
    s_and_b32 s51, s51, 3
wp_6_t:
    s_cmp_eq_u32 s51, 3
    s_cbranch_scc0 wp_6
    s_lshl_b32 s50, s52, 15
    s_xor_b32 s50, s50, 32768
    buffer_load_dwordx4 v[112:115], v5, s[16:19], s50 offen offset:0 sc1
    v_mfma_f32_32x32x16_bf16 v[48:63], v[76:79], v[116:119], v[48:63]
    ds_read_b64_tr_b16 v[68:69], v13 offset:41024
    ds_read_b64_tr_b16 v[70:71], v13 offset:42048
    s_waitcnt vmcnt(14) lgkmcnt(8)
    v_mfma_f32_32x32x16_bf16 v[32:47], v[80:83], v[120:123], v[32:47]
    ds_read_b64_tr_b16 v[72:73], v12 offset:43008
    ds_read_b64_tr_b16 v[74:75], v12 offset:44032
    buffer_load_dwordx4 v[116:119], v5, s[16:19], s50 offen offset:1024 sc1
    v_mfma_f32_32x32x16_bf16 v[48:63], v[84:87], v[120:123], v[48:63]
    ds_read_b64_tr_b16 v[76:77], v13 offset:43072
    ds_read_b64_tr_b16 v[78:79], v13 offset:44096
    s_waitcnt vmcnt(14) lgkmcnt(8)
    v_mfma_f32_32x32x16_bf16 v[32:47], v[88:91], v[124:127], v[32:47]
    ds_read_b64_tr_b16 v[80:81], v12 offset:45056
    ds_read_b64_tr_b16 v[82:83], v12 offset:46080
    buffer_load_dwordx4 v[120:123], v5, s[16:19], s50 offen offset:2048 sc1
    v_mfma_f32_32x32x16_bf16 v[48:63], v[92:95], v[124:127], v[48:63]
    ds_read_b64_tr_b16 v[84:85], v13 offset:45120
    ds_read_b64_tr_b16 v[86:87], v13 offset:46144
    s_waitcnt vmcnt(14) lgkmcnt(8)
    v_mfma_f32_32x32x16_bf16 v[32:47], v[64:67], v[128:131], v[32:47]
    ds_read_b64_tr_b16 v[88:89], v12 offset:47104
    ds_read_b64_tr_b16 v[90:91], v12 offset:48128
    buffer_load_dwordx4 v[124:127], v5, s[16:19], s50 offen offset:3072 sc1
    s_add_u32 s50, s50, 4096
    v_mfma_f32_32x32x16_bf16 v[48:63], v[68:71], v[128:131], v[48:63]
    ds_read_b64_tr_b16 v[92:93], v13 offset:47168
    ds_read_b64_tr_b16 v[94:95], v13 offset:48192
    s_waitcnt vmcnt(14) lgkmcnt(8)
    v_mfma_f32_32x32x16_bf16 v[32:47], v[72:75], v[132:135], v[32:47]
    ds_read_b64_tr_b16 v[64:65], v12 offset:49152
    ds_read_b64_tr_b16 v[66:67], v12 offset:50176
    buffer_load_dwordx4 v[128:131], v5, s[16:19], s50 offen offset:0 sc1
    v_mfma_f32_32x32x16_bf16 v[48:63], v[76:79], v[132:135], v[48:63]
    ds_read_b64_tr_b16 v[68:69], v13 offset:49216
    ds_read_b64_tr_b16 v[70:71], v13 offset:50240
    s_waitcnt vmcnt(14) lgkmcnt(8)
    v_mfma_f32_32x32x16_bf16 v[32:47], v[80:83], v[136:139], v[32:47]
    ds_read_b64_tr_b16 v[72:73], v12 offset:51200
    ds_read_b64_tr_b16 v[74:75], v12 offset:52224
    buffer_load_dwordx4 v[132:135], v5, s[16:19], s50 offen offset:1024 sc1
    v_mfma_f32_32x32x16_bf16 v[48:63], v[84:87], v[136:139], v[48:63]
    ds_read_b64_tr_b16 v[76:77], v13 offset:51264
    ds_read_b64_tr_b16 v[78:79], v13 offset:52288
    s_waitcnt vmcnt(14) lgkmcnt(8)
    v_mfma_f32_32x32x16_bf16 v[32:47], v[88:91], v[140:143], v[32:47]
    ds_read_b64_tr_b16 v[80:81], v12 offset:53248
    ds_read_b64_tr_b16 v[82:83], v12 offset:54272
    buffer_load_dwordx4 v[136:139], v5, s[16:19], s50 offen offset:2048 sc1
    v_mfma_f32_32x32x16_bf16 v[48:63], v[92:95], v[140:143], v[48:63]
    ds_read_b64_tr_b16 v[84:85], v13 offset:53312
    ds_read_b64_tr_b16 v[86:87], v13 offset:54336
    s_waitcnt vmcnt(14) lgkmcnt(8)
    v_mfma_f32_32x32x16_bf16 v[32:47], v[64:67], v[144:147], v[32:47]
    ds_read_b64_tr_b16 v[88:89], v12 offset:55296
    ds_read_b64_tr_b16 v[90:91], v12 offset:56320
    buffer_load_dwordx4 v[140:143], v5, s[16:19], s50 offen offset:3072 sc1
    s_add_u32 s50, s50, 4096
    v_mfma_f32_32x32x16_bf16 v[48:63], v[68:71], v[144:147], v[48:63]
    ds_read_b64_tr_b16 v[92:93], v13 offset:55360
    ds_read_b64_tr_b16 v[94:95], v13 offset:56384
    s_waitcnt vmcnt(14) lgkmcnt(8)
    v_mfma_f32_32x32x16_bf16 v[32:47], v[72:75], v[148:151], v[32:47]
    ds_read_b64_tr_b16 v[64:65], v12 offset:57344
    ds_read_b64_tr_b16 v[66:67], v12 offset:58368
    buffer_load_dwordx4 v[144:147], v5, s[16:19], s50 offen offset:0 sc1
    v_mfma_f32_32x32x16_bf16 v[48:63], v[76:79], v[148:151], v[48:63]
    ds_read_b64_tr_b16 v[68:69], v13 offset:57408
    ds_read_b64_tr_b16 v[70:71], v13 offset:58432
    s_waitcnt vmcnt(14) lgkmcnt(8)
    v_mfma_f32_32x32x16_bf16 v[32:47], v[80:83], v[152:155], v[32:47]
    ds_read_b64_tr_b16 v[72:73], v12 offset:59392
    ds_read_b64_tr_b16 v[74:75], v12 offset:60416
    buffer_load_dwordx4 v[148:151], v5, s[16:19], s50 offen offset:1024 sc1
    v_mfma_f32_32x32x16_bf16 v[48:63], v[84:87], v[152:155], v[48:63]
    ds_read_b64_tr_b16 v[76:77], v13 offset:59456
    ds_read_b64_tr_b16 v[78:79], v13 offset:60480
    s_waitcnt vmcnt(14) lgkmcnt(8)
    v_mfma_f32_32x32x16_bf16 v[32:47], v[88:91], v[156:159], v[32:47]
    ds_read_b64_tr_b16 v[80:81], v12 offset:61440
    ds_read_b64_tr_b16 v[82:83], v12 offset:62464
    buffer_load_dwordx4 v[152:155], v5, s[16:19], s50 offen offset:2048 sc1
    v_mfma_f32_32x32x16_bf16 v[48:63], v[92:95], v[156:159], v[48:63]
    ds_read_b64_tr_b16 v[84:85], v13 offset:61504
    ds_read_b64_tr_b16 v[86:87], v13 offset:62528
    s_waitcnt vmcnt(14) lgkmcnt(8)
    v_mfma_f32_32x32x16_bf16 v[32:47], v[64:67], v[160:163], v[32:47]
    ds_read_b64_tr_b16 v[88:89], v12 offset:63488
    ds_read_b64_tr_b16 v[90:91], v12 offset:64512
    buffer_load_dwordx4 v[156:159], v5, s[16:19], s50 offen offset:3072 sc1
    s_add_u32 s50, s50, 4096
    v_mfma_f32_32x32x16_bf16 v[48:63], v[68:71], v[160:163], v[48:63]
    ds_read_b64_tr_b16 v[92:93], v13 offset:63552
    ds_read_b64_tr_b16 v[94:95], v13 offset:64576
    s_waitcnt vmcnt(14) lgkmcnt(8)
    v_mfma_f32_32x32x16_bf16 v[32:47], v[72:75], v[164:167], v[32:47]
    ds_read_b64_tr_b16 v[64:65], v14 offset:0
    ds_read_b64_tr_b16 v[66:67], v14 offset:1024
    buffer_load_dwordx4 v[160:163], v5, s[16:19], s50 offen offset:0 sc1
    v_mfma_f32_32x32x16_bf16 v[48:63], v[76:79], v[164:167], v[48:63]
    ds_read_b64_tr_b16 v[68:69], v15 offset:64
    ds_read_b64_tr_b16 v[70:71], v15 offset:1088
    s_waitcnt vmcnt(14) lgkmcnt(8)
    v_mfma_f32_32x32x16_bf16 v[32:47], v[80:83], v[168:171], v[32:47]
    ds_read_b64_tr_b16 v[72:73], v14 offset:2048
    ds_read_b64_tr_b16 v[74:75], v14 offset:3072
    buffer_load_dwordx4 v[164:167], v5, s[16:19], s50 offen offset:1024 sc1
    v_mfma_f32_32x32x16_bf16 v[48:63], v[84:87], v[168:171], v[48:63]
    ds_read_b64_tr_b16 v[76:77], v15 offset:2112
    ds_read_b64_tr_b16 v[78:79], v15 offset:3136
    s_waitcnt vmcnt(14) lgkmcnt(8)
    v_mfma_f32_32x32x16_bf16 v[32:47], v[88:91], v[172:175], v[32:47]
    ds_read_b64_tr_b16 v[80:81], v14 offset:4096
    ds_read_b64_tr_b16 v[82:83], v14 offset:5120
    buffer_load_dwordx4 v[168:171], v5, s[16:19], s50 offen offset:2048 sc1
    v_mfma_f32_32x32x16_bf16 v[48:63], v[92:95], v[172:175], v[48:63]
    ds_read_b64_tr_b16 v[84:85], v15 offset:4160
    ds_read_b64_tr_b16 v[86:87], v15 offset:5184
    s_waitcnt vmcnt(14) lgkmcnt(8)
    v_mfma_f32_32x32x16_bf16 v[176:191], v[64:67], v[112:115], v[176:191]
    ds_read_b64_tr_b16 v[88:89], v14 offset:6144
    ds_read_b64_tr_b16 v[90:91], v14 offset:7168
    buffer_load_dwordx4 v[172:175], v5, s[16:19], s50 offen offset:3072 sc1
    s_add_u32 s50, s50, 4096
    v_mfma_f32_32x32x16_bf16 v[192:207], v[68:71], v[112:115], v[192:207]
    ds_read_b64_tr_b16 v[92:93], v15 offset:6208
    ds_read_b64_tr_b16 v[94:95], v15 offset:7232
    s_waitcnt vmcnt(14) lgkmcnt(8)
    v_mfma_f32_32x32x16_bf16 v[176:191], v[72:75], v[116:119], v[176:191]
    ds_read_b64_tr_b16 v[64:65], v14 offset:8192
    ds_read_b64_tr_b16 v[66:67], v14 offset:9216
    buffer_load_dwordx4 v[112:115], v5, s[16:19], s50 offen offset:0 sc1
    v_mfma_f32_32x32x16_bf16 v[192:207], v[76:79], v[116:119], v[192:207]
    ds_read_b64_tr_b16 v[68:69], v15 offset:8256
    ds_read_b64_tr_b16 v[70:71], v15 offset:9280
    s_waitcnt vmcnt(14) lgkmcnt(8)
    v_mfma_f32_32x32x16_bf16 v[176:191], v[80:83], v[120:123], v[176:191]
    ds_read_b64_tr_b16 v[72:73], v14 offset:10240
    ds_read_b64_tr_b16 v[74:75], v14 offset:11264
    buffer_load_dwordx4 v[116:119], v5, s[16:19], s50 offen offset:1024 sc1
    v_mfma_f32_32x32x16_bf16 v[192:207], v[84:87], v[120:123], v[192:207]
    ds_read_b64_tr_b16 v[76:77], v15 offset:10304
    ds_read_b64_tr_b16 v[78:79], v15 offset:11328
    s_waitcnt vmcnt(14) lgkmcnt(8)
    v_mfma_f32_32x32x16_bf16 v[176:191], v[88:91], v[124:127], v[176:191]
    ds_read_b64_tr_b16 v[80:81], v14 offset:12288
    ds_read_b64_tr_b16 v[82:83], v14 offset:13312
    buffer_load_dwordx4 v[120:123], v5, s[16:19], s50 offen offset:2048 sc1
    v_mfma_f32_32x32x16_bf16 v[192:207], v[92:95], v[124:127], v[192:207]
    ds_read_b64_tr_b16 v[84:85], v15 offset:12352
    ds_read_b64_tr_b16 v[86:87], v15 offset:13376
    s_waitcnt vmcnt(14) lgkmcnt(8)
    v_mfma_f32_32x32x16_bf16 v[176:191], v[64:67], v[128:131], v[176:191]
    ds_read_b64_tr_b16 v[88:89], v14 offset:14336
    ds_read_b64_tr_b16 v[90:91], v14 offset:15360
    buffer_load_dwordx4 v[124:127], v5, s[16:19], s50 offen offset:3072 sc1
    s_add_u32 s50, s50, 4096
    v_mfma_f32_32x32x16_bf16 v[192:207], v[68:71], v[128:131], v[192:207]
    ds_read_b64_tr_b16 v[92:93], v15 offset:14400
    ds_read_b64_tr_b16 v[94:95], v15 offset:15424
    s_waitcnt vmcnt(14) lgkmcnt(8)
    v_mfma_f32_32x32x16_bf16 v[176:191], v[72:75], v[132:135], v[176:191]
    ds_read_b64_tr_b16 v[64:65], v14 offset:16384
    ds_read_b64_tr_b16 v[66:67], v14 offset:17408
    buffer_load_dwordx4 v[128:131], v5, s[16:19], s50 offen offset:0 sc1
    v_mfma_f32_32x32x16_bf16 v[192:207], v[76:79], v[132:135], v[192:207]
    ds_read_b64_tr_b16 v[68:69], v15 offset:16448
    ds_read_b64_tr_b16 v[70:71], v15 offset:17472
    s_waitcnt vmcnt(14) lgkmcnt(8)
    v_mfma_f32_32x32x16_bf16 v[176:191], v[80:83], v[136:139], v[176:191]
    ds_read_b64_tr_b16 v[72:73], v14 offset:18432
    ds_read_b64_tr_b16 v[74:75], v14 offset:19456
    buffer_load_dwordx4 v[132:135], v5, s[16:19], s50 offen offset:1024 sc1
    v_mfma_f32_32x32x16_bf16 v[192:207], v[84:87], v[136:139], v[192:207]
    ds_read_b64_tr_b16 v[76:77], v15 offset:18496
    ds_read_b64_tr_b16 v[78:79], v15 offset:19520
    s_waitcnt vmcnt(14) lgkmcnt(8)
    v_mfma_f32_32x32x16_bf16 v[176:191], v[88:91], v[140:143], v[176:191]
    ds_read_b64_tr_b16 v[80:81], v14 offset:20480
    ds_read_b64_tr_b16 v[82:83], v14 offset:21504
    buffer_load_dwordx4 v[136:139], v5, s[16:19], s50 offen offset:2048 sc1
    v_mfma_f32_32x32x16_bf16 v[192:207], v[92:95], v[140:143], v[192:207]
    ds_read_b64_tr_b16 v[84:85], v15 offset:20544
    ds_read_b64_tr_b16 v[86:87], v15 offset:21568
    s_waitcnt vmcnt(14) lgkmcnt(8)
    v_mfma_f32_32x32x16_bf16 v[176:191], v[64:67], v[144:147], v[176:191]
    ds_read_b64_tr_b16 v[88:89], v14 offset:22528
    ds_read_b64_tr_b16 v[90:91], v14 offset:23552
    buffer_load_dwordx4 v[140:143], v5, s[16:19], s50 offen offset:3072 sc1
    s_add_u32 s50, s50, 4096
    v_mfma_f32_32x32x16_bf16 v[192:207], v[68:71], v[144:147], v[192:207]
    ds_read_b64_tr_b16 v[92:93], v15 offset:22592
    ds_read_b64_tr_b16 v[94:95], v15 offset:23616
    s_waitcnt vmcnt(14) lgkmcnt(8)
    v_mfma_f32_32x32x16_bf16 v[176:191], v[72:75], v[148:151], v[176:191]
    ds_read_b64_tr_b16 v[64:65], v14 offset:24576
    ds_read_b64_tr_b16 v[66:67], v14 offset:25600
    buffer_load_dwordx4 v[144:147], v5, s[16:19], s50 offen offset:0 sc1
    v_mfma_f32_32x32x16_bf16 v[192:207], v[76:79], v[148:151], v[192:207]
    ds_read_b64_tr_b16 v[68:69], v15 offset:24640
    ds_read_b64_tr_b16 v[70:71], v15 offset:25664
    s_waitcnt vmcnt(14) lgkmcnt(8)
    v_mfma_f32_32x32x16_bf16 v[176:191], v[80:83], v[152:155], v[176:191]
    ds_read_b64_tr_b16 v[72:73], v14 offset:26624
    ds_read_b64_tr_b16 v[74:75], v14 offset:27648
    buffer_load_dwordx4 v[148:151], v5, s[16:19], s50 offen offset:1024 sc1
    v_mfma_f32_32x32x16_bf16 v[192:207], v[84:87], v[152:155], v[192:207]
    ds_read_b64_tr_b16 v[76:77], v15 offset:26688
    ds_read_b64_tr_b16 v[78:79], v15 offset:27712
    s_waitcnt vmcnt(14) lgkmcnt(8)
    v_mfma_f32_32x32x16_bf16 v[176:191], v[88:91], v[156:159], v[176:191]
    ds_read_b64_tr_b16 v[80:81], v14 offset:28672
    ds_read_b64_tr_b16 v[82:83], v14 offset:29696
    buffer_load_dwordx4 v[152:155], v5, s[16:19], s50 offen offset:2048 sc1
    v_mfma_f32_32x32x16_bf16 v[192:207], v[92:95], v[156:159], v[192:207]
    ds_read_b64_tr_b16 v[84:85], v15 offset:28736
    ds_read_b64_tr_b16 v[86:87], v15 offset:29760
    s_waitcnt vmcnt(14) lgkmcnt(8)
    v_mfma_f32_32x32x16_bf16 v[176:191], v[64:67], v[160:163], v[176:191]
    ds_read_b64_tr_b16 v[88:89], v14 offset:30720
    ds_read_b64_tr_b16 v[90:91], v14 offset:31744
    buffer_load_dwordx4 v[156:159], v5, s[16:19], s50 offen offset:3072 sc1
    s_add_u32 s50, s50, 4096
    v_mfma_f32_32x32x16_bf16 v[192:207], v[68:71], v[160:163], v[192:207]
    ds_read_b64_tr_b16 v[92:93], v15 offset:30784
    ds_read_b64_tr_b16 v[94:95], v15 offset:31808
    s_waitcnt vmcnt(14) lgkmcnt(8)
    v_mfma_f32_32x32x16_bf16 v[176:191], v[72:75], v[164:167], v[176:191]
    ds_read_b64_tr_b16 v[64:65], v14 offset:32768
    ds_read_b64_tr_b16 v[66:67], v14 offset:33792
    buffer_load_dwordx4 v[160:163], v5, s[16:19], s50 offen offset:0 sc1
    v_mfma_f32_32x32x16_bf16 v[192:207], v[76:79], v[164:167], v[192:207]
    ds_read_b64_tr_b16 v[68:69], v15 offset:32832
    ds_read_b64_tr_b16 v[70:71], v15 offset:33856
    s_waitcnt vmcnt(14) lgkmcnt(8)
    v_mfma_f32_32x32x16_bf16 v[176:191], v[80:83], v[168:171], v[176:191]
    ds_read_b64_tr_b16 v[72:73], v14 offset:34816
    ds_read_b64_tr_b16 v[74:75], v14 offset:35840
    buffer_load_dwordx4 v[164:167], v5, s[16:19], s50 offen offset:1024 sc1
    v_mfma_f32_32x32x16_bf16 v[192:207], v[84:87], v[168:171], v[192:207]
    ds_read_b64_tr_b16 v[76:77], v15 offset:34880
    ds_read_b64_tr_b16 v[78:79], v15 offset:35904
    s_waitcnt vmcnt(14) lgkmcnt(8)
    v_mfma_f32_32x32x16_bf16 v[176:191], v[88:91], v[172:175], v[176:191]
    ds_read_b64_tr_b16 v[80:81], v14 offset:36864
    ds_read_b64_tr_b16 v[82:83], v14 offset:37888
    buffer_load_dwordx4 v[168:171], v5, s[16:19], s50 offen offset:2048 sc1
    v_mfma_f32_32x32x16_bf16 v[192:207], v[92:95], v[172:175], v[192:207]
    ds_read_b64_tr_b16 v[84:85], v15 offset:36928
    ds_read_b64_tr_b16 v[86:87], v15 offset:37952
    s_waitcnt vmcnt(14) lgkmcnt(8)
    v_mfma_f32_32x32x16_bf16 v[176:191], v[64:67], v[112:115], v[176:191]
    ds_read_b64_tr_b16 v[88:89], v14 offset:38912
    ds_read_b64_tr_b16 v[90:91], v14 offset:39936
    buffer_load_dwordx4 v[172:175], v5, s[16:19], s50 offen offset:3072 sc1
    s_add_u32 s50, s50, 4096
    v_mfma_f32_32x32x16_bf16 v[192:207], v[68:71], v[112:115], v[192:207]
    ds_read_b64_tr_b16 v[92:93], v15 offset:38976
    ds_read_b64_tr_b16 v[94:95], v15 offset:40000
    s_waitcnt vmcnt(14) lgkmcnt(8)
    v_mfma_f32_32x32x16_bf16 v[176:191], v[72:75], v[116:119], v[176:191]
    ds_read_b64_tr_b16 v[64:65], v14 offset:40960
    ds_read_b64_tr_b16 v[66:67], v14 offset:41984
    v_mfma_f32_32x32x16_bf16 v[192:207], v[76:79], v[116:119], v[192:207]
    ds_read_b64_tr_b16 v[68:69], v15 offset:41024
    ds_read_b64_tr_b16 v[70:71], v15 offset:42048
    s_waitcnt vmcnt(13) lgkmcnt(8)
    v_mfma_f32_32x32x16_bf16 v[176:191], v[80:83], v[120:123], v[176:191]
    ds_read_b64_tr_b16 v[72:73], v14 offset:43008
    ds_read_b64_tr_b16 v[74:75], v14 offset:44032
    v_mfma_f32_32x32x16_bf16 v[192:207], v[84:87], v[120:123], v[192:207]
    ds_read_b64_tr_b16 v[76:77], v15 offset:43072
    ds_read_b64_tr_b16 v[78:79], v15 offset:44096
    s_waitcnt vmcnt(12) lgkmcnt(8)
    v_mfma_f32_32x32x16_bf16 v[176:191], v[88:91], v[124:127], v[176:191]
    ds_read_b64_tr_b16 v[80:81], v14 offset:45056
    ds_read_b64_tr_b16 v[82:83], v14 offset:46080
    v_mfma_f32_32x32x16_bf16 v[192:207], v[92:95], v[124:127], v[192:207]
    ds_read_b64_tr_b16 v[84:85], v15 offset:45120
    ds_read_b64_tr_b16 v[86:87], v15 offset:46144
    s_waitcnt vmcnt(11) lgkmcnt(8)
    v_mfma_f32_32x32x16_bf16 v[176:191], v[64:67], v[128:131], v[176:191]
    ds_read_b64_tr_b16 v[88:89], v14 offset:47104
    ds_read_b64_tr_b16 v[90:91], v14 offset:48128
    v_mfma_f32_32x32x16_bf16 v[192:207], v[68:71], v[128:131], v[192:207]
    ds_read_b64_tr_b16 v[92:93], v15 offset:47168
    ds_read_b64_tr_b16 v[94:95], v15 offset:48192
    s_waitcnt vmcnt(10) lgkmcnt(8)
    v_mfma_f32_32x32x16_bf16 v[176:191], v[72:75], v[132:135], v[176:191]
    ds_read_b64_tr_b16 v[64:65], v14 offset:49152
    ds_read_b64_tr_b16 v[66:67], v14 offset:50176
    v_mfma_f32_32x32x16_bf16 v[192:207], v[76:79], v[132:135], v[192:207]
    ds_read_b64_tr_b16 v[68:69], v15 offset:49216
    ds_read_b64_tr_b16 v[70:71], v15 offset:50240
    s_waitcnt vmcnt(9) lgkmcnt(8)
    v_mfma_f32_32x32x16_bf16 v[176:191], v[80:83], v[136:139], v[176:191]
    ds_read_b64_tr_b16 v[72:73], v14 offset:51200
    ds_read_b64_tr_b16 v[74:75], v14 offset:52224
    v_mfma_f32_32x32x16_bf16 v[192:207], v[84:87], v[136:139], v[192:207]
    ds_read_b64_tr_b16 v[76:77], v15 offset:51264
    ds_read_b64_tr_b16 v[78:79], v15 offset:52288
    s_waitcnt vmcnt(8) lgkmcnt(8)
    v_mfma_f32_32x32x16_bf16 v[176:191], v[88:91], v[140:143], v[176:191]
    ds_read_b64_tr_b16 v[80:81], v14 offset:53248
    ds_read_b64_tr_b16 v[82:83], v14 offset:54272
    v_mfma_f32_32x32x16_bf16 v[192:207], v[92:95], v[140:143], v[192:207]
    ds_read_b64_tr_b16 v[84:85], v15 offset:53312
    ds_read_b64_tr_b16 v[86:87], v15 offset:54336
    s_waitcnt vmcnt(7) lgkmcnt(8)
    v_mfma_f32_32x32x16_bf16 v[176:191], v[64:67], v[144:147], v[176:191]
    ds_read_b64_tr_b16 v[88:89], v14 offset:55296
    ds_read_b64_tr_b16 v[90:91], v14 offset:56320
    v_mfma_f32_32x32x16_bf16 v[192:207], v[68:71], v[144:147], v[192:207]
    ds_read_b64_tr_b16 v[92:93], v15 offset:55360
    ds_read_b64_tr_b16 v[94:95], v15 offset:56384
    s_waitcnt vmcnt(6) lgkmcnt(8)
    v_mfma_f32_32x32x16_bf16 v[176:191], v[72:75], v[148:151], v[176:191]
    ds_read_b64_tr_b16 v[64:65], v14 offset:57344
    ds_read_b64_tr_b16 v[66:67], v14 offset:58368
    v_mfma_f32_32x32x16_bf16 v[192:207], v[76:79], v[148:151], v[192:207]
    ds_read_b64_tr_b16 v[68:69], v15 offset:57408
    ds_read_b64_tr_b16 v[70:71], v15 offset:58432
    s_waitcnt vmcnt(5) lgkmcnt(8)
    v_mfma_f32_32x32x16_bf16 v[176:191], v[80:83], v[152:155], v[176:191]
    ds_read_b64_tr_b16 v[72:73], v14 offset:59392
    ds_read_b64_tr_b16 v[74:75], v14 offset:60416
    v_mfma_f32_32x32x16_bf16 v[192:207], v[84:87], v[152:155], v[192:207]
    ds_read_b64_tr_b16 v[76:77], v15 offset:59456
    ds_read_b64_tr_b16 v[78:79], v15 offset:60480
    s_waitcnt vmcnt(4) lgkmcnt(8)
    v_mfma_f32_32x32x16_bf16 v[176:191], v[88:91], v[156:159], v[176:191]
    ds_read_b64_tr_b16 v[80:81], v14 offset:61440
    ds_read_b64_tr_b16 v[82:83], v14 offset:62464
    v_mfma_f32_32x32x16_bf16 v[192:207], v[92:95], v[156:159], v[192:207]
    ds_read_b64_tr_b16 v[84:85], v15 offset:61504
    ds_read_b64_tr_b16 v[86:87], v15 offset:62528
    s_waitcnt vmcnt(3) lgkmcnt(8)
    v_mfma_f32_32x32x16_bf16 v[176:191], v[64:67], v[160:163], v[176:191]
    ds_read_b64_tr_b16 v[88:89], v14 offset:63488
    ds_read_b64_tr_b16 v[90:91], v14 offset:64512
    v_mfma_f32_32x32x16_bf16 v[192:207], v[68:71], v[160:163], v[192:207]
    ds_read_b64_tr_b16 v[92:93], v15 offset:63552
    ds_read_b64_tr_b16 v[94:95], v15 offset:64576
    s_waitcnt vmcnt(2) lgkmcnt(8)
    v_mfma_f32_32x32x16_bf16 v[176:191], v[72:75], v[164:167], v[176:191]
    v_mfma_f32_32x32x16_bf16 v[192:207], v[76:79], v[164:167], v[192:207]
    s_waitcnt vmcnt(1) lgkmcnt(4)
    v_mfma_f32_32x32x16_bf16 v[176:191], v[80:83], v[168:171], v[176:191]
    v_mfma_f32_32x32x16_bf16 v[192:207], v[84:87], v[168:171], v[192:207]
    s_waitcnt vmcnt(0) lgkmcnt(0)
    v_mfma_f32_32x32x16_bf16 v[176:191], v[88:91], v[172:175], v[176:191]
    v_mfma_f32_32x32x16_bf16 v[192:207], v[92:95], v[172:175], v[192:207]
    s_cmp_eq_u32 s9, 3
    s_nop 7
    s_cbranch_scc1 c_wo_fin
    s_add_u32 s58, s58, 4194304
    s_nop 7
    v_pk_add_f32 v[32:33], v[32:33], v[176:177]
    v_pk_add_f32 v[34:35], v[34:35], v[178:179]
    v_pk_add_f32 v[36:37], v[36:37], v[180:181]
    v_pk_add_f32 v[38:39], v[38:39], v[182:183]
    v_cvt_pk_bf16_f32 v96, v32, v33
    v_cvt_pk_bf16_f32 v97, v34, v35
    v_cvt_pk_bf16_f32 v98, v36, v37
    v_cvt_pk_bf16_f32 v99, v38, v39
    buffer_store_dwordx4 v[96:99], v5, s[12:15], s58 offen offset:0 sc1
    v_pk_add_f32 v[40:41], v[40:41], v[184:185]
    v_pk_add_f32 v[42:43], v[42:43], v[186:187]
    v_pk_add_f32 v[44:45], v[44:45], v[188:189]
    v_pk_add_f32 v[46:47], v[46:47], v[190:191]
    v_cvt_pk_bf16_f32 v100, v40, v41
    v_cvt_pk_bf16_f32 v101, v42, v43
    v_cvt_pk_bf16_f32 v102, v44, v45
    v_cvt_pk_bf16_f32 v103, v46, v47
    buffer_store_dwordx4 v[100:103], v5, s[12:15], s58 offen offset:1024 sc1
    v_pk_add_f32 v[48:49], v[48:49], v[192:193]
    v_pk_add_f32 v[50:51], v[50:51], v[194:195]
    v_pk_add_f32 v[52:53], v[52:53], v[196:197]
    v_pk_add_f32 v[54:55], v[54:55], v[198:199]
    v_cvt_pk_bf16_f32 v104, v48, v49
    v_cvt_pk_bf16_f32 v105, v50, v51
    v_cvt_pk_bf16_f32 v106, v52, v53
    v_cvt_pk_bf16_f32 v107, v54, v55
    buffer_store_dwordx4 v[104:107], v5, s[12:15], s58 offen offset:2048 sc1
    v_pk_add_f32 v[56:57], v[56:57], v[200:201]
    v_pk_add_f32 v[58:59], v[58:59], v[202:203]
    v_pk_add_f32 v[60:61], v[60:61], v[204:205]
    v_pk_add_f32 v[62:63], v[62:63], v[206:207]
    v_cvt_pk_bf16_f32 v108, v56, v57
    v_cvt_pk_bf16_f32 v109, v58, v59
    v_cvt_pk_bf16_f32 v110, v60, v61
    v_cvt_pk_bf16_f32 v111, v62, v63
    buffer_store_dwordx4 v[108:111], v5, s[12:15], s58 offen offset:3072 sc1
    s_barrier
c_wo_stat:
    s_mov_b32 s55, 0x3f803f80
    v_dot2_f32_bf16 v18, v96, s55, 0
    v_dot2_f32_bf16 v19, v96, v96, 0
    v_dot2_f32_bf16 v20, v97, s55, 0
    v_dot2_f32_bf16 v21, v97, v97, 0
    v_dot2_f32_bf16 v18, v98, s55, v18
    v_dot2_f32_bf16 v19, v98, v98, v19
    v_dot2_f32_bf16 v20, v99, s55, v20
    v_dot2_f32_bf16 v21, v99, v99, v21
    v_dot2_f32_bf16 v18, v100, s55, v18
    v_dot2_f32_bf16 v19, v100, v100, v19
    v_dot2_f32_bf16 v20, v101, s55, v20
    v_dot2_f32_bf16 v21, v101, v101, v21
    v_dot2_f32_bf16 v18, v102, s55, v18
    v_dot2_f32_bf16 v19, v102, v102, v19
    v_dot2_f32_bf16 v20, v103, s55, v20
    v_dot2_f32_bf16 v21, v103, v103, v21
    v_dot2_f32_bf16 v18, v104, s55, v18
    v_dot2_f32_bf16 v19, v104, v104, v19
    v_dot2_f32_bf16 v20, v105, s55, v20
    v_dot2_f32_bf16 v21, v105, v105, v21
    v_dot2_f32_bf16 v18, v106, s55, v18
    v_dot2_f32_bf16 v19, v106, v106, v19
    v_dot2_f32_bf16 v20, v107, s55, v20
    v_dot2_f32_bf16 v21, v107, v107, v21
    v_dot2_f32_bf16 v18, v108, s55, v18
    v_dot2_f32_bf16 v19, v108, v108, v19
    v_dot2_f32_bf16 v20, v109, s55, v20
    v_dot2_f32_bf16 v21, v109, v109, v21
    v_dot2_f32_bf16 v18, v110, s55, v18
    v_dot2_f32_bf16 v19, v110, v110, v19
    v_dot2_f32_bf16 v20, v111, s55, v20
    v_dot2_f32_bf16 v21, v111, v111, v21
    v_lshlrev_b32 v16, 3, v1
    s_lshl_b32 s3, s48, 12
    s_lshl_b32 s55, s7, 8
    s_add_u32 s3, s3, s55
    v_permlane32_swap_b32 v18, v20
    v_permlane32_swap_b32 v19, v21
    s_lshl_b32 s55, s9, 18
    v_pk_add_f32 v[18:19], v[18:19], v[20:21]
    s_add_u32 s3, s3, s55
    s_add_u32 s3, s3, 63176704
    v_permlane32_swap_b32 v18, v20
    v_permlane32_swap_b32 v19, v21
    v_pk_add_f32 v[18:19], v[18:19], v[20:21]
    s_mov_b32 exec_hi, 0
    buffer_store_dwordx2 v[18:19], v16, s[12:15], s3 offen sc1
    s_mov_b64 exec, -1
    s_cmp_lg_u32 s9, -1
    s_cbranch_scc1 c_wo_pub
    s_barrier
    v_mov_b32 v24, 159492
non_7:
    ds_read_b32 v25, v24
    s_waitcnt lgkmcnt(0)
    v_readfirstlane_b32 s10, v25
    s_cmp_eq_u32 s10, 0
    s_cbranch_scc1 non_7
c_wo_pub:
    s_mul_i32 s55, s9, 786432
    s_add_u32 s55, s55, 66060288
    v_and_b32 v24, 63, v0
    s_and_b32 s56, s11, 0xe0
    v_lshrrev_b32 v25, 5, v24
    v_add_u32 v24, s56, v24
    v_and_b32 v24, 255, v24
    v_lshlrev_b32 v24, 10, v24
    v_lshl_add_u32 v24, v25, 8, v24
    s_bfe_u32 s56, s11, 0x20003
    s_and_b32 s57, s11, 7
    s_lshl_b32 s56, s56, 7
    s_lshl_b32 s57, s57, 2
    s_add_u32 s55, s55, s56
    s_add_u32 s55, s55, s57
    s_and_b32 s57, s6, s9
    s_bfe_i32 s57, s57, 0x10000
    v_mov_b32 v25, 159488
    v_mov_b32 v26, 1
    v_mov_b32 v27, s10
    s_mov_b64 exec, 1
    s_waitcnt vmcnt(0)
    ds_add_rtn_u32 v26, v25, v26
    s_waitcnt lgkmcnt(0)
    v_readfirstlane_b32 s56, v26
    s_and_b32 s56, s56, 3
    s_cmp_lg_u32 s56, 3
    s_cbranch_scc1 pub_8
    s_mov_b32 exec_lo, -1
    s_mov_b32 exec_hi, s57
    buffer_store_dword v27, v24, s[12:15], s55 offen sc1
pub_8:
    s_mov_b64 exec, -1
    s_cmp_eq_u32 s9, -1
    s_cbranch_scc1 c_wo_pub3
    s_barrier
c_wo_pub3:
    s_add_u32 s9, s9, 1
    s_bitcmp1_b32 s9, 0
    s_cbranch_scc1 c_qkvB
    s_branch c_qkvA
c_wo_fin:
    s_barrier
    v_pk_add_f32 v[32:33], v[32:33], v[176:177]
    v_pk_add_f32 v[34:35], v[34:35], v[178:179]
    v_pk_add_f32 v[36:37], v[36:37], v[180:181]
    v_pk_add_f32 v[38:39], v[38:39], v[182:183]
    v_pk_add_f32 v[40:41], v[40:41], v[184:185]
    v_pk_add_f32 v[42:43], v[42:43], v[186:187]
    v_pk_add_f32 v[44:45], v[44:45], v[188:189]
    v_pk_add_f32 v[46:47], v[46:47], v[190:191]
    v_pk_add_f32 v[48:49], v[48:49], v[192:193]
    v_pk_add_f32 v[50:51], v[50:51], v[194:195]
    v_pk_add_f32 v[52:53], v[52:53], v[196:197]
    v_pk_add_f32 v[54:55], v[54:55], v[198:199]
    v_pk_add_f32 v[56:57], v[56:57], v[200:201]
    v_pk_add_f32 v[58:59], v[58:59], v[202:203]
    v_pk_add_f32 v[60:61], v[60:61], v[204:205]
    v_pk_add_f32 v[62:63], v[62:63], v[206:207]
    v_cvt_pk_bf16_f32 v96, v32, v33
    v_cvt_pk_bf16_f32 v97, v34, v35
    v_cvt_pk_bf16_f32 v98, v36, v37
    v_cvt_pk_bf16_f32 v99, v38, v39
    v_cvt_pk_bf16_f32 v100, v40, v41
    v_cvt_pk_bf16_f32 v101, v42, v43
    v_cvt_pk_bf16_f32 v102, v44, v45
    v_cvt_pk_bf16_f32 v103, v46, v47
    v_cvt_pk_bf16_f32 v104, v48, v49
    v_cvt_pk_bf16_f32 v105, v50, v51
    v_cvt_pk_bf16_f32 v106, v52, v53
    v_cvt_pk_bf16_f32 v107, v54, v55
    v_cvt_pk_bf16_f32 v108, v56, v57
    v_cvt_pk_bf16_f32 v109, v58, v59
    v_cvt_pk_bf16_f32 v110, v60, v61
    v_cvt_pk_bf16_f32 v111, v62, v63
    s_mov_b32 s28, s44
    s_mov_b32 s29, s45
    s_mov_b32 s30, 4194304
    s_mov_b32 s31, 0x00020000
    v_and_b32 v16, 31, v1
    v_mul_u32_u24 v16, 144, v16
    v_lshl_add_u32 v16, v3, 3, v16
    v_mul_u32_u24 v17, 4608, v2
    v_add_u32 v16, v16, v17
    ds_write_b64 v16, v[96:97] offset:0
    ds_write_b64 v16, v[98:99] offset:16
    ds_write_b64 v16, v[100:101] offset:32
    ds_write_b64 v16, v[102:103] offset:48
    ds_write_b64 v16, v[104:105] offset:64
    ds_write_b64 v16, v[106:107] offset:80
    ds_write_b64 v16, v[108:109] offset:96
    ds_write_b64 v16, v[110:111] offset:112
    v_lshrrev_b32 v18, 3, v1
    v_and_b32 v19, 7, v1
    v_mul_u32_u24 v20, 144, v18
    v_lshl_add_u32 v20, v19, 4, v20
    v_add_u32 v20, v20, v17
    v_lshlrev_b32 v21, 11, v18
    v_lshl_add_u32 v21, v19, 4, v21
    s_lshl_b32 s3, s48, 16
    s_lshl_b32 s55, s7, 7
    s_add_u32 s3, s3, s55
    s_waitcnt lgkmcnt(0)
    ds_read_b128 v[32:35], v20 offset:0
    ds_read_b128 v[36:39], v20 offset:1152
    ds_read_b128 v[40:43], v20 offset:2304
    ds_read_b128 v[44:47], v20 offset:3456
    s_waitcnt lgkmcnt(3)
    buffer_store_dwordx4 v[32:35], v21, s[28:31], s3 offen sc1
    s_add_u32 s3, s3, 16384
    s_waitcnt lgkmcnt(2)
    buffer_store_dwordx4 v[36:39], v21, s[28:31], s3 offen sc1
    s_add_u32 s3, s3, 16384
    s_waitcnt lgkmcnt(1)
    buffer_store_dwordx4 v[40:43], v21, s[28:31], s3 offen sc1
    s_add_u32 s3, s3, 16384
    s_waitcnt lgkmcnt(0)
    buffer_store_dwordx4 v[44:47], v21, s[28:31], s3 offen sc1
    s_add_u32 s3, s3, 16384
    s_branch k_exit
c_prep:
    s_mov_b32 s28, s32
    s_mov_b32 s29, s33
    s_mov_b32 s30, 4194304
    s_mov_b32 s31, 0x00020000
    s_lshl_b32 s48, s6, 2
    s_add_u32 s48, s48, s8
    v_lshrrev_b32 v16, 3, v1
    v_and_b32 v17, 7, v1
    v_lshlrev_b32 v18, 11, v16
    v_lshl_add_u32 v18, v17, 4, v18
    s_lshl_b32 s55, s48, 16
    s_lshl_b32 s56, s7, 7
    s_add_u32 s3, s55, s56
    buffer_load_dwordx4 v[32:35], v18, s[28:31], s3 offen nt
    s_add_u32 s3, s3, 16384
    buffer_load_dwordx4 v[36:39], v18, s[28:31], s3 offen nt
    s_add_u32 s3, s3, 16384
    buffer_load_dwordx4 v[40:43], v18, s[28:31], s3 offen nt
    s_add_u32 s3, s3, 16384
    buffer_load_dwordx4 v[44:47], v18, s[28:31], s3 offen nt
    s_add_u32 s3, s3, 16384
    s_barrier
    s_lshl_b32 s56, s7, 12
    s_add_u32 s58, s55, s56
    v_lshlrev_b32 v5, 4, v1
    s_lshl_b32 s3, s8, 12
    s_add_u32 s3, s3, 131072
    v_lshrrev_b32 v18, 1, v17
    v_lshlrev_b32 v18, 10, v18
    v_lshl_add_u32 v18, v16, 4, v18
    v_and_b32 v17, 1, v17
    v_lshl_add_u32 v18, v17, 3, v18
    v_add_u32 v18, s3, v18
    v_add_u32 v19, s3, v5
    s_waitcnt vmcnt(3)
    ds_write_b64 v18, v[32:33] offset:0
    ds_write_b64 v18, v[34:35] offset:512
    s_waitcnt vmcnt(2)
    ds_write_b64 v18, v[36:37] offset:128
    ds_write_b64 v18, v[38:39] offset:640
    s_waitcnt vmcnt(1)
    ds_write_b64 v18, v[40:41] offset:256
    ds_write_b64 v18, v[42:43] offset:768
    s_waitcnt vmcnt(0)
    ds_write_b64 v18, v[44:45] offset:384
    ds_write_b64 v18, v[46:47] offset:896
    s_waitcnt lgkmcnt(0)
    ds_read_b128 v[96:99], v19 offset:0
    ds_read_b128 v[100:103], v19 offset:1024
    ds_read_b128 v[104:107], v19 offset:2048
    ds_read_b128 v[108:111], v19 offset:3072
    s_waitcnt lgkmcnt(3)
    buffer_store_dwordx4 v[96:99], v5, s[12:15], s58 offen offset:0 sc1
    s_waitcnt lgkmcnt(2)
    buffer_store_dwordx4 v[100:103], v5, s[12:15], s58 offen offset:1024 sc1
    s_waitcnt lgkmcnt(1)
    buffer_store_dwordx4 v[104:107], v5, s[12:15], s58 offen offset:2048 sc1
    s_waitcnt lgkmcnt(0)
    buffer_store_dwordx4 v[108:111], v5, s[12:15], s58 offen offset:3072 sc1
    s_branch c_wo_stat
.p2align 6
c_qkvB:
    v_and_b32 v1, 63, v0
    v_lshrrev_b32 v2, 6, v0
    v_lshlrev_b32 v5, 4, v1
    v_lshrrev_b32 v3, 5, v1
    v_and_b32 v4, 15, v0
    v_bfe_u32 v7, v1, 4, 1
    v_lshl_add_u32 v6, v7, 5, v4
    v_lshlrev_b32 v6, 4, v6
    v_lshl_add_u32 v6, v3, 10, v6
    s_lshr_b32 s48, s6, 1
    s_lshl_b32 s48, s48, 2
    s_add_u32 s48, s48, s8
    s_lshl_b32 s55, s48, 17
    s_lshl_b32 s56, s9, 22
    s_add_u32 s55, s55, s56
    s_add_u32 s16, s4, s55
    s_addc_u32 s17, s5, 0
    s_mov_b32 s18, 65536
    s_mov_b32 s19, 0x00020000
    s_add_u32 s56, s55, 65536
    s_add_u32 s20, s4, s56
    s_addc_u32 s21, s5, 0
    s_mov_b32 s22, 65536
    s_mov_b32 s23, 0x00020000
    s_lshl_b32 s49, s7, 12
    s_add_u32 s49, s49, s55
    s_and_b32 s56, s6, 1
    s_lshl_b32 s56, s56, 11
    s_add_u32 s49, s49, s56
    s_add_u32 s49, s49, 16777216
    s_movk_i32 s54, 4096
    v_lshrrev_b32 v16, 2, v4
    v_lshl_add_u32 v18, v7, 2, v16
    v_lshl_add_u32 v18, v3, 4, v18
    v_lshlrev_b32 v18, 6, v18
    v_and_b32 v17, 3, v4
    v_lshl_add_u32 v18, v17, 3, v18
    v_lshl_add_u32 v26, v7, 5, v18
    v_xor_b32 v27, 32, v26
    v_mov_b32 v24, v26
    v_mov_b32 v25, v27
    v_and_b32 v18, 0x30, v1
    v_add_u32 v10, 155648, v18
    v_lshlrev_b32 v11, 2, v4
    v_add_u32 v11, 155648, v11
    v_lshl_add_u32 v8, v2, 8, v11
    v_lshl_add_u32 v9, v2, 8, v10
    s_lshr_b32 s3, s8, 1
    s_and_b32 s55, s8, 1
    s_lshl_b32 s3, s3, 14
    s_lshl_b32 s55, s55, 12
    s_add_u32 s3, s3, s55
    s_add_u32 s3, s3, 81920
    v_lshl_add_u32 v12, v3, 5, v4
    v_lshlrev_b32 v12, 4, v12
    v_lshl_add_u32 v12, v7, 10, v12
    v_add_u32 v12, s3, v12
    v_add_u32 v13, s3, v5
    s_lshr_b32 s84, s9, 1
    s_lshl_b32 s84, s84, 23
    s_lshl_b32 s3, s7, 19
    s_add_u32 s84, s84, s3
    s_and_b32 s3, s6, 1
    s_lshl_b32 s3, s3, 18
    s_add_u32 s84, s84, s3
    s_add_u32 s84, s84, 33554432
    s_lshr_b32 s86, s6, 1
    s_lshl_b32 s3, s86, 15
    s_add_u32 s84, s84, s3
    s_sub_u32 s84, s84, 81920
    s_add_u32 s85, s84, 8192
    s_mul_i32 s53, s9, 786432
    s_add_u32 s53, s53, 66322432
    s_and_b32 s3, s11, 31
    s_lshl_b32 s3, s3, 10
    s_add_u32 s53, s53, s3
    s_lshr_b32 s3, s86, 1
    s_lshl_b32 s3, s3, 7
    s_add_u32 s53, s53, s3
    s_and_b32 s3, s86, 1
    s_lshl_b32 s3, s3, 2
    s_add_u32 s3, s3, s8
    s_lshl_b32 s3, s3, 2
    s_add_u32 s53, s53, s3
    v_lshlrev_b32 v28, 15, v1
    v_mov_b32 v29, s10
    v_mov_b32 v32, 0
    v_mov_b32 v33, 0
    v_mov_b32 v34, 0
    v_mov_b32 v35, 0
    v_mov_b32 v36, 0
    v_mov_b32 v37, 0
    v_mov_b32 v38, 0
    v_mov_b32 v39, 0
    v_mov_b32 v40, 0
    v_mov_b32 v41, 0
    v_mov_b32 v42, 0
    v_mov_b32 v43, 0
    v_mov_b32 v44, 0
    v_mov_b32 v45, 0
    v_mov_b32 v46, 0
    v_mov_b32 v47, 0
    v_mov_b32 v48, 0
    v_mov_b32 v49, 0
    v_mov_b32 v50, 0
    v_mov_b32 v51, 0
    v_mov_b32 v52, 0
    v_mov_b32 v53, 0
    v_mov_b32 v54, 0
    v_mov_b32 v55, 0
    v_mov_b32 v56, 0
    v_mov_b32 v57, 0
    v_mov_b32 v58, 0
    v_mov_b32 v59, 0
    v_mov_b32 v60, 0
    v_mov_b32 v61, 0
    v_mov_b32 v62, 0
    v_mov_b32 v63, 0
    v_mov_b32 v64, 0
    v_mov_b32 v65, 0
    v_mov_b32 v66, 0
    v_mov_b32 v67, 0
    v_mov_b32 v68, 0
    v_mov_b32 v69, 0
    v_mov_b32 v70, 0
    v_mov_b32 v71, 0
    v_mov_b32 v72, 0
    v_mov_b32 v73, 0
    v_mov_b32 v74, 0
    v_mov_b32 v75, 0
    v_mov_b32 v76, 0
    v_mov_b32 v77, 0
    v_mov_b32 v78, 0
    v_mov_b32 v79, 0
    v_mov_b32 v80, 0
    v_mov_b32 v81, 0
    v_mov_b32 v82, 0
    v_mov_b32 v83, 0
    v_mov_b32 v84, 0
    v_mov_b32 v85, 0
    v_mov_b32 v86, 0
    v_mov_b32 v87, 0
    v_mov_b32 v88, 0
    v_mov_b32 v89, 0
    v_mov_b32 v90, 0
    v_mov_b32 v91, 0
    v_mov_b32 v92, 0
    v_mov_b32 v93, 0
    v_mov_b32 v94, 0
    v_mov_b32 v95, 0
    v_mov_b32 v96, 0
    v_mov_b32 v97, 0
    v_mov_b32 v98, 0
    v_mov_b32 v99, 0
    v_mov_b32 v100, 0
    v_mov_b32 v101, 0
    v_mov_b32 v102, 0
    v_mov_b32 v103, 0
    v_mov_b32 v104, 0
    v_mov_b32 v105, 0
    v_mov_b32 v106, 0
    v_mov_b32 v107, 0
    v_mov_b32 v108, 0
    v_mov_b32 v109, 0
    v_mov_b32 v110, 0
    v_mov_b32 v111, 0
    v_mov_b32 v112, 0
    v_mov_b32 v113, 0
    v_mov_b32 v114, 0
    v_mov_b32 v115, 0
    v_mov_b32 v116, 0
    v_mov_b32 v117, 0
    v_mov_b32 v118, 0
    v_mov_b32 v119, 0
    v_mov_b32 v120, 0
    v_mov_b32 v121, 0
    v_mov_b32 v122, 0
    v_mov_b32 v123, 0
    v_mov_b32 v124, 0
    v_mov_b32 v125, 0
    v_mov_b32 v126, 0
    v_mov_b32 v127, 0
    s_mov_b32 s50, 8192
    s_mov_b32 s58, 6144
    s_mov_b32 s51, 12288
    s_mov_b32 s59, 10240
    s_mov_b32 s52, 0
    s_mul_i32 s60, s9, 786432
    s_add_u32 s60, s60, 65273856
    s_lshl_b32 s61, s11, 10
    s_add_u32 s60, s60, s61
    s_and_b32 s61, s8, 2
    s_lshl_b32 s61, s61, 7
    s_add_u32 s60, s60, s61
    s_add_u32 s61, s60, 128
    s_mov_b32 s98, s10
    s_mov_b32 s99, s10
    s_mov_b32 s3, 0x100000
cp_9:
    s_load_dwordx8 s[64:71], s[4:5], s60 glc
    s_load_dwordx8 s[72:79], s[4:5], s61 glc
    s_sub_u32 s3, s3, 1
    s_cbranch_scc1 cp_9_ok
    s_waitcnt lgkmcnt(0)
    s_xor_b64 s[100:101], s[64:65], s[98:99]
    s_xor_b64 s[64:65], s[66:67], s[98:99]
    s_or_b64 s[100:101], s[100:101], s[64:65]
    s_xor_b64 s[64:65], s[68:69], s[98:99]
    s_or_b64 s[100:101], s[100:101], s[64:65]
    s_xor_b64 s[64:65], s[70:71], s[98:99]
    s_or_b64 s[100:101], s[100:101], s[64:65]
    s_xor_b64 s[64:65], s[72:73], s[98:99]
    s_or_b64 s[100:101], s[100:101], s[64:65]
    s_xor_b64 s[64:65], s[74:75], s[98:99]
    s_or_b64 s[100:101], s[100:101], s[64:65]
    s_xor_b64 s[64:65], s[76:77], s[98:99]
    s_or_b64 s[100:101], s[100:101], s[64:65]
    s_xor_b64 s[64:65], s[78:79], s[98:99]
    s_or_b64 s[100:101], s[100:101], s[64:65]
    s_cbranch_scc1 cp_9
cp_9_ok:
    s_waitcnt lgkmcnt(0)
    buffer_load_dwordx4 v[152:155], v6, s[16:19], 0 offen offset:0 sc1
    buffer_load_dwordx4 v[156:159], v6, s[16:19], 0 offen offset:256 sc1
    buffer_load_dwordx4 v[160:163], v6, s[20:23], 0 offen offset:0 sc1
    buffer_load_dwordx4 v[164:167], v6, s[20:23], 0 offen offset:256 sc1
    buffer_load_dwordx4 v[168:171], v6, s[16:19], 0 offen offset:2048 sc1
    buffer_load_dwordx4 v[172:175], v6, s[16:19], 0 offen offset:2304 sc1
    buffer_load_dwordx4 v[176:179], v6, s[20:23], 0 offen offset:2048 sc1
    buffer_load_dwordx4 v[180:183], v6, s[20:23], 0 offen offset:2304 sc1
    s_barrier
    ds_read_b64_tr_b16 v[128:129], v24 offset:0
    ds_read_b64_tr_b16 v[130:131], v24 offset:512
    ds_read_b64_tr_b16 v[132:133], v25 offset:0
    ds_read_b64_tr_b16 v[134:135], v25 offset:512
    ds_read_b64_tr_b16 v[136:137], v24 offset:8192
    ds_read_b64_tr_b16 v[138:139], v24 offset:8704
    ds_read_b64_tr_b16 v[140:141], v25 offset:8192
    ds_read_b64_tr_b16 v[142:143], v25 offset:8704
    ds_read_b64_tr_b16 v[144:145], v24 offset:16384
    ds_read_b64_tr_b16 v[146:147], v24 offset:16896
    buffer_load_dwordx4 a[0:3], v6, s[16:19], s54 offen offset:0 sc1
    buffer_load_dwordx4 a[4:7], v6, s[16:19], s54 offen offset:256 sc1
    buffer_load_dwordx4 a[8:11], v6, s[20:23], s54 offen offset:0 sc1
    buffer_load_dwordx4 a[12:15], v6, s[20:23], s54 offen offset:256 sc1
    buffer_load_dwordx4 a[16:19], v6, s[16:19], s54 offen offset:2048 sc1
    buffer_load_dwordx4 a[20:23], v6, s[16:19], s54 offen offset:2304 sc1
    s_mov_b32 s54, 7
.p2align 3
c_qkvB_loop:
    s_waitcnt vmcnt(12) lgkmcnt(8)
    v_mfma_f32_16x16x32_bf16 v[32:35], v[128:131], v[152:155], v[32:35]
    ds_read_b64_tr_b16 v[148:149], v25 offset:16384
    buffer_load_dwordx4 a[24:27], v6, s[20:23], s58 offen offset:0 sc1
    v_mfma_f32_16x16x32_bf16 v[36:39], v[128:131], v[156:159], v[36:39]
    ds_read_b64_tr_b16 v[150:151], v25 offset:16896
    s_waitcnt lgkmcnt(8)
    v_mfma_f32_16x16x32_bf16 v[52:55], v[132:135], v[156:159], v[52:55]
    v_mfma_f32_16x16x32_bf16 v[48:51], v[132:135], v[152:155], v[48:51]
    s_waitcnt lgkmcnt(6)
    v_mfma_f32_16x16x32_bf16 v[64:67], v[136:139], v[152:155], v[64:67]
    v_mfma_f32_16x16x32_bf16 v[68:71], v[136:139], v[156:159], v[68:71]
    s_waitcnt lgkmcnt(4)
    v_mfma_f32_16x16x32_bf16 v[84:87], v[140:143], v[156:159], v[84:87]
    buffer_load_dwordx4 a[28:31], v6, s[20:23], s58 offen offset:256 sc1
    v_mfma_f32_16x16x32_bf16 v[80:83], v[140:143], v[152:155], v[80:83]
    s_waitcnt lgkmcnt(2)
    v_mfma_f32_16x16x32_bf16 v[96:99], v[152:155], v[144:147], v[96:99]
    v_mfma_f32_16x16x32_bf16 v[100:103], v[156:159], v[144:147], v[100:103]
    s_waitcnt lgkmcnt(0)
    v_mfma_f32_16x16x32_bf16 v[116:119], v[156:159], v[148:151], v[116:119]
    v_mfma_f32_16x16x32_bf16 v[112:115], v[152:155], v[148:151], v[112:115]
    s_waitcnt vmcnt(12)
    v_mfma_f32_16x16x32_bf16 v[40:43], v[128:131], v[160:163], v[40:43]
    buffer_load_dwordx4 v[152:155], v6, s[16:19], s50 offen offset:0 sc1
    v_mfma_f32_16x16x32_bf16 v[44:47], v[128:131], v[164:167], v[44:47]
    v_mfma_f32_16x16x32_bf16 v[60:63], v[132:135], v[164:167], v[60:63]
    ds_read_b64_tr_b16 v[128:129], v24 offset:2048
    v_mfma_f32_16x16x32_bf16 v[56:59], v[132:135], v[160:163], v[56:59]
    ds_read_b64_tr_b16 v[130:131], v24 offset:2560
    v_mfma_f32_16x16x32_bf16 v[72:75], v[136:139], v[160:163], v[72:75]
    ds_read_b64_tr_b16 v[132:133], v25 offset:2048
    v_mfma_f32_16x16x32_bf16 v[76:79], v[136:139], v[164:167], v[76:79]
    ds_read_b64_tr_b16 v[134:135], v25 offset:2560
    v_mfma_f32_16x16x32_bf16 v[92:95], v[140:143], v[164:167], v[92:95]
    ds_read_b64_tr_b16 v[136:137], v24 offset:10240
    buffer_load_dwordx4 v[156:159], v6, s[16:19], s50 offen offset:256 sc1
    v_mfma_f32_16x16x32_bf16 v[88:91], v[140:143], v[160:163], v[88:91]
    ds_read_b64_tr_b16 v[138:139], v24 offset:10752
    v_mfma_f32_16x16x32_bf16 v[104:107], v[160:163], v[144:147], v[104:107]
    ds_read_b64_tr_b16 v[140:141], v25 offset:10240
    v_mfma_f32_16x16x32_bf16 v[108:111], v[164:167], v[144:147], v[108:111]
    ds_read_b64_tr_b16 v[142:143], v25 offset:10752
    v_mfma_f32_16x16x32_bf16 v[124:127], v[164:167], v[148:151], v[124:127]
    ds_read_b64_tr_b16 v[144:145], v24 offset:18432
    v_mfma_f32_16x16x32_bf16 v[120:123], v[160:163], v[148:151], v[120:123]
    ds_read_b64_tr_b16 v[146:147], v24 offset:18944
    s_waitcnt vmcnt(12) lgkmcnt(8)
    v_mfma_f32_16x16x32_bf16 v[32:35], v[128:131], v[168:171], v[32:35]
    ds_read_b64_tr_b16 v[148:149], v25 offset:18432
    buffer_load_dwordx4 v[160:163], v6, s[20:23], s58 offen offset:2048 sc1
    v_mfma_f32_16x16x32_bf16 v[36:39], v[128:131], v[172:175], v[36:39]
    ds_read_b64_tr_b16 v[150:151], v25 offset:18944
    s_waitcnt lgkmcnt(8)
    v_mfma_f32_16x16x32_bf16 v[52:55], v[132:135], v[172:175], v[52:55]
    v_mfma_f32_16x16x32_bf16 v[48:51], v[132:135], v[168:171], v[48:51]
    s_waitcnt lgkmcnt(6)
    v_mfma_f32_16x16x32_bf16 v[64:67], v[136:139], v[168:171], v[64:67]
    v_mfma_f32_16x16x32_bf16 v[68:71], v[136:139], v[172:175], v[68:71]
    s_waitcnt lgkmcnt(4)
    v_mfma_f32_16x16x32_bf16 v[84:87], v[140:143], v[172:175], v[84:87]
    buffer_load_dwordx4 v[164:167], v6, s[20:23], s58 offen offset:2304 sc1
    v_mfma_f32_16x16x32_bf16 v[80:83], v[140:143], v[168:171], v[80:83]
    s_waitcnt lgkmcnt(2)
    v_mfma_f32_16x16x32_bf16 v[96:99], v[168:171], v[144:147], v[96:99]
    v_mfma_f32_16x16x32_bf16 v[100:103], v[172:175], v[144:147], v[100:103]
    s_waitcnt lgkmcnt(0)
    v_mfma_f32_16x16x32_bf16 v[116:119], v[172:175], v[148:151], v[116:119]
    v_mfma_f32_16x16x32_bf16 v[112:115], v[168:171], v[148:151], v[112:115]
    s_waitcnt vmcnt(12)
    v_mfma_f32_16x16x32_bf16 v[40:43], v[128:131], v[176:179], v[40:43]
    buffer_load_dwordx4 v[168:171], v6, s[16:19], s50 offen offset:2048 sc1
    v_mfma_f32_16x16x32_bf16 v[44:47], v[128:131], v[180:183], v[44:47]
    v_mfma_f32_16x16x32_bf16 v[60:63], v[132:135], v[180:183], v[60:63]
    ds_read_b64_tr_b16 v[128:129], v24 offset:4096
    v_mfma_f32_16x16x32_bf16 v[56:59], v[132:135], v[176:179], v[56:59]
    ds_read_b64_tr_b16 v[130:131], v24 offset:4608
    v_mfma_f32_16x16x32_bf16 v[72:75], v[136:139], v[176:179], v[72:75]
    ds_read_b64_tr_b16 v[132:133], v25 offset:4096
    v_mfma_f32_16x16x32_bf16 v[76:79], v[136:139], v[180:183], v[76:79]
    ds_read_b64_tr_b16 v[134:135], v25 offset:4608
    v_mfma_f32_16x16x32_bf16 v[92:95], v[140:143], v[180:183], v[92:95]
    ds_read_b64_tr_b16 v[136:137], v24 offset:12288
    buffer_load_dwordx4 v[172:175], v6, s[16:19], s50 offen offset:2304 sc1
    v_mfma_f32_16x16x32_bf16 v[88:91], v[140:143], v[176:179], v[88:91]
    ds_read_b64_tr_b16 v[138:139], v24 offset:12800
    v_mfma_f32_16x16x32_bf16 v[104:107], v[176:179], v[144:147], v[104:107]
    ds_read_b64_tr_b16 v[140:141], v25 offset:12288
    v_mfma_f32_16x16x32_bf16 v[108:111], v[180:183], v[144:147], v[108:111]
    ds_read_b64_tr_b16 v[142:143], v25 offset:12800
    v_mfma_f32_16x16x32_bf16 v[124:127], v[180:183], v[148:151], v[124:127]
    ds_read_b64_tr_b16 v[144:145], v24 offset:20480
    v_mfma_f32_16x16x32_bf16 v[120:123], v[176:179], v[148:151], v[120:123]
    ds_read_b64_tr_b16 v[146:147], v24 offset:20992
    s_waitcnt vmcnt(12) lgkmcnt(8)
    v_mfma_f32_16x16x32_bf16 v[32:35], v[128:131], a[0:3], v[32:35]
    ds_read_b64_tr_b16 v[148:149], v25 offset:20480
    buffer_load_dwordx4 v[176:179], v6, s[20:23], s59 offen offset:0 sc1
    v_mfma_f32_16x16x32_bf16 v[36:39], v[128:131], a[4:7], v[36:39]
    ds_read_b64_tr_b16 v[150:151], v25 offset:20992
    s_waitcnt lgkmcnt(8)
    v_mfma_f32_16x16x32_bf16 v[52:55], v[132:135], a[4:7], v[52:55]
    s_add_u32 s58, s58, 8192
    v_mfma_f32_16x16x32_bf16 v[48:51], v[132:135], a[0:3], v[48:51]
    s_waitcnt lgkmcnt(6)
    v_mfma_f32_16x16x32_bf16 v[64:67], v[136:139], a[0:3], v[64:67]
    s_add_u32 s50, s50, 8192
    v_mfma_f32_16x16x32_bf16 v[68:71], v[136:139], a[4:7], v[68:71]
    s_waitcnt lgkmcnt(4)
    v_mfma_f32_16x16x32_bf16 v[84:87], v[140:143], a[4:7], v[84:87]
    buffer_load_dwordx4 v[180:183], v6, s[20:23], s59 offen offset:256 sc1
    v_mfma_f32_16x16x32_bf16 v[80:83], v[140:143], a[0:3], v[80:83]
    s_waitcnt lgkmcnt(2)
    v_mfma_f32_16x16x32_bf16 v[96:99], a[0:3], v[144:147], v[96:99]
    s_add_u32 s52, s52, 24576
    v_mfma_f32_16x16x32_bf16 v[100:103], a[4:7], v[144:147], v[100:103]
    s_cmp_eq_u32 s52, 147456
    s_waitcnt lgkmcnt(0)
    v_mfma_f32_16x16x32_bf16 v[116:119], a[4:7], v[148:151], v[116:119]
    s_cselect_b32 s52, 0, s52
    v_mfma_f32_16x16x32_bf16 v[112:115], a[0:3], v[148:151], v[112:115]
    s_waitcnt vmcnt(12)
    v_mfma_f32_16x16x32_bf16 v[40:43], v[128:131], a[8:11], v[40:43]
    buffer_load_dwordx4 a[0:3], v6, s[16:19], s51 offen offset:0 sc1
    v_mfma_f32_16x16x32_bf16 v[44:47], v[128:131], a[12:15], v[44:47]
    s_sub_u32 s54, s54, 1
    v_mfma_f32_16x16x32_bf16 v[60:63], v[132:135], a[12:15], v[60:63]
    ds_read_b64_tr_b16 v[128:129], v24 offset:6144
    v_mfma_f32_16x16x32_bf16 v[56:59], v[132:135], a[8:11], v[56:59]
    ds_read_b64_tr_b16 v[130:131], v24 offset:6656
    v_mfma_f32_16x16x32_bf16 v[72:75], v[136:139], a[8:11], v[72:75]
    ds_read_b64_tr_b16 v[132:133], v25 offset:6144
    v_mfma_f32_16x16x32_bf16 v[76:79], v[136:139], a[12:15], v[76:79]
    ds_read_b64_tr_b16 v[134:135], v25 offset:6656
    v_mfma_f32_16x16x32_bf16 v[92:95], v[140:143], a[12:15], v[92:95]
    ds_read_b64_tr_b16 v[136:137], v24 offset:14336
    buffer_load_dwordx4 a[4:7], v6, s[16:19], s51 offen offset:256 sc1
    v_mfma_f32_16x16x32_bf16 v[88:91], v[140:143], a[8:11], v[88:91]
    ds_read_b64_tr_b16 v[138:139], v24 offset:14848
    v_mfma_f32_16x16x32_bf16 v[104:107], a[8:11], v[144:147], v[104:107]
    ds_read_b64_tr_b16 v[140:141], v25 offset:14336
    v_mfma_f32_16x16x32_bf16 v[108:111], a[12:15], v[144:147], v[108:111]
    ds_read_b64_tr_b16 v[142:143], v25 offset:14848
    v_mfma_f32_16x16x32_bf16 v[124:127], a[12:15], v[148:151], v[124:127]
    ds_read_b64_tr_b16 v[144:145], v24 offset:22528
    v_mfma_f32_16x16x32_bf16 v[120:123], a[8:11], v[148:151], v[120:123]
    ds_read_b64_tr_b16 v[146:147], v24 offset:23040
    s_waitcnt vmcnt(12) lgkmcnt(8)
    v_mfma_f32_16x16x32_bf16 v[32:35], v[128:131], a[16:19], v[32:35]
    ds_read_b64_tr_b16 v[148:149], v25 offset:22528
    buffer_load_dwordx4 a[8:11], v6, s[20:23], s59 offen offset:2048 sc1
    v_mfma_f32_16x16x32_bf16 v[36:39], v[128:131], a[20:23], v[36:39]
    ds_read_b64_tr_b16 v[150:151], v25 offset:23040
    s_waitcnt lgkmcnt(8)
    v_mfma_f32_16x16x32_bf16 v[52:55], v[132:135], a[20:23], v[52:55]
    v_add_u32 v24, s52, v26
    v_mfma_f32_16x16x32_bf16 v[48:51], v[132:135], a[16:19], v[48:51]
    s_waitcnt lgkmcnt(6)
    v_mfma_f32_16x16x32_bf16 v[64:67], v[136:139], a[16:19], v[64:67]
    v_add_u32 v25, s52, v27
    v_mfma_f32_16x16x32_bf16 v[68:71], v[136:139], a[20:23], v[68:71]
    s_waitcnt lgkmcnt(4)
    v_mfma_f32_16x16x32_bf16 v[84:87], v[140:143], a[20:23], v[84:87]
    buffer_load_dwordx4 a[12:15], v6, s[20:23], s59 offen offset:2304 sc1
    v_mfma_f32_16x16x32_bf16 v[80:83], v[140:143], a[16:19], v[80:83]
    s_waitcnt lgkmcnt(2)
    v_mfma_f32_16x16x32_bf16 v[96:99], a[16:19], v[144:147], v[96:99]
    s_add_u32 s59, s59, 8192
    v_mfma_f32_16x16x32_bf16 v[100:103], a[20:23], v[144:147], v[100:103]
    s_waitcnt lgkmcnt(0)
    v_mfma_f32_16x16x32_bf16 v[116:119], a[20:23], v[148:151], v[116:119]
    v_mfma_f32_16x16x32_bf16 v[112:115], a[16:19], v[148:151], v[112:115]
    s_barrier
    s_waitcnt vmcnt(12)
    v_mfma_f32_16x16x32_bf16 v[40:43], v[128:131], a[24:27], v[40:43]
    buffer_load_dwordx4 a[16:19], v6, s[16:19], s51 offen offset:2048 sc1
    v_mfma_f32_16x16x32_bf16 v[44:47], v[128:131], a[28:31], v[44:47]
    v_mfma_f32_16x16x32_bf16 v[60:63], v[132:135], a[28:31], v[60:63]
    ds_read_b64_tr_b16 v[128:129], v24 offset:0
    v_mfma_f32_16x16x32_bf16 v[56:59], v[132:135], a[24:27], v[56:59]
    ds_read_b64_tr_b16 v[130:131], v24 offset:512
    v_mfma_f32_16x16x32_bf16 v[72:75], v[136:139], a[24:27], v[72:75]
    ds_read_b64_tr_b16 v[132:133], v25 offset:0
    v_mfma_f32_16x16x32_bf16 v[76:79], v[136:139], a[28:31], v[76:79]
    ds_read_b64_tr_b16 v[134:135], v25 offset:512
    v_mfma_f32_16x16x32_bf16 v[92:95], v[140:143], a[28:31], v[92:95]
    ds_read_b64_tr_b16 v[136:137], v24 offset:8192
    buffer_load_dwordx4 a[20:23], v6, s[16:19], s51 offen offset:2304 sc1
    v_mfma_f32_16x16x32_bf16 v[88:91], v[140:143], a[24:27], v[88:91]
    ds_read_b64_tr_b16 v[138:139], v24 offset:8704
    v_mfma_f32_16x16x32_bf16 v[104:107], a[24:27], v[144:147], v[104:107]
    ds_read_b64_tr_b16 v[140:141], v25 offset:8192
    s_add_u32 s51, s51, 8192
    v_mfma_f32_16x16x32_bf16 v[108:111], a[28:31], v[144:147], v[108:111]
    ds_read_b64_tr_b16 v[142:143], v25 offset:8704
    v_mfma_f32_16x16x32_bf16 v[124:127], a[28:31], v[148:151], v[124:127]
    ds_read_b64_tr_b16 v[144:145], v24 offset:16384
    s_cmp_lg_u32 s54, 0
    v_mfma_f32_16x16x32_bf16 v[120:123], a[24:27], v[148:151], v[120:123]
    ds_read_b64_tr_b16 v[146:147], v24 offset:16896
    s_cbranch_scc1 c_qkvB_loop
    s_waitcnt vmcnt(12) lgkmcnt(8)
    v_mfma_f32_16x16x32_bf16 v[32:35], v[128:131], v[152:155], v[32:35]
    ds_read_b64_tr_b16 v[148:149], v25 offset:16384
    buffer_load_dwordx4 a[24:27], v6, s[20:23], s58 offen offset:0 sc1
    v_mfma_f32_16x16x32_bf16 v[36:39], v[128:131], v[156:159], v[36:39]
    ds_read_b64_tr_b16 v[150:151], v25 offset:16896
    s_waitcnt lgkmcnt(8)
    v_mfma_f32_16x16x32_bf16 v[52:55], v[132:135], v[156:159], v[52:55]
    ds_read_b32 v184, v8 offset:1280
    v_mfma_f32_16x16x32_bf16 v[48:51], v[132:135], v[152:155], v[48:51]
    ds_read_b32 v186, v8 offset:1344
    s_waitcnt lgkmcnt(8)
    v_mfma_f32_16x16x32_bf16 v[64:67], v[136:139], v[152:155], v[64:67]
    ds_read_b32 v188, v8 offset:1408
    v_mfma_f32_16x16x32_bf16 v[68:71], v[136:139], v[156:159], v[68:71]
    s_waitcnt lgkmcnt(7)
    v_mfma_f32_16x16x32_bf16 v[84:87], v[140:143], v[156:159], v[84:87]
    buffer_load_dwordx4 a[28:31], v6, s[20:23], s58 offen offset:256 sc1
    ds_read_b32 v190, v8 offset:1472
    v_mfma_f32_16x16x32_bf16 v[80:83], v[140:143], v[152:155], v[80:83]
    ds_read_b128 v[212:215], v10 offset:512
    s_waitcnt lgkmcnt(7)
    v_mfma_f32_16x16x32_bf16 v[96:99], v[152:155], v[144:147], v[96:99]
    ds_read_b128 v[216:219], v10 offset:576
    v_mfma_f32_16x16x32_bf16 v[100:103], v[156:159], v[144:147], v[100:103]
    s_waitcnt lgkmcnt(6)
    v_mfma_f32_16x16x32_bf16 v[116:119], v[156:159], v[148:151], v[116:119]
    v_mfma_f32_16x16x32_bf16 v[112:115], v[152:155], v[148:151], v[112:115]
    s_waitcnt vmcnt(12)
    v_mfma_f32_16x16x32_bf16 v[40:43], v[128:131], v[160:163], v[40:43]
    s_waitcnt lgkmcnt(0)
    v_fma_f32 v64, -v184, v212, v64
    v_fma_f32 v65, -v184, v213, v65
    v_mfma_f32_16x16x32_bf16 v[44:47], v[128:131], v[164:167], v[44:47]
    v_fma_f32 v66, -v184, v214, v66
    v_mfma_f32_16x16x32_bf16 v[60:63], v[132:135], v[164:167], v[60:63]
    ds_read_b64_tr_b16 v[128:129], v24 offset:2048
    v_fma_f32 v67, -v184, v215, v67
    v_mfma_f32_16x16x32_bf16 v[56:59], v[132:135], v[160:163], v[56:59]
    ds_read_b64_tr_b16 v[130:131], v24 offset:2560
    v_fma_f32 v68, -v186, v212, v68
    v_fma_f32 v69, -v186, v213, v69
    v_mfma_f32_16x16x32_bf16 v[72:75], v[136:139], v[160:163], v[72:75]
    ds_read_b64_tr_b16 v[132:133], v25 offset:2048
    v_fma_f32 v70, -v186, v214, v70
    v_mfma_f32_16x16x32_bf16 v[76:79], v[136:139], v[164:167], v[76:79]
    ds_read_b64_tr_b16 v[134:135], v25 offset:2560
    v_fma_f32 v71, -v186, v215, v71
    v_mfma_f32_16x16x32_bf16 v[92:95], v[140:143], v[164:167], v[92:95]
    ds_read_b64_tr_b16 v[136:137], v24 offset:10240
    v_fma_f32 v80, -v184, v216, v80
    v_fma_f32 v81, -v184, v217, v81
    v_mfma_f32_16x16x32_bf16 v[88:91], v[140:143], v[160:163], v[88:91]
    ds_read_b64_tr_b16 v[138:139], v24 offset:10752
    v_fma_f32 v82, -v184, v218, v82
    v_mfma_f32_16x16x32_bf16 v[104:107], v[160:163], v[144:147], v[104:107]
    ds_read_b64_tr_b16 v[140:141], v25 offset:10240
    v_fma_f32 v83, -v184, v219, v83
    v_mfma_f32_16x16x32_bf16 v[108:111], v[164:167], v[144:147], v[108:111]
    ds_read_b64_tr_b16 v[142:143], v25 offset:10752
    v_fma_f32 v84, -v186, v216, v84
    v_fma_f32 v85, -v186, v217, v85
    v_mfma_f32_16x16x32_bf16 v[124:127], v[164:167], v[148:151], v[124:127]
    ds_read_b64_tr_b16 v[144:145], v24 offset:18432
    v_fma_f32 v86, -v186, v218, v86
    v_mfma_f32_16x16x32_bf16 v[120:123], v[160:163], v[148:151], v[120:123]
    ds_read_b64_tr_b16 v[146:147], v24 offset:18944
    v_fma_f32 v87, -v186, v219, v87
    s_waitcnt vmcnt(10) lgkmcnt(8)
    v_mfma_f32_16x16x32_bf16 v[32:35], v[128:131], v[168:171], v[32:35]
    ds_read_b64_tr_b16 v[148:149], v25 offset:18432
    v_fma_f32 v72, -v188, v212, v72
    v_fma_f32 v73, -v188, v213, v73
    v_mfma_f32_16x16x32_bf16 v[36:39], v[128:131], v[172:175], v[36:39]
    ds_read_b64_tr_b16 v[150:151], v25 offset:18944
    v_fma_f32 v74, -v188, v214, v74
    s_waitcnt lgkmcnt(8)
    v_mfma_f32_16x16x32_bf16 v[52:55], v[132:135], v[172:175], v[52:55]
    v_fma_f32 v75, -v188, v215, v75
    ds_read_b128 v[152:155], v10 offset:384
    v_mfma_f32_16x16x32_bf16 v[48:51], v[132:135], v[168:171], v[48:51]
    v_fma_f32 v76, -v190, v212, v76
    v_fma_f32 v77, -v190, v213, v77
    ds_read_b128 v[156:159], v10 offset:448
    s_waitcnt lgkmcnt(8)
    v_mfma_f32_16x16x32_bf16 v[64:67], v[136:139], v[168:171], v[64:67]
    v_fma_f32 v78, -v190, v214, v78
    ds_read_b32 v185, v8 offset:2816
    v_mfma_f32_16x16x32_bf16 v[68:71], v[136:139], v[172:175], v[68:71]
    v_fma_f32 v79, -v190, v215, v79
    s_waitcnt lgkmcnt(7)
    v_mfma_f32_16x16x32_bf16 v[84:87], v[140:143], v[172:175], v[84:87]
    v_fma_f32 v88, -v188, v216, v88
    v_fma_f32 v89, -v188, v217, v89
    ds_read_b32 v187, v8 offset:2880
    v_mfma_f32_16x16x32_bf16 v[80:83], v[140:143], v[168:171], v[80:83]
    v_fma_f32 v90, -v188, v218, v90
    ds_read_b32 v189, v8 offset:2944
    s_waitcnt lgkmcnt(7)
    v_mfma_f32_16x16x32_bf16 v[96:99], v[168:171], v[144:147], v[96:99]
    v_fma_f32 v91, -v188, v219, v91
    ds_read_b32 v191, v8 offset:3008
    v_mfma_f32_16x16x32_bf16 v[100:103], v[172:175], v[144:147], v[100:103]
    v_fma_f32 v92, -v190, v216, v92
    v_fma_f32 v93, -v190, v217, v93
    s_waitcnt lgkmcnt(6)
    v_mfma_f32_16x16x32_bf16 v[116:119], v[172:175], v[148:151], v[116:119]
    v_fma_f32 v94, -v190, v218, v94
    v_mfma_f32_16x16x32_bf16 v[112:115], v[168:171], v[148:151], v[112:115]
    v_fma_f32 v95, -v190, v219, v95
    s_waitcnt vmcnt(8)
    v_mfma_f32_16x16x32_bf16 v[40:43], v[128:131], v[176:179], v[40:43]
    s_waitcnt lgkmcnt(0)
    v_fma_f32 v32, -v184, v152, v32
    v_fma_f32 v33, -v184, v153, v33
    v_mfma_f32_16x16x32_bf16 v[44:47], v[128:131], v[180:183], v[44:47]
    v_fma_f32 v34, -v184, v154, v34
    v_mfma_f32_16x16x32_bf16 v[60:63], v[132:135], v[180:183], v[60:63]
    ds_read_b64_tr_b16 v[128:129], v24 offset:4096
    v_fma_f32 v35, -v184, v155, v35
    v_fma_f32 v36, -v186, v152, v36
    v_mfma_f32_16x16x32_bf16 v[56:59], v[132:135], v[176:179], v[56:59]
    ds_read_b64_tr_b16 v[130:131], v24 offset:4608
    v_fma_f32 v37, -v186, v153, v37
    v_mfma_f32_16x16x32_bf16 v[72:75], v[136:139], v[176:179], v[72:75]
    ds_read_b64_tr_b16 v[132:133], v25 offset:4096
    v_fma_f32 v38, -v186, v154, v38
    v_fma_f32 v39, -v186, v155, v39
    v_mfma_f32_16x16x32_bf16 v[76:79], v[136:139], v[180:183], v[76:79]
    ds_read_b64_tr_b16 v[134:135], v25 offset:4608
    v_fma_f32 v48, -v184, v156, v48
    v_mfma_f32_16x16x32_bf16 v[92:95], v[140:143], v[180:183], v[92:95]
    ds_read_b64_tr_b16 v[136:137], v24 offset:12288
    v_fma_f32 v49, -v184, v157, v49
    v_fma_f32 v50, -v184, v158, v50
    v_mfma_f32_16x16x32_bf16 v[88:91], v[140:143], v[176:179], v[88:91]
    ds_read_b64_tr_b16 v[138:139], v24 offset:12800
    v_fma_f32 v51, -v184, v159, v51
    v_mfma_f32_16x16x32_bf16 v[104:107], v[176:179], v[144:147], v[104:107]
    ds_read_b64_tr_b16 v[140:141], v25 offset:12288
    v_fma_f32 v52, -v186, v156, v52
    v_fma_f32 v53, -v186, v157, v53
    v_mfma_f32_16x16x32_bf16 v[108:111], v[180:183], v[144:147], v[108:111]
    ds_read_b64_tr_b16 v[142:143], v25 offset:12800
    v_fma_f32 v54, -v186, v158, v54
    v_mfma_f32_16x16x32_bf16 v[124:127], v[180:183], v[148:151], v[124:127]
    ds_read_b64_tr_b16 v[144:145], v24 offset:20480
    v_fma_f32 v55, -v186, v159, v55
    v_mfma_f32_16x16x32_bf16 v[120:123], v[176:179], v[148:151], v[120:123]
    ds_read_b64_tr_b16 v[146:147], v24 offset:20992
    s_waitcnt vmcnt(6) lgkmcnt(8)
    v_mfma_f32_16x16x32_bf16 v[32:35], v[128:131], a[0:3], v[32:35]
    ds_read_b64_tr_b16 v[148:149], v25 offset:20480
    v_fma_f32 v40, -v188, v152, v40
    v_fma_f32 v41, -v188, v153, v41
    v_mfma_f32_16x16x32_bf16 v[36:39], v[128:131], a[4:7], v[36:39]
    ds_read_b64_tr_b16 v[150:151], v25 offset:20992
    v_fma_f32 v42, -v188, v154, v42
    s_waitcnt lgkmcnt(8)
    v_mfma_f32_16x16x32_bf16 v[52:55], v[132:135], a[4:7], v[52:55]
    v_fma_f32 v43, -v188, v155, v43
    v_fma_f32 v44, -v190, v152, v44
    ds_read_b128 v[168:171], v9 offset:1280
    v_mfma_f32_16x16x32_bf16 v[48:51], v[132:135], a[0:3], v[48:51]
    v_fma_f32 v45, -v190, v153, v45
    ds_read_b128 v[172:175], v9 offset:1344
    s_waitcnt lgkmcnt(8)
    v_mfma_f32_16x16x32_bf16 v[64:67], v[136:139], a[0:3], v[64:67]
    v_fma_f32 v46, -v190, v154, v46
    v_fma_f32 v47, -v190, v155, v47
    v_mfma_f32_16x16x32_bf16 v[68:71], v[136:139], a[4:7], v[68:71]
    v_fma_f32 v56, -v188, v156, v56
    ds_read_b128 v[176:179], v9 offset:1408
    s_waitcnt lgkmcnt(7)
    v_mfma_f32_16x16x32_bf16 v[84:87], v[140:143], a[4:7], v[84:87]
    v_fma_f32 v57, -v188, v157, v57
    v_fma_f32 v58, -v188, v158, v58
    ds_read_b128 v[180:183], v9 offset:1472
    v_mfma_f32_16x16x32_bf16 v[80:83], v[140:143], a[0:3], v[80:83]
    v_fma_f32 v59, -v188, v159, v59
    s_waitcnt lgkmcnt(6)
    v_mfma_f32_16x16x32_bf16 v[96:99], a[0:3], v[144:147], v[96:99]
    v_fma_f32 v60, -v190, v156, v60
    v_fma_f32 v61, -v190, v157, v61
    ds_read2_b32 v[220:221], v11 offset0:160 offset1:176
    v_mfma_f32_16x16x32_bf16 v[100:103], a[4:7], v[144:147], v[100:103]
    v_fma_f32 v62, -v190, v158, v62
    s_waitcnt lgkmcnt(5)
    v_mfma_f32_16x16x32_bf16 v[116:119], a[4:7], v[148:151], v[116:119]
    v_fma_f32 v63, -v190, v159, v63
    v_mfma_f32_16x16x32_bf16 v[112:115], a[0:3], v[148:151], v[112:115]
    s_waitcnt vmcnt(4)
    v_mfma_f32_16x16x32_bf16 v[40:43], v[128:131], a[8:11], v[40:43]
    v_mfma_f32_16x16x32_bf16 v[44:47], v[128:131], a[12:15], v[44:47]
    s_waitcnt lgkmcnt(0)
    v_fma_f32 v96, -v168, v220, v96
    v_fma_f32 v97, -v169, v220, v97
    v_mfma_f32_16x16x32_bf16 v[60:63], v[132:135], a[12:15], v[60:63]
    ds_read_b64_tr_b16 v[128:129], v24 offset:6144
    v_fma_f32 v98, -v170, v220, v98
    v_mfma_f32_16x16x32_bf16 v[56:59], v[132:135], a[8:11], v[56:59]
    ds_read_b64_tr_b16 v[130:131], v24 offset:6656
    v_fma_f32 v99, -v171, v220, v99
    v_fma_f32 v100, -v172, v220, v100
    v_mfma_f32_16x16x32_bf16 v[72:75], v[136:139], a[8:11], v[72:75]
    ds_read_b64_tr_b16 v[132:133], v25 offset:6144
    v_fma_f32 v101, -v173, v220, v101
    v_mfma_f32_16x16x32_bf16 v[76:79], v[136:139], a[12:15], v[76:79]
    ds_read_b64_tr_b16 v[134:135], v25 offset:6656
    v_fma_f32 v102, -v174, v220, v102
    v_fma_f32 v103, -v175, v220, v103
    v_mfma_f32_16x16x32_bf16 v[92:95], v[140:143], a[12:15], v[92:95]
    ds_read_b64_tr_b16 v[136:137], v24 offset:14336
    v_fma_f32 v112, -v168, v221, v112
    v_mfma_f32_16x16x32_bf16 v[88:91], v[140:143], a[8:11], v[88:91]
    ds_read_b64_tr_b16 v[138:139], v24 offset:14848
    v_fma_f32 v113, -v169, v221, v113
    v_fma_f32 v114, -v170, v221, v114
    v_mfma_f32_16x16x32_bf16 v[104:107], a[8:11], v[144:147], v[104:107]
    ds_read_b64_tr_b16 v[140:141], v25 offset:14336
    v_fma_f32 v115, -v171, v221, v115
    v_mfma_f32_16x16x32_bf16 v[108:111], a[12:15], v[144:147], v[108:111]
    ds_read_b64_tr_b16 v[142:143], v25 offset:14848
    v_fma_f32 v116, -v172, v221, v116
    v_fma_f32 v117, -v173, v221, v117
    v_mfma_f32_16x16x32_bf16 v[124:127], a[12:15], v[148:151], v[124:127]
    ds_read_b64_tr_b16 v[144:145], v24 offset:22528
    v_fma_f32 v118, -v174, v221, v118
    v_mfma_f32_16x16x32_bf16 v[120:123], a[8:11], v[148:151], v[120:123]
    ds_read_b64_tr_b16 v[146:147], v24 offset:23040
    v_fma_f32 v119, -v175, v221, v119
    s_waitcnt vmcnt(2) lgkmcnt(8)
    v_mfma_f32_16x16x32_bf16 v[32:35], v[128:131], a[16:19], v[32:35]
    ds_read_b64_tr_b16 v[148:149], v25 offset:22528
    v_mfma_f32_16x16x32_bf16 v[36:39], v[128:131], a[20:23], v[36:39]
    ds_read_b64_tr_b16 v[150:151], v25 offset:23040
    v_fma_f32 v104, -v176, v220, v104
    v_fma_f32 v105, -v177, v220, v105
    s_waitcnt lgkmcnt(8)
    v_mfma_f32_16x16x32_bf16 v[52:55], v[132:135], a[20:23], v[52:55]
    v_fma_f32 v106, -v178, v220, v106
    ds_read_b128 v[152:155], v9 offset:2816
    v_mfma_f32_16x16x32_bf16 v[48:51], v[132:135], a[16:19], v[48:51]
    v_fma_f32 v107, -v179, v220, v107
    v_fma_f32 v108, -v180, v220, v108
    s_waitcnt lgkmcnt(7)
    v_mfma_f32_16x16x32_bf16 v[64:67], v[136:139], a[16:19], v[64:67]
    v_fma_f32 v109, -v181, v220, v109
    ds_read_b128 v[156:159], v9 offset:2880
    v_mfma_f32_16x16x32_bf16 v[68:71], v[136:139], a[20:23], v[68:71]
    v_fma_f32 v110, -v182, v220, v110
    v_fma_f32 v111, -v183, v220, v111
    s_waitcnt lgkmcnt(6)
    v_mfma_f32_16x16x32_bf16 v[84:87], v[140:143], a[20:23], v[84:87]
    v_fma_f32 v120, -v176, v221, v120
    ds_read_b128 v[160:163], v9 offset:2944
    v_mfma_f32_16x16x32_bf16 v[80:83], v[140:143], a[16:19], v[80:83]
    v_fma_f32 v121, -v177, v221, v121
    v_fma_f32 v122, -v178, v221, v122
    s_waitcnt lgkmcnt(5)
    v_mfma_f32_16x16x32_bf16 v[96:99], a[16:19], v[144:147], v[96:99]
    v_fma_f32 v123, -v179, v221, v123
    ds_read_b128 v[164:167], v9 offset:3008
    v_mfma_f32_16x16x32_bf16 v[100:103], a[20:23], v[144:147], v[100:103]
    v_fma_f32 v124, -v180, v221, v124
    v_fma_f32 v125, -v181, v221, v125
    s_waitcnt lgkmcnt(4)
    v_mfma_f32_16x16x32_bf16 v[116:119], a[20:23], v[148:151], v[116:119]
    v_fma_f32 v126, -v182, v221, v126
    v_mfma_f32_16x16x32_bf16 v[112:115], a[16:19], v[148:151], v[112:115]
    v_fma_f32 v127, -v183, v221, v127
    s_barrier
    s_waitcnt vmcnt(0)
    v_mfma_f32_16x16x32_bf16 v[40:43], v[128:131], a[24:27], v[40:43]
    v_mul_f32 v64, v185, v64
    v_mul_f32 v65, v185, v65
    v_mfma_f32_16x16x32_bf16 v[44:47], v[128:131], a[28:31], v[44:47]
    v_mul_f32 v66, v185, v66
    v_mul_f32 v67, v185, v67
    v_mfma_f32_16x16x32_bf16 v[60:63], v[132:135], a[28:31], v[60:63]
    v_mul_f32 v80, v185, v80
    v_mul_f32 v81, v185, v81
    v_mfma_f32_16x16x32_bf16 v[56:59], v[132:135], a[24:27], v[56:59]
    v_mul_f32 v82, v185, v82
    v_mul_f32 v83, v185, v83
    v_mfma_f32_16x16x32_bf16 v[72:75], v[136:139], a[24:27], v[72:75]
    v_cvt_pk_bf16_f32 v64, v64, v65
    v_cvt_pk_bf16_f32 v65, v66, v67
    v_mfma_f32_16x16x32_bf16 v[76:79], v[136:139], a[28:31], v[76:79]
    v_cvt_pk_bf16_f32 v66, v80, v81
    v_cvt_pk_bf16_f32 v67, v82, v83
    v_mfma_f32_16x16x32_bf16 v[92:95], v[140:143], a[28:31], v[92:95]
    v_mul_f32 v68, v187, v68
    v_mul_f32 v69, v187, v69
    v_mfma_f32_16x16x32_bf16 v[88:91], v[140:143], a[24:27], v[88:91]
    v_mul_f32 v70, v187, v70
    v_mul_f32 v71, v187, v71
    v_mfma_f32_16x16x32_bf16 v[104:107], a[24:27], v[144:147], v[104:107]
    v_mul_f32 v84, v187, v84
    v_mul_f32 v85, v187, v85
    v_mfma_f32_16x16x32_bf16 v[108:111], a[28:31], v[144:147], v[108:111]
    v_mul_f32 v86, v187, v86
    v_mul_f32 v87, v187, v87
    v_mfma_f32_16x16x32_bf16 v[124:127], a[28:31], v[148:151], v[124:127]
    v_cvt_pk_bf16_f32 v68, v68, v69
    v_cvt_pk_bf16_f32 v69, v70, v71
    v_mfma_f32_16x16x32_bf16 v[120:123], a[24:27], v[148:151], v[120:123]
    v_cvt_pk_bf16_f32 v70, v84, v85
    v_cvt_pk_bf16_f32 v71, v86, v87
    buffer_store_dwordx4 v[64:67], v12, s[12:15], s84 offen offset:0 sc1
    ds_write_b128 v12, v[64:67] offset:0
    buffer_store_dwordx4 v[68:71], v12, s[12:15], s84 offen offset:256 sc1
    ds_write_b128 v12, v[68:71] offset:256
    v_pk_mul_f32 v[72:73], v[188:189], v[72:73] op_sel:[1,0] op_sel_hi:[1,1]
    v_pk_mul_f32 v[74:75], v[188:189], v[74:75] op_sel:[1,0] op_sel_hi:[1,1]
    v_pk_mul_f32 v[88:89], v[188:189], v[88:89] op_sel:[1,0] op_sel_hi:[1,1]
    v_pk_mul_f32 v[90:91], v[188:189], v[90:91] op_sel:[1,0] op_sel_hi:[1,1]
    v_cvt_pk_bf16_f32 v72, v72, v73
    v_cvt_pk_bf16_f32 v73, v74, v75
    v_cvt_pk_bf16_f32 v74, v88, v89
    v_cvt_pk_bf16_f32 v75, v90, v91
    buffer_store_dwordx4 v[72:75], v12, s[12:15], s84 offen offset:2048 sc1
    ds_write_b128 v12, v[72:75] offset:2048
    v_pk_mul_f32 v[76:77], v[190:191], v[76:77] op_sel:[1,0] op_sel_hi:[1,1]
    v_pk_mul_f32 v[78:79], v[190:191], v[78:79] op_sel:[1,0] op_sel_hi:[1,1]
    v_pk_mul_f32 v[92:93], v[190:191], v[92:93] op_sel:[1,0] op_sel_hi:[1,1]
    v_pk_mul_f32 v[94:95], v[190:191], v[94:95] op_sel:[1,0] op_sel_hi:[1,1]
    v_cvt_pk_bf16_f32 v76, v76, v77
    v_cvt_pk_bf16_f32 v77, v78, v79
    v_cvt_pk_bf16_f32 v78, v92, v93
    v_cvt_pk_bf16_f32 v79, v94, v95
    buffer_store_dwordx4 v[76:79], v12, s[12:15], s84 offen offset:2304 sc1
    ds_write_b128 v12, v[76:79] offset:2304
    s_waitcnt lgkmcnt(4)
    v_pk_mul_f32 v[96:97], v[152:153], v[96:97]
    v_pk_mul_f32 v[98:99], v[154:155], v[98:99]
    v_pk_mul_f32 v[112:113], v[152:153], v[112:113]
    v_pk_mul_f32 v[114:115], v[154:155], v[114:115]
    v_cvt_pk_bf16_f32 v96, v96, v97
    v_cvt_pk_bf16_f32 v97, v98, v99
    v_cvt_pk_bf16_f32 v98, v112, v113
    v_cvt_pk_bf16_f32 v99, v114, v115
    v_mul_f32 v185, 0x3e8293ee, v185
    v_permlane16_swap_b32 v96, v98
    v_permlane16_swap_b32 v97, v99
    buffer_store_dwordx4 v[96:99], v13, s[12:15], s85 offen offset:0 sc1
    ds_write_b128 v13, v[96:99] offset:8192
    v_pk_mul_f32 v[100:101], v[156:157], v[100:101]
    v_pk_mul_f32 v[102:103], v[158:159], v[102:103]
    v_pk_mul_f32 v[116:117], v[156:157], v[116:117]
    v_pk_mul_f32 v[118:119], v[158:159], v[118:119]
    v_cvt_pk_bf16_f32 v100, v100, v101
    v_cvt_pk_bf16_f32 v101, v102, v103
    v_cvt_pk_bf16_f32 v102, v116, v117
    v_cvt_pk_bf16_f32 v103, v118, v119
    v_mul_f32 v187, 0x3e8293ee, v187
    v_permlane16_swap_b32 v100, v102
    v_permlane16_swap_b32 v101, v103
    buffer_store_dwordx4 v[100:103], v13, s[12:15], s85 offen offset:1024 sc1
    ds_write_b128 v13, v[100:103] offset:9216
    v_pk_mul_f32 v[104:105], v[160:161], v[104:105]
    v_pk_mul_f32 v[106:107], v[162:163], v[106:107]
    v_pk_mul_f32 v[120:121], v[160:161], v[120:121]
    v_pk_mul_f32 v[122:123], v[162:163], v[122:123]
    v_cvt_pk_bf16_f32 v104, v104, v105
    v_cvt_pk_bf16_f32 v105, v106, v107
    v_cvt_pk_bf16_f32 v106, v120, v121
    v_cvt_pk_bf16_f32 v107, v122, v123
    v_mul_f32 v189, 0x3e8293ee, v189
    v_permlane16_swap_b32 v104, v106
    v_permlane16_swap_b32 v105, v107
    buffer_store_dwordx4 v[104:107], v13, s[12:15], s85 offen offset:2048 sc1
    ds_write_b128 v13, v[104:107] offset:10240
    v_pk_mul_f32 v[108:109], v[164:165], v[108:109]
    v_pk_mul_f32 v[110:111], v[166:167], v[110:111]
    v_pk_mul_f32 v[124:125], v[164:165], v[124:125]
    v_pk_mul_f32 v[126:127], v[166:167], v[126:127]
    v_cvt_pk_bf16_f32 v108, v108, v109
    v_cvt_pk_bf16_f32 v109, v110, v111
    v_cvt_pk_bf16_f32 v110, v124, v125
    v_cvt_pk_bf16_f32 v111, v126, v127
    v_mul_f32 v191, 0x3e8293ee, v191
    v_permlane16_swap_b32 v108, v110
    v_permlane16_swap_b32 v109, v111
    buffer_store_dwordx4 v[108:111], v13, s[12:15], s85 offen offset:3072 sc1
    ds_write_b128 v13, v[108:111] offset:11264
    v_add_u32 v24, 81920, v5
    s_waitcnt lgkmcnt(0)
    s_barrier
    ds_read_b128 v[128:131], v24 offset:0
    ds_read_b128 v[132:135], v24 offset:1024
    ds_read_b128 v[136:139], v24 offset:2048
    ds_read_b128 v[140:143], v24 offset:3072
    v_pk_mul_f32 v[32:33], v[184:185], v[32:33] op_sel:[1,0] op_sel_hi:[1,1]
    v_pk_mul_f32 v[34:35], v[184:185], v[34:35] op_sel:[1,0] op_sel_hi:[1,1]
    v_pk_mul_f32 v[48:49], v[184:185], v[48:49] op_sel:[1,0] op_sel_hi:[1,1]
    v_pk_mul_f32 v[50:51], v[184:185], v[50:51] op_sel:[1,0] op_sel_hi:[1,1]
    v_cvt_pk_bf16_f32 v8, v32, v33
    v_cvt_pk_bf16_f32 v9, v34, v35
    v_cvt_pk_bf16_f32 v10, v48, v49
    v_cvt_pk_bf16_f32 v11, v50, v51
    v_pk_mul_f32 v[36:37], v[186:187], v[36:37] op_sel:[1,0] op_sel_hi:[1,1]
    v_pk_mul_f32 v[38:39], v[186:187], v[38:39] op_sel:[1,0] op_sel_hi:[1,1]
    v_pk_mul_f32 v[52:53], v[186:187], v[52:53] op_sel:[1,0] op_sel_hi:[1,1]
    v_pk_mul_f32 v[54:55], v[186:187], v[54:55] op_sel:[1,0] op_sel_hi:[1,1]
    v_cvt_pk_bf16_f32 v12, v36, v37
    v_cvt_pk_bf16_f32 v13, v38, v39
    v_cvt_pk_bf16_f32 v14, v52, v53
    v_cvt_pk_bf16_f32 v15, v54, v55
    v_pk_mul_f32 v[40:41], v[188:189], v[40:41] op_sel:[1,0] op_sel_hi:[1,1]
    v_pk_mul_f32 v[42:43], v[188:189], v[42:43] op_sel:[1,0] op_sel_hi:[1,1]
    v_pk_mul_f32 v[56:57], v[188:189], v[56:57] op_sel:[1,0] op_sel_hi:[1,1]
    v_pk_mul_f32 v[58:59], v[188:189], v[58:59] op_sel:[1,0] op_sel_hi:[1,1]
    v_cvt_pk_bf16_f32 v16, v40, v41
    v_cvt_pk_bf16_f32 v17, v42, v43
    v_cvt_pk_bf16_f32 v18, v56, v57
    v_cvt_pk_bf16_f32 v19, v58, v59
    v_pk_mul_f32 v[44:45], v[190:191], v[44:45] op_sel:[1,0] op_sel_hi:[1,1]
    v_pk_mul_f32 v[46:47], v[190:191], v[46:47] op_sel:[1,0] op_sel_hi:[1,1]
    v_pk_mul_f32 v[60:61], v[190:191], v[60:61] op_sel:[1,0] op_sel_hi:[1,1]
    v_pk_mul_f32 v[62:63], v[190:191], v[62:63] op_sel:[1,0] op_sel_hi:[1,1]
    v_cvt_pk_bf16_f32 v20, v44, v45
    v_cvt_pk_bf16_f32 v21, v46, v47
    v_cvt_pk_bf16_f32 v22, v60, v61
    v_cvt_pk_bf16_f32 v23, v62, v63
    v_permlane16_swap_b32 v8, v12
    v_permlane16_swap_b32 v9, v13
    v_permlane16_swap_b32 v10, v14
    v_permlane16_swap_b32 v11, v15
    v_permlane16_swap_b32 v16, v20
    v_permlane16_swap_b32 v17, v21
    v_permlane16_swap_b32 v18, v22
    v_permlane16_swap_b32 v19, v23
    s_waitcnt lgkmcnt(0)
    v_mfma_f32_32x32x16_bf16 v[64:79], v[128:131], v[8:11], 0
    v_mfma_f32_32x32x16_bf16 v[64:79], v[132:135], v[12:15], v[64:79]
    v_and_b32 v25, 7, v1
    v_mov_b32 v26, 0x3f803f80
    v_cmp_eq_u32 vcc, 0, v25
    s_nop 1
    v_cndmask_b32 v200, 0, v26, vcc
    v_cndmask_b32 v201, 0, v26, vcc
    v_cmp_eq_u32 vcc, 4, v25
    s_nop 1
    v_cndmask_b32 v202, 0, v26, vcc
    v_cndmask_b32 v203, 0, v26, vcc
    v_mov_b32 v204, 0xdddddddd
    v_mov_b32 v160, 0
    v_mov_b32 v161, 0
    v_mov_b32 v162, 0
    v_mov_b32 v163, 0
    v_mov_b32 v164, 0
    v_mov_b32 v165, 0
    v_mov_b32 v166, 0
    v_mov_b32 v167, 0
    v_mov_b32 v168, 0
    v_mov_b32 v169, 0
    v_mov_b32 v170, 0
    v_mov_b32 v171, 0
    v_mov_b32 v172, 0
    v_mov_b32 v173, 0
    v_mov_b32 v174, 0
    v_mov_b32 v175, 0
    v_mov_b32 v192, 0
    v_mov_b32 v193, 0
    v_mov_b32 v194, 0
    v_mov_b32 v195, 0
    v_mov_b32 v176, 0
    v_mov_b32 v177, 0
    v_mov_b32 v178, 0
    v_mov_b32 v179, 0
    v_mov_b32 v180, 0
    v_mov_b32 v181, 0
    v_mov_b32 v182, 0
    v_mov_b32 v183, 0
    v_mov_b32 v184, 0
    v_mov_b32 v185, 0
    v_mov_b32 v186, 0
    v_mov_b32 v187, 0
    v_mov_b32 v188, 0
    v_mov_b32 v189, 0
    v_mov_b32 v190, 0
    v_mov_b32 v191, 0
    v_mov_b32 v196, 0
    v_mov_b32 v197, 0
    v_mov_b32 v198, 0
    v_mov_b32 v199, 0
    v_mov_b32 v112, 0
    v_mov_b32 v113, 0
    v_mov_b32 v114, 0
    v_mov_b32 v115, 0
    v_mov_b32 v116, 0
    v_mov_b32 v117, 0
    v_mov_b32 v118, 0
    v_mov_b32 v119, 0
    v_mov_b32 v120, 0
    v_mov_b32 v121, 0
    v_mov_b32 v122, 0
    v_mov_b32 v123, 0
    v_mov_b32 v124, 0
    v_mov_b32 v125, 0
    v_mov_b32 v126, 0
    v_mov_b32 v127, 0
    v_mov_b32 v152, 0
    v_mov_b32 v153, 0
    v_mov_b32 v154, 0
    v_mov_b32 v155, 0
    v_mov_b32 v156, 0
    v_mov_b32 v157, 0
    v_mov_b32 v158, 0
    v_mov_b32 v159, 0
    s_mov_b32 s54, 4
    s_mov_b64 exec, 0xff
    s_waitcnt vmcnt(0)
    buffer_store_dword v29, v28, s[12:15], s53 offen sc1
    s_mov_b64 exec, -1
.p2align 3
c_attn_loop:
    v_mfma_f32_32x32x16_bf16 v[80:95], v[128:131], v[16:19], 0
    v_exp_f32 v64, v64
    v_exp_f32 v65, v65
    v_exp_f32 v66, v66
    v_mfma_f32_32x32x16_bf16 v[80:95], v[132:135], v[20:23], v[80:95]
    v_exp_f32 v67, v67
    v_exp_f32 v68, v68
    v_exp_f32 v69, v69
    v_smfmac_f32_32x32x32_bf16 v[176:191], v[152:155], v[112:119], v204
    s_waitcnt lgkmcnt(0)
    v_exp_f32 v70, v70
    v_exp_f32 v71, v71
    v_exp_f32 v72, v72
    v_smfmac_f32_16x16x64_bf16 v[196:199], v[200:203], v[112:119], v204
    ds_read_b128 v[144:147], v24 offset:8192
    v_exp_f32 v73, v73
    v_exp_f32 v74, v74
    v_smfmac_f32_32x32x32_bf16 v[176:191], v[156:159], v[120:127], v204
    v_exp_f32 v75, v75
    v_exp_f32 v76, v76
    v_exp_f32 v77, v77
    v_smfmac_f32_16x16x64_bf16 v[196:199], v[200:203], v[120:127], v204
    ds_read_b128 v[148:151], v24 offset:9216
    v_exp_f32 v78, v78
    v_exp_f32 v79, v79
    v_mfma_f32_32x32x16_bf16 v[96:111], v[136:139], v[8:11], 0
    v_exp_f32 v80, v80
    v_exp_f32 v81, v81
    v_exp_f32 v82, v82
    v_mfma_f32_32x32x16_bf16 v[96:111], v[140:143], v[12:15], v[96:111]
    s_waitcnt lgkmcnt(1)
    v_exp_f32 v83, v83
    v_exp_f32 v84, v84
    v_exp_f32 v85, v85
    v_smfmac_f32_32x32x32_bf16 v[160:175], v[144:147], v[64:71], v204
    s_waitcnt lgkmcnt(0)
    v_exp_f32 v86, v86
    v_exp_f32 v87, v87
    v_exp_f32 v88, v88
    v_smfmac_f32_16x16x64_bf16 v[192:195], v[200:203], v[64:71], v204
    ds_read_b128 v[128:131], v24 offset:4096
    v_exp_f32 v89, v89
    v_exp_f32 v90, v90
    v_smfmac_f32_32x32x32_bf16 v[160:175], v[148:151], v[72:79], v204
    v_exp_f32 v91, v91
    v_exp_f32 v92, v92
    v_exp_f32 v93, v93
    v_smfmac_f32_16x16x64_bf16 v[192:195], v[200:203], v[72:79], v204
    ds_read_b128 v[132:135], v24 offset:5120
    v_exp_f32 v94, v94
    v_exp_f32 v95, v95
    v_mfma_f32_32x32x16_bf16 v[112:127], v[136:139], v[16:19], 0
    v_exp_f32 v96, v96
    v_exp_f32 v97, v97
    v_exp_f32 v98, v98
    v_mfma_f32_32x32x16_bf16 v[112:127], v[140:143], v[20:23], v[112:127]
    v_exp_f32 v99, v99
    v_exp_f32 v100, v100
    v_exp_f32 v101, v101
    v_smfmac_f32_32x32x32_bf16 v[176:191], v[144:147], v[80:87], v204
    s_waitcnt lgkmcnt(0)
    v_exp_f32 v102, v102
    v_exp_f32 v103, v103
    v_exp_f32 v104, v104
    v_smfmac_f32_16x16x64_bf16 v[196:199], v[200:203], v[80:87], v204
    ds_read_b128 v[152:155], v24 offset:10240
    v_exp_f32 v105, v105
    v_exp_f32 v106, v106
    v_smfmac_f32_32x32x32_bf16 v[176:191], v[148:151], v[88:95], v204
    v_exp_f32 v107, v107
    v_exp_f32 v108, v108
    v_exp_f32 v109, v109
    v_smfmac_f32_16x16x64_bf16 v[196:199], v[200:203], v[88:95], v204
    ds_read_b128 v[156:159], v24 offset:11264
    v_exp_f32 v110, v110
    v_exp_f32 v111, v111
    v_mfma_f32_32x32x16_bf16 v[64:79], v[128:131], v[8:11], 0
    v_exp_f32 v112, v112
    v_exp_f32 v113, v113
    v_exp_f32 v114, v114
    v_mfma_f32_32x32x16_bf16 v[64:79], v[132:135], v[12:15], v[64:79]
    s_waitcnt lgkmcnt(1)
    v_exp_f32 v115, v115
    v_exp_f32 v116, v116
    v_exp_f32 v117, v117
    v_smfmac_f32_32x32x32_bf16 v[160:175], v[152:155], v[96:103], v204
    s_waitcnt lgkmcnt(0)
    v_exp_f32 v118, v118
    v_exp_f32 v119, v119
    v_exp_f32 v120, v120
    v_smfmac_f32_16x16x64_bf16 v[192:195], v[200:203], v[96:103], v204
    ds_read_b128 v[136:139], v24 offset:6144
    v_exp_f32 v121, v121
    v_exp_f32 v122, v122
    v_smfmac_f32_32x32x32_bf16 v[160:175], v[156:159], v[104:111], v204
    v_exp_f32 v123, v123
    v_exp_f32 v124, v124
    v_exp_f32 v125, v125
    v_smfmac_f32_16x16x64_bf16 v[192:195], v[200:203], v[104:111], v204
    ds_read_b128 v[140:143], v24 offset:7168
    v_exp_f32 v126, v126
    v_exp_f32 v127, v127
    v_mfma_f32_32x32x16_bf16 v[80:95], v[128:131], v[16:19], 0
    s_cmp_eq_u32 s54, 4
    v_exp_f32 v64, v64
    v_exp_f32 v65, v65
    v_exp_f32 v66, v66
    v_mfma_f32_32x32x16_bf16 v[80:95], v[132:135], v[20:23], v[80:95]
    v_exp_f32 v67, v67
    v_exp_f32 v68, v68
    v_exp_f32 v69, v69
    v_smfmac_f32_32x32x32_bf16 v[176:191], v[152:155], v[112:119], v204
    s_waitcnt lgkmcnt(0)
    v_exp_f32 v70, v70
    v_exp_f32 v71, v71
    v_exp_f32 v72, v72
    v_smfmac_f32_16x16x64_bf16 v[196:199], v[200:203], v[112:119], v204
    ds_read_b128 v[144:147], v24 offset:12288
    v_exp_f32 v73, v73
    v_exp_f32 v74, v74
    v_smfmac_f32_32x32x32_bf16 v[176:191], v[156:159], v[120:127], v204
    v_exp_f32 v75, v75
    v_exp_f32 v76, v76
    v_exp_f32 v77, v77
    v_smfmac_f32_16x16x64_bf16 v[196:199], v[200:203], v[120:127], v204
    ds_read_b128 v[148:151], v24 offset:13312
    v_exp_f32 v78, v78
    v_exp_f32 v79, v79
    v_mfma_f32_32x32x16_bf16 v[96:111], v[136:139], v[8:11], 0
    s_cbranch_scc1 c_attn_nobar
    s_barrier
c_attn_nobar:
    v_exp_f32 v80, v80
    v_exp_f32 v81, v81
    v_exp_f32 v82, v82
    v_mfma_f32_32x32x16_bf16 v[96:111], v[140:143], v[12:15], v[96:111]
    s_waitcnt lgkmcnt(1)
    v_exp_f32 v83, v83
    v_exp_f32 v84, v84
    v_exp_f32 v85, v85
    v_smfmac_f32_32x32x32_bf16 v[160:175], v[144:147], v[64:71], v204
    s_waitcnt lgkmcnt(0)
    v_exp_f32 v86, v86
    v_exp_f32 v87, v87
    v_exp_f32 v88, v88
    v_smfmac_f32_16x16x64_bf16 v[192:195], v[200:203], v[64:71], v204
    ds_read_b128 v[128:131], v24 offset:16384
    v_exp_f32 v89, v89
    v_exp_f32 v90, v90
    v_smfmac_f32_32x32x32_bf16 v[160:175], v[148:151], v[72:79], v204
    v_exp_f32 v91, v91
    v_exp_f32 v92, v92
    v_exp_f32 v93, v93
    v_smfmac_f32_16x16x64_bf16 v[192:195], v[200:203], v[72:79], v204
    ds_read_b128 v[132:135], v24 offset:17408
    v_exp_f32 v94, v94
    v_exp_f32 v95, v95
    v_mfma_f32_32x32x16_bf16 v[112:127], v[136:139], v[16:19], 0
    v_exp_f32 v96, v96
    v_exp_f32 v97, v97
    v_exp_f32 v98, v98
    v_mfma_f32_32x32x16_bf16 v[112:127], v[140:143], v[20:23], v[112:127]
    v_exp_f32 v99, v99
    v_exp_f32 v100, v100
    v_exp_f32 v101, v101
    v_smfmac_f32_32x32x32_bf16 v[176:191], v[144:147], v[80:87], v204
    s_waitcnt lgkmcnt(0)
    v_exp_f32 v102, v102
    v_exp_f32 v103, v103
    v_exp_f32 v104, v104
    v_smfmac_f32_16x16x64_bf16 v[196:199], v[200:203], v[80:87], v204
    ds_read_b128 v[152:155], v24 offset:14336
    v_exp_f32 v105, v105
    v_exp_f32 v106, v106
    v_smfmac_f32_32x32x32_bf16 v[176:191], v[148:151], v[88:95], v204
    v_exp_f32 v107, v107
    v_exp_f32 v108, v108
    v_exp_f32 v109, v109
    v_smfmac_f32_16x16x64_bf16 v[196:199], v[200:203], v[88:95], v204
    ds_read_b128 v[156:159], v24 offset:15360
    v_exp_f32 v110, v110
    v_exp_f32 v111, v111
    v_mfma_f32_32x32x16_bf16 v[64:79], v[128:131], v[8:11], 0
    v_exp_f32 v112, v112
    v_exp_f32 v113, v113
    v_exp_f32 v114, v114
    v_mfma_f32_32x32x16_bf16 v[64:79], v[132:135], v[12:15], v[64:79]
    s_waitcnt lgkmcnt(1)
    v_exp_f32 v115, v115
    v_exp_f32 v116, v116
    v_exp_f32 v117, v117
    v_smfmac_f32_32x32x32_bf16 v[160:175], v[152:155], v[96:103], v204
    s_waitcnt lgkmcnt(0)
    v_exp_f32 v118, v118
    v_exp_f32 v119, v119
    v_exp_f32 v120, v120
    v_smfmac_f32_16x16x64_bf16 v[192:195], v[200:203], v[96:103], v204
    ds_read_b128 v[136:139], v24 offset:18432
    v_exp_f32 v121, v121
    v_exp_f32 v122, v122
    v_smfmac_f32_32x32x32_bf16 v[160:175], v[156:159], v[104:111], v204
    v_exp_f32 v123, v123
    v_exp_f32 v124, v124
    v_exp_f32 v125, v125
    v_smfmac_f32_16x16x64_bf16 v[192:195], v[200:203], v[104:111], v204
    ds_read_b128 v[140:143], v24 offset:19456
    v_exp_f32 v126, v126
    v_exp_f32 v127, v127
    v_mfma_f32_32x32x16_bf16 v[80:95], v[128:131], v[16:19], 0
    v_exp_f32 v64, v64
    v_exp_f32 v65, v65
    v_exp_f32 v66, v66
    v_mfma_f32_32x32x16_bf16 v[80:95], v[132:135], v[20:23], v[80:95]
    v_exp_f32 v67, v67
    v_exp_f32 v68, v68
    v_exp_f32 v69, v69
    v_smfmac_f32_32x32x32_bf16 v[176:191], v[152:155], v[112:119], v204
    s_waitcnt lgkmcnt(0)
    v_exp_f32 v70, v70
    v_exp_f32 v71, v71
    v_exp_f32 v72, v72
    v_smfmac_f32_16x16x64_bf16 v[196:199], v[200:203], v[112:119], v204
    ds_read_b128 v[144:147], v24 offset:24576
    v_exp_f32 v73, v73
    v_exp_f32 v74, v74
    v_smfmac_f32_32x32x32_bf16 v[176:191], v[156:159], v[120:127], v204
    v_exp_f32 v75, v75
    v_exp_f32 v76, v76
    v_exp_f32 v77, v77
    v_smfmac_f32_16x16x64_bf16 v[196:199], v[200:203], v[120:127], v204
    ds_read_b128 v[148:151], v24 offset:25600
    v_exp_f32 v78, v78
    v_exp_f32 v79, v79
    v_mfma_f32_32x32x16_bf16 v[96:111], v[136:139], v[8:11], 0
    v_exp_f32 v80, v80
    v_exp_f32 v81, v81
    v_exp_f32 v82, v82
    v_mfma_f32_32x32x16_bf16 v[96:111], v[140:143], v[12:15], v[96:111]
    s_waitcnt lgkmcnt(1)
    v_exp_f32 v83, v83
    v_exp_f32 v84, v84
    v_exp_f32 v85, v85
    v_smfmac_f32_32x32x32_bf16 v[160:175], v[144:147], v[64:71], v204
    s_waitcnt lgkmcnt(0)
    v_exp_f32 v86, v86
    v_exp_f32 v87, v87
    v_exp_f32 v88, v88
    v_smfmac_f32_16x16x64_bf16 v[192:195], v[200:203], v[64:71], v204
    ds_read_b128 v[128:131], v24 offset:20480
    v_exp_f32 v89, v89
    v_exp_f32 v90, v90
    v_smfmac_f32_32x32x32_bf16 v[160:175], v[148:151], v[72:79], v204
    v_exp_f32 v91, v91
    v_exp_f32 v92, v92
    v_exp_f32 v93, v93
    v_smfmac_f32_16x16x64_bf16 v[192:195], v[200:203], v[72:79], v204
    ds_read_b128 v[132:135], v24 offset:21504
    v_exp_f32 v94, v94
    v_exp_f32 v95, v95
    v_mfma_f32_32x32x16_bf16 v[112:127], v[136:139], v[16:19], 0
    v_exp_f32 v96, v96
    v_exp_f32 v97, v97
    v_exp_f32 v98, v98
    v_mfma_f32_32x32x16_bf16 v[112:127], v[140:143], v[20:23], v[112:127]
    v_exp_f32 v99, v99
    v_exp_f32 v100, v100
    v_exp_f32 v101, v101
    v_smfmac_f32_32x32x32_bf16 v[176:191], v[144:147], v[80:87], v204
    s_waitcnt lgkmcnt(0)
    v_exp_f32 v102, v102
    v_exp_f32 v103, v103
    v_exp_f32 v104, v104
    v_smfmac_f32_16x16x64_bf16 v[196:199], v[200:203], v[80:87], v204
    ds_read_b128 v[152:155], v24 offset:26624
    v_exp_f32 v105, v105
    v_exp_f32 v106, v106
    v_smfmac_f32_32x32x32_bf16 v[176:191], v[148:151], v[88:95], v204
    v_exp_f32 v107, v107
    v_exp_f32 v108, v108
    v_exp_f32 v109, v109
    v_smfmac_f32_16x16x64_bf16 v[196:199], v[200:203], v[88:95], v204
    ds_read_b128 v[156:159], v24 offset:27648
    v_exp_f32 v110, v110
    v_exp_f32 v111, v111
    v_mfma_f32_32x32x16_bf16 v[64:79], v[128:131], v[8:11], 0
    v_exp_f32 v112, v112
    v_exp_f32 v113, v113
    v_exp_f32 v114, v114
    v_mfma_f32_32x32x16_bf16 v[64:79], v[132:135], v[12:15], v[64:79]
    s_waitcnt lgkmcnt(1)
    v_exp_f32 v115, v115
    v_exp_f32 v116, v116
    v_exp_f32 v117, v117
    v_smfmac_f32_32x32x32_bf16 v[160:175], v[152:155], v[96:103], v204
    s_waitcnt lgkmcnt(0)
    v_exp_f32 v118, v118
    v_exp_f32 v119, v119
    v_exp_f32 v120, v120
    v_smfmac_f32_16x16x64_bf16 v[192:195], v[200:203], v[96:103], v204
    ds_read_b128 v[136:139], v24 offset:22528
    v_exp_f32 v121, v121
    v_exp_f32 v122, v122
    v_smfmac_f32_32x32x32_bf16 v[160:175], v[156:159], v[104:111], v204
    v_exp_f32 v123, v123
    v_exp_f32 v124, v124
    v_exp_f32 v125, v125
    v_smfmac_f32_16x16x64_bf16 v[192:195], v[200:203], v[104:111], v204
    ds_read_b128 v[140:143], v24 offset:23552
    v_exp_f32 v126, v126
    v_exp_f32 v127, v127
    v_mfma_f32_32x32x16_bf16 v[80:95], v[128:131], v[16:19], 0
    v_exp_f32 v64, v64
    v_exp_f32 v65, v65
    v_exp_f32 v66, v66
    v_mfma_f32_32x32x16_bf16 v[80:95], v[132:135], v[20:23], v[80:95]
    v_exp_f32 v67, v67
    v_exp_f32 v68, v68
    v_exp_f32 v69, v69
    v_smfmac_f32_32x32x32_bf16 v[176:191], v[152:155], v[112:119], v204
    s_waitcnt lgkmcnt(0)
    v_exp_f32 v70, v70
    v_exp_f32 v71, v71
    v_exp_f32 v72, v72
    v_smfmac_f32_16x16x64_bf16 v[196:199], v[200:203], v[112:119], v204
    ds_read_b128 v[144:147], v24 offset:28672
    v_exp_f32 v73, v73
    v_exp_f32 v74, v74
    v_smfmac_f32_32x32x32_bf16 v[176:191], v[156:159], v[120:127], v204
    v_exp_f32 v75, v75
    v_exp_f32 v76, v76
    v_exp_f32 v77, v77
    v_smfmac_f32_16x16x64_bf16 v[196:199], v[200:203], v[120:127], v204
    ds_read_b128 v[148:151], v24 offset:29696
    v_exp_f32 v78, v78
    v_exp_f32 v79, v79
    v_mfma_f32_32x32x16_bf16 v[96:111], v[136:139], v[8:11], 0
    s_barrier
    v_exp_f32 v80, v80
    v_exp_f32 v81, v81
    v_exp_f32 v82, v82
    v_mfma_f32_32x32x16_bf16 v[96:111], v[140:143], v[12:15], v[96:111]
    s_waitcnt lgkmcnt(1)
    v_exp_f32 v83, v83
    v_exp_f32 v84, v84
    v_exp_f32 v85, v85
    v_smfmac_f32_32x32x32_bf16 v[160:175], v[144:147], v[64:71], v204
    s_waitcnt lgkmcnt(0)
    v_exp_f32 v86, v86
    v_exp_f32 v87, v87
    v_exp_f32 v88, v88
    v_smfmac_f32_16x16x64_bf16 v[192:195], v[200:203], v[64:71], v204
    ds_read_b128 v[128:131], v24 offset:32768
    v_exp_f32 v89, v89
    v_exp_f32 v90, v90
    v_smfmac_f32_32x32x32_bf16 v[160:175], v[148:151], v[72:79], v204
    v_exp_f32 v91, v91
    v_exp_f32 v92, v92
    v_exp_f32 v93, v93
    v_smfmac_f32_16x16x64_bf16 v[192:195], v[200:203], v[72:79], v204
    ds_read_b128 v[132:135], v24 offset:33792
    v_exp_f32 v94, v94
    v_exp_f32 v95, v95
    v_mfma_f32_32x32x16_bf16 v[112:127], v[136:139], v[16:19], 0
    v_exp_f32 v96, v96
    v_exp_f32 v97, v97
    v_exp_f32 v98, v98
    v_mfma_f32_32x32x16_bf16 v[112:127], v[140:143], v[20:23], v[112:127]
    v_exp_f32 v99, v99
    v_exp_f32 v100, v100
    v_exp_f32 v101, v101
    v_smfmac_f32_32x32x32_bf16 v[176:191], v[144:147], v[80:87], v204
    s_waitcnt lgkmcnt(0)
    v_exp_f32 v102, v102
    v_exp_f32 v103, v103
    v_exp_f32 v104, v104
    v_smfmac_f32_16x16x64_bf16 v[196:199], v[200:203], v[80:87], v204
    ds_read_b128 v[152:155], v24 offset:30720
    v_exp_f32 v105, v105
    v_exp_f32 v106, v106
    v_smfmac_f32_32x32x32_bf16 v[176:191], v[148:151], v[88:95], v204
    v_exp_f32 v107, v107
    v_exp_f32 v108, v108
    v_exp_f32 v109, v109
    v_smfmac_f32_16x16x64_bf16 v[196:199], v[200:203], v[88:95], v204
    ds_read_b128 v[156:159], v24 offset:31744
    v_exp_f32 v110, v110
    v_exp_f32 v111, v111
    v_mfma_f32_32x32x16_bf16 v[64:79], v[128:131], v[8:11], 0
    v_exp_f32 v112, v112
    v_exp_f32 v113, v113
    v_exp_f32 v114, v114
    v_mfma_f32_32x32x16_bf16 v[64:79], v[132:135], v[12:15], v[64:79]
    s_waitcnt lgkmcnt(1)
    v_exp_f32 v115, v115
    v_exp_f32 v116, v116
    v_exp_f32 v117, v117
    v_smfmac_f32_32x32x32_bf16 v[160:175], v[152:155], v[96:103], v204
    s_waitcnt lgkmcnt(0)
    v_exp_f32 v118, v118
    v_exp_f32 v119, v119
    v_exp_f32 v120, v120
    v_smfmac_f32_16x16x64_bf16 v[192:195], v[200:203], v[96:103], v204
    ds_read_b128 v[136:139], v24 offset:34816
    v_exp_f32 v121, v121
    v_exp_f32 v122, v122
    v_smfmac_f32_32x32x32_bf16 v[160:175], v[156:159], v[104:111], v204
    v_exp_f32 v123, v123
    v_exp_f32 v124, v124
    v_exp_f32 v125, v125
    v_smfmac_f32_16x16x64_bf16 v[192:195], v[200:203], v[104:111], v204
    ds_read_b128 v[140:143], v24 offset:35840
    v_exp_f32 v126, v126
    v_exp_f32 v127, v127
    v_mfma_f32_32x32x16_bf16 v[80:95], v[128:131], v[16:19], 0
    v_exp_f32 v64, v64
    v_exp_f32 v65, v65
    v_exp_f32 v66, v66
    v_mfma_f32_32x32x16_bf16 v[80:95], v[132:135], v[20:23], v[80:95]
    v_exp_f32 v67, v67
    v_exp_f32 v68, v68
    v_exp_f32 v69, v69
    v_smfmac_f32_32x32x32_bf16 v[176:191], v[152:155], v[112:119], v204
    s_waitcnt lgkmcnt(0)
    v_exp_f32 v70, v70
    v_exp_f32 v71, v71
    v_exp_f32 v72, v72
    v_smfmac_f32_16x16x64_bf16 v[196:199], v[200:203], v[112:119], v204
    ds_read_b128 v[144:147], v24 offset:40960
    v_exp_f32 v73, v73
    v_exp_f32 v74, v74
    v_smfmac_f32_32x32x32_bf16 v[176:191], v[156:159], v[120:127], v204
    v_exp_f32 v75, v75
    v_exp_f32 v76, v76
    v_exp_f32 v77, v77
    v_smfmac_f32_16x16x64_bf16 v[196:199], v[200:203], v[120:127], v204
    ds_read_b128 v[148:151], v24 offset:41984
    v_exp_f32 v78, v78
    v_exp_f32 v79, v79
    v_mfma_f32_32x32x16_bf16 v[96:111], v[136:139], v[8:11], 0
    v_exp_f32 v80, v80
    v_exp_f32 v81, v81
    v_exp_f32 v82, v82
    v_mfma_f32_32x32x16_bf16 v[96:111], v[140:143], v[12:15], v[96:111]
    s_waitcnt lgkmcnt(1)
    v_exp_f32 v83, v83
    v_exp_f32 v84, v84
    v_exp_f32 v85, v85
    v_smfmac_f32_32x32x32_bf16 v[160:175], v[144:147], v[64:71], v204
    s_waitcnt lgkmcnt(0)
    v_exp_f32 v86, v86
    v_exp_f32 v87, v87
    v_exp_f32 v88, v88
    v_smfmac_f32_16x16x64_bf16 v[192:195], v[200:203], v[64:71], v204
    ds_read_b128 v[128:131], v24 offset:36864
    v_exp_f32 v89, v89
    v_exp_f32 v90, v90
    v_smfmac_f32_32x32x32_bf16 v[160:175], v[148:151], v[72:79], v204
    v_exp_f32 v91, v91
    v_exp_f32 v92, v92
    v_exp_f32 v93, v93
    v_smfmac_f32_16x16x64_bf16 v[192:195], v[200:203], v[72:79], v204
    ds_read_b128 v[132:135], v24 offset:37888
    v_exp_f32 v94, v94
    v_exp_f32 v95, v95
    v_mfma_f32_32x32x16_bf16 v[112:127], v[136:139], v[16:19], 0
    v_exp_f32 v96, v96
    v_exp_f32 v97, v97
    v_exp_f32 v98, v98
    v_mfma_f32_32x32x16_bf16 v[112:127], v[140:143], v[20:23], v[112:127]
    v_exp_f32 v99, v99
    v_exp_f32 v100, v100
    v_exp_f32 v101, v101
    v_smfmac_f32_32x32x32_bf16 v[176:191], v[144:147], v[80:87], v204
    s_waitcnt lgkmcnt(0)
    v_exp_f32 v102, v102
    v_exp_f32 v103, v103
    v_exp_f32 v104, v104
    v_smfmac_f32_16x16x64_bf16 v[196:199], v[200:203], v[80:87], v204
    ds_read_b128 v[152:155], v24 offset:43008
    v_exp_f32 v105, v105
    v_exp_f32 v106, v106
    v_smfmac_f32_32x32x32_bf16 v[176:191], v[148:151], v[88:95], v204
    v_exp_f32 v107, v107
    v_exp_f32 v108, v108
    v_exp_f32 v109, v109
    v_smfmac_f32_16x16x64_bf16 v[196:199], v[200:203], v[88:95], v204
    ds_read_b128 v[156:159], v24 offset:44032
    v_exp_f32 v110, v110
    v_exp_f32 v111, v111
    v_mfma_f32_32x32x16_bf16 v[64:79], v[128:131], v[8:11], 0
    v_exp_f32 v112, v112
    v_exp_f32 v113, v113
    v_exp_f32 v114, v114
    v_mfma_f32_32x32x16_bf16 v[64:79], v[132:135], v[12:15], v[64:79]
    s_waitcnt lgkmcnt(1)
    v_exp_f32 v115, v115
    v_exp_f32 v116, v116
    v_exp_f32 v117, v117
    v_smfmac_f32_32x32x32_bf16 v[160:175], v[152:155], v[96:103], v204
    s_waitcnt lgkmcnt(0)
    v_exp_f32 v118, v118
    v_exp_f32 v119, v119
    v_exp_f32 v120, v120
    v_smfmac_f32_16x16x64_bf16 v[192:195], v[200:203], v[96:103], v204
    ds_read_b128 v[136:139], v24 offset:38912
    v_exp_f32 v121, v121
    v_exp_f32 v122, v122
    v_smfmac_f32_32x32x32_bf16 v[160:175], v[156:159], v[104:111], v204
    v_exp_f32 v123, v123
    v_exp_f32 v124, v124
    v_exp_f32 v125, v125
    v_smfmac_f32_16x16x64_bf16 v[192:195], v[200:203], v[104:111], v204
    ds_read_b128 v[140:143], v24 offset:39936
    v_exp_f32 v126, v126
    v_exp_f32 v127, v127
    v_mfma_f32_32x32x16_bf16 v[80:95], v[128:131], v[16:19], 0
    v_exp_f32 v64, v64
    v_exp_f32 v65, v65
    v_exp_f32 v66, v66
    v_mfma_f32_32x32x16_bf16 v[80:95], v[132:135], v[20:23], v[80:95]
    v_exp_f32 v67, v67
    v_exp_f32 v68, v68
    v_exp_f32 v69, v69
    v_smfmac_f32_32x32x32_bf16 v[176:191], v[152:155], v[112:119], v204
    s_waitcnt lgkmcnt(0)
    v_exp_f32 v70, v70
    v_exp_f32 v71, v71
    v_exp_f32 v72, v72
    v_smfmac_f32_16x16x64_bf16 v[196:199], v[200:203], v[112:119], v204
    ds_read_b128 v[144:147], v24 offset:45056
    v_exp_f32 v73, v73
    v_exp_f32 v74, v74
    v_smfmac_f32_32x32x32_bf16 v[176:191], v[156:159], v[120:127], v204
    v_exp_f32 v75, v75
    v_exp_f32 v76, v76
    v_exp_f32 v77, v77
    v_smfmac_f32_16x16x64_bf16 v[196:199], v[200:203], v[120:127], v204
    ds_read_b128 v[148:151], v24 offset:46080
    v_exp_f32 v78, v78
    v_exp_f32 v79, v79
    v_mfma_f32_32x32x16_bf16 v[96:111], v[136:139], v[8:11], 0
    s_barrier
    v_exp_f32 v80, v80
    v_exp_f32 v81, v81
    v_exp_f32 v82, v82
    v_mfma_f32_32x32x16_bf16 v[96:111], v[140:143], v[12:15], v[96:111]
    s_waitcnt lgkmcnt(1)
    v_exp_f32 v83, v83
    v_exp_f32 v84, v84
    v_exp_f32 v85, v85
    v_smfmac_f32_32x32x32_bf16 v[160:175], v[144:147], v[64:71], v204
    s_waitcnt lgkmcnt(0)
    v_exp_f32 v86, v86
    v_exp_f32 v87, v87
    v_exp_f32 v88, v88
    v_smfmac_f32_16x16x64_bf16 v[192:195], v[200:203], v[64:71], v204
    ds_read_b128 v[128:131], v24 offset:49152
    v_exp_f32 v89, v89
    v_exp_f32 v90, v90
    v_smfmac_f32_32x32x32_bf16 v[160:175], v[148:151], v[72:79], v204
    v_exp_f32 v91, v91
    v_exp_f32 v92, v92
    v_exp_f32 v93, v93
    v_smfmac_f32_16x16x64_bf16 v[192:195], v[200:203], v[72:79], v204
    ds_read_b128 v[132:135], v24 offset:50176
    v_exp_f32 v94, v94
    v_exp_f32 v95, v95
    v_mfma_f32_32x32x16_bf16 v[112:127], v[136:139], v[16:19], 0
    v_exp_f32 v96, v96
    v_exp_f32 v97, v97
    v_exp_f32 v98, v98
    v_mfma_f32_32x32x16_bf16 v[112:127], v[140:143], v[20:23], v[112:127]
    v_exp_f32 v99, v99
    v_exp_f32 v100, v100
    v_exp_f32 v101, v101
    v_smfmac_f32_32x32x32_bf16 v[176:191], v[144:147], v[80:87], v204
    s_waitcnt lgkmcnt(0)
    v_exp_f32 v102, v102
    v_exp_f32 v103, v103
    v_exp_f32 v104, v104
    v_smfmac_f32_16x16x64_bf16 v[196:199], v[200:203], v[80:87], v204
    ds_read_b128 v[152:155], v24 offset:47104
    v_exp_f32 v105, v105
    v_exp_f32 v106, v106
    v_smfmac_f32_32x32x32_bf16 v[176:191], v[148:151], v[88:95], v204
    v_exp_f32 v107, v107
    v_exp_f32 v108, v108
    v_exp_f32 v109, v109
    v_smfmac_f32_16x16x64_bf16 v[196:199], v[200:203], v[88:95], v204
    ds_read_b128 v[156:159], v24 offset:48128
    v_exp_f32 v110, v110
    v_exp_f32 v111, v111
    v_mfma_f32_32x32x16_bf16 v[64:79], v[128:131], v[8:11], 0
    v_exp_f32 v112, v112
    v_exp_f32 v113, v113
    v_exp_f32 v114, v114
    v_mfma_f32_32x32x16_bf16 v[64:79], v[132:135], v[12:15], v[64:79]
    s_waitcnt lgkmcnt(1)
    v_exp_f32 v115, v115
    v_exp_f32 v116, v116
    v_exp_f32 v117, v117
    v_smfmac_f32_32x32x32_bf16 v[160:175], v[152:155], v[96:103], v204
    s_waitcnt lgkmcnt(0)
    v_exp_f32 v118, v118
    v_exp_f32 v119, v119
    v_exp_f32 v120, v120
    v_smfmac_f32_16x16x64_bf16 v[192:195], v[200:203], v[96:103], v204
    ds_read_b128 v[136:139], v24 offset:51200
    v_exp_f32 v121, v121
    v_exp_f32 v122, v122
    v_smfmac_f32_32x32x32_bf16 v[160:175], v[156:159], v[104:111], v204
    v_exp_f32 v123, v123
    v_exp_f32 v124, v124
    v_exp_f32 v125, v125
    v_smfmac_f32_16x16x64_bf16 v[192:195], v[200:203], v[104:111], v204
    ds_read_b128 v[140:143], v24 offset:52224
    v_exp_f32 v126, v126
    v_exp_f32 v127, v127
    v_mfma_f32_32x32x16_bf16 v[80:95], v[128:131], v[16:19], 0
    v_exp_f32 v64, v64
    v_exp_f32 v65, v65
    v_exp_f32 v66, v66
    v_mfma_f32_32x32x16_bf16 v[80:95], v[132:135], v[20:23], v[80:95]
    v_exp_f32 v67, v67
    v_exp_f32 v68, v68
    v_exp_f32 v69, v69
    v_smfmac_f32_32x32x32_bf16 v[176:191], v[152:155], v[112:119], v204
    s_waitcnt lgkmcnt(0)
    v_exp_f32 v70, v70
    v_exp_f32 v71, v71
    v_exp_f32 v72, v72
    v_smfmac_f32_16x16x64_bf16 v[196:199], v[200:203], v[112:119], v204
    ds_read_b128 v[144:147], v24 offset:57344
    v_exp_f32 v73, v73
    v_exp_f32 v74, v74
    v_smfmac_f32_32x32x32_bf16 v[176:191], v[156:159], v[120:127], v204
    v_exp_f32 v75, v75
    v_exp_f32 v76, v76
    v_exp_f32 v77, v77
    v_smfmac_f32_16x16x64_bf16 v[196:199], v[200:203], v[120:127], v204
    ds_read_b128 v[148:151], v24 offset:58368
    v_exp_f32 v78, v78
    v_exp_f32 v79, v79
    v_mfma_f32_32x32x16_bf16 v[96:111], v[136:139], v[8:11], 0
    v_exp_f32 v80, v80
    v_exp_f32 v81, v81
    v_exp_f32 v82, v82
    v_mfma_f32_32x32x16_bf16 v[96:111], v[140:143], v[12:15], v[96:111]
    s_waitcnt lgkmcnt(1)
    v_exp_f32 v83, v83
    v_exp_f32 v84, v84
    v_exp_f32 v85, v85
    v_smfmac_f32_32x32x32_bf16 v[160:175], v[144:147], v[64:71], v204
    s_waitcnt lgkmcnt(0)
    v_exp_f32 v86, v86
    v_exp_f32 v87, v87
    v_exp_f32 v88, v88
    v_smfmac_f32_16x16x64_bf16 v[192:195], v[200:203], v[64:71], v204
    ds_read_b128 v[128:131], v24 offset:53248
    v_exp_f32 v89, v89
    v_exp_f32 v90, v90
    v_smfmac_f32_32x32x32_bf16 v[160:175], v[148:151], v[72:79], v204
    v_exp_f32 v91, v91
    v_exp_f32 v92, v92
    v_exp_f32 v93, v93
    v_smfmac_f32_16x16x64_bf16 v[192:195], v[200:203], v[72:79], v204
    ds_read_b128 v[132:135], v24 offset:54272
    v_exp_f32 v94, v94
    v_exp_f32 v95, v95
    v_mfma_f32_32x32x16_bf16 v[112:127], v[136:139], v[16:19], 0
    v_exp_f32 v96, v96
    v_exp_f32 v97, v97
    v_exp_f32 v98, v98
    v_mfma_f32_32x32x16_bf16 v[112:127], v[140:143], v[20:23], v[112:127]
    v_exp_f32 v99, v99
    v_exp_f32 v100, v100
    v_exp_f32 v101, v101
    v_smfmac_f32_32x32x32_bf16 v[176:191], v[144:147], v[80:87], v204
    s_waitcnt lgkmcnt(0)
    v_exp_f32 v102, v102
    v_exp_f32 v103, v103
    v_exp_f32 v104, v104
    v_smfmac_f32_16x16x64_bf16 v[196:199], v[200:203], v[80:87], v204
    ds_read_b128 v[152:155], v24 offset:59392
    v_exp_f32 v105, v105
    v_exp_f32 v106, v106
    v_smfmac_f32_32x32x32_bf16 v[176:191], v[148:151], v[88:95], v204
    v_exp_f32 v107, v107
    v_exp_f32 v108, v108
    v_exp_f32 v109, v109
    v_smfmac_f32_16x16x64_bf16 v[196:199], v[200:203], v[88:95], v204
    ds_read_b128 v[156:159], v24 offset:60416
    v_exp_f32 v110, v110
    v_exp_f32 v111, v111
    v_mfma_f32_32x32x16_bf16 v[64:79], v[128:131], v[8:11], 0
    v_exp_f32 v112, v112
    v_exp_f32 v113, v113
    v_exp_f32 v114, v114
    v_mfma_f32_32x32x16_bf16 v[64:79], v[132:135], v[12:15], v[64:79]
    s_waitcnt lgkmcnt(1)
    v_exp_f32 v115, v115
    v_exp_f32 v116, v116
    v_exp_f32 v117, v117
    v_smfmac_f32_32x32x32_bf16 v[160:175], v[152:155], v[96:103], v204
    s_waitcnt lgkmcnt(0)
    v_exp_f32 v118, v118
    v_exp_f32 v119, v119
    v_exp_f32 v120, v120
    v_smfmac_f32_16x16x64_bf16 v[192:195], v[200:203], v[96:103], v204
    ds_read_b128 v[136:139], v24 offset:55296
    v_exp_f32 v121, v121
    v_exp_f32 v122, v122
    v_smfmac_f32_32x32x32_bf16 v[160:175], v[156:159], v[104:111], v204
    v_exp_f32 v123, v123
    v_exp_f32 v124, v124
    v_exp_f32 v125, v125
    v_smfmac_f32_16x16x64_bf16 v[192:195], v[200:203], v[104:111], v204
    ds_read_b128 v[140:143], v24 offset:56320
    v_exp_f32 v126, v126
    v_exp_f32 v127, v127
    v_mfma_f32_32x32x16_bf16 v[80:95], v[128:131], v[16:19], 0
    v_exp_f32 v64, v64
    v_exp_f32 v65, v65
    v_exp_f32 v66, v66
    v_mfma_f32_32x32x16_bf16 v[80:95], v[132:135], v[20:23], v[80:95]
    v_exp_f32 v67, v67
    v_exp_f32 v68, v68
    v_exp_f32 v69, v69
    v_smfmac_f32_32x32x32_bf16 v[176:191], v[152:155], v[112:119], v204
    s_waitcnt lgkmcnt(0)
    v_exp_f32 v70, v70
    v_exp_f32 v71, v71
    v_exp_f32 v72, v72
    v_smfmac_f32_16x16x64_bf16 v[196:199], v[200:203], v[112:119], v204
    ds_read_b128 v[144:147], v24 offset:61440
    v_exp_f32 v73, v73
    v_exp_f32 v74, v74
    v_smfmac_f32_32x32x32_bf16 v[176:191], v[156:159], v[120:127], v204
    v_exp_f32 v75, v75
    v_exp_f32 v76, v76
    v_exp_f32 v77, v77
    v_smfmac_f32_16x16x64_bf16 v[196:199], v[200:203], v[120:127], v204
    ds_read_b128 v[148:151], v24 offset:62464
    v_exp_f32 v78, v78
    v_exp_f32 v79, v79
    v_mfma_f32_32x32x16_bf16 v[96:111], v[136:139], v[8:11], 0
    s_barrier
    v_exp_f32 v80, v80
    v_exp_f32 v81, v81
    v_exp_f32 v82, v82
    v_mfma_f32_32x32x16_bf16 v[96:111], v[140:143], v[12:15], v[96:111]
    s_waitcnt lgkmcnt(1)
    v_exp_f32 v83, v83
    v_exp_f32 v84, v84
    v_exp_f32 v85, v85
    v_smfmac_f32_32x32x32_bf16 v[160:175], v[144:147], v[64:71], v204
    s_waitcnt lgkmcnt(0)
    v_exp_f32 v86, v86
    v_exp_f32 v87, v87
    v_exp_f32 v88, v88
    v_smfmac_f32_16x16x64_bf16 v[192:195], v[200:203], v[64:71], v204
    ds_read_b128 v[128:131], v24 offset:0
    v_exp_f32 v89, v89
    v_exp_f32 v90, v90
    v_smfmac_f32_32x32x32_bf16 v[160:175], v[148:151], v[72:79], v204
    v_exp_f32 v91, v91
    v_exp_f32 v92, v92
    v_exp_f32 v93, v93
    v_smfmac_f32_16x16x64_bf16 v[192:195], v[200:203], v[72:79], v204
    ds_read_b128 v[132:135], v24 offset:1024
    v_exp_f32 v94, v94
    v_exp_f32 v95, v95
    v_mfma_f32_32x32x16_bf16 v[112:127], v[136:139], v[16:19], 0
    v_exp_f32 v96, v96
    v_exp_f32 v97, v97
    v_exp_f32 v98, v98
    v_mfma_f32_32x32x16_bf16 v[112:127], v[140:143], v[20:23], v[112:127]
    v_exp_f32 v99, v99
    v_exp_f32 v100, v100
    v_exp_f32 v101, v101
    v_smfmac_f32_32x32x32_bf16 v[176:191], v[144:147], v[80:87], v204
    s_waitcnt lgkmcnt(0)
    v_exp_f32 v102, v102
    v_exp_f32 v103, v103
    v_exp_f32 v104, v104
    v_smfmac_f32_16x16x64_bf16 v[196:199], v[200:203], v[80:87], v204
    ds_read_b128 v[152:155], v24 offset:63488
    v_exp_f32 v105, v105
    v_exp_f32 v106, v106
    v_smfmac_f32_32x32x32_bf16 v[176:191], v[148:151], v[88:95], v204
    v_exp_f32 v107, v107
    v_exp_f32 v108, v108
    v_exp_f32 v109, v109
    v_smfmac_f32_16x16x64_bf16 v[196:199], v[200:203], v[88:95], v204
    ds_read_b128 v[156:159], v24 offset:64512
    v_exp_f32 v110, v110
    v_exp_f32 v111, v111
    v_mfma_f32_32x32x16_bf16 v[64:79], v[128:131], v[8:11], 0
    s_sub_u32 s54, s54, 1
    v_exp_f32 v112, v112
    v_exp_f32 v113, v113
    v_exp_f32 v114, v114
    v_mfma_f32_32x32x16_bf16 v[64:79], v[132:135], v[12:15], v[64:79]
    s_waitcnt lgkmcnt(1)
    v_exp_f32 v115, v115
    v_exp_f32 v116, v116
    v_exp_f32 v117, v117
    v_smfmac_f32_32x32x32_bf16 v[160:175], v[152:155], v[96:103], v204
    s_waitcnt lgkmcnt(0)
    v_exp_f32 v118, v118
    v_exp_f32 v119, v119
    v_exp_f32 v120, v120
    v_smfmac_f32_16x16x64_bf16 v[192:195], v[200:203], v[96:103], v204
    ds_read_b128 v[136:139], v24 offset:2048
    v_exp_f32 v121, v121
    v_exp_f32 v122, v122
    v_smfmac_f32_32x32x32_bf16 v[160:175], v[156:159], v[104:111], v204
    s_cmp_lg_u32 s54, 0
    v_exp_f32 v123, v123
    v_exp_f32 v124, v124
    v_exp_f32 v125, v125
    v_smfmac_f32_16x16x64_bf16 v[192:195], v[200:203], v[104:111], v204
    ds_read_b128 v[140:143], v24 offset:3072
    v_exp_f32 v126, v126
    v_exp_f32 v127, v127
    s_cbranch_scc1 c_attn_loop
    v_smfmac_f32_16x16x64_bf16 v[196:199], v[200:203], v[112:119], v204
    v_smfmac_f32_16x16x64_bf16 v[196:199], v[200:203], v[120:127], v204
    v_smfmac_f32_32x32x32_bf16 v[176:191], v[152:155], v[112:119], v204
    v_smfmac_f32_32x32x32_bf16 v[176:191], v[156:159], v[120:127], v204
    v_mov_b32 v25, 0x5f000000
    v_mov_b32 v26, 0x2b800000
    v_cmp_lt_f32 s[56:57], v192, v25
    v_cmp_gt_f32 vcc, v192, v26
    s_and_b64 s[56:57], s[56:57], vcc
    s_nop 0
    v_cmp_lt_f32 vcc, v196, v25
    s_and_b64 s[56:57], s[56:57], vcc
    v_cmp_gt_f32 vcc, v196, v26
    s_and_b64 s[56:57], s[56:57], vcc
    s_cmp_lg_u64 s[56:57], -1
    s_cbranch_scc1 c_attn_slow
c_attn_fin:
    s_lshl_b32 s3, s48, 17
    s_lshl_b32 s55, s7, 12
    s_add_u32 s3, s3, s55
    s_and_b32 s55, s6, 1
    s_lshl_b32 s55, s55, 11
    s_add_u32 s3, s3, s55
    s_lshl_b32 s55, s9, 22
    s_add_u32 s3, s3, s55
    s_add_u32 s3, s3, 16777216
    v_rcp_f32 v192, v192
    s_nop 0
    v_pk_mul_f32 v[160:161], v[192:193], v[160:161] op_sel_hi:[0,1]
    v_pk_mul_f32 v[162:163], v[192:193], v[162:163] op_sel_hi:[0,1]
    v_pk_mul_f32 v[164:165], v[192:193], v[164:165] op_sel_hi:[0,1]
    v_pk_mul_f32 v[166:167], v[192:193], v[166:167] op_sel_hi:[0,1]
    v_pk_mul_f32 v[168:169], v[192:193], v[168:169] op_sel_hi:[0,1]
    v_pk_mul_f32 v[170:171], v[192:193], v[170:171] op_sel_hi:[0,1]
    v_pk_mul_f32 v[172:173], v[192:193], v[172:173] op_sel_hi:[0,1]
    v_pk_mul_f32 v[174:175], v[192:193], v[174:175] op_sel_hi:[0,1]
    v_cvt_pk_bf16_f32 v160, v160, v161
    v_cvt_pk_bf16_f32 v161, v162, v163
    v_cvt_pk_bf16_f32 v162, v164, v165
    v_cvt_pk_bf16_f32 v163, v166, v167
    v_cvt_pk_bf16_f32 v164, v168, v169
    v_cvt_pk_bf16_f32 v165, v170, v171
    v_cvt_pk_bf16_f32 v166, v172, v173
    v_cvt_pk_bf16_f32 v167, v174, v175
    buffer_store_dwordx4 v[160:163], v5, s[12:15], s3 offen offset:0 sc1
    buffer_store_dwordx4 v[164:167], v5, s[12:15], s3 offen offset:1024 sc1
    s_add_u32 s3, s3, 65536
    v_rcp_f32 v196, v196
    s_nop 0
    v_pk_mul_f32 v[176:177], v[196:197], v[176:177] op_sel_hi:[0,1]
    v_pk_mul_f32 v[178:179], v[196:197], v[178:179] op_sel_hi:[0,1]
    v_pk_mul_f32 v[180:181], v[196:197], v[180:181] op_sel_hi:[0,1]
    v_pk_mul_f32 v[182:183], v[196:197], v[182:183] op_sel_hi:[0,1]
    v_pk_mul_f32 v[184:185], v[196:197], v[184:185] op_sel_hi:[0,1]
    v_pk_mul_f32 v[186:187], v[196:197], v[186:187] op_sel_hi:[0,1]
    v_pk_mul_f32 v[188:189], v[196:197], v[188:189] op_sel_hi:[0,1]
    v_pk_mul_f32 v[190:191], v[196:197], v[190:191] op_sel_hi:[0,1]
    v_cvt_pk_bf16_f32 v176, v176, v177
    v_cvt_pk_bf16_f32 v177, v178, v179
    v_cvt_pk_bf16_f32 v178, v180, v181
    v_cvt_pk_bf16_f32 v179, v182, v183
    v_cvt_pk_bf16_f32 v180, v184, v185
    v_cvt_pk_bf16_f32 v181, v186, v187
    v_cvt_pk_bf16_f32 v182, v188, v189
    v_cvt_pk_bf16_f32 v183, v190, v191
    buffer_store_dwordx4 v[176:179], v5, s[12:15], s3 offen offset:0 sc1
    buffer_store_dwordx4 v[180:183], v5, s[12:15], s3 offen offset:1024 sc1
    s_add_u32 s3, s3, 65536
    s_branch c_wo
.p2align 6
h_first:
    s_memrealtime s[50:51]
    s_cmp_lg_u32 s2, 0
    s_cbranch_scc1 h_first_nonon
    s_mov_b32 s16, s46
    s_mov_b32 s17, s47
    s_mov_b32 s18, 256
    s_mov_b32 s19, 0x00020000
    v_lshlrev_b32 v14, 6, v1
    s_waitcnt lgkmcnt(0)
    s_or_b32 s50, s50, 1
    v_mov_b32 v13, s50
    buffer_store_dword v13, v14, s[16:19], 0 offen sc1
h_first_nonon:
    v_mov_b32 v8, 0
    v_mov_b32 v9, 0
    v_mov_b32 v10, 159488
    ds_write_b64 v10, v[8:9]
    ds_write_b64 v10, v[8:9] offset:8
    ds_write_b64 v10, v[8:9] offset:16
    ds_write_b64 v10, v[8:9] offset:24
    s_waitcnt lgkmcnt(0)
    s_barrier
    s_barrier
    s_sub_u32 s50, s50, 8000
    s_load_dword s10, s[46:47], 0
    s_waitcnt lgkmcnt(0)
    s_sub_u32 s51, s10, s50
    s_and_b32 s3, s10, 1
    s_cselect_b32 s51, s51, -1
    s_cmp_ge_i32 s51, 0
    s_cbranch_scc1 h_first_non_ok
    s_load_dword s10, s[46:47], 128
    s_waitcnt lgkmcnt(0)
    s_sub_u32 s51, s10, s50
    s_and_b32 s3, s10, 1
    s_cselect_b32 s51, s51, -1
    s_cmp_ge_i32 s51, 0
    s_cbranch_scc1 h_first_non_ok
    s_load_dword s10, s[46:47], 64
    s_waitcnt lgkmcnt(0)
    s_sub_u32 s51, s10, s50
    s_and_b32 s3, s10, 1
    s_cselect_b32 s51, s51, -1
    s_cmp_ge_i32 s51, 0
    s_cbranch_scc1 h_first_non_ok
    s_load_dword s10, s[46:47], 192
    s_waitcnt lgkmcnt(0)
    s_sub_u32 s51, s10, s50
    s_and_b32 s3, s10, 1
    s_cselect_b32 s51, s51, -1
    s_cmp_ge_i32 s51, 0
    s_cbranch_scc1 h_first_non_ok
    s_mov_b32 s58, 0
    s_and_b32 s57, s2, 0xc0
h_first_non:
    s_load_dword s10, s[46:47], s57 glc
    s_waitcnt lgkmcnt(0)
    s_sub_u32 s51, s10, s50
    s_and_b32 s3, s10, 1
    s_cselect_b32 s51, s51, -1
    s_cmp_ge_i32 s51, 0
    s_cbranch_scc1 h_first_non_ok
    s_add_u32 s58, s58, 1
    s_cmp_gt_u32 s58, 100
    s_cselect_b32 s50, s10, s50
    s_cmp_lt_u32 s58, 0x100000
    s_cbranch_scc1 h_first_non
    s_mov_b32 s10, 1
h_first_non_ok:
    v_mov_b32 v12, s10
    ds_write_b32 v10, v12 offset:4
    v_lshlrev_b32 v13, 7, v1
    s_lshl_b32 s50, s2, 13
    s_mov_b32 s28, s36
    s_mov_b32 s29, s37
    s_mov_b32 s30, 2097152
    s_mov_b32 s31, 0x00020000
    buffer_load_dword v14, v13, s[28:31], s50 offen
    s_mov_b32 s9, 0
h_qkvA:
    s_mul_i32 s98, s9, 786432
    s_add_u32 s98, s98, 65273856
    s_lshl_b32 s99, s11, 10
    s_add_u32 s98, s98, s99
    s_add_u32 s96, s4, s98
    s_addc_u32 s97, s5, 0
    s_mov_b32 s98, s10
    s_mov_b32 s99, s10
    v_and_b32 v1, 63, v0
    v_lshlrev_b32 v5, 4, v1
    v_and_b32 v20, 15, v1
    v_lshrrev_b32 v11, 4, v1
    v_min_u32 v11, 2, v11
    v_lshlrev_b32 v21, 3, v20
    v_lshl_add_u32 v12, v11, 7, v21
    v_add_u32 v12, 155648, v12
    v_lshl_add_u32 v11, v11, 16, v21
    v_mov_b32 v10, 159496
    s_add_u32 s3, s9, 1
    v_mov_b32 v13, s3
    s_and_b32 s3, s6, 14
    s_lshl_b32 s3, s3, 2
    s_sub_u32 s3, s3, 1
    s_max_i32 s3, s3, 0
    s_lshl_b32 s3, s3, 16
    s_lshl_b32 s48, s9, 22
    s_add_u32 s3, s3, s48
    s_add_u32 s20, s4, s3
    s_addc_u32 s21, s5, 0
    s_mov_b32 s22, 65536
    s_mov_b32 s23, 0x00020000
    s_cmp_lt_u32 s6, 2
    s_cselect_b32 s22, 0, s22
    s_cselect_b32 s3, 0, 512
    s_add_u32 s96, s96, s3
    s_addc_u32 s97, s97, 0
    v_bfe_u32 v21, v1, 4, 1
    v_lshl_add_u32 v6, v21, 5, v20
    v_lshlrev_b32 v6, 4, v6
    v_lshrrev_b32 v21, 5, v1
    v_lshl_add_u32 v6, v21, 10, v6
    v_add_u32 v6, 256, v6
    v_add_u32 v16, 49152, v5
    s_cmp_eq_u32 s9, 0
    s_cbranch_scc1 h_qkvA_noend
    s_barrier
    s_cmp_lt_u32 s9, 2
    s_cbranch_scc1 c4_10
    ds_write_b128 v16, v[64:67] offset:0
    ds_write_b128 v16, v[68:71] offset:1024
    ds_write_b128 v16, v[72:75] offset:2048
    ds_write_b128 v16, v[76:79] offset:3072
    ds_write_b128 v16, v[80:83] offset:4096
    ds_write_b128 v16, v[84:87] offset:5120
    ds_write_b128 v16, v[88:91] offset:6144
    ds_write_b128 v16, v[92:95] offset:7168
    ds_write_b128 v16, v[96:99] offset:8192
    ds_write_b128 v16, v[100:103] offset:9216
    ds_write_b128 v16, v[104:107] offset:10240
    ds_write_b128 v16, v[108:111] offset:11264
    ds_write_b128 v16, v[112:115] offset:12288
    ds_write_b128 v16, v[116:119] offset:13312
    ds_write_b128 v16, v[120:123] offset:14336
    ds_write_b128 v16, v[124:127] offset:15360
    ds_write_b128 v16, v[128:131] offset:16384
    ds_write_b128 v16, v[132:135] offset:17408
    ds_write_b128 v16, v[136:139] offset:18432
    ds_write_b128 v16, v[140:143] offset:19456
    ds_write_b128 v16, v[144:147] offset:20480
    ds_write_b128 v16, v[148:151] offset:21504
    ds_write_b128 v16, v[152:155] offset:22528
    ds_write_b128 v16, v[156:159] offset:23552
    s_waitcnt lgkmcnt(0)
c4_10:
    s_barrier
h_qkvA_noend:
    s_mov_b32 s3, 0x100000
poll_11:
    s_load_dwordx8 s[80:87], s[96:97], 0 glc
    s_load_dwordx8 s[88:95], s[96:97], 128 glc
    s_sub_u32 s3, s3, 1
    s_cbranch_scc1 poll_11_ok
    s_waitcnt lgkmcnt(0)
    s_xor_b64 s[100:101], s[80:81], s[98:99]
    s_xor_b64 s[80:81], s[82:83], s[98:99]
    s_or_b64 s[100:101], s[100:101], s[80:81]
    s_xor_b64 s[80:81], s[84:85], s[98:99]
    s_or_b64 s[100:101], s[100:101], s[80:81]
    s_xor_b64 s[80:81], s[86:87], s[98:99]
    s_or_b64 s[100:101], s[100:101], s[80:81]
    s_xor_b64 s[80:81], s[88:89], s[98:99]
    s_or_b64 s[100:101], s[100:101], s[80:81]
    s_xor_b64 s[80:81], s[90:91], s[98:99]
    s_or_b64 s[100:101], s[100:101], s[80:81]
    s_xor_b64 s[80:81], s[92:93], s[98:99]
    s_or_b64 s[100:101], s[100:101], s[80:81]
    s_xor_b64 s[80:81], s[94:95], s[98:99]
    s_or_b64 s[100:101], s[100:101], s[80:81]
    s_cbranch_scc1 poll_11
poll_11_ok:
    s_waitcnt lgkmcnt(0)
    ds_write_b32 v10, v13
    s_mov_b32 m0, 147456
    s_mov_b32 s48, 0
    buffer_load_dwordx4 v6, s[20:23], s48 offen sc1 lds
    s_mov_b32 m0, 148480
    s_mov_b32 s48, 2048
    buffer_load_dwordx4 v6, s[20:23], s48 offen sc1 lds
    s_mov_b32 m0, 149504
    s_mov_b32 s48, 4096
    buffer_load_dwordx4 v6, s[20:23], s48 offen sc1 lds
    s_mov_b32 m0, 150528
    s_mov_b32 s48, 6144
    buffer_load_dwordx4 v6, s[20:23], s48 offen sc1 lds
    s_mov_b32 m0, 151552
    s_mov_b32 s48, 8192
    buffer_load_dwordx4 v6, s[20:23], s48 offen sc1 lds
    s_mov_b32 m0, 152576
    s_mov_b32 s48, 10240
    buffer_load_dwordx4 v6, s[20:23], s48 offen sc1 lds
    s_mov_b32 m0, 153600
    s_mov_b32 s48, 12288
    buffer_load_dwordx4 v6, s[20:23], s48 offen sc1 lds
    s_mov_b32 m0, 154624
    s_mov_b32 s48, 14336
    buffer_load_dwordx4 v6, s[20:23], s48 offen sc1 lds
    s_lshl_b32 s56, s7, 12
    s_and_b32 s57, s6, 1
    s_lshl_b32 s57, s57, 7
    s_add_u32 s56, s56, s57
    s_add_u32 s56, s56, 63963136
    v_lshlrev_b32 v15, 7, v1
    s_lshr_b32 s59, s2, 3
    s_mul_i32 s59, s59, 3
    s_lshr_b32 s59, s59, 5
    s_lshl_b32 s3, s9, 4
    s_add_u32 s59, s59, s3
    s_waitcnt vmcnt(4)
    s_barrier
    s_waitcnt vmcnt(0)
    s_barrier
    s_mov_b32 m0, 147456
    s_mov_b32 s48, 16384
    buffer_load_dwordx4 v6, s[20:23], s48 offen sc1 lds
    s_mov_b32 m0, 148480
    s_mov_b32 s48, 18432
    buffer_load_dwordx4 v6, s[20:23], s48 offen sc1 lds
    s_mov_b32 m0, 149504
    s_mov_b32 s48, 20480
    buffer_load_dwordx4 v6, s[20:23], s48 offen sc1 lds
    s_mov_b32 m0, 150528
    s_mov_b32 s48, 22528
    buffer_load_dwordx4 v6, s[20:23], s48 offen sc1 lds
    s_waitcnt vmcnt(0)
    s_waitcnt vmcnt(0)
    s_barrier
    s_mov_b32 m0, 151552
    s_mov_b32 s48, 24576
    buffer_load_dwordx4 v6, s[20:23], s48 offen sc1 lds
    s_mov_b32 m0, 152576
    s_mov_b32 s48, 26624
    buffer_load_dwordx4 v6, s[20:23], s48 offen sc1 lds
    s_mov_b32 m0, 153600
    s_mov_b32 s48, 28672
    buffer_load_dwordx4 v6, s[20:23], s48 offen sc1 lds
    s_mov_b32 m0, 154624
    s_mov_b32 s48, 30720
    buffer_load_dwordx4 v6, s[20:23], s48 offen sc1 lds
    s_cmp_ge_u32 s9, 2
    s_cbranch_scc1 cs_13
    buffer_load_dwordx2 v[32:33], v11, s[12:15], s56 offen offset:0 sc1
    buffer_load_dwordx2 v[34:35], v11, s[12:15], s56 offen offset:256 sc1
    buffer_load_dwordx2 v[36:37], v11, s[12:15], s56 offen offset:512 sc1
    buffer_load_dwordx2 v[38:39], v11, s[12:15], s56 offen offset:768 sc1
    buffer_load_dwordx2 v[40:41], v11, s[12:15], s56 offen offset:1024 sc1
    buffer_load_dwordx2 v[42:43], v11, s[12:15], s56 offen offset:1280 sc1
    buffer_load_dwordx2 v[44:45], v11, s[12:15], s56 offen offset:1536 sc1
    buffer_load_dwordx2 v[46:47], v11, s[12:15], s56 offen offset:1792 sc1
    buffer_load_dwordx2 v[48:49], v11, s[12:15], s56 offen offset:2048 sc1
    buffer_load_dwordx2 v[50:51], v11, s[12:15], s56 offen offset:2304 sc1
    buffer_load_dwordx2 v[52:53], v11, s[12:15], s56 offen offset:2560 sc1
    buffer_load_dwordx2 v[54:55], v11, s[12:15], s56 offen offset:2816 sc1
cs_13:
    s_waitcnt vmcnt(0)
    s_waitcnt vmcnt(12)
    s_barrier
    s_mov_b32 m0, 147456
    s_mov_b32 s48, 32768
    buffer_load_dwordx4 v6, s[20:23], s48 offen sc1 lds
    s_mov_b32 m0, 148480
    s_mov_b32 s48, 34816
    buffer_load_dwordx4 v6, s[20:23], s48 offen sc1 lds
    s_mov_b32 m0, 149504
    s_mov_b32 s48, 36864
    buffer_load_dwordx4 v6, s[20:23], s48 offen sc1 lds
    s_mov_b32 m0, 150528
    s_mov_b32 s48, 38912
    buffer_load_dwordx4 v6, s[20:23], s48 offen sc1 lds
    s_cmp_ge_u32 s9, 2
    s_cbranch_scc1 cs_14
    buffer_load_dwordx2 v[56:57], v11, s[12:15], s56 offen offset:3072 sc1
    buffer_load_dwordx2 v[58:59], v11, s[12:15], s56 offen offset:3328 sc1
    buffer_load_dwordx2 v[60:61], v11, s[12:15], s56 offen offset:3584 sc1
    buffer_load_dwordx2 v[62:63], v11, s[12:15], s56 offen offset:3840 sc1
cs_14:
    s_waitcnt vmcnt(0)
    s_waitcnt vmcnt(4)
    s_barrier
    s_mov_b32 m0, 151552
    s_mov_b32 s48, 40960
    buffer_load_dwordx4 v6, s[20:23], s48 offen sc1 lds
    s_mov_b32 m0, 152576
    s_mov_b32 s48, 43008
    buffer_load_dwordx4 v6, s[20:23], s48 offen sc1 lds
    s_mov_b32 m0, 153600
    s_mov_b32 s48, 45056
    buffer_load_dwordx4 v6, s[20:23], s48 offen sc1 lds
    s_mov_b32 m0, 154624
    s_mov_b32 s48, 47104
    buffer_load_dwordx4 v6, s[20:23], s48 offen sc1 lds
    s_cmp_ge_u32 s9, 2
    s_cbranch_scc1 c4_15
    ds_read_b128 v[64:67], v16 offset:0
    ds_read_b128 v[68:71], v16 offset:1024
    ds_read_b128 v[72:75], v16 offset:2048
    ds_read_b128 v[76:79], v16 offset:3072
    ds_read_b128 v[80:83], v16 offset:4096
    ds_read_b128 v[84:87], v16 offset:5120
    ds_read_b128 v[88:91], v16 offset:6144
    ds_read_b128 v[92:95], v16 offset:7168
    ds_read_b128 v[96:99], v16 offset:8192
    ds_read_b128 v[100:103], v16 offset:9216
    ds_read_b128 v[104:107], v16 offset:10240
    ds_read_b128 v[108:111], v16 offset:11264
    ds_read_b128 v[112:115], v16 offset:12288
    ds_read_b128 v[116:119], v16 offset:13312
    ds_read_b128 v[120:123], v16 offset:14336
    ds_read_b128 v[124:127], v16 offset:15360
    ds_read_b128 v[128:131], v16 offset:16384
    ds_read_b128 v[132:135], v16 offset:17408
    ds_read_b128 v[136:139], v16 offset:18432
    ds_read_b128 v[140:143], v16 offset:19456
    ds_read_b128 v[144:147], v16 offset:20480
    ds_read_b128 v[148:151], v16 offset:21504
    ds_read_b128 v[152:155], v16 offset:22528
    ds_read_b128 v[156:159], v16 offset:23552
    s_waitcnt lgkmcnt(0)
c4_15:
    s_cmp_ge_u32 s9, 2
    s_cbranch_scc1 cs_16
    s_waitcnt vmcnt(4)
    v_add_f32 v32, v32, v48
    v_add_f32 v33, v33, v49
    v_add_f32 v34, v34, v50
    v_add_f32 v35, v35, v51
    v_add_f32 v36, v36, v52
    v_add_f32 v37, v37, v53
    v_add_f32 v38, v38, v54
    v_add_f32 v39, v39, v55
    v_add_f32 v40, v40, v56
    v_add_f32 v41, v41, v57
    v_add_f32 v42, v42, v58
    v_add_f32 v43, v43, v59
cs_16:
    s_waitcnt vmcnt(0)
    s_waitcnt vmcnt(0)
    s_barrier
    s_mov_b32 m0, 147456
    s_mov_b32 s48, 49152
    buffer_load_dwordx4 v6, s[20:23], s48 offen sc1 lds
    s_mov_b32 m0, 148480
    s_mov_b32 s48, 51200
    buffer_load_dwordx4 v6, s[20:23], s48 offen sc1 lds
    s_mov_b32 m0, 149504
    s_mov_b32 s48, 53248
    buffer_load_dwordx4 v6, s[20:23], s48 offen sc1 lds
    s_mov_b32 m0, 150528
    s_mov_b32 s48, 55296
    buffer_load_dwordx4 v6, s[20:23], s48 offen sc1 lds
    s_cmp_ge_u32 s9, 2
    s_cbranch_scc1 cs_17
    v_add_f32 v44, v44, v60
    v_add_f32 v45, v45, v61
    v_add_f32 v46, v46, v62
    v_add_f32 v47, v47, v63
    v_add_f32 v32, v32, v40
    v_add_f32 v33, v33, v41
    v_add_f32 v34, v34, v42
    v_add_f32 v35, v35, v43
    v_add_f32 v36, v36, v44
    v_add_f32 v37, v37, v45
    v_add_f32 v38, v38, v46
    v_add_f32 v39, v39, v47
cs_17:
    s_waitcnt vmcnt(0)
    s_waitcnt vmcnt(0)
    s_barrier
    s_mov_b32 m0, 151552
    s_mov_b32 s48, 57344
    buffer_load_dwordx4 v6, s[20:23], s48 offen sc1 lds
    s_mov_b32 m0, 152576
    s_mov_b32 s48, 59392
    buffer_load_dwordx4 v6, s[20:23], s48 offen sc1 lds
    s_mov_b32 m0, 153600
    s_mov_b32 s48, 61440
    buffer_load_dwordx4 v6, s[20:23], s48 offen sc1 lds
    s_mov_b32 m0, 154624
    s_mov_b32 s48, 63488
    buffer_load_dwordx4 v6, s[20:23], s48 offen sc1 lds
    s_cmp_ge_u32 s9, 2
    s_cbranch_scc1 cs_18
    v_add_f32 v32, v32, v36
    v_add_f32 v33, v33, v37
    v_add_f32 v34, v34, v38
    v_add_f32 v35, v35, v39
    v_add_f32 v32, v32, v34
    v_add_f32 v33, v33, v35
    ds_write_b64 v12, v[32:33]
    s_waitcnt lgkmcnt(0)
cs_18:
    s_waitcnt vmcnt(0)
    s_waitcnt vmcnt(0)
    s_barrier
    s_barrier
    s_barrier
    s_branch h_wo
h_qkvB:
    s_mul_i32 s98, s9, 786432
    s_add_u32 s98, s98, 65273856
    s_lshl_b32 s99, s11, 10
    s_add_u32 s98, s98, s99
    s_add_u32 s96, s4, s98
    s_addc_u32 s97, s5, 0
    s_mov_b32 s98, s10
    s_mov_b32 s99, s10
    v_and_b32 v1, 63, v0
    v_lshlrev_b32 v5, 4, v1
    v_and_b32 v20, 15, v1
    v_lshrrev_b32 v11, 4, v1
    v_min_u32 v11, 2, v11
    v_lshlrev_b32 v21, 3, v20
    v_lshl_add_u32 v12, v11, 7, v21
    v_add_u32 v12, 156032, v12
    v_lshl_add_u32 v11, v11, 16, v21
    v_mov_b32 v10, 159496
    s_add_u32 s3, s9, 1
    v_mov_b32 v13, s3
    v_add_u32 v16, 49152, v5
    s_barrier
    s_cmp_lt_u32 s9, 2
    s_cbranch_scc1 c4_21
    ds_write_b128 v16, v[160:163] offset:0
    ds_write_b128 v16, v[164:167] offset:1024
    ds_write_b128 v16, v[168:171] offset:2048
    ds_write_b128 v16, v[172:175] offset:3072
    ds_write_b128 v16, v[176:179] offset:4096
    ds_write_b128 v16, v[180:183] offset:5120
    ds_write_b128 v16, v[184:187] offset:6144
    ds_write_b128 v16, v[188:191] offset:7168
    ds_write_b128 v16, v[192:195] offset:8192
    ds_write_b128 v16, v[196:199] offset:9216
    ds_write_b128 v16, v[200:203] offset:10240
    ds_write_b128 v16, v[204:207] offset:11264
    ds_write_b128 v16, v[208:211] offset:12288
    ds_write_b128 v16, v[212:215] offset:13312
    ds_write_b128 v16, v[216:219] offset:14336
    ds_write_b128 v16, v[220:223] offset:15360
    ds_write_b128 v16, a[0:3] offset:16384
    ds_write_b128 v16, a[4:7] offset:17408
    ds_write_b128 v16, a[8:11] offset:18432
    ds_write_b128 v16, a[12:15] offset:19456
    ds_write_b128 v16, a[16:19] offset:20480
    ds_write_b128 v16, a[20:23] offset:21504
    ds_write_b128 v16, a[24:27] offset:22528
    ds_write_b128 v16, a[28:31] offset:23552
    s_waitcnt lgkmcnt(0)
c4_21:
    s_barrier
    s_mov_b32 s3, 0x100000
poll_22:
    s_load_dwordx8 s[88:95], s[96:97], 0 glc
    s_sub_u32 s3, s3, 1
    s_cbranch_scc1 poll_22_ok
    s_waitcnt lgkmcnt(0)
    s_xor_b64 s[100:101], s[88:89], s[98:99]
    s_xor_b64 s[88:89], s[90:91], s[98:99]
    s_or_b64 s[100:101], s[100:101], s[88:89]
    s_xor_b64 s[88:89], s[92:93], s[98:99]
    s_or_b64 s[100:101], s[100:101], s[88:89]
    s_xor_b64 s[88:89], s[94:95], s[98:99]
    s_or_b64 s[100:101], s[100:101], s[88:89]
    s_cbranch_scc1 poll_22
poll_22_ok:
    s_waitcnt lgkmcnt(0)
    ds_write_b32 v10, v13
    s_lshl_b32 s56, s7, 12
    s_and_b32 s57, s6, 1
    s_lshl_b32 s57, s57, 7
    s_add_u32 s56, s56, s57
    s_add_u32 s56, s56, 64159744
    s_barrier
    s_barrier
    s_barrier
    s_cmp_ge_u32 s9, 2
    s_cbranch_scc1 cs_24
    buffer_load_dwordx2 v[32:33], v11, s[12:15], s56 offen offset:0 sc1
    buffer_load_dwordx2 v[34:35], v11, s[12:15], s56 offen offset:256 sc1
    buffer_load_dwordx2 v[36:37], v11, s[12:15], s56 offen offset:512 sc1
    buffer_load_dwordx2 v[38:39], v11, s[12:15], s56 offen offset:768 sc1
    buffer_load_dwordx2 v[40:41], v11, s[12:15], s56 offen offset:1024 sc1
    buffer_load_dwordx2 v[42:43], v11, s[12:15], s56 offen offset:1280 sc1
    buffer_load_dwordx2 v[44:45], v11, s[12:15], s56 offen offset:1536 sc1
    buffer_load_dwordx2 v[46:47], v11, s[12:15], s56 offen offset:1792 sc1
    buffer_load_dwordx2 v[48:49], v11, s[12:15], s56 offen offset:2048 sc1
    buffer_load_dwordx2 v[50:51], v11, s[12:15], s56 offen offset:2304 sc1
    buffer_load_dwordx2 v[52:53], v11, s[12:15], s56 offen offset:2560 sc1
    buffer_load_dwordx2 v[54:55], v11, s[12:15], s56 offen offset:2816 sc1
cs_24:
    s_barrier
    s_cmp_ge_u32 s9, 2
    s_cbranch_scc1 cs_25
    buffer_load_dwordx2 v[56:57], v11, s[12:15], s56 offen offset:3072 sc1
    buffer_load_dwordx2 v[58:59], v11, s[12:15], s56 offen offset:3328 sc1
    buffer_load_dwordx2 v[60:61], v11, s[12:15], s56 offen offset:3584 sc1
    buffer_load_dwordx2 v[62:63], v11, s[12:15], s56 offen offset:3840 sc1
cs_25:
    s_barrier
    s_cmp_ge_u32 s9, 2
    s_cbranch_scc1 c4_26
    ds_read_b128 v[160:163], v16 offset:0
    ds_read_b128 v[164:167], v16 offset:1024
    ds_read_b128 v[168:171], v16 offset:2048
    ds_read_b128 v[172:175], v16 offset:3072
    ds_read_b128 v[176:179], v16 offset:4096
    ds_read_b128 v[180:183], v16 offset:5120
    ds_read_b128 v[184:187], v16 offset:6144
    ds_read_b128 v[188:191], v16 offset:7168
    ds_read_b128 v[192:195], v16 offset:8192
    ds_read_b128 v[196:199], v16 offset:9216
    ds_read_b128 v[200:203], v16 offset:10240
    ds_read_b128 v[204:207], v16 offset:11264
    ds_read_b128 v[208:211], v16 offset:12288
    ds_read_b128 v[212:215], v16 offset:13312
    ds_read_b128 v[216:219], v16 offset:14336
    ds_read_b128 v[220:223], v16 offset:15360
    ds_read_b128 a[0:3], v16 offset:16384
    ds_read_b128 a[4:7], v16 offset:17408
    ds_read_b128 a[8:11], v16 offset:18432
    ds_read_b128 a[12:15], v16 offset:19456
    ds_read_b128 a[16:19], v16 offset:20480
    ds_read_b128 a[20:23], v16 offset:21504
    ds_read_b128 a[24:27], v16 offset:22528
    ds_read_b128 a[28:31], v16 offset:23552
    s_waitcnt lgkmcnt(0)
c4_26:
    s_cmp_ge_u32 s9, 2
    s_cbranch_scc1 cs_27
    s_waitcnt vmcnt(0)
    v_add_f32 v32, v32, v48
    v_add_f32 v33, v33, v49
    v_add_f32 v34, v34, v50
    v_add_f32 v35, v35, v51
    v_add_f32 v36, v36, v52
    v_add_f32 v37, v37, v53
    v_add_f32 v38, v38, v54
    v_add_f32 v39, v39, v55
    v_add_f32 v40, v40, v56
    v_add_f32 v41, v41, v57
    v_add_f32 v42, v42, v58
    v_add_f32 v43, v43, v59
cs_27:
    s_barrier
    s_cmp_ge_u32 s9, 2
    s_cbranch_scc1 cs_28
    v_add_f32 v44, v44, v60
    v_add_f32 v45, v45, v61
    v_add_f32 v46, v46, v62
    v_add_f32 v47, v47, v63
    v_add_f32 v32, v32, v40
    v_add_f32 v33, v33, v41
    v_add_f32 v34, v34, v42
    v_add_f32 v35, v35, v43
    v_add_f32 v36, v36, v44
    v_add_f32 v37, v37, v45
    v_add_f32 v38, v38, v46
    v_add_f32 v39, v39, v47
cs_28:
    s_barrier
    s_cmp_ge_u32 s9, 2
    s_cbranch_scc1 cs_29
    v_add_f32 v32, v32, v36
    v_add_f32 v33, v33, v37
    v_add_f32 v34, v34, v38
    v_add_f32 v35, v35, v39
    v_add_f32 v32, v32, v34
    v_add_f32 v33, v33, v35
    ds_write_b64 v12, v[32:33]
    s_waitcnt lgkmcnt(0)
cs_29:
    s_barrier
    s_barrier
    s_branch s_attn
.p2align 6
l_first:
    s_sub_u32 s51, s8, 5
    s_mul_i32 s61, s51, 0
    s_add_u32 s61, s61, s2
    s_and_b32 s61, s61, 255
    s_lshl_b32 s3, s51, 8
    s_add_u32 s61, s61, s3
    s_and_b32 s62, s61, 15
    s_lshr_b32 s63, s61, 4
    v_lshrrev_b32 v20, 3, v1
    v_mul_u32_u24 v12, 6144, v20
    v_and_b32 v21, 7, v1
    v_lshl_add_u32 v12, v21, 4, v12
    s_mov_b32 s20, s34
    s_mov_b32 s21, s35
    s_mov_b32 s22, 6291456
    s_mov_b32 s23, 0x00020000
    s_mov_b32 s28, s40
    s_mov_b32 s29, s41
    s_mov_b32 s30, 6291456
    s_mov_b32 s31, 0x00020000
    s_mul_i32 s52, s62, 393216
    s_lshl_b32 s56, s63, 7
    s_add_u32 s52, s52, s56
    s_barrier
    s_add_u32 s53, s52, 0
    buffer_load_dwordx4 v[160:163], v12, s[20:23], s53 offen nt
    s_add_u32 s53, s52, 49152
    buffer_load_dwordx4 v[164:167], v12, s[20:23], s53 offen nt
    s_add_u32 s53, s52, 98304
    buffer_load_dwordx4 v[168:171], v12, s[20:23], s53 offen nt
    s_add_u32 s53, s52, 147456
    buffer_load_dwordx4 v[172:175], v12, s[20:23], s53 offen nt
    v_lshlrev_b32 v14, 6, v20
    v_lshrrev_b32 v22, 5, v1
    v_bfe_u32 v23, v1, 1, 1
    v_xor_b32 v22, v22, v23
    v_lshl_add_u32 v14, v22, 5, v14
    v_and_b32 v22, 1, v1
    v_lshl_add_u32 v14, v22, 4, v14
    v_bfe_u32 v23, v1, 2, 1
    v_mul_u32_u24 v23, 196608, v23
    v_add_u32 v14, v14, v23
    v_lshlrev_b32 v22, 4, v22
    v_mov_b32 v23, 0x3f80
    v_lshlrev_b32 v23, v22, v23
    v_bfe_u32 v22, v1, 1, 3
    v_cmp_eq_u32 vcc, 0, v22
    s_nop 1
    v_cndmask_b32 v24, 0, v23, vcc
    v_cmp_eq_u32 vcc, 1, v22
    s_nop 1
    v_cndmask_b32 v25, 0, v23, vcc
    v_cmp_eq_u32 vcc, 2, v22
    s_nop 1
    v_cndmask_b32 v26, 0, v23, vcc
    v_cmp_eq_u32 vcc, 3, v22
    s_nop 1
    v_cndmask_b32 v27, 0, v23, vcc
    v_lshlrev_b32 v15, 5, v21
    v_and_b32 v22, 16, v1
    v_add_u32 v15, v15, v22
    v_lshlrev_b32 v16, 14, v1
    s_mov_b32 s9, 0
    s_lshr_b32 s55, s63, 4
    s_and_b32 s56, s63, 15
    s_lshl_b32 s57, s56, 4
    s_lshr_b32 s58, s62, 1
    s_add_u32 s57, s57, s58
    s_mul_i32 s57, s57, 3
    s_add_u32 s57, s57, s55
    s_lshl_b32 s57, s57, 13
    s_and_b32 s58, s62, 1
    s_lshl_b32 s58, s58, 12
    s_add_u32 s57, s57, s58
    s_add_u32 s57, s57, 50331648
    s_lshl_b32 s54, s61, 8
    s_add_u32 s54, s54, 63963136
    s_lshl_b32 s56, s56, 10
    s_lshl_b32 s55, s55, 7
    s_add_u32 s55, s55, s56
    s_lshl_b32 s56, s62, 2
    s_add_u32 s55, s55, s56
    s_add_u32 s55, s55, 64487424
    s_waitcnt vmcnt(3)
    s_add_u32 s53, s52, 196608
    buffer_load_dwordx4 v[176:179], v12, s[20:23], s53 offen nt
    s_add_u32 s53, s52, 245760
    buffer_load_dwordx4 v[180:183], v12, s[20:23], s53 offen nt
    s_add_u32 s53, s52, 294912
    buffer_load_dwordx4 v[184:187], v12, s[20:23], s53 offen nt
    buffer_store_dwordx4 v[160:163], v14, s[12:15], s57 offen offset:0 sc1
    v_mfma_f32_16x16x32_bf16 v[28:31], v[24:27], v[160:163], 0
    s_barrier
    s_waitcnt vmcnt(6)
    s_add_u32 s53, s52, 344064
    buffer_load_dwordx4 v[188:191], v12, s[20:23], s53 offen nt
    buffer_store_dwordx4 v[164:167], v14, s[12:15], s57 offen offset:512 sc1
    v_mfma_f32_16x16x32_bf16 v[28:31], v[24:27], v[164:167], v[28:31]
    s_waitcnt vmcnt(7)
    buffer_store_dwordx4 v[168:171], v14, s[12:15], s57 offen offset:1024 sc1
    v_mfma_f32_16x16x32_bf16 v[28:31], v[24:27], v[168:171], v[28:31]
    s_waitcnt vmcnt(7)
    buffer_store_dwordx4 v[172:175], v14, s[12:15], s57 offen offset:1536 sc1
    v_mfma_f32_16x16x32_bf16 v[28:31], v[24:27], v[172:175], v[28:31]
    s_waitcnt vmcnt(7)
    buffer_store_dwordx4 v[176:179], v14, s[12:15], s57 offen offset:2048 sc1
    v_mfma_f32_16x16x32_bf16 v[28:31], v[24:27], v[176:179], v[28:31]
    s_waitcnt vmcnt(7)
    buffer_store_dwordx4 v[180:183], v14, s[12:15], s57 offen offset:2560 sc1
    v_mfma_f32_16x16x32_bf16 v[28:31], v[24:27], v[180:183], v[28:31]
    s_waitcnt vmcnt(7)
    buffer_store_dwordx4 v[184:187], v14, s[12:15], s57 offen offset:3072 sc1
    v_mfma_f32_16x16x32_bf16 v[28:31], v[24:27], v[184:187], v[28:31]
    s_waitcnt vmcnt(6)
    buffer_store_dwordx4 v[188:191], v14, s[12:15], s57 offen offset:3584 sc1
    v_mfma_f32_16x16x32_bf16 v[28:31], v[24:27], v[188:191], v[28:31]
    s_nop 7
    v_add_f32_dpp v28, v28, v28 row_ror:8 row_mask:0xf bank_mask:0xf
    v_add_f32_dpp v29, v29, v29 row_ror:8 row_mask:0xf bank_mask:0xf
    v_add_f32_dpp v30, v30, v30 row_ror:8 row_mask:0xf bank_mask:0xf
    v_add_f32_dpp v31, v31, v31 row_ror:8 row_mask:0xf bank_mask:0xf
    s_mov_b64 exec, 0x00ff00ff
    buffer_store_dwordx4 v[28:31], v15, s[12:15], s54 offen sc1
    s_mov_b64 exec, -1
    s_add_u32 s57, s57, 6291456
    s_add_u32 s54, s54, 196608
    v_mov_b32 v8, 159492
non_32:
    ds_read_b32 v9, v8
    s_waitcnt lgkmcnt(0)
    v_readfirstlane_b32 s10, v9
    s_cmp_eq_u32 s10, 0
    s_cbranch_scc1 non_32
    s_mov_b64 exec, 0xffff
    s_waitcnt vmcnt(0)
    buffer_store_dword v9, v16, s[12:15], s55 offen offset:0 sc1
    s_mov_b64 exec, -1
    s_add_u32 s53, s52, 0
    buffer_load_dwordx4 v[192:195], v12, s[28:31], s53 offen nt
    s_add_u32 s53, s52, 49152
    buffer_load_dwordx4 v[196:199], v12, s[28:31], s53 offen nt
    s_add_u32 s53, s52, 98304
    buffer_load_dwordx4 v[200:203], v12, s[28:31], s53 offen nt
    s_add_u32 s53, s52, 147456
    buffer_load_dwordx4 v[204:207], v12, s[28:31], s53 offen nt
    s_add_u32 s53, s52, 196608
    buffer_load_dwordx4 v[208:211], v12, s[28:31], s53 offen nt
    s_add_u32 s53, s52, 245760
    buffer_load_dwordx4 v[212:215], v12, s[28:31], s53 offen nt
    s_add_u32 s53, s52, 294912
    buffer_load_dwordx4 v[216:219], v12, s[28:31], s53 offen nt
    s_add_u32 s53, s52, 344064
    buffer_load_dwordx4 v[220:223], v12, s[28:31], s53 offen nt
    s_mov_b32 s58, s52
    s_lshr_b32 s60, s2, 3
    s_mul_i32 s60, s60, 3
    s_lshr_b32 s60, s60, 5
    s_add_u32 s60, s60, 1
    s_branch l_qkv2
l_qkv:
    s_mov_b32 s60, 0
l_qkv2:
    v_and_b32 v1, 63, v0
    v_lshlrev_b32 v5, 4, v1
    s_sub_u32 s51, s8, 5
    s_lshl_b32 s48, s51, 13
    s_and_b32 s53, s9, 1
    s_lshl_b32 s52, s53, 4
    s_add_u32 s49, s7, s52
    s_lshl_b32 s49, s49, 1
    s_and_b32 s52, s6, 1
    s_add_u32 s49, s49, s52
    s_mul_i32 s49, s49, 196608
    s_add_u32 s49, s49, s48
    s_add_u32 s49, s49, 50331648
    v_mov_b32 v13, 159496
    s_mov_b32 s50, 0
    v_lshrrev_b32 v10, 2, v1
    v_and_b32 v11, 3, v1
    v_lshlrev_b32 v10, 8, v10
    v_lshl_add_u32 v10, v11, 4, v10
    v_lshlrev_b32 v7, 5, v11
    v_lshlrev_b32 v11, 2, v1
    v_add_u32 v11, 155648, v11
    s_lshr_b32 s59, s11, 2
    s_lshl_b32 s59, s59, 12
    s_and_b32 s3, s11, 3
    s_lshl_b32 s3, s3, 6
    s_add_u32 s59, s59, s3
    s_lshl_b32 s3, s9, 18
    s_add_u32 s59, s59, s3
    s_add_u32 s59, s59, 62914560
    s_lshl_b32 s56, s9, 15
    s_add_u32 s56, s56, 64749568
    v_mov_b32 v41, s10
    v_mov_b32 v43, s10
    v_mov_b32 v45, s10
    v_mov_b32 v47, s10
    v_and_b32 v6, 0xff, v5
    s_lshl_b32 s3, s7, 7
    v_lshrrev_b32 v20, 3, v1
    v_lshlrev_b32 v21, 11, v20
    v_lshrrev_b32 v22, 2, v1
    v_lshrrev_b32 v23, 4, v1
    v_xor_b32 v22, v22, v23
    v_and_b32 v22, 1, v22
    v_lshl_add_u32 v21, v22, 6, v21
    v_and_b32 v22, 3, v1
    v_lshl_add_u32 v21, v22, 4, v21
    v_add_u32 v17, s3, v21
    s_lshl_b32 s3, s51, 13
    s_add_u32 s3, s3, 73728
    v_add_u32 v3, s3, v5
    s_cmp_lg_u32 s9, 0
    s_cbranch_scc1 l_qkv_tiled
    s_lshl_b32 s53, s8, 7
    s_lshl_b32 s52, s11, 10
    s_add_u32 s53, s53, s52
    s_add_u32 s53, s53, 64486784
    s_add_u32 s96, s4, s53
    s_addc_u32 s97, s5, 0
    s_mov_b32 s98, s10
    s_mov_b32 s99, s10
    s_mov_b32 s3, 0x100000
poll_33:
    s_load_dwordx16 s[80:95], s[96:97], 0 glc
    s_sub_u32 s3, s3, 1
    s_cbranch_scc1 poll_33_ok
    s_waitcnt lgkmcnt(0)
    s_xor_b64 s[100:101], s[80:81], s[98:99]
    s_xor_b64 s[80:81], s[82:83], s[98:99]
    s_or_b64 s[100:101], s[100:101], s[80:81]
    s_xor_b64 s[80:81], s[84:85], s[98:99]
    s_or_b64 s[100:101], s[100:101], s[80:81]
    s_xor_b64 s[80:81], s[86:87], s[98:99]
    s_or_b64 s[100:101], s[100:101], s[80:81]
    s_xor_b64 s[80:81], s[88:89], s[98:99]
    s_or_b64 s[100:101], s[100:101], s[80:81]
    s_xor_b64 s[80:81], s[90:91], s[98:99]
    s_or_b64 s[100:101], s[100:101], s[80:81]
    s_xor_b64 s[80:81], s[92:93], s[98:99]
    s_or_b64 s[100:101], s[100:101], s[80:81]
    s_xor_b64 s[80:81], s[94:95], s[98:99]
    s_or_b64 s[100:101], s[100:101], s[80:81]
    s_cbranch_scc1 poll_33
poll_33_ok:
    s_waitcnt lgkmcnt(0)
    s_branch l_qkv_fill
l_qkv_tiled:
    s_barrier
    s_cmp_lt_u32 s9, 2
    s_cbranch_scc1 l_qkv_nocache
    s_bitcmp1_b32 s9, 0
    s_cbranch_scc1 l_qkv_c_b
    ds_write_b128 v3, v[64:67] offset:0
    ds_write_b128 v3, v[68:71] offset:1024
    ds_write_b128 v3, v[72:75] offset:2048
    ds_write_b128 v3, v[76:79] offset:3072
    ds_write_b128 v3, v[80:83] offset:4096
    ds_write_b128 v3, v[84:87] offset:5120
    ds_write_b128 v3, v[88:91] offset:6144
    ds_write_b128 v3, v[92:95] offset:7168
    ds_write_b128 v3, v[96:99] offset:24576
    ds_write_b128 v3, v[100:103] offset:25600
    ds_write_b128 v3, v[104:107] offset:26624
    ds_write_b128 v3, v[108:111] offset:27648
    ds_write_b128 v3, v[112:115] offset:28672
    ds_write_b128 v3, v[116:119] offset:29696
    ds_write_b128 v3, v[120:123] offset:30720
    ds_write_b128 v3, v[124:127] offset:31744
    ds_write_b128 v3, v[128:131] offset:49152
    ds_write_b128 v3, v[132:135] offset:50176
    ds_write_b128 v3, v[136:139] offset:51200
    ds_write_b128 v3, v[140:143] offset:52224
    ds_write_b128 v3, v[144:147] offset:53248
    ds_write_b128 v3, v[148:151] offset:54272
    ds_write_b128 v3, v[152:155] offset:55296
    ds_write_b128 v3, v[156:159] offset:56320
    s_branch l_qkv_c_w
l_qkv_c_b:
    ds_write_b128 v3, v[160:163] offset:0
    ds_write_b128 v3, v[164:167] offset:1024
    ds_write_b128 v3, v[168:171] offset:2048
    ds_write_b128 v3, v[172:175] offset:3072
    ds_write_b128 v3, v[176:179] offset:4096
    ds_write_b128 v3, v[180:183] offset:5120
    ds_write_b128 v3, v[184:187] offset:6144
    ds_write_b128 v3, v[188:191] offset:7168
    ds_write_b128 v3, v[192:195] offset:24576
    ds_write_b128 v3, v[196:199] offset:25600
    ds_write_b128 v3, v[200:203] offset:26624
    ds_write_b128 v3, v[204:207] offset:27648
    ds_write_b128 v3, v[208:211] offset:28672
    ds_write_b128 v3, v[212:215] offset:29696
    ds_write_b128 v3, v[216:219] offset:30720
    ds_write_b128 v3, v[220:223] offset:31744
    ds_write_b128 v3, a[0:3] offset:49152
    ds_write_b128 v3, a[4:7] offset:50176
    ds_write_b128 v3, a[8:11] offset:51200
    ds_write_b128 v3, a[12:15] offset:52224
    ds_write_b128 v3, a[16:19] offset:53248
    ds_write_b128 v3, a[20:23] offset:54272
    ds_write_b128 v3, a[24:27] offset:55296
    ds_write_b128 v3, a[28:31] offset:56320
l_qkv_c_w:
    s_waitcnt lgkmcnt(0)
    s_barrier
    s_mov_b32 m0, s48
    s_add_u32 s50, s50, 1
    buffer_load_dwordx4 v5, s[12:15], s49 offen offset:0 sc1 lds
    buffer_load_dwordx4 v5, s[12:15], s49 offen offset:1024 sc1 lds
    buffer_load_dwordx4 v5, s[12:15], s49 offen offset:2048 sc1 lds
    buffer_load_dwordx4 v5, s[12:15], s49 offen offset:3072 sc1 lds
    s_add_u32 s49, s49, 4096
    s_bitcmp1_b32 s50, 0
    s_cselect_b32 s3, 0, 16384
    s_add_u32 s48, s48, s3
    s_add_u32 s49, s49, s3
    s_cmp_eq_u32 s50, 12
    s_cselect_b32 s3, 4294819840, 0
    s_add_u32 s48, s48, 4096
    s_add_u32 s48, s48, s3
    s_mov_b32 m0, s48
    s_add_u32 s50, s50, 1
    buffer_load_dwordx4 v5, s[12:15], s49 offen offset:0 sc1 lds
    buffer_load_dwordx4 v5, s[12:15], s49 offen offset:1024 sc1 lds
    buffer_load_dwordx4 v5, s[12:15], s49 offen offset:2048 sc1 lds
    buffer_load_dwordx4 v5, s[12:15], s49 offen offset:3072 sc1 lds
    s_add_u32 s49, s49, 4096
    s_bitcmp1_b32 s50, 0
    s_cselect_b32 s3, 0, 16384
    s_add_u32 s48, s48, s3
    s_add_u32 s49, s49, s3
    s_cmp_eq_u32 s50, 12
    s_cselect_b32 s3, 4294819840, 0
    s_add_u32 s48, s48, 4096
    s_add_u32 s48, s48, s3
    s_mov_b32 m0, s48
    s_add_u32 s50, s50, 1
    buffer_load_dwordx4 v5, s[12:15], s49 offen offset:0 sc1 lds
    buffer_load_dwordx4 v5, s[12:15], s49 offen offset:1024 sc1 lds
    buffer_load_dwordx4 v5, s[12:15], s49 offen offset:2048 sc1 lds
    buffer_load_dwordx4 v5, s[12:15], s49 offen offset:3072 sc1 lds
    s_add_u32 s49, s49, 4096
    s_bitcmp1_b32 s50, 0
    s_cselect_b32 s3, 0, 16384
    s_add_u32 s48, s48, s3
    s_add_u32 s49, s49, s3
    s_cmp_eq_u32 s50, 12
    s_cselect_b32 s3, 4294819840, 0
    s_add_u32 s48, s48, 4096
    s_add_u32 s48, s48, s3
    s_mov_b32 m0, s48
    s_add_u32 s50, s50, 1
    buffer_load_dwordx4 v5, s[12:15], s49 offen offset:0 sc1 lds
    buffer_load_dwordx4 v5, s[12:15], s49 offen offset:1024 sc1 lds
    buffer_load_dwordx4 v5, s[12:15], s49 offen offset:2048 sc1 lds
    buffer_load_dwordx4 v5, s[12:15], s49 offen offset:3072 sc1 lds
    s_add_u32 s49, s49, 4096
    s_bitcmp1_b32 s50, 0
    s_cselect_b32 s3, 0, 16384
    s_add_u32 s48, s48, s3
    s_add_u32 s49, s49, s3
    s_cmp_eq_u32 s50, 12
    s_cselect_b32 s3, 4294819840, 0
    s_add_u32 s48, s48, 4096
    s_add_u32 s48, s48, s3
    s_mov_b32 s50, 12
    s_add_u32 s49, s49, 98304
    s_lshl_b32 s48, s51, 13
    s_waitcnt vmcnt(8)
    s_barrier
    s_waitcnt vmcnt(0)
    s_branch l_qkv_gone
l_qkv_nocache:
    s_barrier
l_qkv_fill:
    s_mov_b32 m0, s48
    s_add_u32 s50, s50, 1
    buffer_load_dwordx4 v5, s[12:15], s49 offen offset:0 sc1 lds
    buffer_load_dwordx4 v5, s[12:15], s49 offen offset:1024 sc1 lds
    buffer_load_dwordx4 v5, s[12:15], s49 offen offset:2048 sc1 lds
    buffer_load_dwordx4 v5, s[12:15], s49 offen offset:3072 sc1 lds
    s_add_u32 s49, s49, 4096
    s_bitcmp1_b32 s50, 0
    s_cselect_b32 s3, 0, 16384
    s_add_u32 s48, s48, s3
    s_add_u32 s49, s49, s3
    s_cmp_eq_u32 s50, 12
    s_cselect_b32 s3, 4294819840, 0
    s_add_u32 s48, s48, 4096
    s_add_u32 s48, s48, s3
l_qkv_fill1:
    s_mov_b32 m0, s48
    s_add_u32 s50, s50, 1
    buffer_load_dwordx4 v5, s[12:15], s49 offen offset:0 sc1 lds
    buffer_load_dwordx4 v5, s[12:15], s49 offen offset:1024 sc1 lds
    buffer_load_dwordx4 v5, s[12:15], s49 offen offset:2048 sc1 lds
    buffer_load_dwordx4 v5, s[12:15], s49 offen offset:3072 sc1 lds
    s_add_u32 s49, s49, 4096
    s_bitcmp1_b32 s50, 0
    s_cselect_b32 s3, 0, 16384
    s_add_u32 s48, s48, s3
    s_add_u32 s49, s49, s3
    s_cmp_eq_u32 s50, 12
    s_cselect_b32 s3, 4294819840, 0
    s_add_u32 s48, s48, 4096
    s_add_u32 s48, s48, s3
l_qkv_fill2:
    s_add_u32 s52, s9, 1
    s_mov_b32 m0, s48
    s_add_u32 s50, s50, 1
    buffer_load_dwordx4 v5, s[12:15], s49 offen offset:0 sc1 lds
    s_waitcnt vmcnt(10)
    buffer_load_dwordx4 v5, s[12:15], s49 offen offset:1024 sc1 lds
    s_waitcnt vmcnt(10)
    buffer_load_dwordx4 v5, s[12:15], s49 offen offset:2048 sc1 lds
    s_waitcnt vmcnt(10)
    buffer_load_dwordx4 v5, s[12:15], s49 offen offset:3072 sc1 lds
    s_waitcnt vmcnt(10)
    s_add_u32 s49, s49, 4096
    s_bitcmp1_b32 s50, 0
    s_cselect_b32 s3, 0, 16384
    s_add_u32 s48, s48, s3
    s_add_u32 s49, s49, s3
    s_cmp_eq_u32 s50, 12
    s_cselect_b32 s3, 4294819840, 0
    s_add_u32 s48, s48, 4096
    s_add_u32 s48, s48, s3
l_qkv_pre:
    s_mov_b32 m0, s48
    s_add_u32 s50, s50, 1
    buffer_load_dwordx4 v5, s[12:15], s49 offen offset:0 sc1 lds
    s_waitcnt vmcnt(10)
    buffer_load_dwordx4 v5, s[12:15], s49 offen offset:1024 sc1 lds
    s_waitcnt vmcnt(10)
    buffer_load_dwordx4 v5, s[12:15], s49 offen offset:2048 sc1 lds
    s_waitcnt vmcnt(10)
    buffer_load_dwordx4 v5, s[12:15], s49 offen offset:3072 sc1 lds
    s_waitcnt vmcnt(10)
    s_add_u32 s49, s49, 4096
    s_bitcmp1_b32 s50, 0
    s_cselect_b32 s3, 0, 16384
    s_add_u32 s48, s48, s3
    s_add_u32 s49, s49, s3
    s_cmp_eq_u32 s50, 12
    s_cselect_b32 s3, 4294819840, 0
    s_add_u32 s48, s48, 4096
    s_add_u32 s48, s48, s3
    ds_read_b32 v8, v13
    s_cmp_ge_u32 s50, 12
    s_cbranch_scc1 l_qkv_go
    s_waitcnt lgkmcnt(0)
    v_readfirstlane_b32 s3, v8
    s_cmp_lg_u32 s3, s52
    s_cbranch_scc1 l_qkv_pre
    s_cmp_ge_u32 s50, 5
    s_cbranch_scc1 l_qkv_go
    s_waitcnt vmcnt(8)
l_qkv_go:
    s_waitcnt lgkmcnt(0)
    s_barrier
l_qkv_gone:
    s_bitcmp0_b32 s50, 0
    s_cbranch_scc1 l_qkv_even
    s_mov_b32 m0, s48
    s_add_u32 s50, s50, 1
    buffer_load_dwordx4 v5, s[12:15], s49 offen offset:0 sc1 lds
    buffer_load_dwordx4 v5, s[12:15], s49 offen offset:1024 sc1 lds
    buffer_load_dwordx4 v5, s[12:15], s49 offen offset:2048 sc1 lds
    buffer_load_dwordx4 v5, s[12:15], s49 offen offset:3072 sc1 lds
    s_add_u32 s49, s49, 4096
    s_bitcmp1_b32 s50, 0
    s_cselect_b32 s3, 0, 16384
    s_add_u32 s48, s48, s3
    s_add_u32 s49, s49, s3
    s_cmp_eq_u32 s50, 12
    s_cselect_b32 s3, 4294819840, 0
    s_add_u32 s48, s48, 4096
    s_add_u32 s48, s48, s3
l_qkv_even:
    s_cmp_gt_u32 s50, 11
    s_cbranch_scc1 stg_34
    s_mov_b32 m0, s48
    s_add_u32 s50, s50, 1
    buffer_load_dwordx4 v5, s[12:15], s49 offen offset:0 sc1 lds
    buffer_load_dwordx4 v5, s[12:15], s49 offen offset:1024 sc1 lds
    buffer_load_dwordx4 v5, s[12:15], s49 offen offset:2048 sc1 lds
    buffer_load_dwordx4 v5, s[12:15], s49 offen offset:3072 sc1 lds
    s_add_u32 s49, s49, 4096
    s_bitcmp1_b32 s50, 0
    s_cselect_b32 s3, 0, 16384
    s_add_u32 s48, s48, s3
    s_add_u32 s49, s49, s3
    s_cmp_eq_u32 s50, 12
    s_cselect_b32 s3, 4294819840, 0
    s_add_u32 s48, s48, 4096
    s_add_u32 s48, s48, s3
    s_cmp_ge_u32 s9, 2
    s_cbranch_scc1 stg_34
stg_34:
    s_cmp_lg_u32 s51, 0
    s_cbranch_scc1 role_35
    buffer_load_dwordx4 v[32:35], v10, s[12:15], s59 offen sc1
role_35:
    s_lshr_b32 s3, s9, 1
    s_andn2_b32 s3, s50, s3
    s_bitcmp0_b32 s3, 0
    s_cbranch_scc1 str_36
    s_waitcnt vmcnt(1)
    s_mov_b32 m0, s48
    s_add_u32 s50, s50, 1
    buffer_load_dwordx4 v5, s[12:15], s49 offen offset:0 sc1 lds
    buffer_load_dwordx4 v5, s[12:15], s49 offen offset:1024 sc1 lds
    buffer_load_dwordx4 v5, s[12:15], s49 offen offset:2048 sc1 lds
    buffer_load_dwordx4 v5, s[12:15], s49 offen offset:3072 sc1 lds
    s_add_u32 s49, s49, 4096
    s_bitcmp1_b32 s50, 0
    s_cselect_b32 s3, 0, 16384
    s_add_u32 s48, s48, s3
    s_add_u32 s49, s49, s3
    s_cmp_eq_u32 s50, 12
    s_cselect_b32 s3, 4294819840, 0
    s_add_u32 s48, s48, 4096
    s_add_u32 s48, s48, s3
str_36:
    s_waitcnt vmcnt(8)
    s_barrier
    s_waitcnt vmcnt(0)
l_qkv_b0:
    s_cmp_gt_u32 s50, 13
    s_cbranch_scc1 stg_37
    s_mov_b32 m0, s48
    s_add_u32 s50, s50, 1
    buffer_load_dwordx4 v5, s[12:15], s49 offen offset:0 sc1 lds
    buffer_load_dwordx4 v5, s[12:15], s49 offen offset:1024 sc1 lds
    buffer_load_dwordx4 v5, s[12:15], s49 offen offset:2048 sc1 lds
    buffer_load_dwordx4 v5, s[12:15], s49 offen offset:3072 sc1 lds
    s_add_u32 s49, s49, 4096
    s_bitcmp1_b32 s50, 0
    s_cselect_b32 s3, 0, 16384
    s_add_u32 s48, s48, s3
    s_add_u32 s49, s49, s3
    s_cmp_eq_u32 s50, 12
    s_cselect_b32 s3, 4294819840, 0
    s_add_u32 s48, s48, 4096
    s_add_u32 s48, s48, s3
    s_cmp_ge_u32 s9, 2
    s_cbranch_scc1 stg_37
stg_37:
    s_cmp_eq_u32 s60, 0
    s_cbranch_scc1 ub_38
    buffer_store_dwordx4 v[192:195], v14, s[12:15], s57 offen offset:0 sc1
    v_mfma_f32_16x16x32_bf16 v[28:31], v[24:27], v[192:195], 0
    buffer_store_dwordx4 v[196:199], v14, s[12:15], s57 offen offset:512 sc1
    v_mfma_f32_16x16x32_bf16 v[28:31], v[24:27], v[196:199], v[28:31]
ub_38:
    s_cmp_lg_u32 s51, 0
    s_cbranch_scc1 role_39
    v_add_f32_dpp v32, v32, v32 row_ror:4 row_mask:0xf bank_mask:0xf
    v_add_f32_dpp v33, v33, v33 row_ror:4 row_mask:0xf bank_mask:0xf
    v_add_f32_dpp v34, v34, v34 row_ror:4 row_mask:0xf bank_mask:0xf
    v_add_f32_dpp v35, v35, v35 row_ror:4 row_mask:0xf bank_mask:0xf
    v_add_f32_dpp v32, v32, v32 row_ror:8 row_mask:0xf bank_mask:0xf
    v_add_f32_dpp v33, v33, v33 row_ror:8 row_mask:0xf bank_mask:0xf
    v_add_f32_dpp v34, v34, v34 row_ror:8 row_mask:0xf bank_mask:0xf
    v_add_f32_dpp v35, v35, v35 row_ror:8 row_mask:0xf bank_mask:0xf
    v_mov_b32 v36, v32
    v_mov_b32 v37, v33
    v_mov_b32 v38, v34
    v_mov_b32 v39, v35
    v_permlane16_swap_b32 v32, v36
    v_permlane16_swap_b32 v33, v37
    v_permlane16_swap_b32 v34, v38
    v_permlane16_swap_b32 v35, v39
    v_add_f32 v32, v32, v36
    v_add_f32 v33, v33, v37
    v_add_f32 v34, v34, v38
    v_add_f32 v35, v35, v39
    v_mov_b32 v36, v32
    v_mov_b32 v37, v33
    v_mov_b32 v38, v34
    v_mov_b32 v39, v35
    v_permlane32_swap_b32 v32, v36
    v_permlane32_swap_b32 v33, v37
    v_permlane32_swap_b32 v34, v38
    v_permlane32_swap_b32 v35, v39
    v_add_f32 v40, v32, v36
    v_add_f32 v42, v33, v37
    v_add_f32 v44, v34, v38
    v_add_f32 v46, v35, v39
role_39:
    s_lshr_b32 s3, s9, 1
    s_andn2_b32 s3, s50, s3
    s_bitcmp0_b32 s3, 0
    s_cbranch_scc1 str_40
    s_waitcnt vmcnt(1)
    s_mov_b32 m0, s48
    s_add_u32 s50, s50, 1
    buffer_load_dwordx4 v5, s[12:15], s49 offen offset:0 sc1 lds
    buffer_load_dwordx4 v5, s[12:15], s49 offen offset:1024 sc1 lds
    buffer_load_dwordx4 v5, s[12:15], s49 offen offset:2048 sc1 lds
    buffer_load_dwordx4 v5, s[12:15], s49 offen offset:3072 sc1 lds
    s_add_u32 s49, s49, 4096
    s_bitcmp1_b32 s50, 0
    s_cselect_b32 s3, 0, 16384
    s_add_u32 s48, s48, s3
    s_add_u32 s49, s49, s3
    s_cmp_eq_u32 s50, 12
    s_cselect_b32 s3, 4294819840, 0
    s_add_u32 s48, s48, 4096
    s_add_u32 s48, s48, s3
str_40:
    s_waitcnt vmcnt(8)
    s_barrier
    s_cmp_gt_u32 s50, 15
    s_cbranch_scc1 stg_41
    s_mov_b32 m0, s48
    s_add_u32 s50, s50, 1
    buffer_load_dwordx4 v5, s[12:15], s49 offen offset:0 sc1 lds
    buffer_load_dwordx4 v5, s[12:15], s49 offen offset:1024 sc1 lds
    buffer_load_dwordx4 v5, s[12:15], s49 offen offset:2048 sc1 lds
    buffer_load_dwordx4 v5, s[12:15], s49 offen offset:3072 sc1 lds
    s_add_u32 s49, s49, 4096
    s_bitcmp1_b32 s50, 0
    s_cselect_b32 s3, 0, 16384
    s_add_u32 s48, s48, s3
    s_add_u32 s49, s49, s3
    s_cmp_eq_u32 s50, 12
    s_cselect_b32 s3, 4294819840, 0
    s_add_u32 s48, s48, 4096
    s_add_u32 s48, s48, s3
    s_cmp_ge_u32 s9, 2
    s_cbranch_scc1 stg_41
stg_41:
    s_cmp_eq_u32 s60, 0
    s_cbranch_scc1 ub_42
    buffer_store_dwordx4 v[200:203], v14, s[12:15], s57 offen offset:1024 sc1
    v_mfma_f32_16x16x32_bf16 v[28:31], v[24:27], v[200:203], v[28:31]
    buffer_store_dwordx4 v[204:207], v14, s[12:15], s57 offen offset:1536 sc1
    v_mfma_f32_16x16x32_bf16 v[28:31], v[24:27], v[204:207], v[28:31]
ub_42:
    s_cmp_lg_u32 s51, 0
    s_cbranch_scc1 role_43
    v_mul_f32 v40, 0x3a800000, v40
    v_mul_f32 v44, 0x3a800000, v44
    v_mul_f32 v42, 0x3a800000, v42
    v_mul_f32 v46, 0x3a800000, v46
    v_fma_f32 v42, -v40, v40, v42
    v_fma_f32 v46, -v44, v44, v46
    v_max_f32 v42, 0, v42
    v_max_f32 v46, 0, v46
    v_add_f32 v42, 0x3727c5ac, v42
    v_add_f32 v46, 0x3727c5ac, v46
    v_rsq_f32 v42, v42
    v_rsq_f32 v46, v46
    s_lshl_b32 s3, s11, 7
    s_add_u32 s3, s3, s56
    s_mov_b64 exec, 0xf
    buffer_store_dwordx4 v[40:43], v7, s[12:15], s3 offen offset:0 sc1
    buffer_store_dwordx4 v[44:47], v7, s[12:15], s3 offen offset:16 sc1
    s_mov_b64 exec, -1
role_43:
    s_lshr_b32 s3, s9, 1
    s_andn2_b32 s3, s50, s3
    s_bitcmp0_b32 s3, 0
    s_cbranch_scc1 str_44
    s_waitcnt vmcnt(1)
    s_mov_b32 m0, s48
    s_add_u32 s50, s50, 1
    buffer_load_dwordx4 v5, s[12:15], s49 offen offset:0 sc1 lds
    buffer_load_dwordx4 v5, s[12:15], s49 offen offset:1024 sc1 lds
    buffer_load_dwordx4 v5, s[12:15], s49 offen offset:2048 sc1 lds
    buffer_load_dwordx4 v5, s[12:15], s49 offen offset:3072 sc1 lds
    s_add_u32 s49, s49, 4096
    s_bitcmp1_b32 s50, 0
    s_cselect_b32 s3, 0, 16384
    s_add_u32 s48, s48, s3
    s_add_u32 s49, s49, s3
    s_cmp_eq_u32 s50, 12
    s_cselect_b32 s3, 4294819840, 0
    s_add_u32 s48, s48, 4096
    s_add_u32 s48, s48, s3
str_44:
    s_waitcnt vmcnt(8)
    s_barrier
    s_cmp_gt_u32 s50, 15
    s_cbranch_scc1 stg_45
    s_mov_b32 m0, s48
    s_add_u32 s50, s50, 1
    buffer_load_dwordx4 v5, s[12:15], s49 offen offset:0 sc1 lds
    buffer_load_dwordx4 v5, s[12:15], s49 offen offset:1024 sc1 lds
    buffer_load_dwordx4 v5, s[12:15], s49 offen offset:2048 sc1 lds
    buffer_load_dwordx4 v5, s[12:15], s49 offen offset:3072 sc1 lds
    s_add_u32 s49, s49, 4096
    s_bitcmp1_b32 s50, 0
    s_cselect_b32 s3, 0, 16384
    s_add_u32 s48, s48, s3
    s_add_u32 s49, s49, s3
    s_cmp_eq_u32 s50, 12
    s_cselect_b32 s3, 4294819840, 0
    s_add_u32 s48, s48, 4096
    s_add_u32 s48, s48, s3
    s_cmp_ge_u32 s9, 2
    s_cbranch_scc1 stg_45
stg_45:
    s_cmp_eq_u32 s60, 0
    s_cbranch_scc1 ub_46
    buffer_store_dwordx4 v[208:211], v14, s[12:15], s57 offen offset:2048 sc1
    v_mfma_f32_16x16x32_bf16 v[28:31], v[24:27], v[208:211], v[28:31]
    buffer_store_dwordx4 v[212:215], v14, s[12:15], s57 offen offset:2560 sc1
    v_mfma_f32_16x16x32_bf16 v[28:31], v[24:27], v[212:215], v[28:31]
ub_46:
    s_lshr_b32 s3, s9, 1
    s_andn2_b32 s3, s50, s3
    s_bitcmp0_b32 s3, 0
    s_cbranch_scc1 str_47
    s_waitcnt vmcnt(1)
    s_mov_b32 m0, s48
    s_add_u32 s50, s50, 1
    buffer_load_dwordx4 v5, s[12:15], s49 offen offset:0 sc1 lds
    buffer_load_dwordx4 v5, s[12:15], s49 offen offset:1024 sc1 lds
    buffer_load_dwordx4 v5, s[12:15], s49 offen offset:2048 sc1 lds
    buffer_load_dwordx4 v5, s[12:15], s49 offen offset:3072 sc1 lds
    s_add_u32 s49, s49, 4096
    s_bitcmp1_b32 s50, 0
    s_cselect_b32 s3, 0, 16384
    s_add_u32 s48, s48, s3
    s_add_u32 s49, s49, s3
    s_cmp_eq_u32 s50, 12
    s_cselect_b32 s3, 4294819840, 0
    s_add_u32 s48, s48, 4096
    s_add_u32 s48, s48, s3
str_47:
    s_waitcnt vmcnt(8)
    s_barrier
    s_cmp_gt_u32 s50, 15
    s_cbranch_scc1 stg_48
    s_mov_b32 m0, s48
    s_add_u32 s50, s50, 1
    buffer_load_dwordx4 v5, s[12:15], s49 offen offset:0 sc1 lds
    buffer_load_dwordx4 v5, s[12:15], s49 offen offset:1024 sc1 lds
    buffer_load_dwordx4 v5, s[12:15], s49 offen offset:2048 sc1 lds
    buffer_load_dwordx4 v5, s[12:15], s49 offen offset:3072 sc1 lds
    s_add_u32 s49, s49, 4096
    s_bitcmp1_b32 s50, 0
    s_cselect_b32 s3, 0, 16384
    s_add_u32 s48, s48, s3
    s_add_u32 s49, s49, s3
    s_cmp_eq_u32 s50, 12
    s_cselect_b32 s3, 4294819840, 0
    s_add_u32 s48, s48, 4096
    s_add_u32 s48, s48, s3
    s_cmp_ge_u32 s9, 2
    s_cbranch_scc1 stg_48
stg_48:
    s_cmp_eq_u32 s60, 0
    s_cbranch_scc1 ub_49
    buffer_store_dwordx4 v[216:219], v14, s[12:15], s57 offen offset:3072 sc1
    v_mfma_f32_16x16x32_bf16 v[28:31], v[24:27], v[216:219], v[28:31]
    buffer_store_dwordx4 v[220:223], v14, s[12:15], s57 offen offset:3584 sc1
    v_mfma_f32_16x16x32_bf16 v[28:31], v[24:27], v[220:223], v[28:31]
ub_49:
    s_cmp_ge_u32 s9, 2
    s_cbranch_scc1 wc_50
    s_bitcmp1_b32 s9, 0
    s_cbranch_scc1 wc_50_b
    ds_read_b128 v[64:67], v3 offset:0
    ds_read_b128 v[68:71], v3 offset:1024
    ds_read_b128 v[72:75], v3 offset:2048
    ds_read_b128 v[76:79], v3 offset:3072
    ds_read_b128 v[80:83], v3 offset:4096
    ds_read_b128 v[84:87], v3 offset:5120
    ds_read_b128 v[88:91], v3 offset:6144
    ds_read_b128 v[92:95], v3 offset:7168
    s_branch wc_50_w
wc_50_b:
    ds_read_b128 v[160:163], v3 offset:0
    ds_read_b128 v[164:167], v3 offset:1024
    ds_read_b128 v[168:171], v3 offset:2048
    ds_read_b128 v[172:175], v3 offset:3072
    ds_read_b128 v[176:179], v3 offset:4096
    ds_read_b128 v[180:183], v3 offset:5120
    ds_read_b128 v[184:187], v3 offset:6144
    ds_read_b128 v[188:191], v3 offset:7168
wc_50_w:
    s_waitcnt lgkmcnt(0)
wc_50:
    s_cmp_lg_u32 s51, 1
    s_cbranch_scc1 role_51
    s_and_b32 s52, s11, 0xe0
    s_lshl_b32 s52, s52, 7
    s_add_u32 s52, s52, s56
    s_lshr_b32 s3, s6, 1
    s_min_u32 s3, s3, 1
    s_andn2_b32 s3, s3, s9
    s_lshl_b32 s3, s3, 8
    s_sub_u32 s53, s52, s3
    buffer_load_dwordx4 v[32:35], v5, s[12:15], s52 offen offset:0 sc1
    buffer_load_dwordx4 v[36:39], v5, s[12:15], s52 offen offset:1024 sc1
    buffer_load_dwordx4 v[40:43], v5, s[12:15], s52 offen offset:2048 sc1
    buffer_load_dwordx4 v[44:47], v5, s[12:15], s52 offen offset:3072 sc1
    buffer_load_dwordx4 v[48:51], v6, s[12:15], s53 offen sc1
role_51:
    s_lshr_b32 s3, s9, 1
    s_andn2_b32 s3, s50, s3
    s_bitcmp0_b32 s3, 0
    s_cbranch_scc1 str_52
    s_waitcnt vmcnt(1)
    s_mov_b32 m0, s48
    s_add_u32 s50, s50, 1
    buffer_load_dwordx4 v5, s[12:15], s49 offen offset:0 sc1 lds
    buffer_load_dwordx4 v5, s[12:15], s49 offen offset:1024 sc1 lds
    buffer_load_dwordx4 v5, s[12:15], s49 offen offset:2048 sc1 lds
    buffer_load_dwordx4 v5, s[12:15], s49 offen offset:3072 sc1 lds
    s_add_u32 s49, s49, 4096
    s_bitcmp1_b32 s50, 0
    s_cselect_b32 s3, 0, 16384
    s_add_u32 s48, s48, s3
    s_add_u32 s49, s49, s3
    s_cmp_eq_u32 s50, 12
    s_cselect_b32 s3, 4294819840, 0
    s_add_u32 s48, s48, 4096
    s_add_u32 s48, s48, s3
str_52:
    s_waitcnt vmcnt(8)
    s_barrier
    s_waitcnt vmcnt(0)
    s_cmp_gt_u32 s50, 15
    s_cbranch_scc1 stg_53
    s_mov_b32 m0, s48
    s_add_u32 s50, s50, 1
    buffer_load_dwordx4 v5, s[12:15], s49 offen offset:0 sc1 lds
    buffer_load_dwordx4 v5, s[12:15], s49 offen offset:1024 sc1 lds
    buffer_load_dwordx4 v5, s[12:15], s49 offen offset:2048 sc1 lds
    buffer_load_dwordx4 v5, s[12:15], s49 offen offset:3072 sc1 lds
    s_add_u32 s49, s49, 4096
    s_bitcmp1_b32 s50, 0
    s_cselect_b32 s3, 0, 16384
    s_add_u32 s48, s48, s3
    s_add_u32 s49, s49, s3
    s_cmp_eq_u32 s50, 12
    s_cselect_b32 s3, 4294819840, 0
    s_add_u32 s48, s48, 4096
    s_add_u32 s48, s48, s3
    s_cmp_ge_u32 s9, 2
    s_cbranch_scc1 stg_53
stg_53:
    s_cmp_eq_u32 s60, 0
    s_cbranch_scc1 ub_54
    v_add_f32_dpp v28, v28, v28 row_ror:8 row_mask:0xf bank_mask:0xf
    v_add_f32_dpp v29, v29, v29 row_ror:8 row_mask:0xf bank_mask:0xf
    v_add_f32_dpp v30, v30, v30 row_ror:8 row_mask:0xf bank_mask:0xf
    v_add_f32_dpp v31, v31, v31 row_ror:8 row_mask:0xf bank_mask:0xf
    s_mov_b64 exec, 0x00ff00ff
    buffer_store_dwordx4 v[28:31], v15, s[12:15], s54 offen sc1
    s_mov_b64 exec, -1
ub_54:
    s_cmp_ge_u32 s9, 2
    s_cbranch_scc1 wc_55
    s_bitcmp1_b32 s9, 0
    s_cbranch_scc1 wc_55_b
    ds_read_b128 v[96:99], v3 offset:24576
    ds_read_b128 v[100:103], v3 offset:25600
    ds_read_b128 v[104:107], v3 offset:26624
    ds_read_b128 v[108:111], v3 offset:27648
    ds_read_b128 v[112:115], v3 offset:28672
    ds_read_b128 v[116:119], v3 offset:29696
    ds_read_b128 v[120:123], v3 offset:30720
    ds_read_b128 v[124:127], v3 offset:31744
    s_branch wc_55_w
wc_55_b:
    ds_read_b128 v[192:195], v3 offset:24576
    ds_read_b128 v[196:199], v3 offset:25600
    ds_read_b128 v[200:203], v3 offset:26624
    ds_read_b128 v[204:207], v3 offset:27648
    ds_read_b128 v[208:211], v3 offset:28672
    ds_read_b128 v[212:215], v3 offset:29696
    ds_read_b128 v[216:219], v3 offset:30720
    ds_read_b128 v[220:223], v3 offset:31744
wc_55_w:
    s_waitcnt lgkmcnt(0)
wc_55:
    s_cmp_lg_u32 s51, 1
    s_cbranch_scc1 role_56
    s_mov_b32 s3, 0x100000
l_st_chk:
    v_cmp_ne_u32 s[64:65], s10, v33
    v_cmp_ne_u32 vcc, s10, v35
    s_or_b64 s[64:65], s[64:65], vcc
    v_cmp_ne_u32 vcc, s10, v37
    s_or_b64 s[64:65], s[64:65], vcc
    v_cmp_ne_u32 vcc, s10, v39
    s_or_b64 s[64:65], s[64:65], vcc
    v_cmp_ne_u32 vcc, s10, v41
    s_or_b64 s[64:65], s[64:65], vcc
    v_cmp_ne_u32 vcc, s10, v43
    s_or_b64 s[64:65], s[64:65], vcc
    v_cmp_ne_u32 vcc, s10, v45
    s_or_b64 s[64:65], s[64:65], vcc
    v_cmp_ne_u32 vcc, s10, v47
    s_or_b64 s[64:65], s[64:65], vcc
    v_cmp_ne_u32 vcc, s10, v49
    s_or_b64 s[64:65], s[64:65], vcc
    v_cmp_ne_u32 vcc, s10, v51
    s_or_b64 s[64:65], s[64:65], vcc
    s_cbranch_scc0 l_st_ok
    s_sub_u32 s3, s3, 1
    s_cbranch_scc0 l_st_again
l_st_ok:
    ds_write_b32 v11, v32 offset:1280
    ds_write_b32 v11, v34 offset:2816
    ds_write_b32 v11, v36 offset:1536
    ds_write_b32 v11, v38 offset:3072
    ds_write_b32 v11, v40 offset:1792
    ds_write_b32 v11, v42 offset:3328
    ds_write_b32 v11, v44 offset:2048
    ds_write_b32 v11, v46 offset:3584
    s_mov_b64 exec, 0xffff
    ds_write_b32 v11, v48 offset:1216
    ds_write_b32 v11, v50 offset:2752
    s_mov_b64 exec, -1
    s_waitcnt lgkmcnt(0)
role_56:
    s_lshr_b32 s3, s9, 1
    s_andn2_b32 s3, s50, s3
    s_bitcmp0_b32 s3, 0
    s_cbranch_scc1 str_57
    s_waitcnt vmcnt(1)
    s_mov_b32 m0, s48
    s_add_u32 s50, s50, 1
    buffer_load_dwordx4 v5, s[12:15], s49 offen offset:0 sc1 lds
    buffer_load_dwordx4 v5, s[12:15], s49 offen offset:1024 sc1 lds
    buffer_load_dwordx4 v5, s[12:15], s49 offen offset:2048 sc1 lds
    buffer_load_dwordx4 v5, s[12:15], s49 offen offset:3072 sc1 lds
    s_add_u32 s49, s49, 4096
    s_bitcmp1_b32 s50, 0
    s_cselect_b32 s3, 0, 16384
    s_add_u32 s48, s48, s3
    s_add_u32 s49, s49, s3
    s_cmp_eq_u32 s50, 12
    s_cselect_b32 s3, 4294819840, 0
    s_add_u32 s48, s48, 4096
    s_add_u32 s48, s48, s3
str_57:
    s_add_u32 s61, s51, 48
    s_bitcmp1_b32 s9, 0
    s_cbranch_scc1 wo_58
    s_mov_b32 s24, s36
    s_mov_b32 s25, s37
    s_mov_b32 s26, 2097152
    s_mov_b32 s27, 0x00020000
    s_and_b32 s3, s7, 7
    s_cmp_eq_u32 s3, 3
    s_cbranch_scc0 wo_58
    s_cmp_eq_u32 s9, 0
    s_cbranch_scc1 wo_58
wop_59:
    s_lshl_b32 m0, s61, 10
    s_lshr_b32 s3, s61, 1
    s_xor_b32 s3, s3, s61
    s_and_b32 s3, s3, 1
    s_mul_i32 s3, s3, 3
    s_xor_b32 s3, s3, s61
    s_lshl_b32 s3, s3, 14
    buffer_load_dwordx4 v17, s[24:27], s3 offen lds
    s_add_u32 s61, s61, 3
    s_waitcnt vmcnt(4)
    s_cmp_lt_u32 s61, 66
    s_cbranch_scc1 wop_59
wo_58:
    s_waitcnt vmcnt(8)
    s_barrier
    s_cmp_eq_u32 s60, 0
    s_cbranch_scc1 ub_60
    s_waitcnt vmcnt(0)
    s_mov_b64 exec, 0xffff
    buffer_store_dword v9, v16, s[12:15], s55 offen offset:384 sc1
    s_mov_b64 exec, -1
ub_60:
    s_cmp_ge_u32 s9, 2
    s_cbranch_scc1 wc_61
    s_bitcmp1_b32 s9, 0
    s_cbranch_scc1 wc_61_b
    ds_read_b128 v[128:131], v3 offset:49152
    ds_read_b128 v[132:135], v3 offset:50176
    ds_read_b128 v[136:139], v3 offset:51200
    ds_read_b128 v[140:143], v3 offset:52224
    ds_read_b128 v[144:147], v3 offset:53248
    ds_read_b128 v[148:151], v3 offset:54272
    ds_read_b128 v[152:155], v3 offset:55296
    ds_read_b128 v[156:159], v3 offset:56320
    s_branch wc_61_w
wc_61_b:
    ds_read_b128 a[0:3], v3 offset:49152
    ds_read_b128 a[4:7], v3 offset:50176
    ds_read_b128 a[8:11], v3 offset:51200
    ds_read_b128 a[12:15], v3 offset:52224
    ds_read_b128 a[16:19], v3 offset:53248
    ds_read_b128 a[20:23], v3 offset:54272
    ds_read_b128 a[24:27], v3 offset:55296
    ds_read_b128 a[28:31], v3 offset:56320
wc_61_w:
    s_waitcnt lgkmcnt(0)
wc_61:
    s_bitcmp1_b32 s9, 0
    s_cbranch_scc1 wo_62
    s_mov_b32 s24, s36
    s_mov_b32 s25, s37
    s_mov_b32 s26, 2097152
    s_mov_b32 s27, 0x00020000
    s_and_b32 s3, s7, 7
    s_cmp_eq_u32 s3, 3
    s_cbranch_scc0 wo_62
    s_cmp_eq_u32 s9, 0
    s_cbranch_scc1 wo_62
wop_63:
    s_lshl_b32 m0, s61, 10
    s_lshr_b32 s3, s61, 1
    s_xor_b32 s3, s3, s61
    s_and_b32 s3, s3, 1
    s_mul_i32 s3, s3, 3
    s_xor_b32 s3, s3, s61
    s_lshl_b32 s3, s3, 14
    buffer_load_dwordx4 v17, s[24:27], s3 offen lds
    s_add_u32 s61, s61, 3
    s_waitcnt vmcnt(4)
    s_cmp_lt_u32 s61, 84
    s_cbranch_scc1 wop_63
wo_62:
    s_waitcnt vmcnt(0)
    s_barrier
    s_bitcmp1_b32 s9, 0
    s_cbranch_scc1 wo_64
    s_mov_b32 s24, s36
    s_mov_b32 s25, s37
    s_mov_b32 s26, 2097152
    s_mov_b32 s27, 0x00020000
    s_and_b32 s3, s7, 7
    s_cmp_eq_u32 s3, 3
    s_cselect_b32 s62, 27, 48
    s_cselect_b32 s63, 12, 24
    s_add_u32 s62, s62, s61
    s_sub_u32 s62, s62, s51
    s_add_u32 s63, s63, s62
wop_65:
    s_lshl_b32 m0, s61, 10
    s_lshr_b32 s3, s61, 1
    s_xor_b32 s3, s3, s61
    s_and_b32 s3, s3, 1
    s_mul_i32 s3, s3, 3
    s_xor_b32 s3, s3, s61
    s_lshl_b32 s3, s3, 14
    buffer_load_dwordx4 v17, s[24:27], s3 offen lds
    s_add_u32 s61, s61, 3
    s_waitcnt vmcnt(7)
    s_cmp_lt_u32 s61, s62
    s_cbranch_scc1 wop_65
wo_64:
    s_barrier
    s_bitcmp1_b32 s9, 0
    s_cbranch_scc1 s_attn
    s_mov_b32 s24, s36
    s_mov_b32 s25, s37
    s_mov_b32 s26, 2097152
    s_mov_b32 s27, 0x00020000
wop_66:
    s_lshl_b32 m0, s61, 10
    s_lshr_b32 s3, s61, 1
    s_xor_b32 s3, s3, s61
    s_and_b32 s3, s3, 1
    s_mul_i32 s3, s3, 3
    s_xor_b32 s3, s3, s61
    s_lshl_b32 s3, s3, 14
    buffer_load_dwordx4 v17, s[24:27], s3 offen lds
    s_add_u32 s61, s61, 3
    s_waitcnt vmcnt(7)
    s_cmp_lt_u32 s61, s63
    s_cbranch_scc1 wop_66
    s_barrier
wop_67:
    s_lshl_b32 m0, s61, 10
    s_lshr_b32 s3, s61, 1
    s_xor_b32 s3, s3, s61
    s_and_b32 s3, s3, 1
    s_mul_i32 s3, s3, 3
    s_xor_b32 s3, s3, s61
    s_lshl_b32 s3, s3, 14
    buffer_load_dwordx4 v17, s[24:27], s3 offen lds
    s_add_u32 s61, s61, 3
    s_waitcnt vmcnt(7)
    s_cmp_lt_u32 s61, 128
    s_cbranch_scc1 wop_67
    s_mov_b32 s61, s51
wop_68:
    s_lshl_b32 m0, s61, 10
    s_lshr_b32 s3, s61, 1
    s_xor_b32 s3, s3, s61
    s_and_b32 s3, s3, 1
    s_mul_i32 s3, s3, 3
    s_xor_b32 s3, s3, s61
    s_lshl_b32 s3, s3, 14
    buffer_load_dwordx4 v17, s[24:27], s3 offen lds
    s_add_u32 s61, s61, 3
    s_waitcnt vmcnt(7)
    s_cmp_lt_u32 s61, 48
    s_cbranch_scc1 wop_68
    s_branch l_wo
l_st_again:
    buffer_load_dwordx4 v[32:35], v5, s[12:15], s52 offen offset:0 sc1
    buffer_load_dwordx4 v[36:39], v5, s[12:15], s52 offen offset:1024 sc1
    buffer_load_dwordx4 v[40:43], v5, s[12:15], s52 offen offset:2048 sc1
    buffer_load_dwordx4 v[44:47], v5, s[12:15], s52 offen offset:3072 sc1
    buffer_load_dwordx4 v[48:51], v6, s[12:15], s53 offen sc1
    s_waitcnt vmcnt(0)
    s_branch l_st_chk
.p2align 6
h_wo:
l_wo:
    s_mul_i32 s98, s9, 786432
    s_add_u32 s98, s98, 65798144
    s_lshl_b32 s99, s11, 10
    s_add_u32 s98, s98, s99
    s_add_u32 s96, s4, s98
    s_addc_u32 s97, s5, 0
    s_mov_b32 s98, s10
    s_mov_b32 s99, s10
    s_sub_u32 s59, s8, 4
    s_lshl_b32 s60, s59, 7
    s_add_u32 s96, s96, s60
    s_addc_u32 s97, s97, 0
    s_lshl_b32 s60, s9, 2
    s_add_u32 s60, s60, 159504
    v_mov_b32 v10, s60
    s_lshl_b32 s60, 1, s59
    v_mov_b32 v11, s60
    v_lshlrev_b32 v13, 4, v11
    s_mov_b64 exec, 1
    s_waitcnt vmcnt(0)
    ds_or_b32 v10, v13
    s_mov_b32 s3, 0x100000
poll_69:
    s_load_dwordx8 s[88:95], s[96:97], 0 glc
    s_sub_u32 s3, s3, 1
    s_cbranch_scc1 poll_69_ok
    s_waitcnt lgkmcnt(0)
    s_xor_b64 s[100:101], s[88:89], s[98:99]
    s_xor_b64 s[88:89], s[90:91], s[98:99]
    s_or_b64 s[100:101], s[100:101], s[88:89]
    s_xor_b64 s[88:89], s[92:93], s[98:99]
    s_or_b64 s[100:101], s[100:101], s[88:89]
    s_xor_b64 s[88:89], s[94:95], s[98:99]
    s_or_b64 s[100:101], s[100:101], s[88:89]
    s_cbranch_scc1 poll_69
poll_69_ok:
    s_waitcnt lgkmcnt(0)
    ds_or_b32 v10, v11
    s_mov_b64 exec, -1
    s_setprio 0
    s_waitcnt lgkmcnt(0)
    s_cmp_eq_u32 s8, 4
    s_cbranch_scc1 l_wo_end
    s_cmp_lg_u32 s9, 0
    s_cbranch_scc1 l_wo_end
    s_lshl_b32 s53, s8, 7
    s_lshl_b32 s52, s11, 10
    s_add_u32 s53, s53, s52
    s_add_u32 s53, s53, 64487168
    s_add_u32 s96, s4, s53
    s_addc_u32 s97, s5, 0
    s_mov_b32 s98, s10
    s_mov_b32 s99, s10
    s_mov_b32 s3, 0x100000
poll_70:
    s_load_dwordx16 s[80:95], s[96:97], 0 glc
    s_sub_u32 s3, s3, 1
    s_cbranch_scc1 poll_70_ok
    s_waitcnt lgkmcnt(0)
    s_xor_b64 s[100:101], s[80:81], s[98:99]
    s_xor_b64 s[80:81], s[82:83], s[98:99]
    s_or_b64 s[100:101], s[100:101], s[80:81]
    s_xor_b64 s[80:81], s[84:85], s[98:99]
    s_or_b64 s[100:101], s[100:101], s[80:81]
    s_xor_b64 s[80:81], s[86:87], s[98:99]
    s_or_b64 s[100:101], s[100:101], s[80:81]
    s_xor_b64 s[80:81], s[88:89], s[98:99]
    s_or_b64 s[100:101], s[100:101], s[80:81]
    s_xor_b64 s[80:81], s[90:91], s[98:99]
    s_or_b64 s[100:101], s[100:101], s[80:81]
    s_xor_b64 s[80:81], s[92:93], s[98:99]
    s_or_b64 s[100:101], s[100:101], s[80:81]
    s_xor_b64 s[80:81], s[94:95], s[98:99]
    s_or_b64 s[100:101], s[100:101], s[80:81]
    s_cbranch_scc1 poll_70
poll_70_ok:
    s_waitcnt lgkmcnt(0)
l_wo_end:
    s_add_u32 s9, s9, 1
    s_cmp_lg_u32 s9, 4
    s_cbranch_scc1 l_wo_next
    s_barrier
    s_branch k_exit
l_wo_next:
    s_cmp_lg_u32 s8, 4
    s_cbranch_scc1 l_qkv
    s_cmp_eq_u32 s9, 2
    s_cbranch_scc1 h_qkvA
    s_branch h_qkvB
.p2align 6
s_attn:
    s_sub_u32 s48, s8, 4
    s_lshl_b32 s3, s7, 7
    v_lshrrev_b32 v20, 3, v1
    v_lshlrev_b32 v21, 11, v20
    v_lshrrev_b32 v22, 2, v1
    v_lshrrev_b32 v23, 4, v1
    v_xor_b32 v22, v22, v23
    v_and_b32 v22, 1, v22
    v_lshl_add_u32 v21, v22, 6, v21
    v_and_b32 v22, 3, v1
    v_lshl_add_u32 v21, v22, 4, v21
    v_add_u32 v7, s3, v21
    s_mov_b32 s24, s42
    s_mov_b32 s25, s43
    s_mov_b32 s26, 2097152
    s_mov_b32 s27, 0x00020000
    s_lshr_b32 s49, s9, 1
    s_lshl_b32 s49, s49, 23
    s_lshl_b32 s52, s7, 19
    s_add_u32 s49, s49, s52
    s_and_b32 s52, s6, 1
    s_lshl_b32 s52, s52, 18
    s_add_u32 s49, s49, s52
    s_add_u32 s49, s49, 33554432
    s_lshr_b32 s61, s6, 1
    s_mul_i32 s54, s9, 786432
    s_add_u32 s54, s54, 66322432
    s_lshl_b32 s55, s11, 10
    s_add_u32 s54, s54, s55
    s_add_u32 s52, s4, s54
    s_addc_u32 s53, s5, 0
    s_mov_b32 s54, s10
    s_mov_b32 s55, s10
    s_lshl_b32 s51, s48, 11
    s_add_u32 s49, s49, s51
    s_add_u32 s51, s51, 81920
    s_mov_b32 s60, s48
    s_setprio 3
    s_barrier
    s_lshl_b32 s58, 1, s61
    s_mov_b32 s57, 0
    s_add_u32 s62, s61, 1
    s_and_b32 s62, s62, 7
    s_lshl_b32 s50, s62, 15
    s_add_u32 s50, s50, s49
    s_lshr_b32 s63, s62, 1
    s_lshl_b32 s63, s63, 7
    s_and_b32 s62, s62, 1
    s_lshl_b32 s62, s62, 4
    s_add_u32 s62, s62, s63
    s_mov_b32 s58, 0x100000
need_71:
    s_load_dwordx4 s[64:67], s[52:53], s62 glc
    s_sub_u32 s58, s58, 1
    s_cbranch_scc1 need_71_ok
    s_waitcnt lgkmcnt(0)
need_71_t:
    s_cmp_ge_u32 s48, 2
    s_cselect_b32 s63, s65, s64
    s_cmp_lg_u32 s63, s10
    s_cbranch_scc1 need_71
need_71_ok:
    s_waitcnt lgkmcnt(0)
    s_add_u32 m0, s51, 32768
    s_nop 0
    buffer_load_dwordx4 v5, s[12:15], s50 offen offset:0 sc1 lds
    buffer_load_dwordx4 v5, s[12:15], s50 offen offset:1024 sc1 lds
    s_add_u32 s50, s50, 8192
    s_add_u32 m0, s51, 40960
    s_nop 0
    buffer_load_dwordx4 v5, s[12:15], s50 offen offset:0 sc1 lds
    buffer_load_dwordx4 v5, s[12:15], s50 offen offset:1024 sc1 lds
    s_add_u32 s50, s50, 8192
    s_branch need_72_t
need_72:
    s_load_dwordx4 s[64:67], s[52:53], s62 glc
    s_sub_u32 s58, s58, 1
    s_cbranch_scc1 need_72_ok
    s_waitcnt lgkmcnt(0)
need_72_t:
    s_cmp_ge_u32 s48, 2
    s_cselect_b32 s63, s67, s66
    s_cmp_lg_u32 s63, s10
    s_cbranch_scc1 need_72
need_72_ok:
    s_waitcnt lgkmcnt(0)
    s_add_u32 m0, s51, 49152
    s_nop 0
    buffer_load_dwordx4 v5, s[12:15], s50 offen offset:0 sc1 lds
    buffer_load_dwordx4 v5, s[12:15], s50 offen offset:1024 sc1 lds
    s_add_u32 s50, s50, 8192
    s_add_u32 m0, s51, 57344
    s_nop 0
    buffer_load_dwordx4 v5, s[12:15], s50 offen offset:0 sc1 lds
    buffer_load_dwordx4 v5, s[12:15], s50 offen offset:1024 sc1 lds
    s_add_u32 s50, s50, 8192
    s_waitcnt vmcnt(4)
    s_barrier
    s_add_u32 s62, s61, 2
    s_and_b32 s62, s62, 7
    s_lshl_b32 s50, s62, 15
    s_add_u32 s50, s50, s49
    s_lshr_b32 s63, s62, 1
    s_lshl_b32 s63, s63, 7
    s_and_b32 s62, s62, 1
    s_lshl_b32 s62, s62, 4
    s_add_u32 s62, s62, s63
    s_mov_b32 s58, 0x100000
need_73:
    s_load_dwordx4 s[64:67], s[52:53], s62 glc
    s_sub_u32 s58, s58, 1
    s_cbranch_scc1 need_73_ok
    s_waitcnt lgkmcnt(0)
need_73_t:
    s_cmp_ge_u32 s48, 2
    s_cselect_b32 s63, s65, s64
    s_cmp_lg_u32 s63, s10
    s_cbranch_scc1 need_73
need_73_ok:
    s_waitcnt lgkmcnt(0)
    s_add_u32 m0, s51, 0
    s_nop 0
    buffer_load_dwordx4 v5, s[12:15], s50 offen offset:0 sc1 lds
    buffer_load_dwordx4 v5, s[12:15], s50 offen offset:1024 sc1 lds
    s_add_u32 s50, s50, 8192
    s_add_u32 m0, s51, 8192
    s_nop 0
    buffer_load_dwordx4 v5, s[12:15], s50 offen offset:0 sc1 lds
    buffer_load_dwordx4 v5, s[12:15], s50 offen offset:1024 sc1 lds
    s_add_u32 s50, s50, 8192
    s_waitcnt vmcnt(4)
    s_barrier
    s_branch need_74_t
need_74:
    s_load_dwordx4 s[64:67], s[52:53], s62 glc
    s_sub_u32 s58, s58, 1
    s_cbranch_scc1 need_74_ok
    s_waitcnt lgkmcnt(0)
need_74_t:
    s_cmp_ge_u32 s48, 2
    s_cselect_b32 s63, s67, s66
    s_cmp_lg_u32 s63, s10
    s_cbranch_scc1 need_74
need_74_ok:
    s_waitcnt lgkmcnt(0)
    s_add_u32 m0, s51, 16384
    s_nop 0
    buffer_load_dwordx4 v5, s[12:15], s50 offen offset:0 sc1 lds
    buffer_load_dwordx4 v5, s[12:15], s50 offen offset:1024 sc1 lds
    s_add_u32 s50, s50, 8192
    s_add_u32 m0, s51, 24576
    s_nop 0
    buffer_load_dwordx4 v5, s[12:15], s50 offen offset:0 sc1 lds
    buffer_load_dwordx4 v5, s[12:15], s50 offen offset:1024 sc1 lds
    s_add_u32 s50, s50, 8192
    s_waitcnt vmcnt(4)
    s_barrier
    s_add_u32 s62, s61, 3
    s_and_b32 s62, s62, 7
    s_lshl_b32 s50, s62, 15
    s_add_u32 s50, s50, s49
    s_lshr_b32 s63, s62, 1
    s_lshl_b32 s63, s63, 7
    s_and_b32 s62, s62, 1
    s_lshl_b32 s62, s62, 4
    s_add_u32 s62, s62, s63
    s_mov_b32 s58, 0x100000
need_75:
    s_load_dwordx4 s[64:67], s[52:53], s62 glc
    s_sub_u32 s58, s58, 1
    s_cbranch_scc1 need_75_ok
    s_waitcnt lgkmcnt(0)
need_75_t:
    s_cmp_ge_u32 s48, 2
    s_cselect_b32 s63, s65, s64
    s_cmp_lg_u32 s63, s10
    s_cbranch_scc1 need_75
need_75_ok:
    s_waitcnt lgkmcnt(0)
    s_add_u32 m0, s51, 32768
    s_nop 0
    buffer_load_dwordx4 v5, s[12:15], s50 offen offset:0 sc1 lds
    buffer_load_dwordx4 v5, s[12:15], s50 offen offset:1024 sc1 lds
    s_add_u32 s50, s50, 8192
    s_add_u32 m0, s51, 40960
    s_nop 0
    buffer_load_dwordx4 v5, s[12:15], s50 offen offset:0 sc1 lds
    buffer_load_dwordx4 v5, s[12:15], s50 offen offset:1024 sc1 lds
    s_add_u32 s50, s50, 8192
    s_lshl_b32 m0, s60, 10
    s_lshl_b32 s3, s60, 14
    buffer_load_dwordx4 v7, s[24:27], s3 offen lds
    s_add_u32 s60, s60, 4
    s_lshl_b32 m0, s60, 10
    s_lshl_b32 s3, s60, 14
    buffer_load_dwordx4 v7, s[24:27], s3 offen lds
    s_add_u32 s60, s60, 4
    s_waitcnt vmcnt(6)
    s_barrier
    s_branch need_76_t
need_76:
    s_load_dwordx4 s[64:67], s[52:53], s62 glc
    s_sub_u32 s58, s58, 1
    s_cbranch_scc1 need_76_ok
    s_waitcnt lgkmcnt(0)
need_76_t:
    s_cmp_ge_u32 s48, 2
    s_cselect_b32 s63, s67, s66
    s_cmp_lg_u32 s63, s10
    s_cbranch_scc1 need_76
need_76_ok:
    s_waitcnt lgkmcnt(0)
    s_add_u32 m0, s51, 49152
    s_nop 0
    buffer_load_dwordx4 v5, s[12:15], s50 offen offset:0 sc1 lds
    buffer_load_dwordx4 v5, s[12:15], s50 offen offset:1024 sc1 lds
    s_add_u32 s50, s50, 8192
    s_add_u32 m0, s51, 57344
    s_nop 0
    buffer_load_dwordx4 v5, s[12:15], s50 offen offset:0 sc1 lds
    buffer_load_dwordx4 v5, s[12:15], s50 offen offset:1024 sc1 lds
    s_add_u32 s50, s50, 8192
    s_lshl_b32 m0, s60, 10
    s_lshl_b32 s3, s60, 14
    buffer_load_dwordx4 v7, s[24:27], s3 offen lds
    s_add_u32 s60, s60, 4
    s_lshl_b32 m0, s60, 10
    s_lshl_b32 s3, s60, 14
    buffer_load_dwordx4 v7, s[24:27], s3 offen lds
    s_add_u32 s60, s60, 4
    s_waitcnt vmcnt(8)
    s_barrier
    s_add_u32 s62, s61, 4
    s_and_b32 s62, s62, 7
    s_lshl_b32 s50, s62, 15
    s_add_u32 s50, s50, s49
    s_lshr_b32 s63, s62, 1
    s_lshl_b32 s63, s63, 7
    s_and_b32 s62, s62, 1
    s_lshl_b32 s62, s62, 4
    s_add_u32 s62, s62, s63
    s_mov_b32 s58, 0x100000
need_77:
    s_load_dwordx4 s[64:67], s[52:53], s62 glc
    s_sub_u32 s58, s58, 1
    s_cbranch_scc1 need_77_ok
    s_waitcnt lgkmcnt(0)
need_77_t:
    s_cmp_ge_u32 s48, 2
    s_cselect_b32 s63, s65, s64
    s_cmp_lg_u32 s63, s10
    s_cbranch_scc1 need_77
need_77_ok:
    s_waitcnt lgkmcnt(0)
    s_add_u32 m0, s51, 0
    s_nop 0
    buffer_load_dwordx4 v5, s[12:15], s50 offen offset:0 sc1 lds
    buffer_load_dwordx4 v5, s[12:15], s50 offen offset:1024 sc1 lds
    s_add_u32 s50, s50, 8192
    s_add_u32 m0, s51, 8192
    s_nop 0
    buffer_load_dwordx4 v5, s[12:15], s50 offen offset:0 sc1 lds
    buffer_load_dwordx4 v5, s[12:15], s50 offen offset:1024 sc1 lds
    s_add_u32 s50, s50, 8192
    s_lshl_b32 m0, s60, 10
    s_lshl_b32 s3, s60, 14
    buffer_load_dwordx4 v7, s[24:27], s3 offen lds
    s_add_u32 s60, s60, 4
    s_lshl_b32 m0, s60, 10
    s_lshl_b32 s3, s60, 14
    buffer_load_dwordx4 v7, s[24:27], s3 offen lds
    s_add_u32 s60, s60, 4
    s_waitcnt vmcnt(8)
    s_barrier
    s_branch need_78_t
need_78:
    s_load_dwordx4 s[64:67], s[52:53], s62 glc
    s_sub_u32 s58, s58, 1
    s_cbranch_scc1 need_78_ok
    s_waitcnt lgkmcnt(0)
need_78_t:
    s_cmp_ge_u32 s48, 2
    s_cselect_b32 s63, s67, s66
    s_cmp_lg_u32 s63, s10
    s_cbranch_scc1 need_78
need_78_ok:
    s_waitcnt lgkmcnt(0)
    s_add_u32 m0, s51, 16384
    s_nop 0
    buffer_load_dwordx4 v5, s[12:15], s50 offen offset:0 sc1 lds
    buffer_load_dwordx4 v5, s[12:15], s50 offen offset:1024 sc1 lds
    s_add_u32 s50, s50, 8192
    s_add_u32 m0, s51, 24576
    s_nop 0
    buffer_load_dwordx4 v5, s[12:15], s50 offen offset:0 sc1 lds
    buffer_load_dwordx4 v5, s[12:15], s50 offen offset:1024 sc1 lds
    s_add_u32 s50, s50, 8192
    s_lshl_b32 m0, s60, 10
    s_lshl_b32 s3, s60, 14
    buffer_load_dwordx4 v7, s[24:27], s3 offen lds
    s_add_u32 s60, s60, 4
    s_lshl_b32 m0, s60, 10
    s_lshl_b32 s3, s60, 14
    buffer_load_dwordx4 v7, s[24:27], s3 offen lds
    s_add_u32 s60, s60, 4
    s_waitcnt vmcnt(8)
    s_barrier
    s_add_u32 s62, s61, 5
    s_and_b32 s62, s62, 7
    s_lshl_b32 s50, s62, 15
    s_add_u32 s50, s50, s49
    s_lshr_b32 s63, s62, 1
    s_lshl_b32 s63, s63, 7
    s_and_b32 s62, s62, 1
    s_lshl_b32 s62, s62, 4
    s_add_u32 s62, s62, s63
    s_mov_b32 s58, 0x100000
need_79:
    s_load_dwordx4 s[64:67], s[52:53], s62 glc
    s_sub_u32 s58, s58, 1
    s_cbranch_scc1 need_79_ok
    s_waitcnt lgkmcnt(0)
need_79_t:
    s_cmp_ge_u32 s48, 2
    s_cselect_b32 s63, s65, s64
    s_cmp_lg_u32 s63, s10
    s_cbranch_scc1 need_79
need_79_ok:
    s_waitcnt lgkmcnt(0)
    s_add_u32 m0, s51, 32768
    s_nop 0
    buffer_load_dwordx4 v5, s[12:15], s50 offen offset:0 sc1 lds
    buffer_load_dwordx4 v5, s[12:15], s50 offen offset:1024 sc1 lds
    s_add_u32 s50, s50, 8192
    s_add_u32 m0, s51, 40960
    s_nop 0
    buffer_load_dwordx4 v5, s[12:15], s50 offen offset:0 sc1 lds
    buffer_load_dwordx4 v5, s[12:15], s50 offen offset:1024 sc1 lds
    s_add_u32 s50, s50, 8192
    s_lshl_b32 m0, s60, 10
    s_lshl_b32 s3, s60, 14
    buffer_load_dwordx4 v7, s[24:27], s3 offen lds
    s_add_u32 s60, s60, 4
    s_lshl_b32 m0, s60, 10
    s_lshl_b32 s3, s60, 14
    buffer_load_dwordx4 v7, s[24:27], s3 offen lds
    s_add_u32 s60, s60, 4
    s_waitcnt vmcnt(8)
    s_barrier
    s_branch need_80_t
need_80:
    s_load_dwordx4 s[64:67], s[52:53], s62 glc
    s_sub_u32 s58, s58, 1
    s_cbranch_scc1 need_80_ok
    s_waitcnt lgkmcnt(0)
need_80_t:
    s_cmp_ge_u32 s48, 2
    s_cselect_b32 s63, s67, s66
    s_cmp_lg_u32 s63, s10
    s_cbranch_scc1 need_80
need_80_ok:
    s_waitcnt lgkmcnt(0)
    s_add_u32 m0, s51, 49152
    s_nop 0
    buffer_load_dwordx4 v5, s[12:15], s50 offen offset:0 sc1 lds
    buffer_load_dwordx4 v5, s[12:15], s50 offen offset:1024 sc1 lds
    s_add_u32 s50, s50, 8192
    s_add_u32 m0, s51, 57344
    s_nop 0
    buffer_load_dwordx4 v5, s[12:15], s50 offen offset:0 sc1 lds
    buffer_load_dwordx4 v5, s[12:15], s50 offen offset:1024 sc1 lds
    s_add_u32 s50, s50, 8192
    s_lshl_b32 m0, s60, 10
    s_lshl_b32 s3, s60, 14
    buffer_load_dwordx4 v7, s[24:27], s3 offen lds
    s_add_u32 s60, s60, 4
    s_lshl_b32 m0, s60, 10
    s_lshl_b32 s3, s60, 14
    buffer_load_dwordx4 v7, s[24:27], s3 offen lds
    s_add_u32 s60, s60, 4
    s_waitcnt vmcnt(8)
    s_barrier
    s_add_u32 s62, s61, 6
    s_and_b32 s62, s62, 7
    s_lshl_b32 s50, s62, 15
    s_add_u32 s50, s50, s49
    s_lshr_b32 s63, s62, 1
    s_lshl_b32 s63, s63, 7
    s_and_b32 s62, s62, 1
    s_lshl_b32 s62, s62, 4
    s_add_u32 s62, s62, s63
    s_mov_b32 s58, 0x100000
need_81:
    s_load_dwordx4 s[64:67], s[52:53], s62 glc
    s_sub_u32 s58, s58, 1
    s_cbranch_scc1 need_81_ok
    s_waitcnt lgkmcnt(0)
need_81_t:
    s_cmp_ge_u32 s48, 2
    s_cselect_b32 s63, s65, s64
    s_cmp_lg_u32 s63, s10
    s_cbranch_scc1 need_81
need_81_ok:
    s_waitcnt lgkmcnt(0)
    s_add_u32 m0, s51, 0
    s_nop 0
    buffer_load_dwordx4 v5, s[12:15], s50 offen offset:0 sc1 lds
    buffer_load_dwordx4 v5, s[12:15], s50 offen offset:1024 sc1 lds
    s_add_u32 s50, s50, 8192
    s_add_u32 m0, s51, 8192
    s_nop 0
    buffer_load_dwordx4 v5, s[12:15], s50 offen offset:0 sc1 lds
    buffer_load_dwordx4 v5, s[12:15], s50 offen offset:1024 sc1 lds
    s_add_u32 s50, s50, 8192
    s_lshl_b32 m0, s60, 10
    s_lshl_b32 s3, s60, 14
    buffer_load_dwordx4 v7, s[24:27], s3 offen lds
    s_add_u32 s60, s60, 4
    s_lshl_b32 m0, s60, 10
    s_lshl_b32 s3, s60, 14
    buffer_load_dwordx4 v7, s[24:27], s3 offen lds
    s_add_u32 s60, s60, 4
    s_waitcnt vmcnt(8)
    s_barrier
    s_branch need_82_t
need_82:
    s_load_dwordx4 s[64:67], s[52:53], s62 glc
    s_sub_u32 s58, s58, 1
    s_cbranch_scc1 need_82_ok
    s_waitcnt lgkmcnt(0)
need_82_t:
    s_cmp_ge_u32 s48, 2
    s_cselect_b32 s63, s67, s66
    s_cmp_lg_u32 s63, s10
    s_cbranch_scc1 need_82
need_82_ok:
    s_waitcnt lgkmcnt(0)
    s_add_u32 m0, s51, 16384
    s_nop 0
    buffer_load_dwordx4 v5, s[12:15], s50 offen offset:0 sc1 lds
    buffer_load_dwordx4 v5, s[12:15], s50 offen offset:1024 sc1 lds
    s_add_u32 s50, s50, 8192
    s_add_u32 m0, s51, 24576
    s_nop 0
    buffer_load_dwordx4 v5, s[12:15], s50 offen offset:0 sc1 lds
    buffer_load_dwordx4 v5, s[12:15], s50 offen offset:1024 sc1 lds
    s_add_u32 s50, s50, 8192
    s_lshl_b32 m0, s60, 10
    s_lshl_b32 s3, s60, 14
    buffer_load_dwordx4 v7, s[24:27], s3 offen lds
    s_add_u32 s60, s60, 4
    s_lshl_b32 m0, s60, 10
    s_lshl_b32 s3, s60, 14
    buffer_load_dwordx4 v7, s[24:27], s3 offen lds
    s_add_u32 s60, s60, 4
    s_waitcnt vmcnt(8)
    s_barrier
    s_add_u32 s62, s61, 7
    s_and_b32 s62, s62, 7
    s_lshl_b32 s50, s62, 15
    s_add_u32 s50, s50, s49
    s_lshr_b32 s63, s62, 1
    s_lshl_b32 s63, s63, 7
    s_and_b32 s62, s62, 1
    s_lshl_b32 s62, s62, 4
    s_add_u32 s62, s62, s63
    s_mov_b32 s58, 0x100000
need_83:
    s_load_dwordx4 s[64:67], s[52:53], s62 glc
    s_sub_u32 s58, s58, 1
    s_cbranch_scc1 need_83_ok
    s_waitcnt lgkmcnt(0)
need_83_t:
    s_cmp_ge_u32 s48, 2
    s_cselect_b32 s63, s65, s64
    s_cmp_lg_u32 s63, s10
    s_cbranch_scc1 need_83
need_83_ok:
    s_waitcnt lgkmcnt(0)
    s_add_u32 m0, s51, 32768
    s_nop 0
    buffer_load_dwordx4 v5, s[12:15], s50 offen offset:0 sc1 lds
    buffer_load_dwordx4 v5, s[12:15], s50 offen offset:1024 sc1 lds
    s_add_u32 s50, s50, 8192
    s_add_u32 m0, s51, 40960
    s_nop 0
    buffer_load_dwordx4 v5, s[12:15], s50 offen offset:0 sc1 lds
    buffer_load_dwordx4 v5, s[12:15], s50 offen offset:1024 sc1 lds
    s_add_u32 s50, s50, 8192
    s_lshl_b32 m0, s60, 10
    s_lshl_b32 s3, s60, 14
    buffer_load_dwordx4 v7, s[24:27], s3 offen lds
    s_add_u32 s60, s60, 4
    s_lshl_b32 m0, s60, 10
    s_lshl_b32 s3, s60, 14
    buffer_load_dwordx4 v7, s[24:27], s3 offen lds
    s_add_u32 s60, s60, 4
    s_waitcnt vmcnt(8)
    s_barrier
    s_branch need_84_t
need_84:
    s_load_dwordx4 s[64:67], s[52:53], s62 glc
    s_sub_u32 s58, s58, 1
    s_cbranch_scc1 need_84_ok
    s_waitcnt lgkmcnt(0)
need_84_t:
    s_cmp_ge_u32 s48, 2
    s_cselect_b32 s63, s67, s66
    s_cmp_lg_u32 s63, s10
    s_cbranch_scc1 need_84
need_84_ok:
    s_waitcnt lgkmcnt(0)
    s_add_u32 m0, s51, 49152
    s_nop 0
    buffer_load_dwordx4 v5, s[12:15], s50 offen offset:0 sc1 lds
    buffer_load_dwordx4 v5, s[12:15], s50 offen offset:1024 sc1 lds
    s_add_u32 s50, s50, 8192
    s_add_u32 m0, s51, 57344
    s_nop 0
    buffer_load_dwordx4 v5, s[12:15], s50 offen offset:0 sc1 lds
    buffer_load_dwordx4 v5, s[12:15], s50 offen offset:1024 sc1 lds
    s_add_u32 s50, s50, 8192
    s_lshl_b32 m0, s60, 10
    s_lshl_b32 s3, s60, 14
    buffer_load_dwordx4 v7, s[24:27], s3 offen lds
    s_add_u32 s60, s60, 4
    s_lshl_b32 m0, s60, 10
    s_lshl_b32 s3, s60, 14
    buffer_load_dwordx4 v7, s[24:27], s3 offen lds
    s_add_u32 s60, s60, 4
    s_waitcnt vmcnt(8)
    s_barrier
    s_lshl_b32 m0, s60, 10
    s_lshl_b32 s3, s60, 14
    buffer_load_dwordx4 v7, s[24:27], s3 offen lds
    s_add_u32 s60, s60, 4
    s_lshl_b32 m0, s60, 10
    s_lshl_b32 s3, s60, 14
    buffer_load_dwordx4 v7, s[24:27], s3 offen lds
    s_add_u32 s60, s60, 4
    s_lshl_b32 m0, s60, 10
    s_lshl_b32 s3, s60, 14
    buffer_load_dwordx4 v7, s[24:27], s3 offen lds
    s_add_u32 s60, s60, 4
    s_lshl_b32 m0, s60, 10
    s_lshl_b32 s3, s60, 14
    buffer_load_dwordx4 v7, s[24:27], s3 offen lds
    s_add_u32 s60, s60, 4
    s_waitcnt vmcnt(6)
    s_barrier
    s_lshl_b32 m0, s60, 10
    s_lshl_b32 s3, s60, 14
    buffer_load_dwordx4 v7, s[24:27], s3 offen lds
    s_add_u32 s60, s60, 4
    s_lshl_b32 m0, s60, 10
    s_lshl_b32 s3, s60, 14
    buffer_load_dwordx4 v7, s[24:27], s3 offen lds
    s_add_u32 s60, s60, 4
    s_lshl_b32 m0, s60, 10
    s_lshl_b32 s3, s60, 14
    buffer_load_dwordx4 v7, s[24:27], s3 offen lds
    s_add_u32 s60, s60, 4
    s_lshl_b32 m0, s60, 10
    s_lshl_b32 s3, s60, 14
    buffer_load_dwordx4 v7, s[24:27], s3 offen lds
    s_add_u32 s60, s60, 4
    s_barrier
    s_lshl_b32 m0, s60, 10
    s_lshl_b32 s3, s60, 14
    buffer_load_dwordx4 v7, s[24:27], s3 offen lds
    s_add_u32 s60, s60, 4
    s_lshl_b32 m0, s60, 10
    s_lshl_b32 s3, s60, 14
    buffer_load_dwordx4 v7, s[24:27], s3 offen lds
    s_add_u32 s60, s60, 4
    s_lshl_b32 m0, s60, 10
    s_lshl_b32 s3, s60, 14
    buffer_load_dwordx4 v7, s[24:27], s3 offen lds
    s_add_u32 s60, s60, 4
    s_lshl_b32 m0, s60, 10
    s_lshl_b32 s3, s60, 14
    buffer_load_dwordx4 v7, s[24:27], s3 offen lds
    s_add_u32 s60, s60, 4
    s_cmp_eq_u32 s8, 4
    s_cbranch_scc1 h_wo
    s_branch l_wo
.p2align 6
c_attn_slow:
    s_waitcnt lgkmcnt(0)
    s_lshr_b32 s56, s9, 1
    s_lshl_b32 s56, s56, 23
    s_lshl_b32 s55, s7, 19
    s_add_u32 s56, s56, s55
    s_and_b32 s55, s6, 1
    s_lshl_b32 s55, s55, 18
    s_add_u32 s56, s56, s55
    s_add_u32 s56, s56, 33554432
    v_mov_b32 v28, 0xff800000
    v_mov_b32 v30, 0xff800000
    s_mov_b32 s57, 0
c_attn_slow1:
    s_lshr_b32 s55, s57, 2
    s_lshl_b32 s55, s55, 14
    s_and_b32 s58, s57, 3
    s_lshl_b32 s58, s58, 11
    s_add_u32 s55, s55, s58
    s_add_u32 s55, s55, s56
    buffer_load_dwordx4 v[128:131], v5, s[12:15], s55 offen offset:0 sc1
    buffer_load_dwordx4 v[132:135], v5, s[12:15], s55 offen offset:1024 sc1
    s_waitcnt vmcnt(0)
    v_mfma_f32_32x32x16_bf16 v[64:79], v[128:131], v[8:11], 0
    v_mfma_f32_32x32x16_bf16 v[80:95], v[128:131], v[16:19], 0
    v_mfma_f32_32x32x16_bf16 v[64:79], v[132:135], v[12:15], v[64:79]
    v_mfma_f32_32x32x16_bf16 v[80:95], v[132:135], v[20:23], v[80:95]
    s_nop 10
    v_max3_f32 v28, v28, v64, v65
    v_max3_f32 v28, v28, v66, v67
    v_max3_f32 v28, v28, v68, v69
    v_max3_f32 v28, v28, v70, v71
    v_max3_f32 v28, v28, v72, v73
    v_max3_f32 v28, v28, v74, v75
    v_max3_f32 v28, v28, v76, v77
    v_max3_f32 v28, v28, v78, v79
    v_max3_f32 v30, v30, v80, v81
    v_max3_f32 v30, v30, v82, v83
    v_max3_f32 v30, v30, v84, v85
    v_max3_f32 v30, v30, v86, v87
    v_max3_f32 v30, v30, v88, v89
    v_max3_f32 v30, v30, v90, v91
    v_max3_f32 v30, v30, v92, v93
    v_max3_f32 v30, v30, v94, v95
    s_add_u32 s57, s57, 1
    s_cmp_lt_u32 s57, 64
    s_cbranch_scc1 c_attn_slow1
    v_mov_b32 v29, v28
    s_nop 1
    v_permlane32_swap_b32 v28, v29
    v_max_f32 v28, v28, v29
    v_sub_f32 v96, 0, v28
    v_sub_f32 v97, 0, v28
    v_sub_f32 v98, 0, v28
    v_sub_f32 v99, 0, v28
    v_sub_f32 v100, 0, v28
    v_sub_f32 v101, 0, v28
    v_sub_f32 v102, 0, v28
    v_sub_f32 v103, 0, v28
    v_sub_f32 v104, 0, v28
    v_sub_f32 v105, 0, v28
    v_sub_f32 v106, 0, v28
    v_sub_f32 v107, 0, v28
    v_sub_f32 v108, 0, v28
    v_sub_f32 v109, 0, v28
    v_sub_f32 v110, 0, v28
    v_sub_f32 v111, 0, v28
    v_mov_b32 v160, 0
    v_mov_b32 v161, 0
    v_mov_b32 v162, 0
    v_mov_b32 v163, 0
    v_mov_b32 v164, 0
    v_mov_b32 v165, 0
    v_mov_b32 v166, 0
    v_mov_b32 v167, 0
    v_mov_b32 v168, 0
    v_mov_b32 v169, 0
    v_mov_b32 v170, 0
    v_mov_b32 v171, 0
    v_mov_b32 v172, 0
    v_mov_b32 v173, 0
    v_mov_b32 v174, 0
    v_mov_b32 v175, 0
    v_mov_b32 v192, 0
    v_mov_b32 v193, 0
    v_mov_b32 v194, 0
    v_mov_b32 v195, 0
    v_mov_b32 v31, v30
    s_nop 1
    v_permlane32_swap_b32 v30, v31
    v_max_f32 v30, v30, v31
    v_sub_f32 v112, 0, v30
    v_sub_f32 v113, 0, v30
    v_sub_f32 v114, 0, v30
    v_sub_f32 v115, 0, v30
    v_sub_f32 v116, 0, v30
    v_sub_f32 v117, 0, v30
    v_sub_f32 v118, 0, v30
    v_sub_f32 v119, 0, v30
    v_sub_f32 v120, 0, v30
    v_sub_f32 v121, 0, v30
    v_sub_f32 v122, 0, v30
    v_sub_f32 v123, 0, v30
    v_sub_f32 v124, 0, v30
    v_sub_f32 v125, 0, v30
    v_sub_f32 v126, 0, v30
    v_sub_f32 v127, 0, v30
    v_mov_b32 v176, 0
    v_mov_b32 v177, 0
    v_mov_b32 v178, 0
    v_mov_b32 v179, 0
    v_mov_b32 v180, 0
    v_mov_b32 v181, 0
    v_mov_b32 v182, 0
    v_mov_b32 v183, 0
    v_mov_b32 v184, 0
    v_mov_b32 v185, 0
    v_mov_b32 v186, 0
    v_mov_b32 v187, 0
    v_mov_b32 v188, 0
    v_mov_b32 v189, 0
    v_mov_b32 v190, 0
    v_mov_b32 v191, 0
    v_mov_b32 v196, 0
    v_mov_b32 v197, 0
    v_mov_b32 v198, 0
    v_mov_b32 v199, 0
    s_mov_b32 s57, 0
c_attn_slow2:
    s_lshr_b32 s55, s57, 2
    s_lshl_b32 s55, s55, 14
    s_and_b32 s58, s57, 3
    s_lshl_b32 s58, s58, 11
    s_add_u32 s55, s55, s58
    s_add_u32 s55, s55, s56
    buffer_load_dwordx4 v[128:131], v5, s[12:15], s55 offen offset:0 sc1
    buffer_load_dwordx4 v[132:135], v5, s[12:15], s55 offen offset:1024 sc1
    s_add_u32 s55, s55, 8192
    buffer_load_dwordx4 v[144:147], v5, s[12:15], s55 offen offset:0 sc1
    buffer_load_dwordx4 v[148:151], v5, s[12:15], s55 offen offset:1024 sc1
    s_waitcnt vmcnt(0)
    v_mfma_f32_32x32x16_bf16 v[64:79], v[128:131], v[8:11], v[96:111]
    v_mfma_f32_32x32x16_bf16 v[80:95], v[128:131], v[16:19], v[112:127]
    v_mfma_f32_32x32x16_bf16 v[64:79], v[132:135], v[12:15], v[64:79]
    v_mfma_f32_32x32x16_bf16 v[80:95], v[132:135], v[20:23], v[80:95]
    s_nop 10
    v_exp_f32 v64, v64
    v_exp_f32 v65, v65
    v_exp_f32 v66, v66
    v_exp_f32 v67, v67
    v_exp_f32 v68, v68
    v_exp_f32 v69, v69
    v_exp_f32 v70, v70
    v_exp_f32 v71, v71
    v_exp_f32 v72, v72
    v_exp_f32 v73, v73
    v_exp_f32 v74, v74
    v_exp_f32 v75, v75
    v_exp_f32 v76, v76
    v_exp_f32 v77, v77
    v_exp_f32 v78, v78
    v_exp_f32 v79, v79
    v_exp_f32 v80, v80
    v_exp_f32 v81, v81
    v_exp_f32 v82, v82
    v_exp_f32 v83, v83
    v_exp_f32 v84, v84
    v_exp_f32 v85, v85
    v_exp_f32 v86, v86
    v_exp_f32 v87, v87
    v_exp_f32 v88, v88
    v_exp_f32 v89, v89
    v_exp_f32 v90, v90
    v_exp_f32 v91, v91
    v_exp_f32 v92, v92
    v_exp_f32 v93, v93
    v_exp_f32 v94, v94
    v_exp_f32 v95, v95
    v_smfmac_f32_32x32x32_bf16 v[160:175], v[144:147], v[64:71], v204
    v_smfmac_f32_16x16x64_bf16 v[192:195], v[200:203], v[64:71], v204
    v_smfmac_f32_32x32x32_bf16 v[160:175], v[148:151], v[72:79], v204
    v_smfmac_f32_16x16x64_bf16 v[192:195], v[200:203], v[72:79], v204
    v_smfmac_f32_32x32x32_bf16 v[176:191], v[144:147], v[80:87], v204
    v_smfmac_f32_16x16x64_bf16 v[196:199], v[200:203], v[80:87], v204
    v_smfmac_f32_32x32x32_bf16 v[176:191], v[148:151], v[88:95], v204
    v_smfmac_f32_16x16x64_bf16 v[196:199], v[200:203], v[88:95], v204
    s_add_u32 s57, s57, 1
    s_cmp_lt_u32 s57, 64
    s_nop 15
    s_cbranch_scc1 c_attn_slow2
    s_branch c_attn_fin
    s_endpgm
.section .rodata,"a"
.p2align 6
.amdhsa_kernel interleave_layers__sliding_local_dilated__softmax_full_mha__prompt_kernel
  .amdhsa_next_free_vgpr 256
  .amdhsa_next_free_sgpr 102
  .amdhsa_accum_offset 224
  .amdhsa_group_segment_fixed_size 0
  .amdhsa_kernarg_size 72
  .amdhsa_user_sgpr_count 2
  .amdhsa_user_sgpr_kernarg_segment_ptr 1
  .amdhsa_system_sgpr_workgroup_id_x 1
.end_amdhsa_kernel
```

```asm
; @launch grid=(256,1,1) block=(512,1,1) lds=159744
.amdgcn_target "amdgcn-amd-amdhsa--gfx950"
.text
.globl interleave_layers__sliding_local_dilated__softmax_full_mha__prompt_kernel
.type interleave_layers__sliding_local_dilated__softmax_full_mha__prompt_kernel,@function
.p2align 8
interleave_layers__sliding_local_dilated__softmax_full_mha__prompt_kernel:
    s_cmp_ge_u32 s2, 256
    s_cbranch_scc1 k_exit2
    s_load_dwordx16 s[32:47], s[0:1], 0
    s_load_dwordx2 s[4:5], s[0:1], 64
    v_lshrrev_b32 v2, 6, v0
    v_and_b32 v1, 63, v0
    v_mov_b32 v12, 0
    v_mov_b32 v14, 0
    v_mov_b32 v15, 0
    v_mov_b32 v16, 0
    v_readfirstlane_b32 s8, v2
    s_and_b32 s3, s2, 1
    s_lshl_b32 s3, s3, 3
    s_bfe_u32 s6, s2, 0x30003
    s_add_u32 s6, s3, s6
    s_bfe_u32 s3, s2, 0x20001
    s_lshl_b32 s3, s3, 2
    s_lshr_b32 s7, s2, 6
    s_add_u32 s7, s3, s7
    s_lshl_b32 s11, s6, 4
    s_add_u32 s11, s11, s7
    s_mov_b32 s9, -1
    s_mov_b32 s96, 0
    s_mov_b32 s10, 0
    s_cmp_lt_u32 s8, 4
    s_cbranch_scc1 c_prep
    s_cmp_eq_u32 s8, 4
    s_cbranch_scc1 h_first
k_heads:
l_first:
    s_sub_u32 s51, s8, 5
    s_mul_i32 s61, s51, 0
    s_add_u32 s61, s61, s2
    s_and_b32 s61, s61, 255
    s_lshl_b32 s3, s51, 8
    s_add_u32 s61, s61, s3
    s_and_b32 s62, s61, 15
    s_lshr_b32 s63, s61, 4
    v_lshrrev_b32 v20, 3, v1
    v_mul_u32_u24 v12, 6144, v20
    v_and_b32 v21, 7, v1
    v_lshl_add_u32 v12, v21, 4, v12
    s_mul_i32 s52, s62, 393216
    s_lshl_b32 s56, s63, 7
    s_add_u32 s52, s52, s56
    s_waitcnt lgkmcnt(0)
    s_mov_b32 s12, s4
    s_mov_b32 s13, s5
    s_mov_b32 s14, 71303168
    s_mov_b32 s15, 0x00020000
    s_mov_b32 s20, s34
    s_mov_b32 s21, s35
    s_mov_b32 s22, 6291456
    s_mov_b32 s23, 0x00020000
    s_barrier
    s_add_u32 s53, s52, 0
    buffer_load_dwordx4 v[160:163], v12, s[20:23], s53 offen nt
    s_add_u32 s53, s52, 49152
    buffer_load_dwordx4 v[164:167], v12, s[20:23], s53 offen nt
    s_add_u32 s53, s52, 98304
    buffer_load_dwordx4 v[168:171], v12, s[20:23], s53 offen nt
    s_add_u32 s53, s52, 147456
    buffer_load_dwordx4 v[172:175], v12, s[20:23], s53 offen nt
    s_branch l_first_tail
c_prep:
    s_lshl_b32 s48, s6, 2
    s_add_u32 s48, s48, s8
    v_lshrrev_b32 v16, 3, v1
    v_and_b32 v17, 7, v1
    v_lshlrev_b32 v18, 11, v16
    v_lshl_add_u32 v18, v17, 4, v18
    s_lshl_b32 s55, s48, 16
    s_lshl_b32 s56, s7, 7
    s_add_u32 s3, s55, s56
    s_waitcnt lgkmcnt(0)
    s_mov_b32 s12, s4
    s_mov_b32 s13, s5
    s_mov_b32 s14, 71303168
    s_mov_b32 s15, 0x00020000
    s_mov_b32 s28, s32
    s_mov_b32 s29, s33
    s_mov_b32 s30, 4194304
    s_mov_b32 s31, 0x00020000
    buffer_load_dwordx4 v[32:35], v18, s[28:31], s3 offen nt
    s_add_u32 s3, s3, 16384
    buffer_load_dwordx4 v[36:39], v18, s[28:31], s3 offen nt
    s_add_u32 s3, s3, 16384
    buffer_load_dwordx4 v[40:43], v18, s[28:31], s3 offen nt
    s_add_u32 s3, s3, 16384
    buffer_load_dwordx4 v[44:47], v18, s[28:31], s3 offen nt
    s_add_u32 s3, s3, 16384
    s_barrier
    s_branch c_prep_tail
h_first:
    s_memrealtime s[50:51]
    s_getpc_b64 s[52:53]
h_first_pc:
    s_sub_u32 s52, s52, h_first_pc-interleave_layers__sliding_local_dilated__softmax_full_mha__prompt_kernel
    s_subb_u32 s53, s53, 0
    s_lshr_b32 s3, s2, 3
    s_lshl_b32 s3, s3, 11
    v_and_b32 v13, 15, v1
    v_lshl_add_u32 v13, v13, 7, s3
    v_min_u32 v13, k_end-interleave_layers__sliding_local_dilated__softmax_full_mha__prompt_kernel-4, v13
    v_mov_b32 v17, s53
    v_add_co_u32 v16, vcc, s52, v13
    s_nop 1
    v_addc_co_u32 v17, vcc, 0, v17, vcc
    s_mov_b64 exec, 0xffff
    global_load_dword v18, v[16:17], off
    s_mov_b64 exec, -1
    s_waitcnt lgkmcnt(0)
    s_mov_b32 s12, s4
    s_mov_b32 s13, s5
    s_mov_b32 s14, 71303168
    s_mov_b32 s15, 0x00020000
    s_cmp_lg_u32 s2, 0
    s_cbranch_scc1 h_first_nonon
    s_mov_b32 s16, s46
    s_mov_b32 s17, s47
    s_mov_b32 s18, 256
    s_mov_b32 s19, 0x00020000
    v_lshlrev_b32 v14, 6, v1
    s_or_b32 s50, s50, 1
    v_mov_b32 v13, s50
    buffer_store_dword v13, v14, s[16:19], 0 offen sc1
h_first_nonon:
    s_barrier
    s_branch h_first_tail
k_exit:
k_exit2:
    s_endpgm
.p2align 6
c_qkvA:
    v_and_b32 v1, 63, v0
    v_lshrrev_b32 v2, 6, v0
    v_lshlrev_b32 v5, 4, v1
    v_lshrrev_b32 v3, 5, v1
    v_and_b32 v4, 15, v0
    v_bfe_u32 v7, v1, 4, 1
    v_lshl_add_u32 v6, v7, 5, v4
    v_lshlrev_b32 v6, 4, v6
    v_lshl_add_u32 v6, v3, 10, v6
    s_lshr_b32 s48, s6, 1
    s_lshl_b32 s48, s48, 2
    s_add_u32 s48, s48, s8
    s_lshl_b32 s55, s48, 17
    s_lshl_b32 s56, s9, 22
    s_add_u32 s55, s55, s56
    s_add_u32 s16, s4, s55
    s_addc_u32 s17, s5, 0
    s_mov_b32 s18, 65536
    s_mov_b32 s19, 0x00020000
    s_add_u32 s56, s55, 65536
    s_add_u32 s20, s4, s56
    s_addc_u32 s21, s5, 0
    s_mov_b32 s22, 65536
    s_mov_b32 s23, 0x00020000
    s_lshl_b32 s49, s7, 12
    s_add_u32 s49, s49, s55
    s_and_b32 s56, s6, 1
    s_lshl_b32 s56, s56, 11
    s_add_u32 s49, s49, s56
    s_add_u32 s49, s49, 16777216
    s_movk_i32 s54, 4096
    v_lshrrev_b32 v16, 2, v4
    v_lshl_add_u32 v18, v7, 2, v16
    v_lshl_add_u32 v18, v3, 4, v18
    v_lshlrev_b32 v18, 6, v18
    v_and_b32 v17, 3, v4
    v_lshl_add_u32 v18, v17, 3, v18
    v_lshl_add_u32 v26, v7, 5, v18
    v_xor_b32 v27, 32, v26
    v_mov_b32 v24, v26
    v_mov_b32 v25, v27
    v_and_b32 v18, 0x30, v1
    v_add_u32 v10, 155648, v18
    v_lshlrev_b32 v11, 2, v4
    v_add_u32 v11, 155648, v11
    v_lshl_add_u32 v8, v2, 8, v11
    v_lshl_add_u32 v9, v2, 8, v10
    s_lshr_b32 s3, s8, 1
    s_and_b32 s55, s8, 1
    s_lshl_b32 s56, s55, 5
    v_xor_b32 v29, s56, v26
    s_lshl_b32 s56, s3, 13
    s_add_u32 s56, s56, 8192
    v_add_u32 v29, s56, v29
    v_mov_b32 v28, v29
    v_add_u32 v30, 147456, v5
    v_lshl_add_u32 v14, v2, 6, v10
    v_lshl_add_u32 v12, v2, 11, v5
    v_add_u32 v12, 131072, v12
    v_lshlrev_b32 v16, 8, v16
    v_lshl_add_u32 v16, v18, 2, v16
    v_lshl_add_u32 v16, v17, 1, v16
    v_add_u32 v16, 1024, v16
    v_cmp_gt_u32 vcc, 2, v2
    s_nop 1
    v_cndmask_b32 v13, v16, v5, vcc
    s_lshl_b32 s56, s55, 3
    s_add_u32 s56, s56, 131072
    v_add_u32 v13, s56, v13
    v_lshrrev_b32 v18, 2, v18
    v_sub_u32 v18, v4, v18
    v_mov_b32 v19, 0xf149f2ca
    v_add_u32 v16, 0x0, v18
    v_and_b32 v16, 0xfffffff1, v16
    v_cmp_eq_u32 vcc, 0, v16
    s_nop 1
    v_cndmask_b32 v196, v19, 0, vcc
    v_add_u32 v16, 0xffffffff, v18
    v_and_b32 v16, 0xfffffff1, v16
    v_cmp_eq_u32 vcc, 0, v16
    s_nop 1
    v_cndmask_b32 v197, v19, 0, vcc
    v_add_u32 v16, 0xfffffffe, v18
    v_and_b32 v16, 0xfffffff1, v16
    v_cmp_eq_u32 vcc, 0, v16
    s_nop 1
    v_cndmask_b32 v198, v19, 0, vcc
    v_add_u32 v16, 0xfffffffd, v18
    v_and_b32 v16, 0xfffffff1, v16
    v_cmp_eq_u32 vcc, 0, v16
    s_nop 1
    v_cndmask_b32 v199, v19, 0, vcc
    v_add_u32 v16, 0x10, v18
    v_and_b32 v16, 0xfffffff1, v16
    v_cmp_eq_u32 vcc, 0, v16
    s_nop 1
    v_cndmask_b32 v200, v19, 0, vcc
    v_add_u32 v16, 0xf, v18
    v_and_b32 v16, 0xfffffff1, v16
    v_cmp_eq_u32 vcc, 0, v16
    s_nop 1
    v_cndmask_b32 v201, v19, 0, vcc
    v_add_u32 v16, 0xe, v18
    v_and_b32 v16, 0xfffffff1, v16
    v_cmp_eq_u32 vcc, 0, v16
    s_nop 1
    v_cndmask_b32 v202, v19, 0, vcc
    v_add_u32 v16, 0xd, v18
    v_and_b32 v16, 0xfffffff1, v16
    v_cmp_eq_u32 vcc, 0, v16
    s_nop 1
    v_cndmask_b32 v203, v19, 0, vcc
    s_cmp_eq_u32 s48, 0
    s_cselect_b64 vcc, -1, 0
    v_cndmask_b32 v204, v200, v19, vcc
    v_cndmask_b32 v205, v201, v19, vcc
    v_cndmask_b32 v206, v202, v19, vcc
    v_cndmask_b32 v207, v203, v19, vcc
    v_mov_b32 v208, 0x3f803f80
    v_mov_b32 v209, 0x3f803f80
    v_mov_b32 v210, 0x3f803f80
    v_mov_b32 v211, 0x3f803f80
    v_mov_b32 v184, 0
    v_mov_b32 v185, 0
    v_mov_b32 v186, 0
    v_mov_b32 v187, 0
    v_mov_b32 v188, 0
    v_mov_b32 v189, 0
    v_mov_b32 v190, 0
    v_mov_b32 v191, 0
    v_mov_b32 v192, 0
    v_mov_b32 v193, 0
    v_mov_b32 v194, 0
    v_mov_b32 v195, 0
    v_mov_b32 v32, 0
    v_mov_b32 v33, 0
    v_mov_b32 v34, 0
    v_mov_b32 v35, 0
    v_mov_b32 v36, 0
    v_mov_b32 v37, 0
    v_mov_b32 v38, 0
    v_mov_b32 v39, 0
    v_mov_b32 v40, 0
    v_mov_b32 v41, 0
    v_mov_b32 v42, 0
    v_mov_b32 v43, 0
    v_mov_b32 v44, 0
    v_mov_b32 v45, 0
    v_mov_b32 v46, 0
    v_mov_b32 v47, 0
    v_mov_b32 v48, 0
    v_mov_b32 v49, 0
    v_mov_b32 v50, 0
    v_mov_b32 v51, 0
    v_mov_b32 v52, 0
    v_mov_b32 v53, 0
    v_mov_b32 v54, 0
    v_mov_b32 v55, 0
    v_mov_b32 v56, 0
    v_mov_b32 v57, 0
    v_mov_b32 v58, 0
    v_mov_b32 v59, 0
    v_mov_b32 v60, 0
    v_mov_b32 v61, 0
    v_mov_b32 v62, 0
    v_mov_b32 v63, 0
    v_mov_b32 v64, 0
    v_mov_b32 v65, 0
    v_mov_b32 v66, 0
    v_mov_b32 v67, 0
    v_mov_b32 v68, 0
    v_mov_b32 v69, 0
    v_mov_b32 v70, 0
    v_mov_b32 v71, 0
    v_mov_b32 v72, 0
    v_mov_b32 v73, 0
    v_mov_b32 v74, 0
    v_mov_b32 v75, 0
    v_mov_b32 v76, 0
    v_mov_b32 v77, 0
    v_mov_b32 v78, 0
    v_mov_b32 v79, 0
    v_mov_b32 v80, 0
    v_mov_b32 v81, 0
    v_mov_b32 v82, 0
    v_mov_b32 v83, 0
    v_mov_b32 v84, 0
    v_mov_b32 v85, 0
    v_mov_b32 v86, 0
    v_mov_b32 v87, 0
    v_mov_b32 v88, 0
    v_mov_b32 v89, 0
    v_mov_b32 v90, 0
    v_mov_b32 v91, 0
    v_mov_b32 v92, 0
    v_mov_b32 v93, 0
    v_mov_b32 v94, 0
    v_mov_b32 v95, 0
    v_mov_b32 v96, 0
    v_mov_b32 v97, 0
    v_mov_b32 v98, 0
    v_mov_b32 v99, 0
    v_mov_b32 v100, 0
    v_mov_b32 v101, 0
    v_mov_b32 v102, 0
    v_mov_b32 v103, 0
    v_mov_b32 v104, 0
    v_mov_b32 v105, 0
    v_mov_b32 v106, 0
    v_mov_b32 v107, 0
    v_mov_b32 v108, 0
    v_mov_b32 v109, 0
    v_mov_b32 v110, 0
    v_mov_b32 v111, 0
    v_mov_b32 v112, 0
    v_mov_b32 v113, 0
    v_mov_b32 v114, 0
    v_mov_b32 v115, 0
    v_mov_b32 v116, 0
    v_mov_b32 v117, 0
    v_mov_b32 v118, 0
    v_mov_b32 v119, 0
    v_mov_b32 v120, 0
    v_mov_b32 v121, 0
    v_mov_b32 v122, 0
    v_mov_b32 v123, 0
    v_mov_b32 v124, 0
    v_mov_b32 v125, 0
    v_mov_b32 v126, 0
    v_mov_b32 v127, 0
    s_mov_b32 s50, 8192
    s_mov_b32 s58, 6144
    s_mov_b32 s51, 12288
    s_mov_b32 s59, 10240
    s_mov_b32 s52, 0
    s_mul_i32 s60, s9, 786432
    s_add_u32 s60, s60, 65273856
    s_lshl_b32 s61, s11, 10
    s_add_u32 s60, s60, s61
    s_and_b32 s61, s8, 2
    s_lshl_b32 s61, s61, 7
    s_add_u32 s60, s60, s61
    s_add_u32 s61, s60, 128
    s_mov_b32 s98, s10
    s_mov_b32 s99, s10
    s_mov_b32 s3, 0x100000
cp_1:
    s_load_dwordx8 s[64:71], s[4:5], s60 glc
    s_load_dwordx8 s[72:79], s[4:5], s61 glc
    s_sub_u32 s3, s3, 1
    s_cbranch_scc1 cp_1_ok
    s_waitcnt lgkmcnt(0)
    s_xor_b64 s[100:101], s[64:65], s[98:99]
    s_xor_b64 s[64:65], s[66:67], s[98:99]
    s_or_b64 s[100:101], s[100:101], s[64:65]
    s_xor_b64 s[64:65], s[68:69], s[98:99]
    s_or_b64 s[100:101], s[100:101], s[64:65]
    s_xor_b64 s[64:65], s[70:71], s[98:99]
    s_or_b64 s[100:101], s[100:101], s[64:65]
    s_xor_b64 s[64:65], s[72:73], s[98:99]
    s_or_b64 s[100:101], s[100:101], s[64:65]
    s_xor_b64 s[64:65], s[74:75], s[98:99]
    s_or_b64 s[100:101], s[100:101], s[64:65]
    s_xor_b64 s[64:65], s[76:77], s[98:99]
    s_or_b64 s[100:101], s[100:101], s[64:65]
    s_xor_b64 s[64:65], s[78:79], s[98:99]
    s_or_b64 s[100:101], s[100:101], s[64:65]
    s_cbranch_scc1 cp_1
cp_1_ok:
    s_waitcnt lgkmcnt(0)
    buffer_load_dwordx4 v[152:155], v6, s[16:19], 0 offen offset:0 sc1
    buffer_load_dwordx4 v[156:159], v6, s[16:19], 0 offen offset:256 sc1
    buffer_load_dwordx4 v[160:163], v6, s[20:23], 0 offen offset:0 sc1
    buffer_load_dwordx4 v[164:167], v6, s[20:23], 0 offen offset:256 sc1
    buffer_load_dwordx4 v[168:171], v6, s[16:19], 0 offen offset:2048 sc1
    buffer_load_dwordx4 v[172:175], v6, s[16:19], 0 offen offset:2304 sc1
    buffer_load_dwordx4 v[176:179], v6, s[20:23], 0 offen offset:2048 sc1
    buffer_load_dwordx4 v[180:183], v6, s[20:23], 0 offen offset:2304 sc1
    s_barrier
    ds_read_b64_tr_b16 v[128:129], v24 offset:0
    ds_read_b64_tr_b16 v[130:131], v24 offset:512
    ds_read_b64_tr_b16 v[132:133], v25 offset:0
    ds_read_b64_tr_b16 v[134:135], v25 offset:512
    ds_read_b64_tr_b16 v[136:137], v24 offset:8192
    ds_read_b64_tr_b16 v[138:139], v24 offset:8704
    ds_read_b64_tr_b16 v[140:141], v25 offset:8192
    ds_read_b64_tr_b16 v[142:143], v25 offset:8704
    ds_read_b64_tr_b16 v[144:145], v24 offset:16384
    ds_read_b64_tr_b16 v[146:147], v24 offset:16896
    buffer_load_dwordx4 a[0:3], v6, s[16:19], s54 offen offset:0 sc1
    buffer_load_dwordx4 a[4:7], v6, s[16:19], s54 offen offset:256 sc1
    buffer_load_dwordx4 a[8:11], v6, s[20:23], s54 offen offset:0 sc1
    buffer_load_dwordx4 a[12:15], v6, s[20:23], s54 offen offset:256 sc1
    buffer_load_dwordx4 a[16:19], v6, s[16:19], s54 offen offset:2048 sc1
    buffer_load_dwordx4 a[20:23], v6, s[16:19], s54 offen offset:2304 sc1
    s_mov_b32 s54, 7
.p2align 3
c_qkvA_loop:
    s_waitcnt vmcnt(12) lgkmcnt(8)
    v_mfma_f32_16x16x32_bf16 v[184:187], v[188:191], v[192:195], v[184:187]
    v_mfma_f32_16x16x32_bf16 v[32:35], v[128:131], v[152:155], v[32:35]
    ds_read_b64_tr_b16 v[148:149], v25 offset:16384
    buffer_load_dwordx4 a[24:27], v6, s[20:23], s58 offen offset:0 sc1
    v_mfma_f32_16x16x32_bf16 v[36:39], v[128:131], v[156:159], v[36:39]
    ds_read_b64_tr_b16 v[150:151], v25 offset:16896
    s_waitcnt lgkmcnt(8)
    v_mfma_f32_16x16x32_bf16 v[52:55], v[132:135], v[156:159], v[52:55]
    v_mfma_f32_16x16x32_bf16 v[48:51], v[132:135], v[152:155], v[48:51]
    ds_read_b64_tr_b16 v[188:189], v28 offset:0
    s_waitcnt lgkmcnt(7)
    v_mfma_f32_16x16x32_bf16 v[64:67], v[136:139], v[152:155], v[64:67]
    v_mfma_f32_16x16x32_bf16 v[68:71], v[136:139], v[156:159], v[68:71]
    ds_read_b64_tr_b16 v[190:191], v28 offset:512
    s_waitcnt lgkmcnt(6)
    v_mfma_f32_16x16x32_bf16 v[84:87], v[140:143], v[156:159], v[84:87]
    buffer_load_dwordx4 a[28:31], v6, s[20:23], s58 offen offset:256 sc1
    v_mfma_f32_16x16x32_bf16 v[80:83], v[140:143], v[152:155], v[80:83]
    ds_read_b128 v[192:195], v30 offset:0
    s_waitcnt lgkmcnt(5)
    v_mfma_f32_16x16x32_bf16 v[96:99], v[152:155], v[144:147], v[96:99]
    v_mfma_f32_16x16x32_bf16 v[100:103], v[156:159], v[144:147], v[100:103]
    s_waitcnt lgkmcnt(3)
    v_mfma_f32_16x16x32_bf16 v[116:119], v[156:159], v[148:151], v[116:119]
    v_mfma_f32_16x16x32_bf16 v[112:115], v[152:155], v[148:151], v[112:115]
    s_waitcnt vmcnt(12)
    v_mfma_f32_16x16x32_bf16 v[40:43], v[128:131], v[160:163], v[40:43]
    buffer_load_dwordx4 v[152:155], v6, s[16:19], s50 offen offset:0 sc1
    v_mfma_f32_16x16x32_bf16 v[44:47], v[128:131], v[164:167], v[44:47]
    v_mfma_f32_16x16x32_bf16 v[60:63], v[132:135], v[164:167], v[60:63]
    ds_read_b64_tr_b16 v[128:129], v24 offset:2048
    v_mfma_f32_16x16x32_bf16 v[56:59], v[132:135], v[160:163], v[56:59]
    ds_read_b64_tr_b16 v[130:131], v24 offset:2560
    v_mfma_f32_16x16x32_bf16 v[72:75], v[136:139], v[160:163], v[72:75]
    ds_read_b64_tr_b16 v[132:133], v25 offset:2048
    v_mfma_f32_16x16x32_bf16 v[76:79], v[136:139], v[164:167], v[76:79]
    ds_read_b64_tr_b16 v[134:135], v25 offset:2560
    v_mfma_f32_16x16x32_bf16 v[92:95], v[140:143], v[164:167], v[92:95]
    ds_read_b64_tr_b16 v[136:137], v24 offset:10240
    buffer_load_dwordx4 v[156:159], v6, s[16:19], s50 offen offset:256 sc1
    v_mfma_f32_16x16x32_bf16 v[88:91], v[140:143], v[160:163], v[88:91]
    ds_read_b64_tr_b16 v[138:139], v24 offset:10752
    v_mfma_f32_16x16x32_bf16 v[104:107], v[160:163], v[144:147], v[104:107]
    ds_read_b64_tr_b16 v[140:141], v25 offset:10240
    v_mfma_f32_16x16x32_bf16 v[108:111], v[164:167], v[144:147], v[108:111]
    ds_read_b64_tr_b16 v[142:143], v25 offset:10752
    v_mfma_f32_16x16x32_bf16 v[124:127], v[164:167], v[148:151], v[124:127]
    ds_read_b64_tr_b16 v[144:145], v24 offset:18432
    v_mfma_f32_16x16x32_bf16 v[120:123], v[160:163], v[148:151], v[120:123]
    ds_read_b64_tr_b16 v[146:147], v24 offset:18944
    s_waitcnt vmcnt(12) lgkmcnt(8)
    v_mfma_f32_16x16x32_bf16 v[184:187], v[188:191], v[192:195], v[184:187]
    v_mfma_f32_16x16x32_bf16 v[32:35], v[128:131], v[168:171], v[32:35]
    ds_read_b64_tr_b16 v[148:149], v25 offset:18432
    buffer_load_dwordx4 v[160:163], v6, s[20:23], s58 offen offset:2048 sc1
    v_mfma_f32_16x16x32_bf16 v[36:39], v[128:131], v[172:175], v[36:39]
    ds_read_b64_tr_b16 v[150:151], v25 offset:18944
    s_waitcnt lgkmcnt(8)
    v_mfma_f32_16x16x32_bf16 v[52:55], v[132:135], v[172:175], v[52:55]
    v_mfma_f32_16x16x32_bf16 v[48:51], v[132:135], v[168:171], v[48:51]
    ds_read_b64_tr_b16 v[188:189], v28 offset:2048
    s_waitcnt lgkmcnt(7)
    v_mfma_f32_16x16x32_bf16 v[64:67], v[136:139], v[168:171], v[64:67]
    v_mfma_f32_16x16x32_bf16 v[68:71], v[136:139], v[172:175], v[68:71]
    ds_read_b64_tr_b16 v[190:191], v28 offset:2560
    s_waitcnt lgkmcnt(6)
    v_mfma_f32_16x16x32_bf16 v[84:87], v[140:143], v[172:175], v[84:87]
    buffer_load_dwordx4 v[164:167], v6, s[20:23], s58 offen offset:2304 sc1
    v_mfma_f32_16x16x32_bf16 v[80:83], v[140:143], v[168:171], v[80:83]
    ds_read_b128 v[192:195], v30 offset:1024
    s_waitcnt lgkmcnt(5)
    v_mfma_f32_16x16x32_bf16 v[96:99], v[168:171], v[144:147], v[96:99]
    v_mfma_f32_16x16x32_bf16 v[100:103], v[172:175], v[144:147], v[100:103]
    s_waitcnt lgkmcnt(3)
    v_mfma_f32_16x16x32_bf16 v[116:119], v[172:175], v[148:151], v[116:119]
    v_mfma_f32_16x16x32_bf16 v[112:115], v[168:171], v[148:151], v[112:115]
    s_waitcnt vmcnt(12)
    v_mfma_f32_16x16x32_bf16 v[40:43], v[128:131], v[176:179], v[40:43]
    buffer_load_dwordx4 v[168:171], v6, s[16:19], s50 offen offset:2048 sc1
    v_mfma_f32_16x16x32_bf16 v[44:47], v[128:131], v[180:183], v[44:47]
    v_mfma_f32_16x16x32_bf16 v[60:63], v[132:135], v[180:183], v[60:63]
    ds_read_b64_tr_b16 v[128:129], v24 offset:4096
    v_mfma_f32_16x16x32_bf16 v[56:59], v[132:135], v[176:179], v[56:59]
    ds_read_b64_tr_b16 v[130:131], v24 offset:4608
    v_mfma_f32_16x16x32_bf16 v[72:75], v[136:139], v[176:179], v[72:75]
    ds_read_b64_tr_b16 v[132:133], v25 offset:4096
    v_mfma_f32_16x16x32_bf16 v[76:79], v[136:139], v[180:183], v[76:79]
    ds_read_b64_tr_b16 v[134:135], v25 offset:4608
    v_mfma_f32_16x16x32_bf16 v[92:95], v[140:143], v[180:183], v[92:95]
    ds_read_b64_tr_b16 v[136:137], v24 offset:12288
    buffer_load_dwordx4 v[172:175], v6, s[16:19], s50 offen offset:2304 sc1
    v_mfma_f32_16x16x32_bf16 v[88:91], v[140:143], v[176:179], v[88:91]
    ds_read_b64_tr_b16 v[138:139], v24 offset:12800
    v_mfma_f32_16x16x32_bf16 v[104:107], v[176:179], v[144:147], v[104:107]
    ds_read_b64_tr_b16 v[140:141], v25 offset:12288
    v_mfma_f32_16x16x32_bf16 v[108:111], v[180:183], v[144:147], v[108:111]
    ds_read_b64_tr_b16 v[142:143], v25 offset:12800
    v_mfma_f32_16x16x32_bf16 v[124:127], v[180:183], v[148:151], v[124:127]
    ds_read_b64_tr_b16 v[144:145], v24 offset:20480
    v_mfma_f32_16x16x32_bf16 v[120:123], v[176:179], v[148:151], v[120:123]
    ds_read_b64_tr_b16 v[146:147], v24 offset:20992
    s_waitcnt vmcnt(12) lgkmcnt(8)
    v_mfma_f32_16x16x32_bf16 v[184:187], v[188:191], v[192:195], v[184:187]
    v_mfma_f32_16x16x32_bf16 v[32:35], v[128:131], a[0:3], v[32:35]
    ds_read_b64_tr_b16 v[148:149], v25 offset:20480
    buffer_load_dwordx4 v[176:179], v6, s[20:23], s59 offen offset:0 sc1
    v_mfma_f32_16x16x32_bf16 v[36:39], v[128:131], a[4:7], v[36:39]
    ds_read_b64_tr_b16 v[150:151], v25 offset:20992
    s_waitcnt lgkmcnt(8)
    v_mfma_f32_16x16x32_bf16 v[52:55], v[132:135], a[4:7], v[52:55]
    s_add_u32 s58, s58, 8192
    v_mfma_f32_16x16x32_bf16 v[48:51], v[132:135], a[0:3], v[48:51]
    ds_read_b64_tr_b16 v[188:189], v28 offset:4096
    s_waitcnt lgkmcnt(7)
    v_mfma_f32_16x16x32_bf16 v[64:67], v[136:139], a[0:3], v[64:67]
    s_add_u32 s50, s50, 8192
    v_mfma_f32_16x16x32_bf16 v[68:71], v[136:139], a[4:7], v[68:71]
    ds_read_b64_tr_b16 v[190:191], v28 offset:4608
    s_waitcnt lgkmcnt(6)
    v_mfma_f32_16x16x32_bf16 v[84:87], v[140:143], a[4:7], v[84:87]
    buffer_load_dwordx4 v[180:183], v6, s[20:23], s59 offen offset:256 sc1
    v_mfma_f32_16x16x32_bf16 v[80:83], v[140:143], a[0:3], v[80:83]
    ds_read_b128 v[192:195], v30 offset:2048
    s_waitcnt lgkmcnt(5)
    v_mfma_f32_16x16x32_bf16 v[96:99], a[0:3], v[144:147], v[96:99]
    s_add_u32 s52, s52, 24576
    v_mfma_f32_16x16x32_bf16 v[100:103], a[4:7], v[144:147], v[100:103]
    s_cmp_eq_u32 s52, 147456
    s_waitcnt lgkmcnt(3)
    v_mfma_f32_16x16x32_bf16 v[116:119], a[4:7], v[148:151], v[116:119]
    s_cselect_b32 s52, 0, s52
    v_mfma_f32_16x16x32_bf16 v[112:115], a[0:3], v[148:151], v[112:115]
    s_waitcnt vmcnt(12)
    v_mfma_f32_16x16x32_bf16 v[40:43], v[128:131], a[8:11], v[40:43]
    buffer_load_dwordx4 a[0:3], v6, s[16:19], s51 offen offset:0 sc1
    v_mfma_f32_16x16x32_bf16 v[44:47], v[128:131], a[12:15], v[44:47]
    s_sub_u32 s54, s54, 1
    v_mfma_f32_16x16x32_bf16 v[60:63], v[132:135], a[12:15], v[60:63]
    ds_read_b64_tr_b16 v[128:129], v24 offset:6144
    v_mfma_f32_16x16x32_bf16 v[56:59], v[132:135], a[8:11], v[56:59]
    ds_read_b64_tr_b16 v[130:131], v24 offset:6656
    v_mfma_f32_16x16x32_bf16 v[72:75], v[136:139], a[8:11], v[72:75]
    ds_read_b64_tr_b16 v[132:133], v25 offset:6144
    v_mfma_f32_16x16x32_bf16 v[76:79], v[136:139], a[12:15], v[76:79]
    ds_read_b64_tr_b16 v[134:135], v25 offset:6656
    v_mfma_f32_16x16x32_bf16 v[92:95], v[140:143], a[12:15], v[92:95]
    ds_read_b64_tr_b16 v[136:137], v24 offset:14336
    buffer_load_dwordx4 a[4:7], v6, s[16:19], s51 offen offset:256 sc1
    v_mfma_f32_16x16x32_bf16 v[88:91], v[140:143], a[8:11], v[88:91]
    ds_read_b64_tr_b16 v[138:139], v24 offset:14848
    v_mfma_f32_16x16x32_bf16 v[104:107], a[8:11], v[144:147], v[104:107]
    ds_read_b64_tr_b16 v[140:141], v25 offset:14336
    v_mfma_f32_16x16x32_bf16 v[108:111], a[12:15], v[144:147], v[108:111]
    ds_read_b64_tr_b16 v[142:143], v25 offset:14848
    v_mfma_f32_16x16x32_bf16 v[124:127], a[12:15], v[148:151], v[124:127]
    ds_read_b64_tr_b16 v[144:145], v24 offset:22528
    v_mfma_f32_16x16x32_bf16 v[120:123], a[8:11], v[148:151], v[120:123]
    ds_read_b64_tr_b16 v[146:147], v24 offset:23040
    s_waitcnt vmcnt(12) lgkmcnt(8)
    v_mfma_f32_16x16x32_bf16 v[184:187], v[188:191], v[192:195], v[184:187]
    v_mfma_f32_16x16x32_bf16 v[32:35], v[128:131], a[16:19], v[32:35]
    ds_read_b64_tr_b16 v[148:149], v25 offset:22528
    buffer_load_dwordx4 a[8:11], v6, s[20:23], s59 offen offset:2048 sc1
    v_mfma_f32_16x16x32_bf16 v[36:39], v[128:131], a[20:23], v[36:39]
    ds_read_b64_tr_b16 v[150:151], v25 offset:23040
    s_waitcnt lgkmcnt(8)
    v_mfma_f32_16x16x32_bf16 v[52:55], v[132:135], a[20:23], v[52:55]
    v_add_u32 v24, s52, v26
    v_mfma_f32_16x16x32_bf16 v[48:51], v[132:135], a[16:19], v[48:51]
    ds_read_b64_tr_b16 v[188:189], v28 offset:6144
    s_waitcnt lgkmcnt(7)
    v_mfma_f32_16x16x32_bf16 v[64:67], v[136:139], a[16:19], v[64:67]
    v_add_u32 v25, s52, v27
    v_mfma_f32_16x16x32_bf16 v[68:71], v[136:139], a[20:23], v[68:71]
    ds_read_b64_tr_b16 v[190:191], v28 offset:6656
    s_waitcnt lgkmcnt(6)
    v_mfma_f32_16x16x32_bf16 v[84:87], v[140:143], a[20:23], v[84:87]
    buffer_load_dwordx4 a[12:15], v6, s[20:23], s59 offen offset:2304 sc1
    v_mfma_f32_16x16x32_bf16 v[80:83], v[140:143], a[16:19], v[80:83]
    ds_read_b128 v[192:195], v30 offset:3072
    s_waitcnt lgkmcnt(5)
    v_mfma_f32_16x16x32_bf16 v[96:99], a[16:19], v[144:147], v[96:99]
    s_add_u32 s59, s59, 8192
    v_mfma_f32_16x16x32_bf16 v[100:103], a[20:23], v[144:147], v[100:103]
    v_add_u32 v28, s52, v29
    s_waitcnt lgkmcnt(3)
    v_mfma_f32_16x16x32_bf16 v[116:119], a[20:23], v[148:151], v[116:119]
    s_waitcnt lgkmcnt(0)
    v_mfma_f32_16x16x32_bf16 v[112:115], a[16:19], v[148:151], v[112:115]
    s_barrier
    s_waitcnt vmcnt(12)
    v_mfma_f32_16x16x32_bf16 v[40:43], v[128:131], a[24:27], v[40:43]
    buffer_load_dwordx4 a[16:19], v6, s[16:19], s51 offen offset:2048 sc1
    v_mfma_f32_16x16x32_bf16 v[44:47], v[128:131], a[28:31], v[44:47]
    v_xor_b32 v30, 4096, v30
    v_mfma_f32_16x16x32_bf16 v[60:63], v[132:135], a[28:31], v[60:63]
    ds_read_b64_tr_b16 v[128:129], v24 offset:0
    v_mfma_f32_16x16x32_bf16 v[56:59], v[132:135], a[24:27], v[56:59]
    ds_read_b64_tr_b16 v[130:131], v24 offset:512
    v_mfma_f32_16x16x32_bf16 v[72:75], v[136:139], a[24:27], v[72:75]
    ds_read_b64_tr_b16 v[132:133], v25 offset:0
    v_mfma_f32_16x16x32_bf16 v[76:79], v[136:139], a[28:31], v[76:79]
    ds_read_b64_tr_b16 v[134:135], v25 offset:512
    v_mfma_f32_16x16x32_bf16 v[92:95], v[140:143], a[28:31], v[92:95]
    ds_read_b64_tr_b16 v[136:137], v24 offset:8192
    buffer_load_dwordx4 a[20:23], v6, s[16:19], s51 offen offset:2304 sc1
    v_mfma_f32_16x16x32_bf16 v[88:91], v[140:143], a[24:27], v[88:91]
    ds_read_b64_tr_b16 v[138:139], v24 offset:8704
    v_mfma_f32_16x16x32_bf16 v[104:107], a[24:27], v[144:147], v[104:107]
    ds_read_b64_tr_b16 v[140:141], v25 offset:8192
    s_add_u32 s51, s51, 8192
    v_mfma_f32_16x16x32_bf16 v[108:111], a[28:31], v[144:147], v[108:111]
    ds_read_b64_tr_b16 v[142:143], v25 offset:8704
    v_mfma_f32_16x16x32_bf16 v[124:127], a[28:31], v[148:151], v[124:127]
    ds_read_b64_tr_b16 v[144:145], v24 offset:16384
    s_cmp_lg_u32 s54, 0
    v_mfma_f32_16x16x32_bf16 v[120:123], a[24:27], v[148:151], v[120:123]
    ds_read_b64_tr_b16 v[146:147], v24 offset:16896
    s_cbranch_scc1 c_qkvA_loop
    s_waitcnt vmcnt(12) lgkmcnt(8)
    v_mfma_f32_16x16x32_bf16 v[184:187], v[188:191], v[192:195], v[184:187]
    v_mfma_f32_16x16x32_bf16 v[32:35], v[128:131], v[152:155], v[32:35]
    ds_read_b64_tr_b16 v[148:149], v25 offset:16384
    buffer_load_dwordx4 a[24:27], v6, s[20:23], s58 offen offset:0 sc1
    v_mfma_f32_16x16x32_bf16 v[36:39], v[128:131], v[156:159], v[36:39]
    ds_read_b64_tr_b16 v[150:151], v25 offset:16896
    s_waitcnt lgkmcnt(8)
    v_mfma_f32_16x16x32_bf16 v[52:55], v[132:135], v[156:159], v[52:55]
    ds_read_b32 v16, v8 offset:1280
    v_mfma_f32_16x16x32_bf16 v[48:51], v[132:135], v[152:155], v[48:51]
    ds_read_b64_tr_b16 v[188:189], v28 offset:0
    ds_read_b32 v18, v8 offset:1344
    s_waitcnt lgkmcnt(9)
    v_mfma_f32_16x16x32_bf16 v[64:67], v[136:139], v[152:155], v[64:67]
    ds_read_b32 v20, v8 offset:1408
    v_mfma_f32_16x16x32_bf16 v[68:71], v[136:139], v[156:159], v[68:71]
    ds_read_b64_tr_b16 v[190:191], v28 offset:512
    s_waitcnt lgkmcnt(9)
    v_mfma_f32_16x16x32_bf16 v[84:87], v[140:143], v[156:159], v[84:87]
    buffer_load_dwordx4 a[28:31], v6, s[20:23], s58 offen offset:256 sc1
    ds_read_b32 v22, v8 offset:1472
    v_mfma_f32_16x16x32_bf16 v[80:83], v[140:143], v[152:155], v[80:83]
    ds_read_b128 v[192:195], v30 offset:0
    ds_read_b128 v[212:215], v10 offset:128
    s_waitcnt lgkmcnt(10)
    v_mfma_f32_16x16x32_bf16 v[96:99], v[152:155], v[144:147], v[96:99]
    ds_read_b128 v[216:219], v10 offset:192
    v_mfma_f32_16x16x32_bf16 v[100:103], v[156:159], v[144:147], v[100:103]
    s_waitcnt lgkmcnt(9)
    v_mfma_f32_16x16x32_bf16 v[116:119], v[156:159], v[148:151], v[116:119]
    v_mfma_f32_16x16x32_bf16 v[112:115], v[152:155], v[148:151], v[112:115]
    s_waitcnt vmcnt(12)
    v_mfma_f32_16x16x32_bf16 v[40:43], v[128:131], v[160:163], v[40:43]
    s_waitcnt lgkmcnt(0)
    v_fma_f32 v64, -v16, v212, v64
    v_fma_f32 v65, -v16, v213, v65
    v_mfma_f32_16x16x32_bf16 v[44:47], v[128:131], v[164:167], v[44:47]
    v_fma_f32 v66, -v16, v214, v66
    v_mfma_f32_16x16x32_bf16 v[60:63], v[132:135], v[164:167], v[60:63]
    ds_read_b64_tr_b16 v[128:129], v24 offset:2048
    v_fma_f32 v67, -v16, v215, v67
    v_mfma_f32_16x16x32_bf16 v[56:59], v[132:135], v[160:163], v[56:59]
    ds_read_b64_tr_b16 v[130:131], v24 offset:2560
    v_fma_f32 v68, -v18, v212, v68
    v_fma_f32 v69, -v18, v213, v69
    v_mfma_f32_16x16x32_bf16 v[72:75], v[136:139], v[160:163], v[72:75]
    ds_read_b64_tr_b16 v[132:133], v25 offset:2048
    v_fma_f32 v70, -v18, v214, v70
    v_mfma_f32_16x16x32_bf16 v[76:79], v[136:139], v[164:167], v[76:79]
    ds_read_b64_tr_b16 v[134:135], v25 offset:2560
    v_fma_f32 v71, -v18, v215, v71
    v_mfma_f32_16x16x32_bf16 v[92:95], v[140:143], v[164:167], v[92:95]
    ds_read_b64_tr_b16 v[136:137], v24 offset:10240
    v_fma_f32 v80, -v16, v216, v80
    v_fma_f32 v81, -v16, v217, v81
    v_mfma_f32_16x16x32_bf16 v[88:91], v[140:143], v[160:163], v[88:91]
    ds_read_b64_tr_b16 v[138:139], v24 offset:10752
    v_fma_f32 v82, -v16, v218, v82
    v_mfma_f32_16x16x32_bf16 v[104:107], v[160:163], v[144:147], v[104:107]
    ds_read_b64_tr_b16 v[140:141], v25 offset:10240
    v_fma_f32 v83, -v16, v219, v83
    v_mfma_f32_16x16x32_bf16 v[108:111], v[164:167], v[144:147], v[108:111]
    ds_read_b64_tr_b16 v[142:143], v25 offset:10752
    v_fma_f32 v84, -v18, v216, v84
    v_fma_f32 v85, -v18, v217, v85
    v_mfma_f32_16x16x32_bf16 v[124:127], v[164:167], v[148:151], v[124:127]
    ds_read_b64_tr_b16 v[144:145], v24 offset:18432
    v_fma_f32 v86, -v18, v218, v86
    v_mfma_f32_16x16x32_bf16 v[120:123], v[160:163], v[148:151], v[120:123]
    ds_read_b64_tr_b16 v[146:147], v24 offset:18944
    v_fma_f32 v87, -v18, v219, v87
    s_waitcnt vmcnt(10) lgkmcnt(8)
    v_mfma_f32_16x16x32_bf16 v[184:187], v[188:191], v[192:195], v[184:187]
    v_mfma_f32_16x16x32_bf16 v[32:35], v[128:131], v[168:171], v[32:35]
    ds_read_b64_tr_b16 v[148:149], v25 offset:18432
    v_fma_f32 v72, -v20, v212, v72
    v_fma_f32 v73, -v20, v213, v73
    v_mfma_f32_16x16x32_bf16 v[36:39], v[128:131], v[172:175], v[36:39]
    ds_read_b64_tr_b16 v[150:151], v25 offset:18944
    v_fma_f32 v74, -v20, v214, v74
    s_waitcnt lgkmcnt(8)
    v_mfma_f32_16x16x32_bf16 v[52:55], v[132:135], v[172:175], v[52:55]
    v_fma_f32 v75, -v20, v215, v75
    ds_read_b128 v[152:155], v10 offset:0
    v_mfma_f32_16x16x32_bf16 v[48:51], v[132:135], v[168:171], v[48:51]
    ds_read_b64_tr_b16 v[188:189], v28 offset:2048
    v_fma_f32 v76, -v22, v212, v76
    v_fma_f32 v77, -v22, v213, v77
    ds_read_b128 v[156:159], v10 offset:64
    s_waitcnt lgkmcnt(9)
    v_mfma_f32_16x16x32_bf16 v[64:67], v[136:139], v[168:171], v[64:67]
    v_fma_f32 v78, -v22, v214, v78
    ds_read_b32 v17, v8 offset:2816
    v_mfma_f32_16x16x32_bf16 v[68:71], v[136:139], v[172:175], v[68:71]
    ds_read_b64_tr_b16 v[190:191], v28 offset:2560
    v_fma_f32 v79, -v22, v215, v79
    s_waitcnt lgkmcnt(9)
    v_mfma_f32_16x16x32_bf16 v[84:87], v[140:143], v[172:175], v[84:87]
    v_fma_f32 v88, -v20, v216, v88
    v_fma_f32 v89, -v20, v217, v89
    ds_read_b32 v19, v8 offset:2880
    v_mfma_f32_16x16x32_bf16 v[80:83], v[140:143], v[168:171], v[80:83]
    ds_read_b128 v[192:195], v30 offset:1024
    v_fma_f32 v90, -v20, v218, v90
    ds_read_b32 v21, v8 offset:2944
    s_waitcnt lgkmcnt(10)
    v_mfma_f32_16x16x32_bf16 v[96:99], v[168:171], v[144:147], v[96:99]
    v_fma_f32 v91, -v20, v219, v91
    ds_read_b32 v23, v8 offset:3008
    v_mfma_f32_16x16x32_bf16 v[100:103], v[172:175], v[144:147], v[100:103]
    v_fma_f32 v92, -v22, v216, v92
    v_fma_f32 v93, -v22, v217, v93
    s_waitcnt lgkmcnt(9)
    v_mfma_f32_16x16x32_bf16 v[116:119], v[172:175], v[148:151], v[116:119]
    v_fma_f32 v94, -v22, v218, v94
    v_mfma_f32_16x16x32_bf16 v[112:115], v[168:171], v[148:151], v[112:115]
    v_fma_f32 v95, -v22, v219, v95
    s_waitcnt vmcnt(8)
    v_mfma_f32_16x16x32_bf16 v[40:43], v[128:131], v[176:179], v[40:43]
    s_waitcnt lgkmcnt(0)
    v_fma_f32 v32, -v16, v152, v32
    v_fma_f32 v33, -v16, v153, v33
    v_mfma_f32_16x16x32_bf16 v[44:47], v[128:131], v[180:183], v[44:47]
    v_fma_f32 v34, -v16, v154, v34
    v_mfma_f32_16x16x32_bf16 v[60:63], v[132:135], v[180:183], v[60:63]
    ds_read_b64_tr_b16 v[128:129], v24 offset:4096
    v_fma_f32 v35, -v16, v155, v35
    v_fma_f32 v36, -v18, v152, v36
    v_mfma_f32_16x16x32_bf16 v[56:59], v[132:135], v[176:179], v[56:59]
    ds_read_b64_tr_b16 v[130:131], v24 offset:4608
    v_fma_f32 v37, -v18, v153, v37
    v_mfma_f32_16x16x32_bf16 v[72:75], v[136:139], v[176:179], v[72:75]
    ds_read_b64_tr_b16 v[132:133], v25 offset:4096
    v_fma_f32 v38, -v18, v154, v38
    v_fma_f32 v39, -v18, v155, v39
    v_mfma_f32_16x16x32_bf16 v[76:79], v[136:139], v[180:183], v[76:79]
    ds_read_b64_tr_b16 v[134:135], v25 offset:4608
    v_fma_f32 v48, -v16, v156, v48
    v_mfma_f32_16x16x32_bf16 v[92:95], v[140:143], v[180:183], v[92:95]
    ds_read_b64_tr_b16 v[136:137], v24 offset:12288
    v_fma_f32 v49, -v16, v157, v49
    v_fma_f32 v50, -v16, v158, v50
    v_mfma_f32_16x16x32_bf16 v[88:91], v[140:143], v[176:179], v[88:91]
    ds_read_b64_tr_b16 v[138:139], v24 offset:12800
    v_fma_f32 v51, -v16, v159, v51
    v_mfma_f32_16x16x32_bf16 v[104:107], v[176:179], v[144:147], v[104:107]
    ds_read_b64_tr_b16 v[140:141], v25 offset:12288
    v_fma_f32 v52, -v18, v156, v52
    v_fma_f32 v53, -v18, v157, v53
    v_mfma_f32_16x16x32_bf16 v[108:111], v[180:183], v[144:147], v[108:111]
    ds_read_b64_tr_b16 v[142:143], v25 offset:12800
    v_fma_f32 v54, -v18, v158, v54
    v_mfma_f32_16x16x32_bf16 v[124:127], v[180:183], v[148:151], v[124:127]
    ds_read_b64_tr_b16 v[144:145], v24 offset:20480
    v_fma_f32 v55, -v18, v159, v55
    v_mfma_f32_16x16x32_bf16 v[120:123], v[176:179], v[148:151], v[120:123]
    ds_read_b64_tr_b16 v[146:147], v24 offset:20992
    s_waitcnt vmcnt(6) lgkmcnt(8)
    v_mfma_f32_16x16x32_bf16 v[184:187], v[188:191], v[192:195], v[184:187]
    v_mfma_f32_16x16x32_bf16 v[32:35], v[128:131], a[0:3], v[32:35]
    ds_read_b64_tr_b16 v[148:149], v25 offset:20480
    v_fma_f32 v40, -v20, v152, v40
    v_fma_f32 v41, -v20, v153, v41
    v_mfma_f32_16x16x32_bf16 v[36:39], v[128:131], a[4:7], v[36:39]
    ds_read_b64_tr_b16 v[150:151], v25 offset:20992
    v_fma_f32 v42, -v20, v154, v42
    s_waitcnt lgkmcnt(8)
    v_mfma_f32_16x16x32_bf16 v[52:55], v[132:135], a[4:7], v[52:55]
    v_fma_f32 v43, -v20, v155, v43
    v_fma_f32 v44, -v22, v152, v44
    ds_read_b128 v[168:171], v9 offset:1280
    v_mfma_f32_16x16x32_bf16 v[48:51], v[132:135], a[0:3], v[48:51]
    ds_read_b64_tr_b16 v[188:189], v28 offset:4096
    v_fma_f32 v45, -v22, v153, v45
    ds_read_b128 v[172:175], v9 offset:1344
    s_waitcnt lgkmcnt(9)
    v_mfma_f32_16x16x32_bf16 v[64:67], v[136:139], a[0:3], v[64:67]
    v_fma_f32 v46, -v22, v154, v46
    v_fma_f32 v47, -v22, v155, v47
    v_mfma_f32_16x16x32_bf16 v[68:71], v[136:139], a[4:7], v[68:71]
    ds_read_b64_tr_b16 v[190:191], v28 offset:4608
    v_fma_f32 v56, -v20, v156, v56
    ds_read_b128 v[176:179], v9 offset:1408
    s_waitcnt lgkmcnt(9)
    v_mfma_f32_16x16x32_bf16 v[84:87], v[140:143], a[4:7], v[84:87]
    v_fma_f32 v57, -v20, v157, v57
    v_fma_f32 v58, -v20, v158, v58
    ds_read_b128 v[180:183], v9 offset:1472
    v_mfma_f32_16x16x32_bf16 v[80:83], v[140:143], a[0:3], v[80:83]
    ds_read_b128 v[192:195], v30 offset:2048
    v_fma_f32 v59, -v20, v159, v59
    s_waitcnt lgkmcnt(9)
    v_mfma_f32_16x16x32_bf16 v[96:99], a[0:3], v[144:147], v[96:99]
    v_fma_f32 v60, -v22, v156, v60
    v_fma_f32 v61, -v22, v157, v61
    ds_read2_b32 v[220:221], v11 offset0:64 offset1:80
    v_mfma_f32_16x16x32_bf16 v[100:103], a[4:7], v[144:147], v[100:103]
    v_fma_f32 v62, -v22, v158, v62
    s_waitcnt lgkmcnt(8)
    v_mfma_f32_16x16x32_bf16 v[116:119], a[4:7], v[148:151], v[116:119]
    v_fma_f32 v63, -v22, v159, v63
    v_mfma_f32_16x16x32_bf16 v[112:115], a[0:3], v[148:151], v[112:115]
    s_waitcnt vmcnt(4)
    v_mfma_f32_16x16x32_bf16 v[40:43], v[128:131], a[8:11], v[40:43]
    v_mfma_f32_16x16x32_bf16 v[44:47], v[128:131], a[12:15], v[44:47]
    s_waitcnt lgkmcnt(0)
    v_fma_f32 v96, -v168, v220, v96
    v_fma_f32 v97, -v169, v220, v97
    v_mfma_f32_16x16x32_bf16 v[60:63], v[132:135], a[12:15], v[60:63]
    ds_read_b64_tr_b16 v[128:129], v24 offset:6144
    v_fma_f32 v98, -v170, v220, v98
    v_mfma_f32_16x16x32_bf16 v[56:59], v[132:135], a[8:11], v[56:59]
    ds_read_b64_tr_b16 v[130:131], v24 offset:6656
    v_fma_f32 v99, -v171, v220, v99
    v_fma_f32 v100, -v172, v220, v100
    v_mfma_f32_16x16x32_bf16 v[72:75], v[136:139], a[8:11], v[72:75]
    ds_read_b64_tr_b16 v[132:133], v25 offset:6144
    v_fma_f32 v101, -v173, v220, v101
    v_mfma_f32_16x16x32_bf16 v[76:79], v[136:139], a[12:15], v[76:79]
    ds_read_b64_tr_b16 v[134:135], v25 offset:6656
    v_fma_f32 v102, -v174, v220, v102
    v_fma_f32 v103, -v175, v220, v103
    v_mfma_f32_16x16x32_bf16 v[92:95], v[140:143], a[12:15], v[92:95]
    ds_read_b64_tr_b16 v[136:137], v24 offset:14336
    v_fma_f32 v112, -v168, v221, v112
    v_mfma_f32_16x16x32_bf16 v[88:91], v[140:143], a[8:11], v[88:91]
    ds_read_b64_tr_b16 v[138:139], v24 offset:14848
    v_fma_f32 v113, -v169, v221, v113
    v_fma_f32 v114, -v170, v221, v114
    v_mfma_f32_16x16x32_bf16 v[104:107], a[8:11], v[144:147], v[104:107]
    ds_read_b64_tr_b16 v[140:141], v25 offset:14336
    v_fma_f32 v115, -v171, v221, v115
    v_mfma_f32_16x16x32_bf16 v[108:111], a[12:15], v[144:147], v[108:111]
    ds_read_b64_tr_b16 v[142:143], v25 offset:14848
    v_fma_f32 v116, -v172, v221, v116
    v_fma_f32 v117, -v173, v221, v117
    v_mfma_f32_16x16x32_bf16 v[124:127], a[12:15], v[148:151], v[124:127]
    ds_read_b64_tr_b16 v[144:145], v24 offset:22528
    v_fma_f32 v118, -v174, v221, v118
    v_mfma_f32_16x16x32_bf16 v[120:123], a[8:11], v[148:151], v[120:123]
    ds_read_b64_tr_b16 v[146:147], v24 offset:23040
    v_fma_f32 v119, -v175, v221, v119
    s_waitcnt vmcnt(2) lgkmcnt(8)
    v_mfma_f32_16x16x32_bf16 v[184:187], v[188:191], v[192:195], v[184:187]
    v_mfma_f32_16x16x32_bf16 v[32:35], v[128:131], a[16:19], v[32:35]
    ds_read_b64_tr_b16 v[148:149], v25 offset:22528
    v_mfma_f32_16x16x32_bf16 v[36:39], v[128:131], a[20:23], v[36:39]
    ds_read_b64_tr_b16 v[150:151], v25 offset:23040
    v_fma_f32 v104, -v176, v220, v104
    v_fma_f32 v105, -v177, v220, v105
    s_waitcnt lgkmcnt(8)
    v_mfma_f32_16x16x32_bf16 v[52:55], v[132:135], a[20:23], v[52:55]
    v_fma_f32 v106, -v178, v220, v106
    ds_read_b128 v[152:155], v9 offset:2816
    v_mfma_f32_16x16x32_bf16 v[48:51], v[132:135], a[16:19], v[48:51]
    ds_read_b64_tr_b16 v[188:189], v28 offset:6144
    v_fma_f32 v107, -v179, v220, v107
    v_fma_f32 v108, -v180, v220, v108
    ds_read_b128 v[156:159], v9 offset:2880
    s_waitcnt lgkmcnt(9)
    v_mfma_f32_16x16x32_bf16 v[64:67], v[136:139], a[16:19], v[64:67]
    v_fma_f32 v109, -v181, v220, v109
    ds_read_b128 v[160:163], v9 offset:2944
    v_mfma_f32_16x16x32_bf16 v[68:71], v[136:139], a[20:23], v[68:71]
    ds_read_b64_tr_b16 v[190:191], v28 offset:6656
    v_fma_f32 v110, -v182, v220, v110
    v_fma_f32 v111, -v183, v220, v111
    ds_read_b128 v[164:167], v9 offset:3008
    s_waitcnt lgkmcnt(10)
    v_mfma_f32_16x16x32_bf16 v[84:87], v[140:143], a[20:23], v[84:87]
    v_fma_f32 v120, -v176, v221, v120
    ds_read_b128 v[212:215], v14 offset:128
    v_mfma_f32_16x16x32_bf16 v[80:83], v[140:143], a[16:19], v[80:83]
    ds_read_b128 v[192:195], v30 offset:3072
    v_fma_f32 v121, -v177, v221, v121
    v_fma_f32 v122, -v178, v221, v122
    ds_read_b32 v222, v11 offset:1216
    s_waitcnt lgkmcnt(11)
    v_mfma_f32_16x16x32_bf16 v[96:99], a[16:19], v[144:147], v[96:99]
    v_fma_f32 v123, -v179, v221, v123
    ds_read_b32 v223, v11 offset:2752
    v_mfma_f32_16x16x32_bf16 v[100:103], a[20:23], v[144:147], v[100:103]
    v_fma_f32 v124, -v180, v221, v124
    v_fma_f32 v125, -v181, v221, v125
    s_waitcnt lgkmcnt(10)
    v_mfma_f32_16x16x32_bf16 v[116:119], a[20:23], v[148:151], v[116:119]
    v_fma_f32 v126, -v182, v221, v126
    s_waitcnt lgkmcnt(2)
    v_mfma_f32_16x16x32_bf16 v[112:115], a[16:19], v[148:151], v[112:115]
    v_fma_f32 v127, -v183, v221, v127
    s_barrier
    s_waitcnt vmcnt(0)
    v_mfma_f32_16x16x32_bf16 v[40:43], v[128:131], a[24:27], v[40:43]
    v_mul_f32 v64, v17, v64
    v_mul_f32 v65, v17, v65
    v_mfma_f32_16x16x32_bf16 v[44:47], v[128:131], a[28:31], v[44:47]
    v_mul_f32 v66, v17, v66
    v_mul_f32 v67, v17, v67
    v_mfma_f32_16x16x32_bf16 v[60:63], v[132:135], a[28:31], v[60:63]
    v_mul_f32 v80, v17, v80
    v_mul_f32 v81, v17, v81
    v_mfma_f32_16x16x32_bf16 v[56:59], v[132:135], a[24:27], v[56:59]
    v_mul_f32 v82, v17, v82
    v_mul_f32 v83, v17, v83
    v_mfma_f32_16x16x32_bf16 v[72:75], v[136:139], a[24:27], v[72:75]
    v_cvt_pk_bf16_f32 v64, v64, v65
    v_cvt_pk_bf16_f32 v65, v66, v67
    v_mfma_f32_16x16x32_bf16 v[76:79], v[136:139], a[28:31], v[76:79]
    v_cvt_pk_bf16_f32 v66, v80, v81
    v_cvt_pk_bf16_f32 v67, v82, v83
    v_mfma_f32_16x16x32_bf16 v[92:95], v[140:143], a[28:31], v[92:95]
    v_mul_f32 v68, v19, v68
    v_mul_f32 v69, v19, v69
    v_mfma_f32_16x16x32_bf16 v[88:91], v[140:143], a[24:27], v[88:91]
    v_mul_f32 v70, v19, v70
    v_mul_f32 v71, v19, v71
    v_mfma_f32_16x16x32_bf16 v[104:107], a[24:27], v[144:147], v[104:107]
    v_mul_f32 v84, v19, v84
    v_mul_f32 v85, v19, v85
    v_mfma_f32_16x16x32_bf16 v[108:111], a[28:31], v[144:147], v[108:111]
    v_mul_f32 v86, v19, v86
    v_mul_f32 v87, v19, v87
    v_mfma_f32_16x16x32_bf16 v[124:127], a[28:31], v[148:151], v[124:127]
    v_cvt_pk_bf16_f32 v68, v68, v69
    v_cvt_pk_bf16_f32 v69, v70, v71
    v_mfma_f32_16x16x32_bf16 v[120:123], a[24:27], v[148:151], v[120:123]
    v_cvt_pk_bf16_f32 v70, v84, v85
    v_cvt_pk_bf16_f32 v71, v86, v87
    v_mfma_f32_16x16x32_bf16 v[184:187], v[188:191], v[192:195], v[184:187]
    v_pk_mul_f32 v[72:73], v[20:21], v[72:73] op_sel:[1,0] op_sel_hi:[1,1]
    v_pk_mul_f32 v[74:75], v[20:21], v[74:75] op_sel:[1,0] op_sel_hi:[1,1]
    v_pk_mul_f32 v[88:89], v[20:21], v[88:89] op_sel:[1,0] op_sel_hi:[1,1]
    v_pk_mul_f32 v[90:91], v[20:21], v[90:91] op_sel:[1,0] op_sel_hi:[1,1]
    v_cvt_pk_bf16_f32 v72, v72, v73
    v_cvt_pk_bf16_f32 v73, v74, v75
    v_cvt_pk_bf16_f32 v74, v88, v89
    v_cvt_pk_bf16_f32 v75, v90, v91
    v_pk_mul_f32 v[76:77], v[22:23], v[76:77] op_sel:[1,0] op_sel_hi:[1,1]
    v_pk_mul_f32 v[78:79], v[22:23], v[78:79] op_sel:[1,0] op_sel_hi:[1,1]
    v_pk_mul_f32 v[92:93], v[22:23], v[92:93] op_sel:[1,0] op_sel_hi:[1,1]
    v_pk_mul_f32 v[94:95], v[22:23], v[94:95] op_sel:[1,0] op_sel_hi:[1,1]
    v_cvt_pk_bf16_f32 v76, v76, v77
    v_cvt_pk_bf16_f32 v77, v78, v79
    v_cvt_pk_bf16_f32 v78, v92, v93
    v_cvt_pk_bf16_f32 v79, v94, v95
    ds_write_b128 v12, v[76:79] offset:2048
    s_waitcnt lgkmcnt(1)
    v_pk_mul_f32 v[96:97], v[152:153], v[96:97]
    v_pk_mul_f32 v[98:99], v[154:155], v[98:99]
    v_pk_mul_f32 v[112:113], v[152:153], v[112:113]
    v_pk_mul_f32 v[114:115], v[154:155], v[114:115]
    v_cvt_pk_bf16_f32 v99, v98, v99
    v_cvt_pk_bf16_f32 v98, v96, v97
    v_cvt_pk_bf16_f32 v115, v114, v115
    v_cvt_pk_bf16_f32 v114, v112, v113
    v_pk_mul_f32 v[100:101], v[156:157], v[100:101]
    v_pk_mul_f32 v[102:103], v[158:159], v[102:103]
    v_pk_mul_f32 v[116:117], v[156:157], v[116:117]
    v_pk_mul_f32 v[118:119], v[158:159], v[118:119]
    v_cvt_pk_bf16_f32 v100, v100, v101
    v_cvt_pk_bf16_f32 v101, v102, v103
    v_cvt_pk_bf16_f32 v116, v116, v117
    v_cvt_pk_bf16_f32 v117, v118, v119
    v_pk_mul_f32 v[104:105], v[160:161], v[104:105]
    v_pk_mul_f32 v[106:107], v[162:163], v[106:107]
    v_pk_mul_f32 v[120:121], v[160:161], v[120:121]
    v_pk_mul_f32 v[122:123], v[162:163], v[122:123]
    v_cvt_pk_bf16_f32 v102, v104, v105
    v_cvt_pk_bf16_f32 v103, v106, v107
    v_cvt_pk_bf16_f32 v118, v120, v121
    v_cvt_pk_bf16_f32 v119, v122, v123
    v_pk_mul_f32 v[108:109], v[164:165], v[108:109]
    v_pk_mul_f32 v[110:111], v[166:167], v[110:111]
    v_pk_mul_f32 v[124:125], v[164:165], v[124:125]
    v_pk_mul_f32 v[126:127], v[166:167], v[126:127]
    v_cvt_pk_bf16_f32 v104, v108, v109
    v_cvt_pk_bf16_f32 v105, v110, v111
    v_cvt_pk_bf16_f32 v120, v124, v125
    v_cvt_pk_bf16_f32 v121, v126, v127
    ds_write_b64 v12, v[104:105] offset:3072
    ds_write_b64 v12, v[120:121] offset:3080
    v_pk_fma_f32 v[184:185], v[222:223], v[212:213], v[184:185] op_sel_hi:[0,1,1] neg_lo:[1,0,0] neg_hi:[1,0,0]
    v_pk_fma_f32 v[186:187], v[222:223], v[214:215], v[186:187] op_sel_hi:[0,1,1] neg_lo:[1,0,0] neg_hi:[1,0,0]
    v_pk_mul_f32 v[184:185], v[222:223], v[184:185] op_sel:[1,0] op_sel_hi:[1,1]
    v_pk_mul_f32 v[186:187], v[222:223], v[186:187] op_sel:[1,0] op_sel_hi:[1,1]
    v_cvt_pk_bf16_f32 v184, v184, v185
    v_cvt_pk_bf16_f32 v185, v186, v187
    s_cmp_ge_u32 s8, 2
    s_cbranch_scc1 c_qkvA_hv
    ds_write_b64 v13, v[184:185]
    s_branch c_qkvA_hd
c_qkvA_hv:
    ds_write_b16 v13, v184 offset:0
    ds_write_b16_d16_hi v13, v184 offset:16
    ds_write_b16 v13, v185 offset:32
    ds_write_b16_d16_hi v13, v185 offset:48
c_qkvA_hd:
    v_cvt_pk_bf16_f32 v44, v44, v45
    v_cvt_pk_bf16_f32 v45, v46, v47
    v_cvt_pk_bf16_f32 v46, v60, v61
    v_cvt_pk_bf16_f32 v47, v62, v63
    v_mul_f32 v23, 0x3e8293ee, v23
    v_cvt_pk_bf16_f32 v40, v40, v41
    v_mfma_f32_16x16x32_bf16 v[156:159], v[76:79], v[44:47], v[196:199]
    v_cvt_pk_bf16_f32 v41, v42, v43
    v_cvt_pk_bf16_f32 v42, v56, v57
    v_mfma_f32_16x16x32_bf16 v[152:155], v[72:75], v[44:47], v[200:203]
    v_cvt_pk_bf16_f32 v43, v58, v59
    v_mul_f32 v21, 0x3e8293ee, v21
    s_waitcnt lgkmcnt(0)
    s_barrier
    ds_read_b128 v[172:175], v12
    ds_read_b64 v[96:97], v12 offset:1024
    ds_read_b64 v[112:113], v12 offset:1032
    v_mfma_f32_16x16x32_bf16 v[148:151], v[72:75], v[40:43], v[196:199]
    v_cvt_pk_bf16_f32 v36, v36, v37
    v_cvt_pk_bf16_f32 v37, v38, v39
    v_mfma_f32_16x16x32_bf16 v[144:147], v[68:71], v[40:43], v[200:203]
    v_cvt_pk_bf16_f32 v38, v52, v53
    v_cvt_pk_bf16_f32 v39, v54, v55
    v_mul_f32 v19, 0x3e8293ee, v19
    v_cvt_pk_bf16_f32 v32, v32, v33
    v_mfma_f32_16x16x32_bf16 v[140:143], v[68:71], v[36:39], v[196:199]
    v_cvt_pk_bf16_f32 v33, v34, v35
    v_cvt_pk_bf16_f32 v34, v48, v49
    v_mfma_f32_16x16x32_bf16 v[136:139], v[64:67], v[36:39], v[200:203]
    v_cvt_pk_bf16_f32 v35, v50, v51
    v_mul_f32 v17, 0x3e8293ee, v17
    v_max3_f32 v179, v152, v153, v154
    s_waitcnt lgkmcnt(2)
    v_mfma_f32_16x16x32_bf16 v[132:135], v[64:67], v[32:35], v[196:199]
    v_max3_f32 v179, v179, v155, v156
    v_max3_f32 v179, v179, v157, v158
    v_mfma_f32_16x16x32_bf16 v[128:131], v[172:175], v[32:35], v[204:207]
    v_max_f32 v179, v179, v159
    v_mov_b32 v183, v179
    v_max3_f32 v178, v144, v145, v146
    v_max3_f32 v178, v178, v147, v148
    v_max3_f32 v178, v178, v149, v150
    v_max_f32 v178, v178, v151
    v_mov_b32 v182, v178
    v_max3_f32 v177, v136, v137, v138
    v_max3_f32 v177, v177, v139, v140
    v_max3_f32 v177, v177, v141, v142
    v_max_f32 v177, v177, v143
    v_mov_b32 v181, v177
    v_permlane32_swap_b32 v179, v183
    v_permlane32_swap_b32 v178, v182
    v_permlane32_swap_b32 v177, v181
    v_max3_f32 v176, v128, v129, v130
    v_max3_f32 v176, v176, v131, v132
    v_max3_f32 v176, v176, v133, v134
    v_max_f32 v176, v176, v135
    v_mov_b32 v180, v176
    v_max_f32 v179, v179, v183
    v_max_f32 v178, v178, v182
    v_max_f32 v177, v177, v181
    v_permlane32_swap_b32 v176, v180
    v_mov_b32 v183, v179
    v_mov_b32 v182, v178
    v_mov_b32 v181, v177
    v_max_f32 v176, v176, v180
    v_mov_b32 v180, v176
    v_permlane16_swap_b32 v179, v183
    v_permlane16_swap_b32 v178, v182
    v_permlane16_swap_b32 v177, v181
    v_permlane16_swap_b32 v176, v180
    v_max_f32 v179, v179, v183
    v_max_f32 v178, v178, v182
    v_max_f32 v177, v177, v181
    v_max_f32 v176, v176, v180
    v_mul_f32_e64 v22, -v179, v23
    v_mul_f32_e64 v20, -v178, v21
    v_mul_f32_e64 v18, -v177, v19
    v_mul_f32_e64 v16, -v176, v17
    s_waitcnt lgkmcnt(0)
    s_add_u32 s51, s49, 65536
    v_pk_fma_f32 v[152:153], v[152:153], v[22:23], v[22:23] op_sel:[0,1,0] op_sel_hi:[1,1,0]
    v_pk_fma_f32 v[154:155], v[154:155], v[22:23], v[22:23] op_sel:[0,1,0] op_sel_hi:[1,1,0]
    v_pk_fma_f32 v[156:157], v[156:157], v[22:23], v[22:23] op_sel:[0,1,0] op_sel_hi:[1,1,0]
    v_pk_fma_f32 v[158:159], v[158:159], v[22:23], v[22:23] op_sel:[0,1,0] op_sel_hi:[1,1,0]
    v_pk_fma_f32 v[144:145], v[144:145], v[20:21], v[20:21] op_sel:[0,1,0] op_sel_hi:[1,1,0]
    v_pk_fma_f32 v[146:147], v[146:147], v[20:21], v[20:21] op_sel:[0,1,0] op_sel_hi:[1,1,0]
    v_pk_fma_f32 v[148:149], v[148:149], v[20:21], v[20:21] op_sel:[0,1,0] op_sel_hi:[1,1,0]
    v_pk_fma_f32 v[150:151], v[150:151], v[20:21], v[20:21] op_sel:[0,1,0] op_sel_hi:[1,1,0]
    v_pk_fma_f32 v[136:137], v[136:137], v[18:19], v[18:19] op_sel:[0,1,0] op_sel_hi:[1,1,0]
    v_pk_fma_f32 v[138:139], v[138:139], v[18:19], v[18:19] op_sel:[0,1,0] op_sel_hi:[1,1,0]
    v_pk_fma_f32 v[140:141], v[140:141], v[18:19], v[18:19] op_sel:[0,1,0] op_sel_hi:[1,1,0]
    v_pk_fma_f32 v[142:143], v[142:143], v[18:19], v[18:19] op_sel:[0,1,0] op_sel_hi:[1,1,0]
    v_pk_fma_f32 v[128:129], v[128:129], v[16:17], v[16:17] op_sel:[0,1,0] op_sel_hi:[1,1,0]
    v_pk_fma_f32 v[130:131], v[130:131], v[16:17], v[16:17] op_sel:[0,1,0] op_sel_hi:[1,1,0]
    v_pk_fma_f32 v[132:133], v[132:133], v[16:17], v[16:17] op_sel:[0,1,0] op_sel_hi:[1,1,0]
    v_pk_fma_f32 v[134:135], v[134:135], v[16:17], v[16:17] op_sel:[0,1,0] op_sel_hi:[1,1,0]
    v_exp_f32 v152, v152
    v_exp_f32 v153, v153
    v_exp_f32 v154, v154
    v_exp_f32 v155, v155
    v_exp_f32 v156, v156
    v_exp_f32 v157, v157
    v_exp_f32 v158, v158
    v_exp_f32 v159, v159
    v_cvt_pk_bf16_f32 v172, v152, v153
    v_cvt_pk_bf16_f32 v173, v154, v155
    v_cvt_pk_bf16_f32 v174, v156, v157
    v_cvt_pk_bf16_f32 v175, v158, v159
    v_exp_f32 v144, v144
    v_exp_f32 v145, v145
    v_mfma_f32_16x16x32_bf16 v[92:95], v[208:211], v[172:175], 0
    v_exp_f32 v146, v146
    v_mfma_f32_16x16x32_bf16 v[60:63], v[102:105], v[172:175], 0
    v_exp_f32 v147, v147
    v_mfma_f32_16x16x32_bf16 v[76:79], v[118:121], v[172:175], 0
    v_exp_f32 v148, v148
    v_exp_f32 v149, v149
    v_exp_f32 v150, v150
    v_exp_f32 v151, v151
    v_rcp_f32 v92, v92
    v_cvt_pk_bf16_f32 v168, v144, v145
    v_cvt_pk_bf16_f32 v169, v146, v147
    v_cvt_pk_bf16_f32 v170, v148, v149
    v_cvt_pk_bf16_f32 v171, v150, v151
    v_pk_mul_f32 v[60:61], v[92:93], v[60:61] op_sel_hi:[0,1]
    v_pk_mul_f32 v[62:63], v[92:93], v[62:63] op_sel_hi:[0,1]
    v_pk_mul_f32 v[76:77], v[92:93], v[76:77] op_sel_hi:[0,1]
    v_pk_mul_f32 v[78:79], v[92:93], v[78:79] op_sel_hi:[0,1]
    v_cvt_pk_bf16_f32 v60, v60, v61
    v_cvt_pk_bf16_f32 v61, v62, v63
    v_cvt_pk_bf16_f32 v62, v76, v77
    v_cvt_pk_bf16_f32 v63, v78, v79
    buffer_store_dwordx4 v[60:63], v6, s[12:15], s51 offen offset:256 sc1
    v_exp_f32 v136, v136
    v_exp_f32 v137, v137
    v_mfma_f32_16x16x32_bf16 v[88:91], v[208:211], v[168:171], 0
    v_exp_f32 v138, v138
    v_mfma_f32_16x16x32_bf16 v[56:59], v[100:103], v[168:171], 0
    v_exp_f32 v139, v139
    v_mfma_f32_16x16x32_bf16 v[72:75], v[116:119], v[168:171], 0
    v_exp_f32 v140, v140
    v_exp_f32 v141, v141
    v_exp_f32 v142, v142
    v_exp_f32 v143, v143
    v_rcp_f32 v88, v88
    v_cvt_pk_bf16_f32 v164, v136, v137
    v_cvt_pk_bf16_f32 v165, v138, v139
    v_cvt_pk_bf16_f32 v166, v140, v141
    v_cvt_pk_bf16_f32 v167, v142, v143
    v_pk_mul_f32 v[56:57], v[88:89], v[56:57] op_sel_hi:[0,1]
    v_pk_mul_f32 v[58:59], v[88:89], v[58:59] op_sel_hi:[0,1]
    v_pk_mul_f32 v[72:73], v[88:89], v[72:73] op_sel_hi:[0,1]
    v_pk_mul_f32 v[74:75], v[88:89], v[74:75] op_sel_hi:[0,1]
    v_cvt_pk_bf16_f32 v56, v56, v57
    v_cvt_pk_bf16_f32 v57, v58, v59
    v_cvt_pk_bf16_f32 v58, v72, v73
    v_cvt_pk_bf16_f32 v59, v74, v75
    buffer_store_dwordx4 v[56:59], v6, s[12:15], s51 offen offset:0 sc1
    v_exp_f32 v128, v128
    v_exp_f32 v129, v129
    v_mfma_f32_16x16x32_bf16 v[84:87], v[208:211], v[164:167], 0
    v_exp_f32 v130, v130
    v_mfma_f32_16x16x32_bf16 v[52:55], v[98:101], v[164:167], 0
    v_exp_f32 v131, v131
    v_mfma_f32_16x16x32_bf16 v[68:71], v[114:117], v[164:167], 0
    v_exp_f32 v132, v132
    v_exp_f32 v133, v133
    v_exp_f32 v134, v134
    v_exp_f32 v135, v135
    v_rcp_f32 v84, v84
    v_cvt_pk_bf16_f32 v160, v128, v129
    v_cvt_pk_bf16_f32 v161, v130, v131
    v_cvt_pk_bf16_f32 v162, v132, v133
    v_cvt_pk_bf16_f32 v163, v134, v135
    v_pk_mul_f32 v[52:53], v[84:85], v[52:53] op_sel_hi:[0,1]
    v_pk_mul_f32 v[54:55], v[84:85], v[54:55] op_sel_hi:[0,1]
    v_mfma_f32_16x16x32_bf16 v[80:83], v[208:211], v[160:163], 0
    v_pk_mul_f32 v[68:69], v[84:85], v[68:69] op_sel_hi:[0,1]
    v_pk_mul_f32 v[70:71], v[84:85], v[70:71] op_sel_hi:[0,1]
    v_mfma_f32_16x16x32_bf16 v[48:51], v[96:99], v[160:163], 0
    v_cvt_pk_bf16_f32 v52, v52, v53
    v_cvt_pk_bf16_f32 v53, v54, v55
    v_mfma_f32_16x16x32_bf16 v[64:67], v[112:115], v[160:163], 0
    v_cvt_pk_bf16_f32 v54, v68, v69
    v_cvt_pk_bf16_f32 v55, v70, v71
    buffer_store_dwordx4 v[52:55], v6, s[12:15], s49 offen offset:256 sc1
    v_rcp_f32 v80, v80
    s_nop 0
    v_pk_mul_f32 v[48:49], v[80:81], v[48:49] op_sel_hi:[0,1]
    v_pk_mul_f32 v[50:51], v[80:81], v[50:51] op_sel_hi:[0,1]
    s_nop 0
    v_pk_mul_f32 v[64:65], v[80:81], v[64:65] op_sel_hi:[0,1]
    v_pk_mul_f32 v[66:67], v[80:81], v[66:67] op_sel_hi:[0,1]
    v_cvt_pk_bf16_f32 v48, v48, v49
    v_cvt_pk_bf16_f32 v49, v50, v51
    v_cvt_pk_bf16_f32 v50, v64, v65
    v_cvt_pk_bf16_f32 v51, v66, v67
    buffer_store_dwordx4 v[48:51], v6, s[12:15], s49 offen offset:0 sc1
    s_branch c_wo
.p2align 6
c_wo:
    v_and_b32 v1, 63, v0
    v_lshrrev_b32 v2, 6, v0
    v_lshlrev_b32 v5, 4, v1
    v_lshrrev_b32 v3, 5, v1
    s_lshl_b32 s48, s6, 2
    s_add_u32 s48, s48, s8
    s_lshl_b32 s55, s48, 16
    s_lshl_b32 s56, s9, 22
    s_add_u32 s55, s55, s56
    s_lshl_b32 s56, s7, 12
    s_add_u32 s58, s55, s56
    s_add_u32 s55, s55, 16777216
    s_add_u32 s16, s4, s55
    s_addc_u32 s17, s5, 0
    s_mov_b32 s18, 65536
    s_mov_b32 s19, 0x00020000
    s_lshl_b32 s60, s9, 2
    s_add_u32 s60, s60, 159504
    v_mov_b32 v28, s60
    s_mul_i32 s55, s9, 786432
    s_add_u32 s55, s55, 65798144
    v_and_b32 v24, 63, v0
    s_and_b32 s56, s11, 0xe0
    v_lshrrev_b32 v25, 5, v24
    v_add_u32 v24, s56, v24
    v_and_b32 v24, 255, v24
    v_lshlrev_b32 v24, 10, v24
    v_lshl_add_u32 v24, v25, 8, v24
    s_bfe_u32 s56, s11, 0x20003
    s_and_b32 s57, s11, 7
    s_lshl_b32 s56, s56, 7
    s_lshl_b32 s57, s57, 2
    s_add_u32 s55, s55, s56
    s_add_u32 s55, s55, s57
    v_mov_b32 v25, 159488
    v_mov_b32 v26, 1
    v_mov_b32 v27, s10
    v_and_b32 v4, 15, v0
    v_lshrrev_b32 v16, 2, v4
    v_lshl_add_u32 v16, v3, 2, v16
    v_lshlrev_b32 v16, 7, v16
    v_bfe_u32 v17, v1, 4, 1
    v_lshl_add_u32 v16, v17, 5, v16
    v_and_b32 v17, 3, v4
    v_lshl_add_u32 v16, v17, 3, v16
    v_lshrrev_b32 v17, 3, v4
    v_lshlrev_b32 v18, 6, v17
    v_add_u32 v12, v16, v18
    v_sub_u32 v13, v16, v18
    ds_read_b32 v29, v28
    buffer_load_dwordx4 v[96:99], v5, s[12:15], s58 offen offset:0 sc1
    buffer_load_dwordx4 v[100:103], v5, s[12:15], s58 offen offset:1024 sc1
    buffer_load_dwordx4 v[104:107], v5, s[12:15], s58 offen offset:2048 sc1
    buffer_load_dwordx4 v[108:111], v5, s[12:15], s58 offen offset:3072 sc1
    s_waitcnt lgkmcnt(0)
    v_readfirstlane_b32 s60, v29
    s_lshr_b32 s51, s60, 2
    s_and_b32 s51, s51, s60
    s_and_b32 s51, s51, 3
    s_cmp_eq_u32 s51, 0
    s_cbranch_scc1 c_wo_late
    s_and_b32 s52, s51, 1
    s_xor_b32 s52, s52, 1
    s_lshl_b32 s50, s52, 15
    buffer_load_dwordx4 v[112:115], v5, s[16:19], s50 offen offset:0 sc1
    buffer_load_dwordx4 v[116:119], v5, s[16:19], s50 offen offset:1024 sc1
    buffer_load_dwordx4 v[120:123], v5, s[16:19], s50 offen offset:2048 sc1
    buffer_load_dwordx4 v[124:127], v5, s[16:19], s50 offen offset:3072 sc1
    s_add_u32 s50, s50, 4096
    buffer_load_dwordx4 v[128:131], v5, s[16:19], s50 offen offset:0 sc1
    s_mov_b64 exec, 1
    s_waitcnt vmcnt(9)
    ds_add_rtn_u32 v26, v25, v26
    s_waitcnt lgkmcnt(0)
    v_readfirstlane_b32 s56, v26
    s_and_b32 s56, s56, 3
    s_cmp_lg_u32 s56, 3
    s_cbranch_scc1 pub_2
    s_mov_b32 exec_lo, -1
    buffer_store_dword v27, v24, s[12:15], s55 offen sc1
pub_2:
    s_mov_b64 exec, -1
    s_branch c_wo_run
c_wo_late:
    s_mov_b64 exec, 1
    s_waitcnt vmcnt(4)
    ds_add_rtn_u32 v26, v25, v26
    s_waitcnt lgkmcnt(0)
    v_readfirstlane_b32 s56, v26
    s_and_b32 s56, s56, 3
    s_cmp_lg_u32 s56, 3
    s_cbranch_scc1 pub_3
    s_mov_b32 exec_lo, -1
    buffer_store_dword v27, v24, s[12:15], s55 offen sc1
pub_3:
    s_mov_b64 exec, -1
    s_branch wp_4_t
wp_4:
    ds_read_b32 v29, v28
    s_waitcnt lgkmcnt(0)
    v_readfirstlane_b32 s60, v29
    s_lshr_b32 s51, s60, 2
    s_and_b32 s51, s51, s60
    s_and_b32 s51, s51, 3
wp_4_t:
    s_cmp_lg_u32 s51, 0
    s_cbranch_scc0 wp_4
    s_and_b32 s52, s51, 1
    s_xor_b32 s52, s52, 1
    s_lshl_b32 s50, s52, 15
    buffer_load_dwordx4 v[112:115], v5, s[16:19], s50 offen offset:0 sc1
    buffer_load_dwordx4 v[116:119], v5, s[16:19], s50 offen offset:1024 sc1
    buffer_load_dwordx4 v[120:123], v5, s[16:19], s50 offen offset:2048 sc1
    buffer_load_dwordx4 v[124:127], v5, s[16:19], s50 offen offset:3072 sc1
    s_add_u32 s50, s50, 4096
    buffer_load_dwordx4 v[128:131], v5, s[16:19], s50 offen offset:0 sc1
c_wo_run:
    buffer_load_dwordx4 v[132:135], v5, s[16:19], s50 offen offset:1024 sc1
    buffer_load_dwordx4 v[136:139], v5, s[16:19], s50 offen offset:2048 sc1
    buffer_load_dwordx4 v[140:143], v5, s[16:19], s50 offen offset:3072 sc1
    s_add_u32 s50, s50, 4096
    s_lshl_b32 s3, s52, 16
    v_add_u32 v12, s3, v12
    v_add_u32 v13, s3, v13
    v_xor_b32 v14, 0x10000, v12
    v_xor_b32 v15, 0x10000, v13
    s_cmp_eq_u32 s52, 0
    s_mov_b32 s3, 0x0c0c0c0c
    s_cselect_b32 s53, 0x01000c0c, s3
    s_cselect_b32 s54, 0x03020c0c, s3
    s_cselect_b32 s59, s3, 0x01000c0c
    s_cselect_b32 s97, s3, 0x03020c0c
    s_branch wp_5_t
wp_5:
    ds_read_b32 v29, v28
    s_waitcnt lgkmcnt(0)
    v_readfirstlane_b32 s60, v29
    s_lshr_b32 s51, s60, 2
    s_and_b32 s51, s51, s60
    s_and_b32 s51, s51, 3
wp_5_t:
    s_cmp_ge_u32 s60, 0xf0
    s_cbranch_scc0 wp_5
    ds_read_b64_tr_b16 v[64:65], v12 offset:0
    ds_read_b64_tr_b16 v[66:67], v12 offset:1024
    ds_read_b64_tr_b16 v[68:69], v13 offset:64
    ds_read_b64_tr_b16 v[70:71], v13 offset:1088
    ds_read_b64_tr_b16 v[72:73], v12 offset:2048
    ds_read_b64_tr_b16 v[74:75], v12 offset:3072
    ds_read_b64_tr_b16 v[76:77], v13 offset:2112
    ds_read_b64_tr_b16 v[78:79], v13 offset:3136
    ds_read_b64_tr_b16 v[80:81], v12 offset:4096
    ds_read_b64_tr_b16 v[82:83], v12 offset:5120
    ds_read_b64_tr_b16 v[84:85], v13 offset:4160
    ds_read_b64_tr_b16 v[86:87], v13 offset:5184
    s_waitcnt vmcnt(8)
    v_perm_b32 v32, v96, v96, s53
    v_perm_b32 v33, v96, v96, s54
    v_perm_b32 v34, v97, v97, s53
    v_perm_b32 v35, v97, v97, s54
    v_perm_b32 v36, v98, v98, s53
    v_perm_b32 v37, v98, v98, s54
    v_perm_b32 v38, v99, v99, s53
    v_perm_b32 v39, v99, v99, s54
    v_perm_b32 v40, v100, v100, s53
    v_perm_b32 v41, v100, v100, s54
    v_perm_b32 v42, v101, v101, s53
    v_perm_b32 v43, v101, v101, s54
    v_perm_b32 v44, v102, v102, s53
    v_perm_b32 v45, v102, v102, s54
    v_perm_b32 v46, v103, v103, s53
    v_perm_b32 v47, v103, v103, s54
    v_perm_b32 v48, v104, v104, s53
    v_perm_b32 v49, v104, v104, s54
    v_perm_b32 v50, v105, v105, s53
    v_perm_b32 v51, v105, v105, s54
    v_perm_b32 v52, v106, v106, s53
    v_perm_b32 v53, v106, v106, s54
    v_perm_b32 v54, v107, v107, s53
    v_perm_b32 v55, v107, v107, s54
    v_perm_b32 v56, v108, v108, s53
    v_perm_b32 v57, v108, v108, s54
    v_perm_b32 v58, v109, v109, s53
    v_perm_b32 v59, v109, v109, s54
    v_perm_b32 v60, v110, v110, s53
    v_perm_b32 v61, v110, v110, s54
    v_perm_b32 v62, v111, v111, s53
    v_perm_b32 v63, v111, v111, s54
    buffer_load_dwordx4 v[144:147], v5, s[16:19], s50 offen offset:0 sc1
    buffer_load_dwordx4 v[148:151], v5, s[16:19], s50 offen offset:1024 sc1
    buffer_load_dwordx4 v[152:155], v5, s[16:19], s50 offen offset:2048 sc1
    buffer_load_dwordx4 v[156:159], v5, s[16:19], s50 offen offset:3072 sc1
    s_add_u32 s50, s50, 4096
    buffer_load_dwordx4 v[160:163], v5, s[16:19], s50 offen offset:0 sc1
    buffer_load_dwordx4 v[164:167], v5, s[16:19], s50 offen offset:1024 sc1
    buffer_load_dwordx4 v[168:171], v5, s[16:19], s50 offen offset:2048 sc1
    s_waitcnt vmcnt(14) lgkmcnt(8)
    v_mfma_f32_32x32x16_bf16 v[32:47], v[64:67], v[112:115], v[32:47]
    ds_read_b64_tr_b16 v[88:89], v12 offset:6144
    ds_read_b64_tr_b16 v[90:91], v12 offset:7168
    buffer_load_dwordx4 v[172:175], v5, s[16:19], s50 offen offset:3072 sc1
    s_add_u32 s50, s50, 4096
    v_perm_b32 v176, v96, v96, s59
    v_mfma_f32_32x32x16_bf16 v[48:63], v[68:71], v[112:115], v[48:63]
    ds_read_b64_tr_b16 v[92:93], v13 offset:6208
    ds_read_b64_tr_b16 v[94:95], v13 offset:7232
    v_perm_b32 v177, v96, v96, s97
    s_waitcnt vmcnt(14) lgkmcnt(8)
    v_mfma_f32_32x32x16_bf16 v[32:47], v[72:75], v[116:119], v[32:47]
    ds_read_b64_tr_b16 v[64:65], v12 offset:8192
    ds_read_b64_tr_b16 v[66:67], v12 offset:9216
    buffer_load_dwordx4 v[112:115], v5, s[16:19], s50 offen offset:0 sc1
    v_perm_b32 v178, v97, v97, s59
    v_mfma_f32_32x32x16_bf16 v[48:63], v[76:79], v[116:119], v[48:63]
    ds_read_b64_tr_b16 v[68:69], v13 offset:8256
    ds_read_b64_tr_b16 v[70:71], v13 offset:9280
    v_perm_b32 v179, v97, v97, s97
    s_waitcnt vmcnt(14) lgkmcnt(8)
    v_mfma_f32_32x32x16_bf16 v[32:47], v[80:83], v[120:123], v[32:47]
    ds_read_b64_tr_b16 v[72:73], v12 offset:10240
    ds_read_b64_tr_b16 v[74:75], v12 offset:11264
    buffer_load_dwordx4 v[116:119], v5, s[16:19], s50 offen offset:1024 sc1
    v_perm_b32 v180, v98, v98, s59
    v_mfma_f32_32x32x16_bf16 v[48:63], v[84:87], v[120:123], v[48:63]
    ds_read_b64_tr_b16 v[76:77], v13 offset:10304
    ds_read_b64_tr_b16 v[78:79], v13 offset:11328
    v_perm_b32 v181, v98, v98, s97
    s_waitcnt vmcnt(14) lgkmcnt(8)
    v_mfma_f32_32x32x16_bf16 v[32:47], v[88:91], v[124:127], v[32:47]
    ds_read_b64_tr_b16 v[80:81], v12 offset:12288
    ds_read_b64_tr_b16 v[82:83], v12 offset:13312
    buffer_load_dwordx4 v[120:123], v5, s[16:19], s50 offen offset:2048 sc1
    v_perm_b32 v182, v99, v99, s59
    v_mfma_f32_32x32x16_bf16 v[48:63], v[92:95], v[124:127], v[48:63]
    ds_read_b64_tr_b16 v[84:85], v13 offset:12352
    ds_read_b64_tr_b16 v[86:87], v13 offset:13376
    v_perm_b32 v183, v99, v99, s97
    s_waitcnt vmcnt(14) lgkmcnt(8)
    v_mfma_f32_32x32x16_bf16 v[32:47], v[64:67], v[128:131], v[32:47]
    ds_read_b64_tr_b16 v[88:89], v12 offset:14336
    ds_read_b64_tr_b16 v[90:91], v12 offset:15360
    buffer_load_dwordx4 v[124:127], v5, s[16:19], s50 offen offset:3072 sc1
    s_add_u32 s50, s50, 4096
    v_perm_b32 v184, v100, v100, s59
    v_mfma_f32_32x32x16_bf16 v[48:63], v[68:71], v[128:131], v[48:63]
    ds_read_b64_tr_b16 v[92:93], v13 offset:14400
    ds_read_b64_tr_b16 v[94:95], v13 offset:15424
    v_perm_b32 v185, v100, v100, s97
    s_waitcnt vmcnt(14) lgkmcnt(8)
    v_mfma_f32_32x32x16_bf16 v[32:47], v[72:75], v[132:135], v[32:47]
    ds_read_b64_tr_b16 v[64:65], v12 offset:16384
    ds_read_b64_tr_b16 v[66:67], v12 offset:17408
    buffer_load_dwordx4 v[128:131], v5, s[16:19], s50 offen offset:0 sc1
    v_perm_b32 v186, v101, v101, s59
    v_mfma_f32_32x32x16_bf16 v[48:63], v[76:79], v[132:135], v[48:63]
    ds_read_b64_tr_b16 v[68:69], v13 offset:16448
    ds_read_b64_tr_b16 v[70:71], v13 offset:17472
    v_perm_b32 v187, v101, v101, s97
    s_waitcnt vmcnt(14) lgkmcnt(8)
    v_mfma_f32_32x32x16_bf16 v[32:47], v[80:83], v[136:139], v[32:47]
    ds_read_b64_tr_b16 v[72:73], v12 offset:18432
    ds_read_b64_tr_b16 v[74:75], v12 offset:19456
    buffer_load_dwordx4 v[132:135], v5, s[16:19], s50 offen offset:1024 sc1
    v_perm_b32 v188, v102, v102, s59
    v_mfma_f32_32x32x16_bf16 v[48:63], v[84:87], v[136:139], v[48:63]
    ds_read_b64_tr_b16 v[76:77], v13 offset:18496
    ds_read_b64_tr_b16 v[78:79], v13 offset:19520
    v_perm_b32 v189, v102, v102, s97
    s_waitcnt vmcnt(14) lgkmcnt(8)
    v_mfma_f32_32x32x16_bf16 v[32:47], v[88:91], v[140:143], v[32:47]
    ds_read_b64_tr_b16 v[80:81], v12 offset:20480
    ds_read_b64_tr_b16 v[82:83], v12 offset:21504
    buffer_load_dwordx4 v[136:139], v5, s[16:19], s50 offen offset:2048 sc1
    v_perm_b32 v190, v103, v103, s59
    v_mfma_f32_32x32x16_bf16 v[48:63], v[92:95], v[140:143], v[48:63]
    ds_read_b64_tr_b16 v[84:85], v13 offset:20544
    ds_read_b64_tr_b16 v[86:87], v13 offset:21568
    v_perm_b32 v191, v103, v103, s97
    s_waitcnt vmcnt(14) lgkmcnt(8)
    v_mfma_f32_32x32x16_bf16 v[32:47], v[64:67], v[144:147], v[32:47]
    ds_read_b64_tr_b16 v[88:89], v12 offset:22528
    ds_read_b64_tr_b16 v[90:91], v12 offset:23552
    buffer_load_dwordx4 v[140:143], v5, s[16:19], s50 offen offset:3072 sc1
    s_add_u32 s50, s50, 4096
    v_perm_b32 v192, v104, v104, s59
    v_mfma_f32_32x32x16_bf16 v[48:63], v[68:71], v[144:147], v[48:63]
    ds_read_b64_tr_b16 v[92:93], v13 offset:22592
    ds_read_b64_tr_b16 v[94:95], v13 offset:23616
    v_perm_b32 v193, v104, v104, s97
    s_waitcnt vmcnt(14) lgkmcnt(8)
    v_mfma_f32_32x32x16_bf16 v[32:47], v[72:75], v[148:151], v[32:47]
    ds_read_b64_tr_b16 v[64:65], v12 offset:24576
    ds_read_b64_tr_b16 v[66:67], v12 offset:25600
    buffer_load_dwordx4 v[144:147], v5, s[16:19], s50 offen offset:0 sc1
    v_perm_b32 v194, v105, v105, s59
    v_mfma_f32_32x32x16_bf16 v[48:63], v[76:79], v[148:151], v[48:63]
    ds_read_b64_tr_b16 v[68:69], v13 offset:24640
    ds_read_b64_tr_b16 v[70:71], v13 offset:25664
    v_perm_b32 v195, v105, v105, s97
    s_waitcnt vmcnt(14) lgkmcnt(8)
    v_mfma_f32_32x32x16_bf16 v[32:47], v[80:83], v[152:155], v[32:47]
    ds_read_b64_tr_b16 v[72:73], v12 offset:26624
    ds_read_b64_tr_b16 v[74:75], v12 offset:27648
    buffer_load_dwordx4 v[148:151], v5, s[16:19], s50 offen offset:1024 sc1
    v_perm_b32 v196, v106, v106, s59
    v_mfma_f32_32x32x16_bf16 v[48:63], v[84:87], v[152:155], v[48:63]
    ds_read_b64_tr_b16 v[76:77], v13 offset:26688
    ds_read_b64_tr_b16 v[78:79], v13 offset:27712
    v_perm_b32 v197, v106, v106, s97
    s_waitcnt vmcnt(14) lgkmcnt(8)
    v_mfma_f32_32x32x16_bf16 v[32:47], v[88:91], v[156:159], v[32:47]
    ds_read_b64_tr_b16 v[80:81], v12 offset:28672
    ds_read_b64_tr_b16 v[82:83], v12 offset:29696
    buffer_load_dwordx4 v[152:155], v5, s[16:19], s50 offen offset:2048 sc1
    v_perm_b32 v198, v107, v107, s59
    v_mfma_f32_32x32x16_bf16 v[48:63], v[92:95], v[156:159], v[48:63]
    ds_read_b64_tr_b16 v[84:85], v13 offset:28736
    ds_read_b64_tr_b16 v[86:87], v13 offset:29760
    v_perm_b32 v199, v107, v107, s97
    s_waitcnt vmcnt(14) lgkmcnt(8)
    v_mfma_f32_32x32x16_bf16 v[32:47], v[64:67], v[160:163], v[32:47]
    ds_read_b64_tr_b16 v[88:89], v12 offset:30720
    ds_read_b64_tr_b16 v[90:91], v12 offset:31744
    buffer_load_dwordx4 v[156:159], v5, s[16:19], s50 offen offset:3072 sc1
    s_add_u32 s50, s50, 4096
    v_perm_b32 v200, v108, v108, s59
    v_mfma_f32_32x32x16_bf16 v[48:63], v[68:71], v[160:163], v[48:63]
    ds_read_b64_tr_b16 v[92:93], v13 offset:30784
    ds_read_b64_tr_b16 v[94:95], v13 offset:31808
    v_perm_b32 v201, v108, v108, s97
    s_waitcnt vmcnt(14) lgkmcnt(8)
    v_mfma_f32_32x32x16_bf16 v[32:47], v[72:75], v[164:167], v[32:47]
    ds_read_b64_tr_b16 v[64:65], v12 offset:32768
    ds_read_b64_tr_b16 v[66:67], v12 offset:33792
    buffer_load_dwordx4 v[160:163], v5, s[16:19], s50 offen offset:0 sc1
    v_perm_b32 v202, v109, v109, s59
    v_mfma_f32_32x32x16_bf16 v[48:63], v[76:79], v[164:167], v[48:63]
    ds_read_b64_tr_b16 v[68:69], v13 offset:32832
    ds_read_b64_tr_b16 v[70:71], v13 offset:33856
    v_perm_b32 v203, v109, v109, s97
    s_waitcnt vmcnt(14) lgkmcnt(8)
    v_mfma_f32_32x32x16_bf16 v[32:47], v[80:83], v[168:171], v[32:47]
    ds_read_b64_tr_b16 v[72:73], v12 offset:34816
    ds_read_b64_tr_b16 v[74:75], v12 offset:35840
    buffer_load_dwordx4 v[164:167], v5, s[16:19], s50 offen offset:1024 sc1
    v_perm_b32 v204, v110, v110, s59
    v_mfma_f32_32x32x16_bf16 v[48:63], v[84:87], v[168:171], v[48:63]
    ds_read_b64_tr_b16 v[76:77], v13 offset:34880
    ds_read_b64_tr_b16 v[78:79], v13 offset:35904
    v_perm_b32 v205, v110, v110, s97
    s_waitcnt vmcnt(14) lgkmcnt(8)
    v_mfma_f32_32x32x16_bf16 v[32:47], v[88:91], v[172:175], v[32:47]
    ds_read_b64_tr_b16 v[80:81], v12 offset:36864
    ds_read_b64_tr_b16 v[82:83], v12 offset:37888
    buffer_load_dwordx4 v[168:171], v5, s[16:19], s50 offen offset:2048 sc1
    v_perm_b32 v206, v111, v111, s59
    v_mfma_f32_32x32x16_bf16 v[48:63], v[92:95], v[172:175], v[48:63]
    ds_read_b64_tr_b16 v[84:85], v13 offset:36928
    ds_read_b64_tr_b16 v[86:87], v13 offset:37952
    v_perm_b32 v207, v111, v111, s97
    s_waitcnt vmcnt(14) lgkmcnt(8)
    v_mfma_f32_32x32x16_bf16 v[32:47], v[64:67], v[112:115], v[32:47]
    ds_read_b64_tr_b16 v[88:89], v12 offset:38912
    ds_read_b64_tr_b16 v[90:91], v12 offset:39936
    buffer_load_dwordx4 v[172:175], v5, s[16:19], s50 offen offset:3072 sc1
    s_add_u32 s50, s50, 4096
    v_mfma_f32_32x32x16_bf16 v[48:63], v[68:71], v[112:115], v[48:63]
    ds_read_b64_tr_b16 v[92:93], v13 offset:38976
    ds_read_b64_tr_b16 v[94:95], v13 offset:40000
    s_waitcnt vmcnt(14) lgkmcnt(8)
    v_mfma_f32_32x32x16_bf16 v[32:47], v[72:75], v[116:119], v[32:47]
    ds_read_b64_tr_b16 v[64:65], v12 offset:40960
    ds_read_b64_tr_b16 v[66:67], v12 offset:41984
    s_branch wp_6_t
wp_6:
    ds_read_b32 v29, v28
    s_waitcnt lgkmcnt(0)
    v_readfirstlane_b32 s60, v29
    s_lshr_b32 s51, s60, 2
    s_and_b32 s51, s51, s60
    s_and_b32 s51, s51, 3
wp_6_t:
    s_cmp_eq_u32 s51, 3
    s_cbranch_scc0 wp_6
    s_lshl_b32 s50, s52, 15
    s_xor_b32 s50, s50, 32768
    buffer_load_dwordx4 v[112:115], v5, s[16:19], s50 offen offset:0 sc1
    v_mfma_f32_32x32x16_bf16 v[48:63], v[76:79], v[116:119], v[48:63]
    ds_read_b64_tr_b16 v[68:69], v13 offset:41024
    ds_read_b64_tr_b16 v[70:71], v13 offset:42048
    s_waitcnt vmcnt(14) lgkmcnt(8)
    v_mfma_f32_32x32x16_bf16 v[32:47], v[80:83], v[120:123], v[32:47]
    ds_read_b64_tr_b16 v[72:73], v12 offset:43008
    ds_read_b64_tr_b16 v[74:75], v12 offset:44032
    buffer_load_dwordx4 v[116:119], v5, s[16:19], s50 offen offset:1024 sc1
    v_mfma_f32_32x32x16_bf16 v[48:63], v[84:87], v[120:123], v[48:63]
    ds_read_b64_tr_b16 v[76:77], v13 offset:43072
    ds_read_b64_tr_b16 v[78:79], v13 offset:44096
    s_waitcnt vmcnt(14) lgkmcnt(8)
    v_mfma_f32_32x32x16_bf16 v[32:47], v[88:91], v[124:127], v[32:47]
    ds_read_b64_tr_b16 v[80:81], v12 offset:45056
    ds_read_b64_tr_b16 v[82:83], v12 offset:46080
    buffer_load_dwordx4 v[120:123], v5, s[16:19], s50 offen offset:2048 sc1
    v_mfma_f32_32x32x16_bf16 v[48:63], v[92:95], v[124:127], v[48:63]
    ds_read_b64_tr_b16 v[84:85], v13 offset:45120
    ds_read_b64_tr_b16 v[86:87], v13 offset:46144
    s_waitcnt vmcnt(14) lgkmcnt(8)
    v_mfma_f32_32x32x16_bf16 v[32:47], v[64:67], v[128:131], v[32:47]
    ds_read_b64_tr_b16 v[88:89], v12 offset:47104
    ds_read_b64_tr_b16 v[90:91], v12 offset:48128
    buffer_load_dwordx4 v[124:127], v5, s[16:19], s50 offen offset:3072 sc1
    s_add_u32 s50, s50, 4096
    v_mfma_f32_32x32x16_bf16 v[48:63], v[68:71], v[128:131], v[48:63]
    ds_read_b64_tr_b16 v[92:93], v13 offset:47168
    ds_read_b64_tr_b16 v[94:95], v13 offset:48192
    s_waitcnt vmcnt(14) lgkmcnt(8)
    v_mfma_f32_32x32x16_bf16 v[32:47], v[72:75], v[132:135], v[32:47]
    ds_read_b64_tr_b16 v[64:65], v12 offset:49152
    ds_read_b64_tr_b16 v[66:67], v12 offset:50176
    buffer_load_dwordx4 v[128:131], v5, s[16:19], s50 offen offset:0 sc1
    v_mfma_f32_32x32x16_bf16 v[48:63], v[76:79], v[132:135], v[48:63]
    ds_read_b64_tr_b16 v[68:69], v13 offset:49216
    ds_read_b64_tr_b16 v[70:71], v13 offset:50240
    s_waitcnt vmcnt(14) lgkmcnt(8)
    v_mfma_f32_32x32x16_bf16 v[32:47], v[80:83], v[136:139], v[32:47]
    ds_read_b64_tr_b16 v[72:73], v12 offset:51200
    ds_read_b64_tr_b16 v[74:75], v12 offset:52224
    buffer_load_dwordx4 v[132:135], v5, s[16:19], s50 offen offset:1024 sc1
    v_mfma_f32_32x32x16_bf16 v[48:63], v[84:87], v[136:139], v[48:63]
    ds_read_b64_tr_b16 v[76:77], v13 offset:51264
    ds_read_b64_tr_b16 v[78:79], v13 offset:52288
    s_waitcnt vmcnt(14) lgkmcnt(8)
    v_mfma_f32_32x32x16_bf16 v[32:47], v[88:91], v[140:143], v[32:47]
    ds_read_b64_tr_b16 v[80:81], v12 offset:53248
    ds_read_b64_tr_b16 v[82:83], v12 offset:54272
    buffer_load_dwordx4 v[136:139], v5, s[16:19], s50 offen offset:2048 sc1
    v_mfma_f32_32x32x16_bf16 v[48:63], v[92:95], v[140:143], v[48:63]
    ds_read_b64_tr_b16 v[84:85], v13 offset:53312
    ds_read_b64_tr_b16 v[86:87], v13 offset:54336
    s_waitcnt vmcnt(14) lgkmcnt(8)
    v_mfma_f32_32x32x16_bf16 v[32:47], v[64:67], v[144:147], v[32:47]
    ds_read_b64_tr_b16 v[88:89], v12 offset:55296
    ds_read_b64_tr_b16 v[90:91], v12 offset:56320
    buffer_load_dwordx4 v[140:143], v5, s[16:19], s50 offen offset:3072 sc1
    s_add_u32 s50, s50, 4096
    v_mfma_f32_32x32x16_bf16 v[48:63], v[68:71], v[144:147], v[48:63]
    ds_read_b64_tr_b16 v[92:93], v13 offset:55360
    ds_read_b64_tr_b16 v[94:95], v13 offset:56384
    s_waitcnt vmcnt(14) lgkmcnt(8)
    v_mfma_f32_32x32x16_bf16 v[32:47], v[72:75], v[148:151], v[32:47]
    ds_read_b64_tr_b16 v[64:65], v12 offset:57344
    ds_read_b64_tr_b16 v[66:67], v12 offset:58368
    buffer_load_dwordx4 v[144:147], v5, s[16:19], s50 offen offset:0 sc1
    v_mfma_f32_32x32x16_bf16 v[48:63], v[76:79], v[148:151], v[48:63]
    ds_read_b64_tr_b16 v[68:69], v13 offset:57408
    ds_read_b64_tr_b16 v[70:71], v13 offset:58432
    s_waitcnt vmcnt(14) lgkmcnt(8)
    v_mfma_f32_32x32x16_bf16 v[32:47], v[80:83], v[152:155], v[32:47]
    ds_read_b64_tr_b16 v[72:73], v12 offset:59392
    ds_read_b64_tr_b16 v[74:75], v12 offset:60416
    buffer_load_dwordx4 v[148:151], v5, s[16:19], s50 offen offset:1024 sc1
    v_mfma_f32_32x32x16_bf16 v[48:63], v[84:87], v[152:155], v[48:63]
    ds_read_b64_tr_b16 v[76:77], v13 offset:59456
    ds_read_b64_tr_b16 v[78:79], v13 offset:60480
    s_waitcnt vmcnt(14) lgkmcnt(8)
    v_mfma_f32_32x32x16_bf16 v[32:47], v[88:91], v[156:159], v[32:47]
    ds_read_b64_tr_b16 v[80:81], v12 offset:61440
    ds_read_b64_tr_b16 v[82:83], v12 offset:62464
    buffer_load_dwordx4 v[152:155], v5, s[16:19], s50 offen offset:2048 sc1
    v_mfma_f32_32x32x16_bf16 v[48:63], v[92:95], v[156:159], v[48:63]
    ds_read_b64_tr_b16 v[84:85], v13 offset:61504
    ds_read_b64_tr_b16 v[86:87], v13 offset:62528
    s_waitcnt vmcnt(14) lgkmcnt(8)
    v_mfma_f32_32x32x16_bf16 v[32:47], v[64:67], v[160:163], v[32:47]
    ds_read_b64_tr_b16 v[88:89], v12 offset:63488
    ds_read_b64_tr_b16 v[90:91], v12 offset:64512
    buffer_load_dwordx4 v[156:159], v5, s[16:19], s50 offen offset:3072 sc1
    s_add_u32 s50, s50, 4096
    v_mfma_f32_32x32x16_bf16 v[48:63], v[68:71], v[160:163], v[48:63]
    ds_read_b64_tr_b16 v[92:93], v13 offset:63552
    ds_read_b64_tr_b16 v[94:95], v13 offset:64576
    s_waitcnt vmcnt(14) lgkmcnt(8)
    v_mfma_f32_32x32x16_bf16 v[32:47], v[72:75], v[164:167], v[32:47]
    ds_read_b64_tr_b16 v[64:65], v14 offset:0
    ds_read_b64_tr_b16 v[66:67], v14 offset:1024
    buffer_load_dwordx4 v[160:163], v5, s[16:19], s50 offen offset:0 sc1
    v_mfma_f32_32x32x16_bf16 v[48:63], v[76:79], v[164:167], v[48:63]
    ds_read_b64_tr_b16 v[68:69], v15 offset:64
    ds_read_b64_tr_b16 v[70:71], v15 offset:1088
    s_waitcnt vmcnt(14) lgkmcnt(8)
    v_mfma_f32_32x32x16_bf16 v[32:47], v[80:83], v[168:171], v[32:47]
    ds_read_b64_tr_b16 v[72:73], v14 offset:2048
    ds_read_b64_tr_b16 v[74:75], v14 offset:3072
    buffer_load_dwordx4 v[164:167], v5, s[16:19], s50 offen offset:1024 sc1
    v_mfma_f32_32x32x16_bf16 v[48:63], v[84:87], v[168:171], v[48:63]
    ds_read_b64_tr_b16 v[76:77], v15 offset:2112
    ds_read_b64_tr_b16 v[78:79], v15 offset:3136
    s_waitcnt vmcnt(14) lgkmcnt(8)
    v_mfma_f32_32x32x16_bf16 v[32:47], v[88:91], v[172:175], v[32:47]
    ds_read_b64_tr_b16 v[80:81], v14 offset:4096
    ds_read_b64_tr_b16 v[82:83], v14 offset:5120
    buffer_load_dwordx4 v[168:171], v5, s[16:19], s50 offen offset:2048 sc1
    v_mfma_f32_32x32x16_bf16 v[48:63], v[92:95], v[172:175], v[48:63]
    ds_read_b64_tr_b16 v[84:85], v15 offset:4160
    ds_read_b64_tr_b16 v[86:87], v15 offset:5184
    s_waitcnt vmcnt(14) lgkmcnt(8)
    v_mfma_f32_32x32x16_bf16 v[176:191], v[64:67], v[112:115], v[176:191]
    ds_read_b64_tr_b16 v[88:89], v14 offset:6144
    ds_read_b64_tr_b16 v[90:91], v14 offset:7168
    buffer_load_dwordx4 v[172:175], v5, s[16:19], s50 offen offset:3072 sc1
    s_add_u32 s50, s50, 4096
    v_mfma_f32_32x32x16_bf16 v[192:207], v[68:71], v[112:115], v[192:207]
    ds_read_b64_tr_b16 v[92:93], v15 offset:6208
    ds_read_b64_tr_b16 v[94:95], v15 offset:7232
    s_waitcnt vmcnt(14) lgkmcnt(8)
    v_mfma_f32_32x32x16_bf16 v[176:191], v[72:75], v[116:119], v[176:191]
    ds_read_b64_tr_b16 v[64:65], v14 offset:8192
    ds_read_b64_tr_b16 v[66:67], v14 offset:9216
    buffer_load_dwordx4 v[112:115], v5, s[16:19], s50 offen offset:0 sc1
    v_mfma_f32_32x32x16_bf16 v[192:207], v[76:79], v[116:119], v[192:207]
    ds_read_b64_tr_b16 v[68:69], v15 offset:8256
    ds_read_b64_tr_b16 v[70:71], v15 offset:9280
    s_waitcnt vmcnt(14) lgkmcnt(8)
    v_mfma_f32_32x32x16_bf16 v[176:191], v[80:83], v[120:123], v[176:191]
    ds_read_b64_tr_b16 v[72:73], v14 offset:10240
    ds_read_b64_tr_b16 v[74:75], v14 offset:11264
    buffer_load_dwordx4 v[116:119], v5, s[16:19], s50 offen offset:1024 sc1
    v_mfma_f32_32x32x16_bf16 v[192:207], v[84:87], v[120:123], v[192:207]
    ds_read_b64_tr_b16 v[76:77], v15 offset:10304
    ds_read_b64_tr_b16 v[78:79], v15 offset:11328
    s_waitcnt vmcnt(14) lgkmcnt(8)
    v_mfma_f32_32x32x16_bf16 v[176:191], v[88:91], v[124:127], v[176:191]
    ds_read_b64_tr_b16 v[80:81], v14 offset:12288
    ds_read_b64_tr_b16 v[82:83], v14 offset:13312
    buffer_load_dwordx4 v[120:123], v5, s[16:19], s50 offen offset:2048 sc1
    v_mfma_f32_32x32x16_bf16 v[192:207], v[92:95], v[124:127], v[192:207]
    ds_read_b64_tr_b16 v[84:85], v15 offset:12352
    ds_read_b64_tr_b16 v[86:87], v15 offset:13376
    s_waitcnt vmcnt(14) lgkmcnt(8)
    v_mfma_f32_32x32x16_bf16 v[176:191], v[64:67], v[128:131], v[176:191]
    ds_read_b64_tr_b16 v[88:89], v14 offset:14336
    ds_read_b64_tr_b16 v[90:91], v14 offset:15360
    buffer_load_dwordx4 v[124:127], v5, s[16:19], s50 offen offset:3072 sc1
    s_add_u32 s50, s50, 4096
    v_mfma_f32_32x32x16_bf16 v[192:207], v[68:71], v[128:131], v[192:207]
    ds_read_b64_tr_b16 v[92:93], v15 offset:14400
    ds_read_b64_tr_b16 v[94:95], v15 offset:15424
    s_waitcnt vmcnt(14) lgkmcnt(8)
    v_mfma_f32_32x32x16_bf16 v[176:191], v[72:75], v[132:135], v[176:191]
    ds_read_b64_tr_b16 v[64:65], v14 offset:16384
    ds_read_b64_tr_b16 v[66:67], v14 offset:17408
    buffer_load_dwordx4 v[128:131], v5, s[16:19], s50 offen offset:0 sc1
    v_mfma_f32_32x32x16_bf16 v[192:207], v[76:79], v[132:135], v[192:207]
    ds_read_b64_tr_b16 v[68:69], v15 offset:16448
    ds_read_b64_tr_b16 v[70:71], v15 offset:17472
    s_waitcnt vmcnt(14) lgkmcnt(8)
    v_mfma_f32_32x32x16_bf16 v[176:191], v[80:83], v[136:139], v[176:191]
    ds_read_b64_tr_b16 v[72:73], v14 offset:18432
    ds_read_b64_tr_b16 v[74:75], v14 offset:19456
    buffer_load_dwordx4 v[132:135], v5, s[16:19], s50 offen offset:1024 sc1
    v_mfma_f32_32x32x16_bf16 v[192:207], v[84:87], v[136:139], v[192:207]
    ds_read_b64_tr_b16 v[76:77], v15 offset:18496
    ds_read_b64_tr_b16 v[78:79], v15 offset:19520
    s_waitcnt vmcnt(14) lgkmcnt(8)
    v_mfma_f32_32x32x16_bf16 v[176:191], v[88:91], v[140:143], v[176:191]
    ds_read_b64_tr_b16 v[80:81], v14 offset:20480
    ds_read_b64_tr_b16 v[82:83], v14 offset:21504
    buffer_load_dwordx4 v[136:139], v5, s[16:19], s50 offen offset:2048 sc1
    v_mfma_f32_32x32x16_bf16 v[192:207], v[92:95], v[140:143], v[192:207]
    ds_read_b64_tr_b16 v[84:85], v15 offset:20544
    ds_read_b64_tr_b16 v[86:87], v15 offset:21568
    s_waitcnt vmcnt(14) lgkmcnt(8)
    v_mfma_f32_32x32x16_bf16 v[176:191], v[64:67], v[144:147], v[176:191]
    ds_read_b64_tr_b16 v[88:89], v14 offset:22528
    ds_read_b64_tr_b16 v[90:91], v14 offset:23552
    buffer_load_dwordx4 v[140:143], v5, s[16:19], s50 offen offset:3072 sc1
    s_add_u32 s50, s50, 4096
    v_mfma_f32_32x32x16_bf16 v[192:207], v[68:71], v[144:147], v[192:207]
    ds_read_b64_tr_b16 v[92:93], v15 offset:22592
    ds_read_b64_tr_b16 v[94:95], v15 offset:23616
    s_waitcnt vmcnt(14) lgkmcnt(8)
    v_mfma_f32_32x32x16_bf16 v[176:191], v[72:75], v[148:151], v[176:191]
    ds_read_b64_tr_b16 v[64:65], v14 offset:24576
    ds_read_b64_tr_b16 v[66:67], v14 offset:25600
    buffer_load_dwordx4 v[144:147], v5, s[16:19], s50 offen offset:0 sc1
    v_mfma_f32_32x32x16_bf16 v[192:207], v[76:79], v[148:151], v[192:207]
    ds_read_b64_tr_b16 v[68:69], v15 offset:24640
    ds_read_b64_tr_b16 v[70:71], v15 offset:25664
    s_waitcnt vmcnt(14) lgkmcnt(8)
    v_mfma_f32_32x32x16_bf16 v[176:191], v[80:83], v[152:155], v[176:191]
    ds_read_b64_tr_b16 v[72:73], v14 offset:26624
    ds_read_b64_tr_b16 v[74:75], v14 offset:27648
    buffer_load_dwordx4 v[148:151], v5, s[16:19], s50 offen offset:1024 sc1
    v_mfma_f32_32x32x16_bf16 v[192:207], v[84:87], v[152:155], v[192:207]
    ds_read_b64_tr_b16 v[76:77], v15 offset:26688
    ds_read_b64_tr_b16 v[78:79], v15 offset:27712
    s_waitcnt vmcnt(14) lgkmcnt(8)
    v_mfma_f32_32x32x16_bf16 v[176:191], v[88:91], v[156:159], v[176:191]
    ds_read_b64_tr_b16 v[80:81], v14 offset:28672
    ds_read_b64_tr_b16 v[82:83], v14 offset:29696
    buffer_load_dwordx4 v[152:155], v5, s[16:19], s50 offen offset:2048 sc1
    v_mfma_f32_32x32x16_bf16 v[192:207], v[92:95], v[156:159], v[192:207]
    ds_read_b64_tr_b16 v[84:85], v15 offset:28736
    ds_read_b64_tr_b16 v[86:87], v15 offset:29760
    s_waitcnt vmcnt(14) lgkmcnt(8)
    v_mfma_f32_32x32x16_bf16 v[176:191], v[64:67], v[160:163], v[176:191]
    ds_read_b64_tr_b16 v[88:89], v14 offset:30720
    ds_read_b64_tr_b16 v[90:91], v14 offset:31744
    buffer_load_dwordx4 v[156:159], v5, s[16:19], s50 offen offset:3072 sc1
    s_add_u32 s50, s50, 4096
    v_mfma_f32_32x32x16_bf16 v[192:207], v[68:71], v[160:163], v[192:207]
    ds_read_b64_tr_b16 v[92:93], v15 offset:30784
    ds_read_b64_tr_b16 v[94:95], v15 offset:31808
    s_waitcnt vmcnt(14) lgkmcnt(8)
    v_mfma_f32_32x32x16_bf16 v[176:191], v[72:75], v[164:167], v[176:191]
    ds_read_b64_tr_b16 v[64:65], v14 offset:32768
    ds_read_b64_tr_b16 v[66:67], v14 offset:33792
    buffer_load_dwordx4 v[160:163], v5, s[16:19], s50 offen offset:0 sc1
    v_mfma_f32_32x32x16_bf16 v[192:207], v[76:79], v[164:167], v[192:207]
    ds_read_b64_tr_b16 v[68:69], v15 offset:32832
    ds_read_b64_tr_b16 v[70:71], v15 offset:33856
    s_waitcnt vmcnt(14) lgkmcnt(8)
    v_mfma_f32_32x32x16_bf16 v[176:191], v[80:83], v[168:171], v[176:191]
    ds_read_b64_tr_b16 v[72:73], v14 offset:34816
    ds_read_b64_tr_b16 v[74:75], v14 offset:35840
    buffer_load_dwordx4 v[164:167], v5, s[16:19], s50 offen offset:1024 sc1
    v_mfma_f32_32x32x16_bf16 v[192:207], v[84:87], v[168:171], v[192:207]
    ds_read_b64_tr_b16 v[76:77], v15 offset:34880
    ds_read_b64_tr_b16 v[78:79], v15 offset:35904
    s_waitcnt vmcnt(14) lgkmcnt(8)
    v_mfma_f32_32x32x16_bf16 v[176:191], v[88:91], v[172:175], v[176:191]
    ds_read_b64_tr_b16 v[80:81], v14 offset:36864
    ds_read_b64_tr_b16 v[82:83], v14 offset:37888
    buffer_load_dwordx4 v[168:171], v5, s[16:19], s50 offen offset:2048 sc1
    v_mfma_f32_32x32x16_bf16 v[192:207], v[92:95], v[172:175], v[192:207]
    ds_read_b64_tr_b16 v[84:85], v15 offset:36928
    ds_read_b64_tr_b16 v[86:87], v15 offset:37952
    s_waitcnt vmcnt(14) lgkmcnt(8)
    v_mfma_f32_32x32x16_bf16 v[176:191], v[64:67], v[112:115], v[176:191]
    ds_read_b64_tr_b16 v[88:89], v14 offset:38912
    ds_read_b64_tr_b16 v[90:91], v14 offset:39936
    buffer_load_dwordx4 v[172:175], v5, s[16:19], s50 offen offset:3072 sc1
    s_add_u32 s50, s50, 4096
    v_mfma_f32_32x32x16_bf16 v[192:207], v[68:71], v[112:115], v[192:207]
    ds_read_b64_tr_b16 v[92:93], v15 offset:38976
    ds_read_b64_tr_b16 v[94:95], v15 offset:40000
    s_waitcnt vmcnt(14) lgkmcnt(8)
    v_mfma_f32_32x32x16_bf16 v[176:191], v[72:75], v[116:119], v[176:191]
    ds_read_b64_tr_b16 v[64:65], v14 offset:40960
    ds_read_b64_tr_b16 v[66:67], v14 offset:41984
    v_mfma_f32_32x32x16_bf16 v[192:207], v[76:79], v[116:119], v[192:207]
    ds_read_b64_tr_b16 v[68:69], v15 offset:41024
    ds_read_b64_tr_b16 v[70:71], v15 offset:42048
    s_waitcnt vmcnt(13) lgkmcnt(8)
    v_mfma_f32_32x32x16_bf16 v[176:191], v[80:83], v[120:123], v[176:191]
    ds_read_b64_tr_b16 v[72:73], v14 offset:43008
    ds_read_b64_tr_b16 v[74:75], v14 offset:44032
    v_mfma_f32_32x32x16_bf16 v[192:207], v[84:87], v[120:123], v[192:207]
    ds_read_b64_tr_b16 v[76:77], v15 offset:43072
    ds_read_b64_tr_b16 v[78:79], v15 offset:44096
    s_waitcnt vmcnt(12) lgkmcnt(8)
    v_mfma_f32_32x32x16_bf16 v[176:191], v[88:91], v[124:127], v[176:191]
    ds_read_b64_tr_b16 v[80:81], v14 offset:45056
    ds_read_b64_tr_b16 v[82:83], v14 offset:46080
    v_mfma_f32_32x32x16_bf16 v[192:207], v[92:95], v[124:127], v[192:207]
    ds_read_b64_tr_b16 v[84:85], v15 offset:45120
    ds_read_b64_tr_b16 v[86:87], v15 offset:46144
    s_waitcnt vmcnt(11) lgkmcnt(8)
    v_mfma_f32_32x32x16_bf16 v[176:191], v[64:67], v[128:131], v[176:191]
    ds_read_b64_tr_b16 v[88:89], v14 offset:47104
    ds_read_b64_tr_b16 v[90:91], v14 offset:48128
    v_mfma_f32_32x32x16_bf16 v[192:207], v[68:71], v[128:131], v[192:207]
    ds_read_b64_tr_b16 v[92:93], v15 offset:47168
    ds_read_b64_tr_b16 v[94:95], v15 offset:48192
    s_waitcnt vmcnt(10) lgkmcnt(8)
    v_mfma_f32_32x32x16_bf16 v[176:191], v[72:75], v[132:135], v[176:191]
    ds_read_b64_tr_b16 v[64:65], v14 offset:49152
    ds_read_b64_tr_b16 v[66:67], v14 offset:50176
    v_mfma_f32_32x32x16_bf16 v[192:207], v[76:79], v[132:135], v[192:207]
    ds_read_b64_tr_b16 v[68:69], v15 offset:49216
    ds_read_b64_tr_b16 v[70:71], v15 offset:50240
    s_waitcnt vmcnt(9) lgkmcnt(8)
    v_mfma_f32_32x32x16_bf16 v[176:191], v[80:83], v[136:139], v[176:191]
    ds_read_b64_tr_b16 v[72:73], v14 offset:51200
    ds_read_b64_tr_b16 v[74:75], v14 offset:52224
    v_mfma_f32_32x32x16_bf16 v[192:207], v[84:87], v[136:139], v[192:207]
    ds_read_b64_tr_b16 v[76:77], v15 offset:51264
    ds_read_b64_tr_b16 v[78:79], v15 offset:52288
    s_waitcnt vmcnt(8) lgkmcnt(8)
    v_mfma_f32_32x32x16_bf16 v[176:191], v[88:91], v[140:143], v[176:191]
    ds_read_b64_tr_b16 v[80:81], v14 offset:53248
    ds_read_b64_tr_b16 v[82:83], v14 offset:54272
    v_mfma_f32_32x32x16_bf16 v[192:207], v[92:95], v[140:143], v[192:207]
    ds_read_b64_tr_b16 v[84:85], v15 offset:53312
    ds_read_b64_tr_b16 v[86:87], v15 offset:54336
    s_waitcnt vmcnt(7) lgkmcnt(8)
    v_mfma_f32_32x32x16_bf16 v[176:191], v[64:67], v[144:147], v[176:191]
    ds_read_b64_tr_b16 v[88:89], v14 offset:55296
    ds_read_b64_tr_b16 v[90:91], v14 offset:56320
    v_mfma_f32_32x32x16_bf16 v[192:207], v[68:71], v[144:147], v[192:207]
    ds_read_b64_tr_b16 v[92:93], v15 offset:55360
    ds_read_b64_tr_b16 v[94:95], v15 offset:56384
    s_waitcnt vmcnt(6) lgkmcnt(8)
    v_mfma_f32_32x32x16_bf16 v[176:191], v[72:75], v[148:151], v[176:191]
    ds_read_b64_tr_b16 v[64:65], v14 offset:57344
    ds_read_b64_tr_b16 v[66:67], v14 offset:58368
    v_mfma_f32_32x32x16_bf16 v[192:207], v[76:79], v[148:151], v[192:207]
    ds_read_b64_tr_b16 v[68:69], v15 offset:57408
    ds_read_b64_tr_b16 v[70:71], v15 offset:58432
    s_waitcnt vmcnt(5) lgkmcnt(8)
    v_mfma_f32_32x32x16_bf16 v[176:191], v[80:83], v[152:155], v[176:191]
    ds_read_b64_tr_b16 v[72:73], v14 offset:59392
    ds_read_b64_tr_b16 v[74:75], v14 offset:60416
    v_mfma_f32_32x32x16_bf16 v[192:207], v[84:87], v[152:155], v[192:207]
    ds_read_b64_tr_b16 v[76:77], v15 offset:59456
    ds_read_b64_tr_b16 v[78:79], v15 offset:60480
    s_waitcnt vmcnt(4) lgkmcnt(8)
    v_mfma_f32_32x32x16_bf16 v[176:191], v[88:91], v[156:159], v[176:191]
    ds_read_b64_tr_b16 v[80:81], v14 offset:61440
    ds_read_b64_tr_b16 v[82:83], v14 offset:62464
    v_mfma_f32_32x32x16_bf16 v[192:207], v[92:95], v[156:159], v[192:207]
    ds_read_b64_tr_b16 v[84:85], v15 offset:61504
    ds_read_b64_tr_b16 v[86:87], v15 offset:62528
    s_waitcnt vmcnt(3) lgkmcnt(8)
    v_mfma_f32_32x32x16_bf16 v[176:191], v[64:67], v[160:163], v[176:191]
    ds_read_b64_tr_b16 v[88:89], v14 offset:63488
    ds_read_b64_tr_b16 v[90:91], v14 offset:64512
    v_mfma_f32_32x32x16_bf16 v[192:207], v[68:71], v[160:163], v[192:207]
    ds_read_b64_tr_b16 v[92:93], v15 offset:63552
    ds_read_b64_tr_b16 v[94:95], v15 offset:64576
    s_waitcnt vmcnt(2) lgkmcnt(8)
    v_mfma_f32_32x32x16_bf16 v[176:191], v[72:75], v[164:167], v[176:191]
    v_mfma_f32_32x32x16_bf16 v[192:207], v[76:79], v[164:167], v[192:207]
    s_waitcnt vmcnt(1) lgkmcnt(4)
    v_mfma_f32_32x32x16_bf16 v[176:191], v[80:83], v[168:171], v[176:191]
    v_mfma_f32_32x32x16_bf16 v[192:207], v[84:87], v[168:171], v[192:207]
    s_waitcnt vmcnt(0) lgkmcnt(0)
    v_mfma_f32_32x32x16_bf16 v[176:191], v[88:91], v[172:175], v[176:191]
    v_mfma_f32_32x32x16_bf16 v[192:207], v[92:95], v[172:175], v[192:207]
    s_cmp_eq_u32 s9, 3
    s_nop 7
    s_cbranch_scc1 c_wo_fin
    s_add_u32 s58, s58, 4194304
    s_nop 7
    v_pk_add_f32 v[32:33], v[32:33], v[176:177]
    v_pk_add_f32 v[34:35], v[34:35], v[178:179]
    v_pk_add_f32 v[36:37], v[36:37], v[180:181]
    v_pk_add_f32 v[38:39], v[38:39], v[182:183]
    v_cvt_pk_bf16_f32 v96, v32, v33
    v_cvt_pk_bf16_f32 v97, v34, v35
    v_cvt_pk_bf16_f32 v98, v36, v37
    v_cvt_pk_bf16_f32 v99, v38, v39
    buffer_store_dwordx4 v[96:99], v5, s[12:15], s58 offen offset:0 sc1
    v_pk_add_f32 v[40:41], v[40:41], v[184:185]
    v_pk_add_f32 v[42:43], v[42:43], v[186:187]
    v_pk_add_f32 v[44:45], v[44:45], v[188:189]
    v_pk_add_f32 v[46:47], v[46:47], v[190:191]
    v_cvt_pk_bf16_f32 v100, v40, v41
    v_cvt_pk_bf16_f32 v101, v42, v43
    v_cvt_pk_bf16_f32 v102, v44, v45
    v_cvt_pk_bf16_f32 v103, v46, v47
    buffer_store_dwordx4 v[100:103], v5, s[12:15], s58 offen offset:1024 sc1
    v_pk_add_f32 v[48:49], v[48:49], v[192:193]
    v_pk_add_f32 v[50:51], v[50:51], v[194:195]
    v_pk_add_f32 v[52:53], v[52:53], v[196:197]
    v_pk_add_f32 v[54:55], v[54:55], v[198:199]
    v_cvt_pk_bf16_f32 v104, v48, v49
    v_cvt_pk_bf16_f32 v105, v50, v51
    v_cvt_pk_bf16_f32 v106, v52, v53
    v_cvt_pk_bf16_f32 v107, v54, v55
    buffer_store_dwordx4 v[104:107], v5, s[12:15], s58 offen offset:2048 sc1
    v_pk_add_f32 v[56:57], v[56:57], v[200:201]
    v_pk_add_f32 v[58:59], v[58:59], v[202:203]
    v_pk_add_f32 v[60:61], v[60:61], v[204:205]
    v_pk_add_f32 v[62:63], v[62:63], v[206:207]
    v_cvt_pk_bf16_f32 v108, v56, v57
    v_cvt_pk_bf16_f32 v109, v58, v59
    v_cvt_pk_bf16_f32 v110, v60, v61
    v_cvt_pk_bf16_f32 v111, v62, v63
    buffer_store_dwordx4 v[108:111], v5, s[12:15], s58 offen offset:3072 sc1
    s_barrier
c_wo_stat:
    s_mov_b32 s55, 0x3f803f80
    v_dot2_f32_bf16 v18, v96, s55, 0
    v_dot2_f32_bf16 v19, v96, v96, 0
    v_dot2_f32_bf16 v20, v97, s55, 0
    v_dot2_f32_bf16 v21, v97, v97, 0
    v_dot2_f32_bf16 v18, v98, s55, v18
    v_dot2_f32_bf16 v19, v98, v98, v19
    v_dot2_f32_bf16 v20, v99, s55, v20
    v_dot2_f32_bf16 v21, v99, v99, v21
    v_dot2_f32_bf16 v18, v100, s55, v18
    v_dot2_f32_bf16 v19, v100, v100, v19
    v_dot2_f32_bf16 v20, v101, s55, v20
    v_dot2_f32_bf16 v21, v101, v101, v21
    v_dot2_f32_bf16 v18, v102, s55, v18
    v_dot2_f32_bf16 v19, v102, v102, v19
    v_dot2_f32_bf16 v20, v103, s55, v20
    v_dot2_f32_bf16 v21, v103, v103, v21
    v_dot2_f32_bf16 v18, v104, s55, v18
    v_dot2_f32_bf16 v19, v104, v104, v19
    v_dot2_f32_bf16 v20, v105, s55, v20
    v_dot2_f32_bf16 v21, v105, v105, v21
    v_dot2_f32_bf16 v18, v106, s55, v18
    v_dot2_f32_bf16 v19, v106, v106, v19
    v_dot2_f32_bf16 v20, v107, s55, v20
    v_dot2_f32_bf16 v21, v107, v107, v21
    v_dot2_f32_bf16 v18, v108, s55, v18
    v_dot2_f32_bf16 v19, v108, v108, v19
    v_dot2_f32_bf16 v20, v109, s55, v20
    v_dot2_f32_bf16 v21, v109, v109, v21
    v_dot2_f32_bf16 v18, v110, s55, v18
    v_dot2_f32_bf16 v19, v110, v110, v19
    v_dot2_f32_bf16 v20, v111, s55, v20
    v_dot2_f32_bf16 v21, v111, v111, v21
    v_lshlrev_b32 v16, 3, v1
    s_lshl_b32 s3, s48, 12
    s_lshl_b32 s55, s7, 8
    s_add_u32 s3, s3, s55
    v_permlane32_swap_b32 v18, v20
    v_permlane32_swap_b32 v19, v21
    s_lshl_b32 s55, s9, 18
    v_pk_add_f32 v[18:19], v[18:19], v[20:21]
    s_add_u32 s3, s3, s55
    s_add_u32 s3, s3, 63176704
    v_permlane32_swap_b32 v18, v20
    v_permlane32_swap_b32 v19, v21
    v_pk_add_f32 v[18:19], v[18:19], v[20:21]
    s_mov_b32 exec_hi, 0
    buffer_store_dwordx2 v[18:19], v16, s[12:15], s3 offen sc1
    s_mov_b64 exec, -1
    s_cmp_lg_u32 s9, -1
    s_cbranch_scc1 c_wo_pub
    s_barrier
    v_mov_b32 v24, 159492
non_7:
    ds_read_b32 v25, v24
    s_waitcnt lgkmcnt(0)
    v_readfirstlane_b32 s10, v25
    s_cmp_eq_u32 s10, 0
    s_cbranch_scc1 non_7
c_wo_pub:
    s_mul_i32 s55, s9, 786432
    s_add_u32 s55, s55, 66060288
    v_and_b32 v24, 63, v0
    s_and_b32 s56, s11, 0xe0
    v_lshrrev_b32 v25, 5, v24
    v_add_u32 v24, s56, v24
    v_and_b32 v24, 255, v24
    v_lshlrev_b32 v24, 10, v24
    v_lshl_add_u32 v24, v25, 8, v24
    s_bfe_u32 s56, s11, 0x20003
    s_and_b32 s57, s11, 7
    s_lshl_b32 s56, s56, 7
    s_lshl_b32 s57, s57, 2
    s_add_u32 s55, s55, s56
    s_add_u32 s55, s55, s57
    s_and_b32 s57, s6, s9
    s_bfe_i32 s57, s57, 0x10000
    v_mov_b32 v25, 159488
    v_mov_b32 v26, 1
    v_mov_b32 v27, s10
    s_mov_b64 exec, 1
    s_waitcnt vmcnt(0)
    ds_add_rtn_u32 v26, v25, v26
    s_waitcnt lgkmcnt(0)
    v_readfirstlane_b32 s56, v26
    s_and_b32 s56, s56, 3
    s_cmp_lg_u32 s56, 3
    s_cbranch_scc1 pub_8
    s_mov_b32 exec_lo, -1
    s_mov_b32 exec_hi, s57
    buffer_store_dword v27, v24, s[12:15], s55 offen sc1
pub_8:
    s_mov_b64 exec, -1
    s_cmp_eq_u32 s9, -1
    s_cbranch_scc1 c_wo_pub3
    s_barrier
c_wo_pub3:
    s_add_u32 s9, s9, 1
    s_bitcmp1_b32 s9, 0
    s_cbranch_scc1 c_qkvB
    s_branch c_qkvA
c_wo_fin:
    s_barrier
    v_pk_add_f32 v[32:33], v[32:33], v[176:177]
    v_pk_add_f32 v[34:35], v[34:35], v[178:179]
    v_pk_add_f32 v[36:37], v[36:37], v[180:181]
    v_pk_add_f32 v[38:39], v[38:39], v[182:183]
    v_pk_add_f32 v[40:41], v[40:41], v[184:185]
    v_pk_add_f32 v[42:43], v[42:43], v[186:187]
    v_pk_add_f32 v[44:45], v[44:45], v[188:189]
    v_pk_add_f32 v[46:47], v[46:47], v[190:191]
    v_pk_add_f32 v[48:49], v[48:49], v[192:193]
    v_pk_add_f32 v[50:51], v[50:51], v[194:195]
    v_pk_add_f32 v[52:53], v[52:53], v[196:197]
    v_pk_add_f32 v[54:55], v[54:55], v[198:199]
    v_pk_add_f32 v[56:57], v[56:57], v[200:201]
    v_pk_add_f32 v[58:59], v[58:59], v[202:203]
    v_pk_add_f32 v[60:61], v[60:61], v[204:205]
    v_pk_add_f32 v[62:63], v[62:63], v[206:207]
    v_cvt_pk_bf16_f32 v96, v32, v33
    v_cvt_pk_bf16_f32 v97, v34, v35
    v_cvt_pk_bf16_f32 v98, v36, v37
    v_cvt_pk_bf16_f32 v99, v38, v39
    v_cvt_pk_bf16_f32 v100, v40, v41
    v_cvt_pk_bf16_f32 v101, v42, v43
    v_cvt_pk_bf16_f32 v102, v44, v45
    v_cvt_pk_bf16_f32 v103, v46, v47
    v_cvt_pk_bf16_f32 v104, v48, v49
    v_cvt_pk_bf16_f32 v105, v50, v51
    v_cvt_pk_bf16_f32 v106, v52, v53
    v_cvt_pk_bf16_f32 v107, v54, v55
    v_cvt_pk_bf16_f32 v108, v56, v57
    v_cvt_pk_bf16_f32 v109, v58, v59
    v_cvt_pk_bf16_f32 v110, v60, v61
    v_cvt_pk_bf16_f32 v111, v62, v63
    s_mov_b32 s28, s44
    s_mov_b32 s29, s45
    s_mov_b32 s30, 4194304
    s_mov_b32 s31, 0x00020000
    v_and_b32 v16, 31, v1
    v_mul_u32_u24 v16, 144, v16
    v_lshl_add_u32 v16, v3, 3, v16
    v_mul_u32_u24 v17, 4608, v2
    v_add_u32 v16, v16, v17
    ds_write_b64 v16, v[96:97] offset:0
    ds_write_b64 v16, v[98:99] offset:16
    ds_write_b64 v16, v[100:101] offset:32
    ds_write_b64 v16, v[102:103] offset:48
    ds_write_b64 v16, v[104:105] offset:64
    ds_write_b64 v16, v[106:107] offset:80
    ds_write_b64 v16, v[108:109] offset:96
    ds_write_b64 v16, v[110:111] offset:112
    v_lshrrev_b32 v18, 3, v1
    v_and_b32 v19, 7, v1
    v_mul_u32_u24 v20, 144, v18
    v_lshl_add_u32 v20, v19, 4, v20
    v_add_u32 v20, v20, v17
    v_lshlrev_b32 v21, 11, v18
    v_lshl_add_u32 v21, v19, 4, v21
    s_lshl_b32 s3, s48, 16
    s_lshl_b32 s55, s7, 7
    s_add_u32 s3, s3, s55
    s_waitcnt lgkmcnt(0)
    ds_read_b128 v[32:35], v20 offset:0
    ds_read_b128 v[36:39], v20 offset:1152
    ds_read_b128 v[40:43], v20 offset:2304
    ds_read_b128 v[44:47], v20 offset:3456
    s_waitcnt lgkmcnt(3)
    buffer_store_dwordx4 v[32:35], v21, s[28:31], s3 offen sc1
    s_add_u32 s3, s3, 16384
    s_waitcnt lgkmcnt(2)
    buffer_store_dwordx4 v[36:39], v21, s[28:31], s3 offen sc1
    s_add_u32 s3, s3, 16384
    s_waitcnt lgkmcnt(1)
    buffer_store_dwordx4 v[40:43], v21, s[28:31], s3 offen sc1
    s_add_u32 s3, s3, 16384
    s_waitcnt lgkmcnt(0)
    buffer_store_dwordx4 v[44:47], v21, s[28:31], s3 offen sc1
    s_add_u32 s3, s3, 16384
    s_branch k_exit
c_prep_tail:
    s_lshl_b32 s56, s7, 12
    s_add_u32 s58, s55, s56
    v_lshlrev_b32 v5, 4, v1
    s_lshl_b32 s3, s8, 12
    s_add_u32 s3, s3, 131072
    v_lshrrev_b32 v18, 1, v17
    v_lshlrev_b32 v18, 10, v18
    v_lshl_add_u32 v18, v16, 4, v18
    v_and_b32 v17, 1, v17
    v_lshl_add_u32 v18, v17, 3, v18
    v_add_u32 v18, s3, v18
    v_add_u32 v19, s3, v5
    s_waitcnt vmcnt(3)
    ds_write_b64 v18, v[32:33] offset:0
    ds_write_b64 v18, v[34:35] offset:512
    s_waitcnt vmcnt(2)
    ds_write_b64 v18, v[36:37] offset:128
    ds_write_b64 v18, v[38:39] offset:640
    s_waitcnt vmcnt(1)
    ds_write_b64 v18, v[40:41] offset:256
    ds_write_b64 v18, v[42:43] offset:768
    s_waitcnt vmcnt(0)
    ds_write_b64 v18, v[44:45] offset:384
    ds_write_b64 v18, v[46:47] offset:896
    s_waitcnt lgkmcnt(0)
    ds_read_b128 v[96:99], v19 offset:0
    ds_read_b128 v[100:103], v19 offset:1024
    ds_read_b128 v[104:107], v19 offset:2048
    ds_read_b128 v[108:111], v19 offset:3072
    s_waitcnt lgkmcnt(3)
    buffer_store_dwordx4 v[96:99], v5, s[12:15], s58 offen offset:0 sc1
    s_waitcnt lgkmcnt(2)
    buffer_store_dwordx4 v[100:103], v5, s[12:15], s58 offen offset:1024 sc1
    s_waitcnt lgkmcnt(1)
    buffer_store_dwordx4 v[104:107], v5, s[12:15], s58 offen offset:2048 sc1
    s_waitcnt lgkmcnt(0)
    buffer_store_dwordx4 v[108:111], v5, s[12:15], s58 offen offset:3072 sc1
    s_branch c_wo_stat
.p2align 6
c_qkvB:
    v_and_b32 v1, 63, v0
    v_lshrrev_b32 v2, 6, v0
    v_lshlrev_b32 v5, 4, v1
    v_lshrrev_b32 v3, 5, v1
    v_and_b32 v4, 15, v0
    v_bfe_u32 v7, v1, 4, 1
    v_lshl_add_u32 v6, v7, 5, v4
    v_lshlrev_b32 v6, 4, v6
    v_lshl_add_u32 v6, v3, 10, v6
    s_lshr_b32 s48, s6, 1
    s_lshl_b32 s48, s48, 2
    s_add_u32 s48, s48, s8
    s_lshl_b32 s55, s48, 17
    s_lshl_b32 s56, s9, 22
    s_add_u32 s55, s55, s56
    s_add_u32 s16, s4, s55
    s_addc_u32 s17, s5, 0
    s_mov_b32 s18, 65536
    s_mov_b32 s19, 0x00020000
    s_add_u32 s56, s55, 65536
    s_add_u32 s20, s4, s56
    s_addc_u32 s21, s5, 0
    s_mov_b32 s22, 65536
    s_mov_b32 s23, 0x00020000
    s_lshl_b32 s49, s7, 12
    s_add_u32 s49, s49, s55
    s_and_b32 s56, s6, 1
    s_lshl_b32 s56, s56, 11
    s_add_u32 s49, s49, s56
    s_add_u32 s49, s49, 16777216
    s_movk_i32 s54, 4096
    v_lshrrev_b32 v16, 2, v4
    v_lshl_add_u32 v18, v7, 2, v16
    v_lshl_add_u32 v18, v3, 4, v18
    v_lshlrev_b32 v18, 6, v18
    v_and_b32 v17, 3, v4
    v_lshl_add_u32 v18, v17, 3, v18
    v_lshl_add_u32 v26, v7, 5, v18
    v_xor_b32 v27, 32, v26
    v_mov_b32 v24, v26
    v_mov_b32 v25, v27
    v_and_b32 v18, 0x30, v1
    v_add_u32 v10, 155648, v18
    v_lshlrev_b32 v11, 2, v4
    v_add_u32 v11, 155648, v11
    v_lshl_add_u32 v8, v2, 8, v11
    v_lshl_add_u32 v9, v2, 8, v10
    s_lshr_b32 s3, s8, 1
    s_and_b32 s55, s8, 1
    s_lshl_b32 s3, s3, 14
    s_lshl_b32 s55, s55, 12
    s_add_u32 s3, s3, s55
    s_add_u32 s3, s3, 81920
    v_lshl_add_u32 v12, v3, 5, v4
    v_lshlrev_b32 v12, 4, v12
    v_lshl_add_u32 v12, v7, 10, v12
    v_add_u32 v12, s3, v12
    v_add_u32 v13, s3, v5
    s_lshr_b32 s84, s9, 1
    s_lshl_b32 s84, s84, 23
    s_lshl_b32 s3, s7, 19
    s_add_u32 s84, s84, s3
    s_and_b32 s3, s6, 1
    s_lshl_b32 s3, s3, 18
    s_add_u32 s84, s84, s3
    s_add_u32 s84, s84, 33554432
    s_lshr_b32 s86, s6, 1
    s_lshl_b32 s3, s86, 15
    s_add_u32 s84, s84, s3
    s_sub_u32 s84, s84, 81920
    s_add_u32 s85, s84, 8192
    s_mul_i32 s53, s9, 786432
    s_add_u32 s53, s53, 66322432
    s_and_b32 s3, s11, 31
    s_lshl_b32 s3, s3, 10
    s_add_u32 s53, s53, s3
    s_lshr_b32 s3, s86, 1
    s_lshl_b32 s3, s3, 7
    s_add_u32 s53, s53, s3
    s_and_b32 s3, s86, 1
    s_lshl_b32 s3, s3, 2
    s_add_u32 s3, s3, s8
    s_lshl_b32 s3, s3, 2
    s_add_u32 s53, s53, s3
    v_lshlrev_b32 v28, 15, v1
    v_mov_b32 v29, s10
    v_mov_b32 v32, 0
    v_mov_b32 v33, 0
    v_mov_b32 v34, 0
    v_mov_b32 v35, 0
    v_mov_b32 v36, 0
    v_mov_b32 v37, 0
    v_mov_b32 v38, 0
    v_mov_b32 v39, 0
    v_mov_b32 v40, 0
    v_mov_b32 v41, 0
    v_mov_b32 v42, 0
    v_mov_b32 v43, 0
    v_mov_b32 v44, 0
    v_mov_b32 v45, 0
    v_mov_b32 v46, 0
    v_mov_b32 v47, 0
    v_mov_b32 v48, 0
    v_mov_b32 v49, 0
    v_mov_b32 v50, 0
    v_mov_b32 v51, 0
    v_mov_b32 v52, 0
    v_mov_b32 v53, 0
    v_mov_b32 v54, 0
    v_mov_b32 v55, 0
    v_mov_b32 v56, 0
    v_mov_b32 v57, 0
    v_mov_b32 v58, 0
    v_mov_b32 v59, 0
    v_mov_b32 v60, 0
    v_mov_b32 v61, 0
    v_mov_b32 v62, 0
    v_mov_b32 v63, 0
    v_mov_b32 v64, 0
    v_mov_b32 v65, 0
    v_mov_b32 v66, 0
    v_mov_b32 v67, 0
    v_mov_b32 v68, 0
    v_mov_b32 v69, 0
    v_mov_b32 v70, 0
    v_mov_b32 v71, 0
    v_mov_b32 v72, 0
    v_mov_b32 v73, 0
    v_mov_b32 v74, 0
    v_mov_b32 v75, 0
    v_mov_b32 v76, 0
    v_mov_b32 v77, 0
    v_mov_b32 v78, 0
    v_mov_b32 v79, 0
    v_mov_b32 v80, 0
    v_mov_b32 v81, 0
    v_mov_b32 v82, 0
    v_mov_b32 v83, 0
    v_mov_b32 v84, 0
    v_mov_b32 v85, 0
    v_mov_b32 v86, 0
    v_mov_b32 v87, 0
    v_mov_b32 v88, 0
    v_mov_b32 v89, 0
    v_mov_b32 v90, 0
    v_mov_b32 v91, 0
    v_mov_b32 v92, 0
    v_mov_b32 v93, 0
    v_mov_b32 v94, 0
    v_mov_b32 v95, 0
    v_mov_b32 v96, 0
    v_mov_b32 v97, 0
    v_mov_b32 v98, 0
    v_mov_b32 v99, 0
    v_mov_b32 v100, 0
    v_mov_b32 v101, 0
    v_mov_b32 v102, 0
    v_mov_b32 v103, 0
    v_mov_b32 v104, 0
    v_mov_b32 v105, 0
    v_mov_b32 v106, 0
    v_mov_b32 v107, 0
    v_mov_b32 v108, 0
    v_mov_b32 v109, 0
    v_mov_b32 v110, 0
    v_mov_b32 v111, 0
    v_mov_b32 v112, 0
    v_mov_b32 v113, 0
    v_mov_b32 v114, 0
    v_mov_b32 v115, 0
    v_mov_b32 v116, 0
    v_mov_b32 v117, 0
    v_mov_b32 v118, 0
    v_mov_b32 v119, 0
    v_mov_b32 v120, 0
    v_mov_b32 v121, 0
    v_mov_b32 v122, 0
    v_mov_b32 v123, 0
    v_mov_b32 v124, 0
    v_mov_b32 v125, 0
    v_mov_b32 v126, 0
    v_mov_b32 v127, 0
    s_mov_b32 s50, 8192
    s_mov_b32 s58, 6144
    s_mov_b32 s51, 12288
    s_mov_b32 s59, 10240
    s_mov_b32 s52, 0
    s_mul_i32 s60, s9, 786432
    s_add_u32 s60, s60, 65273856
    s_lshl_b32 s61, s11, 10
    s_add_u32 s60, s60, s61
    s_and_b32 s61, s8, 2
    s_lshl_b32 s61, s61, 7
    s_add_u32 s60, s60, s61
    s_add_u32 s61, s60, 128
    s_mov_b32 s98, s10
    s_mov_b32 s99, s10
    s_mov_b32 s3, 0x100000
cp_9:
    s_load_dwordx8 s[64:71], s[4:5], s60 glc
    s_load_dwordx8 s[72:79], s[4:5], s61 glc
    s_sub_u32 s3, s3, 1
    s_cbranch_scc1 cp_9_ok
    s_waitcnt lgkmcnt(0)
    s_xor_b64 s[100:101], s[64:65], s[98:99]
    s_xor_b64 s[64:65], s[66:67], s[98:99]
    s_or_b64 s[100:101], s[100:101], s[64:65]
    s_xor_b64 s[64:65], s[68:69], s[98:99]
    s_or_b64 s[100:101], s[100:101], s[64:65]
    s_xor_b64 s[64:65], s[70:71], s[98:99]
    s_or_b64 s[100:101], s[100:101], s[64:65]
    s_xor_b64 s[64:65], s[72:73], s[98:99]
    s_or_b64 s[100:101], s[100:101], s[64:65]
    s_xor_b64 s[64:65], s[74:75], s[98:99]
    s_or_b64 s[100:101], s[100:101], s[64:65]
    s_xor_b64 s[64:65], s[76:77], s[98:99]
    s_or_b64 s[100:101], s[100:101], s[64:65]
    s_xor_b64 s[64:65], s[78:79], s[98:99]
    s_or_b64 s[100:101], s[100:101], s[64:65]
    s_cbranch_scc1 cp_9
cp_9_ok:
    s_waitcnt lgkmcnt(0)
    buffer_load_dwordx4 v[152:155], v6, s[16:19], 0 offen offset:0 sc1
    buffer_load_dwordx4 v[156:159], v6, s[16:19], 0 offen offset:256 sc1
    buffer_load_dwordx4 v[160:163], v6, s[20:23], 0 offen offset:0 sc1
    buffer_load_dwordx4 v[164:167], v6, s[20:23], 0 offen offset:256 sc1
    buffer_load_dwordx4 v[168:171], v6, s[16:19], 0 offen offset:2048 sc1
    buffer_load_dwordx4 v[172:175], v6, s[16:19], 0 offen offset:2304 sc1
    buffer_load_dwordx4 v[176:179], v6, s[20:23], 0 offen offset:2048 sc1
    buffer_load_dwordx4 v[180:183], v6, s[20:23], 0 offen offset:2304 sc1
    s_barrier
    ds_read_b64_tr_b16 v[128:129], v24 offset:0
    ds_read_b64_tr_b16 v[130:131], v24 offset:512
    ds_read_b64_tr_b16 v[132:133], v25 offset:0
    ds_read_b64_tr_b16 v[134:135], v25 offset:512
    ds_read_b64_tr_b16 v[136:137], v24 offset:8192
    ds_read_b64_tr_b16 v[138:139], v24 offset:8704
    ds_read_b64_tr_b16 v[140:141], v25 offset:8192
    ds_read_b64_tr_b16 v[142:143], v25 offset:8704
    ds_read_b64_tr_b16 v[144:145], v24 offset:16384
    ds_read_b64_tr_b16 v[146:147], v24 offset:16896
    buffer_load_dwordx4 a[0:3], v6, s[16:19], s54 offen offset:0 sc1
    buffer_load_dwordx4 a[4:7], v6, s[16:19], s54 offen offset:256 sc1
    buffer_load_dwordx4 a[8:11], v6, s[20:23], s54 offen offset:0 sc1
    buffer_load_dwordx4 a[12:15], v6, s[20:23], s54 offen offset:256 sc1
    buffer_load_dwordx4 a[16:19], v6, s[16:19], s54 offen offset:2048 sc1
    buffer_load_dwordx4 a[20:23], v6, s[16:19], s54 offen offset:2304 sc1
    s_mov_b32 s54, 7
.p2align 3
c_qkvB_loop:
    s_waitcnt vmcnt(12) lgkmcnt(8)
    v_mfma_f32_16x16x32_bf16 v[32:35], v[128:131], v[152:155], v[32:35]
    ds_read_b64_tr_b16 v[148:149], v25 offset:16384
    buffer_load_dwordx4 a[24:27], v6, s[20:23], s58 offen offset:0 sc1
    v_mfma_f32_16x16x32_bf16 v[36:39], v[128:131], v[156:159], v[36:39]
    ds_read_b64_tr_b16 v[150:151], v25 offset:16896
    s_waitcnt lgkmcnt(8)
    v_mfma_f32_16x16x32_bf16 v[52:55], v[132:135], v[156:159], v[52:55]
    v_mfma_f32_16x16x32_bf16 v[48:51], v[132:135], v[152:155], v[48:51]
    s_waitcnt lgkmcnt(6)
    v_mfma_f32_16x16x32_bf16 v[64:67], v[136:139], v[152:155], v[64:67]
    v_mfma_f32_16x16x32_bf16 v[68:71], v[136:139], v[156:159], v[68:71]
    s_waitcnt lgkmcnt(4)
    v_mfma_f32_16x16x32_bf16 v[84:87], v[140:143], v[156:159], v[84:87]
    buffer_load_dwordx4 a[28:31], v6, s[20:23], s58 offen offset:256 sc1
    v_mfma_f32_16x16x32_bf16 v[80:83], v[140:143], v[152:155], v[80:83]
    s_waitcnt lgkmcnt(2)
    v_mfma_f32_16x16x32_bf16 v[96:99], v[152:155], v[144:147], v[96:99]
    v_mfma_f32_16x16x32_bf16 v[100:103], v[156:159], v[144:147], v[100:103]
    s_waitcnt lgkmcnt(0)
    v_mfma_f32_16x16x32_bf16 v[116:119], v[156:159], v[148:151], v[116:119]
    v_mfma_f32_16x16x32_bf16 v[112:115], v[152:155], v[148:151], v[112:115]
    s_waitcnt vmcnt(12)
    v_mfma_f32_16x16x32_bf16 v[40:43], v[128:131], v[160:163], v[40:43]
    buffer_load_dwordx4 v[152:155], v6, s[16:19], s50 offen offset:0 sc1
    v_mfma_f32_16x16x32_bf16 v[44:47], v[128:131], v[164:167], v[44:47]
    v_mfma_f32_16x16x32_bf16 v[60:63], v[132:135], v[164:167], v[60:63]
    ds_read_b64_tr_b16 v[128:129], v24 offset:2048
    v_mfma_f32_16x16x32_bf16 v[56:59], v[132:135], v[160:163], v[56:59]
    ds_read_b64_tr_b16 v[130:131], v24 offset:2560
    v_mfma_f32_16x16x32_bf16 v[72:75], v[136:139], v[160:163], v[72:75]
    ds_read_b64_tr_b16 v[132:133], v25 offset:2048
    v_mfma_f32_16x16x32_bf16 v[76:79], v[136:139], v[164:167], v[76:79]
    ds_read_b64_tr_b16 v[134:135], v25 offset:2560
    v_mfma_f32_16x16x32_bf16 v[92:95], v[140:143], v[164:167], v[92:95]
    ds_read_b64_tr_b16 v[136:137], v24 offset:10240
    buffer_load_dwordx4 v[156:159], v6, s[16:19], s50 offen offset:256 sc1
    v_mfma_f32_16x16x32_bf16 v[88:91], v[140:143], v[160:163], v[88:91]
    ds_read_b64_tr_b16 v[138:139], v24 offset:10752
    v_mfma_f32_16x16x32_bf16 v[104:107], v[160:163], v[144:147], v[104:107]
    ds_read_b64_tr_b16 v[140:141], v25 offset:10240
    v_mfma_f32_16x16x32_bf16 v[108:111], v[164:167], v[144:147], v[108:111]
    ds_read_b64_tr_b16 v[142:143], v25 offset:10752
    v_mfma_f32_16x16x32_bf16 v[124:127], v[164:167], v[148:151], v[124:127]
    ds_read_b64_tr_b16 v[144:145], v24 offset:18432
    v_mfma_f32_16x16x32_bf16 v[120:123], v[160:163], v[148:151], v[120:123]
    ds_read_b64_tr_b16 v[146:147], v24 offset:18944
    s_waitcnt vmcnt(12) lgkmcnt(8)
    v_mfma_f32_16x16x32_bf16 v[32:35], v[128:131], v[168:171], v[32:35]
    ds_read_b64_tr_b16 v[148:149], v25 offset:18432
    buffer_load_dwordx4 v[160:163], v6, s[20:23], s58 offen offset:2048 sc1
    v_mfma_f32_16x16x32_bf16 v[36:39], v[128:131], v[172:175], v[36:39]
    ds_read_b64_tr_b16 v[150:151], v25 offset:18944
    s_waitcnt lgkmcnt(8)
    v_mfma_f32_16x16x32_bf16 v[52:55], v[132:135], v[172:175], v[52:55]
    v_mfma_f32_16x16x32_bf16 v[48:51], v[132:135], v[168:171], v[48:51]
    s_waitcnt lgkmcnt(6)
    v_mfma_f32_16x16x32_bf16 v[64:67], v[136:139], v[168:171], v[64:67]
    v_mfma_f32_16x16x32_bf16 v[68:71], v[136:139], v[172:175], v[68:71]
    s_waitcnt lgkmcnt(4)
    v_mfma_f32_16x16x32_bf16 v[84:87], v[140:143], v[172:175], v[84:87]
    buffer_load_dwordx4 v[164:167], v6, s[20:23], s58 offen offset:2304 sc1
    v_mfma_f32_16x16x32_bf16 v[80:83], v[140:143], v[168:171], v[80:83]
    s_waitcnt lgkmcnt(2)
    v_mfma_f32_16x16x32_bf16 v[96:99], v[168:171], v[144:147], v[96:99]
    v_mfma_f32_16x16x32_bf16 v[100:103], v[172:175], v[144:147], v[100:103]
    s_waitcnt lgkmcnt(0)
    v_mfma_f32_16x16x32_bf16 v[116:119], v[172:175], v[148:151], v[116:119]
    v_mfma_f32_16x16x32_bf16 v[112:115], v[168:171], v[148:151], v[112:115]
    s_waitcnt vmcnt(12)
    v_mfma_f32_16x16x32_bf16 v[40:43], v[128:131], v[176:179], v[40:43]
    buffer_load_dwordx4 v[168:171], v6, s[16:19], s50 offen offset:2048 sc1
    v_mfma_f32_16x16x32_bf16 v[44:47], v[128:131], v[180:183], v[44:47]
    v_mfma_f32_16x16x32_bf16 v[60:63], v[132:135], v[180:183], v[60:63]
    ds_read_b64_tr_b16 v[128:129], v24 offset:4096
    v_mfma_f32_16x16x32_bf16 v[56:59], v[132:135], v[176:179], v[56:59]
    ds_read_b64_tr_b16 v[130:131], v24 offset:4608
    v_mfma_f32_16x16x32_bf16 v[72:75], v[136:139], v[176:179], v[72:75]
    ds_read_b64_tr_b16 v[132:133], v25 offset:4096
    v_mfma_f32_16x16x32_bf16 v[76:79], v[136:139], v[180:183], v[76:79]
    ds_read_b64_tr_b16 v[134:135], v25 offset:4608
    v_mfma_f32_16x16x32_bf16 v[92:95], v[140:143], v[180:183], v[92:95]
    ds_read_b64_tr_b16 v[136:137], v24 offset:12288
    buffer_load_dwordx4 v[172:175], v6, s[16:19], s50 offen offset:2304 sc1
    v_mfma_f32_16x16x32_bf16 v[88:91], v[140:143], v[176:179], v[88:91]
    ds_read_b64_tr_b16 v[138:139], v24 offset:12800
    v_mfma_f32_16x16x32_bf16 v[104:107], v[176:179], v[144:147], v[104:107]
    ds_read_b64_tr_b16 v[140:141], v25 offset:12288
    v_mfma_f32_16x16x32_bf16 v[108:111], v[180:183], v[144:147], v[108:111]
    ds_read_b64_tr_b16 v[142:143], v25 offset:12800
    v_mfma_f32_16x16x32_bf16 v[124:127], v[180:183], v[148:151], v[124:127]
    ds_read_b64_tr_b16 v[144:145], v24 offset:20480
    v_mfma_f32_16x16x32_bf16 v[120:123], v[176:179], v[148:151], v[120:123]
    ds_read_b64_tr_b16 v[146:147], v24 offset:20992
    s_waitcnt vmcnt(12) lgkmcnt(8)
    v_mfma_f32_16x16x32_bf16 v[32:35], v[128:131], a[0:3], v[32:35]
    ds_read_b64_tr_b16 v[148:149], v25 offset:20480
    buffer_load_dwordx4 v[176:179], v6, s[20:23], s59 offen offset:0 sc1
    v_mfma_f32_16x16x32_bf16 v[36:39], v[128:131], a[4:7], v[36:39]
    ds_read_b64_tr_b16 v[150:151], v25 offset:20992
    s_waitcnt lgkmcnt(8)
    v_mfma_f32_16x16x32_bf16 v[52:55], v[132:135], a[4:7], v[52:55]
    s_add_u32 s58, s58, 8192
    v_mfma_f32_16x16x32_bf16 v[48:51], v[132:135], a[0:3], v[48:51]
    s_waitcnt lgkmcnt(6)
    v_mfma_f32_16x16x32_bf16 v[64:67], v[136:139], a[0:3], v[64:67]
    s_add_u32 s50, s50, 8192
    v_mfma_f32_16x16x32_bf16 v[68:71], v[136:139], a[4:7], v[68:71]
    s_waitcnt lgkmcnt(4)
    v_mfma_f32_16x16x32_bf16 v[84:87], v[140:143], a[4:7], v[84:87]
    buffer_load_dwordx4 v[180:183], v6, s[20:23], s59 offen offset:256 sc1
    v_mfma_f32_16x16x32_bf16 v[80:83], v[140:143], a[0:3], v[80:83]
    s_waitcnt lgkmcnt(2)
    v_mfma_f32_16x16x32_bf16 v[96:99], a[0:3], v[144:147], v[96:99]
    s_add_u32 s52, s52, 24576
    v_mfma_f32_16x16x32_bf16 v[100:103], a[4:7], v[144:147], v[100:103]
    s_cmp_eq_u32 s52, 147456
    s_waitcnt lgkmcnt(0)
    v_mfma_f32_16x16x32_bf16 v[116:119], a[4:7], v[148:151], v[116:119]
    s_cselect_b32 s52, 0, s52
    v_mfma_f32_16x16x32_bf16 v[112:115], a[0:3], v[148:151], v[112:115]
    s_waitcnt vmcnt(12)
    v_mfma_f32_16x16x32_bf16 v[40:43], v[128:131], a[8:11], v[40:43]
    buffer_load_dwordx4 a[0:3], v6, s[16:19], s51 offen offset:0 sc1
    v_mfma_f32_16x16x32_bf16 v[44:47], v[128:131], a[12:15], v[44:47]
    s_sub_u32 s54, s54, 1
    v_mfma_f32_16x16x32_bf16 v[60:63], v[132:135], a[12:15], v[60:63]
    ds_read_b64_tr_b16 v[128:129], v24 offset:6144
    v_mfma_f32_16x16x32_bf16 v[56:59], v[132:135], a[8:11], v[56:59]
    ds_read_b64_tr_b16 v[130:131], v24 offset:6656
    v_mfma_f32_16x16x32_bf16 v[72:75], v[136:139], a[8:11], v[72:75]
    ds_read_b64_tr_b16 v[132:133], v25 offset:6144
    v_mfma_f32_16x16x32_bf16 v[76:79], v[136:139], a[12:15], v[76:79]
    ds_read_b64_tr_b16 v[134:135], v25 offset:6656
    v_mfma_f32_16x16x32_bf16 v[92:95], v[140:143], a[12:15], v[92:95]
    ds_read_b64_tr_b16 v[136:137], v24 offset:14336
    buffer_load_dwordx4 a[4:7], v6, s[16:19], s51 offen offset:256 sc1
    v_mfma_f32_16x16x32_bf16 v[88:91], v[140:143], a[8:11], v[88:91]
    ds_read_b64_tr_b16 v[138:139], v24 offset:14848
    v_mfma_f32_16x16x32_bf16 v[104:107], a[8:11], v[144:147], v[104:107]
    ds_read_b64_tr_b16 v[140:141], v25 offset:14336
    v_mfma_f32_16x16x32_bf16 v[108:111], a[12:15], v[144:147], v[108:111]
    ds_read_b64_tr_b16 v[142:143], v25 offset:14848
    v_mfma_f32_16x16x32_bf16 v[124:127], a[12:15], v[148:151], v[124:127]
    ds_read_b64_tr_b16 v[144:145], v24 offset:22528
    v_mfma_f32_16x16x32_bf16 v[120:123], a[8:11], v[148:151], v[120:123]
    ds_read_b64_tr_b16 v[146:147], v24 offset:23040
    s_waitcnt vmcnt(12) lgkmcnt(8)
    v_mfma_f32_16x16x32_bf16 v[32:35], v[128:131], a[16:19], v[32:35]
    ds_read_b64_tr_b16 v[148:149], v25 offset:22528
    buffer_load_dwordx4 a[8:11], v6, s[20:23], s59 offen offset:2048 sc1
    v_mfma_f32_16x16x32_bf16 v[36:39], v[128:131], a[20:23], v[36:39]
    ds_read_b64_tr_b16 v[150:151], v25 offset:23040
    s_waitcnt lgkmcnt(8)
    v_mfma_f32_16x16x32_bf16 v[52:55], v[132:135], a[20:23], v[52:55]
    v_add_u32 v24, s52, v26
    v_mfma_f32_16x16x32_bf16 v[48:51], v[132:135], a[16:19], v[48:51]
    s_waitcnt lgkmcnt(6)
    v_mfma_f32_16x16x32_bf16 v[64:67], v[136:139], a[16:19], v[64:67]
    v_add_u32 v25, s52, v27
    v_mfma_f32_16x16x32_bf16 v[68:71], v[136:139], a[20:23], v[68:71]
    s_waitcnt lgkmcnt(4)
    v_mfma_f32_16x16x32_bf16 v[84:87], v[140:143], a[20:23], v[84:87]
    buffer_load_dwordx4 a[12:15], v6, s[20:23], s59 offen offset:2304 sc1
    v_mfma_f32_16x16x32_bf16 v[80:83], v[140:143], a[16:19], v[80:83]
    s_waitcnt lgkmcnt(2)
    v_mfma_f32_16x16x32_bf16 v[96:99], a[16:19], v[144:147], v[96:99]
    s_add_u32 s59, s59, 8192
    v_mfma_f32_16x16x32_bf16 v[100:103], a[20:23], v[144:147], v[100:103]
    s_waitcnt lgkmcnt(0)
    v_mfma_f32_16x16x32_bf16 v[116:119], a[20:23], v[148:151], v[116:119]
    v_mfma_f32_16x16x32_bf16 v[112:115], a[16:19], v[148:151], v[112:115]
    s_barrier
    s_waitcnt vmcnt(12)
    v_mfma_f32_16x16x32_bf16 v[40:43], v[128:131], a[24:27], v[40:43]
    buffer_load_dwordx4 a[16:19], v6, s[16:19], s51 offen offset:2048 sc1
    v_mfma_f32_16x16x32_bf16 v[44:47], v[128:131], a[28:31], v[44:47]
    v_mfma_f32_16x16x32_bf16 v[60:63], v[132:135], a[28:31], v[60:63]
    ds_read_b64_tr_b16 v[128:129], v24 offset:0
    v_mfma_f32_16x16x32_bf16 v[56:59], v[132:135], a[24:27], v[56:59]
    ds_read_b64_tr_b16 v[130:131], v24 offset:512
    v_mfma_f32_16x16x32_bf16 v[72:75], v[136:139], a[24:27], v[72:75]
    ds_read_b64_tr_b16 v[132:133], v25 offset:0
    v_mfma_f32_16x16x32_bf16 v[76:79], v[136:139], a[28:31], v[76:79]
    ds_read_b64_tr_b16 v[134:135], v25 offset:512
    v_mfma_f32_16x16x32_bf16 v[92:95], v[140:143], a[28:31], v[92:95]
    ds_read_b64_tr_b16 v[136:137], v24 offset:8192
    buffer_load_dwordx4 a[20:23], v6, s[16:19], s51 offen offset:2304 sc1
    v_mfma_f32_16x16x32_bf16 v[88:91], v[140:143], a[24:27], v[88:91]
    ds_read_b64_tr_b16 v[138:139], v24 offset:8704
    v_mfma_f32_16x16x32_bf16 v[104:107], a[24:27], v[144:147], v[104:107]
    ds_read_b64_tr_b16 v[140:141], v25 offset:8192
    s_add_u32 s51, s51, 8192
    v_mfma_f32_16x16x32_bf16 v[108:111], a[28:31], v[144:147], v[108:111]
    ds_read_b64_tr_b16 v[142:143], v25 offset:8704
    v_mfma_f32_16x16x32_bf16 v[124:127], a[28:31], v[148:151], v[124:127]
    ds_read_b64_tr_b16 v[144:145], v24 offset:16384
    s_cmp_lg_u32 s54, 0
    v_mfma_f32_16x16x32_bf16 v[120:123], a[24:27], v[148:151], v[120:123]
    ds_read_b64_tr_b16 v[146:147], v24 offset:16896
    s_cbranch_scc1 c_qkvB_loop
    s_waitcnt vmcnt(12) lgkmcnt(8)
    v_mfma_f32_16x16x32_bf16 v[32:35], v[128:131], v[152:155], v[32:35]
    ds_read_b64_tr_b16 v[148:149], v25 offset:16384
    buffer_load_dwordx4 a[24:27], v6, s[20:23], s58 offen offset:0 sc1
    v_mfma_f32_16x16x32_bf16 v[36:39], v[128:131], v[156:159], v[36:39]
    ds_read_b64_tr_b16 v[150:151], v25 offset:16896
    s_waitcnt lgkmcnt(8)
    v_mfma_f32_16x16x32_bf16 v[52:55], v[132:135], v[156:159], v[52:55]
    ds_read_b32 v184, v8 offset:1280
    v_mfma_f32_16x16x32_bf16 v[48:51], v[132:135], v[152:155], v[48:51]
    ds_read_b32 v186, v8 offset:1344
    s_waitcnt lgkmcnt(8)
    v_mfma_f32_16x16x32_bf16 v[64:67], v[136:139], v[152:155], v[64:67]
    ds_read_b32 v188, v8 offset:1408
    v_mfma_f32_16x16x32_bf16 v[68:71], v[136:139], v[156:159], v[68:71]
    s_waitcnt lgkmcnt(7)
    v_mfma_f32_16x16x32_bf16 v[84:87], v[140:143], v[156:159], v[84:87]
    buffer_load_dwordx4 a[28:31], v6, s[20:23], s58 offen offset:256 sc1
    ds_read_b32 v190, v8 offset:1472
    v_mfma_f32_16x16x32_bf16 v[80:83], v[140:143], v[152:155], v[80:83]
    ds_read_b128 v[212:215], v10 offset:512
    s_waitcnt lgkmcnt(7)
    v_mfma_f32_16x16x32_bf16 v[96:99], v[152:155], v[144:147], v[96:99]
    ds_read_b128 v[216:219], v10 offset:576
    v_mfma_f32_16x16x32_bf16 v[100:103], v[156:159], v[144:147], v[100:103]
    s_waitcnt lgkmcnt(6)
    v_mfma_f32_16x16x32_bf16 v[116:119], v[156:159], v[148:151], v[116:119]
    v_mfma_f32_16x16x32_bf16 v[112:115], v[152:155], v[148:151], v[112:115]
    s_waitcnt vmcnt(12)
    v_mfma_f32_16x16x32_bf16 v[40:43], v[128:131], v[160:163], v[40:43]
    s_waitcnt lgkmcnt(0)
    v_fma_f32 v64, -v184, v212, v64
    v_fma_f32 v65, -v184, v213, v65
    v_mfma_f32_16x16x32_bf16 v[44:47], v[128:131], v[164:167], v[44:47]
    v_fma_f32 v66, -v184, v214, v66
    v_mfma_f32_16x16x32_bf16 v[60:63], v[132:135], v[164:167], v[60:63]
    ds_read_b64_tr_b16 v[128:129], v24 offset:2048
    v_fma_f32 v67, -v184, v215, v67
    v_mfma_f32_16x16x32_bf16 v[56:59], v[132:135], v[160:163], v[56:59]
    ds_read_b64_tr_b16 v[130:131], v24 offset:2560
    v_fma_f32 v68, -v186, v212, v68
    v_fma_f32 v69, -v186, v213, v69
    v_mfma_f32_16x16x32_bf16 v[72:75], v[136:139], v[160:163], v[72:75]
    ds_read_b64_tr_b16 v[132:133], v25 offset:2048
    v_fma_f32 v70, -v186, v214, v70
    v_mfma_f32_16x16x32_bf16 v[76:79], v[136:139], v[164:167], v[76:79]
    ds_read_b64_tr_b16 v[134:135], v25 offset:2560
    v_fma_f32 v71, -v186, v215, v71
    v_mfma_f32_16x16x32_bf16 v[92:95], v[140:143], v[164:167], v[92:95]
    ds_read_b64_tr_b16 v[136:137], v24 offset:10240
    v_fma_f32 v80, -v184, v216, v80
    v_fma_f32 v81, -v184, v217, v81
    v_mfma_f32_16x16x32_bf16 v[88:91], v[140:143], v[160:163], v[88:91]
    ds_read_b64_tr_b16 v[138:139], v24 offset:10752
    v_fma_f32 v82, -v184, v218, v82
    v_mfma_f32_16x16x32_bf16 v[104:107], v[160:163], v[144:147], v[104:107]
    ds_read_b64_tr_b16 v[140:141], v25 offset:10240
    v_fma_f32 v83, -v184, v219, v83
    v_mfma_f32_16x16x32_bf16 v[108:111], v[164:167], v[144:147], v[108:111]
    ds_read_b64_tr_b16 v[142:143], v25 offset:10752
    v_fma_f32 v84, -v186, v216, v84
    v_fma_f32 v85, -v186, v217, v85
    v_mfma_f32_16x16x32_bf16 v[124:127], v[164:167], v[148:151], v[124:127]
    ds_read_b64_tr_b16 v[144:145], v24 offset:18432
    v_fma_f32 v86, -v186, v218, v86
    v_mfma_f32_16x16x32_bf16 v[120:123], v[160:163], v[148:151], v[120:123]
    ds_read_b64_tr_b16 v[146:147], v24 offset:18944
    v_fma_f32 v87, -v186, v219, v87
    s_waitcnt vmcnt(10) lgkmcnt(8)
    v_mfma_f32_16x16x32_bf16 v[32:35], v[128:131], v[168:171], v[32:35]
    ds_read_b64_tr_b16 v[148:149], v25 offset:18432
    v_fma_f32 v72, -v188, v212, v72
    v_fma_f32 v73, -v188, v213, v73
    v_mfma_f32_16x16x32_bf16 v[36:39], v[128:131], v[172:175], v[36:39]
    ds_read_b64_tr_b16 v[150:151], v25 offset:18944
    v_fma_f32 v74, -v188, v214, v74
    s_waitcnt lgkmcnt(8)
    v_mfma_f32_16x16x32_bf16 v[52:55], v[132:135], v[172:175], v[52:55]
    v_fma_f32 v75, -v188, v215, v75
    ds_read_b128 v[152:155], v10 offset:384
    v_mfma_f32_16x16x32_bf16 v[48:51], v[132:135], v[168:171], v[48:51]
    v_fma_f32 v76, -v190, v212, v76
    v_fma_f32 v77, -v190, v213, v77
    ds_read_b128 v[156:159], v10 offset:448
    s_waitcnt lgkmcnt(8)
    v_mfma_f32_16x16x32_bf16 v[64:67], v[136:139], v[168:171], v[64:67]
    v_fma_f32 v78, -v190, v214, v78
    ds_read_b32 v185, v8 offset:2816
    v_mfma_f32_16x16x32_bf16 v[68:71], v[136:139], v[172:175], v[68:71]
    v_fma_f32 v79, -v190, v215, v79
    s_waitcnt lgkmcnt(7)
    v_mfma_f32_16x16x32_bf16 v[84:87], v[140:143], v[172:175], v[84:87]
    v_fma_f32 v88, -v188, v216, v88
    v_fma_f32 v89, -v188, v217, v89
    ds_read_b32 v187, v8 offset:2880
    v_mfma_f32_16x16x32_bf16 v[80:83], v[140:143], v[168:171], v[80:83]
    v_fma_f32 v90, -v188, v218, v90
    ds_read_b32 v189, v8 offset:2944
    s_waitcnt lgkmcnt(7)
    v_mfma_f32_16x16x32_bf16 v[96:99], v[168:171], v[144:147], v[96:99]
    v_fma_f32 v91, -v188, v219, v91
    ds_read_b32 v191, v8 offset:3008
    v_mfma_f32_16x16x32_bf16 v[100:103], v[172:175], v[144:147], v[100:103]
    v_fma_f32 v92, -v190, v216, v92
    v_fma_f32 v93, -v190, v217, v93
    s_waitcnt lgkmcnt(6)
    v_mfma_f32_16x16x32_bf16 v[116:119], v[172:175], v[148:151], v[116:119]
    v_fma_f32 v94, -v190, v218, v94
    v_mfma_f32_16x16x32_bf16 v[112:115], v[168:171], v[148:151], v[112:115]
    v_fma_f32 v95, -v190, v219, v95
    s_waitcnt vmcnt(8)
    v_mfma_f32_16x16x32_bf16 v[40:43], v[128:131], v[176:179], v[40:43]
    s_waitcnt lgkmcnt(0)
    v_fma_f32 v32, -v184, v152, v32
    v_fma_f32 v33, -v184, v153, v33
    v_mfma_f32_16x16x32_bf16 v[44:47], v[128:131], v[180:183], v[44:47]
    v_fma_f32 v34, -v184, v154, v34
    v_mfma_f32_16x16x32_bf16 v[60:63], v[132:135], v[180:183], v[60:63]
    ds_read_b64_tr_b16 v[128:129], v24 offset:4096
    v_fma_f32 v35, -v184, v155, v35
    v_fma_f32 v36, -v186, v152, v36
    v_mfma_f32_16x16x32_bf16 v[56:59], v[132:135], v[176:179], v[56:59]
    ds_read_b64_tr_b16 v[130:131], v24 offset:4608
    v_fma_f32 v37, -v186, v153, v37
    v_mfma_f32_16x16x32_bf16 v[72:75], v[136:139], v[176:179], v[72:75]
    ds_read_b64_tr_b16 v[132:133], v25 offset:4096
    v_fma_f32 v38, -v186, v154, v38
    v_fma_f32 v39, -v186, v155, v39
    v_mfma_f32_16x16x32_bf16 v[76:79], v[136:139], v[180:183], v[76:79]
    ds_read_b64_tr_b16 v[134:135], v25 offset:4608
    v_fma_f32 v48, -v184, v156, v48
    v_mfma_f32_16x16x32_bf16 v[92:95], v[140:143], v[180:183], v[92:95]
    ds_read_b64_tr_b16 v[136:137], v24 offset:12288
    v_fma_f32 v49, -v184, v157, v49
    v_fma_f32 v50, -v184, v158, v50
    v_mfma_f32_16x16x32_bf16 v[88:91], v[140:143], v[176:179], v[88:91]
    ds_read_b64_tr_b16 v[138:139], v24 offset:12800
    v_fma_f32 v51, -v184, v159, v51
    v_mfma_f32_16x16x32_bf16 v[104:107], v[176:179], v[144:147], v[104:107]
    ds_read_b64_tr_b16 v[140:141], v25 offset:12288
    v_fma_f32 v52, -v186, v156, v52
    v_fma_f32 v53, -v186, v157, v53
    v_mfma_f32_16x16x32_bf16 v[108:111], v[180:183], v[144:147], v[108:111]
    ds_read_b64_tr_b16 v[142:143], v25 offset:12800
    v_fma_f32 v54, -v186, v158, v54
    v_mfma_f32_16x16x32_bf16 v[124:127], v[180:183], v[148:151], v[124:127]
    ds_read_b64_tr_b16 v[144:145], v24 offset:20480
    v_fma_f32 v55, -v186, v159, v55
    v_mfma_f32_16x16x32_bf16 v[120:123], v[176:179], v[148:151], v[120:123]
    ds_read_b64_tr_b16 v[146:147], v24 offset:20992
    s_waitcnt vmcnt(6) lgkmcnt(8)
    v_mfma_f32_16x16x32_bf16 v[32:35], v[128:131], a[0:3], v[32:35]
    ds_read_b64_tr_b16 v[148:149], v25 offset:20480
    v_fma_f32 v40, -v188, v152, v40
    v_fma_f32 v41, -v188, v153, v41
    v_mfma_f32_16x16x32_bf16 v[36:39], v[128:131], a[4:7], v[36:39]
    ds_read_b64_tr_b16 v[150:151], v25 offset:20992
    v_fma_f32 v42, -v188, v154, v42
    s_waitcnt lgkmcnt(8)
    v_mfma_f32_16x16x32_bf16 v[52:55], v[132:135], a[4:7], v[52:55]
    v_fma_f32 v43, -v188, v155, v43
    v_fma_f32 v44, -v190, v152, v44
    ds_read_b128 v[168:171], v9 offset:1280
    v_mfma_f32_16x16x32_bf16 v[48:51], v[132:135], a[0:3], v[48:51]
    v_fma_f32 v45, -v190, v153, v45
    ds_read_b128 v[172:175], v9 offset:1344
    s_waitcnt lgkmcnt(8)
    v_mfma_f32_16x16x32_bf16 v[64:67], v[136:139], a[0:3], v[64:67]
    v_fma_f32 v46, -v190, v154, v46
    v_fma_f32 v47, -v190, v155, v47
    v_mfma_f32_16x16x32_bf16 v[68:71], v[136:139], a[4:7], v[68:71]
    v_fma_f32 v56, -v188, v156, v56
    ds_read_b128 v[176:179], v9 offset:1408
    s_waitcnt lgkmcnt(7)
    v_mfma_f32_16x16x32_bf16 v[84:87], v[140:143], a[4:7], v[84:87]
    v_fma_f32 v57, -v188, v157, v57
    v_fma_f32 v58, -v188, v158, v58
    ds_read_b128 v[180:183], v9 offset:1472
    v_mfma_f32_16x16x32_bf16 v[80:83], v[140:143], a[0:3], v[80:83]
    v_fma_f32 v59, -v188, v159, v59
    s_waitcnt lgkmcnt(6)
    v_mfma_f32_16x16x32_bf16 v[96:99], a[0:3], v[144:147], v[96:99]
    v_fma_f32 v60, -v190, v156, v60
    v_fma_f32 v61, -v190, v157, v61
    ds_read2_b32 v[220:221], v11 offset0:160 offset1:176
    v_mfma_f32_16x16x32_bf16 v[100:103], a[4:7], v[144:147], v[100:103]
    v_fma_f32 v62, -v190, v158, v62
    s_waitcnt lgkmcnt(5)
    v_mfma_f32_16x16x32_bf16 v[116:119], a[4:7], v[148:151], v[116:119]
    v_fma_f32 v63, -v190, v159, v63
    v_mfma_f32_16x16x32_bf16 v[112:115], a[0:3], v[148:151], v[112:115]
    s_waitcnt vmcnt(4)
    v_mfma_f32_16x16x32_bf16 v[40:43], v[128:131], a[8:11], v[40:43]
    v_mfma_f32_16x16x32_bf16 v[44:47], v[128:131], a[12:15], v[44:47]
    s_waitcnt lgkmcnt(0)
    v_fma_f32 v96, -v168, v220, v96
    v_fma_f32 v97, -v169, v220, v97
    v_mfma_f32_16x16x32_bf16 v[60:63], v[132:135], a[12:15], v[60:63]
    ds_read_b64_tr_b16 v[128:129], v24 offset:6144
    v_fma_f32 v98, -v170, v220, v98
    v_mfma_f32_16x16x32_bf16 v[56:59], v[132:135], a[8:11], v[56:59]
    ds_read_b64_tr_b16 v[130:131], v24 offset:6656
    v_fma_f32 v99, -v171, v220, v99
    v_fma_f32 v100, -v172, v220, v100
    v_mfma_f32_16x16x32_bf16 v[72:75], v[136:139], a[8:11], v[72:75]
    ds_read_b64_tr_b16 v[132:133], v25 offset:6144
    v_fma_f32 v101, -v173, v220, v101
    v_mfma_f32_16x16x32_bf16 v[76:79], v[136:139], a[12:15], v[76:79]
    ds_read_b64_tr_b16 v[134:135], v25 offset:6656
    v_fma_f32 v102, -v174, v220, v102
    v_fma_f32 v103, -v175, v220, v103
    v_mfma_f32_16x16x32_bf16 v[92:95], v[140:143], a[12:15], v[92:95]
    ds_read_b64_tr_b16 v[136:137], v24 offset:14336
    v_fma_f32 v112, -v168, v221, v112
    v_mfma_f32_16x16x32_bf16 v[88:91], v[140:143], a[8:11], v[88:91]
    ds_read_b64_tr_b16 v[138:139], v24 offset:14848
    v_fma_f32 v113, -v169, v221, v113
    v_fma_f32 v114, -v170, v221, v114
    v_mfma_f32_16x16x32_bf16 v[104:107], a[8:11], v[144:147], v[104:107]
    ds_read_b64_tr_b16 v[140:141], v25 offset:14336
    v_fma_f32 v115, -v171, v221, v115
    v_mfma_f32_16x16x32_bf16 v[108:111], a[12:15], v[144:147], v[108:111]
    ds_read_b64_tr_b16 v[142:143], v25 offset:14848
    v_fma_f32 v116, -v172, v221, v116
    v_fma_f32 v117, -v173, v221, v117
    v_mfma_f32_16x16x32_bf16 v[124:127], a[12:15], v[148:151], v[124:127]
    ds_read_b64_tr_b16 v[144:145], v24 offset:22528
    v_fma_f32 v118, -v174, v221, v118
    v_mfma_f32_16x16x32_bf16 v[120:123], a[8:11], v[148:151], v[120:123]
    ds_read_b64_tr_b16 v[146:147], v24 offset:23040
    v_fma_f32 v119, -v175, v221, v119
    s_waitcnt vmcnt(2) lgkmcnt(8)
    v_mfma_f32_16x16x32_bf16 v[32:35], v[128:131], a[16:19], v[32:35]
    ds_read_b64_tr_b16 v[148:149], v25 offset:22528
    v_mfma_f32_16x16x32_bf16 v[36:39], v[128:131], a[20:23], v[36:39]
    ds_read_b64_tr_b16 v[150:151], v25 offset:23040
    v_fma_f32 v104, -v176, v220, v104
    v_fma_f32 v105, -v177, v220, v105
    s_waitcnt lgkmcnt(8)
    v_mfma_f32_16x16x32_bf16 v[52:55], v[132:135], a[20:23], v[52:55]
    v_fma_f32 v106, -v178, v220, v106
    ds_read_b128 v[152:155], v9 offset:2816
    v_mfma_f32_16x16x32_bf16 v[48:51], v[132:135], a[16:19], v[48:51]
    v_fma_f32 v107, -v179, v220, v107
    v_fma_f32 v108, -v180, v220, v108
    s_waitcnt lgkmcnt(7)
    v_mfma_f32_16x16x32_bf16 v[64:67], v[136:139], a[16:19], v[64:67]
    v_fma_f32 v109, -v181, v220, v109
    ds_read_b128 v[156:159], v9 offset:2880
    v_mfma_f32_16x16x32_bf16 v[68:71], v[136:139], a[20:23], v[68:71]
    v_fma_f32 v110, -v182, v220, v110
    v_fma_f32 v111, -v183, v220, v111
    s_waitcnt lgkmcnt(6)
    v_mfma_f32_16x16x32_bf16 v[84:87], v[140:143], a[20:23], v[84:87]
    v_fma_f32 v120, -v176, v221, v120
    ds_read_b128 v[160:163], v9 offset:2944
    v_mfma_f32_16x16x32_bf16 v[80:83], v[140:143], a[16:19], v[80:83]
    v_fma_f32 v121, -v177, v221, v121
    v_fma_f32 v122, -v178, v221, v122
    s_waitcnt lgkmcnt(5)
    v_mfma_f32_16x16x32_bf16 v[96:99], a[16:19], v[144:147], v[96:99]
    v_fma_f32 v123, -v179, v221, v123
    ds_read_b128 v[164:167], v9 offset:3008
    v_mfma_f32_16x16x32_bf16 v[100:103], a[20:23], v[144:147], v[100:103]
    v_fma_f32 v124, -v180, v221, v124
    v_fma_f32 v125, -v181, v221, v125
    s_waitcnt lgkmcnt(4)
    v_mfma_f32_16x16x32_bf16 v[116:119], a[20:23], v[148:151], v[116:119]
    v_fma_f32 v126, -v182, v221, v126
    v_mfma_f32_16x16x32_bf16 v[112:115], a[16:19], v[148:151], v[112:115]
    v_fma_f32 v127, -v183, v221, v127
    s_barrier
    s_waitcnt vmcnt(0)
    v_mfma_f32_16x16x32_bf16 v[40:43], v[128:131], a[24:27], v[40:43]
    v_mul_f32 v64, v185, v64
    v_mul_f32 v65, v185, v65
    v_mfma_f32_16x16x32_bf16 v[44:47], v[128:131], a[28:31], v[44:47]
    v_mul_f32 v66, v185, v66
    v_mul_f32 v67, v185, v67
    v_mfma_f32_16x16x32_bf16 v[60:63], v[132:135], a[28:31], v[60:63]
    v_mul_f32 v80, v185, v80
    v_mul_f32 v81, v185, v81
    v_mfma_f32_16x16x32_bf16 v[56:59], v[132:135], a[24:27], v[56:59]
    v_mul_f32 v82, v185, v82
    v_mul_f32 v83, v185, v83
    v_mfma_f32_16x16x32_bf16 v[72:75], v[136:139], a[24:27], v[72:75]
    v_cvt_pk_bf16_f32 v64, v64, v65
    v_cvt_pk_bf16_f32 v65, v66, v67
    v_mfma_f32_16x16x32_bf16 v[76:79], v[136:139], a[28:31], v[76:79]
    v_cvt_pk_bf16_f32 v66, v80, v81
    v_cvt_pk_bf16_f32 v67, v82, v83
    v_mfma_f32_16x16x32_bf16 v[92:95], v[140:143], a[28:31], v[92:95]
    v_mul_f32 v68, v187, v68
    v_mul_f32 v69, v187, v69
    v_mfma_f32_16x16x32_bf16 v[88:91], v[140:143], a[24:27], v[88:91]
    v_mul_f32 v70, v187, v70
    v_mul_f32 v71, v187, v71
    v_mfma_f32_16x16x32_bf16 v[104:107], a[24:27], v[144:147], v[104:107]
    v_mul_f32 v84, v187, v84
    v_mul_f32 v85, v187, v85
    v_mfma_f32_16x16x32_bf16 v[108:111], a[28:31], v[144:147], v[108:111]
    v_mul_f32 v86, v187, v86
    v_mul_f32 v87, v187, v87
    v_mfma_f32_16x16x32_bf16 v[124:127], a[28:31], v[148:151], v[124:127]
    v_cvt_pk_bf16_f32 v68, v68, v69
    v_cvt_pk_bf16_f32 v69, v70, v71
    v_mfma_f32_16x16x32_bf16 v[120:123], a[24:27], v[148:151], v[120:123]
    v_cvt_pk_bf16_f32 v70, v84, v85
    v_cvt_pk_bf16_f32 v71, v86, v87
    buffer_store_dwordx4 v[64:67], v12, s[12:15], s84 offen offset:0 sc1
    ds_write_b128 v12, v[64:67] offset:0
    buffer_store_dwordx4 v[68:71], v12, s[12:15], s84 offen offset:256 sc1
    ds_write_b128 v12, v[68:71] offset:256
    v_pk_mul_f32 v[72:73], v[188:189], v[72:73] op_sel:[1,0] op_sel_hi:[1,1]
    v_pk_mul_f32 v[74:75], v[188:189], v[74:75] op_sel:[1,0] op_sel_hi:[1,1]
    v_pk_mul_f32 v[88:89], v[188:189], v[88:89] op_sel:[1,0] op_sel_hi:[1,1]
    v_pk_mul_f32 v[90:91], v[188:189], v[90:91] op_sel:[1,0] op_sel_hi:[1,1]
    v_cvt_pk_bf16_f32 v72, v72, v73
    v_cvt_pk_bf16_f32 v73, v74, v75
    v_cvt_pk_bf16_f32 v74, v88, v89
    v_cvt_pk_bf16_f32 v75, v90, v91
    buffer_store_dwordx4 v[72:75], v12, s[12:15], s84 offen offset:2048 sc1
    ds_write_b128 v12, v[72:75] offset:2048
    v_pk_mul_f32 v[76:77], v[190:191], v[76:77] op_sel:[1,0] op_sel_hi:[1,1]
    v_pk_mul_f32 v[78:79], v[190:191], v[78:79] op_sel:[1,0] op_sel_hi:[1,1]
    v_pk_mul_f32 v[92:93], v[190:191], v[92:93] op_sel:[1,0] op_sel_hi:[1,1]
    v_pk_mul_f32 v[94:95], v[190:191], v[94:95] op_sel:[1,0] op_sel_hi:[1,1]
    v_cvt_pk_bf16_f32 v76, v76, v77
    v_cvt_pk_bf16_f32 v77, v78, v79
    v_cvt_pk_bf16_f32 v78, v92, v93
    v_cvt_pk_bf16_f32 v79, v94, v95
    buffer_store_dwordx4 v[76:79], v12, s[12:15], s84 offen offset:2304 sc1
    ds_write_b128 v12, v[76:79] offset:2304
    s_waitcnt lgkmcnt(4)
    v_pk_mul_f32 v[96:97], v[152:153], v[96:97]
    v_pk_mul_f32 v[98:99], v[154:155], v[98:99]
    v_pk_mul_f32 v[112:113], v[152:153], v[112:113]
    v_pk_mul_f32 v[114:115], v[154:155], v[114:115]
    v_cvt_pk_bf16_f32 v96, v96, v97
    v_cvt_pk_bf16_f32 v97, v98, v99
    v_cvt_pk_bf16_f32 v98, v112, v113
    v_cvt_pk_bf16_f32 v99, v114, v115
    v_mul_f32 v185, 0x3e8293ee, v185
    v_permlane16_swap_b32 v96, v98
    v_permlane16_swap_b32 v97, v99
    buffer_store_dwordx4 v[96:99], v13, s[12:15], s85 offen offset:0 sc1
    ds_write_b128 v13, v[96:99] offset:8192
    v_pk_mul_f32 v[100:101], v[156:157], v[100:101]
    v_pk_mul_f32 v[102:103], v[158:159], v[102:103]
    v_pk_mul_f32 v[116:117], v[156:157], v[116:117]
    v_pk_mul_f32 v[118:119], v[158:159], v[118:119]
    v_cvt_pk_bf16_f32 v100, v100, v101
    v_cvt_pk_bf16_f32 v101, v102, v103
    v_cvt_pk_bf16_f32 v102, v116, v117
    v_cvt_pk_bf16_f32 v103, v118, v119
    v_mul_f32 v187, 0x3e8293ee, v187
    v_permlane16_swap_b32 v100, v102
    v_permlane16_swap_b32 v101, v103
    buffer_store_dwordx4 v[100:103], v13, s[12:15], s85 offen offset:1024 sc1
    ds_write_b128 v13, v[100:103] offset:9216
    v_pk_mul_f32 v[104:105], v[160:161], v[104:105]
    v_pk_mul_f32 v[106:107], v[162:163], v[106:107]
    v_pk_mul_f32 v[120:121], v[160:161], v[120:121]
    v_pk_mul_f32 v[122:123], v[162:163], v[122:123]
    v_cvt_pk_bf16_f32 v104, v104, v105
    v_cvt_pk_bf16_f32 v105, v106, v107
    v_cvt_pk_bf16_f32 v106, v120, v121
    v_cvt_pk_bf16_f32 v107, v122, v123
    v_mul_f32 v189, 0x3e8293ee, v189
    v_permlane16_swap_b32 v104, v106
    v_permlane16_swap_b32 v105, v107
    buffer_store_dwordx4 v[104:107], v13, s[12:15], s85 offen offset:2048 sc1
    ds_write_b128 v13, v[104:107] offset:10240
    v_pk_mul_f32 v[108:109], v[164:165], v[108:109]
    v_pk_mul_f32 v[110:111], v[166:167], v[110:111]
    v_pk_mul_f32 v[124:125], v[164:165], v[124:125]
    v_pk_mul_f32 v[126:127], v[166:167], v[126:127]
    v_cvt_pk_bf16_f32 v108, v108, v109
    v_cvt_pk_bf16_f32 v109, v110, v111
    v_cvt_pk_bf16_f32 v110, v124, v125
    v_cvt_pk_bf16_f32 v111, v126, v127
    v_mul_f32 v191, 0x3e8293ee, v191
    v_permlane16_swap_b32 v108, v110
    v_permlane16_swap_b32 v109, v111
    buffer_store_dwordx4 v[108:111], v13, s[12:15], s85 offen offset:3072 sc1
    ds_write_b128 v13, v[108:111] offset:11264
    v_add_u32 v24, 81920, v5
    s_waitcnt lgkmcnt(0)
    s_barrier
    ds_read_b128 v[128:131], v24 offset:0
    ds_read_b128 v[132:135], v24 offset:1024
    ds_read_b128 v[136:139], v24 offset:2048
    ds_read_b128 v[140:143], v24 offset:3072
    v_pk_mul_f32 v[32:33], v[184:185], v[32:33] op_sel:[1,0] op_sel_hi:[1,1]
    v_pk_mul_f32 v[34:35], v[184:185], v[34:35] op_sel:[1,0] op_sel_hi:[1,1]
    v_pk_mul_f32 v[48:49], v[184:185], v[48:49] op_sel:[1,0] op_sel_hi:[1,1]
    v_pk_mul_f32 v[50:51], v[184:185], v[50:51] op_sel:[1,0] op_sel_hi:[1,1]
    v_cvt_pk_bf16_f32 v8, v32, v33
    v_cvt_pk_bf16_f32 v9, v34, v35
    v_cvt_pk_bf16_f32 v10, v48, v49
    v_cvt_pk_bf16_f32 v11, v50, v51
    v_pk_mul_f32 v[36:37], v[186:187], v[36:37] op_sel:[1,0] op_sel_hi:[1,1]
    v_pk_mul_f32 v[38:39], v[186:187], v[38:39] op_sel:[1,0] op_sel_hi:[1,1]
    v_pk_mul_f32 v[52:53], v[186:187], v[52:53] op_sel:[1,0] op_sel_hi:[1,1]
    v_pk_mul_f32 v[54:55], v[186:187], v[54:55] op_sel:[1,0] op_sel_hi:[1,1]
    v_cvt_pk_bf16_f32 v12, v36, v37
    v_cvt_pk_bf16_f32 v13, v38, v39
    v_cvt_pk_bf16_f32 v14, v52, v53
    v_cvt_pk_bf16_f32 v15, v54, v55
    v_pk_mul_f32 v[40:41], v[188:189], v[40:41] op_sel:[1,0] op_sel_hi:[1,1]
    v_pk_mul_f32 v[42:43], v[188:189], v[42:43] op_sel:[1,0] op_sel_hi:[1,1]
    v_pk_mul_f32 v[56:57], v[188:189], v[56:57] op_sel:[1,0] op_sel_hi:[1,1]
    v_pk_mul_f32 v[58:59], v[188:189], v[58:59] op_sel:[1,0] op_sel_hi:[1,1]
    v_cvt_pk_bf16_f32 v16, v40, v41
    v_cvt_pk_bf16_f32 v17, v42, v43
    v_cvt_pk_bf16_f32 v18, v56, v57
    v_cvt_pk_bf16_f32 v19, v58, v59
    v_pk_mul_f32 v[44:45], v[190:191], v[44:45] op_sel:[1,0] op_sel_hi:[1,1]
    v_pk_mul_f32 v[46:47], v[190:191], v[46:47] op_sel:[1,0] op_sel_hi:[1,1]
    v_pk_mul_f32 v[60:61], v[190:191], v[60:61] op_sel:[1,0] op_sel_hi:[1,1]
    v_pk_mul_f32 v[62:63], v[190:191], v[62:63] op_sel:[1,0] op_sel_hi:[1,1]
    v_cvt_pk_bf16_f32 v20, v44, v45
    v_cvt_pk_bf16_f32 v21, v46, v47
    v_cvt_pk_bf16_f32 v22, v60, v61
    v_cvt_pk_bf16_f32 v23, v62, v63
    v_permlane16_swap_b32 v8, v12
    v_permlane16_swap_b32 v9, v13
    v_permlane16_swap_b32 v10, v14
    v_permlane16_swap_b32 v11, v15
    v_permlane16_swap_b32 v16, v20
    v_permlane16_swap_b32 v17, v21
    v_permlane16_swap_b32 v18, v22
    v_permlane16_swap_b32 v19, v23
    s_waitcnt lgkmcnt(0)
    v_mfma_f32_32x32x16_bf16 v[64:79], v[128:131], v[8:11], 0
    v_mfma_f32_32x32x16_bf16 v[64:79], v[132:135], v[12:15], v[64:79]
    v_and_b32 v25, 7, v1
    v_mov_b32 v26, 0x3f803f80
    v_cmp_eq_u32 vcc, 0, v25
    s_nop 1
    v_cndmask_b32 v200, 0, v26, vcc
    v_cndmask_b32 v201, 0, v26, vcc
    v_cmp_eq_u32 vcc, 4, v25
    s_nop 1
    v_cndmask_b32 v202, 0, v26, vcc
    v_cndmask_b32 v203, 0, v26, vcc
    v_mov_b32 v204, 0xdddddddd
    v_mov_b32 v160, 0
    v_mov_b32 v161, 0
    v_mov_b32 v162, 0
    v_mov_b32 v163, 0
    v_mov_b32 v164, 0
    v_mov_b32 v165, 0
    v_mov_b32 v166, 0
    v_mov_b32 v167, 0
    v_mov_b32 v168, 0
    v_mov_b32 v169, 0
    v_mov_b32 v170, 0
    v_mov_b32 v171, 0
    v_mov_b32 v172, 0
    v_mov_b32 v173, 0
    v_mov_b32 v174, 0
    v_mov_b32 v175, 0
    v_mov_b32 v192, 0
    v_mov_b32 v193, 0
    v_mov_b32 v194, 0
    v_mov_b32 v195, 0
    v_mov_b32 v176, 0
    v_mov_b32 v177, 0
    v_mov_b32 v178, 0
    v_mov_b32 v179, 0
    v_mov_b32 v180, 0
    v_mov_b32 v181, 0
    v_mov_b32 v182, 0
    v_mov_b32 v183, 0
    v_mov_b32 v184, 0
    v_mov_b32 v185, 0
    v_mov_b32 v186, 0
    v_mov_b32 v187, 0
    v_mov_b32 v188, 0
    v_mov_b32 v189, 0
    v_mov_b32 v190, 0
    v_mov_b32 v191, 0
    v_mov_b32 v196, 0
    v_mov_b32 v197, 0
    v_mov_b32 v198, 0
    v_mov_b32 v199, 0
    v_mov_b32 v112, 0
    v_mov_b32 v113, 0
    v_mov_b32 v114, 0
    v_mov_b32 v115, 0
    v_mov_b32 v116, 0
    v_mov_b32 v117, 0
    v_mov_b32 v118, 0
    v_mov_b32 v119, 0
    v_mov_b32 v120, 0
    v_mov_b32 v121, 0
    v_mov_b32 v122, 0
    v_mov_b32 v123, 0
    v_mov_b32 v124, 0
    v_mov_b32 v125, 0
    v_mov_b32 v126, 0
    v_mov_b32 v127, 0
    v_mov_b32 v152, 0
    v_mov_b32 v153, 0
    v_mov_b32 v154, 0
    v_mov_b32 v155, 0
    v_mov_b32 v156, 0
    v_mov_b32 v157, 0
    v_mov_b32 v158, 0
    v_mov_b32 v159, 0
    s_mov_b32 s54, 4
    s_mov_b64 exec, 0xff
    s_waitcnt vmcnt(0)
    buffer_store_dword v29, v28, s[12:15], s53 offen sc1
    s_mov_b64 exec, -1
.p2align 3
c_attn_loop:
    v_mfma_f32_32x32x16_bf16 v[80:95], v[128:131], v[16:19], 0
    v_exp_f32 v64, v64
    v_exp_f32 v65, v65
    v_exp_f32 v66, v66
    v_mfma_f32_32x32x16_bf16 v[80:95], v[132:135], v[20:23], v[80:95]
    v_exp_f32 v67, v67
    v_exp_f32 v68, v68
    v_exp_f32 v69, v69
    v_smfmac_f32_32x32x32_bf16 v[176:191], v[152:155], v[112:119], v204
    s_waitcnt lgkmcnt(0)
    v_exp_f32 v70, v70
    v_exp_f32 v71, v71
    v_exp_f32 v72, v72
    v_smfmac_f32_16x16x64_bf16 v[196:199], v[200:203], v[112:119], v204
    ds_read_b128 v[144:147], v24 offset:8192
    v_exp_f32 v73, v73
    v_exp_f32 v74, v74
    v_smfmac_f32_32x32x32_bf16 v[176:191], v[156:159], v[120:127], v204
    v_exp_f32 v75, v75
    v_exp_f32 v76, v76
    v_exp_f32 v77, v77
    v_smfmac_f32_16x16x64_bf16 v[196:199], v[200:203], v[120:127], v204
    ds_read_b128 v[148:151], v24 offset:9216
    v_exp_f32 v78, v78
    v_exp_f32 v79, v79
    v_mfma_f32_32x32x16_bf16 v[96:111], v[136:139], v[8:11], 0
    v_exp_f32 v80, v80
    v_exp_f32 v81, v81
    v_exp_f32 v82, v82
    v_mfma_f32_32x32x16_bf16 v[96:111], v[140:143], v[12:15], v[96:111]
    s_waitcnt lgkmcnt(1)
    v_exp_f32 v83, v83
    v_exp_f32 v84, v84
    v_exp_f32 v85, v85
    v_smfmac_f32_32x32x32_bf16 v[160:175], v[144:147], v[64:71], v204
    s_waitcnt lgkmcnt(0)
    v_exp_f32 v86, v86
    v_exp_f32 v87, v87
    v_exp_f32 v88, v88
    v_smfmac_f32_16x16x64_bf16 v[192:195], v[200:203], v[64:71], v204
    ds_read_b128 v[128:131], v24 offset:4096
    v_exp_f32 v89, v89
    v_exp_f32 v90, v90
    v_smfmac_f32_32x32x32_bf16 v[160:175], v[148:151], v[72:79], v204
    v_exp_f32 v91, v91
    v_exp_f32 v92, v92
    v_exp_f32 v93, v93
    v_smfmac_f32_16x16x64_bf16 v[192:195], v[200:203], v[72:79], v204
    ds_read_b128 v[132:135], v24 offset:5120
    v_exp_f32 v94, v94
    v_exp_f32 v95, v95
    v_mfma_f32_32x32x16_bf16 v[112:127], v[136:139], v[16:19], 0
    v_exp_f32 v96, v96
    v_exp_f32 v97, v97
    v_exp_f32 v98, v98
    v_mfma_f32_32x32x16_bf16 v[112:127], v[140:143], v[20:23], v[112:127]
    v_exp_f32 v99, v99
    v_exp_f32 v100, v100
    v_exp_f32 v101, v101
    v_smfmac_f32_32x32x32_bf16 v[176:191], v[144:147], v[80:87], v204
    s_waitcnt lgkmcnt(0)
    v_exp_f32 v102, v102
    v_exp_f32 v103, v103
    v_exp_f32 v104, v104
    v_smfmac_f32_16x16x64_bf16 v[196:199], v[200:203], v[80:87], v204
    ds_read_b128 v[152:155], v24 offset:10240
    v_exp_f32 v105, v105
    v_exp_f32 v106, v106
    v_smfmac_f32_32x32x32_bf16 v[176:191], v[148:151], v[88:95], v204
    v_exp_f32 v107, v107
    v_exp_f32 v108, v108
    v_exp_f32 v109, v109
    v_smfmac_f32_16x16x64_bf16 v[196:199], v[200:203], v[88:95], v204
    ds_read_b128 v[156:159], v24 offset:11264
    v_exp_f32 v110, v110
    v_exp_f32 v111, v111
    v_mfma_f32_32x32x16_bf16 v[64:79], v[128:131], v[8:11], 0
    v_exp_f32 v112, v112
    v_exp_f32 v113, v113
    v_exp_f32 v114, v114
    v_mfma_f32_32x32x16_bf16 v[64:79], v[132:135], v[12:15], v[64:79]
    s_waitcnt lgkmcnt(1)
    v_exp_f32 v115, v115
    v_exp_f32 v116, v116
    v_exp_f32 v117, v117
    v_smfmac_f32_32x32x32_bf16 v[160:175], v[152:155], v[96:103], v204
    s_waitcnt lgkmcnt(0)
    v_exp_f32 v118, v118
    v_exp_f32 v119, v119
    v_exp_f32 v120, v120
    v_smfmac_f32_16x16x64_bf16 v[192:195], v[200:203], v[96:103], v204
    ds_read_b128 v[136:139], v24 offset:6144
    v_exp_f32 v121, v121
    v_exp_f32 v122, v122
    v_smfmac_f32_32x32x32_bf16 v[160:175], v[156:159], v[104:111], v204
    v_exp_f32 v123, v123
    v_exp_f32 v124, v124
    v_exp_f32 v125, v125
    v_smfmac_f32_16x16x64_bf16 v[192:195], v[200:203], v[104:111], v204
    ds_read_b128 v[140:143], v24 offset:7168
    v_exp_f32 v126, v126
    v_exp_f32 v127, v127
    v_mfma_f32_32x32x16_bf16 v[80:95], v[128:131], v[16:19], 0
    s_cmp_eq_u32 s54, 4
    v_exp_f32 v64, v64
    v_exp_f32 v65, v65
    v_exp_f32 v66, v66
    v_mfma_f32_32x32x16_bf16 v[80:95], v[132:135], v[20:23], v[80:95]
    v_exp_f32 v67, v67
    v_exp_f32 v68, v68
    v_exp_f32 v69, v69
    v_smfmac_f32_32x32x32_bf16 v[176:191], v[152:155], v[112:119], v204
    s_waitcnt lgkmcnt(0)
    v_exp_f32 v70, v70
    v_exp_f32 v71, v71
    v_exp_f32 v72, v72
    v_smfmac_f32_16x16x64_bf16 v[196:199], v[200:203], v[112:119], v204
    ds_read_b128 v[144:147], v24 offset:12288
    v_exp_f32 v73, v73
    v_exp_f32 v74, v74
    v_smfmac_f32_32x32x32_bf16 v[176:191], v[156:159], v[120:127], v204
    v_exp_f32 v75, v75
    v_exp_f32 v76, v76
    v_exp_f32 v77, v77
    v_smfmac_f32_16x16x64_bf16 v[196:199], v[200:203], v[120:127], v204
    ds_read_b128 v[148:151], v24 offset:13312
    v_exp_f32 v78, v78
    v_exp_f32 v79, v79
    v_mfma_f32_32x32x16_bf16 v[96:111], v[136:139], v[8:11], 0
    s_cbranch_scc1 c_attn_nobar
    s_barrier
c_attn_nobar:
    v_exp_f32 v80, v80
    v_exp_f32 v81, v81
    v_exp_f32 v82, v82
    v_mfma_f32_32x32x16_bf16 v[96:111], v[140:143], v[12:15], v[96:111]
    s_waitcnt lgkmcnt(1)
    v_exp_f32 v83, v83
    v_exp_f32 v84, v84
    v_exp_f32 v85, v85
    v_smfmac_f32_32x32x32_bf16 v[160:175], v[144:147], v[64:71], v204
    s_waitcnt lgkmcnt(0)
    v_exp_f32 v86, v86
    v_exp_f32 v87, v87
    v_exp_f32 v88, v88
    v_smfmac_f32_16x16x64_bf16 v[192:195], v[200:203], v[64:71], v204
    ds_read_b128 v[128:131], v24 offset:16384
    v_exp_f32 v89, v89
    v_exp_f32 v90, v90
    v_smfmac_f32_32x32x32_bf16 v[160:175], v[148:151], v[72:79], v204
    v_exp_f32 v91, v91
    v_exp_f32 v92, v92
    v_exp_f32 v93, v93
    v_smfmac_f32_16x16x64_bf16 v[192:195], v[200:203], v[72:79], v204
    ds_read_b128 v[132:135], v24 offset:17408
    v_exp_f32 v94, v94
    v_exp_f32 v95, v95
    v_mfma_f32_32x32x16_bf16 v[112:127], v[136:139], v[16:19], 0
    v_exp_f32 v96, v96
    v_exp_f32 v97, v97
    v_exp_f32 v98, v98
    v_mfma_f32_32x32x16_bf16 v[112:127], v[140:143], v[20:23], v[112:127]
    v_exp_f32 v99, v99
    v_exp_f32 v100, v100
    v_exp_f32 v101, v101
    v_smfmac_f32_32x32x32_bf16 v[176:191], v[144:147], v[80:87], v204
    s_waitcnt lgkmcnt(0)
    v_exp_f32 v102, v102
    v_exp_f32 v103, v103
    v_exp_f32 v104, v104
    v_smfmac_f32_16x16x64_bf16 v[196:199], v[200:203], v[80:87], v204
    ds_read_b128 v[152:155], v24 offset:14336
    v_exp_f32 v105, v105
    v_exp_f32 v106, v106
    v_smfmac_f32_32x32x32_bf16 v[176:191], v[148:151], v[88:95], v204
    v_exp_f32 v107, v107
    v_exp_f32 v108, v108
    v_exp_f32 v109, v109
    v_smfmac_f32_16x16x64_bf16 v[196:199], v[200:203], v[88:95], v204
    ds_read_b128 v[156:159], v24 offset:15360
    v_exp_f32 v110, v110
    v_exp_f32 v111, v111
    v_mfma_f32_32x32x16_bf16 v[64:79], v[128:131], v[8:11], 0
    v_exp_f32 v112, v112
    v_exp_f32 v113, v113
    v_exp_f32 v114, v114
    v_mfma_f32_32x32x16_bf16 v[64:79], v[132:135], v[12:15], v[64:79]
    s_waitcnt lgkmcnt(1)
    v_exp_f32 v115, v115
    v_exp_f32 v116, v116
    v_exp_f32 v117, v117
    v_smfmac_f32_32x32x32_bf16 v[160:175], v[152:155], v[96:103], v204
    s_waitcnt lgkmcnt(0)
    v_exp_f32 v118, v118
    v_exp_f32 v119, v119
    v_exp_f32 v120, v120
    v_smfmac_f32_16x16x64_bf16 v[192:195], v[200:203], v[96:103], v204
    ds_read_b128 v[136:139], v24 offset:18432
    v_exp_f32 v121, v121
    v_exp_f32 v122, v122
    v_smfmac_f32_32x32x32_bf16 v[160:175], v[156:159], v[104:111], v204
    v_exp_f32 v123, v123
    v_exp_f32 v124, v124
    v_exp_f32 v125, v125
    v_smfmac_f32_16x16x64_bf16 v[192:195], v[200:203], v[104:111], v204
    ds_read_b128 v[140:143], v24 offset:19456
    v_exp_f32 v126, v126
    v_exp_f32 v127, v127
    v_mfma_f32_32x32x16_bf16 v[80:95], v[128:131], v[16:19], 0
    v_exp_f32 v64, v64
    v_exp_f32 v65, v65
    v_exp_f32 v66, v66
    v_mfma_f32_32x32x16_bf16 v[80:95], v[132:135], v[20:23], v[80:95]
    v_exp_f32 v67, v67
    v_exp_f32 v68, v68
    v_exp_f32 v69, v69
    v_smfmac_f32_32x32x32_bf16 v[176:191], v[152:155], v[112:119], v204
    s_waitcnt lgkmcnt(0)
    v_exp_f32 v70, v70
    v_exp_f32 v71, v71
    v_exp_f32 v72, v72
    v_smfmac_f32_16x16x64_bf16 v[196:199], v[200:203], v[112:119], v204
    ds_read_b128 v[144:147], v24 offset:24576
    v_exp_f32 v73, v73
    v_exp_f32 v74, v74
    v_smfmac_f32_32x32x32_bf16 v[176:191], v[156:159], v[120:127], v204
    v_exp_f32 v75, v75
    v_exp_f32 v76, v76
    v_exp_f32 v77, v77
    v_smfmac_f32_16x16x64_bf16 v[196:199], v[200:203], v[120:127], v204
    ds_read_b128 v[148:151], v24 offset:25600
    v_exp_f32 v78, v78
    v_exp_f32 v79, v79
    v_mfma_f32_32x32x16_bf16 v[96:111], v[136:139], v[8:11], 0
    v_exp_f32 v80, v80
    v_exp_f32 v81, v81
    v_exp_f32 v82, v82
    v_mfma_f32_32x32x16_bf16 v[96:111], v[140:143], v[12:15], v[96:111]
    s_waitcnt lgkmcnt(1)
    v_exp_f32 v83, v83
    v_exp_f32 v84, v84
    v_exp_f32 v85, v85
    v_smfmac_f32_32x32x32_bf16 v[160:175], v[144:147], v[64:71], v204
    s_waitcnt lgkmcnt(0)
    v_exp_f32 v86, v86
    v_exp_f32 v87, v87
    v_exp_f32 v88, v88
    v_smfmac_f32_16x16x64_bf16 v[192:195], v[200:203], v[64:71], v204
    ds_read_b128 v[128:131], v24 offset:20480
    v_exp_f32 v89, v89
    v_exp_f32 v90, v90
    v_smfmac_f32_32x32x32_bf16 v[160:175], v[148:151], v[72:79], v204
    v_exp_f32 v91, v91
    v_exp_f32 v92, v92
    v_exp_f32 v93, v93
    v_smfmac_f32_16x16x64_bf16 v[192:195], v[200:203], v[72:79], v204
    ds_read_b128 v[132:135], v24 offset:21504
    v_exp_f32 v94, v94
    v_exp_f32 v95, v95
    v_mfma_f32_32x32x16_bf16 v[112:127], v[136:139], v[16:19], 0
    v_exp_f32 v96, v96
    v_exp_f32 v97, v97
    v_exp_f32 v98, v98
    v_mfma_f32_32x32x16_bf16 v[112:127], v[140:143], v[20:23], v[112:127]
    v_exp_f32 v99, v99
    v_exp_f32 v100, v100
    v_exp_f32 v101, v101
    v_smfmac_f32_32x32x32_bf16 v[176:191], v[144:147], v[80:87], v204
    s_waitcnt lgkmcnt(0)
    v_exp_f32 v102, v102
    v_exp_f32 v103, v103
    v_exp_f32 v104, v104
    v_smfmac_f32_16x16x64_bf16 v[196:199], v[200:203], v[80:87], v204
    ds_read_b128 v[152:155], v24 offset:26624
    v_exp_f32 v105, v105
    v_exp_f32 v106, v106
    v_smfmac_f32_32x32x32_bf16 v[176:191], v[148:151], v[88:95], v204
    v_exp_f32 v107, v107
    v_exp_f32 v108, v108
    v_exp_f32 v109, v109
    v_smfmac_f32_16x16x64_bf16 v[196:199], v[200:203], v[88:95], v204
    ds_read_b128 v[156:159], v24 offset:27648
    v_exp_f32 v110, v110
    v_exp_f32 v111, v111
    v_mfma_f32_32x32x16_bf16 v[64:79], v[128:131], v[8:11], 0
    v_exp_f32 v112, v112
    v_exp_f32 v113, v113
    v_exp_f32 v114, v114
    v_mfma_f32_32x32x16_bf16 v[64:79], v[132:135], v[12:15], v[64:79]
    s_waitcnt lgkmcnt(1)
    v_exp_f32 v115, v115
    v_exp_f32 v116, v116
    v_exp_f32 v117, v117
    v_smfmac_f32_32x32x32_bf16 v[160:175], v[152:155], v[96:103], v204
    s_waitcnt lgkmcnt(0)
    v_exp_f32 v118, v118
    v_exp_f32 v119, v119
    v_exp_f32 v120, v120
    v_smfmac_f32_16x16x64_bf16 v[192:195], v[200:203], v[96:103], v204
    ds_read_b128 v[136:139], v24 offset:22528
    v_exp_f32 v121, v121
    v_exp_f32 v122, v122
    v_smfmac_f32_32x32x32_bf16 v[160:175], v[156:159], v[104:111], v204
    v_exp_f32 v123, v123
    v_exp_f32 v124, v124
    v_exp_f32 v125, v125
    v_smfmac_f32_16x16x64_bf16 v[192:195], v[200:203], v[104:111], v204
    ds_read_b128 v[140:143], v24 offset:23552
    v_exp_f32 v126, v126
    v_exp_f32 v127, v127
    v_mfma_f32_32x32x16_bf16 v[80:95], v[128:131], v[16:19], 0
    v_exp_f32 v64, v64
    v_exp_f32 v65, v65
    v_exp_f32 v66, v66
    v_mfma_f32_32x32x16_bf16 v[80:95], v[132:135], v[20:23], v[80:95]
    v_exp_f32 v67, v67
    v_exp_f32 v68, v68
    v_exp_f32 v69, v69
    v_smfmac_f32_32x32x32_bf16 v[176:191], v[152:155], v[112:119], v204
    s_waitcnt lgkmcnt(0)
    v_exp_f32 v70, v70
    v_exp_f32 v71, v71
    v_exp_f32 v72, v72
    v_smfmac_f32_16x16x64_bf16 v[196:199], v[200:203], v[112:119], v204
    ds_read_b128 v[144:147], v24 offset:28672
    v_exp_f32 v73, v73
    v_exp_f32 v74, v74
    v_smfmac_f32_32x32x32_bf16 v[176:191], v[156:159], v[120:127], v204
    v_exp_f32 v75, v75
    v_exp_f32 v76, v76
    v_exp_f32 v77, v77
    v_smfmac_f32_16x16x64_bf16 v[196:199], v[200:203], v[120:127], v204
    ds_read_b128 v[148:151], v24 offset:29696
    v_exp_f32 v78, v78
    v_exp_f32 v79, v79
    v_mfma_f32_32x32x16_bf16 v[96:111], v[136:139], v[8:11], 0
    s_barrier
    v_exp_f32 v80, v80
    v_exp_f32 v81, v81
    v_exp_f32 v82, v82
    v_mfma_f32_32x32x16_bf16 v[96:111], v[140:143], v[12:15], v[96:111]
    s_waitcnt lgkmcnt(1)
    v_exp_f32 v83, v83
    v_exp_f32 v84, v84
    v_exp_f32 v85, v85
    v_smfmac_f32_32x32x32_bf16 v[160:175], v[144:147], v[64:71], v204
    s_waitcnt lgkmcnt(0)
    v_exp_f32 v86, v86
    v_exp_f32 v87, v87
    v_exp_f32 v88, v88
    v_smfmac_f32_16x16x64_bf16 v[192:195], v[200:203], v[64:71], v204
    ds_read_b128 v[128:131], v24 offset:32768
    v_exp_f32 v89, v89
    v_exp_f32 v90, v90
    v_smfmac_f32_32x32x32_bf16 v[160:175], v[148:151], v[72:79], v204
    v_exp_f32 v91, v91
    v_exp_f32 v92, v92
    v_exp_f32 v93, v93
    v_smfmac_f32_16x16x64_bf16 v[192:195], v[200:203], v[72:79], v204
    ds_read_b128 v[132:135], v24 offset:33792
    v_exp_f32 v94, v94
    v_exp_f32 v95, v95
    v_mfma_f32_32x32x16_bf16 v[112:127], v[136:139], v[16:19], 0
    v_exp_f32 v96, v96
    v_exp_f32 v97, v97
    v_exp_f32 v98, v98
    v_mfma_f32_32x32x16_bf16 v[112:127], v[140:143], v[20:23], v[112:127]
    v_exp_f32 v99, v99
    v_exp_f32 v100, v100
    v_exp_f32 v101, v101
    v_smfmac_f32_32x32x32_bf16 v[176:191], v[144:147], v[80:87], v204
    s_waitcnt lgkmcnt(0)
    v_exp_f32 v102, v102
    v_exp_f32 v103, v103
    v_exp_f32 v104, v104
    v_smfmac_f32_16x16x64_bf16 v[196:199], v[200:203], v[80:87], v204
    ds_read_b128 v[152:155], v24 offset:30720
    v_exp_f32 v105, v105
    v_exp_f32 v106, v106
    v_smfmac_f32_32x32x32_bf16 v[176:191], v[148:151], v[88:95], v204
    v_exp_f32 v107, v107
    v_exp_f32 v108, v108
    v_exp_f32 v109, v109
    v_smfmac_f32_16x16x64_bf16 v[196:199], v[200:203], v[88:95], v204
    ds_read_b128 v[156:159], v24 offset:31744
    v_exp_f32 v110, v110
    v_exp_f32 v111, v111
    v_mfma_f32_32x32x16_bf16 v[64:79], v[128:131], v[8:11], 0
    v_exp_f32 v112, v112
    v_exp_f32 v113, v113
    v_exp_f32 v114, v114
    v_mfma_f32_32x32x16_bf16 v[64:79], v[132:135], v[12:15], v[64:79]
    s_waitcnt lgkmcnt(1)
    v_exp_f32 v115, v115
    v_exp_f32 v116, v116
    v_exp_f32 v117, v117
    v_smfmac_f32_32x32x32_bf16 v[160:175], v[152:155], v[96:103], v204
    s_waitcnt lgkmcnt(0)
    v_exp_f32 v118, v118
    v_exp_f32 v119, v119
    v_exp_f32 v120, v120
    v_smfmac_f32_16x16x64_bf16 v[192:195], v[200:203], v[96:103], v204
    ds_read_b128 v[136:139], v24 offset:34816
    v_exp_f32 v121, v121
    v_exp_f32 v122, v122
    v_smfmac_f32_32x32x32_bf16 v[160:175], v[156:159], v[104:111], v204
    v_exp_f32 v123, v123
    v_exp_f32 v124, v124
    v_exp_f32 v125, v125
    v_smfmac_f32_16x16x64_bf16 v[192:195], v[200:203], v[104:111], v204
    ds_read_b128 v[140:143], v24 offset:35840
    v_exp_f32 v126, v126
    v_exp_f32 v127, v127
    v_mfma_f32_32x32x16_bf16 v[80:95], v[128:131], v[16:19], 0
    v_exp_f32 v64, v64
    v_exp_f32 v65, v65
    v_exp_f32 v66, v66
    v_mfma_f32_32x32x16_bf16 v[80:95], v[132:135], v[20:23], v[80:95]
    v_exp_f32 v67, v67
    v_exp_f32 v68, v68
    v_exp_f32 v69, v69
    v_smfmac_f32_32x32x32_bf16 v[176:191], v[152:155], v[112:119], v204
    s_waitcnt lgkmcnt(0)
    v_exp_f32 v70, v70
    v_exp_f32 v71, v71
    v_exp_f32 v72, v72
    v_smfmac_f32_16x16x64_bf16 v[196:199], v[200:203], v[112:119], v204
    ds_read_b128 v[144:147], v24 offset:40960
    v_exp_f32 v73, v73
    v_exp_f32 v74, v74
    v_smfmac_f32_32x32x32_bf16 v[176:191], v[156:159], v[120:127], v204
    v_exp_f32 v75, v75
    v_exp_f32 v76, v76
    v_exp_f32 v77, v77
    v_smfmac_f32_16x16x64_bf16 v[196:199], v[200:203], v[120:127], v204
    ds_read_b128 v[148:151], v24 offset:41984
    v_exp_f32 v78, v78
    v_exp_f32 v79, v79
    v_mfma_f32_32x32x16_bf16 v[96:111], v[136:139], v[8:11], 0
    v_exp_f32 v80, v80
    v_exp_f32 v81, v81
    v_exp_f32 v82, v82
    v_mfma_f32_32x32x16_bf16 v[96:111], v[140:143], v[12:15], v[96:111]
    s_waitcnt lgkmcnt(1)
    v_exp_f32 v83, v83
    v_exp_f32 v84, v84
    v_exp_f32 v85, v85
    v_smfmac_f32_32x32x32_bf16 v[160:175], v[144:147], v[64:71], v204
    s_waitcnt lgkmcnt(0)
    v_exp_f32 v86, v86
    v_exp_f32 v87, v87
    v_exp_f32 v88, v88
    v_smfmac_f32_16x16x64_bf16 v[192:195], v[200:203], v[64:71], v204
    ds_read_b128 v[128:131], v24 offset:36864
    v_exp_f32 v89, v89
    v_exp_f32 v90, v90
    v_smfmac_f32_32x32x32_bf16 v[160:175], v[148:151], v[72:79], v204
    v_exp_f32 v91, v91
    v_exp_f32 v92, v92
    v_exp_f32 v93, v93
    v_smfmac_f32_16x16x64_bf16 v[192:195], v[200:203], v[72:79], v204
    ds_read_b128 v[132:135], v24 offset:37888
    v_exp_f32 v94, v94
    v_exp_f32 v95, v95
    v_mfma_f32_32x32x16_bf16 v[112:127], v[136:139], v[16:19], 0
    v_exp_f32 v96, v96
    v_exp_f32 v97, v97
    v_exp_f32 v98, v98
    v_mfma_f32_32x32x16_bf16 v[112:127], v[140:143], v[20:23], v[112:127]
    v_exp_f32 v99, v99
    v_exp_f32 v100, v100
    v_exp_f32 v101, v101
    v_smfmac_f32_32x32x32_bf16 v[176:191], v[144:147], v[80:87], v204
    s_waitcnt lgkmcnt(0)
    v_exp_f32 v102, v102
    v_exp_f32 v103, v103
    v_exp_f32 v104, v104
    v_smfmac_f32_16x16x64_bf16 v[196:199], v[200:203], v[80:87], v204
    ds_read_b128 v[152:155], v24 offset:43008
    v_exp_f32 v105, v105
    v_exp_f32 v106, v106
    v_smfmac_f32_32x32x32_bf16 v[176:191], v[148:151], v[88:95], v204
    v_exp_f32 v107, v107
    v_exp_f32 v108, v108
    v_exp_f32 v109, v109
    v_smfmac_f32_16x16x64_bf16 v[196:199], v[200:203], v[88:95], v204
    ds_read_b128 v[156:159], v24 offset:44032
    v_exp_f32 v110, v110
    v_exp_f32 v111, v111
    v_mfma_f32_32x32x16_bf16 v[64:79], v[128:131], v[8:11], 0
    v_exp_f32 v112, v112
    v_exp_f32 v113, v113
    v_exp_f32 v114, v114
    v_mfma_f32_32x32x16_bf16 v[64:79], v[132:135], v[12:15], v[64:79]
    s_waitcnt lgkmcnt(1)
    v_exp_f32 v115, v115
    v_exp_f32 v116, v116
    v_exp_f32 v117, v117
    v_smfmac_f32_32x32x32_bf16 v[160:175], v[152:155], v[96:103], v204
    s_waitcnt lgkmcnt(0)
    v_exp_f32 v118, v118
    v_exp_f32 v119, v119
    v_exp_f32 v120, v120
    v_smfmac_f32_16x16x64_bf16 v[192:195], v[200:203], v[96:103], v204
    ds_read_b128 v[136:139], v24 offset:38912
    v_exp_f32 v121, v121
    v_exp_f32 v122, v122
    v_smfmac_f32_32x32x32_bf16 v[160:175], v[156:159], v[104:111], v204
    v_exp_f32 v123, v123
    v_exp_f32 v124, v124
    v_exp_f32 v125, v125
    v_smfmac_f32_16x16x64_bf16 v[192:195], v[200:203], v[104:111], v204
    ds_read_b128 v[140:143], v24 offset:39936
    v_exp_f32 v126, v126
    v_exp_f32 v127, v127
    v_mfma_f32_32x32x16_bf16 v[80:95], v[128:131], v[16:19], 0
    v_exp_f32 v64, v64
    v_exp_f32 v65, v65
    v_exp_f32 v66, v66
    v_mfma_f32_32x32x16_bf16 v[80:95], v[132:135], v[20:23], v[80:95]
    v_exp_f32 v67, v67
    v_exp_f32 v68, v68
    v_exp_f32 v69, v69
    v_smfmac_f32_32x32x32_bf16 v[176:191], v[152:155], v[112:119], v204
    s_waitcnt lgkmcnt(0)
    v_exp_f32 v70, v70
    v_exp_f32 v71, v71
    v_exp_f32 v72, v72
    v_smfmac_f32_16x16x64_bf16 v[196:199], v[200:203], v[112:119], v204
    ds_read_b128 v[144:147], v24 offset:45056
    v_exp_f32 v73, v73
    v_exp_f32 v74, v74
    v_smfmac_f32_32x32x32_bf16 v[176:191], v[156:159], v[120:127], v204
    v_exp_f32 v75, v75
    v_exp_f32 v76, v76
    v_exp_f32 v77, v77
    v_smfmac_f32_16x16x64_bf16 v[196:199], v[200:203], v[120:127], v204
    ds_read_b128 v[148:151], v24 offset:46080
    v_exp_f32 v78, v78
    v_exp_f32 v79, v79
    v_mfma_f32_32x32x16_bf16 v[96:111], v[136:139], v[8:11], 0
    s_barrier
    v_exp_f32 v80, v80
    v_exp_f32 v81, v81
    v_exp_f32 v82, v82
    v_mfma_f32_32x32x16_bf16 v[96:111], v[140:143], v[12:15], v[96:111]
    s_waitcnt lgkmcnt(1)
    v_exp_f32 v83, v83
    v_exp_f32 v84, v84
    v_exp_f32 v85, v85
    v_smfmac_f32_32x32x32_bf16 v[160:175], v[144:147], v[64:71], v204
    s_waitcnt lgkmcnt(0)
    v_exp_f32 v86, v86
    v_exp_f32 v87, v87
    v_exp_f32 v88, v88
    v_smfmac_f32_16x16x64_bf16 v[192:195], v[200:203], v[64:71], v204
    ds_read_b128 v[128:131], v24 offset:49152
    v_exp_f32 v89, v89
    v_exp_f32 v90, v90
    v_smfmac_f32_32x32x32_bf16 v[160:175], v[148:151], v[72:79], v204
    v_exp_f32 v91, v91
    v_exp_f32 v92, v92
    v_exp_f32 v93, v93
    v_smfmac_f32_16x16x64_bf16 v[192:195], v[200:203], v[72:79], v204
    ds_read_b128 v[132:135], v24 offset:50176
    v_exp_f32 v94, v94
    v_exp_f32 v95, v95
    v_mfma_f32_32x32x16_bf16 v[112:127], v[136:139], v[16:19], 0
    v_exp_f32 v96, v96
    v_exp_f32 v97, v97
    v_exp_f32 v98, v98
    v_mfma_f32_32x32x16_bf16 v[112:127], v[140:143], v[20:23], v[112:127]
    v_exp_f32 v99, v99
    v_exp_f32 v100, v100
    v_exp_f32 v101, v101
    v_smfmac_f32_32x32x32_bf16 v[176:191], v[144:147], v[80:87], v204
    s_waitcnt lgkmcnt(0)
    v_exp_f32 v102, v102
    v_exp_f32 v103, v103
    v_exp_f32 v104, v104
    v_smfmac_f32_16x16x64_bf16 v[196:199], v[200:203], v[80:87], v204
    ds_read_b128 v[152:155], v24 offset:47104
    v_exp_f32 v105, v105
    v_exp_f32 v106, v106
    v_smfmac_f32_32x32x32_bf16 v[176:191], v[148:151], v[88:95], v204
    v_exp_f32 v107, v107
    v_exp_f32 v108, v108
    v_exp_f32 v109, v109
    v_smfmac_f32_16x16x64_bf16 v[196:199], v[200:203], v[88:95], v204
    ds_read_b128 v[156:159], v24 offset:48128
    v_exp_f32 v110, v110
    v_exp_f32 v111, v111
    v_mfma_f32_32x32x16_bf16 v[64:79], v[128:131], v[8:11], 0
    v_exp_f32 v112, v112
    v_exp_f32 v113, v113
    v_exp_f32 v114, v114
    v_mfma_f32_32x32x16_bf16 v[64:79], v[132:135], v[12:15], v[64:79]
    s_waitcnt lgkmcnt(1)
    v_exp_f32 v115, v115
    v_exp_f32 v116, v116
    v_exp_f32 v117, v117
    v_smfmac_f32_32x32x32_bf16 v[160:175], v[152:155], v[96:103], v204
    s_waitcnt lgkmcnt(0)
    v_exp_f32 v118, v118
    v_exp_f32 v119, v119
    v_exp_f32 v120, v120
    v_smfmac_f32_16x16x64_bf16 v[192:195], v[200:203], v[96:103], v204
    ds_read_b128 v[136:139], v24 offset:51200
    v_exp_f32 v121, v121
    v_exp_f32 v122, v122
    v_smfmac_f32_32x32x32_bf16 v[160:175], v[156:159], v[104:111], v204
    v_exp_f32 v123, v123
    v_exp_f32 v124, v124
    v_exp_f32 v125, v125
    v_smfmac_f32_16x16x64_bf16 v[192:195], v[200:203], v[104:111], v204
    ds_read_b128 v[140:143], v24 offset:52224
    v_exp_f32 v126, v126
    v_exp_f32 v127, v127
    v_mfma_f32_32x32x16_bf16 v[80:95], v[128:131], v[16:19], 0
    v_exp_f32 v64, v64
    v_exp_f32 v65, v65
    v_exp_f32 v66, v66
    v_mfma_f32_32x32x16_bf16 v[80:95], v[132:135], v[20:23], v[80:95]
    v_exp_f32 v67, v67
    v_exp_f32 v68, v68
    v_exp_f32 v69, v69
    v_smfmac_f32_32x32x32_bf16 v[176:191], v[152:155], v[112:119], v204
    s_waitcnt lgkmcnt(0)
    v_exp_f32 v70, v70
    v_exp_f32 v71, v71
    v_exp_f32 v72, v72
    v_smfmac_f32_16x16x64_bf16 v[196:199], v[200:203], v[112:119], v204
    ds_read_b128 v[144:147], v24 offset:57344
    v_exp_f32 v73, v73
    v_exp_f32 v74, v74
    v_smfmac_f32_32x32x32_bf16 v[176:191], v[156:159], v[120:127], v204
    v_exp_f32 v75, v75
    v_exp_f32 v76, v76
    v_exp_f32 v77, v77
    v_smfmac_f32_16x16x64_bf16 v[196:199], v[200:203], v[120:127], v204
    ds_read_b128 v[148:151], v24 offset:58368
    v_exp_f32 v78, v78
    v_exp_f32 v79, v79
    v_mfma_f32_32x32x16_bf16 v[96:111], v[136:139], v[8:11], 0
    v_exp_f32 v80, v80
    v_exp_f32 v81, v81
    v_exp_f32 v82, v82
    v_mfma_f32_32x32x16_bf16 v[96:111], v[140:143], v[12:15], v[96:111]
    s_waitcnt lgkmcnt(1)
    v_exp_f32 v83, v83
    v_exp_f32 v84, v84
    v_exp_f32 v85, v85
    v_smfmac_f32_32x32x32_bf16 v[160:175], v[144:147], v[64:71], v204
    s_waitcnt lgkmcnt(0)
    v_exp_f32 v86, v86
    v_exp_f32 v87, v87
    v_exp_f32 v88, v88
    v_smfmac_f32_16x16x64_bf16 v[192:195], v[200:203], v[64:71], v204
    ds_read_b128 v[128:131], v24 offset:53248
    v_exp_f32 v89, v89
    v_exp_f32 v90, v90
    v_smfmac_f32_32x32x32_bf16 v[160:175], v[148:151], v[72:79], v204
    v_exp_f32 v91, v91
    v_exp_f32 v92, v92
    v_exp_f32 v93, v93
    v_smfmac_f32_16x16x64_bf16 v[192:195], v[200:203], v[72:79], v204
    ds_read_b128 v[132:135], v24 offset:54272
    v_exp_f32 v94, v94
    v_exp_f32 v95, v95
    v_mfma_f32_32x32x16_bf16 v[112:127], v[136:139], v[16:19], 0
    v_exp_f32 v96, v96
    v_exp_f32 v97, v97
    v_exp_f32 v98, v98
    v_mfma_f32_32x32x16_bf16 v[112:127], v[140:143], v[20:23], v[112:127]
    v_exp_f32 v99, v99
    v_exp_f32 v100, v100
    v_exp_f32 v101, v101
    v_smfmac_f32_32x32x32_bf16 v[176:191], v[144:147], v[80:87], v204
    s_waitcnt lgkmcnt(0)
    v_exp_f32 v102, v102
    v_exp_f32 v103, v103
    v_exp_f32 v104, v104
    v_smfmac_f32_16x16x64_bf16 v[196:199], v[200:203], v[80:87], v204
    ds_read_b128 v[152:155], v24 offset:59392
    v_exp_f32 v105, v105
    v_exp_f32 v106, v106
    v_smfmac_f32_32x32x32_bf16 v[176:191], v[148:151], v[88:95], v204
    v_exp_f32 v107, v107
    v_exp_f32 v108, v108
    v_exp_f32 v109, v109
    v_smfmac_f32_16x16x64_bf16 v[196:199], v[200:203], v[88:95], v204
    ds_read_b128 v[156:159], v24 offset:60416
    v_exp_f32 v110, v110
    v_exp_f32 v111, v111
    v_mfma_f32_32x32x16_bf16 v[64:79], v[128:131], v[8:11], 0
    v_exp_f32 v112, v112
    v_exp_f32 v113, v113
    v_exp_f32 v114, v114
    v_mfma_f32_32x32x16_bf16 v[64:79], v[132:135], v[12:15], v[64:79]
    s_waitcnt lgkmcnt(1)
    v_exp_f32 v115, v115
    v_exp_f32 v116, v116
    v_exp_f32 v117, v117
    v_smfmac_f32_32x32x32_bf16 v[160:175], v[152:155], v[96:103], v204
    s_waitcnt lgkmcnt(0)
    v_exp_f32 v118, v118
    v_exp_f32 v119, v119
    v_exp_f32 v120, v120
    v_smfmac_f32_16x16x64_bf16 v[192:195], v[200:203], v[96:103], v204
    ds_read_b128 v[136:139], v24 offset:55296
    v_exp_f32 v121, v121
    v_exp_f32 v122, v122
    v_smfmac_f32_32x32x32_bf16 v[160:175], v[156:159], v[104:111], v204
    v_exp_f32 v123, v123
    v_exp_f32 v124, v124
    v_exp_f32 v125, v125
    v_smfmac_f32_16x16x64_bf16 v[192:195], v[200:203], v[104:111], v204
    ds_read_b128 v[140:143], v24 offset:56320
    v_exp_f32 v126, v126
    v_exp_f32 v127, v127
    v_mfma_f32_32x32x16_bf16 v[80:95], v[128:131], v[16:19], 0
    v_exp_f32 v64, v64
    v_exp_f32 v65, v65
    v_exp_f32 v66, v66
    v_mfma_f32_32x32x16_bf16 v[80:95], v[132:135], v[20:23], v[80:95]
    v_exp_f32 v67, v67
    v_exp_f32 v68, v68
    v_exp_f32 v69, v69
    v_smfmac_f32_32x32x32_bf16 v[176:191], v[152:155], v[112:119], v204
    s_waitcnt lgkmcnt(0)
    v_exp_f32 v70, v70
    v_exp_f32 v71, v71
    v_exp_f32 v72, v72
    v_smfmac_f32_16x16x64_bf16 v[196:199], v[200:203], v[112:119], v204
    ds_read_b128 v[144:147], v24 offset:61440
    v_exp_f32 v73, v73
    v_exp_f32 v74, v74
    v_smfmac_f32_32x32x32_bf16 v[176:191], v[156:159], v[120:127], v204
    v_exp_f32 v75, v75
    v_exp_f32 v76, v76
    v_exp_f32 v77, v77
    v_smfmac_f32_16x16x64_bf16 v[196:199], v[200:203], v[120:127], v204
    ds_read_b128 v[148:151], v24 offset:62464
    v_exp_f32 v78, v78
    v_exp_f32 v79, v79
    v_mfma_f32_32x32x16_bf16 v[96:111], v[136:139], v[8:11], 0
    s_barrier
    v_exp_f32 v80, v80
    v_exp_f32 v81, v81
    v_exp_f32 v82, v82
    v_mfma_f32_32x32x16_bf16 v[96:111], v[140:143], v[12:15], v[96:111]
    s_waitcnt lgkmcnt(1)
    v_exp_f32 v83, v83
    v_exp_f32 v84, v84
    v_exp_f32 v85, v85
    v_smfmac_f32_32x32x32_bf16 v[160:175], v[144:147], v[64:71], v204
    s_waitcnt lgkmcnt(0)
    v_exp_f32 v86, v86
    v_exp_f32 v87, v87
    v_exp_f32 v88, v88
    v_smfmac_f32_16x16x64_bf16 v[192:195], v[200:203], v[64:71], v204
    ds_read_b128 v[128:131], v24 offset:0
    v_exp_f32 v89, v89
    v_exp_f32 v90, v90
    v_smfmac_f32_32x32x32_bf16 v[160:175], v[148:151], v[72:79], v204
    v_exp_f32 v91, v91
    v_exp_f32 v92, v92
    v_exp_f32 v93, v93
    v_smfmac_f32_16x16x64_bf16 v[192:195], v[200:203], v[72:79], v204
    ds_read_b128 v[132:135], v24 offset:1024
    v_exp_f32 v94, v94
    v_exp_f32 v95, v95
    v_mfma_f32_32x32x16_bf16 v[112:127], v[136:139], v[16:19], 0
    v_exp_f32 v96, v96
    v_exp_f32 v97, v97
    v_exp_f32 v98, v98
    v_mfma_f32_32x32x16_bf16 v[112:127], v[140:143], v[20:23], v[112:127]
    v_exp_f32 v99, v99
    v_exp_f32 v100, v100
    v_exp_f32 v101, v101
    v_smfmac_f32_32x32x32_bf16 v[176:191], v[144:147], v[80:87], v204
    s_waitcnt lgkmcnt(0)
    v_exp_f32 v102, v102
    v_exp_f32 v103, v103
    v_exp_f32 v104, v104
    v_smfmac_f32_16x16x64_bf16 v[196:199], v[200:203], v[80:87], v204
    ds_read_b128 v[152:155], v24 offset:63488
    v_exp_f32 v105, v105
    v_exp_f32 v106, v106
    v_smfmac_f32_32x32x32_bf16 v[176:191], v[148:151], v[88:95], v204
    v_exp_f32 v107, v107
    v_exp_f32 v108, v108
    v_exp_f32 v109, v109
    v_smfmac_f32_16x16x64_bf16 v[196:199], v[200:203], v[88:95], v204
    ds_read_b128 v[156:159], v24 offset:64512
    v_exp_f32 v110, v110
    v_exp_f32 v111, v111
    v_mfma_f32_32x32x16_bf16 v[64:79], v[128:131], v[8:11], 0
    s_sub_u32 s54, s54, 1
    v_exp_f32 v112, v112
    v_exp_f32 v113, v113
    v_exp_f32 v114, v114
    v_mfma_f32_32x32x16_bf16 v[64:79], v[132:135], v[12:15], v[64:79]
    s_waitcnt lgkmcnt(1)
    v_exp_f32 v115, v115
    v_exp_f32 v116, v116
    v_exp_f32 v117, v117
    v_smfmac_f32_32x32x32_bf16 v[160:175], v[152:155], v[96:103], v204
    s_waitcnt lgkmcnt(0)
    v_exp_f32 v118, v118
    v_exp_f32 v119, v119
    v_exp_f32 v120, v120
    v_smfmac_f32_16x16x64_bf16 v[192:195], v[200:203], v[96:103], v204
    ds_read_b128 v[136:139], v24 offset:2048
    v_exp_f32 v121, v121
    v_exp_f32 v122, v122
    v_smfmac_f32_32x32x32_bf16 v[160:175], v[156:159], v[104:111], v204
    s_cmp_lg_u32 s54, 0
    v_exp_f32 v123, v123
    v_exp_f32 v124, v124
    v_exp_f32 v125, v125
    v_smfmac_f32_16x16x64_bf16 v[192:195], v[200:203], v[104:111], v204
    ds_read_b128 v[140:143], v24 offset:3072
    v_exp_f32 v126, v126
    v_exp_f32 v127, v127
    s_cbranch_scc1 c_attn_loop
    v_smfmac_f32_16x16x64_bf16 v[196:199], v[200:203], v[112:119], v204
    v_smfmac_f32_16x16x64_bf16 v[196:199], v[200:203], v[120:127], v204
    v_smfmac_f32_32x32x32_bf16 v[176:191], v[152:155], v[112:119], v204
    v_smfmac_f32_32x32x32_bf16 v[176:191], v[156:159], v[120:127], v204
    v_mov_b32 v25, 0x5f000000
    v_mov_b32 v26, 0x2b800000
    v_cmp_lt_f32 s[56:57], v192, v25
    v_cmp_gt_f32 vcc, v192, v26
    s_and_b64 s[56:57], s[56:57], vcc
    s_nop 0
    v_cmp_lt_f32 vcc, v196, v25
    s_and_b64 s[56:57], s[56:57], vcc
    v_cmp_gt_f32 vcc, v196, v26
    s_and_b64 s[56:57], s[56:57], vcc
    s_cmp_lg_u64 s[56:57], -1
    s_cbranch_scc1 c_attn_slow
c_attn_fin:
    s_lshl_b32 s3, s48, 17
    s_lshl_b32 s55, s7, 12
    s_add_u32 s3, s3, s55
    s_and_b32 s55, s6, 1
    s_lshl_b32 s55, s55, 11
    s_add_u32 s3, s3, s55
    s_lshl_b32 s55, s9, 22
    s_add_u32 s3, s3, s55
    s_add_u32 s3, s3, 16777216
    v_rcp_f32 v192, v192
    s_nop 0
    v_pk_mul_f32 v[160:161], v[192:193], v[160:161] op_sel_hi:[0,1]
    v_pk_mul_f32 v[162:163], v[192:193], v[162:163] op_sel_hi:[0,1]
    v_pk_mul_f32 v[164:165], v[192:193], v[164:165] op_sel_hi:[0,1]
    v_pk_mul_f32 v[166:167], v[192:193], v[166:167] op_sel_hi:[0,1]
    v_pk_mul_f32 v[168:169], v[192:193], v[168:169] op_sel_hi:[0,1]
    v_pk_mul_f32 v[170:171], v[192:193], v[170:171] op_sel_hi:[0,1]
    v_pk_mul_f32 v[172:173], v[192:193], v[172:173] op_sel_hi:[0,1]
    v_pk_mul_f32 v[174:175], v[192:193], v[174:175] op_sel_hi:[0,1]
    v_cvt_pk_bf16_f32 v160, v160, v161
    v_cvt_pk_bf16_f32 v161, v162, v163
    v_cvt_pk_bf16_f32 v162, v164, v165
    v_cvt_pk_bf16_f32 v163, v166, v167
    v_cvt_pk_bf16_f32 v164, v168, v169
    v_cvt_pk_bf16_f32 v165, v170, v171
    v_cvt_pk_bf16_f32 v166, v172, v173
    v_cvt_pk_bf16_f32 v167, v174, v175
    buffer_store_dwordx4 v[160:163], v5, s[12:15], s3 offen offset:0 sc1
    buffer_store_dwordx4 v[164:167], v5, s[12:15], s3 offen offset:1024 sc1
    s_add_u32 s3, s3, 65536
    v_rcp_f32 v196, v196
    s_nop 0
    v_pk_mul_f32 v[176:177], v[196:197], v[176:177] op_sel_hi:[0,1]
    v_pk_mul_f32 v[178:179], v[196:197], v[178:179] op_sel_hi:[0,1]
    v_pk_mul_f32 v[180:181], v[196:197], v[180:181] op_sel_hi:[0,1]
    v_pk_mul_f32 v[182:183], v[196:197], v[182:183] op_sel_hi:[0,1]
    v_pk_mul_f32 v[184:185], v[196:197], v[184:185] op_sel_hi:[0,1]
    v_pk_mul_f32 v[186:187], v[196:197], v[186:187] op_sel_hi:[0,1]
    v_pk_mul_f32 v[188:189], v[196:197], v[188:189] op_sel_hi:[0,1]
    v_pk_mul_f32 v[190:191], v[196:197], v[190:191] op_sel_hi:[0,1]
    v_cvt_pk_bf16_f32 v176, v176, v177
    v_cvt_pk_bf16_f32 v177, v178, v179
    v_cvt_pk_bf16_f32 v178, v180, v181
    v_cvt_pk_bf16_f32 v179, v182, v183
    v_cvt_pk_bf16_f32 v180, v184, v185
    v_cvt_pk_bf16_f32 v181, v186, v187
    v_cvt_pk_bf16_f32 v182, v188, v189
    v_cvt_pk_bf16_f32 v183, v190, v191
    buffer_store_dwordx4 v[176:179], v5, s[12:15], s3 offen offset:0 sc1
    buffer_store_dwordx4 v[180:183], v5, s[12:15], s3 offen offset:1024 sc1
    s_add_u32 s3, s3, 65536
    s_branch c_wo
.p2align 6
h_first_tail:
    v_mov_b32 v8, 0
    v_mov_b32 v9, 0
    v_mov_b32 v10, 159488
    ds_write_b64 v10, v[8:9]
    ds_write_b64 v10, v[8:9] offset:8
    ds_write_b64 v10, v[8:9] offset:16
    ds_write_b64 v10, v[8:9] offset:24
    s_waitcnt lgkmcnt(0)
    s_barrier
    s_sub_u32 s50, s50, 8000
    s_load_dword s10, s[46:47], 0
    s_waitcnt lgkmcnt(0)
    s_sub_u32 s51, s10, s50
    s_and_b32 s3, s10, 1
    s_cselect_b32 s51, s51, -1
    s_cmp_ge_i32 s51, 0
    s_cbranch_scc1 h_first_non_ok
    s_load_dword s10, s[46:47], 128
    s_waitcnt lgkmcnt(0)
    s_sub_u32 s51, s10, s50
    s_and_b32 s3, s10, 1
    s_cselect_b32 s51, s51, -1
    s_cmp_ge_i32 s51, 0
    s_cbranch_scc1 h_first_non_ok
    s_load_dword s10, s[46:47], 64
    s_waitcnt lgkmcnt(0)
    s_sub_u32 s51, s10, s50
    s_and_b32 s3, s10, 1
    s_cselect_b32 s51, s51, -1
    s_cmp_ge_i32 s51, 0
    s_cbranch_scc1 h_first_non_ok
    s_load_dword s10, s[46:47], 192
    s_waitcnt lgkmcnt(0)
    s_sub_u32 s51, s10, s50
    s_and_b32 s3, s10, 1
    s_cselect_b32 s51, s51, -1
    s_cmp_ge_i32 s51, 0
    s_cbranch_scc1 h_first_non_ok
    s_mov_b32 s58, 0
    s_and_b32 s57, s2, 0xc0
h_first_non:
    s_load_dword s10, s[46:47], s57 glc
    s_waitcnt lgkmcnt(0)
    s_sub_u32 s51, s10, s50
    s_and_b32 s3, s10, 1
    s_cselect_b32 s51, s51, -1
    s_cmp_ge_i32 s51, 0
    s_cbranch_scc1 h_first_non_ok
    s_add_u32 s58, s58, 1
    s_cmp_gt_u32 s58, 100
    s_cselect_b32 s50, s10, s50
    s_cmp_lt_u32 s58, 0x100000
    s_cbranch_scc1 h_first_non
    s_mov_b32 s10, 1
h_first_non_ok:
    v_mov_b32 v12, s10
    ds_write_b32 v10, v12 offset:4
    v_lshlrev_b32 v13, 7, v1
    s_lshl_b32 s50, s2, 13
    s_mov_b32 s28, s36
    s_mov_b32 s29, s37
    s_mov_b32 s30, 2097152
    s_mov_b32 s31, 0x00020000
    buffer_load_dword v14, v13, s[28:31], s50 offen
    s_mov_b32 s9, 0
h_qkvA:
    s_mul_i32 s98, s9, 786432
    s_add_u32 s98, s98, 65273856
    s_lshl_b32 s99, s11, 10
    s_add_u32 s98, s98, s99
    s_add_u32 s96, s4, s98
    s_addc_u32 s97, s5, 0
    s_mov_b32 s98, s10
    s_mov_b32 s99, s10
    v_and_b32 v1, 63, v0
    v_lshlrev_b32 v5, 4, v1
    v_and_b32 v20, 15, v1
    v_lshrrev_b32 v11, 4, v1
    v_min_u32 v11, 2, v11
    v_lshlrev_b32 v21, 3, v20
    v_lshl_add_u32 v12, v11, 7, v21
    v_add_u32 v12, 155648, v12
    v_lshl_add_u32 v11, v11, 16, v21
    v_mov_b32 v10, 159496
    s_add_u32 s3, s9, 1
    v_mov_b32 v13, s3
    s_and_b32 s3, s6, 14
    s_lshl_b32 s3, s3, 2
    s_sub_u32 s3, s3, 1
    s_max_i32 s3, s3, 0
    s_lshl_b32 s3, s3, 16
    s_lshl_b32 s48, s9, 22
    s_add_u32 s3, s3, s48
    s_add_u32 s20, s4, s3
    s_addc_u32 s21, s5, 0
    s_mov_b32 s22, 65536
    s_mov_b32 s23, 0x00020000
    s_cmp_lt_u32 s6, 2
    s_cselect_b32 s22, 0, s22
    s_cselect_b32 s3, 0, 512
    s_add_u32 s96, s96, s3
    s_addc_u32 s97, s97, 0
    v_bfe_u32 v21, v1, 4, 1
    v_lshl_add_u32 v6, v21, 5, v20
    v_lshlrev_b32 v6, 4, v6
    v_lshrrev_b32 v21, 5, v1
    v_lshl_add_u32 v6, v21, 10, v6
    v_add_u32 v6, 256, v6
    v_add_u32 v16, 49152, v5
    s_cmp_eq_u32 s9, 0
    s_cbranch_scc1 h_qkvA_noend
    s_barrier
    s_cmp_lt_u32 s9, 2
    s_cbranch_scc1 c4_10
    ds_write_b128 v16, v[64:67] offset:0
    ds_write_b128 v16, v[68:71] offset:1024
    ds_write_b128 v16, v[72:75] offset:2048
    ds_write_b128 v16, v[76:79] offset:3072
    ds_write_b128 v16, v[80:83] offset:4096
    ds_write_b128 v16, v[84:87] offset:5120
    ds_write_b128 v16, v[88:91] offset:6144
    ds_write_b128 v16, v[92:95] offset:7168
    ds_write_b128 v16, v[96:99] offset:8192
    ds_write_b128 v16, v[100:103] offset:9216
    ds_write_b128 v16, v[104:107] offset:10240
    ds_write_b128 v16, v[108:111] offset:11264
    ds_write_b128 v16, v[112:115] offset:12288
    ds_write_b128 v16, v[116:119] offset:13312
    ds_write_b128 v16, v[120:123] offset:14336
    ds_write_b128 v16, v[124:127] offset:15360
    ds_write_b128 v16, v[128:131] offset:16384
    ds_write_b128 v16, v[132:135] offset:17408
    ds_write_b128 v16, v[136:139] offset:18432
    ds_write_b128 v16, v[140:143] offset:19456
    ds_write_b128 v16, v[144:147] offset:20480
    ds_write_b128 v16, v[148:151] offset:21504
    ds_write_b128 v16, v[152:155] offset:22528
    ds_write_b128 v16, v[156:159] offset:23552
    s_waitcnt lgkmcnt(0)
c4_10:
    s_barrier
h_qkvA_noend:
    s_mov_b32 s3, 0x100000
poll_11:
    s_load_dwordx8 s[80:87], s[96:97], 0 glc
    s_load_dwordx8 s[88:95], s[96:97], 128 glc
    s_sub_u32 s3, s3, 1
    s_cbranch_scc1 poll_11_ok
    s_waitcnt lgkmcnt(0)
    s_xor_b64 s[100:101], s[80:81], s[98:99]
    s_xor_b64 s[80:81], s[82:83], s[98:99]
    s_or_b64 s[100:101], s[100:101], s[80:81]
    s_xor_b64 s[80:81], s[84:85], s[98:99]
    s_or_b64 s[100:101], s[100:101], s[80:81]
    s_xor_b64 s[80:81], s[86:87], s[98:99]
    s_or_b64 s[100:101], s[100:101], s[80:81]
    s_xor_b64 s[80:81], s[88:89], s[98:99]
    s_or_b64 s[100:101], s[100:101], s[80:81]
    s_xor_b64 s[80:81], s[90:91], s[98:99]
    s_or_b64 s[100:101], s[100:101], s[80:81]
    s_xor_b64 s[80:81], s[92:93], s[98:99]
    s_or_b64 s[100:101], s[100:101], s[80:81]
    s_xor_b64 s[80:81], s[94:95], s[98:99]
    s_or_b64 s[100:101], s[100:101], s[80:81]
    s_cbranch_scc1 poll_11
poll_11_ok:
    s_waitcnt lgkmcnt(0)
    ds_write_b32 v10, v13
    s_mov_b32 m0, 147456
    s_mov_b32 s48, 0
    buffer_load_dwordx4 v6, s[20:23], s48 offen sc1 lds
    s_mov_b32 m0, 148480
    s_mov_b32 s48, 2048
    buffer_load_dwordx4 v6, s[20:23], s48 offen sc1 lds
    s_mov_b32 m0, 149504
    s_mov_b32 s48, 4096
    buffer_load_dwordx4 v6, s[20:23], s48 offen sc1 lds
    s_mov_b32 m0, 150528
    s_mov_b32 s48, 6144
    buffer_load_dwordx4 v6, s[20:23], s48 offen sc1 lds
    s_mov_b32 m0, 151552
    s_mov_b32 s48, 8192
    buffer_load_dwordx4 v6, s[20:23], s48 offen sc1 lds
    s_mov_b32 m0, 152576
    s_mov_b32 s48, 10240
    buffer_load_dwordx4 v6, s[20:23], s48 offen sc1 lds
    s_mov_b32 m0, 153600
    s_mov_b32 s48, 12288
    buffer_load_dwordx4 v6, s[20:23], s48 offen sc1 lds
    s_mov_b32 m0, 154624
    s_mov_b32 s48, 14336
    buffer_load_dwordx4 v6, s[20:23], s48 offen sc1 lds
    s_lshl_b32 s56, s7, 12
    s_and_b32 s57, s6, 1
    s_lshl_b32 s57, s57, 7
    s_add_u32 s56, s56, s57
    s_add_u32 s56, s56, 63963136
    v_lshlrev_b32 v15, 7, v1
    s_lshr_b32 s59, s2, 3
    s_mul_i32 s59, s59, 3
    s_lshr_b32 s59, s59, 5
    s_lshl_b32 s3, s9, 4
    s_add_u32 s59, s59, s3
    s_waitcnt vmcnt(4)
    s_barrier
    s_waitcnt vmcnt(0)
    s_barrier
    s_mov_b32 m0, 147456
    s_mov_b32 s48, 16384
    buffer_load_dwordx4 v6, s[20:23], s48 offen sc1 lds
    s_mov_b32 m0, 148480
    s_mov_b32 s48, 18432
    buffer_load_dwordx4 v6, s[20:23], s48 offen sc1 lds
    s_mov_b32 m0, 149504
    s_mov_b32 s48, 20480
    buffer_load_dwordx4 v6, s[20:23], s48 offen sc1 lds
    s_mov_b32 m0, 150528
    s_mov_b32 s48, 22528
    buffer_load_dwordx4 v6, s[20:23], s48 offen sc1 lds
    s_waitcnt vmcnt(0)
    s_waitcnt vmcnt(0)
    s_barrier
    s_mov_b32 m0, 151552
    s_mov_b32 s48, 24576
    buffer_load_dwordx4 v6, s[20:23], s48 offen sc1 lds
    s_mov_b32 m0, 152576
    s_mov_b32 s48, 26624
    buffer_load_dwordx4 v6, s[20:23], s48 offen sc1 lds
    s_mov_b32 m0, 153600
    s_mov_b32 s48, 28672
    buffer_load_dwordx4 v6, s[20:23], s48 offen sc1 lds
    s_mov_b32 m0, 154624
    s_mov_b32 s48, 30720
    buffer_load_dwordx4 v6, s[20:23], s48 offen sc1 lds
    s_cmp_ge_u32 s9, 2
    s_cbranch_scc1 cs_13
    buffer_load_dwordx2 v[32:33], v11, s[12:15], s56 offen offset:0 sc1
    buffer_load_dwordx2 v[34:35], v11, s[12:15], s56 offen offset:256 sc1
    buffer_load_dwordx2 v[36:37], v11, s[12:15], s56 offen offset:512 sc1
    buffer_load_dwordx2 v[38:39], v11, s[12:15], s56 offen offset:768 sc1
    buffer_load_dwordx2 v[40:41], v11, s[12:15], s56 offen offset:1024 sc1
    buffer_load_dwordx2 v[42:43], v11, s[12:15], s56 offen offset:1280 sc1
    buffer_load_dwordx2 v[44:45], v11, s[12:15], s56 offen offset:1536 sc1
    buffer_load_dwordx2 v[46:47], v11, s[12:15], s56 offen offset:1792 sc1
    buffer_load_dwordx2 v[48:49], v11, s[12:15], s56 offen offset:2048 sc1
    buffer_load_dwordx2 v[50:51], v11, s[12:15], s56 offen offset:2304 sc1
    buffer_load_dwordx2 v[52:53], v11, s[12:15], s56 offen offset:2560 sc1
    buffer_load_dwordx2 v[54:55], v11, s[12:15], s56 offen offset:2816 sc1
cs_13:
    s_waitcnt vmcnt(0)
    s_waitcnt vmcnt(12)
    s_barrier
    s_mov_b32 m0, 147456
    s_mov_b32 s48, 32768
    buffer_load_dwordx4 v6, s[20:23], s48 offen sc1 lds
    s_mov_b32 m0, 148480
    s_mov_b32 s48, 34816
    buffer_load_dwordx4 v6, s[20:23], s48 offen sc1 lds
    s_mov_b32 m0, 149504
    s_mov_b32 s48, 36864
    buffer_load_dwordx4 v6, s[20:23], s48 offen sc1 lds
    s_mov_b32 m0, 150528
    s_mov_b32 s48, 38912
    buffer_load_dwordx4 v6, s[20:23], s48 offen sc1 lds
    s_cmp_ge_u32 s9, 2
    s_cbranch_scc1 cs_14
    buffer_load_dwordx2 v[56:57], v11, s[12:15], s56 offen offset:3072 sc1
    buffer_load_dwordx2 v[58:59], v11, s[12:15], s56 offen offset:3328 sc1
    buffer_load_dwordx2 v[60:61], v11, s[12:15], s56 offen offset:3584 sc1
    buffer_load_dwordx2 v[62:63], v11, s[12:15], s56 offen offset:3840 sc1
cs_14:
    s_waitcnt vmcnt(0)
    s_waitcnt vmcnt(4)
    s_barrier
    s_mov_b32 m0, 151552
    s_mov_b32 s48, 40960
    buffer_load_dwordx4 v6, s[20:23], s48 offen sc1 lds
    s_mov_b32 m0, 152576
    s_mov_b32 s48, 43008
    buffer_load_dwordx4 v6, s[20:23], s48 offen sc1 lds
    s_mov_b32 m0, 153600
    s_mov_b32 s48, 45056
    buffer_load_dwordx4 v6, s[20:23], s48 offen sc1 lds
    s_mov_b32 m0, 154624
    s_mov_b32 s48, 47104
    buffer_load_dwordx4 v6, s[20:23], s48 offen sc1 lds
    s_cmp_ge_u32 s9, 2
    s_cbranch_scc1 c4_15
    ds_read_b128 v[64:67], v16 offset:0
    ds_read_b128 v[68:71], v16 offset:1024
    ds_read_b128 v[72:75], v16 offset:2048
    ds_read_b128 v[76:79], v16 offset:3072
    ds_read_b128 v[80:83], v16 offset:4096
    ds_read_b128 v[84:87], v16 offset:5120
    ds_read_b128 v[88:91], v16 offset:6144
    ds_read_b128 v[92:95], v16 offset:7168
    ds_read_b128 v[96:99], v16 offset:8192
    ds_read_b128 v[100:103], v16 offset:9216
    ds_read_b128 v[104:107], v16 offset:10240
    ds_read_b128 v[108:111], v16 offset:11264
    ds_read_b128 v[112:115], v16 offset:12288
    ds_read_b128 v[116:119], v16 offset:13312
    ds_read_b128 v[120:123], v16 offset:14336
    ds_read_b128 v[124:127], v16 offset:15360
    ds_read_b128 v[128:131], v16 offset:16384
    ds_read_b128 v[132:135], v16 offset:17408
    ds_read_b128 v[136:139], v16 offset:18432
    ds_read_b128 v[140:143], v16 offset:19456
    ds_read_b128 v[144:147], v16 offset:20480
    ds_read_b128 v[148:151], v16 offset:21504
    ds_read_b128 v[152:155], v16 offset:22528
    ds_read_b128 v[156:159], v16 offset:23552
    s_waitcnt lgkmcnt(0)
c4_15:
    s_cmp_ge_u32 s9, 2
    s_cbranch_scc1 cs_16
    s_waitcnt vmcnt(4)
    v_add_f32 v32, v32, v48
    v_add_f32 v33, v33, v49
    v_add_f32 v34, v34, v50
    v_add_f32 v35, v35, v51
    v_add_f32 v36, v36, v52
    v_add_f32 v37, v37, v53
    v_add_f32 v38, v38, v54
    v_add_f32 v39, v39, v55
    v_add_f32 v40, v40, v56
    v_add_f32 v41, v41, v57
    v_add_f32 v42, v42, v58
    v_add_f32 v43, v43, v59
cs_16:
    s_waitcnt vmcnt(0)
    s_waitcnt vmcnt(0)
    s_barrier
    s_mov_b32 m0, 147456
    s_mov_b32 s48, 49152
    buffer_load_dwordx4 v6, s[20:23], s48 offen sc1 lds
    s_mov_b32 m0, 148480
    s_mov_b32 s48, 51200
    buffer_load_dwordx4 v6, s[20:23], s48 offen sc1 lds
    s_mov_b32 m0, 149504
    s_mov_b32 s48, 53248
    buffer_load_dwordx4 v6, s[20:23], s48 offen sc1 lds
    s_mov_b32 m0, 150528
    s_mov_b32 s48, 55296
    buffer_load_dwordx4 v6, s[20:23], s48 offen sc1 lds
    s_cmp_ge_u32 s9, 2
    s_cbranch_scc1 cs_17
    v_add_f32 v44, v44, v60
    v_add_f32 v45, v45, v61
    v_add_f32 v46, v46, v62
    v_add_f32 v47, v47, v63
    v_add_f32 v32, v32, v40
    v_add_f32 v33, v33, v41
    v_add_f32 v34, v34, v42
    v_add_f32 v35, v35, v43
    v_add_f32 v36, v36, v44
    v_add_f32 v37, v37, v45
    v_add_f32 v38, v38, v46
    v_add_f32 v39, v39, v47
cs_17:
    s_waitcnt vmcnt(0)
    s_waitcnt vmcnt(0)
    s_barrier
    s_mov_b32 m0, 151552
    s_mov_b32 s48, 57344
    buffer_load_dwordx4 v6, s[20:23], s48 offen sc1 lds
    s_mov_b32 m0, 152576
    s_mov_b32 s48, 59392
    buffer_load_dwordx4 v6, s[20:23], s48 offen sc1 lds
    s_mov_b32 m0, 153600
    s_mov_b32 s48, 61440
    buffer_load_dwordx4 v6, s[20:23], s48 offen sc1 lds
    s_mov_b32 m0, 154624
    s_mov_b32 s48, 63488
    buffer_load_dwordx4 v6, s[20:23], s48 offen sc1 lds
    s_cmp_ge_u32 s9, 2
    s_cbranch_scc1 cs_18
    v_add_f32 v32, v32, v36
    v_add_f32 v33, v33, v37
    v_add_f32 v34, v34, v38
    v_add_f32 v35, v35, v39
    v_add_f32 v32, v32, v34
    v_add_f32 v33, v33, v35
    ds_write_b64 v12, v[32:33]
    s_waitcnt lgkmcnt(0)
cs_18:
    s_waitcnt vmcnt(0)
    s_waitcnt vmcnt(0)
    s_barrier
    s_barrier
    s_barrier
    s_branch h_wo
h_qkvB:
    s_mul_i32 s98, s9, 786432
    s_add_u32 s98, s98, 65273856
    s_lshl_b32 s99, s11, 10
    s_add_u32 s98, s98, s99
    s_add_u32 s96, s4, s98
    s_addc_u32 s97, s5, 0
    s_mov_b32 s98, s10
    s_mov_b32 s99, s10
    v_and_b32 v1, 63, v0
    v_lshlrev_b32 v5, 4, v1
    v_and_b32 v20, 15, v1
    v_lshrrev_b32 v11, 4, v1
    v_min_u32 v11, 2, v11
    v_lshlrev_b32 v21, 3, v20
    v_lshl_add_u32 v12, v11, 7, v21
    v_add_u32 v12, 156032, v12
    v_lshl_add_u32 v11, v11, 16, v21
    v_mov_b32 v10, 159496
    s_add_u32 s3, s9, 1
    v_mov_b32 v13, s3
    v_add_u32 v16, 49152, v5
    s_barrier
    s_cmp_lt_u32 s9, 2
    s_cbranch_scc1 c4_21
    ds_write_b128 v16, v[160:163] offset:0
    ds_write_b128 v16, v[164:167] offset:1024
    ds_write_b128 v16, v[168:171] offset:2048
    ds_write_b128 v16, v[172:175] offset:3072
    ds_write_b128 v16, v[176:179] offset:4096
    ds_write_b128 v16, v[180:183] offset:5120
    ds_write_b128 v16, v[184:187] offset:6144
    ds_write_b128 v16, v[188:191] offset:7168
    ds_write_b128 v16, v[192:195] offset:8192
    ds_write_b128 v16, v[196:199] offset:9216
    ds_write_b128 v16, v[200:203] offset:10240
    ds_write_b128 v16, v[204:207] offset:11264
    ds_write_b128 v16, v[208:211] offset:12288
    ds_write_b128 v16, v[212:215] offset:13312
    ds_write_b128 v16, v[216:219] offset:14336
    ds_write_b128 v16, v[220:223] offset:15360
    ds_write_b128 v16, a[0:3] offset:16384
    ds_write_b128 v16, a[4:7] offset:17408
    ds_write_b128 v16, a[8:11] offset:18432
    ds_write_b128 v16, a[12:15] offset:19456
    ds_write_b128 v16, a[16:19] offset:20480
    ds_write_b128 v16, a[20:23] offset:21504
    ds_write_b128 v16, a[24:27] offset:22528
    ds_write_b128 v16, a[28:31] offset:23552
    s_waitcnt lgkmcnt(0)
c4_21:
    s_barrier
    s_mov_b32 s3, 0x100000
poll_22:
    s_load_dwordx8 s[88:95], s[96:97], 0 glc
    s_sub_u32 s3, s3, 1
    s_cbranch_scc1 poll_22_ok
    s_waitcnt lgkmcnt(0)
    s_xor_b64 s[100:101], s[88:89], s[98:99]
    s_xor_b64 s[88:89], s[90:91], s[98:99]
    s_or_b64 s[100:101], s[100:101], s[88:89]
    s_xor_b64 s[88:89], s[92:93], s[98:99]
    s_or_b64 s[100:101], s[100:101], s[88:89]
    s_xor_b64 s[88:89], s[94:95], s[98:99]
    s_or_b64 s[100:101], s[100:101], s[88:89]
    s_cbranch_scc1 poll_22
poll_22_ok:
    s_waitcnt lgkmcnt(0)
    ds_write_b32 v10, v13
    s_lshl_b32 s56, s7, 12
    s_and_b32 s57, s6, 1
    s_lshl_b32 s57, s57, 7
    s_add_u32 s56, s56, s57
    s_add_u32 s56, s56, 64159744
    s_barrier
    s_barrier
    s_barrier
    s_cmp_ge_u32 s9, 2
    s_cbranch_scc1 cs_24
    buffer_load_dwordx2 v[32:33], v11, s[12:15], s56 offen offset:0 sc1
    buffer_load_dwordx2 v[34:35], v11, s[12:15], s56 offen offset:256 sc1
    buffer_load_dwordx2 v[36:37], v11, s[12:15], s56 offen offset:512 sc1
    buffer_load_dwordx2 v[38:39], v11, s[12:15], s56 offen offset:768 sc1
    buffer_load_dwordx2 v[40:41], v11, s[12:15], s56 offen offset:1024 sc1
    buffer_load_dwordx2 v[42:43], v11, s[12:15], s56 offen offset:1280 sc1
    buffer_load_dwordx2 v[44:45], v11, s[12:15], s56 offen offset:1536 sc1
    buffer_load_dwordx2 v[46:47], v11, s[12:15], s56 offen offset:1792 sc1
    buffer_load_dwordx2 v[48:49], v11, s[12:15], s56 offen offset:2048 sc1
    buffer_load_dwordx2 v[50:51], v11, s[12:15], s56 offen offset:2304 sc1
    buffer_load_dwordx2 v[52:53], v11, s[12:15], s56 offen offset:2560 sc1
    buffer_load_dwordx2 v[54:55], v11, s[12:15], s56 offen offset:2816 sc1
cs_24:
    s_barrier
    s_cmp_ge_u32 s9, 2
    s_cbranch_scc1 cs_25
    buffer_load_dwordx2 v[56:57], v11, s[12:15], s56 offen offset:3072 sc1
    buffer_load_dwordx2 v[58:59], v11, s[12:15], s56 offen offset:3328 sc1
    buffer_load_dwordx2 v[60:61], v11, s[12:15], s56 offen offset:3584 sc1
    buffer_load_dwordx2 v[62:63], v11, s[12:15], s56 offen offset:3840 sc1
cs_25:
    s_barrier
    s_cmp_ge_u32 s9, 2
    s_cbranch_scc1 c4_26
    ds_read_b128 v[160:163], v16 offset:0
    ds_read_b128 v[164:167], v16 offset:1024
    ds_read_b128 v[168:171], v16 offset:2048
    ds_read_b128 v[172:175], v16 offset:3072
    ds_read_b128 v[176:179], v16 offset:4096
    ds_read_b128 v[180:183], v16 offset:5120
    ds_read_b128 v[184:187], v16 offset:6144
    ds_read_b128 v[188:191], v16 offset:7168
    ds_read_b128 v[192:195], v16 offset:8192
    ds_read_b128 v[196:199], v16 offset:9216
    ds_read_b128 v[200:203], v16 offset:10240
    ds_read_b128 v[204:207], v16 offset:11264
    ds_read_b128 v[208:211], v16 offset:12288
    ds_read_b128 v[212:215], v16 offset:13312
    ds_read_b128 v[216:219], v16 offset:14336
    ds_read_b128 v[220:223], v16 offset:15360
    ds_read_b128 a[0:3], v16 offset:16384
    ds_read_b128 a[4:7], v16 offset:17408
    ds_read_b128 a[8:11], v16 offset:18432
    ds_read_b128 a[12:15], v16 offset:19456
    ds_read_b128 a[16:19], v16 offset:20480
    ds_read_b128 a[20:23], v16 offset:21504
    ds_read_b128 a[24:27], v16 offset:22528
    ds_read_b128 a[28:31], v16 offset:23552
    s_waitcnt lgkmcnt(0)
c4_26:
    s_cmp_ge_u32 s9, 2
    s_cbranch_scc1 cs_27
    s_waitcnt vmcnt(0)
    v_add_f32 v32, v32, v48
    v_add_f32 v33, v33, v49
    v_add_f32 v34, v34, v50
    v_add_f32 v35, v35, v51
    v_add_f32 v36, v36, v52
    v_add_f32 v37, v37, v53
    v_add_f32 v38, v38, v54
    v_add_f32 v39, v39, v55
    v_add_f32 v40, v40, v56
    v_add_f32 v41, v41, v57
    v_add_f32 v42, v42, v58
    v_add_f32 v43, v43, v59
cs_27:
    s_barrier
    s_cmp_ge_u32 s9, 2
    s_cbranch_scc1 cs_28
    v_add_f32 v44, v44, v60
    v_add_f32 v45, v45, v61
    v_add_f32 v46, v46, v62
    v_add_f32 v47, v47, v63
    v_add_f32 v32, v32, v40
    v_add_f32 v33, v33, v41
    v_add_f32 v34, v34, v42
    v_add_f32 v35, v35, v43
    v_add_f32 v36, v36, v44
    v_add_f32 v37, v37, v45
    v_add_f32 v38, v38, v46
    v_add_f32 v39, v39, v47
cs_28:
    s_barrier
    s_cmp_ge_u32 s9, 2
    s_cbranch_scc1 cs_29
    v_add_f32 v32, v32, v36
    v_add_f32 v33, v33, v37
    v_add_f32 v34, v34, v38
    v_add_f32 v35, v35, v39
    v_add_f32 v32, v32, v34
    v_add_f32 v33, v33, v35
    ds_write_b64 v12, v[32:33]
    s_waitcnt lgkmcnt(0)
cs_29:
    s_barrier
    s_barrier
    s_branch s_attn
.p2align 6
l_first_tail:
    s_mov_b32 s28, s40
    s_mov_b32 s29, s41
    s_mov_b32 s30, 6291456
    s_mov_b32 s31, 0x00020000
    v_lshlrev_b32 v14, 6, v20
    v_lshrrev_b32 v22, 5, v1
    v_bfe_u32 v23, v1, 1, 1
    v_xor_b32 v22, v22, v23
    v_lshl_add_u32 v14, v22, 5, v14
    v_and_b32 v22, 1, v1
    v_lshl_add_u32 v14, v22, 4, v14
    v_bfe_u32 v23, v1, 2, 1
    v_mul_u32_u24 v23, 196608, v23
    v_add_u32 v14, v14, v23
    v_lshlrev_b32 v22, 4, v22
    v_mov_b32 v23, 0x3f80
    v_lshlrev_b32 v23, v22, v23
    v_bfe_u32 v22, v1, 1, 3
    v_cmp_eq_u32 vcc, 0, v22
    s_nop 1
    v_cndmask_b32 v24, 0, v23, vcc
    v_cmp_eq_u32 vcc, 1, v22
    s_nop 1
    v_cndmask_b32 v25, 0, v23, vcc
    v_cmp_eq_u32 vcc, 2, v22
    s_nop 1
    v_cndmask_b32 v26, 0, v23, vcc
    v_cmp_eq_u32 vcc, 3, v22
    s_nop 1
    v_cndmask_b32 v27, 0, v23, vcc
    v_lshlrev_b32 v15, 5, v21
    v_and_b32 v22, 16, v1
    v_add_u32 v15, v15, v22
    v_lshlrev_b32 v16, 14, v1
    s_mov_b32 s9, 0
    s_lshr_b32 s55, s63, 4
    s_and_b32 s56, s63, 15
    s_lshl_b32 s57, s56, 4
    s_lshr_b32 s58, s62, 1
    s_add_u32 s57, s57, s58
    s_mul_i32 s57, s57, 3
    s_add_u32 s57, s57, s55
    s_lshl_b32 s57, s57, 13
    s_and_b32 s58, s62, 1
    s_lshl_b32 s58, s58, 12
    s_add_u32 s57, s57, s58
    s_add_u32 s57, s57, 50331648
    s_lshl_b32 s54, s61, 8
    s_add_u32 s54, s54, 63963136
    s_lshl_b32 s56, s56, 10
    s_lshl_b32 s55, s55, 7
    s_add_u32 s55, s55, s56
    s_lshl_b32 s56, s62, 2
    s_add_u32 s55, s55, s56
    s_add_u32 s55, s55, 64487424
    s_waitcnt vmcnt(3)
    s_add_u32 s53, s52, 196608
    buffer_load_dwordx4 v[176:179], v12, s[20:23], s53 offen nt
    s_add_u32 s53, s52, 245760
    buffer_load_dwordx4 v[180:183], v12, s[20:23], s53 offen nt
    s_add_u32 s53, s52, 294912
    buffer_load_dwordx4 v[184:187], v12, s[20:23], s53 offen nt
    buffer_store_dwordx4 v[160:163], v14, s[12:15], s57 offen offset:0 sc1
    v_mfma_f32_16x16x32_bf16 v[28:31], v[24:27], v[160:163], 0
    s_barrier
    s_waitcnt vmcnt(6)
    s_add_u32 s53, s52, 344064
    buffer_load_dwordx4 v[188:191], v12, s[20:23], s53 offen nt
    buffer_store_dwordx4 v[164:167], v14, s[12:15], s57 offen offset:512 sc1
    v_mfma_f32_16x16x32_bf16 v[28:31], v[24:27], v[164:167], v[28:31]
    s_waitcnt vmcnt(7)
    buffer_store_dwordx4 v[168:171], v14, s[12:15], s57 offen offset:1024 sc1
    v_mfma_f32_16x16x32_bf16 v[28:31], v[24:27], v[168:171], v[28:31]
    s_waitcnt vmcnt(7)
    buffer_store_dwordx4 v[172:175], v14, s[12:15], s57 offen offset:1536 sc1
    v_mfma_f32_16x16x32_bf16 v[28:31], v[24:27], v[172:175], v[28:31]
    s_waitcnt vmcnt(7)
    buffer_store_dwordx4 v[176:179], v14, s[12:15], s57 offen offset:2048 sc1
    v_mfma_f32_16x16x32_bf16 v[28:31], v[24:27], v[176:179], v[28:31]
    s_waitcnt vmcnt(7)
    buffer_store_dwordx4 v[180:183], v14, s[12:15], s57 offen offset:2560 sc1
    v_mfma_f32_16x16x32_bf16 v[28:31], v[24:27], v[180:183], v[28:31]
    s_waitcnt vmcnt(7)
    buffer_store_dwordx4 v[184:187], v14, s[12:15], s57 offen offset:3072 sc1
    v_mfma_f32_16x16x32_bf16 v[28:31], v[24:27], v[184:187], v[28:31]
    s_waitcnt vmcnt(6)
    buffer_store_dwordx4 v[188:191], v14, s[12:15], s57 offen offset:3584 sc1
    v_mfma_f32_16x16x32_bf16 v[28:31], v[24:27], v[188:191], v[28:31]
    s_nop 7
    v_add_f32_dpp v28, v28, v28 row_ror:8 row_mask:0xf bank_mask:0xf
    v_add_f32_dpp v29, v29, v29 row_ror:8 row_mask:0xf bank_mask:0xf
    v_add_f32_dpp v30, v30, v30 row_ror:8 row_mask:0xf bank_mask:0xf
    v_add_f32_dpp v31, v31, v31 row_ror:8 row_mask:0xf bank_mask:0xf
    s_mov_b64 exec, 0x00ff00ff
    buffer_store_dwordx4 v[28:31], v15, s[12:15], s54 offen sc1
    s_mov_b64 exec, -1
    s_add_u32 s57, s57, 6291456
    s_add_u32 s54, s54, 196608
    v_mov_b32 v8, 159492
non_32:
    ds_read_b32 v9, v8
    s_waitcnt lgkmcnt(0)
    v_readfirstlane_b32 s10, v9
    s_cmp_eq_u32 s10, 0
    s_cbranch_scc1 non_32
    s_mov_b64 exec, 0xffff
    s_waitcnt vmcnt(0)
    buffer_store_dword v9, v16, s[12:15], s55 offen offset:0 sc1
    s_mov_b64 exec, -1
    s_add_u32 s53, s52, 0
    buffer_load_dwordx4 v[192:195], v12, s[28:31], s53 offen nt
    s_add_u32 s53, s52, 49152
    buffer_load_dwordx4 v[196:199], v12, s[28:31], s53 offen nt
    s_add_u32 s53, s52, 98304
    buffer_load_dwordx4 v[200:203], v12, s[28:31], s53 offen nt
    s_add_u32 s53, s52, 147456
    buffer_load_dwordx4 v[204:207], v12, s[28:31], s53 offen nt
    s_add_u32 s53, s52, 196608
    buffer_load_dwordx4 v[208:211], v12, s[28:31], s53 offen nt
    s_add_u32 s53, s52, 245760
    buffer_load_dwordx4 v[212:215], v12, s[28:31], s53 offen nt
    s_add_u32 s53, s52, 294912
    buffer_load_dwordx4 v[216:219], v12, s[28:31], s53 offen nt
    s_add_u32 s53, s52, 344064
    buffer_load_dwordx4 v[220:223], v12, s[28:31], s53 offen nt
    s_mov_b32 s58, s52
    s_lshr_b32 s60, s2, 3
    s_mul_i32 s60, s60, 3
    s_lshr_b32 s60, s60, 5
    s_add_u32 s60, s60, 1
    s_branch l_qkv2
l_qkv:
    s_mov_b32 s60, 0
l_qkv2:
    v_and_b32 v1, 63, v0
    v_lshlrev_b32 v5, 4, v1
    s_sub_u32 s51, s8, 5
    s_lshl_b32 s48, s51, 13
    s_and_b32 s53, s9, 1
    s_lshl_b32 s52, s53, 4
    s_add_u32 s49, s7, s52
    s_lshl_b32 s49, s49, 1
    s_and_b32 s52, s6, 1
    s_add_u32 s49, s49, s52
    s_mul_i32 s49, s49, 196608
    s_add_u32 s49, s49, s48
    s_add_u32 s49, s49, 50331648
    v_mov_b32 v13, 159496
    s_mov_b32 s50, 0
    v_lshrrev_b32 v10, 2, v1
    v_and_b32 v11, 3, v1
    v_lshlrev_b32 v10, 8, v10
    v_lshl_add_u32 v10, v11, 4, v10
    v_lshlrev_b32 v7, 5, v11
    v_lshlrev_b32 v11, 2, v1
    v_add_u32 v11, 155648, v11
    s_lshr_b32 s59, s11, 2
    s_lshl_b32 s59, s59, 12
    s_and_b32 s3, s11, 3
    s_lshl_b32 s3, s3, 6
    s_add_u32 s59, s59, s3
    s_lshl_b32 s3, s9, 18
    s_add_u32 s59, s59, s3
    s_add_u32 s59, s59, 62914560
    s_lshl_b32 s56, s9, 15
    s_add_u32 s56, s56, 64749568
    v_mov_b32 v41, s10
    v_mov_b32 v43, s10
    v_mov_b32 v45, s10
    v_mov_b32 v47, s10
    v_and_b32 v6, 0xff, v5
    s_lshl_b32 s3, s7, 7
    v_lshrrev_b32 v20, 3, v1
    v_lshlrev_b32 v21, 11, v20
    v_lshrrev_b32 v22, 2, v1
    v_lshrrev_b32 v23, 4, v1
    v_xor_b32 v22, v22, v23
    v_and_b32 v22, 1, v22
    v_lshl_add_u32 v21, v22, 6, v21
    v_and_b32 v22, 3, v1
    v_lshl_add_u32 v21, v22, 4, v21
    v_add_u32 v17, s3, v21
    s_lshl_b32 s3, s51, 13
    s_add_u32 s3, s3, 73728
    v_add_u32 v3, s3, v5
    s_cmp_lg_u32 s9, 0
    s_cbranch_scc1 l_qkv_tiled
    s_lshl_b32 s53, s8, 7
    s_lshl_b32 s52, s11, 10
    s_add_u32 s53, s53, s52
    s_add_u32 s53, s53, 64486784
    s_add_u32 s96, s4, s53
    s_addc_u32 s97, s5, 0
    s_mov_b32 s98, s10
    s_mov_b32 s99, s10
    s_mov_b32 s3, 0x100000
poll_33:
    s_load_dwordx16 s[80:95], s[96:97], 0 glc
    s_sub_u32 s3, s3, 1
    s_cbranch_scc1 poll_33_ok
    s_waitcnt lgkmcnt(0)
    s_xor_b64 s[100:101], s[80:81], s[98:99]
    s_xor_b64 s[80:81], s[82:83], s[98:99]
    s_or_b64 s[100:101], s[100:101], s[80:81]
    s_xor_b64 s[80:81], s[84:85], s[98:99]
    s_or_b64 s[100:101], s[100:101], s[80:81]
    s_xor_b64 s[80:81], s[86:87], s[98:99]
    s_or_b64 s[100:101], s[100:101], s[80:81]
    s_xor_b64 s[80:81], s[88:89], s[98:99]
    s_or_b64 s[100:101], s[100:101], s[80:81]
    s_xor_b64 s[80:81], s[90:91], s[98:99]
    s_or_b64 s[100:101], s[100:101], s[80:81]
    s_xor_b64 s[80:81], s[92:93], s[98:99]
    s_or_b64 s[100:101], s[100:101], s[80:81]
    s_xor_b64 s[80:81], s[94:95], s[98:99]
    s_or_b64 s[100:101], s[100:101], s[80:81]
    s_cbranch_scc1 poll_33
poll_33_ok:
    s_waitcnt lgkmcnt(0)
    s_branch l_qkv_fill
l_qkv_tiled:
    s_barrier
    s_cmp_lt_u32 s9, 2
    s_cbranch_scc1 l_qkv_nocache
    s_bitcmp1_b32 s9, 0
    s_cbranch_scc1 l_qkv_c_b
    ds_write_b128 v3, v[64:67] offset:0
    ds_write_b128 v3, v[68:71] offset:1024
    ds_write_b128 v3, v[72:75] offset:2048
    ds_write_b128 v3, v[76:79] offset:3072
    ds_write_b128 v3, v[80:83] offset:4096
    ds_write_b128 v3, v[84:87] offset:5120
    ds_write_b128 v3, v[88:91] offset:6144
    ds_write_b128 v3, v[92:95] offset:7168
    ds_write_b128 v3, v[96:99] offset:24576
    ds_write_b128 v3, v[100:103] offset:25600
    ds_write_b128 v3, v[104:107] offset:26624
    ds_write_b128 v3, v[108:111] offset:27648
    ds_write_b128 v3, v[112:115] offset:28672
    ds_write_b128 v3, v[116:119] offset:29696
    ds_write_b128 v3, v[120:123] offset:30720
    ds_write_b128 v3, v[124:127] offset:31744
    ds_write_b128 v3, v[128:131] offset:49152
    ds_write_b128 v3, v[132:135] offset:50176
    ds_write_b128 v3, v[136:139] offset:51200
    ds_write_b128 v3, v[140:143] offset:52224
    ds_write_b128 v3, v[144:147] offset:53248
    ds_write_b128 v3, v[148:151] offset:54272
    ds_write_b128 v3, v[152:155] offset:55296
    ds_write_b128 v3, v[156:159] offset:56320
    s_branch l_qkv_c_w
l_qkv_c_b:
    ds_write_b128 v3, v[160:163] offset:0
    ds_write_b128 v3, v[164:167] offset:1024
    ds_write_b128 v3, v[168:171] offset:2048
    ds_write_b128 v3, v[172:175] offset:3072
    ds_write_b128 v3, v[176:179] offset:4096
    ds_write_b128 v3, v[180:183] offset:5120
    ds_write_b128 v3, v[184:187] offset:6144
    ds_write_b128 v3, v[188:191] offset:7168
    ds_write_b128 v3, v[192:195] offset:24576
    ds_write_b128 v3, v[196:199] offset:25600
    ds_write_b128 v3, v[200:203] offset:26624
    ds_write_b128 v3, v[204:207] offset:27648
    ds_write_b128 v3, v[208:211] offset:28672
    ds_write_b128 v3, v[212:215] offset:29696
    ds_write_b128 v3, v[216:219] offset:30720
    ds_write_b128 v3, v[220:223] offset:31744
    ds_write_b128 v3, a[0:3] offset:49152
    ds_write_b128 v3, a[4:7] offset:50176
    ds_write_b128 v3, a[8:11] offset:51200
    ds_write_b128 v3, a[12:15] offset:52224
    ds_write_b128 v3, a[16:19] offset:53248
    ds_write_b128 v3, a[20:23] offset:54272
    ds_write_b128 v3, a[24:27] offset:55296
    ds_write_b128 v3, a[28:31] offset:56320
l_qkv_c_w:
    s_waitcnt lgkmcnt(0)
    s_barrier
    s_mov_b32 m0, s48
    s_add_u32 s50, s50, 1
    buffer_load_dwordx4 v5, s[12:15], s49 offen offset:0 sc1 lds
    buffer_load_dwordx4 v5, s[12:15], s49 offen offset:1024 sc1 lds
    buffer_load_dwordx4 v5, s[12:15], s49 offen offset:2048 sc1 lds
    buffer_load_dwordx4 v5, s[12:15], s49 offen offset:3072 sc1 lds
    s_add_u32 s49, s49, 4096
    s_bitcmp1_b32 s50, 0
    s_cselect_b32 s3, 0, 16384
    s_add_u32 s48, s48, s3
    s_add_u32 s49, s49, s3
    s_cmp_eq_u32 s50, 12
    s_cselect_b32 s3, 4294819840, 0
    s_add_u32 s48, s48, 4096
    s_add_u32 s48, s48, s3
    s_mov_b32 m0, s48
    s_add_u32 s50, s50, 1
    buffer_load_dwordx4 v5, s[12:15], s49 offen offset:0 sc1 lds
    buffer_load_dwordx4 v5, s[12:15], s49 offen offset:1024 sc1 lds
    buffer_load_dwordx4 v5, s[12:15], s49 offen offset:2048 sc1 lds
    buffer_load_dwordx4 v5, s[12:15], s49 offen offset:3072 sc1 lds
    s_add_u32 s49, s49, 4096
    s_bitcmp1_b32 s50, 0
    s_cselect_b32 s3, 0, 16384
    s_add_u32 s48, s48, s3
    s_add_u32 s49, s49, s3
    s_cmp_eq_u32 s50, 12
    s_cselect_b32 s3, 4294819840, 0
    s_add_u32 s48, s48, 4096
    s_add_u32 s48, s48, s3
    s_mov_b32 m0, s48
    s_add_u32 s50, s50, 1
    buffer_load_dwordx4 v5, s[12:15], s49 offen offset:0 sc1 lds
    buffer_load_dwordx4 v5, s[12:15], s49 offen offset:1024 sc1 lds
    buffer_load_dwordx4 v5, s[12:15], s49 offen offset:2048 sc1 lds
    buffer_load_dwordx4 v5, s[12:15], s49 offen offset:3072 sc1 lds
    s_add_u32 s49, s49, 4096
    s_bitcmp1_b32 s50, 0
    s_cselect_b32 s3, 0, 16384
    s_add_u32 s48, s48, s3
    s_add_u32 s49, s49, s3
    s_cmp_eq_u32 s50, 12
    s_cselect_b32 s3, 4294819840, 0
    s_add_u32 s48, s48, 4096
    s_add_u32 s48, s48, s3
    s_mov_b32 m0, s48
    s_add_u32 s50, s50, 1
    buffer_load_dwordx4 v5, s[12:15], s49 offen offset:0 sc1 lds
    buffer_load_dwordx4 v5, s[12:15], s49 offen offset:1024 sc1 lds
    buffer_load_dwordx4 v5, s[12:15], s49 offen offset:2048 sc1 lds
    buffer_load_dwordx4 v5, s[12:15], s49 offen offset:3072 sc1 lds
    s_add_u32 s49, s49, 4096
    s_bitcmp1_b32 s50, 0
    s_cselect_b32 s3, 0, 16384
    s_add_u32 s48, s48, s3
    s_add_u32 s49, s49, s3
    s_cmp_eq_u32 s50, 12
    s_cselect_b32 s3, 4294819840, 0
    s_add_u32 s48, s48, 4096
    s_add_u32 s48, s48, s3
    s_mov_b32 s50, 12
    s_add_u32 s49, s49, 98304
    s_lshl_b32 s48, s51, 13
    s_waitcnt vmcnt(8)
    s_barrier
    s_waitcnt vmcnt(0)
    s_branch l_qkv_gone
l_qkv_nocache:
    s_barrier
l_qkv_fill:
    s_mov_b32 m0, s48
    s_add_u32 s50, s50, 1
    buffer_load_dwordx4 v5, s[12:15], s49 offen offset:0 sc1 lds
    buffer_load_dwordx4 v5, s[12:15], s49 offen offset:1024 sc1 lds
    buffer_load_dwordx4 v5, s[12:15], s49 offen offset:2048 sc1 lds
    buffer_load_dwordx4 v5, s[12:15], s49 offen offset:3072 sc1 lds
    s_add_u32 s49, s49, 4096
    s_bitcmp1_b32 s50, 0
    s_cselect_b32 s3, 0, 16384
    s_add_u32 s48, s48, s3
    s_add_u32 s49, s49, s3
    s_cmp_eq_u32 s50, 12
    s_cselect_b32 s3, 4294819840, 0
    s_add_u32 s48, s48, 4096
    s_add_u32 s48, s48, s3
l_qkv_fill1:
    s_mov_b32 m0, s48
    s_add_u32 s50, s50, 1
    buffer_load_dwordx4 v5, s[12:15], s49 offen offset:0 sc1 lds
    buffer_load_dwordx4 v5, s[12:15], s49 offen offset:1024 sc1 lds
    buffer_load_dwordx4 v5, s[12:15], s49 offen offset:2048 sc1 lds
    buffer_load_dwordx4 v5, s[12:15], s49 offen offset:3072 sc1 lds
    s_add_u32 s49, s49, 4096
    s_bitcmp1_b32 s50, 0
    s_cselect_b32 s3, 0, 16384
    s_add_u32 s48, s48, s3
    s_add_u32 s49, s49, s3
    s_cmp_eq_u32 s50, 12
    s_cselect_b32 s3, 4294819840, 0
    s_add_u32 s48, s48, 4096
    s_add_u32 s48, s48, s3
l_qkv_fill2:
    s_add_u32 s52, s9, 1
    s_mov_b32 m0, s48
    s_add_u32 s50, s50, 1
    buffer_load_dwordx4 v5, s[12:15], s49 offen offset:0 sc1 lds
    s_waitcnt vmcnt(10)
    buffer_load_dwordx4 v5, s[12:15], s49 offen offset:1024 sc1 lds
    s_waitcnt vmcnt(10)
    buffer_load_dwordx4 v5, s[12:15], s49 offen offset:2048 sc1 lds
    s_waitcnt vmcnt(10)
    buffer_load_dwordx4 v5, s[12:15], s49 offen offset:3072 sc1 lds
    s_waitcnt vmcnt(10)
    s_add_u32 s49, s49, 4096
    s_bitcmp1_b32 s50, 0
    s_cselect_b32 s3, 0, 16384
    s_add_u32 s48, s48, s3
    s_add_u32 s49, s49, s3
    s_cmp_eq_u32 s50, 12
    s_cselect_b32 s3, 4294819840, 0
    s_add_u32 s48, s48, 4096
    s_add_u32 s48, s48, s3
l_qkv_pre:
    s_mov_b32 m0, s48
    s_add_u32 s50, s50, 1
    buffer_load_dwordx4 v5, s[12:15], s49 offen offset:0 sc1 lds
    s_waitcnt vmcnt(10)
    buffer_load_dwordx4 v5, s[12:15], s49 offen offset:1024 sc1 lds
    s_waitcnt vmcnt(10)
    buffer_load_dwordx4 v5, s[12:15], s49 offen offset:2048 sc1 lds
    s_waitcnt vmcnt(10)
    buffer_load_dwordx4 v5, s[12:15], s49 offen offset:3072 sc1 lds
    s_waitcnt vmcnt(10)
    s_add_u32 s49, s49, 4096
    s_bitcmp1_b32 s50, 0
    s_cselect_b32 s3, 0, 16384
    s_add_u32 s48, s48, s3
    s_add_u32 s49, s49, s3
    s_cmp_eq_u32 s50, 12
    s_cselect_b32 s3, 4294819840, 0
    s_add_u32 s48, s48, 4096
    s_add_u32 s48, s48, s3
    ds_read_b32 v8, v13
    s_cmp_ge_u32 s50, 12
    s_cbranch_scc1 l_qkv_go
    s_waitcnt lgkmcnt(0)
    v_readfirstlane_b32 s3, v8
    s_cmp_lg_u32 s3, s52
    s_cbranch_scc1 l_qkv_pre
    s_cmp_ge_u32 s50, 5
    s_cbranch_scc1 l_qkv_go
    s_waitcnt vmcnt(8)
l_qkv_go:
    s_waitcnt lgkmcnt(0)
    s_barrier
l_qkv_gone:
    s_bitcmp0_b32 s50, 0
    s_cbranch_scc1 l_qkv_even
    s_mov_b32 m0, s48
    s_add_u32 s50, s50, 1
    buffer_load_dwordx4 v5, s[12:15], s49 offen offset:0 sc1 lds
    buffer_load_dwordx4 v5, s[12:15], s49 offen offset:1024 sc1 lds
    buffer_load_dwordx4 v5, s[12:15], s49 offen offset:2048 sc1 lds
    buffer_load_dwordx4 v5, s[12:15], s49 offen offset:3072 sc1 lds
    s_add_u32 s49, s49, 4096
    s_bitcmp1_b32 s50, 0
    s_cselect_b32 s3, 0, 16384
    s_add_u32 s48, s48, s3
    s_add_u32 s49, s49, s3
    s_cmp_eq_u32 s50, 12
    s_cselect_b32 s3, 4294819840, 0
    s_add_u32 s48, s48, 4096
    s_add_u32 s48, s48, s3
l_qkv_even:
    s_cmp_gt_u32 s50, 11
    s_cbranch_scc1 stg_34
    s_mov_b32 m0, s48
    s_add_u32 s50, s50, 1
    buffer_load_dwordx4 v5, s[12:15], s49 offen offset:0 sc1 lds
    buffer_load_dwordx4 v5, s[12:15], s49 offen offset:1024 sc1 lds
    buffer_load_dwordx4 v5, s[12:15], s49 offen offset:2048 sc1 lds
    buffer_load_dwordx4 v5, s[12:15], s49 offen offset:3072 sc1 lds
    s_add_u32 s49, s49, 4096
    s_bitcmp1_b32 s50, 0
    s_cselect_b32 s3, 0, 16384
    s_add_u32 s48, s48, s3
    s_add_u32 s49, s49, s3
    s_cmp_eq_u32 s50, 12
    s_cselect_b32 s3, 4294819840, 0
    s_add_u32 s48, s48, 4096
    s_add_u32 s48, s48, s3
    s_cmp_ge_u32 s9, 2
    s_cbranch_scc1 stg_34
stg_34:
    s_cmp_lg_u32 s51, 0
    s_cbranch_scc1 role_35
    buffer_load_dwordx4 v[32:35], v10, s[12:15], s59 offen sc1
role_35:
    s_lshr_b32 s3, s9, 1
    s_andn2_b32 s3, s50, s3
    s_bitcmp0_b32 s3, 0
    s_cbranch_scc1 str_36
    s_waitcnt vmcnt(1)
    s_mov_b32 m0, s48
    s_add_u32 s50, s50, 1
    buffer_load_dwordx4 v5, s[12:15], s49 offen offset:0 sc1 lds
    buffer_load_dwordx4 v5, s[12:15], s49 offen offset:1024 sc1 lds
    buffer_load_dwordx4 v5, s[12:15], s49 offen offset:2048 sc1 lds
    buffer_load_dwordx4 v5, s[12:15], s49 offen offset:3072 sc1 lds
    s_add_u32 s49, s49, 4096
    s_bitcmp1_b32 s50, 0
    s_cselect_b32 s3, 0, 16384
    s_add_u32 s48, s48, s3
    s_add_u32 s49, s49, s3
    s_cmp_eq_u32 s50, 12
    s_cselect_b32 s3, 4294819840, 0
    s_add_u32 s48, s48, 4096
    s_add_u32 s48, s48, s3
str_36:
    s_waitcnt vmcnt(8)
    s_barrier
    s_waitcnt vmcnt(0)
l_qkv_b0:
    s_cmp_gt_u32 s50, 13
    s_cbranch_scc1 stg_37
    s_mov_b32 m0, s48
    s_add_u32 s50, s50, 1
    buffer_load_dwordx4 v5, s[12:15], s49 offen offset:0 sc1 lds
    buffer_load_dwordx4 v5, s[12:15], s49 offen offset:1024 sc1 lds
    buffer_load_dwordx4 v5, s[12:15], s49 offen offset:2048 sc1 lds
    buffer_load_dwordx4 v5, s[12:15], s49 offen offset:3072 sc1 lds
    s_add_u32 s49, s49, 4096
    s_bitcmp1_b32 s50, 0
    s_cselect_b32 s3, 0, 16384
    s_add_u32 s48, s48, s3
    s_add_u32 s49, s49, s3
    s_cmp_eq_u32 s50, 12
    s_cselect_b32 s3, 4294819840, 0
    s_add_u32 s48, s48, 4096
    s_add_u32 s48, s48, s3
    s_cmp_ge_u32 s9, 2
    s_cbranch_scc1 stg_37
stg_37:
    s_cmp_eq_u32 s60, 0
    s_cbranch_scc1 ub_38
    buffer_store_dwordx4 v[192:195], v14, s[12:15], s57 offen offset:0 sc1
    v_mfma_f32_16x16x32_bf16 v[28:31], v[24:27], v[192:195], 0
    buffer_store_dwordx4 v[196:199], v14, s[12:15], s57 offen offset:512 sc1
    v_mfma_f32_16x16x32_bf16 v[28:31], v[24:27], v[196:199], v[28:31]
ub_38:
    s_cmp_lg_u32 s51, 0
    s_cbranch_scc1 role_39
    v_add_f32_dpp v32, v32, v32 row_ror:4 row_mask:0xf bank_mask:0xf
    v_add_f32_dpp v33, v33, v33 row_ror:4 row_mask:0xf bank_mask:0xf
    v_add_f32_dpp v34, v34, v34 row_ror:4 row_mask:0xf bank_mask:0xf
    v_add_f32_dpp v35, v35, v35 row_ror:4 row_mask:0xf bank_mask:0xf
    v_add_f32_dpp v32, v32, v32 row_ror:8 row_mask:0xf bank_mask:0xf
    v_add_f32_dpp v33, v33, v33 row_ror:8 row_mask:0xf bank_mask:0xf
    v_add_f32_dpp v34, v34, v34 row_ror:8 row_mask:0xf bank_mask:0xf
    v_add_f32_dpp v35, v35, v35 row_ror:8 row_mask:0xf bank_mask:0xf
    v_mov_b32 v36, v32
    v_mov_b32 v37, v33
    v_mov_b32 v38, v34
    v_mov_b32 v39, v35
    v_permlane16_swap_b32 v32, v36
    v_permlane16_swap_b32 v33, v37
    v_permlane16_swap_b32 v34, v38
    v_permlane16_swap_b32 v35, v39
    v_add_f32 v32, v32, v36
    v_add_f32 v33, v33, v37
    v_add_f32 v34, v34, v38
    v_add_f32 v35, v35, v39
    v_mov_b32 v36, v32
    v_mov_b32 v37, v33
    v_mov_b32 v38, v34
    v_mov_b32 v39, v35
    v_permlane32_swap_b32 v32, v36
    v_permlane32_swap_b32 v33, v37
    v_permlane32_swap_b32 v34, v38
    v_permlane32_swap_b32 v35, v39
    v_add_f32 v40, v32, v36
    v_add_f32 v42, v33, v37
    v_add_f32 v44, v34, v38
    v_add_f32 v46, v35, v39
role_39:
    s_lshr_b32 s3, s9, 1
    s_andn2_b32 s3, s50, s3
    s_bitcmp0_b32 s3, 0
    s_cbranch_scc1 str_40
    s_waitcnt vmcnt(1)
    s_mov_b32 m0, s48
    s_add_u32 s50, s50, 1
    buffer_load_dwordx4 v5, s[12:15], s49 offen offset:0 sc1 lds
    buffer_load_dwordx4 v5, s[12:15], s49 offen offset:1024 sc1 lds
    buffer_load_dwordx4 v5, s[12:15], s49 offen offset:2048 sc1 lds
    buffer_load_dwordx4 v5, s[12:15], s49 offen offset:3072 sc1 lds
    s_add_u32 s49, s49, 4096
    s_bitcmp1_b32 s50, 0
    s_cselect_b32 s3, 0, 16384
    s_add_u32 s48, s48, s3
    s_add_u32 s49, s49, s3
    s_cmp_eq_u32 s50, 12
    s_cselect_b32 s3, 4294819840, 0
    s_add_u32 s48, s48, 4096
    s_add_u32 s48, s48, s3
str_40:
    s_waitcnt vmcnt(8)
    s_barrier
    s_cmp_gt_u32 s50, 15
    s_cbranch_scc1 stg_41
    s_mov_b32 m0, s48
    s_add_u32 s50, s50, 1
    buffer_load_dwordx4 v5, s[12:15], s49 offen offset:0 sc1 lds
    buffer_load_dwordx4 v5, s[12:15], s49 offen offset:1024 sc1 lds
    buffer_load_dwordx4 v5, s[12:15], s49 offen offset:2048 sc1 lds
    buffer_load_dwordx4 v5, s[12:15], s49 offen offset:3072 sc1 lds
    s_add_u32 s49, s49, 4096
    s_bitcmp1_b32 s50, 0
    s_cselect_b32 s3, 0, 16384
    s_add_u32 s48, s48, s3
    s_add_u32 s49, s49, s3
    s_cmp_eq_u32 s50, 12
    s_cselect_b32 s3, 4294819840, 0
    s_add_u32 s48, s48, 4096
    s_add_u32 s48, s48, s3
    s_cmp_ge_u32 s9, 2
    s_cbranch_scc1 stg_41
stg_41:
    s_cmp_eq_u32 s60, 0
    s_cbranch_scc1 ub_42
    buffer_store_dwordx4 v[200:203], v14, s[12:15], s57 offen offset:1024 sc1
    v_mfma_f32_16x16x32_bf16 v[28:31], v[24:27], v[200:203], v[28:31]
    buffer_store_dwordx4 v[204:207], v14, s[12:15], s57 offen offset:1536 sc1
    v_mfma_f32_16x16x32_bf16 v[28:31], v[24:27], v[204:207], v[28:31]
ub_42:
    s_cmp_lg_u32 s51, 0
    s_cbranch_scc1 role_43
    v_mul_f32 v40, 0x3a800000, v40
    v_mul_f32 v44, 0x3a800000, v44
    v_mul_f32 v42, 0x3a800000, v42
    v_mul_f32 v46, 0x3a800000, v46
    v_fma_f32 v42, -v40, v40, v42
    v_fma_f32 v46, -v44, v44, v46
    v_max_f32 v42, 0, v42
    v_max_f32 v46, 0, v46
    v_add_f32 v42, 0x3727c5ac, v42
    v_add_f32 v46, 0x3727c5ac, v46
    v_rsq_f32 v42, v42
    v_rsq_f32 v46, v46
    s_lshl_b32 s3, s11, 7
    s_add_u32 s3, s3, s56
    s_mov_b64 exec, 0xf
    buffer_store_dwordx4 v[40:43], v7, s[12:15], s3 offen offset:0 sc1
    buffer_store_dwordx4 v[44:47], v7, s[12:15], s3 offen offset:16 sc1
    s_mov_b64 exec, -1
role_43:
    s_lshr_b32 s3, s9, 1
    s_andn2_b32 s3, s50, s3
    s_bitcmp0_b32 s3, 0
    s_cbranch_scc1 str_44
    s_waitcnt vmcnt(1)
    s_mov_b32 m0, s48
    s_add_u32 s50, s50, 1
    buffer_load_dwordx4 v5, s[12:15], s49 offen offset:0 sc1 lds
    buffer_load_dwordx4 v5, s[12:15], s49 offen offset:1024 sc1 lds
    buffer_load_dwordx4 v5, s[12:15], s49 offen offset:2048 sc1 lds
    buffer_load_dwordx4 v5, s[12:15], s49 offen offset:3072 sc1 lds
    s_add_u32 s49, s49, 4096
    s_bitcmp1_b32 s50, 0
    s_cselect_b32 s3, 0, 16384
    s_add_u32 s48, s48, s3
    s_add_u32 s49, s49, s3
    s_cmp_eq_u32 s50, 12
    s_cselect_b32 s3, 4294819840, 0
    s_add_u32 s48, s48, 4096
    s_add_u32 s48, s48, s3
str_44:
    s_waitcnt vmcnt(8)
    s_barrier
    s_cmp_gt_u32 s50, 15
    s_cbranch_scc1 stg_45
    s_mov_b32 m0, s48
    s_add_u32 s50, s50, 1
    buffer_load_dwordx4 v5, s[12:15], s49 offen offset:0 sc1 lds
    buffer_load_dwordx4 v5, s[12:15], s49 offen offset:1024 sc1 lds
    buffer_load_dwordx4 v5, s[12:15], s49 offen offset:2048 sc1 lds
    buffer_load_dwordx4 v5, s[12:15], s49 offen offset:3072 sc1 lds
    s_add_u32 s49, s49, 4096
    s_bitcmp1_b32 s50, 0
    s_cselect_b32 s3, 0, 16384
    s_add_u32 s48, s48, s3
    s_add_u32 s49, s49, s3
    s_cmp_eq_u32 s50, 12
    s_cselect_b32 s3, 4294819840, 0
    s_add_u32 s48, s48, 4096
    s_add_u32 s48, s48, s3
    s_cmp_ge_u32 s9, 2
    s_cbranch_scc1 stg_45
stg_45:
    s_cmp_eq_u32 s60, 0
    s_cbranch_scc1 ub_46
    buffer_store_dwordx4 v[208:211], v14, s[12:15], s57 offen offset:2048 sc1
    v_mfma_f32_16x16x32_bf16 v[28:31], v[24:27], v[208:211], v[28:31]
    buffer_store_dwordx4 v[212:215], v14, s[12:15], s57 offen offset:2560 sc1
    v_mfma_f32_16x16x32_bf16 v[28:31], v[24:27], v[212:215], v[28:31]
ub_46:
    s_lshr_b32 s3, s9, 1
    s_andn2_b32 s3, s50, s3
    s_bitcmp0_b32 s3, 0
    s_cbranch_scc1 str_47
    s_waitcnt vmcnt(1)
    s_mov_b32 m0, s48
    s_add_u32 s50, s50, 1
    buffer_load_dwordx4 v5, s[12:15], s49 offen offset:0 sc1 lds
    buffer_load_dwordx4 v5, s[12:15], s49 offen offset:1024 sc1 lds
    buffer_load_dwordx4 v5, s[12:15], s49 offen offset:2048 sc1 lds
    buffer_load_dwordx4 v5, s[12:15], s49 offen offset:3072 sc1 lds
    s_add_u32 s49, s49, 4096
    s_bitcmp1_b32 s50, 0
    s_cselect_b32 s3, 0, 16384
    s_add_u32 s48, s48, s3
    s_add_u32 s49, s49, s3
    s_cmp_eq_u32 s50, 12
    s_cselect_b32 s3, 4294819840, 0
    s_add_u32 s48, s48, 4096
    s_add_u32 s48, s48, s3
str_47:
    s_waitcnt vmcnt(8)
    s_barrier
    s_cmp_gt_u32 s50, 15
    s_cbranch_scc1 stg_48
    s_mov_b32 m0, s48
    s_add_u32 s50, s50, 1
    buffer_load_dwordx4 v5, s[12:15], s49 offen offset:0 sc1 lds
    buffer_load_dwordx4 v5, s[12:15], s49 offen offset:1024 sc1 lds
    buffer_load_dwordx4 v5, s[12:15], s49 offen offset:2048 sc1 lds
    buffer_load_dwordx4 v5, s[12:15], s49 offen offset:3072 sc1 lds
    s_add_u32 s49, s49, 4096
    s_bitcmp1_b32 s50, 0
    s_cselect_b32 s3, 0, 16384
    s_add_u32 s48, s48, s3
    s_add_u32 s49, s49, s3
    s_cmp_eq_u32 s50, 12
    s_cselect_b32 s3, 4294819840, 0
    s_add_u32 s48, s48, 4096
    s_add_u32 s48, s48, s3
    s_cmp_ge_u32 s9, 2
    s_cbranch_scc1 stg_48
stg_48:
    s_cmp_eq_u32 s60, 0
    s_cbranch_scc1 ub_49
    buffer_store_dwordx4 v[216:219], v14, s[12:15], s57 offen offset:3072 sc1
    v_mfma_f32_16x16x32_bf16 v[28:31], v[24:27], v[216:219], v[28:31]
    buffer_store_dwordx4 v[220:223], v14, s[12:15], s57 offen offset:3584 sc1
    v_mfma_f32_16x16x32_bf16 v[28:31], v[24:27], v[220:223], v[28:31]
ub_49:
    s_cmp_ge_u32 s9, 2
    s_cbranch_scc1 wc_50
    s_bitcmp1_b32 s9, 0
    s_cbranch_scc1 wc_50_b
    ds_read_b128 v[64:67], v3 offset:0
    ds_read_b128 v[68:71], v3 offset:1024
    ds_read_b128 v[72:75], v3 offset:2048
    ds_read_b128 v[76:79], v3 offset:3072
    ds_read_b128 v[80:83], v3 offset:4096
    ds_read_b128 v[84:87], v3 offset:5120
    ds_read_b128 v[88:91], v3 offset:6144
    ds_read_b128 v[92:95], v3 offset:7168
    s_branch wc_50_w
wc_50_b:
    ds_read_b128 v[160:163], v3 offset:0
    ds_read_b128 v[164:167], v3 offset:1024
    ds_read_b128 v[168:171], v3 offset:2048
    ds_read_b128 v[172:175], v3 offset:3072
    ds_read_b128 v[176:179], v3 offset:4096
    ds_read_b128 v[180:183], v3 offset:5120
    ds_read_b128 v[184:187], v3 offset:6144
    ds_read_b128 v[188:191], v3 offset:7168
wc_50_w:
    s_waitcnt lgkmcnt(0)
wc_50:
    s_cmp_lg_u32 s51, 1
    s_cbranch_scc1 role_51
    s_and_b32 s52, s11, 0xe0
    s_lshl_b32 s52, s52, 7
    s_add_u32 s52, s52, s56
    s_lshr_b32 s3, s6, 1
    s_min_u32 s3, s3, 1
    s_andn2_b32 s3, s3, s9
    s_lshl_b32 s3, s3, 8
    s_sub_u32 s53, s52, s3
    buffer_load_dwordx4 v[32:35], v5, s[12:15], s52 offen offset:0 sc1
    buffer_load_dwordx4 v[36:39], v5, s[12:15], s52 offen offset:1024 sc1
    buffer_load_dwordx4 v[40:43], v5, s[12:15], s52 offen offset:2048 sc1
    buffer_load_dwordx4 v[44:47], v5, s[12:15], s52 offen offset:3072 sc1
    buffer_load_dwordx4 v[48:51], v6, s[12:15], s53 offen sc1
role_51:
    s_lshr_b32 s3, s9, 1
    s_andn2_b32 s3, s50, s3
    s_bitcmp0_b32 s3, 0
    s_cbranch_scc1 str_52
    s_waitcnt vmcnt(1)
    s_mov_b32 m0, s48
    s_add_u32 s50, s50, 1
    buffer_load_dwordx4 v5, s[12:15], s49 offen offset:0 sc1 lds
    buffer_load_dwordx4 v5, s[12:15], s49 offen offset:1024 sc1 lds
    buffer_load_dwordx4 v5, s[12:15], s49 offen offset:2048 sc1 lds
    buffer_load_dwordx4 v5, s[12:15], s49 offen offset:3072 sc1 lds
    s_add_u32 s49, s49, 4096
    s_bitcmp1_b32 s50, 0
    s_cselect_b32 s3, 0, 16384
    s_add_u32 s48, s48, s3
    s_add_u32 s49, s49, s3
    s_cmp_eq_u32 s50, 12
    s_cselect_b32 s3, 4294819840, 0
    s_add_u32 s48, s48, 4096
    s_add_u32 s48, s48, s3
str_52:
    s_waitcnt vmcnt(8)
    s_barrier
    s_waitcnt vmcnt(0)
    s_cmp_gt_u32 s50, 15
    s_cbranch_scc1 stg_53
    s_mov_b32 m0, s48
    s_add_u32 s50, s50, 1
    buffer_load_dwordx4 v5, s[12:15], s49 offen offset:0 sc1 lds
    buffer_load_dwordx4 v5, s[12:15], s49 offen offset:1024 sc1 lds
    buffer_load_dwordx4 v5, s[12:15], s49 offen offset:2048 sc1 lds
    buffer_load_dwordx4 v5, s[12:15], s49 offen offset:3072 sc1 lds
    s_add_u32 s49, s49, 4096
    s_bitcmp1_b32 s50, 0
    s_cselect_b32 s3, 0, 16384
    s_add_u32 s48, s48, s3
    s_add_u32 s49, s49, s3
    s_cmp_eq_u32 s50, 12
    s_cselect_b32 s3, 4294819840, 0
    s_add_u32 s48, s48, 4096
    s_add_u32 s48, s48, s3
    s_cmp_ge_u32 s9, 2
    s_cbranch_scc1 stg_53
stg_53:
    s_cmp_eq_u32 s60, 0
    s_cbranch_scc1 ub_54
    v_add_f32_dpp v28, v28, v28 row_ror:8 row_mask:0xf bank_mask:0xf
    v_add_f32_dpp v29, v29, v29 row_ror:8 row_mask:0xf bank_mask:0xf
    v_add_f32_dpp v30, v30, v30 row_ror:8 row_mask:0xf bank_mask:0xf
    v_add_f32_dpp v31, v31, v31 row_ror:8 row_mask:0xf bank_mask:0xf
    s_mov_b64 exec, 0x00ff00ff
    buffer_store_dwordx4 v[28:31], v15, s[12:15], s54 offen sc1
    s_mov_b64 exec, -1
ub_54:
    s_cmp_ge_u32 s9, 2
    s_cbranch_scc1 wc_55
    s_bitcmp1_b32 s9, 0
    s_cbranch_scc1 wc_55_b
    ds_read_b128 v[96:99], v3 offset:24576
    ds_read_b128 v[100:103], v3 offset:25600
    ds_read_b128 v[104:107], v3 offset:26624
    ds_read_b128 v[108:111], v3 offset:27648
    ds_read_b128 v[112:115], v3 offset:28672
    ds_read_b128 v[116:119], v3 offset:29696
    ds_read_b128 v[120:123], v3 offset:30720
    ds_read_b128 v[124:127], v3 offset:31744
    s_branch wc_55_w
wc_55_b:
    ds_read_b128 v[192:195], v3 offset:24576
    ds_read_b128 v[196:199], v3 offset:25600
    ds_read_b128 v[200:203], v3 offset:26624
    ds_read_b128 v[204:207], v3 offset:27648
    ds_read_b128 v[208:211], v3 offset:28672
    ds_read_b128 v[212:215], v3 offset:29696
    ds_read_b128 v[216:219], v3 offset:30720
    ds_read_b128 v[220:223], v3 offset:31744
wc_55_w:
    s_waitcnt lgkmcnt(0)
wc_55:
    s_cmp_lg_u32 s51, 1
    s_cbranch_scc1 role_56
    s_mov_b32 s3, 0x100000
l_st_chk:
    v_cmp_ne_u32 s[64:65], s10, v33
    v_cmp_ne_u32 vcc, s10, v35
    s_or_b64 s[64:65], s[64:65], vcc
    v_cmp_ne_u32 vcc, s10, v37
    s_or_b64 s[64:65], s[64:65], vcc
    v_cmp_ne_u32 vcc, s10, v39
    s_or_b64 s[64:65], s[64:65], vcc
    v_cmp_ne_u32 vcc, s10, v41
    s_or_b64 s[64:65], s[64:65], vcc
    v_cmp_ne_u32 vcc, s10, v43
    s_or_b64 s[64:65], s[64:65], vcc
    v_cmp_ne_u32 vcc, s10, v45
    s_or_b64 s[64:65], s[64:65], vcc
    v_cmp_ne_u32 vcc, s10, v47
    s_or_b64 s[64:65], s[64:65], vcc
    v_cmp_ne_u32 vcc, s10, v49
    s_or_b64 s[64:65], s[64:65], vcc
    v_cmp_ne_u32 vcc, s10, v51
    s_or_b64 s[64:65], s[64:65], vcc
    s_cbranch_scc0 l_st_ok
    s_sub_u32 s3, s3, 1
    s_cbranch_scc0 l_st_again
l_st_ok:
    ds_write_b32 v11, v32 offset:1280
    ds_write_b32 v11, v34 offset:2816
    ds_write_b32 v11, v36 offset:1536
    ds_write_b32 v11, v38 offset:3072
    ds_write_b32 v11, v40 offset:1792
    ds_write_b32 v11, v42 offset:3328
    ds_write_b32 v11, v44 offset:2048
    ds_write_b32 v11, v46 offset:3584
    s_mov_b64 exec, 0xffff
    ds_write_b32 v11, v48 offset:1216
    ds_write_b32 v11, v50 offset:2752
    s_mov_b64 exec, -1
    s_waitcnt lgkmcnt(0)
role_56:
    s_lshr_b32 s3, s9, 1
    s_andn2_b32 s3, s50, s3
    s_bitcmp0_b32 s3, 0
    s_cbranch_scc1 str_57
    s_waitcnt vmcnt(1)
    s_mov_b32 m0, s48
    s_add_u32 s50, s50, 1
    buffer_load_dwordx4 v5, s[12:15], s49 offen offset:0 sc1 lds
    buffer_load_dwordx4 v5, s[12:15], s49 offen offset:1024 sc1 lds
    buffer_load_dwordx4 v5, s[12:15], s49 offen offset:2048 sc1 lds
    buffer_load_dwordx4 v5, s[12:15], s49 offen offset:3072 sc1 lds
    s_add_u32 s49, s49, 4096
    s_bitcmp1_b32 s50, 0
    s_cselect_b32 s3, 0, 16384
    s_add_u32 s48, s48, s3
    s_add_u32 s49, s49, s3
    s_cmp_eq_u32 s50, 12
    s_cselect_b32 s3, 4294819840, 0
    s_add_u32 s48, s48, 4096
    s_add_u32 s48, s48, s3
str_57:
    s_add_u32 s61, s51, 48
    s_bitcmp1_b32 s9, 0
    s_cbranch_scc1 wo_58
    s_mov_b32 s24, s36
    s_mov_b32 s25, s37
    s_mov_b32 s26, 2097152
    s_mov_b32 s27, 0x00020000
    s_and_b32 s3, s7, 7
    s_cmp_eq_u32 s3, 3
    s_cbranch_scc0 wo_58
    s_cmp_eq_u32 s9, 0
    s_cbranch_scc1 wo_58
wop_59:
    s_lshl_b32 m0, s61, 10
    s_lshr_b32 s3, s61, 1
    s_xor_b32 s3, s3, s61
    s_and_b32 s3, s3, 1
    s_mul_i32 s3, s3, 3
    s_xor_b32 s3, s3, s61
    s_lshl_b32 s3, s3, 14
    buffer_load_dwordx4 v17, s[24:27], s3 offen lds
    s_add_u32 s61, s61, 3
    s_waitcnt vmcnt(4)
    s_cmp_lt_u32 s61, 66
    s_cbranch_scc1 wop_59
wo_58:
    s_waitcnt vmcnt(8)
    s_barrier
    s_cmp_eq_u32 s60, 0
    s_cbranch_scc1 ub_60
    s_waitcnt vmcnt(0)
    s_mov_b64 exec, 0xffff
    buffer_store_dword v9, v16, s[12:15], s55 offen offset:384 sc1
    s_mov_b64 exec, -1
ub_60:
    s_cmp_ge_u32 s9, 2
    s_cbranch_scc1 wc_61
    s_bitcmp1_b32 s9, 0
    s_cbranch_scc1 wc_61_b
    ds_read_b128 v[128:131], v3 offset:49152
    ds_read_b128 v[132:135], v3 offset:50176
    ds_read_b128 v[136:139], v3 offset:51200
    ds_read_b128 v[140:143], v3 offset:52224
    ds_read_b128 v[144:147], v3 offset:53248
    ds_read_b128 v[148:151], v3 offset:54272
    ds_read_b128 v[152:155], v3 offset:55296
    ds_read_b128 v[156:159], v3 offset:56320
    s_branch wc_61_w
wc_61_b:
    ds_read_b128 a[0:3], v3 offset:49152
    ds_read_b128 a[4:7], v3 offset:50176
    ds_read_b128 a[8:11], v3 offset:51200
    ds_read_b128 a[12:15], v3 offset:52224
    ds_read_b128 a[16:19], v3 offset:53248
    ds_read_b128 a[20:23], v3 offset:54272
    ds_read_b128 a[24:27], v3 offset:55296
    ds_read_b128 a[28:31], v3 offset:56320
wc_61_w:
    s_waitcnt lgkmcnt(0)
wc_61:
    s_bitcmp1_b32 s9, 0
    s_cbranch_scc1 wo_62
    s_mov_b32 s24, s36
    s_mov_b32 s25, s37
    s_mov_b32 s26, 2097152
    s_mov_b32 s27, 0x00020000
    s_and_b32 s3, s7, 7
    s_cmp_eq_u32 s3, 3
    s_cbranch_scc0 wo_62
    s_cmp_eq_u32 s9, 0
    s_cbranch_scc1 wo_62
wop_63:
    s_lshl_b32 m0, s61, 10
    s_lshr_b32 s3, s61, 1
    s_xor_b32 s3, s3, s61
    s_and_b32 s3, s3, 1
    s_mul_i32 s3, s3, 3
    s_xor_b32 s3, s3, s61
    s_lshl_b32 s3, s3, 14
    buffer_load_dwordx4 v17, s[24:27], s3 offen lds
    s_add_u32 s61, s61, 3
    s_waitcnt vmcnt(4)
    s_cmp_lt_u32 s61, 84
    s_cbranch_scc1 wop_63
wo_62:
    s_waitcnt vmcnt(0)
    s_barrier
    s_bitcmp1_b32 s9, 0
    s_cbranch_scc1 wo_64
    s_mov_b32 s24, s36
    s_mov_b32 s25, s37
    s_mov_b32 s26, 2097152
    s_mov_b32 s27, 0x00020000
    s_and_b32 s3, s7, 7
    s_cmp_eq_u32 s3, 3
    s_cselect_b32 s62, 27, 48
    s_cselect_b32 s63, 12, 24
    s_add_u32 s62, s62, s61
    s_sub_u32 s62, s62, s51
    s_add_u32 s63, s63, s62
wop_65:
    s_lshl_b32 m0, s61, 10
    s_lshr_b32 s3, s61, 1
    s_xor_b32 s3, s3, s61
    s_and_b32 s3, s3, 1
    s_mul_i32 s3, s3, 3
    s_xor_b32 s3, s3, s61
    s_lshl_b32 s3, s3, 14
    buffer_load_dwordx4 v17, s[24:27], s3 offen lds
    s_add_u32 s61, s61, 3
    s_waitcnt vmcnt(7)
    s_cmp_lt_u32 s61, s62
    s_cbranch_scc1 wop_65
wo_64:
    s_barrier
    s_bitcmp1_b32 s9, 0
    s_cbranch_scc1 s_attn
    s_mov_b32 s24, s36
    s_mov_b32 s25, s37
    s_mov_b32 s26, 2097152
    s_mov_b32 s27, 0x00020000
wop_66:
    s_lshl_b32 m0, s61, 10
    s_lshr_b32 s3, s61, 1
    s_xor_b32 s3, s3, s61
    s_and_b32 s3, s3, 1
    s_mul_i32 s3, s3, 3
    s_xor_b32 s3, s3, s61
    s_lshl_b32 s3, s3, 14
    buffer_load_dwordx4 v17, s[24:27], s3 offen lds
    s_add_u32 s61, s61, 3
    s_waitcnt vmcnt(7)
    s_cmp_lt_u32 s61, s63
    s_cbranch_scc1 wop_66
    s_barrier
wop_67:
    s_lshl_b32 m0, s61, 10
    s_lshr_b32 s3, s61, 1
    s_xor_b32 s3, s3, s61
    s_and_b32 s3, s3, 1
    s_mul_i32 s3, s3, 3
    s_xor_b32 s3, s3, s61
    s_lshl_b32 s3, s3, 14
    buffer_load_dwordx4 v17, s[24:27], s3 offen lds
    s_add_u32 s61, s61, 3
    s_waitcnt vmcnt(7)
    s_cmp_lt_u32 s61, 128
    s_cbranch_scc1 wop_67
    s_mov_b32 s61, s51
wop_68:
    s_lshl_b32 m0, s61, 10
    s_lshr_b32 s3, s61, 1
    s_xor_b32 s3, s3, s61
    s_and_b32 s3, s3, 1
    s_mul_i32 s3, s3, 3
    s_xor_b32 s3, s3, s61
    s_lshl_b32 s3, s3, 14
    buffer_load_dwordx4 v17, s[24:27], s3 offen lds
    s_add_u32 s61, s61, 3
    s_waitcnt vmcnt(7)
    s_cmp_lt_u32 s61, 48
    s_cbranch_scc1 wop_68
    s_branch l_wo
l_st_again:
    buffer_load_dwordx4 v[32:35], v5, s[12:15], s52 offen offset:0 sc1
    buffer_load_dwordx4 v[36:39], v5, s[12:15], s52 offen offset:1024 sc1
    buffer_load_dwordx4 v[40:43], v5, s[12:15], s52 offen offset:2048 sc1
    buffer_load_dwordx4 v[44:47], v5, s[12:15], s52 offen offset:3072 sc1
    buffer_load_dwordx4 v[48:51], v6, s[12:15], s53 offen sc1
    s_waitcnt vmcnt(0)
    s_branch l_st_chk
.p2align 6
h_wo:
l_wo:
    s_mul_i32 s98, s9, 786432
    s_add_u32 s98, s98, 65798144
    s_lshl_b32 s99, s11, 10
    s_add_u32 s98, s98, s99
    s_add_u32 s96, s4, s98
    s_addc_u32 s97, s5, 0
    s_mov_b32 s98, s10
    s_mov_b32 s99, s10
    s_sub_u32 s59, s8, 4
    s_lshl_b32 s60, s59, 7
    s_add_u32 s96, s96, s60
    s_addc_u32 s97, s97, 0
    s_lshl_b32 s60, s9, 2
    s_add_u32 s60, s60, 159504
    v_mov_b32 v10, s60
    s_lshl_b32 s60, 1, s59
    v_mov_b32 v11, s60
    v_lshlrev_b32 v13, 4, v11
    s_mov_b64 exec, 1
    s_waitcnt vmcnt(0)
    ds_or_b32 v10, v13
    s_mov_b32 s3, 0x100000
poll_69:
    s_load_dwordx8 s[88:95], s[96:97], 0 glc
    s_sub_u32 s3, s3, 1
    s_cbranch_scc1 poll_69_ok
    s_waitcnt lgkmcnt(0)
    s_xor_b64 s[100:101], s[88:89], s[98:99]
    s_xor_b64 s[88:89], s[90:91], s[98:99]
    s_or_b64 s[100:101], s[100:101], s[88:89]
    s_xor_b64 s[88:89], s[92:93], s[98:99]
    s_or_b64 s[100:101], s[100:101], s[88:89]
    s_xor_b64 s[88:89], s[94:95], s[98:99]
    s_or_b64 s[100:101], s[100:101], s[88:89]
    s_cbranch_scc1 poll_69
poll_69_ok:
    s_waitcnt lgkmcnt(0)
    ds_or_b32 v10, v11
    s_mov_b64 exec, -1
    s_setprio 0
    s_waitcnt lgkmcnt(0)
    s_cmp_eq_u32 s8, 4
    s_cbranch_scc1 l_wo_end
    s_cmp_lg_u32 s9, 0
    s_cbranch_scc1 l_wo_end
    s_lshl_b32 s53, s8, 7
    s_lshl_b32 s52, s11, 10
    s_add_u32 s53, s53, s52
    s_add_u32 s53, s53, 64487168
    s_add_u32 s96, s4, s53
    s_addc_u32 s97, s5, 0
    s_mov_b32 s98, s10
    s_mov_b32 s99, s10
    s_mov_b32 s3, 0x100000
poll_70:
    s_load_dwordx16 s[80:95], s[96:97], 0 glc
    s_sub_u32 s3, s3, 1
    s_cbranch_scc1 poll_70_ok
    s_waitcnt lgkmcnt(0)
    s_xor_b64 s[100:101], s[80:81], s[98:99]
    s_xor_b64 s[80:81], s[82:83], s[98:99]
    s_or_b64 s[100:101], s[100:101], s[80:81]
    s_xor_b64 s[80:81], s[84:85], s[98:99]
    s_or_b64 s[100:101], s[100:101], s[80:81]
    s_xor_b64 s[80:81], s[86:87], s[98:99]
    s_or_b64 s[100:101], s[100:101], s[80:81]
    s_xor_b64 s[80:81], s[88:89], s[98:99]
    s_or_b64 s[100:101], s[100:101], s[80:81]
    s_xor_b64 s[80:81], s[90:91], s[98:99]
    s_or_b64 s[100:101], s[100:101], s[80:81]
    s_xor_b64 s[80:81], s[92:93], s[98:99]
    s_or_b64 s[100:101], s[100:101], s[80:81]
    s_xor_b64 s[80:81], s[94:95], s[98:99]
    s_or_b64 s[100:101], s[100:101], s[80:81]
    s_cbranch_scc1 poll_70
poll_70_ok:
    s_waitcnt lgkmcnt(0)
l_wo_end:
    s_add_u32 s9, s9, 1
    s_cmp_lg_u32 s9, 4
    s_cbranch_scc1 l_wo_next
    s_barrier
    s_branch k_exit
l_wo_next:
    s_cmp_lg_u32 s8, 4
    s_cbranch_scc1 l_qkv
    s_cmp_eq_u32 s9, 2
    s_cbranch_scc1 h_qkvA
    s_branch h_qkvB
.p2align 6
s_attn:
    s_sub_u32 s48, s8, 4
    s_lshl_b32 s3, s7, 7
    v_lshrrev_b32 v20, 3, v1
    v_lshlrev_b32 v21, 11, v20
    v_lshrrev_b32 v22, 2, v1
    v_lshrrev_b32 v23, 4, v1
    v_xor_b32 v22, v22, v23
    v_and_b32 v22, 1, v22
    v_lshl_add_u32 v21, v22, 6, v21
    v_and_b32 v22, 3, v1
    v_lshl_add_u32 v21, v22, 4, v21
    v_add_u32 v7, s3, v21
    s_mov_b32 s24, s42
    s_mov_b32 s25, s43
    s_mov_b32 s26, 2097152
    s_mov_b32 s27, 0x00020000
    s_lshr_b32 s49, s9, 1
    s_lshl_b32 s49, s49, 23
    s_lshl_b32 s52, s7, 19
    s_add_u32 s49, s49, s52
    s_and_b32 s52, s6, 1
    s_lshl_b32 s52, s52, 18
    s_add_u32 s49, s49, s52
    s_add_u32 s49, s49, 33554432
    s_lshr_b32 s61, s6, 1
    s_mul_i32 s54, s9, 786432
    s_add_u32 s54, s54, 66322432
    s_lshl_b32 s55, s11, 10
    s_add_u32 s54, s54, s55
    s_add_u32 s52, s4, s54
    s_addc_u32 s53, s5, 0
    s_mov_b32 s54, s10
    s_mov_b32 s55, s10
    s_lshl_b32 s51, s48, 11
    s_add_u32 s49, s49, s51
    s_add_u32 s51, s51, 81920
    s_mov_b32 s60, s48
    s_setprio 3
    s_barrier
    s_lshl_b32 s58, 1, s61
    s_mov_b32 s57, 0
    s_add_u32 s62, s61, 1
    s_and_b32 s62, s62, 7
    s_lshl_b32 s50, s62, 15
    s_add_u32 s50, s50, s49
    s_lshr_b32 s63, s62, 1
    s_lshl_b32 s63, s63, 7
    s_and_b32 s62, s62, 1
    s_lshl_b32 s62, s62, 4
    s_add_u32 s62, s62, s63
    s_mov_b32 s58, 0x100000
need_71:
    s_load_dwordx4 s[64:67], s[52:53], s62 glc
    s_sub_u32 s58, s58, 1
    s_cbranch_scc1 need_71_ok
    s_waitcnt lgkmcnt(0)
need_71_t:
    s_cmp_ge_u32 s48, 2
    s_cselect_b32 s63, s65, s64
    s_cmp_lg_u32 s63, s10
    s_cbranch_scc1 need_71
need_71_ok:
    s_waitcnt lgkmcnt(0)
    s_add_u32 m0, s51, 32768
    s_nop 0
    buffer_load_dwordx4 v5, s[12:15], s50 offen offset:0 sc1 lds
    buffer_load_dwordx4 v5, s[12:15], s50 offen offset:1024 sc1 lds
    s_add_u32 s50, s50, 8192
    s_add_u32 m0, s51, 40960
    s_nop 0
    buffer_load_dwordx4 v5, s[12:15], s50 offen offset:0 sc1 lds
    buffer_load_dwordx4 v5, s[12:15], s50 offen offset:1024 sc1 lds
    s_add_u32 s50, s50, 8192
    s_branch need_72_t
need_72:
    s_load_dwordx4 s[64:67], s[52:53], s62 glc
    s_sub_u32 s58, s58, 1
    s_cbranch_scc1 need_72_ok
    s_waitcnt lgkmcnt(0)
need_72_t:
    s_cmp_ge_u32 s48, 2
    s_cselect_b32 s63, s67, s66
    s_cmp_lg_u32 s63, s10
    s_cbranch_scc1 need_72
need_72_ok:
    s_waitcnt lgkmcnt(0)
    s_add_u32 m0, s51, 49152
    s_nop 0
    buffer_load_dwordx4 v5, s[12:15], s50 offen offset:0 sc1 lds
    buffer_load_dwordx4 v5, s[12:15], s50 offen offset:1024 sc1 lds
    s_add_u32 s50, s50, 8192
    s_add_u32 m0, s51, 57344
    s_nop 0
    buffer_load_dwordx4 v5, s[12:15], s50 offen offset:0 sc1 lds
    buffer_load_dwordx4 v5, s[12:15], s50 offen offset:1024 sc1 lds
    s_add_u32 s50, s50, 8192
    s_waitcnt vmcnt(4)
    s_barrier
    s_add_u32 s62, s61, 2
    s_and_b32 s62, s62, 7
    s_lshl_b32 s50, s62, 15
    s_add_u32 s50, s50, s49
    s_lshr_b32 s63, s62, 1
    s_lshl_b32 s63, s63, 7
    s_and_b32 s62, s62, 1
    s_lshl_b32 s62, s62, 4
    s_add_u32 s62, s62, s63
    s_mov_b32 s58, 0x100000
need_73:
    s_load_dwordx4 s[64:67], s[52:53], s62 glc
    s_sub_u32 s58, s58, 1
    s_cbranch_scc1 need_73_ok
    s_waitcnt lgkmcnt(0)
need_73_t:
    s_cmp_ge_u32 s48, 2
    s_cselect_b32 s63, s65, s64
    s_cmp_lg_u32 s63, s10
    s_cbranch_scc1 need_73
need_73_ok:
    s_waitcnt lgkmcnt(0)
    s_add_u32 m0, s51, 0
    s_nop 0
    buffer_load_dwordx4 v5, s[12:15], s50 offen offset:0 sc1 lds
    buffer_load_dwordx4 v5, s[12:15], s50 offen offset:1024 sc1 lds
    s_add_u32 s50, s50, 8192
    s_add_u32 m0, s51, 8192
    s_nop 0
    buffer_load_dwordx4 v5, s[12:15], s50 offen offset:0 sc1 lds
    buffer_load_dwordx4 v5, s[12:15], s50 offen offset:1024 sc1 lds
    s_add_u32 s50, s50, 8192
    s_waitcnt vmcnt(4)
    s_barrier
    s_branch need_74_t
need_74:
    s_load_dwordx4 s[64:67], s[52:53], s62 glc
    s_sub_u32 s58, s58, 1
    s_cbranch_scc1 need_74_ok
    s_waitcnt lgkmcnt(0)
need_74_t:
    s_cmp_ge_u32 s48, 2
    s_cselect_b32 s63, s67, s66
    s_cmp_lg_u32 s63, s10
    s_cbranch_scc1 need_74
need_74_ok:
    s_waitcnt lgkmcnt(0)
    s_add_u32 m0, s51, 16384
    s_nop 0
    buffer_load_dwordx4 v5, s[12:15], s50 offen offset:0 sc1 lds
    buffer_load_dwordx4 v5, s[12:15], s50 offen offset:1024 sc1 lds
    s_add_u32 s50, s50, 8192
    s_add_u32 m0, s51, 24576
    s_nop 0
    buffer_load_dwordx4 v5, s[12:15], s50 offen offset:0 sc1 lds
    buffer_load_dwordx4 v5, s[12:15], s50 offen offset:1024 sc1 lds
    s_add_u32 s50, s50, 8192
    s_waitcnt vmcnt(4)
    s_barrier
    s_add_u32 s62, s61, 3
    s_and_b32 s62, s62, 7
    s_lshl_b32 s50, s62, 15
    s_add_u32 s50, s50, s49
    s_lshr_b32 s63, s62, 1
    s_lshl_b32 s63, s63, 7
    s_and_b32 s62, s62, 1
    s_lshl_b32 s62, s62, 4
    s_add_u32 s62, s62, s63
    s_mov_b32 s58, 0x100000
need_75:
    s_load_dwordx4 s[64:67], s[52:53], s62 glc
    s_sub_u32 s58, s58, 1
    s_cbranch_scc1 need_75_ok
    s_waitcnt lgkmcnt(0)
need_75_t:
    s_cmp_ge_u32 s48, 2
    s_cselect_b32 s63, s65, s64
    s_cmp_lg_u32 s63, s10
    s_cbranch_scc1 need_75
need_75_ok:
    s_waitcnt lgkmcnt(0)
    s_add_u32 m0, s51, 32768
    s_nop 0
    buffer_load_dwordx4 v5, s[12:15], s50 offen offset:0 sc1 lds
    buffer_load_dwordx4 v5, s[12:15], s50 offen offset:1024 sc1 lds
    s_add_u32 s50, s50, 8192
    s_add_u32 m0, s51, 40960
    s_nop 0
    buffer_load_dwordx4 v5, s[12:15], s50 offen offset:0 sc1 lds
    buffer_load_dwordx4 v5, s[12:15], s50 offen offset:1024 sc1 lds
    s_add_u32 s50, s50, 8192
    s_lshl_b32 m0, s60, 10
    s_lshl_b32 s3, s60, 14
    buffer_load_dwordx4 v7, s[24:27], s3 offen lds
    s_add_u32 s60, s60, 4
    s_lshl_b32 m0, s60, 10
    s_lshl_b32 s3, s60, 14
    buffer_load_dwordx4 v7, s[24:27], s3 offen lds
    s_add_u32 s60, s60, 4
    s_waitcnt vmcnt(6)
    s_barrier
    s_branch need_76_t
need_76:
    s_load_dwordx4 s[64:67], s[52:53], s62 glc
    s_sub_u32 s58, s58, 1
    s_cbranch_scc1 need_76_ok
    s_waitcnt lgkmcnt(0)
need_76_t:
    s_cmp_ge_u32 s48, 2
    s_cselect_b32 s63, s67, s66
    s_cmp_lg_u32 s63, s10
    s_cbranch_scc1 need_76
need_76_ok:
    s_waitcnt lgkmcnt(0)
    s_add_u32 m0, s51, 49152
    s_nop 0
    buffer_load_dwordx4 v5, s[12:15], s50 offen offset:0 sc1 lds
    buffer_load_dwordx4 v5, s[12:15], s50 offen offset:1024 sc1 lds
    s_add_u32 s50, s50, 8192
    s_add_u32 m0, s51, 57344
    s_nop 0
    buffer_load_dwordx4 v5, s[12:15], s50 offen offset:0 sc1 lds
    buffer_load_dwordx4 v5, s[12:15], s50 offen offset:1024 sc1 lds
    s_add_u32 s50, s50, 8192
    s_lshl_b32 m0, s60, 10
    s_lshl_b32 s3, s60, 14
    buffer_load_dwordx4 v7, s[24:27], s3 offen lds
    s_add_u32 s60, s60, 4
    s_lshl_b32 m0, s60, 10
    s_lshl_b32 s3, s60, 14
    buffer_load_dwordx4 v7, s[24:27], s3 offen lds
    s_add_u32 s60, s60, 4
    s_waitcnt vmcnt(8)
    s_barrier
    s_add_u32 s62, s61, 4
    s_and_b32 s62, s62, 7
    s_lshl_b32 s50, s62, 15
    s_add_u32 s50, s50, s49
    s_lshr_b32 s63, s62, 1
    s_lshl_b32 s63, s63, 7
    s_and_b32 s62, s62, 1
    s_lshl_b32 s62, s62, 4
    s_add_u32 s62, s62, s63
    s_mov_b32 s58, 0x100000
need_77:
    s_load_dwordx4 s[64:67], s[52:53], s62 glc
    s_sub_u32 s58, s58, 1
    s_cbranch_scc1 need_77_ok
    s_waitcnt lgkmcnt(0)
need_77_t:
    s_cmp_ge_u32 s48, 2
    s_cselect_b32 s63, s65, s64
    s_cmp_lg_u32 s63, s10
    s_cbranch_scc1 need_77
need_77_ok:
    s_waitcnt lgkmcnt(0)
    s_add_u32 m0, s51, 0
    s_nop 0
    buffer_load_dwordx4 v5, s[12:15], s50 offen offset:0 sc1 lds
    buffer_load_dwordx4 v5, s[12:15], s50 offen offset:1024 sc1 lds
    s_add_u32 s50, s50, 8192
    s_add_u32 m0, s51, 8192
    s_nop 0
    buffer_load_dwordx4 v5, s[12:15], s50 offen offset:0 sc1 lds
    buffer_load_dwordx4 v5, s[12:15], s50 offen offset:1024 sc1 lds
    s_add_u32 s50, s50, 8192
    s_lshl_b32 m0, s60, 10
    s_lshl_b32 s3, s60, 14
    buffer_load_dwordx4 v7, s[24:27], s3 offen lds
    s_add_u32 s60, s60, 4
    s_lshl_b32 m0, s60, 10
    s_lshl_b32 s3, s60, 14
    buffer_load_dwordx4 v7, s[24:27], s3 offen lds
    s_add_u32 s60, s60, 4
    s_waitcnt vmcnt(8)
    s_barrier
    s_branch need_78_t
need_78:
    s_load_dwordx4 s[64:67], s[52:53], s62 glc
    s_sub_u32 s58, s58, 1
    s_cbranch_scc1 need_78_ok
    s_waitcnt lgkmcnt(0)
need_78_t:
    s_cmp_ge_u32 s48, 2
    s_cselect_b32 s63, s67, s66
    s_cmp_lg_u32 s63, s10
    s_cbranch_scc1 need_78
need_78_ok:
    s_waitcnt lgkmcnt(0)
    s_add_u32 m0, s51, 16384
    s_nop 0
    buffer_load_dwordx4 v5, s[12:15], s50 offen offset:0 sc1 lds
    buffer_load_dwordx4 v5, s[12:15], s50 offen offset:1024 sc1 lds
    s_add_u32 s50, s50, 8192
    s_add_u32 m0, s51, 24576
    s_nop 0
    buffer_load_dwordx4 v5, s[12:15], s50 offen offset:0 sc1 lds
    buffer_load_dwordx4 v5, s[12:15], s50 offen offset:1024 sc1 lds
    s_add_u32 s50, s50, 8192
    s_lshl_b32 m0, s60, 10
    s_lshl_b32 s3, s60, 14
    buffer_load_dwordx4 v7, s[24:27], s3 offen lds
    s_add_u32 s60, s60, 4
    s_lshl_b32 m0, s60, 10
    s_lshl_b32 s3, s60, 14
    buffer_load_dwordx4 v7, s[24:27], s3 offen lds
    s_add_u32 s60, s60, 4
    s_waitcnt vmcnt(8)
    s_barrier
    s_add_u32 s62, s61, 5
    s_and_b32 s62, s62, 7
    s_lshl_b32 s50, s62, 15
    s_add_u32 s50, s50, s49
    s_lshr_b32 s63, s62, 1
    s_lshl_b32 s63, s63, 7
    s_and_b32 s62, s62, 1
    s_lshl_b32 s62, s62, 4
    s_add_u32 s62, s62, s63
    s_mov_b32 s58, 0x100000
need_79:
    s_load_dwordx4 s[64:67], s[52:53], s62 glc
    s_sub_u32 s58, s58, 1
    s_cbranch_scc1 need_79_ok
    s_waitcnt lgkmcnt(0)
need_79_t:
    s_cmp_ge_u32 s48, 2
    s_cselect_b32 s63, s65, s64
    s_cmp_lg_u32 s63, s10
    s_cbranch_scc1 need_79
need_79_ok:
    s_waitcnt lgkmcnt(0)
    s_add_u32 m0, s51, 32768
    s_nop 0
    buffer_load_dwordx4 v5, s[12:15], s50 offen offset:0 sc1 lds
    buffer_load_dwordx4 v5, s[12:15], s50 offen offset:1024 sc1 lds
    s_add_u32 s50, s50, 8192
    s_add_u32 m0, s51, 40960
    s_nop 0
    buffer_load_dwordx4 v5, s[12:15], s50 offen offset:0 sc1 lds
    buffer_load_dwordx4 v5, s[12:15], s50 offen offset:1024 sc1 lds
    s_add_u32 s50, s50, 8192
    s_lshl_b32 m0, s60, 10
    s_lshl_b32 s3, s60, 14
    buffer_load_dwordx4 v7, s[24:27], s3 offen lds
    s_add_u32 s60, s60, 4
    s_lshl_b32 m0, s60, 10
    s_lshl_b32 s3, s60, 14
    buffer_load_dwordx4 v7, s[24:27], s3 offen lds
    s_add_u32 s60, s60, 4
    s_waitcnt vmcnt(8)
    s_barrier
    s_branch need_80_t
need_80:
    s_load_dwordx4 s[64:67], s[52:53], s62 glc
    s_sub_u32 s58, s58, 1
    s_cbranch_scc1 need_80_ok
    s_waitcnt lgkmcnt(0)
need_80_t:
    s_cmp_ge_u32 s48, 2
    s_cselect_b32 s63, s67, s66
    s_cmp_lg_u32 s63, s10
    s_cbranch_scc1 need_80
need_80_ok:
    s_waitcnt lgkmcnt(0)
    s_add_u32 m0, s51, 49152
    s_nop 0
    buffer_load_dwordx4 v5, s[12:15], s50 offen offset:0 sc1 lds
    buffer_load_dwordx4 v5, s[12:15], s50 offen offset:1024 sc1 lds
    s_add_u32 s50, s50, 8192
    s_add_u32 m0, s51, 57344
    s_nop 0
    buffer_load_dwordx4 v5, s[12:15], s50 offen offset:0 sc1 lds
    buffer_load_dwordx4 v5, s[12:15], s50 offen offset:1024 sc1 lds
    s_add_u32 s50, s50, 8192
    s_lshl_b32 m0, s60, 10
    s_lshl_b32 s3, s60, 14
    buffer_load_dwordx4 v7, s[24:27], s3 offen lds
    s_add_u32 s60, s60, 4
    s_lshl_b32 m0, s60, 10
    s_lshl_b32 s3, s60, 14
    buffer_load_dwordx4 v7, s[24:27], s3 offen lds
    s_add_u32 s60, s60, 4
    s_waitcnt vmcnt(8)
    s_barrier
    s_add_u32 s62, s61, 6
    s_and_b32 s62, s62, 7
    s_lshl_b32 s50, s62, 15
    s_add_u32 s50, s50, s49
    s_lshr_b32 s63, s62, 1
    s_lshl_b32 s63, s63, 7
    s_and_b32 s62, s62, 1
    s_lshl_b32 s62, s62, 4
    s_add_u32 s62, s62, s63
    s_mov_b32 s58, 0x100000
need_81:
    s_load_dwordx4 s[64:67], s[52:53], s62 glc
    s_sub_u32 s58, s58, 1
    s_cbranch_scc1 need_81_ok
    s_waitcnt lgkmcnt(0)
need_81_t:
    s_cmp_ge_u32 s48, 2
    s_cselect_b32 s63, s65, s64
    s_cmp_lg_u32 s63, s10
    s_cbranch_scc1 need_81
need_81_ok:
    s_waitcnt lgkmcnt(0)
    s_add_u32 m0, s51, 0
    s_nop 0
    buffer_load_dwordx4 v5, s[12:15], s50 offen offset:0 sc1 lds
    buffer_load_dwordx4 v5, s[12:15], s50 offen offset:1024 sc1 lds
    s_add_u32 s50, s50, 8192
    s_add_u32 m0, s51, 8192
    s_nop 0
    buffer_load_dwordx4 v5, s[12:15], s50 offen offset:0 sc1 lds
    buffer_load_dwordx4 v5, s[12:15], s50 offen offset:1024 sc1 lds
    s_add_u32 s50, s50, 8192
    s_lshl_b32 m0, s60, 10
    s_lshl_b32 s3, s60, 14
    buffer_load_dwordx4 v7, s[24:27], s3 offen lds
    s_add_u32 s60, s60, 4
    s_lshl_b32 m0, s60, 10
    s_lshl_b32 s3, s60, 14
    buffer_load_dwordx4 v7, s[24:27], s3 offen lds
    s_add_u32 s60, s60, 4
    s_waitcnt vmcnt(8)
    s_barrier
    s_branch need_82_t
need_82:
    s_load_dwordx4 s[64:67], s[52:53], s62 glc
    s_sub_u32 s58, s58, 1
    s_cbranch_scc1 need_82_ok
    s_waitcnt lgkmcnt(0)
need_82_t:
    s_cmp_ge_u32 s48, 2
    s_cselect_b32 s63, s67, s66
    s_cmp_lg_u32 s63, s10
    s_cbranch_scc1 need_82
need_82_ok:
    s_waitcnt lgkmcnt(0)
    s_add_u32 m0, s51, 16384
    s_nop 0
    buffer_load_dwordx4 v5, s[12:15], s50 offen offset:0 sc1 lds
    buffer_load_dwordx4 v5, s[12:15], s50 offen offset:1024 sc1 lds
    s_add_u32 s50, s50, 8192
    s_add_u32 m0, s51, 24576
    s_nop 0
    buffer_load_dwordx4 v5, s[12:15], s50 offen offset:0 sc1 lds
    buffer_load_dwordx4 v5, s[12:15], s50 offen offset:1024 sc1 lds
    s_add_u32 s50, s50, 8192
    s_lshl_b32 m0, s60, 10
    s_lshl_b32 s3, s60, 14
    buffer_load_dwordx4 v7, s[24:27], s3 offen lds
    s_add_u32 s60, s60, 4
    s_lshl_b32 m0, s60, 10
    s_lshl_b32 s3, s60, 14
    buffer_load_dwordx4 v7, s[24:27], s3 offen lds
    s_add_u32 s60, s60, 4
    s_waitcnt vmcnt(8)
    s_barrier
    s_add_u32 s62, s61, 7
    s_and_b32 s62, s62, 7
    s_lshl_b32 s50, s62, 15
    s_add_u32 s50, s50, s49
    s_lshr_b32 s63, s62, 1
    s_lshl_b32 s63, s63, 7
    s_and_b32 s62, s62, 1
    s_lshl_b32 s62, s62, 4
    s_add_u32 s62, s62, s63
    s_mov_b32 s58, 0x100000
need_83:
    s_load_dwordx4 s[64:67], s[52:53], s62 glc
    s_sub_u32 s58, s58, 1
    s_cbranch_scc1 need_83_ok
    s_waitcnt lgkmcnt(0)
need_83_t:
    s_cmp_ge_u32 s48, 2
    s_cselect_b32 s63, s65, s64
    s_cmp_lg_u32 s63, s10
    s_cbranch_scc1 need_83
need_83_ok:
    s_waitcnt lgkmcnt(0)
    s_add_u32 m0, s51, 32768
    s_nop 0
    buffer_load_dwordx4 v5, s[12:15], s50 offen offset:0 sc1 lds
    buffer_load_dwordx4 v5, s[12:15], s50 offen offset:1024 sc1 lds
    s_add_u32 s50, s50, 8192
    s_add_u32 m0, s51, 40960
    s_nop 0
    buffer_load_dwordx4 v5, s[12:15], s50 offen offset:0 sc1 lds
    buffer_load_dwordx4 v5, s[12:15], s50 offen offset:1024 sc1 lds
    s_add_u32 s50, s50, 8192
    s_lshl_b32 m0, s60, 10
    s_lshl_b32 s3, s60, 14
    buffer_load_dwordx4 v7, s[24:27], s3 offen lds
    s_add_u32 s60, s60, 4
    s_lshl_b32 m0, s60, 10
    s_lshl_b32 s3, s60, 14
    buffer_load_dwordx4 v7, s[24:27], s3 offen lds
    s_add_u32 s60, s60, 4
    s_waitcnt vmcnt(8)
    s_barrier
    s_branch need_84_t
need_84:
    s_load_dwordx4 s[64:67], s[52:53], s62 glc
    s_sub_u32 s58, s58, 1
    s_cbranch_scc1 need_84_ok
    s_waitcnt lgkmcnt(0)
need_84_t:
    s_cmp_ge_u32 s48, 2
    s_cselect_b32 s63, s67, s66
    s_cmp_lg_u32 s63, s10
    s_cbranch_scc1 need_84
need_84_ok:
    s_waitcnt lgkmcnt(0)
    s_add_u32 m0, s51, 49152
    s_nop 0
    buffer_load_dwordx4 v5, s[12:15], s50 offen offset:0 sc1 lds
    buffer_load_dwordx4 v5, s[12:15], s50 offen offset:1024 sc1 lds
    s_add_u32 s50, s50, 8192
    s_add_u32 m0, s51, 57344
    s_nop 0
    buffer_load_dwordx4 v5, s[12:15], s50 offen offset:0 sc1 lds
    buffer_load_dwordx4 v5, s[12:15], s50 offen offset:1024 sc1 lds
    s_add_u32 s50, s50, 8192
    s_lshl_b32 m0, s60, 10
    s_lshl_b32 s3, s60, 14
    buffer_load_dwordx4 v7, s[24:27], s3 offen lds
    s_add_u32 s60, s60, 4
    s_lshl_b32 m0, s60, 10
    s_lshl_b32 s3, s60, 14
    buffer_load_dwordx4 v7, s[24:27], s3 offen lds
    s_add_u32 s60, s60, 4
    s_waitcnt vmcnt(8)
    s_barrier
    s_lshl_b32 m0, s60, 10
    s_lshl_b32 s3, s60, 14
    buffer_load_dwordx4 v7, s[24:27], s3 offen lds
    s_add_u32 s60, s60, 4
    s_lshl_b32 m0, s60, 10
    s_lshl_b32 s3, s60, 14
    buffer_load_dwordx4 v7, s[24:27], s3 offen lds
    s_add_u32 s60, s60, 4
    s_lshl_b32 m0, s60, 10
    s_lshl_b32 s3, s60, 14
    buffer_load_dwordx4 v7, s[24:27], s3 offen lds
    s_add_u32 s60, s60, 4
    s_lshl_b32 m0, s60, 10
    s_lshl_b32 s3, s60, 14
    buffer_load_dwordx4 v7, s[24:27], s3 offen lds
    s_add_u32 s60, s60, 4
    s_waitcnt vmcnt(6)
    s_barrier
    s_lshl_b32 m0, s60, 10
    s_lshl_b32 s3, s60, 14
    buffer_load_dwordx4 v7, s[24:27], s3 offen lds
    s_add_u32 s60, s60, 4
    s_lshl_b32 m0, s60, 10
    s_lshl_b32 s3, s60, 14
    buffer_load_dwordx4 v7, s[24:27], s3 offen lds
    s_add_u32 s60, s60, 4
    s_lshl_b32 m0, s60, 10
    s_lshl_b32 s3, s60, 14
    buffer_load_dwordx4 v7, s[24:27], s3 offen lds
    s_add_u32 s60, s60, 4
    s_lshl_b32 m0, s60, 10
    s_lshl_b32 s3, s60, 14
    buffer_load_dwordx4 v7, s[24:27], s3 offen lds
    s_add_u32 s60, s60, 4
    s_barrier
    s_lshl_b32 m0, s60, 10
    s_lshl_b32 s3, s60, 14
    buffer_load_dwordx4 v7, s[24:27], s3 offen lds
    s_add_u32 s60, s60, 4
    s_lshl_b32 m0, s60, 10
    s_lshl_b32 s3, s60, 14
    buffer_load_dwordx4 v7, s[24:27], s3 offen lds
    s_add_u32 s60, s60, 4
    s_lshl_b32 m0, s60, 10
    s_lshl_b32 s3, s60, 14
    buffer_load_dwordx4 v7, s[24:27], s3 offen lds
    s_add_u32 s60, s60, 4
    s_lshl_b32 m0, s60, 10
    s_lshl_b32 s3, s60, 14
    buffer_load_dwordx4 v7, s[24:27], s3 offen lds
    s_add_u32 s60, s60, 4
    s_cmp_eq_u32 s8, 4
    s_cbranch_scc1 h_wo
    s_branch l_wo
.p2align 6
c_attn_slow:
    s_waitcnt lgkmcnt(0)
    s_lshr_b32 s56, s9, 1
    s_lshl_b32 s56, s56, 23
    s_lshl_b32 s55, s7, 19
    s_add_u32 s56, s56, s55
    s_and_b32 s55, s6, 1
    s_lshl_b32 s55, s55, 18
    s_add_u32 s56, s56, s55
    s_add_u32 s56, s56, 33554432
    v_mov_b32 v28, 0xff800000
    v_mov_b32 v30, 0xff800000
    s_mov_b32 s57, 0
c_attn_slow1:
    s_lshr_b32 s55, s57, 2
    s_lshl_b32 s55, s55, 14
    s_and_b32 s58, s57, 3
    s_lshl_b32 s58, s58, 11
    s_add_u32 s55, s55, s58
    s_add_u32 s55, s55, s56
    buffer_load_dwordx4 v[128:131], v5, s[12:15], s55 offen offset:0 sc1
    buffer_load_dwordx4 v[132:135], v5, s[12:15], s55 offen offset:1024 sc1
    s_waitcnt vmcnt(0)
    v_mfma_f32_32x32x16_bf16 v[64:79], v[128:131], v[8:11], 0
    v_mfma_f32_32x32x16_bf16 v[80:95], v[128:131], v[16:19], 0
    v_mfma_f32_32x32x16_bf16 v[64:79], v[132:135], v[12:15], v[64:79]
    v_mfma_f32_32x32x16_bf16 v[80:95], v[132:135], v[20:23], v[80:95]
    s_nop 10
    v_max3_f32 v28, v28, v64, v65
    v_max3_f32 v28, v28, v66, v67
    v_max3_f32 v28, v28, v68, v69
    v_max3_f32 v28, v28, v70, v71
    v_max3_f32 v28, v28, v72, v73
    v_max3_f32 v28, v28, v74, v75
    v_max3_f32 v28, v28, v76, v77
    v_max3_f32 v28, v28, v78, v79
    v_max3_f32 v30, v30, v80, v81
    v_max3_f32 v30, v30, v82, v83
    v_max3_f32 v30, v30, v84, v85
    v_max3_f32 v30, v30, v86, v87
    v_max3_f32 v30, v30, v88, v89
    v_max3_f32 v30, v30, v90, v91
    v_max3_f32 v30, v30, v92, v93
    v_max3_f32 v30, v30, v94, v95
    s_add_u32 s57, s57, 1
    s_cmp_lt_u32 s57, 64
    s_cbranch_scc1 c_attn_slow1
    v_mov_b32 v29, v28
    s_nop 1
    v_permlane32_swap_b32 v28, v29
    v_max_f32 v28, v28, v29
    v_sub_f32 v96, 0, v28
    v_sub_f32 v97, 0, v28
    v_sub_f32 v98, 0, v28
    v_sub_f32 v99, 0, v28
    v_sub_f32 v100, 0, v28
    v_sub_f32 v101, 0, v28
    v_sub_f32 v102, 0, v28
    v_sub_f32 v103, 0, v28
    v_sub_f32 v104, 0, v28
    v_sub_f32 v105, 0, v28
    v_sub_f32 v106, 0, v28
    v_sub_f32 v107, 0, v28
    v_sub_f32 v108, 0, v28
    v_sub_f32 v109, 0, v28
    v_sub_f32 v110, 0, v28
    v_sub_f32 v111, 0, v28
    v_mov_b32 v160, 0
    v_mov_b32 v161, 0
    v_mov_b32 v162, 0
    v_mov_b32 v163, 0
    v_mov_b32 v164, 0
    v_mov_b32 v165, 0
    v_mov_b32 v166, 0
    v_mov_b32 v167, 0
    v_mov_b32 v168, 0
    v_mov_b32 v169, 0
    v_mov_b32 v170, 0
    v_mov_b32 v171, 0
    v_mov_b32 v172, 0
    v_mov_b32 v173, 0
    v_mov_b32 v174, 0
    v_mov_b32 v175, 0
    v_mov_b32 v192, 0
    v_mov_b32 v193, 0
    v_mov_b32 v194, 0
    v_mov_b32 v195, 0
    v_mov_b32 v31, v30
    s_nop 1
    v_permlane32_swap_b32 v30, v31
    v_max_f32 v30, v30, v31
    v_sub_f32 v112, 0, v30
    v_sub_f32 v113, 0, v30
    v_sub_f32 v114, 0, v30
    v_sub_f32 v115, 0, v30
    v_sub_f32 v116, 0, v30
    v_sub_f32 v117, 0, v30
    v_sub_f32 v118, 0, v30
    v_sub_f32 v119, 0, v30
    v_sub_f32 v120, 0, v30
    v_sub_f32 v121, 0, v30
    v_sub_f32 v122, 0, v30
    v_sub_f32 v123, 0, v30
    v_sub_f32 v124, 0, v30
    v_sub_f32 v125, 0, v30
    v_sub_f32 v126, 0, v30
    v_sub_f32 v127, 0, v30
    v_mov_b32 v176, 0
    v_mov_b32 v177, 0
    v_mov_b32 v178, 0
    v_mov_b32 v179, 0
    v_mov_b32 v180, 0
    v_mov_b32 v181, 0
    v_mov_b32 v182, 0
    v_mov_b32 v183, 0
    v_mov_b32 v184, 0
    v_mov_b32 v185, 0
    v_mov_b32 v186, 0
    v_mov_b32 v187, 0
    v_mov_b32 v188, 0
    v_mov_b32 v189, 0
    v_mov_b32 v190, 0
    v_mov_b32 v191, 0
    v_mov_b32 v196, 0
    v_mov_b32 v197, 0
    v_mov_b32 v198, 0
    v_mov_b32 v199, 0
    s_mov_b32 s57, 0
c_attn_slow2:
    s_lshr_b32 s55, s57, 2
    s_lshl_b32 s55, s55, 14
    s_and_b32 s58, s57, 3
    s_lshl_b32 s58, s58, 11
    s_add_u32 s55, s55, s58
    s_add_u32 s55, s55, s56
    buffer_load_dwordx4 v[128:131], v5, s[12:15], s55 offen offset:0 sc1
    buffer_load_dwordx4 v[132:135], v5, s[12:15], s55 offen offset:1024 sc1
    s_add_u32 s55, s55, 8192
    buffer_load_dwordx4 v[144:147], v5, s[12:15], s55 offen offset:0 sc1
    buffer_load_dwordx4 v[148:151], v5, s[12:15], s55 offen offset:1024 sc1
    s_waitcnt vmcnt(0)
    v_mfma_f32_32x32x16_bf16 v[64:79], v[128:131], v[8:11], v[96:111]
    v_mfma_f32_32x32x16_bf16 v[80:95], v[128:131], v[16:19], v[112:127]
    v_mfma_f32_32x32x16_bf16 v[64:79], v[132:135], v[12:15], v[64:79]
    v_mfma_f32_32x32x16_bf16 v[80:95], v[132:135], v[20:23], v[80:95]
    s_nop 10
    v_exp_f32 v64, v64
    v_exp_f32 v65, v65
    v_exp_f32 v66, v66
    v_exp_f32 v67, v67
    v_exp_f32 v68, v68
    v_exp_f32 v69, v69
    v_exp_f32 v70, v70
    v_exp_f32 v71, v71
    v_exp_f32 v72, v72
    v_exp_f32 v73, v73
    v_exp_f32 v74, v74
    v_exp_f32 v75, v75
    v_exp_f32 v76, v76
    v_exp_f32 v77, v77
    v_exp_f32 v78, v78
    v_exp_f32 v79, v79
    v_exp_f32 v80, v80
    v_exp_f32 v81, v81
    v_exp_f32 v82, v82
    v_exp_f32 v83, v83
    v_exp_f32 v84, v84
    v_exp_f32 v85, v85
    v_exp_f32 v86, v86
    v_exp_f32 v87, v87
    v_exp_f32 v88, v88
    v_exp_f32 v89, v89
    v_exp_f32 v90, v90
    v_exp_f32 v91, v91
    v_exp_f32 v92, v92
    v_exp_f32 v93, v93
    v_exp_f32 v94, v94
    v_exp_f32 v95, v95
    v_smfmac_f32_32x32x32_bf16 v[160:175], v[144:147], v[64:71], v204
    v_smfmac_f32_16x16x64_bf16 v[192:195], v[200:203], v[64:71], v204
    v_smfmac_f32_32x32x32_bf16 v[160:175], v[148:151], v[72:79], v204
    v_smfmac_f32_16x16x64_bf16 v[192:195], v[200:203], v[72:79], v204
    v_smfmac_f32_32x32x32_bf16 v[176:191], v[144:147], v[80:87], v204
    v_smfmac_f32_16x16x64_bf16 v[196:199], v[200:203], v[80:87], v204
    v_smfmac_f32_32x32x32_bf16 v[176:191], v[148:151], v[88:95], v204
    v_smfmac_f32_16x16x64_bf16 v[196:199], v[200:203], v[88:95], v204
    s_add_u32 s57, s57, 1
    s_cmp_lt_u32 s57, 64
    s_nop 15
    s_cbranch_scc1 c_attn_slow2
    s_branch c_attn_fin
    s_endpgm
k_end:
.section .rodata,"a"
.p2align 6
.amdhsa_kernel interleave_layers__sliding_local_dilated__softmax_full_mha__prompt_kernel
  .amdhsa_next_free_vgpr 256
  .amdhsa_next_free_sgpr 102
  .amdhsa_accum_offset 224
  .amdhsa_group_segment_fixed_size 0
  .amdhsa_kernarg_size 72
  .amdhsa_user_sgpr_count 2
  .amdhsa_user_sgpr_kernarg_segment_ptr 1
  .amdhsa_system_sgpr_workgroup_id_x 1
.end_amdhsa_kernel
```

```asm
; @launch grid=(256,1,1) block=(512,1,1) lds=159744
.amdgcn_target "amdgcn-amd-amdhsa--gfx950"
.text
.globl interleave_layers__sliding_local_dilated__softmax_full_mha__prompt_kernel
.type interleave_layers__sliding_local_dilated__softmax_full_mha__prompt_kernel,@function
.p2align 8
interleave_layers__sliding_local_dilated__softmax_full_mha__prompt_kernel:
    s_cmp_ge_u32 s2, 256
    s_cbranch_scc1 k_exit2
    s_load_dwordx16 s[32:47], s[0:1], 0
    s_load_dwordx2 s[4:5], s[0:1], 64
    v_lshrrev_b32 v2, 6, v0
    v_and_b32 v1, 63, v0
    v_mov_b32 v12, 0
    v_mov_b32 v14, 0
    v_mov_b32 v15, 0
    v_mov_b32 v16, 0
    v_readfirstlane_b32 s8, v2
    s_and_b32 s3, s2, 1
    s_lshl_b32 s3, s3, 3
    s_bfe_u32 s6, s2, 0x30003
    s_add_u32 s6, s3, s6
    s_bfe_u32 s3, s2, 0x20001
    s_lshl_b32 s3, s3, 2
    s_lshr_b32 s7, s2, 6
    s_add_u32 s7, s3, s7
    s_lshl_b32 s11, s6, 4
    s_add_u32 s11, s11, s7
    s_mov_b32 s9, -1
    s_mov_b32 s96, 0
    s_mov_b32 s10, 0
    s_cmp_lt_u32 s8, 4
    s_cbranch_scc1 c_prep
    s_cmp_eq_u32 s8, 4
    s_cbranch_scc1 h_first
k_heads:
l_first:
    s_sub_u32 s51, s8, 5
    s_mul_i32 s61, s51, 0
    s_add_u32 s61, s61, s2
    s_and_b32 s61, s61, 255
    s_lshl_b32 s3, s51, 8
    s_add_u32 s61, s61, s3
    s_and_b32 s62, s61, 15
    s_lshr_b32 s63, s61, 4
    v_lshrrev_b32 v20, 3, v1
    v_mul_u32_u24 v12, 6144, v20
    v_and_b32 v21, 7, v1
    v_lshl_add_u32 v12, v21, 4, v12
    s_mul_i32 s52, s62, 393216
    s_lshl_b32 s56, s63, 7
    s_add_u32 s52, s52, s56
    s_waitcnt lgkmcnt(0)
    s_mov_b32 s12, s4
    s_mov_b32 s13, s5
    s_mov_b32 s14, 71303168
    s_mov_b32 s15, 0x00020000
    s_mov_b32 s20, s34
    s_mov_b32 s21, s35
    s_mov_b32 s22, 6291456
    s_mov_b32 s23, 0x00020000
    s_add_u32 s53, s52, 0
    buffer_load_dwordx4 v[160:163], v12, s[20:23], s53 offen nt
    s_add_u32 s53, s52, 49152
    buffer_load_dwordx4 v[164:167], v12, s[20:23], s53 offen nt
    s_add_u32 s53, s52, 98304
    buffer_load_dwordx4 v[168:171], v12, s[20:23], s53 offen nt
    s_add_u32 s53, s52, 147456
    buffer_load_dwordx4 v[172:175], v12, s[20:23], s53 offen nt
    s_add_u32 s53, s52, 196608
    buffer_load_dwordx4 v[176:179], v12, s[20:23], s53 offen nt
    s_add_u32 s53, s52, 245760
    buffer_load_dwordx4 v[180:183], v12, s[20:23], s53 offen nt
    s_add_u32 s53, s52, 294912
    buffer_load_dwordx4 v[184:187], v12, s[20:23], s53 offen nt
    s_add_u32 s53, s52, 344064
    buffer_load_dwordx4 v[188:191], v12, s[20:23], s53 offen nt
    s_barrier
    s_branch l_first_tail
c_prep:
    s_lshl_b32 s48, s6, 2
    s_add_u32 s48, s48, s8
    v_lshrrev_b32 v16, 3, v1
    v_and_b32 v17, 7, v1
    v_lshlrev_b32 v18, 11, v16
    v_lshl_add_u32 v18, v17, 4, v18
    s_lshl_b32 s55, s48, 16
    s_lshl_b32 s56, s7, 7
    s_add_u32 s3, s55, s56
    s_waitcnt lgkmcnt(0)
    s_mov_b32 s12, s4
    s_mov_b32 s13, s5
    s_mov_b32 s14, 71303168
    s_mov_b32 s15, 0x00020000
    s_mov_b32 s28, s32
    s_mov_b32 s29, s33
    s_mov_b32 s30, 4194304
    s_mov_b32 s31, 0x00020000
    buffer_load_dwordx4 v[32:35], v18, s[28:31], s3 offen nt
    s_add_u32 s3, s3, 16384
    buffer_load_dwordx4 v[36:39], v18, s[28:31], s3 offen nt
    s_add_u32 s3, s3, 16384
    buffer_load_dwordx4 v[40:43], v18, s[28:31], s3 offen nt
    s_add_u32 s3, s3, 16384
    buffer_load_dwordx4 v[44:47], v18, s[28:31], s3 offen nt
    s_add_u32 s3, s3, 16384
    s_barrier
    s_branch c_prep_tail
h_first:
    s_memrealtime s[50:51]
    s_getpc_b64 s[52:53]
pc_10:
    s_sub_u32 s52, s52, pc_10-interleave_layers__sliding_local_dilated__softmax_full_mha__prompt_kernel
    s_subb_u32 s53, s53, 0
    s_lshr_b32 s3, s2, 3
    s_lshl_b32 s3, s3, 11
    v_and_b32 v18, 15, v0
    v_lshl_add_u32 v18, v18, 7, s3
    v_min_u32 v18, k_end-interleave_layers__sliding_local_dilated__softmax_full_mha__prompt_kernel-4, v18
    v_mov_b32 v19, s53
    v_add_co_u32 v18, vcc, s52, v18
    s_nop 1
    v_addc_co_u32 v19, vcc, 0, v19, vcc
    s_mov_b64 exec, 0xffff
    global_load_dword v18, v[18:19], off
    s_mov_b64 exec, -1
    s_waitcnt lgkmcnt(0)
    s_mov_b32 s12, s4
    s_mov_b32 s13, s5
    s_mov_b32 s14, 71303168
    s_mov_b32 s15, 0x00020000
    s_cmp_lg_u32 s2, 0
    s_cbranch_scc1 h_first_nonon
    s_mov_b32 s16, s46
    s_mov_b32 s17, s47
    s_mov_b32 s18, 256
    s_mov_b32 s19, 0x00020000
    v_lshlrev_b32 v14, 6, v1
    s_or_b32 s50, s50, 1
    v_mov_b32 v13, s50
    buffer_store_dword v13, v14, s[16:19], 0 offen sc1
h_first_nonon:
    v_mov_b32 v8, 0
    v_mov_b32 v9, 0
    v_mov_b32 v10, 159488
    ds_write_b64 v10, v[8:9]
    ds_write_b64 v10, v[8:9] offset:8
    ds_write_b64 v10, v[8:9] offset:16
    ds_write_b64 v10, v[8:9] offset:24
    s_waitcnt lgkmcnt(0)
    s_barrier
    s_branch h_first_tail
k_exit:
k_exit2:
    s_endpgm
.p2align 6
c_qkvA:
    v_and_b32 v1, 63, v0
    v_lshrrev_b32 v2, 6, v0
    v_lshlrev_b32 v5, 4, v1
    v_lshrrev_b32 v3, 5, v1
    v_and_b32 v4, 15, v0
    v_bfe_u32 v7, v1, 4, 1
    v_lshl_add_u32 v6, v7, 5, v4
    v_lshlrev_b32 v6, 4, v6
    v_lshl_add_u32 v6, v3, 10, v6
    s_lshr_b32 s48, s6, 1
    s_lshl_b32 s48, s48, 2
    s_add_u32 s48, s48, s8
    s_lshl_b32 s55, s48, 17
    s_lshl_b32 s56, s9, 22
    s_add_u32 s55, s55, s56
    s_add_u32 s16, s4, s55
    s_addc_u32 s17, s5, 0
    s_mov_b32 s18, 65536
    s_mov_b32 s19, 0x00020000
    s_add_u32 s56, s55, 65536
    s_add_u32 s20, s4, s56
    s_addc_u32 s21, s5, 0
    s_mov_b32 s22, 65536
    s_mov_b32 s23, 0x00020000
    s_lshl_b32 s49, s7, 12
    s_add_u32 s49, s49, s55
    s_and_b32 s56, s6, 1
    s_lshl_b32 s56, s56, 11
    s_add_u32 s49, s49, s56
    s_add_u32 s49, s49, 16777216
    s_movk_i32 s54, 4096
    v_lshrrev_b32 v16, 2, v4
    v_lshl_add_u32 v18, v7, 2, v16
    v_lshl_add_u32 v18, v3, 4, v18
    v_lshlrev_b32 v18, 6, v18
    v_and_b32 v17, 3, v4
    v_lshl_add_u32 v18, v17, 3, v18
    v_lshl_add_u32 v26, v7, 5, v18
    v_xor_b32 v27, 32, v26
    v_mov_b32 v24, v26
    v_mov_b32 v25, v27
    v_and_b32 v18, 0x30, v1
    v_add_u32 v10, 155648, v18
    v_lshlrev_b32 v11, 2, v4
    v_add_u32 v11, 155648, v11
    v_lshl_add_u32 v8, v2, 8, v11
    v_lshl_add_u32 v9, v2, 8, v10
    s_lshr_b32 s3, s8, 1
    s_and_b32 s55, s8, 1
    s_lshl_b32 s56, s55, 5
    v_xor_b32 v29, s56, v26
    s_lshl_b32 s56, s3, 13
    s_add_u32 s56, s56, 8192
    v_add_u32 v29, s56, v29
    v_mov_b32 v28, v29
    v_add_u32 v30, 147456, v5
    v_lshl_add_u32 v14, v2, 6, v10
    v_lshl_add_u32 v12, v2, 11, v5
    v_add_u32 v12, 131072, v12
    v_lshlrev_b32 v16, 8, v16
    v_lshl_add_u32 v16, v18, 2, v16
    v_lshl_add_u32 v16, v17, 1, v16
    v_add_u32 v16, 1024, v16
    v_cmp_gt_u32 vcc, 2, v2
    s_nop 1
    v_cndmask_b32 v13, v16, v5, vcc
    s_lshl_b32 s56, s55, 3
    s_add_u32 s56, s56, 131072
    v_add_u32 v13, s56, v13
    v_lshrrev_b32 v18, 2, v18
    v_sub_u32 v18, v4, v18
    v_mov_b32 v19, 0xf149f2ca
    v_add_u32 v16, 0x0, v18
    v_and_b32 v16, 0xfffffff1, v16
    v_cmp_eq_u32 vcc, 0, v16
    s_nop 1
    v_cndmask_b32 v196, v19, 0, vcc
    v_add_u32 v16, 0xffffffff, v18
    v_and_b32 v16, 0xfffffff1, v16
    v_cmp_eq_u32 vcc, 0, v16
    s_nop 1
    v_cndmask_b32 v197, v19, 0, vcc
    v_add_u32 v16, 0xfffffffe, v18
    v_and_b32 v16, 0xfffffff1, v16
    v_cmp_eq_u32 vcc, 0, v16
    s_nop 1
    v_cndmask_b32 v198, v19, 0, vcc
    v_add_u32 v16, 0xfffffffd, v18
    v_and_b32 v16, 0xfffffff1, v16
    v_cmp_eq_u32 vcc, 0, v16
    s_nop 1
    v_cndmask_b32 v199, v19, 0, vcc
    v_add_u32 v16, 0x10, v18
    v_and_b32 v16, 0xfffffff1, v16
    v_cmp_eq_u32 vcc, 0, v16
    s_nop 1
    v_cndmask_b32 v200, v19, 0, vcc
    v_add_u32 v16, 0xf, v18
    v_and_b32 v16, 0xfffffff1, v16
    v_cmp_eq_u32 vcc, 0, v16
    s_nop 1
    v_cndmask_b32 v201, v19, 0, vcc
    v_add_u32 v16, 0xe, v18
    v_and_b32 v16, 0xfffffff1, v16
    v_cmp_eq_u32 vcc, 0, v16
    s_nop 1
    v_cndmask_b32 v202, v19, 0, vcc
    v_add_u32 v16, 0xd, v18
    v_and_b32 v16, 0xfffffff1, v16
    v_cmp_eq_u32 vcc, 0, v16
    s_nop 1
    v_cndmask_b32 v203, v19, 0, vcc
    s_cmp_eq_u32 s48, 0
    s_cselect_b64 vcc, -1, 0
    v_cndmask_b32 v204, v200, v19, vcc
    v_cndmask_b32 v205, v201, v19, vcc
    v_cndmask_b32 v206, v202, v19, vcc
    v_cndmask_b32 v207, v203, v19, vcc
    v_mov_b32 v208, 0x3f803f80
    v_mov_b32 v209, 0x3f803f80
    v_mov_b32 v210, 0x3f803f80
    v_mov_b32 v211, 0x3f803f80
    v_mov_b32 v184, 0
    v_mov_b32 v185, 0
    v_mov_b32 v186, 0
    v_mov_b32 v187, 0
    v_mov_b32 v188, 0
    v_mov_b32 v189, 0
    v_mov_b32 v190, 0
    v_mov_b32 v191, 0
    v_mov_b32 v192, 0
    v_mov_b32 v193, 0
    v_mov_b32 v194, 0
    v_mov_b32 v195, 0
    v_mov_b32 v32, 0
    v_mov_b32 v33, 0
    v_mov_b32 v34, 0
    v_mov_b32 v35, 0
    v_mov_b32 v36, 0
    v_mov_b32 v37, 0
    v_mov_b32 v38, 0
    v_mov_b32 v39, 0
    v_mov_b32 v40, 0
    v_mov_b32 v41, 0
    v_mov_b32 v42, 0
    v_mov_b32 v43, 0
    v_mov_b32 v44, 0
    v_mov_b32 v45, 0
    v_mov_b32 v46, 0
    v_mov_b32 v47, 0
    v_mov_b32 v48, 0
    v_mov_b32 v49, 0
    v_mov_b32 v50, 0
    v_mov_b32 v51, 0
    v_mov_b32 v52, 0
    v_mov_b32 v53, 0
    v_mov_b32 v54, 0
    v_mov_b32 v55, 0
    v_mov_b32 v56, 0
    v_mov_b32 v57, 0
    v_mov_b32 v58, 0
    v_mov_b32 v59, 0
    v_mov_b32 v60, 0
    v_mov_b32 v61, 0
    v_mov_b32 v62, 0
    v_mov_b32 v63, 0
    v_mov_b32 v64, 0
    v_mov_b32 v65, 0
    v_mov_b32 v66, 0
    v_mov_b32 v67, 0
    v_mov_b32 v68, 0
    v_mov_b32 v69, 0
    v_mov_b32 v70, 0
    v_mov_b32 v71, 0
    v_mov_b32 v72, 0
    v_mov_b32 v73, 0
    v_mov_b32 v74, 0
    v_mov_b32 v75, 0
    v_mov_b32 v76, 0
    v_mov_b32 v77, 0
    v_mov_b32 v78, 0
    v_mov_b32 v79, 0
    v_mov_b32 v80, 0
    v_mov_b32 v81, 0
    v_mov_b32 v82, 0
    v_mov_b32 v83, 0
    v_mov_b32 v84, 0
    v_mov_b32 v85, 0
    v_mov_b32 v86, 0
    v_mov_b32 v87, 0
    v_mov_b32 v88, 0
    v_mov_b32 v89, 0
    v_mov_b32 v90, 0
    v_mov_b32 v91, 0
    v_mov_b32 v92, 0
    v_mov_b32 v93, 0
    v_mov_b32 v94, 0
    v_mov_b32 v95, 0
    v_mov_b32 v96, 0
    v_mov_b32 v97, 0
    v_mov_b32 v98, 0
    v_mov_b32 v99, 0
    v_mov_b32 v100, 0
    v_mov_b32 v101, 0
    v_mov_b32 v102, 0
    v_mov_b32 v103, 0
    v_mov_b32 v104, 0
    v_mov_b32 v105, 0
    v_mov_b32 v106, 0
    v_mov_b32 v107, 0
    v_mov_b32 v108, 0
    v_mov_b32 v109, 0
    v_mov_b32 v110, 0
    v_mov_b32 v111, 0
    v_mov_b32 v112, 0
    v_mov_b32 v113, 0
    v_mov_b32 v114, 0
    v_mov_b32 v115, 0
    v_mov_b32 v116, 0
    v_mov_b32 v117, 0
    v_mov_b32 v118, 0
    v_mov_b32 v119, 0
    v_mov_b32 v120, 0
    v_mov_b32 v121, 0
    v_mov_b32 v122, 0
    v_mov_b32 v123, 0
    v_mov_b32 v124, 0
    v_mov_b32 v125, 0
    v_mov_b32 v126, 0
    v_mov_b32 v127, 0
    s_mov_b32 s50, 8192
    s_mov_b32 s58, 6144
    s_mov_b32 s51, 12288
    s_mov_b32 s59, 10240
    s_mov_b32 s52, 0
    s_mul_i32 s60, s9, 786432
    s_add_u32 s60, s60, 65273856
    s_lshl_b32 s61, s11, 10
    s_add_u32 s60, s60, s61
    s_and_b32 s61, s8, 2
    s_lshl_b32 s61, s61, 7
    s_add_u32 s60, s60, s61
    s_add_u32 s61, s60, 128
    s_mov_b32 s98, s10
    s_mov_b32 s99, s10
    s_mov_b32 s3, 0x100000
cp_1:
    s_load_dwordx8 s[64:71], s[4:5], s60 glc
    s_load_dwordx8 s[72:79], s[4:5], s61 glc
    s_sub_u32 s3, s3, 1
    s_cbranch_scc1 cp_1_ok
    s_waitcnt lgkmcnt(0)
    s_xor_b64 s[100:101], s[64:65], s[98:99]
    s_xor_b64 s[64:65], s[66:67], s[98:99]
    s_or_b64 s[100:101], s[100:101], s[64:65]
    s_xor_b64 s[64:65], s[68:69], s[98:99]
    s_or_b64 s[100:101], s[100:101], s[64:65]
    s_xor_b64 s[64:65], s[70:71], s[98:99]
    s_or_b64 s[100:101], s[100:101], s[64:65]
    s_xor_b64 s[64:65], s[72:73], s[98:99]
    s_or_b64 s[100:101], s[100:101], s[64:65]
    s_xor_b64 s[64:65], s[74:75], s[98:99]
    s_or_b64 s[100:101], s[100:101], s[64:65]
    s_xor_b64 s[64:65], s[76:77], s[98:99]
    s_or_b64 s[100:101], s[100:101], s[64:65]
    s_xor_b64 s[64:65], s[78:79], s[98:99]
    s_or_b64 s[100:101], s[100:101], s[64:65]
    s_cbranch_scc1 cp_1
cp_1_ok:
    s_waitcnt lgkmcnt(0)
    buffer_load_dwordx4 v[152:155], v6, s[16:19], 0 offen offset:0 sc1
    buffer_load_dwordx4 v[156:159], v6, s[16:19], 0 offen offset:256 sc1
    buffer_load_dwordx4 v[160:163], v6, s[20:23], 0 offen offset:0 sc1
    buffer_load_dwordx4 v[164:167], v6, s[20:23], 0 offen offset:256 sc1
    buffer_load_dwordx4 v[168:171], v6, s[16:19], 0 offen offset:2048 sc1
    buffer_load_dwordx4 v[172:175], v6, s[16:19], 0 offen offset:2304 sc1
    buffer_load_dwordx4 v[176:179], v6, s[20:23], 0 offen offset:2048 sc1
    buffer_load_dwordx4 v[180:183], v6, s[20:23], 0 offen offset:2304 sc1
    s_barrier
    ds_read_b64_tr_b16 v[128:129], v24 offset:0
    ds_read_b64_tr_b16 v[130:131], v24 offset:512
    ds_read_b64_tr_b16 v[132:133], v25 offset:0
    ds_read_b64_tr_b16 v[134:135], v25 offset:512
    ds_read_b64_tr_b16 v[136:137], v24 offset:8192
    ds_read_b64_tr_b16 v[138:139], v24 offset:8704
    ds_read_b64_tr_b16 v[140:141], v25 offset:8192
    ds_read_b64_tr_b16 v[142:143], v25 offset:8704
    ds_read_b64_tr_b16 v[144:145], v24 offset:16384
    ds_read_b64_tr_b16 v[146:147], v24 offset:16896
    buffer_load_dwordx4 a[0:3], v6, s[16:19], s54 offen offset:0 sc1
    buffer_load_dwordx4 a[4:7], v6, s[16:19], s54 offen offset:256 sc1
    buffer_load_dwordx4 a[8:11], v6, s[20:23], s54 offen offset:0 sc1
    buffer_load_dwordx4 a[12:15], v6, s[20:23], s54 offen offset:256 sc1
    buffer_load_dwordx4 a[16:19], v6, s[16:19], s54 offen offset:2048 sc1
    buffer_load_dwordx4 a[20:23], v6, s[16:19], s54 offen offset:2304 sc1
    s_mov_b32 s54, 7
.p2align 3
c_qkvA_loop:
    s_waitcnt vmcnt(12) lgkmcnt(8)
    v_mfma_f32_16x16x32_bf16 v[184:187], v[188:191], v[192:195], v[184:187]
    v_mfma_f32_16x16x32_bf16 v[32:35], v[128:131], v[152:155], v[32:35]
    ds_read_b64_tr_b16 v[148:149], v25 offset:16384
    buffer_load_dwordx4 a[24:27], v6, s[20:23], s58 offen offset:0 sc1
    v_mfma_f32_16x16x32_bf16 v[36:39], v[128:131], v[156:159], v[36:39]
    ds_read_b64_tr_b16 v[150:151], v25 offset:16896
    s_waitcnt lgkmcnt(8)
    v_mfma_f32_16x16x32_bf16 v[52:55], v[132:135], v[156:159], v[52:55]
    v_mfma_f32_16x16x32_bf16 v[48:51], v[132:135], v[152:155], v[48:51]
    ds_read_b64_tr_b16 v[188:189], v28 offset:0
    s_waitcnt lgkmcnt(7)
    v_mfma_f32_16x16x32_bf16 v[64:67], v[136:139], v[152:155], v[64:67]
    v_mfma_f32_16x16x32_bf16 v[68:71], v[136:139], v[156:159], v[68:71]
    ds_read_b64_tr_b16 v[190:191], v28 offset:512
    s_waitcnt lgkmcnt(6)
    v_mfma_f32_16x16x32_bf16 v[84:87], v[140:143], v[156:159], v[84:87]
    buffer_load_dwordx4 a[28:31], v6, s[20:23], s58 offen offset:256 sc1
    v_mfma_f32_16x16x32_bf16 v[80:83], v[140:143], v[152:155], v[80:83]
    ds_read_b128 v[192:195], v30 offset:0
    s_waitcnt lgkmcnt(5)
    v_mfma_f32_16x16x32_bf16 v[96:99], v[152:155], v[144:147], v[96:99]
    v_mfma_f32_16x16x32_bf16 v[100:103], v[156:159], v[144:147], v[100:103]
    s_waitcnt lgkmcnt(3)
    v_mfma_f32_16x16x32_bf16 v[116:119], v[156:159], v[148:151], v[116:119]
    v_mfma_f32_16x16x32_bf16 v[112:115], v[152:155], v[148:151], v[112:115]
    s_waitcnt vmcnt(12)
    v_mfma_f32_16x16x32_bf16 v[40:43], v[128:131], v[160:163], v[40:43]
    buffer_load_dwordx4 v[152:155], v6, s[16:19], s50 offen offset:0 sc1
    v_mfma_f32_16x16x32_bf16 v[44:47], v[128:131], v[164:167], v[44:47]
    v_mfma_f32_16x16x32_bf16 v[60:63], v[132:135], v[164:167], v[60:63]
    ds_read_b64_tr_b16 v[128:129], v24 offset:2048
    v_mfma_f32_16x16x32_bf16 v[56:59], v[132:135], v[160:163], v[56:59]
    ds_read_b64_tr_b16 v[130:131], v24 offset:2560
    v_mfma_f32_16x16x32_bf16 v[72:75], v[136:139], v[160:163], v[72:75]
    ds_read_b64_tr_b16 v[132:133], v25 offset:2048
    v_mfma_f32_16x16x32_bf16 v[76:79], v[136:139], v[164:167], v[76:79]
    ds_read_b64_tr_b16 v[134:135], v25 offset:2560
    v_mfma_f32_16x16x32_bf16 v[92:95], v[140:143], v[164:167], v[92:95]
    ds_read_b64_tr_b16 v[136:137], v24 offset:10240
    buffer_load_dwordx4 v[156:159], v6, s[16:19], s50 offen offset:256 sc1
    v_mfma_f32_16x16x32_bf16 v[88:91], v[140:143], v[160:163], v[88:91]
    ds_read_b64_tr_b16 v[138:139], v24 offset:10752
    v_mfma_f32_16x16x32_bf16 v[104:107], v[160:163], v[144:147], v[104:107]
    ds_read_b64_tr_b16 v[140:141], v25 offset:10240
    v_mfma_f32_16x16x32_bf16 v[108:111], v[164:167], v[144:147], v[108:111]
    ds_read_b64_tr_b16 v[142:143], v25 offset:10752
    v_mfma_f32_16x16x32_bf16 v[124:127], v[164:167], v[148:151], v[124:127]
    ds_read_b64_tr_b16 v[144:145], v24 offset:18432
    v_mfma_f32_16x16x32_bf16 v[120:123], v[160:163], v[148:151], v[120:123]
    ds_read_b64_tr_b16 v[146:147], v24 offset:18944
    s_waitcnt vmcnt(12) lgkmcnt(8)
    v_mfma_f32_16x16x32_bf16 v[184:187], v[188:191], v[192:195], v[184:187]
    v_mfma_f32_16x16x32_bf16 v[32:35], v[128:131], v[168:171], v[32:35]
    ds_read_b64_tr_b16 v[148:149], v25 offset:18432
    buffer_load_dwordx4 v[160:163], v6, s[20:23], s58 offen offset:2048 sc1
    v_mfma_f32_16x16x32_bf16 v[36:39], v[128:131], v[172:175], v[36:39]
    ds_read_b64_tr_b16 v[150:151], v25 offset:18944
    s_waitcnt lgkmcnt(8)
    v_mfma_f32_16x16x32_bf16 v[52:55], v[132:135], v[172:175], v[52:55]
    v_mfma_f32_16x16x32_bf16 v[48:51], v[132:135], v[168:171], v[48:51]
    ds_read_b64_tr_b16 v[188:189], v28 offset:2048
    s_waitcnt lgkmcnt(7)
    v_mfma_f32_16x16x32_bf16 v[64:67], v[136:139], v[168:171], v[64:67]
    v_mfma_f32_16x16x32_bf16 v[68:71], v[136:139], v[172:175], v[68:71]
    ds_read_b64_tr_b16 v[190:191], v28 offset:2560
    s_waitcnt lgkmcnt(6)
    v_mfma_f32_16x16x32_bf16 v[84:87], v[140:143], v[172:175], v[84:87]
    buffer_load_dwordx4 v[164:167], v6, s[20:23], s58 offen offset:2304 sc1
    v_mfma_f32_16x16x32_bf16 v[80:83], v[140:143], v[168:171], v[80:83]
    ds_read_b128 v[192:195], v30 offset:1024
    s_waitcnt lgkmcnt(5)
    v_mfma_f32_16x16x32_bf16 v[96:99], v[168:171], v[144:147], v[96:99]
    v_mfma_f32_16x16x32_bf16 v[100:103], v[172:175], v[144:147], v[100:103]
    s_waitcnt lgkmcnt(3)
    v_mfma_f32_16x16x32_bf16 v[116:119], v[172:175], v[148:151], v[116:119]
    v_mfma_f32_16x16x32_bf16 v[112:115], v[168:171], v[148:151], v[112:115]
    s_waitcnt vmcnt(12)
    v_mfma_f32_16x16x32_bf16 v[40:43], v[128:131], v[176:179], v[40:43]
    buffer_load_dwordx4 v[168:171], v6, s[16:19], s50 offen offset:2048 sc1
    v_mfma_f32_16x16x32_bf16 v[44:47], v[128:131], v[180:183], v[44:47]
    v_mfma_f32_16x16x32_bf16 v[60:63], v[132:135], v[180:183], v[60:63]
    ds_read_b64_tr_b16 v[128:129], v24 offset:4096
    v_mfma_f32_16x16x32_bf16 v[56:59], v[132:135], v[176:179], v[56:59]
    ds_read_b64_tr_b16 v[130:131], v24 offset:4608
    v_mfma_f32_16x16x32_bf16 v[72:75], v[136:139], v[176:179], v[72:75]
    ds_read_b64_tr_b16 v[132:133], v25 offset:4096
    v_mfma_f32_16x16x32_bf16 v[76:79], v[136:139], v[180:183], v[76:79]
    ds_read_b64_tr_b16 v[134:135], v25 offset:4608
    v_mfma_f32_16x16x32_bf16 v[92:95], v[140:143], v[180:183], v[92:95]
    ds_read_b64_tr_b16 v[136:137], v24 offset:12288
    buffer_load_dwordx4 v[172:175], v6, s[16:19], s50 offen offset:2304 sc1
    v_mfma_f32_16x16x32_bf16 v[88:91], v[140:143], v[176:179], v[88:91]
    ds_read_b64_tr_b16 v[138:139], v24 offset:12800
    v_mfma_f32_16x16x32_bf16 v[104:107], v[176:179], v[144:147], v[104:107]
    ds_read_b64_tr_b16 v[140:141], v25 offset:12288
    v_mfma_f32_16x16x32_bf16 v[108:111], v[180:183], v[144:147], v[108:111]
    ds_read_b64_tr_b16 v[142:143], v25 offset:12800
    v_mfma_f32_16x16x32_bf16 v[124:127], v[180:183], v[148:151], v[124:127]
    ds_read_b64_tr_b16 v[144:145], v24 offset:20480
    v_mfma_f32_16x16x32_bf16 v[120:123], v[176:179], v[148:151], v[120:123]
    ds_read_b64_tr_b16 v[146:147], v24 offset:20992
    s_waitcnt vmcnt(12) lgkmcnt(8)
    v_mfma_f32_16x16x32_bf16 v[184:187], v[188:191], v[192:195], v[184:187]
    v_mfma_f32_16x16x32_bf16 v[32:35], v[128:131], a[0:3], v[32:35]
    ds_read_b64_tr_b16 v[148:149], v25 offset:20480
    buffer_load_dwordx4 v[176:179], v6, s[20:23], s59 offen offset:0 sc1
    v_mfma_f32_16x16x32_bf16 v[36:39], v[128:131], a[4:7], v[36:39]
    ds_read_b64_tr_b16 v[150:151], v25 offset:20992
    s_waitcnt lgkmcnt(8)
    v_mfma_f32_16x16x32_bf16 v[52:55], v[132:135], a[4:7], v[52:55]
    s_add_u32 s58, s58, 8192
    v_mfma_f32_16x16x32_bf16 v[48:51], v[132:135], a[0:3], v[48:51]
    ds_read_b64_tr_b16 v[188:189], v28 offset:4096
    s_waitcnt lgkmcnt(7)
    v_mfma_f32_16x16x32_bf16 v[64:67], v[136:139], a[0:3], v[64:67]
    s_add_u32 s50, s50, 8192
    v_mfma_f32_16x16x32_bf16 v[68:71], v[136:139], a[4:7], v[68:71]
    ds_read_b64_tr_b16 v[190:191], v28 offset:4608
    s_waitcnt lgkmcnt(6)
    v_mfma_f32_16x16x32_bf16 v[84:87], v[140:143], a[4:7], v[84:87]
    buffer_load_dwordx4 v[180:183], v6, s[20:23], s59 offen offset:256 sc1
    v_mfma_f32_16x16x32_bf16 v[80:83], v[140:143], a[0:3], v[80:83]
    ds_read_b128 v[192:195], v30 offset:2048
    s_waitcnt lgkmcnt(5)
    v_mfma_f32_16x16x32_bf16 v[96:99], a[0:3], v[144:147], v[96:99]
    s_add_u32 s52, s52, 24576
    v_mfma_f32_16x16x32_bf16 v[100:103], a[4:7], v[144:147], v[100:103]
    s_cmp_eq_u32 s52, 147456
    s_waitcnt lgkmcnt(3)
    v_mfma_f32_16x16x32_bf16 v[116:119], a[4:7], v[148:151], v[116:119]
    s_cselect_b32 s52, 0, s52
    v_mfma_f32_16x16x32_bf16 v[112:115], a[0:3], v[148:151], v[112:115]
    s_waitcnt vmcnt(12)
    v_mfma_f32_16x16x32_bf16 v[40:43], v[128:131], a[8:11], v[40:43]
    buffer_load_dwordx4 a[0:3], v6, s[16:19], s51 offen offset:0 sc1
    v_mfma_f32_16x16x32_bf16 v[44:47], v[128:131], a[12:15], v[44:47]
    s_sub_u32 s54, s54, 1
    v_mfma_f32_16x16x32_bf16 v[60:63], v[132:135], a[12:15], v[60:63]
    ds_read_b64_tr_b16 v[128:129], v24 offset:6144
    v_mfma_f32_16x16x32_bf16 v[56:59], v[132:135], a[8:11], v[56:59]
    ds_read_b64_tr_b16 v[130:131], v24 offset:6656
    v_mfma_f32_16x16x32_bf16 v[72:75], v[136:139], a[8:11], v[72:75]
    ds_read_b64_tr_b16 v[132:133], v25 offset:6144
    v_mfma_f32_16x16x32_bf16 v[76:79], v[136:139], a[12:15], v[76:79]
    ds_read_b64_tr_b16 v[134:135], v25 offset:6656
    v_mfma_f32_16x16x32_bf16 v[92:95], v[140:143], a[12:15], v[92:95]
    ds_read_b64_tr_b16 v[136:137], v24 offset:14336
    buffer_load_dwordx4 a[4:7], v6, s[16:19], s51 offen offset:256 sc1
    v_mfma_f32_16x16x32_bf16 v[88:91], v[140:143], a[8:11], v[88:91]
    ds_read_b64_tr_b16 v[138:139], v24 offset:14848
    v_mfma_f32_16x16x32_bf16 v[104:107], a[8:11], v[144:147], v[104:107]
    ds_read_b64_tr_b16 v[140:141], v25 offset:14336
    v_mfma_f32_16x16x32_bf16 v[108:111], a[12:15], v[144:147], v[108:111]
    ds_read_b64_tr_b16 v[142:143], v25 offset:14848
    v_mfma_f32_16x16x32_bf16 v[124:127], a[12:15], v[148:151], v[124:127]
    ds_read_b64_tr_b16 v[144:145], v24 offset:22528
    v_mfma_f32_16x16x32_bf16 v[120:123], a[8:11], v[148:151], v[120:123]
    ds_read_b64_tr_b16 v[146:147], v24 offset:23040
    s_waitcnt vmcnt(12) lgkmcnt(8)
    v_mfma_f32_16x16x32_bf16 v[184:187], v[188:191], v[192:195], v[184:187]
    v_mfma_f32_16x16x32_bf16 v[32:35], v[128:131], a[16:19], v[32:35]
    ds_read_b64_tr_b16 v[148:149], v25 offset:22528
    buffer_load_dwordx4 a[8:11], v6, s[20:23], s59 offen offset:2048 sc1
    v_mfma_f32_16x16x32_bf16 v[36:39], v[128:131], a[20:23], v[36:39]
    ds_read_b64_tr_b16 v[150:151], v25 offset:23040
    s_waitcnt lgkmcnt(8)
    v_mfma_f32_16x16x32_bf16 v[52:55], v[132:135], a[20:23], v[52:55]
    v_add_u32 v24, s52, v26
    v_mfma_f32_16x16x32_bf16 v[48:51], v[132:135], a[16:19], v[48:51]
    ds_read_b64_tr_b16 v[188:189], v28 offset:6144
    s_waitcnt lgkmcnt(7)
    v_mfma_f32_16x16x32_bf16 v[64:67], v[136:139], a[16:19], v[64:67]
    v_add_u32 v25, s52, v27
    v_mfma_f32_16x16x32_bf16 v[68:71], v[136:139], a[20:23], v[68:71]
    ds_read_b64_tr_b16 v[190:191], v28 offset:6656
    s_waitcnt lgkmcnt(6)
    v_mfma_f32_16x16x32_bf16 v[84:87], v[140:143], a[20:23], v[84:87]
    buffer_load_dwordx4 a[12:15], v6, s[20:23], s59 offen offset:2304 sc1
    v_mfma_f32_16x16x32_bf16 v[80:83], v[140:143], a[16:19], v[80:83]
    ds_read_b128 v[192:195], v30 offset:3072
    s_waitcnt lgkmcnt(5)
    v_mfma_f32_16x16x32_bf16 v[96:99], a[16:19], v[144:147], v[96:99]
    s_add_u32 s59, s59, 8192
    v_mfma_f32_16x16x32_bf16 v[100:103], a[20:23], v[144:147], v[100:103]
    v_add_u32 v28, s52, v29
    s_waitcnt lgkmcnt(3)
    v_mfma_f32_16x16x32_bf16 v[116:119], a[20:23], v[148:151], v[116:119]
    s_waitcnt lgkmcnt(0)
    v_mfma_f32_16x16x32_bf16 v[112:115], a[16:19], v[148:151], v[112:115]
    s_barrier
    s_waitcnt vmcnt(12)
    v_mfma_f32_16x16x32_bf16 v[40:43], v[128:131], a[24:27], v[40:43]
    buffer_load_dwordx4 a[16:19], v6, s[16:19], s51 offen offset:2048 sc1
    v_mfma_f32_16x16x32_bf16 v[44:47], v[128:131], a[28:31], v[44:47]
    v_xor_b32 v30, 4096, v30
    v_mfma_f32_16x16x32_bf16 v[60:63], v[132:135], a[28:31], v[60:63]
    ds_read_b64_tr_b16 v[128:129], v24 offset:0
    v_mfma_f32_16x16x32_bf16 v[56:59], v[132:135], a[24:27], v[56:59]
    ds_read_b64_tr_b16 v[130:131], v24 offset:512
    v_mfma_f32_16x16x32_bf16 v[72:75], v[136:139], a[24:27], v[72:75]
    ds_read_b64_tr_b16 v[132:133], v25 offset:0
    v_mfma_f32_16x16x32_bf16 v[76:79], v[136:139], a[28:31], v[76:79]
    ds_read_b64_tr_b16 v[134:135], v25 offset:512
    v_mfma_f32_16x16x32_bf16 v[92:95], v[140:143], a[28:31], v[92:95]
    ds_read_b64_tr_b16 v[136:137], v24 offset:8192
    buffer_load_dwordx4 a[20:23], v6, s[16:19], s51 offen offset:2304 sc1
    v_mfma_f32_16x16x32_bf16 v[88:91], v[140:143], a[24:27], v[88:91]
    ds_read_b64_tr_b16 v[138:139], v24 offset:8704
    v_mfma_f32_16x16x32_bf16 v[104:107], a[24:27], v[144:147], v[104:107]
    ds_read_b64_tr_b16 v[140:141], v25 offset:8192
    s_add_u32 s51, s51, 8192
    v_mfma_f32_16x16x32_bf16 v[108:111], a[28:31], v[144:147], v[108:111]
    ds_read_b64_tr_b16 v[142:143], v25 offset:8704
    v_mfma_f32_16x16x32_bf16 v[124:127], a[28:31], v[148:151], v[124:127]
    ds_read_b64_tr_b16 v[144:145], v24 offset:16384
    s_cmp_lg_u32 s54, 0
    v_mfma_f32_16x16x32_bf16 v[120:123], a[24:27], v[148:151], v[120:123]
    ds_read_b64_tr_b16 v[146:147], v24 offset:16896
    s_cbranch_scc1 c_qkvA_loop
    s_waitcnt vmcnt(12) lgkmcnt(8)
    v_mfma_f32_16x16x32_bf16 v[184:187], v[188:191], v[192:195], v[184:187]
    v_mfma_f32_16x16x32_bf16 v[32:35], v[128:131], v[152:155], v[32:35]
    ds_read_b64_tr_b16 v[148:149], v25 offset:16384
    buffer_load_dwordx4 a[24:27], v6, s[20:23], s58 offen offset:0 sc1
    v_mfma_f32_16x16x32_bf16 v[36:39], v[128:131], v[156:159], v[36:39]
    ds_read_b64_tr_b16 v[150:151], v25 offset:16896
    s_waitcnt lgkmcnt(8)
    v_mfma_f32_16x16x32_bf16 v[52:55], v[132:135], v[156:159], v[52:55]
    ds_read_b32 v16, v8 offset:1280
    v_mfma_f32_16x16x32_bf16 v[48:51], v[132:135], v[152:155], v[48:51]
    ds_read_b64_tr_b16 v[188:189], v28 offset:0
    ds_read_b32 v18, v8 offset:1344
    s_waitcnt lgkmcnt(9)
    v_mfma_f32_16x16x32_bf16 v[64:67], v[136:139], v[152:155], v[64:67]
    ds_read_b32 v20, v8 offset:1408
    v_mfma_f32_16x16x32_bf16 v[68:71], v[136:139], v[156:159], v[68:71]
    ds_read_b64_tr_b16 v[190:191], v28 offset:512
    s_waitcnt lgkmcnt(9)
    v_mfma_f32_16x16x32_bf16 v[84:87], v[140:143], v[156:159], v[84:87]
    buffer_load_dwordx4 a[28:31], v6, s[20:23], s58 offen offset:256 sc1
    ds_read_b32 v22, v8 offset:1472
    v_mfma_f32_16x16x32_bf16 v[80:83], v[140:143], v[152:155], v[80:83]
    ds_read_b128 v[192:195], v30 offset:0
    ds_read_b128 v[212:215], v10 offset:128
    s_waitcnt lgkmcnt(10)
    v_mfma_f32_16x16x32_bf16 v[96:99], v[152:155], v[144:147], v[96:99]
    ds_read_b128 v[216:219], v10 offset:192
    v_mfma_f32_16x16x32_bf16 v[100:103], v[156:159], v[144:147], v[100:103]
    s_waitcnt lgkmcnt(9)
    v_mfma_f32_16x16x32_bf16 v[116:119], v[156:159], v[148:151], v[116:119]
    v_mfma_f32_16x16x32_bf16 v[112:115], v[152:155], v[148:151], v[112:115]
    s_waitcnt vmcnt(12)
    v_mfma_f32_16x16x32_bf16 v[40:43], v[128:131], v[160:163], v[40:43]
    s_waitcnt lgkmcnt(0)
    v_fma_f32 v64, -v16, v212, v64
    v_fma_f32 v65, -v16, v213, v65
    v_mfma_f32_16x16x32_bf16 v[44:47], v[128:131], v[164:167], v[44:47]
    v_fma_f32 v66, -v16, v214, v66
    v_mfma_f32_16x16x32_bf16 v[60:63], v[132:135], v[164:167], v[60:63]
    ds_read_b64_tr_b16 v[128:129], v24 offset:2048
    v_fma_f32 v67, -v16, v215, v67
    v_mfma_f32_16x16x32_bf16 v[56:59], v[132:135], v[160:163], v[56:59]
    ds_read_b64_tr_b16 v[130:131], v24 offset:2560
    v_fma_f32 v68, -v18, v212, v68
    v_fma_f32 v69, -v18, v213, v69
    v_mfma_f32_16x16x32_bf16 v[72:75], v[136:139], v[160:163], v[72:75]
    ds_read_b64_tr_b16 v[132:133], v25 offset:2048
    v_fma_f32 v70, -v18, v214, v70
    v_mfma_f32_16x16x32_bf16 v[76:79], v[136:139], v[164:167], v[76:79]
    ds_read_b64_tr_b16 v[134:135], v25 offset:2560
    v_fma_f32 v71, -v18, v215, v71
    v_mfma_f32_16x16x32_bf16 v[92:95], v[140:143], v[164:167], v[92:95]
    ds_read_b64_tr_b16 v[136:137], v24 offset:10240
    v_fma_f32 v80, -v16, v216, v80
    v_fma_f32 v81, -v16, v217, v81
    v_mfma_f32_16x16x32_bf16 v[88:91], v[140:143], v[160:163], v[88:91]
    ds_read_b64_tr_b16 v[138:139], v24 offset:10752
    v_fma_f32 v82, -v16, v218, v82
    v_mfma_f32_16x16x32_bf16 v[104:107], v[160:163], v[144:147], v[104:107]
    ds_read_b64_tr_b16 v[140:141], v25 offset:10240
    v_fma_f32 v83, -v16, v219, v83
    v_mfma_f32_16x16x32_bf16 v[108:111], v[164:167], v[144:147], v[108:111]
    ds_read_b64_tr_b16 v[142:143], v25 offset:10752
    v_fma_f32 v84, -v18, v216, v84
    v_fma_f32 v85, -v18, v217, v85
    v_mfma_f32_16x16x32_bf16 v[124:127], v[164:167], v[148:151], v[124:127]
    ds_read_b64_tr_b16 v[144:145], v24 offset:18432
    v_fma_f32 v86, -v18, v218, v86
    v_mfma_f32_16x16x32_bf16 v[120:123], v[160:163], v[148:151], v[120:123]
    ds_read_b64_tr_b16 v[146:147], v24 offset:18944
    v_fma_f32 v87, -v18, v219, v87
    s_waitcnt vmcnt(10) lgkmcnt(8)
    v_mfma_f32_16x16x32_bf16 v[184:187], v[188:191], v[192:195], v[184:187]
    v_mfma_f32_16x16x32_bf16 v[32:35], v[128:131], v[168:171], v[32:35]
    ds_read_b64_tr_b16 v[148:149], v25 offset:18432
    v_fma_f32 v72, -v20, v212, v72
    v_fma_f32 v73, -v20, v213, v73
    v_mfma_f32_16x16x32_bf16 v[36:39], v[128:131], v[172:175], v[36:39]
    ds_read_b64_tr_b16 v[150:151], v25 offset:18944
    v_fma_f32 v74, -v20, v214, v74
    s_waitcnt lgkmcnt(8)
    v_mfma_f32_16x16x32_bf16 v[52:55], v[132:135], v[172:175], v[52:55]
    v_fma_f32 v75, -v20, v215, v75
    ds_read_b128 v[152:155], v10 offset:0
    v_mfma_f32_16x16x32_bf16 v[48:51], v[132:135], v[168:171], v[48:51]
    ds_read_b64_tr_b16 v[188:189], v28 offset:2048
    v_fma_f32 v76, -v22, v212, v76
    v_fma_f32 v77, -v22, v213, v77
    ds_read_b128 v[156:159], v10 offset:64
    s_waitcnt lgkmcnt(9)
    v_mfma_f32_16x16x32_bf16 v[64:67], v[136:139], v[168:171], v[64:67]
    v_fma_f32 v78, -v22, v214, v78
    ds_read_b32 v17, v8 offset:2816
    v_mfma_f32_16x16x32_bf16 v[68:71], v[136:139], v[172:175], v[68:71]
    ds_read_b64_tr_b16 v[190:191], v28 offset:2560
    v_fma_f32 v79, -v22, v215, v79
    s_waitcnt lgkmcnt(9)
    v_mfma_f32_16x16x32_bf16 v[84:87], v[140:143], v[172:175], v[84:87]
    v_fma_f32 v88, -v20, v216, v88
    v_fma_f32 v89, -v20, v217, v89
    ds_read_b32 v19, v8 offset:2880
    v_mfma_f32_16x16x32_bf16 v[80:83], v[140:143], v[168:171], v[80:83]
    ds_read_b128 v[192:195], v30 offset:1024
    v_fma_f32 v90, -v20, v218, v90
    ds_read_b32 v21, v8 offset:2944
    s_waitcnt lgkmcnt(10)
    v_mfma_f32_16x16x32_bf16 v[96:99], v[168:171], v[144:147], v[96:99]
    v_fma_f32 v91, -v20, v219, v91
    ds_read_b32 v23, v8 offset:3008
    v_mfma_f32_16x16x32_bf16 v[100:103], v[172:175], v[144:147], v[100:103]
    v_fma_f32 v92, -v22, v216, v92
    v_fma_f32 v93, -v22, v217, v93
    s_waitcnt lgkmcnt(9)
    v_mfma_f32_16x16x32_bf16 v[116:119], v[172:175], v[148:151], v[116:119]
    v_fma_f32 v94, -v22, v218, v94
    v_mfma_f32_16x16x32_bf16 v[112:115], v[168:171], v[148:151], v[112:115]
    v_fma_f32 v95, -v22, v219, v95
    s_waitcnt vmcnt(8)
    v_mfma_f32_16x16x32_bf16 v[40:43], v[128:131], v[176:179], v[40:43]
    s_waitcnt lgkmcnt(0)
    v_fma_f32 v32, -v16, v152, v32
    v_fma_f32 v33, -v16, v153, v33
    v_mfma_f32_16x16x32_bf16 v[44:47], v[128:131], v[180:183], v[44:47]
    v_fma_f32 v34, -v16, v154, v34
    v_mfma_f32_16x16x32_bf16 v[60:63], v[132:135], v[180:183], v[60:63]
    ds_read_b64_tr_b16 v[128:129], v24 offset:4096
    v_fma_f32 v35, -v16, v155, v35
    v_fma_f32 v36, -v18, v152, v36
    v_mfma_f32_16x16x32_bf16 v[56:59], v[132:135], v[176:179], v[56:59]
    ds_read_b64_tr_b16 v[130:131], v24 offset:4608
    v_fma_f32 v37, -v18, v153, v37
    v_mfma_f32_16x16x32_bf16 v[72:75], v[136:139], v[176:179], v[72:75]
    ds_read_b64_tr_b16 v[132:133], v25 offset:4096
    v_fma_f32 v38, -v18, v154, v38
    v_fma_f32 v39, -v18, v155, v39
    v_mfma_f32_16x16x32_bf16 v[76:79], v[136:139], v[180:183], v[76:79]
    ds_read_b64_tr_b16 v[134:135], v25 offset:4608
    v_fma_f32 v48, -v16, v156, v48
    v_mfma_f32_16x16x32_bf16 v[92:95], v[140:143], v[180:183], v[92:95]
    ds_read_b64_tr_b16 v[136:137], v24 offset:12288
    v_fma_f32 v49, -v16, v157, v49
    v_fma_f32 v50, -v16, v158, v50
    v_mfma_f32_16x16x32_bf16 v[88:91], v[140:143], v[176:179], v[88:91]
    ds_read_b64_tr_b16 v[138:139], v24 offset:12800
    v_fma_f32 v51, -v16, v159, v51
    v_mfma_f32_16x16x32_bf16 v[104:107], v[176:179], v[144:147], v[104:107]
    ds_read_b64_tr_b16 v[140:141], v25 offset:12288
    v_fma_f32 v52, -v18, v156, v52
    v_fma_f32 v53, -v18, v157, v53
    v_mfma_f32_16x16x32_bf16 v[108:111], v[180:183], v[144:147], v[108:111]
    ds_read_b64_tr_b16 v[142:143], v25 offset:12800
    v_fma_f32 v54, -v18, v158, v54
    v_mfma_f32_16x16x32_bf16 v[124:127], v[180:183], v[148:151], v[124:127]
    ds_read_b64_tr_b16 v[144:145], v24 offset:20480
    v_fma_f32 v55, -v18, v159, v55
    v_mfma_f32_16x16x32_bf16 v[120:123], v[176:179], v[148:151], v[120:123]
    ds_read_b64_tr_b16 v[146:147], v24 offset:20992
    s_waitcnt vmcnt(6) lgkmcnt(8)
    v_mfma_f32_16x16x32_bf16 v[184:187], v[188:191], v[192:195], v[184:187]
    v_mfma_f32_16x16x32_bf16 v[32:35], v[128:131], a[0:3], v[32:35]
    ds_read_b64_tr_b16 v[148:149], v25 offset:20480
    v_fma_f32 v40, -v20, v152, v40
    v_fma_f32 v41, -v20, v153, v41
    v_mfma_f32_16x16x32_bf16 v[36:39], v[128:131], a[4:7], v[36:39]
    ds_read_b64_tr_b16 v[150:151], v25 offset:20992
    v_fma_f32 v42, -v20, v154, v42
    s_waitcnt lgkmcnt(8)
    v_mfma_f32_16x16x32_bf16 v[52:55], v[132:135], a[4:7], v[52:55]
    v_fma_f32 v43, -v20, v155, v43
    v_fma_f32 v44, -v22, v152, v44
    ds_read_b128 v[168:171], v9 offset:1280
    v_mfma_f32_16x16x32_bf16 v[48:51], v[132:135], a[0:3], v[48:51]
    ds_read_b64_tr_b16 v[188:189], v28 offset:4096
    v_fma_f32 v45, -v22, v153, v45
    ds_read_b128 v[172:175], v9 offset:1344
    s_waitcnt lgkmcnt(9)
    v_mfma_f32_16x16x32_bf16 v[64:67], v[136:139], a[0:3], v[64:67]
    v_fma_f32 v46, -v22, v154, v46
    v_fma_f32 v47, -v22, v155, v47
    v_mfma_f32_16x16x32_bf16 v[68:71], v[136:139], a[4:7], v[68:71]
    ds_read_b64_tr_b16 v[190:191], v28 offset:4608
    v_fma_f32 v56, -v20, v156, v56
    ds_read_b128 v[176:179], v9 offset:1408
    s_waitcnt lgkmcnt(9)
    v_mfma_f32_16x16x32_bf16 v[84:87], v[140:143], a[4:7], v[84:87]
    v_fma_f32 v57, -v20, v157, v57
    v_fma_f32 v58, -v20, v158, v58
    ds_read_b128 v[180:183], v9 offset:1472
    v_mfma_f32_16x16x32_bf16 v[80:83], v[140:143], a[0:3], v[80:83]
    ds_read_b128 v[192:195], v30 offset:2048
    v_fma_f32 v59, -v20, v159, v59
    s_waitcnt lgkmcnt(9)
    v_mfma_f32_16x16x32_bf16 v[96:99], a[0:3], v[144:147], v[96:99]
    v_fma_f32 v60, -v22, v156, v60
    v_fma_f32 v61, -v22, v157, v61
    ds_read2_b32 v[220:221], v11 offset0:64 offset1:80
    v_mfma_f32_16x16x32_bf16 v[100:103], a[4:7], v[144:147], v[100:103]
    v_fma_f32 v62, -v22, v158, v62
    s_waitcnt lgkmcnt(8)
    v_mfma_f32_16x16x32_bf16 v[116:119], a[4:7], v[148:151], v[116:119]
    v_fma_f32 v63, -v22, v159, v63
    v_mfma_f32_16x16x32_bf16 v[112:115], a[0:3], v[148:151], v[112:115]
    s_waitcnt vmcnt(4)
    v_mfma_f32_16x16x32_bf16 v[40:43], v[128:131], a[8:11], v[40:43]
    v_mfma_f32_16x16x32_bf16 v[44:47], v[128:131], a[12:15], v[44:47]
    s_waitcnt lgkmcnt(0)
    v_fma_f32 v96, -v168, v220, v96
    v_fma_f32 v97, -v169, v220, v97
    v_mfma_f32_16x16x32_bf16 v[60:63], v[132:135], a[12:15], v[60:63]
    ds_read_b64_tr_b16 v[128:129], v24 offset:6144
    v_fma_f32 v98, -v170, v220, v98
    v_mfma_f32_16x16x32_bf16 v[56:59], v[132:135], a[8:11], v[56:59]
    ds_read_b64_tr_b16 v[130:131], v24 offset:6656
    v_fma_f32 v99, -v171, v220, v99
    v_fma_f32 v100, -v172, v220, v100
    v_mfma_f32_16x16x32_bf16 v[72:75], v[136:139], a[8:11], v[72:75]
    ds_read_b64_tr_b16 v[132:133], v25 offset:6144
    v_fma_f32 v101, -v173, v220, v101
    v_mfma_f32_16x16x32_bf16 v[76:79], v[136:139], a[12:15], v[76:79]
    ds_read_b64_tr_b16 v[134:135], v25 offset:6656
    v_fma_f32 v102, -v174, v220, v102
    v_fma_f32 v103, -v175, v220, v103
    v_mfma_f32_16x16x32_bf16 v[92:95], v[140:143], a[12:15], v[92:95]
    ds_read_b64_tr_b16 v[136:137], v24 offset:14336
    v_fma_f32 v112, -v168, v221, v112
    v_mfma_f32_16x16x32_bf16 v[88:91], v[140:143], a[8:11], v[88:91]
    ds_read_b64_tr_b16 v[138:139], v24 offset:14848
    v_fma_f32 v113, -v169, v221, v113
    v_fma_f32 v114, -v170, v221, v114
    v_mfma_f32_16x16x32_bf16 v[104:107], a[8:11], v[144:147], v[104:107]
    ds_read_b64_tr_b16 v[140:141], v25 offset:14336
    v_fma_f32 v115, -v171, v221, v115
    v_mfma_f32_16x16x32_bf16 v[108:111], a[12:15], v[144:147], v[108:111]
    ds_read_b64_tr_b16 v[142:143], v25 offset:14848
    v_fma_f32 v116, -v172, v221, v116
    v_fma_f32 v117, -v173, v221, v117
    v_mfma_f32_16x16x32_bf16 v[124:127], a[12:15], v[148:151], v[124:127]
    ds_read_b64_tr_b16 v[144:145], v24 offset:22528
    v_fma_f32 v118, -v174, v221, v118
    v_mfma_f32_16x16x32_bf16 v[120:123], a[8:11], v[148:151], v[120:123]
    ds_read_b64_tr_b16 v[146:147], v24 offset:23040
    v_fma_f32 v119, -v175, v221, v119
    s_waitcnt vmcnt(2) lgkmcnt(8)
    v_mfma_f32_16x16x32_bf16 v[184:187], v[188:191], v[192:195], v[184:187]
    v_mfma_f32_16x16x32_bf16 v[32:35], v[128:131], a[16:19], v[32:35]
    ds_read_b64_tr_b16 v[148:149], v25 offset:22528
    v_mfma_f32_16x16x32_bf16 v[36:39], v[128:131], a[20:23], v[36:39]
    ds_read_b64_tr_b16 v[150:151], v25 offset:23040
    v_fma_f32 v104, -v176, v220, v104
    v_fma_f32 v105, -v177, v220, v105
    s_waitcnt lgkmcnt(8)
    v_mfma_f32_16x16x32_bf16 v[52:55], v[132:135], a[20:23], v[52:55]
    v_fma_f32 v106, -v178, v220, v106
    ds_read_b128 v[152:155], v9 offset:2816
    v_mfma_f32_16x16x32_bf16 v[48:51], v[132:135], a[16:19], v[48:51]
    ds_read_b64_tr_b16 v[188:189], v28 offset:6144
    v_fma_f32 v107, -v179, v220, v107
    v_fma_f32 v108, -v180, v220, v108
    ds_read_b128 v[156:159], v9 offset:2880
    s_waitcnt lgkmcnt(9)
    v_mfma_f32_16x16x32_bf16 v[64:67], v[136:139], a[16:19], v[64:67]
    v_fma_f32 v109, -v181, v220, v109
    ds_read_b128 v[160:163], v9 offset:2944
    v_mfma_f32_16x16x32_bf16 v[68:71], v[136:139], a[20:23], v[68:71]
    ds_read_b64_tr_b16 v[190:191], v28 offset:6656
    v_fma_f32 v110, -v182, v220, v110
    v_fma_f32 v111, -v183, v220, v111
    ds_read_b128 v[164:167], v9 offset:3008
    s_waitcnt lgkmcnt(10)
    v_mfma_f32_16x16x32_bf16 v[84:87], v[140:143], a[20:23], v[84:87]
    v_fma_f32 v120, -v176, v221, v120
    ds_read_b128 v[212:215], v14 offset:128
    v_mfma_f32_16x16x32_bf16 v[80:83], v[140:143], a[16:19], v[80:83]
    ds_read_b128 v[192:195], v30 offset:3072
    v_fma_f32 v121, -v177, v221, v121
    v_fma_f32 v122, -v178, v221, v122
    ds_read_b32 v222, v11 offset:1216
    s_waitcnt lgkmcnt(11)
    v_mfma_f32_16x16x32_bf16 v[96:99], a[16:19], v[144:147], v[96:99]
    v_fma_f32 v123, -v179, v221, v123
    ds_read_b32 v223, v11 offset:2752
    v_mfma_f32_16x16x32_bf16 v[100:103], a[20:23], v[144:147], v[100:103]
    v_fma_f32 v124, -v180, v221, v124
    v_fma_f32 v125, -v181, v221, v125
    s_waitcnt lgkmcnt(10)
    v_mfma_f32_16x16x32_bf16 v[116:119], a[20:23], v[148:151], v[116:119]
    v_fma_f32 v126, -v182, v221, v126
    s_waitcnt lgkmcnt(2)
    v_mfma_f32_16x16x32_bf16 v[112:115], a[16:19], v[148:151], v[112:115]
    v_fma_f32 v127, -v183, v221, v127
    s_barrier
    s_waitcnt vmcnt(0)
    v_mfma_f32_16x16x32_bf16 v[40:43], v[128:131], a[24:27], v[40:43]
    v_mul_f32 v64, v17, v64
    v_mul_f32 v65, v17, v65
    v_mfma_f32_16x16x32_bf16 v[44:47], v[128:131], a[28:31], v[44:47]
    v_mul_f32 v66, v17, v66
    v_mul_f32 v67, v17, v67
    v_mfma_f32_16x16x32_bf16 v[60:63], v[132:135], a[28:31], v[60:63]
    v_mul_f32 v80, v17, v80
    v_mul_f32 v81, v17, v81
    v_mfma_f32_16x16x32_bf16 v[56:59], v[132:135], a[24:27], v[56:59]
    v_mul_f32 v82, v17, v82
    v_mul_f32 v83, v17, v83
    v_mfma_f32_16x16x32_bf16 v[72:75], v[136:139], a[24:27], v[72:75]
    v_cvt_pk_bf16_f32 v64, v64, v65
    v_cvt_pk_bf16_f32 v65, v66, v67
    v_mfma_f32_16x16x32_bf16 v[76:79], v[136:139], a[28:31], v[76:79]
    v_cvt_pk_bf16_f32 v66, v80, v81
    v_cvt_pk_bf16_f32 v67, v82, v83
    v_mfma_f32_16x16x32_bf16 v[92:95], v[140:143], a[28:31], v[92:95]
    v_mul_f32 v68, v19, v68
    v_mul_f32 v69, v19, v69
    v_mfma_f32_16x16x32_bf16 v[88:91], v[140:143], a[24:27], v[88:91]
    v_mul_f32 v70, v19, v70
    v_mul_f32 v71, v19, v71
    v_mfma_f32_16x16x32_bf16 v[104:107], a[24:27], v[144:147], v[104:107]
    v_mul_f32 v84, v19, v84
    v_mul_f32 v85, v19, v85
    v_mfma_f32_16x16x32_bf16 v[108:111], a[28:31], v[144:147], v[108:111]
    v_mul_f32 v86, v19, v86
    v_mul_f32 v87, v19, v87
    v_mfma_f32_16x16x32_bf16 v[124:127], a[28:31], v[148:151], v[124:127]
    v_cvt_pk_bf16_f32 v68, v68, v69
    v_cvt_pk_bf16_f32 v69, v70, v71
    v_mfma_f32_16x16x32_bf16 v[120:123], a[24:27], v[148:151], v[120:123]
    v_cvt_pk_bf16_f32 v70, v84, v85
    v_cvt_pk_bf16_f32 v71, v86, v87
    v_mfma_f32_16x16x32_bf16 v[184:187], v[188:191], v[192:195], v[184:187]
    v_pk_mul_f32 v[72:73], v[20:21], v[72:73] op_sel:[1,0] op_sel_hi:[1,1]
    v_pk_mul_f32 v[74:75], v[20:21], v[74:75] op_sel:[1,0] op_sel_hi:[1,1]
    v_pk_mul_f32 v[88:89], v[20:21], v[88:89] op_sel:[1,0] op_sel_hi:[1,1]
    v_pk_mul_f32 v[90:91], v[20:21], v[90:91] op_sel:[1,0] op_sel_hi:[1,1]
    v_cvt_pk_bf16_f32 v72, v72, v73
    v_cvt_pk_bf16_f32 v73, v74, v75
    v_cvt_pk_bf16_f32 v74, v88, v89
    v_cvt_pk_bf16_f32 v75, v90, v91
    v_pk_mul_f32 v[76:77], v[22:23], v[76:77] op_sel:[1,0] op_sel_hi:[1,1]
    v_pk_mul_f32 v[78:79], v[22:23], v[78:79] op_sel:[1,0] op_sel_hi:[1,1]
    v_pk_mul_f32 v[92:93], v[22:23], v[92:93] op_sel:[1,0] op_sel_hi:[1,1]
    v_pk_mul_f32 v[94:95], v[22:23], v[94:95] op_sel:[1,0] op_sel_hi:[1,1]
    v_cvt_pk_bf16_f32 v76, v76, v77
    v_cvt_pk_bf16_f32 v77, v78, v79
    v_cvt_pk_bf16_f32 v78, v92, v93
    v_cvt_pk_bf16_f32 v79, v94, v95
    ds_write_b128 v12, v[76:79] offset:2048
    s_waitcnt lgkmcnt(1)
    v_pk_mul_f32 v[96:97], v[152:153], v[96:97]
    v_pk_mul_f32 v[98:99], v[154:155], v[98:99]
    v_pk_mul_f32 v[112:113], v[152:153], v[112:113]
    v_pk_mul_f32 v[114:115], v[154:155], v[114:115]
    v_cvt_pk_bf16_f32 v99, v98, v99
    v_cvt_pk_bf16_f32 v98, v96, v97
    v_cvt_pk_bf16_f32 v115, v114, v115
    v_cvt_pk_bf16_f32 v114, v112, v113
    v_pk_mul_f32 v[100:101], v[156:157], v[100:101]
    v_pk_mul_f32 v[102:103], v[158:159], v[102:103]
    v_pk_mul_f32 v[116:117], v[156:157], v[116:117]
    v_pk_mul_f32 v[118:119], v[158:159], v[118:119]
    v_cvt_pk_bf16_f32 v100, v100, v101
    v_cvt_pk_bf16_f32 v101, v102, v103
    v_cvt_pk_bf16_f32 v116, v116, v117
    v_cvt_pk_bf16_f32 v117, v118, v119
    v_pk_mul_f32 v[104:105], v[160:161], v[104:105]
    v_pk_mul_f32 v[106:107], v[162:163], v[106:107]
    v_pk_mul_f32 v[120:121], v[160:161], v[120:121]
    v_pk_mul_f32 v[122:123], v[162:163], v[122:123]
    v_cvt_pk_bf16_f32 v102, v104, v105
    v_cvt_pk_bf16_f32 v103, v106, v107
    v_cvt_pk_bf16_f32 v118, v120, v121
    v_cvt_pk_bf16_f32 v119, v122, v123
    v_pk_mul_f32 v[108:109], v[164:165], v[108:109]
    v_pk_mul_f32 v[110:111], v[166:167], v[110:111]
    v_pk_mul_f32 v[124:125], v[164:165], v[124:125]
    v_pk_mul_f32 v[126:127], v[166:167], v[126:127]
    v_cvt_pk_bf16_f32 v104, v108, v109
    v_cvt_pk_bf16_f32 v105, v110, v111
    v_cvt_pk_bf16_f32 v120, v124, v125
    v_cvt_pk_bf16_f32 v121, v126, v127
    ds_write_b64 v12, v[104:105] offset:3072
    ds_write_b64 v12, v[120:121] offset:3080
    v_pk_fma_f32 v[184:185], v[222:223], v[212:213], v[184:185] op_sel_hi:[0,1,1] neg_lo:[1,0,0] neg_hi:[1,0,0]
    v_pk_fma_f32 v[186:187], v[222:223], v[214:215], v[186:187] op_sel_hi:[0,1,1] neg_lo:[1,0,0] neg_hi:[1,0,0]
    v_pk_mul_f32 v[184:185], v[222:223], v[184:185] op_sel:[1,0] op_sel_hi:[1,1]
    v_pk_mul_f32 v[186:187], v[222:223], v[186:187] op_sel:[1,0] op_sel_hi:[1,1]
    v_cvt_pk_bf16_f32 v184, v184, v185
    v_cvt_pk_bf16_f32 v185, v186, v187
    s_cmp_ge_u32 s8, 2
    s_cbranch_scc1 c_qkvA_hv
    ds_write_b64 v13, v[184:185]
    s_branch c_qkvA_hd
c_qkvA_hv:
    ds_write_b16 v13, v184 offset:0
    ds_write_b16_d16_hi v13, v184 offset:16
    ds_write_b16 v13, v185 offset:32
    ds_write_b16_d16_hi v13, v185 offset:48
c_qkvA_hd:
    v_cvt_pk_bf16_f32 v44, v44, v45
    v_cvt_pk_bf16_f32 v45, v46, v47
    v_cvt_pk_bf16_f32 v46, v60, v61
    v_cvt_pk_bf16_f32 v47, v62, v63
    v_mul_f32 v23, 0x3e8293ee, v23
    v_cvt_pk_bf16_f32 v40, v40, v41
    v_mfma_f32_16x16x32_bf16 v[156:159], v[76:79], v[44:47], v[196:199]
    v_cvt_pk_bf16_f32 v41, v42, v43
    v_cvt_pk_bf16_f32 v42, v56, v57
    v_mfma_f32_16x16x32_bf16 v[152:155], v[72:75], v[44:47], v[200:203]
    v_cvt_pk_bf16_f32 v43, v58, v59
    v_mul_f32 v21, 0x3e8293ee, v21
    s_waitcnt lgkmcnt(0)
    s_barrier
    ds_read_b128 v[172:175], v12
    ds_read_b64 v[96:97], v12 offset:1024
    ds_read_b64 v[112:113], v12 offset:1032
    v_mfma_f32_16x16x32_bf16 v[148:151], v[72:75], v[40:43], v[196:199]
    v_cvt_pk_bf16_f32 v36, v36, v37
    v_cvt_pk_bf16_f32 v37, v38, v39
    v_mfma_f32_16x16x32_bf16 v[144:147], v[68:71], v[40:43], v[200:203]
    v_cvt_pk_bf16_f32 v38, v52, v53
    v_cvt_pk_bf16_f32 v39, v54, v55
    v_mul_f32 v19, 0x3e8293ee, v19
    v_cvt_pk_bf16_f32 v32, v32, v33
    v_mfma_f32_16x16x32_bf16 v[140:143], v[68:71], v[36:39], v[196:199]
    v_cvt_pk_bf16_f32 v33, v34, v35
    v_cvt_pk_bf16_f32 v34, v48, v49
    v_mfma_f32_16x16x32_bf16 v[136:139], v[64:67], v[36:39], v[200:203]
    v_cvt_pk_bf16_f32 v35, v50, v51
    v_mul_f32 v17, 0x3e8293ee, v17
    v_max3_f32 v179, v152, v153, v154
    s_waitcnt lgkmcnt(2)
    v_mfma_f32_16x16x32_bf16 v[132:135], v[64:67], v[32:35], v[196:199]
    v_max3_f32 v179, v179, v155, v156
    v_max3_f32 v179, v179, v157, v158
    v_mfma_f32_16x16x32_bf16 v[128:131], v[172:175], v[32:35], v[204:207]
    v_max_f32 v179, v179, v159
    v_mov_b32 v183, v179
    v_max3_f32 v178, v144, v145, v146
    v_max3_f32 v178, v178, v147, v148
    v_max3_f32 v178, v178, v149, v150
    v_max_f32 v178, v178, v151
    v_mov_b32 v182, v178
    v_max3_f32 v177, v136, v137, v138
    v_max3_f32 v177, v177, v139, v140
    v_max3_f32 v177, v177, v141, v142
    v_max_f32 v177, v177, v143
    v_mov_b32 v181, v177
    v_permlane32_swap_b32 v179, v183
    v_permlane32_swap_b32 v178, v182
    v_permlane32_swap_b32 v177, v181
    v_max3_f32 v176, v128, v129, v130
    v_max3_f32 v176, v176, v131, v132
    v_max3_f32 v176, v176, v133, v134
    v_max_f32 v176, v176, v135
    v_mov_b32 v180, v176
    v_max_f32 v179, v179, v183
    v_max_f32 v178, v178, v182
    v_max_f32 v177, v177, v181
    v_permlane32_swap_b32 v176, v180
    v_mov_b32 v183, v179
    v_mov_b32 v182, v178
    v_mov_b32 v181, v177
    v_max_f32 v176, v176, v180
    v_mov_b32 v180, v176
    v_permlane16_swap_b32 v179, v183
    v_permlane16_swap_b32 v178, v182
    v_permlane16_swap_b32 v177, v181
    v_permlane16_swap_b32 v176, v180
    v_max_f32 v179, v179, v183
    v_max_f32 v178, v178, v182
    v_max_f32 v177, v177, v181
    v_max_f32 v176, v176, v180
    v_mul_f32_e64 v22, -v179, v23
    v_mul_f32_e64 v20, -v178, v21
    v_mul_f32_e64 v18, -v177, v19
    v_mul_f32_e64 v16, -v176, v17
    s_waitcnt lgkmcnt(0)
    s_add_u32 s51, s49, 65536
    v_pk_fma_f32 v[152:153], v[152:153], v[22:23], v[22:23] op_sel:[0,1,0] op_sel_hi:[1,1,0]
    v_pk_fma_f32 v[154:155], v[154:155], v[22:23], v[22:23] op_sel:[0,1,0] op_sel_hi:[1,1,0]
    v_pk_fma_f32 v[156:157], v[156:157], v[22:23], v[22:23] op_sel:[0,1,0] op_sel_hi:[1,1,0]
    v_pk_fma_f32 v[158:159], v[158:159], v[22:23], v[22:23] op_sel:[0,1,0] op_sel_hi:[1,1,0]
    v_pk_fma_f32 v[144:145], v[144:145], v[20:21], v[20:21] op_sel:[0,1,0] op_sel_hi:[1,1,0]
    v_pk_fma_f32 v[146:147], v[146:147], v[20:21], v[20:21] op_sel:[0,1,0] op_sel_hi:[1,1,0]
    v_pk_fma_f32 v[148:149], v[148:149], v[20:21], v[20:21] op_sel:[0,1,0] op_sel_hi:[1,1,0]
    v_pk_fma_f32 v[150:151], v[150:151], v[20:21], v[20:21] op_sel:[0,1,0] op_sel_hi:[1,1,0]
    v_pk_fma_f32 v[136:137], v[136:137], v[18:19], v[18:19] op_sel:[0,1,0] op_sel_hi:[1,1,0]
    v_pk_fma_f32 v[138:139], v[138:139], v[18:19], v[18:19] op_sel:[0,1,0] op_sel_hi:[1,1,0]
    v_pk_fma_f32 v[140:141], v[140:141], v[18:19], v[18:19] op_sel:[0,1,0] op_sel_hi:[1,1,0]
    v_pk_fma_f32 v[142:143], v[142:143], v[18:19], v[18:19] op_sel:[0,1,0] op_sel_hi:[1,1,0]
    v_pk_fma_f32 v[128:129], v[128:129], v[16:17], v[16:17] op_sel:[0,1,0] op_sel_hi:[1,1,0]
    v_pk_fma_f32 v[130:131], v[130:131], v[16:17], v[16:17] op_sel:[0,1,0] op_sel_hi:[1,1,0]
    v_pk_fma_f32 v[132:133], v[132:133], v[16:17], v[16:17] op_sel:[0,1,0] op_sel_hi:[1,1,0]
    v_pk_fma_f32 v[134:135], v[134:135], v[16:17], v[16:17] op_sel:[0,1,0] op_sel_hi:[1,1,0]
    v_exp_f32 v152, v152
    v_exp_f32 v153, v153
    v_exp_f32 v154, v154
    v_exp_f32 v155, v155
    v_exp_f32 v156, v156
    v_exp_f32 v157, v157
    v_exp_f32 v158, v158
    v_exp_f32 v159, v159
    v_cvt_pk_bf16_f32 v172, v152, v153
    v_cvt_pk_bf16_f32 v173, v154, v155
    v_cvt_pk_bf16_f32 v174, v156, v157
    v_cvt_pk_bf16_f32 v175, v158, v159
    v_exp_f32 v144, v144
    v_exp_f32 v145, v145
    v_mfma_f32_16x16x32_bf16 v[92:95], v[208:211], v[172:175], 0
    v_exp_f32 v146, v146
    v_mfma_f32_16x16x32_bf16 v[60:63], v[102:105], v[172:175], 0
    v_exp_f32 v147, v147
    v_mfma_f32_16x16x32_bf16 v[76:79], v[118:121], v[172:175], 0
    v_exp_f32 v148, v148
    v_exp_f32 v149, v149
    v_exp_f32 v150, v150
    v_exp_f32 v151, v151
    v_rcp_f32 v92, v92
    v_cvt_pk_bf16_f32 v168, v144, v145
    v_cvt_pk_bf16_f32 v169, v146, v147
    v_cvt_pk_bf16_f32 v170, v148, v149
    v_cvt_pk_bf16_f32 v171, v150, v151
    v_pk_mul_f32 v[60:61], v[92:93], v[60:61] op_sel_hi:[0,1]
    v_pk_mul_f32 v[62:63], v[92:93], v[62:63] op_sel_hi:[0,1]
    v_pk_mul_f32 v[76:77], v[92:93], v[76:77] op_sel_hi:[0,1]
    v_pk_mul_f32 v[78:79], v[92:93], v[78:79] op_sel_hi:[0,1]
    v_cvt_pk_bf16_f32 v60, v60, v61
    v_cvt_pk_bf16_f32 v61, v62, v63
    v_cvt_pk_bf16_f32 v62, v76, v77
    v_cvt_pk_bf16_f32 v63, v78, v79
    buffer_store_dwordx4 v[60:63], v6, s[12:15], s51 offen offset:256 sc1
    v_exp_f32 v136, v136
    v_exp_f32 v137, v137
    v_mfma_f32_16x16x32_bf16 v[88:91], v[208:211], v[168:171], 0
    v_exp_f32 v138, v138
    v_mfma_f32_16x16x32_bf16 v[56:59], v[100:103], v[168:171], 0
    v_exp_f32 v139, v139
    v_mfma_f32_16x16x32_bf16 v[72:75], v[116:119], v[168:171], 0
    v_exp_f32 v140, v140
    v_exp_f32 v141, v141
    v_exp_f32 v142, v142
    v_exp_f32 v143, v143
    v_rcp_f32 v88, v88
    v_cvt_pk_bf16_f32 v164, v136, v137
    v_cvt_pk_bf16_f32 v165, v138, v139
    v_cvt_pk_bf16_f32 v166, v140, v141
    v_cvt_pk_bf16_f32 v167, v142, v143
    v_pk_mul_f32 v[56:57], v[88:89], v[56:57] op_sel_hi:[0,1]
    v_pk_mul_f32 v[58:59], v[88:89], v[58:59] op_sel_hi:[0,1]
    v_pk_mul_f32 v[72:73], v[88:89], v[72:73] op_sel_hi:[0,1]
    v_pk_mul_f32 v[74:75], v[88:89], v[74:75] op_sel_hi:[0,1]
    v_cvt_pk_bf16_f32 v56, v56, v57
    v_cvt_pk_bf16_f32 v57, v58, v59
    v_cvt_pk_bf16_f32 v58, v72, v73
    v_cvt_pk_bf16_f32 v59, v74, v75
    buffer_store_dwordx4 v[56:59], v6, s[12:15], s51 offen offset:0 sc1
    v_exp_f32 v128, v128
    v_exp_f32 v129, v129
    v_mfma_f32_16x16x32_bf16 v[84:87], v[208:211], v[164:167], 0
    v_exp_f32 v130, v130
    v_mfma_f32_16x16x32_bf16 v[52:55], v[98:101], v[164:167], 0
    v_exp_f32 v131, v131
    v_mfma_f32_16x16x32_bf16 v[68:71], v[114:117], v[164:167], 0
    v_exp_f32 v132, v132
    v_exp_f32 v133, v133
    v_exp_f32 v134, v134
    v_exp_f32 v135, v135
    v_rcp_f32 v84, v84
    v_cvt_pk_bf16_f32 v160, v128, v129
    v_cvt_pk_bf16_f32 v161, v130, v131
    v_cvt_pk_bf16_f32 v162, v132, v133
    v_cvt_pk_bf16_f32 v163, v134, v135
    v_pk_mul_f32 v[52:53], v[84:85], v[52:53] op_sel_hi:[0,1]
    v_pk_mul_f32 v[54:55], v[84:85], v[54:55] op_sel_hi:[0,1]
    v_mfma_f32_16x16x32_bf16 v[80:83], v[208:211], v[160:163], 0
    v_pk_mul_f32 v[68:69], v[84:85], v[68:69] op_sel_hi:[0,1]
    v_pk_mul_f32 v[70:71], v[84:85], v[70:71] op_sel_hi:[0,1]
    v_mfma_f32_16x16x32_bf16 v[48:51], v[96:99], v[160:163], 0
    v_cvt_pk_bf16_f32 v52, v52, v53
    v_cvt_pk_bf16_f32 v53, v54, v55
    v_mfma_f32_16x16x32_bf16 v[64:67], v[112:115], v[160:163], 0
    v_cvt_pk_bf16_f32 v54, v68, v69
    v_cvt_pk_bf16_f32 v55, v70, v71
    buffer_store_dwordx4 v[52:55], v6, s[12:15], s49 offen offset:256 sc1
    v_rcp_f32 v80, v80
    s_nop 0
    v_pk_mul_f32 v[48:49], v[80:81], v[48:49] op_sel_hi:[0,1]
    v_pk_mul_f32 v[50:51], v[80:81], v[50:51] op_sel_hi:[0,1]
    s_nop 0
    v_pk_mul_f32 v[64:65], v[80:81], v[64:65] op_sel_hi:[0,1]
    v_pk_mul_f32 v[66:67], v[80:81], v[66:67] op_sel_hi:[0,1]
    v_cvt_pk_bf16_f32 v48, v48, v49
    v_cvt_pk_bf16_f32 v49, v50, v51
    v_cvt_pk_bf16_f32 v50, v64, v65
    v_cvt_pk_bf16_f32 v51, v66, v67
    buffer_store_dwordx4 v[48:51], v6, s[12:15], s49 offen offset:0 sc1
    s_branch c_wo
.p2align 6
c_wo:
    v_and_b32 v1, 63, v0
    v_lshrrev_b32 v2, 6, v0
    v_lshlrev_b32 v5, 4, v1
    v_lshrrev_b32 v3, 5, v1
    s_lshl_b32 s48, s6, 2
    s_add_u32 s48, s48, s8
    s_lshl_b32 s55, s48, 16
    s_lshl_b32 s56, s9, 22
    s_add_u32 s55, s55, s56
    s_lshl_b32 s56, s7, 12
    s_add_u32 s58, s55, s56
    s_add_u32 s55, s55, 16777216
    s_add_u32 s16, s4, s55
    s_addc_u32 s17, s5, 0
    s_mov_b32 s18, 65536
    s_mov_b32 s19, 0x00020000
    s_lshl_b32 s60, s9, 2
    s_add_u32 s60, s60, 159504
    v_mov_b32 v28, s60
    s_mul_i32 s55, s9, 786432
    s_add_u32 s55, s55, 65798144
    v_and_b32 v24, 63, v0
    s_and_b32 s56, s11, 0xe0
    v_lshrrev_b32 v25, 5, v24
    v_add_u32 v24, s56, v24
    v_and_b32 v24, 255, v24
    v_lshlrev_b32 v24, 10, v24
    v_lshl_add_u32 v24, v25, 8, v24
    s_bfe_u32 s56, s11, 0x20003
    s_and_b32 s57, s11, 7
    s_lshl_b32 s56, s56, 7
    s_lshl_b32 s57, s57, 2
    s_add_u32 s55, s55, s56
    s_add_u32 s55, s55, s57
    v_mov_b32 v25, 159488
    v_mov_b32 v26, 1
    v_mov_b32 v27, s10
    v_and_b32 v4, 15, v0
    v_lshrrev_b32 v16, 2, v4
    v_lshl_add_u32 v16, v3, 2, v16
    v_lshlrev_b32 v16, 7, v16
    v_bfe_u32 v17, v1, 4, 1
    v_lshl_add_u32 v16, v17, 5, v16
    v_and_b32 v17, 3, v4
    v_lshl_add_u32 v16, v17, 3, v16
    v_lshrrev_b32 v17, 3, v4
    v_lshlrev_b32 v18, 6, v17
    v_add_u32 v12, v16, v18
    v_sub_u32 v13, v16, v18
    ds_read_b32 v29, v28
    buffer_load_dwordx4 v[96:99], v5, s[12:15], s58 offen offset:0 sc1
    buffer_load_dwordx4 v[100:103], v5, s[12:15], s58 offen offset:1024 sc1
    buffer_load_dwordx4 v[104:107], v5, s[12:15], s58 offen offset:2048 sc1
    buffer_load_dwordx4 v[108:111], v5, s[12:15], s58 offen offset:3072 sc1
    s_waitcnt lgkmcnt(0)
    v_readfirstlane_b32 s60, v29
    s_lshr_b32 s51, s60, 2
    s_and_b32 s51, s51, s60
    s_and_b32 s51, s51, 3
    s_cmp_eq_u32 s51, 0
    s_cbranch_scc1 c_wo_late
    s_and_b32 s52, s51, 1
    s_xor_b32 s52, s52, 1
    s_lshl_b32 s50, s52, 15
    buffer_load_dwordx4 v[112:115], v5, s[16:19], s50 offen offset:0 sc1
    buffer_load_dwordx4 v[116:119], v5, s[16:19], s50 offen offset:1024 sc1
    buffer_load_dwordx4 v[120:123], v5, s[16:19], s50 offen offset:2048 sc1
    buffer_load_dwordx4 v[124:127], v5, s[16:19], s50 offen offset:3072 sc1
    s_add_u32 s50, s50, 4096
    buffer_load_dwordx4 v[128:131], v5, s[16:19], s50 offen offset:0 sc1
    s_mov_b64 exec, 1
    s_waitcnt vmcnt(9)
    ds_add_rtn_u32 v26, v25, v26
    s_waitcnt lgkmcnt(0)
    v_readfirstlane_b32 s56, v26
    s_and_b32 s56, s56, 3
    s_cmp_lg_u32 s56, 3
    s_cbranch_scc1 pub_2
    s_mov_b32 exec_lo, -1
    buffer_store_dword v27, v24, s[12:15], s55 offen sc1
pub_2:
    s_mov_b64 exec, -1
    s_branch c_wo_run
c_wo_late:
    s_mov_b64 exec, 1
    s_waitcnt vmcnt(4)
    ds_add_rtn_u32 v26, v25, v26
    s_waitcnt lgkmcnt(0)
    v_readfirstlane_b32 s56, v26
    s_and_b32 s56, s56, 3
    s_cmp_lg_u32 s56, 3
    s_cbranch_scc1 pub_3
    s_mov_b32 exec_lo, -1
    buffer_store_dword v27, v24, s[12:15], s55 offen sc1
pub_3:
    s_mov_b64 exec, -1
    s_branch wp_4_t
wp_4:
    ds_read_b32 v29, v28
    s_waitcnt lgkmcnt(0)
    v_readfirstlane_b32 s60, v29
    s_lshr_b32 s51, s60, 2
    s_and_b32 s51, s51, s60
    s_and_b32 s51, s51, 3
wp_4_t:
    s_cmp_lg_u32 s51, 0
    s_cbranch_scc0 wp_4
    s_and_b32 s52, s51, 1
    s_xor_b32 s52, s52, 1
    s_lshl_b32 s50, s52, 15
    buffer_load_dwordx4 v[112:115], v5, s[16:19], s50 offen offset:0 sc1
    buffer_load_dwordx4 v[116:119], v5, s[16:19], s50 offen offset:1024 sc1
    buffer_load_dwordx4 v[120:123], v5, s[16:19], s50 offen offset:2048 sc1
    buffer_load_dwordx4 v[124:127], v5, s[16:19], s50 offen offset:3072 sc1
    s_add_u32 s50, s50, 4096
    buffer_load_dwordx4 v[128:131], v5, s[16:19], s50 offen offset:0 sc1
c_wo_run:
    buffer_load_dwordx4 v[132:135], v5, s[16:19], s50 offen offset:1024 sc1
    buffer_load_dwordx4 v[136:139], v5, s[16:19], s50 offen offset:2048 sc1
    buffer_load_dwordx4 v[140:143], v5, s[16:19], s50 offen offset:3072 sc1
    s_add_u32 s50, s50, 4096
    s_lshl_b32 s3, s52, 16
    v_add_u32 v12, s3, v12
    v_add_u32 v13, s3, v13
    v_xor_b32 v14, 0x10000, v12
    v_xor_b32 v15, 0x10000, v13
    s_cmp_eq_u32 s52, 0
    s_mov_b32 s3, 0x0c0c0c0c
    s_cselect_b32 s53, 0x01000c0c, s3
    s_cselect_b32 s54, 0x03020c0c, s3
    s_cselect_b32 s59, s3, 0x01000c0c
    s_cselect_b32 s97, s3, 0x03020c0c
    s_branch wp_5_t
wp_5:
    ds_read_b32 v29, v28
    s_waitcnt lgkmcnt(0)
    v_readfirstlane_b32 s60, v29
    s_lshr_b32 s51, s60, 2
    s_and_b32 s51, s51, s60
    s_and_b32 s51, s51, 3
wp_5_t:
    s_cmp_ge_u32 s60, 0xf0
    s_cbranch_scc0 wp_5
    ds_read_b64_tr_b16 v[64:65], v12 offset:0
    ds_read_b64_tr_b16 v[66:67], v12 offset:1024
    ds_read_b64_tr_b16 v[68:69], v13 offset:64
    ds_read_b64_tr_b16 v[70:71], v13 offset:1088
    ds_read_b64_tr_b16 v[72:73], v12 offset:2048
    ds_read_b64_tr_b16 v[74:75], v12 offset:3072
    ds_read_b64_tr_b16 v[76:77], v13 offset:2112
    ds_read_b64_tr_b16 v[78:79], v13 offset:3136
    ds_read_b64_tr_b16 v[80:81], v12 offset:4096
    ds_read_b64_tr_b16 v[82:83], v12 offset:5120
    ds_read_b64_tr_b16 v[84:85], v13 offset:4160
    ds_read_b64_tr_b16 v[86:87], v13 offset:5184
    s_waitcnt vmcnt(8)
    v_perm_b32 v32, v96, v96, s53
    v_perm_b32 v33, v96, v96, s54
    v_perm_b32 v34, v97, v97, s53
    v_perm_b32 v35, v97, v97, s54
    v_perm_b32 v36, v98, v98, s53
    v_perm_b32 v37, v98, v98, s54
    v_perm_b32 v38, v99, v99, s53
    v_perm_b32 v39, v99, v99, s54
    v_perm_b32 v40, v100, v100, s53
    v_perm_b32 v41, v100, v100, s54
    v_perm_b32 v42, v101, v101, s53
    v_perm_b32 v43, v101, v101, s54
    v_perm_b32 v44, v102, v102, s53
    v_perm_b32 v45, v102, v102, s54
    v_perm_b32 v46, v103, v103, s53
    v_perm_b32 v47, v103, v103, s54
    v_perm_b32 v48, v104, v104, s53
    v_perm_b32 v49, v104, v104, s54
    v_perm_b32 v50, v105, v105, s53
    v_perm_b32 v51, v105, v105, s54
    v_perm_b32 v52, v106, v106, s53
    v_perm_b32 v53, v106, v106, s54
    v_perm_b32 v54, v107, v107, s53
    v_perm_b32 v55, v107, v107, s54
    v_perm_b32 v56, v108, v108, s53
    v_perm_b32 v57, v108, v108, s54
    v_perm_b32 v58, v109, v109, s53
    v_perm_b32 v59, v109, v109, s54
    v_perm_b32 v60, v110, v110, s53
    v_perm_b32 v61, v110, v110, s54
    v_perm_b32 v62, v111, v111, s53
    v_perm_b32 v63, v111, v111, s54
    buffer_load_dwordx4 v[144:147], v5, s[16:19], s50 offen offset:0 sc1
    buffer_load_dwordx4 v[148:151], v5, s[16:19], s50 offen offset:1024 sc1
    buffer_load_dwordx4 v[152:155], v5, s[16:19], s50 offen offset:2048 sc1
    buffer_load_dwordx4 v[156:159], v5, s[16:19], s50 offen offset:3072 sc1
    s_add_u32 s50, s50, 4096
    buffer_load_dwordx4 v[160:163], v5, s[16:19], s50 offen offset:0 sc1
    buffer_load_dwordx4 v[164:167], v5, s[16:19], s50 offen offset:1024 sc1
    buffer_load_dwordx4 v[168:171], v5, s[16:19], s50 offen offset:2048 sc1
    s_waitcnt vmcnt(14) lgkmcnt(8)
    v_mfma_f32_32x32x16_bf16 v[32:47], v[64:67], v[112:115], v[32:47]
    ds_read_b64_tr_b16 v[88:89], v12 offset:6144
    ds_read_b64_tr_b16 v[90:91], v12 offset:7168
    buffer_load_dwordx4 v[172:175], v5, s[16:19], s50 offen offset:3072 sc1
    s_add_u32 s50, s50, 4096
    v_perm_b32 v176, v96, v96, s59
    v_mfma_f32_32x32x16_bf16 v[48:63], v[68:71], v[112:115], v[48:63]
    ds_read_b64_tr_b16 v[92:93], v13 offset:6208
    ds_read_b64_tr_b16 v[94:95], v13 offset:7232
    v_perm_b32 v177, v96, v96, s97
    s_waitcnt vmcnt(14) lgkmcnt(8)
    v_mfma_f32_32x32x16_bf16 v[32:47], v[72:75], v[116:119], v[32:47]
    ds_read_b64_tr_b16 v[64:65], v12 offset:8192
    ds_read_b64_tr_b16 v[66:67], v12 offset:9216
    buffer_load_dwordx4 v[112:115], v5, s[16:19], s50 offen offset:0 sc1
    v_perm_b32 v178, v97, v97, s59
    v_mfma_f32_32x32x16_bf16 v[48:63], v[76:79], v[116:119], v[48:63]
    ds_read_b64_tr_b16 v[68:69], v13 offset:8256
    ds_read_b64_tr_b16 v[70:71], v13 offset:9280
    v_perm_b32 v179, v97, v97, s97
    s_waitcnt vmcnt(14) lgkmcnt(8)
    v_mfma_f32_32x32x16_bf16 v[32:47], v[80:83], v[120:123], v[32:47]
    ds_read_b64_tr_b16 v[72:73], v12 offset:10240
    ds_read_b64_tr_b16 v[74:75], v12 offset:11264
    buffer_load_dwordx4 v[116:119], v5, s[16:19], s50 offen offset:1024 sc1
    v_perm_b32 v180, v98, v98, s59
    v_mfma_f32_32x32x16_bf16 v[48:63], v[84:87], v[120:123], v[48:63]
    ds_read_b64_tr_b16 v[76:77], v13 offset:10304
    ds_read_b64_tr_b16 v[78:79], v13 offset:11328
    v_perm_b32 v181, v98, v98, s97
    s_waitcnt vmcnt(14) lgkmcnt(8)
    v_mfma_f32_32x32x16_bf16 v[32:47], v[88:91], v[124:127], v[32:47]
    ds_read_b64_tr_b16 v[80:81], v12 offset:12288
    ds_read_b64_tr_b16 v[82:83], v12 offset:13312
    buffer_load_dwordx4 v[120:123], v5, s[16:19], s50 offen offset:2048 sc1
    v_perm_b32 v182, v99, v99, s59
    v_mfma_f32_32x32x16_bf16 v[48:63], v[92:95], v[124:127], v[48:63]
    ds_read_b64_tr_b16 v[84:85], v13 offset:12352
    ds_read_b64_tr_b16 v[86:87], v13 offset:13376
    v_perm_b32 v183, v99, v99, s97
    s_waitcnt vmcnt(14) lgkmcnt(8)
    v_mfma_f32_32x32x16_bf16 v[32:47], v[64:67], v[128:131], v[32:47]
    ds_read_b64_tr_b16 v[88:89], v12 offset:14336
    ds_read_b64_tr_b16 v[90:91], v12 offset:15360
    buffer_load_dwordx4 v[124:127], v5, s[16:19], s50 offen offset:3072 sc1
    s_add_u32 s50, s50, 4096
    v_perm_b32 v184, v100, v100, s59
    v_mfma_f32_32x32x16_bf16 v[48:63], v[68:71], v[128:131], v[48:63]
    ds_read_b64_tr_b16 v[92:93], v13 offset:14400
    ds_read_b64_tr_b16 v[94:95], v13 offset:15424
    v_perm_b32 v185, v100, v100, s97
    s_waitcnt vmcnt(14) lgkmcnt(8)
    v_mfma_f32_32x32x16_bf16 v[32:47], v[72:75], v[132:135], v[32:47]
    ds_read_b64_tr_b16 v[64:65], v12 offset:16384
    ds_read_b64_tr_b16 v[66:67], v12 offset:17408
    buffer_load_dwordx4 v[128:131], v5, s[16:19], s50 offen offset:0 sc1
    v_perm_b32 v186, v101, v101, s59
    v_mfma_f32_32x32x16_bf16 v[48:63], v[76:79], v[132:135], v[48:63]
    ds_read_b64_tr_b16 v[68:69], v13 offset:16448
    ds_read_b64_tr_b16 v[70:71], v13 offset:17472
    v_perm_b32 v187, v101, v101, s97
    s_waitcnt vmcnt(14) lgkmcnt(8)
    v_mfma_f32_32x32x16_bf16 v[32:47], v[80:83], v[136:139], v[32:47]
    ds_read_b64_tr_b16 v[72:73], v12 offset:18432
    ds_read_b64_tr_b16 v[74:75], v12 offset:19456
    buffer_load_dwordx4 v[132:135], v5, s[16:19], s50 offen offset:1024 sc1
    v_perm_b32 v188, v102, v102, s59
    v_mfma_f32_32x32x16_bf16 v[48:63], v[84:87], v[136:139], v[48:63]
    ds_read_b64_tr_b16 v[76:77], v13 offset:18496
    ds_read_b64_tr_b16 v[78:79], v13 offset:19520
    v_perm_b32 v189, v102, v102, s97
    s_waitcnt vmcnt(14) lgkmcnt(8)
    v_mfma_f32_32x32x16_bf16 v[32:47], v[88:91], v[140:143], v[32:47]
    ds_read_b64_tr_b16 v[80:81], v12 offset:20480
    ds_read_b64_tr_b16 v[82:83], v12 offset:21504
    buffer_load_dwordx4 v[136:139], v5, s[16:19], s50 offen offset:2048 sc1
    v_perm_b32 v190, v103, v103, s59
    v_mfma_f32_32x32x16_bf16 v[48:63], v[92:95], v[140:143], v[48:63]
    ds_read_b64_tr_b16 v[84:85], v13 offset:20544
    ds_read_b64_tr_b16 v[86:87], v13 offset:21568
    v_perm_b32 v191, v103, v103, s97
    s_waitcnt vmcnt(14) lgkmcnt(8)
    v_mfma_f32_32x32x16_bf16 v[32:47], v[64:67], v[144:147], v[32:47]
    ds_read_b64_tr_b16 v[88:89], v12 offset:22528
    ds_read_b64_tr_b16 v[90:91], v12 offset:23552
    buffer_load_dwordx4 v[140:143], v5, s[16:19], s50 offen offset:3072 sc1
    s_add_u32 s50, s50, 4096
    v_perm_b32 v192, v104, v104, s59
    v_mfma_f32_32x32x16_bf16 v[48:63], v[68:71], v[144:147], v[48:63]
    ds_read_b64_tr_b16 v[92:93], v13 offset:22592
    ds_read_b64_tr_b16 v[94:95], v13 offset:23616
    v_perm_b32 v193, v104, v104, s97
    s_waitcnt vmcnt(14) lgkmcnt(8)
    v_mfma_f32_32x32x16_bf16 v[32:47], v[72:75], v[148:151], v[32:47]
    ds_read_b64_tr_b16 v[64:65], v12 offset:24576
    ds_read_b64_tr_b16 v[66:67], v12 offset:25600
    buffer_load_dwordx4 v[144:147], v5, s[16:19], s50 offen offset:0 sc1
    v_perm_b32 v194, v105, v105, s59
    v_mfma_f32_32x32x16_bf16 v[48:63], v[76:79], v[148:151], v[48:63]
    ds_read_b64_tr_b16 v[68:69], v13 offset:24640
    ds_read_b64_tr_b16 v[70:71], v13 offset:25664
    v_perm_b32 v195, v105, v105, s97
    s_waitcnt vmcnt(14) lgkmcnt(8)
    v_mfma_f32_32x32x16_bf16 v[32:47], v[80:83], v[152:155], v[32:47]
    ds_read_b64_tr_b16 v[72:73], v12 offset:26624
    ds_read_b64_tr_b16 v[74:75], v12 offset:27648
    buffer_load_dwordx4 v[148:151], v5, s[16:19], s50 offen offset:1024 sc1
    v_perm_b32 v196, v106, v106, s59
    v_mfma_f32_32x32x16_bf16 v[48:63], v[84:87], v[152:155], v[48:63]
    ds_read_b64_tr_b16 v[76:77], v13 offset:26688
    ds_read_b64_tr_b16 v[78:79], v13 offset:27712
    v_perm_b32 v197, v106, v106, s97
    s_waitcnt vmcnt(14) lgkmcnt(8)
    v_mfma_f32_32x32x16_bf16 v[32:47], v[88:91], v[156:159], v[32:47]
    ds_read_b64_tr_b16 v[80:81], v12 offset:28672
    ds_read_b64_tr_b16 v[82:83], v12 offset:29696
    buffer_load_dwordx4 v[152:155], v5, s[16:19], s50 offen offset:2048 sc1
    v_perm_b32 v198, v107, v107, s59
    v_mfma_f32_32x32x16_bf16 v[48:63], v[92:95], v[156:159], v[48:63]
    ds_read_b64_tr_b16 v[84:85], v13 offset:28736
    ds_read_b64_tr_b16 v[86:87], v13 offset:29760
    v_perm_b32 v199, v107, v107, s97
    s_waitcnt vmcnt(14) lgkmcnt(8)
    v_mfma_f32_32x32x16_bf16 v[32:47], v[64:67], v[160:163], v[32:47]
    ds_read_b64_tr_b16 v[88:89], v12 offset:30720
    ds_read_b64_tr_b16 v[90:91], v12 offset:31744
    buffer_load_dwordx4 v[156:159], v5, s[16:19], s50 offen offset:3072 sc1
    s_add_u32 s50, s50, 4096
    v_perm_b32 v200, v108, v108, s59
    v_mfma_f32_32x32x16_bf16 v[48:63], v[68:71], v[160:163], v[48:63]
    ds_read_b64_tr_b16 v[92:93], v13 offset:30784
    ds_read_b64_tr_b16 v[94:95], v13 offset:31808
    v_perm_b32 v201, v108, v108, s97
    s_waitcnt vmcnt(14) lgkmcnt(8)
    v_mfma_f32_32x32x16_bf16 v[32:47], v[72:75], v[164:167], v[32:47]
    ds_read_b64_tr_b16 v[64:65], v12 offset:32768
    ds_read_b64_tr_b16 v[66:67], v12 offset:33792
    buffer_load_dwordx4 v[160:163], v5, s[16:19], s50 offen offset:0 sc1
    v_perm_b32 v202, v109, v109, s59
    v_mfma_f32_32x32x16_bf16 v[48:63], v[76:79], v[164:167], v[48:63]
    ds_read_b64_tr_b16 v[68:69], v13 offset:32832
    ds_read_b64_tr_b16 v[70:71], v13 offset:33856
    v_perm_b32 v203, v109, v109, s97
    s_waitcnt vmcnt(14) lgkmcnt(8)
    v_mfma_f32_32x32x16_bf16 v[32:47], v[80:83], v[168:171], v[32:47]
    ds_read_b64_tr_b16 v[72:73], v12 offset:34816
    ds_read_b64_tr_b16 v[74:75], v12 offset:35840
    buffer_load_dwordx4 v[164:167], v5, s[16:19], s50 offen offset:1024 sc1
    v_perm_b32 v204, v110, v110, s59
    v_mfma_f32_32x32x16_bf16 v[48:63], v[84:87], v[168:171], v[48:63]
    ds_read_b64_tr_b16 v[76:77], v13 offset:34880
    ds_read_b64_tr_b16 v[78:79], v13 offset:35904
    v_perm_b32 v205, v110, v110, s97
    s_waitcnt vmcnt(14) lgkmcnt(8)
    v_mfma_f32_32x32x16_bf16 v[32:47], v[88:91], v[172:175], v[32:47]
    ds_read_b64_tr_b16 v[80:81], v12 offset:36864
    ds_read_b64_tr_b16 v[82:83], v12 offset:37888
    buffer_load_dwordx4 v[168:171], v5, s[16:19], s50 offen offset:2048 sc1
    v_perm_b32 v206, v111, v111, s59
    v_mfma_f32_32x32x16_bf16 v[48:63], v[92:95], v[172:175], v[48:63]
    ds_read_b64_tr_b16 v[84:85], v13 offset:36928
    ds_read_b64_tr_b16 v[86:87], v13 offset:37952
    v_perm_b32 v207, v111, v111, s97
    s_waitcnt vmcnt(14) lgkmcnt(8)
    v_mfma_f32_32x32x16_bf16 v[32:47], v[64:67], v[112:115], v[32:47]
    ds_read_b64_tr_b16 v[88:89], v12 offset:38912
    ds_read_b64_tr_b16 v[90:91], v12 offset:39936
    buffer_load_dwordx4 v[172:175], v5, s[16:19], s50 offen offset:3072 sc1
    s_add_u32 s50, s50, 4096
    v_and_b32 v8, 31, v1
    v_mfma_f32_32x32x16_bf16 v[48:63], v[68:71], v[112:115], v[48:63]
    ds_read_b64_tr_b16 v[92:93], v13 offset:38976
    ds_read_b64_tr_b16 v[94:95], v13 offset:40000
    v_mul_u32_u24 v8, 144, v8
    s_waitcnt vmcnt(14) lgkmcnt(8)
    v_mfma_f32_32x32x16_bf16 v[32:47], v[72:75], v[116:119], v[32:47]
    ds_read_b64_tr_b16 v[64:65], v12 offset:40960
    ds_read_b64_tr_b16 v[66:67], v12 offset:41984
    s_branch wp_6_t
wp_6:
    ds_read_b32 v29, v28
    s_waitcnt lgkmcnt(0)
    v_readfirstlane_b32 s60, v29
    s_lshr_b32 s51, s60, 2
    s_and_b32 s51, s51, s60
    s_and_b32 s51, s51, 3
wp_6_t:
    s_cmp_eq_u32 s51, 3
    s_cbranch_scc0 wp_6
    s_lshl_b32 s50, s52, 15
    s_xor_b32 s50, s50, 32768
    buffer_load_dwordx4 v[112:115], v5, s[16:19], s50 offen offset:0 sc1
    v_lshl_add_u32 v8, v3, 3, v8
    v_mfma_f32_32x32x16_bf16 v[48:63], v[76:79], v[116:119], v[48:63]
    ds_read_b64_tr_b16 v[68:69], v13 offset:41024
    ds_read_b64_tr_b16 v[70:71], v13 offset:42048
    v_mul_u32_u24 v7, 4608, v2
    s_waitcnt vmcnt(14) lgkmcnt(8)
    v_mfma_f32_32x32x16_bf16 v[32:47], v[80:83], v[120:123], v[32:47]
    ds_read_b64_tr_b16 v[72:73], v12 offset:43008
    ds_read_b64_tr_b16 v[74:75], v12 offset:44032
    buffer_load_dwordx4 v[116:119], v5, s[16:19], s50 offen offset:1024 sc1
    v_add_u32 v7, 131072, v7
    v_mfma_f32_32x32x16_bf16 v[48:63], v[84:87], v[120:123], v[48:63]
    ds_read_b64_tr_b16 v[76:77], v13 offset:43072
    ds_read_b64_tr_b16 v[78:79], v13 offset:44096
    v_add_u32 v8, v8, v7
    s_waitcnt vmcnt(14) lgkmcnt(8)
    v_mfma_f32_32x32x16_bf16 v[32:47], v[88:91], v[124:127], v[32:47]
    ds_read_b64_tr_b16 v[80:81], v12 offset:45056
    ds_read_b64_tr_b16 v[82:83], v12 offset:46080
    buffer_load_dwordx4 v[120:123], v5, s[16:19], s50 offen offset:2048 sc1
    v_lshrrev_b32 v10, 3, v1
    v_mfma_f32_32x32x16_bf16 v[48:63], v[92:95], v[124:127], v[48:63]
    ds_read_b64_tr_b16 v[84:85], v13 offset:45120
    ds_read_b64_tr_b16 v[86:87], v13 offset:46144
    v_and_b32 v11, 7, v1
    s_waitcnt vmcnt(14) lgkmcnt(8)
    v_mfma_f32_32x32x16_bf16 v[32:47], v[64:67], v[128:131], v[32:47]
    ds_read_b64_tr_b16 v[88:89], v12 offset:47104
    ds_read_b64_tr_b16 v[90:91], v12 offset:48128
    buffer_load_dwordx4 v[124:127], v5, s[16:19], s50 offen offset:3072 sc1
    s_add_u32 s50, s50, 4096
    v_mul_u32_u24 v9, 144, v10
    v_mfma_f32_32x32x16_bf16 v[48:63], v[68:71], v[128:131], v[48:63]
    ds_read_b64_tr_b16 v[92:93], v13 offset:47168
    ds_read_b64_tr_b16 v[94:95], v13 offset:48192
    v_lshl_add_u32 v9, v11, 4, v9
    s_waitcnt vmcnt(14) lgkmcnt(8)
    v_mfma_f32_32x32x16_bf16 v[32:47], v[72:75], v[132:135], v[32:47]
    ds_read_b64_tr_b16 v[64:65], v12 offset:49152
    ds_read_b64_tr_b16 v[66:67], v12 offset:50176
    buffer_load_dwordx4 v[128:131], v5, s[16:19], s50 offen offset:0 sc1
    v_add_u32 v9, v9, v7
    v_mfma_f32_32x32x16_bf16 v[48:63], v[76:79], v[132:135], v[48:63]
    ds_read_b64_tr_b16 v[68:69], v13 offset:49216
    ds_read_b64_tr_b16 v[70:71], v13 offset:50240
    v_lshlrev_b32 v10, 11, v10
    s_waitcnt vmcnt(14) lgkmcnt(8)
    v_mfma_f32_32x32x16_bf16 v[32:47], v[80:83], v[136:139], v[32:47]
    ds_read_b64_tr_b16 v[72:73], v12 offset:51200
    ds_read_b64_tr_b16 v[74:75], v12 offset:52224
    buffer_load_dwordx4 v[132:135], v5, s[16:19], s50 offen offset:1024 sc1
    v_lshl_add_u32 v10, v11, 4, v10
    v_mfma_f32_32x32x16_bf16 v[48:63], v[84:87], v[136:139], v[48:63]
    ds_read_b64_tr_b16 v[76:77], v13 offset:51264
    ds_read_b64_tr_b16 v[78:79], v13 offset:52288
    s_waitcnt vmcnt(14) lgkmcnt(8)
    v_mfma_f32_32x32x16_bf16 v[32:47], v[88:91], v[140:143], v[32:47]
    ds_read_b64_tr_b16 v[80:81], v12 offset:53248
    ds_read_b64_tr_b16 v[82:83], v12 offset:54272
    buffer_load_dwordx4 v[136:139], v5, s[16:19], s50 offen offset:2048 sc1
    v_mfma_f32_32x32x16_bf16 v[48:63], v[92:95], v[140:143], v[48:63]
    ds_read_b64_tr_b16 v[84:85], v13 offset:53312
    ds_read_b64_tr_b16 v[86:87], v13 offset:54336
    s_waitcnt vmcnt(14) lgkmcnt(8)
    v_mfma_f32_32x32x16_bf16 v[32:47], v[64:67], v[144:147], v[32:47]
    ds_read_b64_tr_b16 v[88:89], v12 offset:55296
    ds_read_b64_tr_b16 v[90:91], v12 offset:56320
    buffer_load_dwordx4 v[140:143], v5, s[16:19], s50 offen offset:3072 sc1
    s_add_u32 s50, s50, 4096
    v_mfma_f32_32x32x16_bf16 v[48:63], v[68:71], v[144:147], v[48:63]
    ds_read_b64_tr_b16 v[92:93], v13 offset:55360
    ds_read_b64_tr_b16 v[94:95], v13 offset:56384
    s_waitcnt vmcnt(14) lgkmcnt(8)
    v_mfma_f32_32x32x16_bf16 v[32:47], v[72:75], v[148:151], v[32:47]
    ds_read_b64_tr_b16 v[64:65], v12 offset:57344
    ds_read_b64_tr_b16 v[66:67], v12 offset:58368
    buffer_load_dwordx4 v[144:147], v5, s[16:19], s50 offen offset:0 sc1
    v_mfma_f32_32x32x16_bf16 v[48:63], v[76:79], v[148:151], v[48:63]
    ds_read_b64_tr_b16 v[68:69], v13 offset:57408
    ds_read_b64_tr_b16 v[70:71], v13 offset:58432
    s_waitcnt vmcnt(14) lgkmcnt(8)
    v_mfma_f32_32x32x16_bf16 v[32:47], v[80:83], v[152:155], v[32:47]
    ds_read_b64_tr_b16 v[72:73], v12 offset:59392
    ds_read_b64_tr_b16 v[74:75], v12 offset:60416
    buffer_load_dwordx4 v[148:151], v5, s[16:19], s50 offen offset:1024 sc1
    v_mfma_f32_32x32x16_bf16 v[48:63], v[84:87], v[152:155], v[48:63]
    ds_read_b64_tr_b16 v[76:77], v13 offset:59456
    ds_read_b64_tr_b16 v[78:79], v13 offset:60480
    s_waitcnt vmcnt(14) lgkmcnt(8)
    v_mfma_f32_32x32x16_bf16 v[32:47], v[88:91], v[156:159], v[32:47]
    ds_read_b64_tr_b16 v[80:81], v12 offset:61440
    ds_read_b64_tr_b16 v[82:83], v12 offset:62464
    buffer_load_dwordx4 v[152:155], v5, s[16:19], s50 offen offset:2048 sc1
    v_mfma_f32_32x32x16_bf16 v[48:63], v[92:95], v[156:159], v[48:63]
    ds_read_b64_tr_b16 v[84:85], v13 offset:61504
    ds_read_b64_tr_b16 v[86:87], v13 offset:62528
    s_waitcnt vmcnt(14) lgkmcnt(8)
    v_mfma_f32_32x32x16_bf16 v[32:47], v[64:67], v[160:163], v[32:47]
    ds_read_b64_tr_b16 v[88:89], v12 offset:63488
    ds_read_b64_tr_b16 v[90:91], v12 offset:64512
    buffer_load_dwordx4 v[156:159], v5, s[16:19], s50 offen offset:3072 sc1
    s_add_u32 s50, s50, 4096
    v_mfma_f32_32x32x16_bf16 v[48:63], v[68:71], v[160:163], v[48:63]
    ds_read_b64_tr_b16 v[92:93], v13 offset:63552
    ds_read_b64_tr_b16 v[94:95], v13 offset:64576
    s_waitcnt vmcnt(14) lgkmcnt(8)
    v_mfma_f32_32x32x16_bf16 v[32:47], v[72:75], v[164:167], v[32:47]
    ds_read_b64_tr_b16 v[64:65], v14 offset:0
    ds_read_b64_tr_b16 v[66:67], v14 offset:1024
    buffer_load_dwordx4 v[160:163], v5, s[16:19], s50 offen offset:0 sc1
    v_mfma_f32_32x32x16_bf16 v[48:63], v[76:79], v[164:167], v[48:63]
    ds_read_b64_tr_b16 v[68:69], v15 offset:64
    ds_read_b64_tr_b16 v[70:71], v15 offset:1088
    s_waitcnt vmcnt(14) lgkmcnt(8)
    v_mfma_f32_32x32x16_bf16 v[32:47], v[80:83], v[168:171], v[32:47]
    ds_read_b64_tr_b16 v[72:73], v14 offset:2048
    ds_read_b64_tr_b16 v[74:75], v14 offset:3072
    buffer_load_dwordx4 v[164:167], v5, s[16:19], s50 offen offset:1024 sc1
    v_mfma_f32_32x32x16_bf16 v[48:63], v[84:87], v[168:171], v[48:63]
    ds_read_b64_tr_b16 v[76:77], v15 offset:2112
    ds_read_b64_tr_b16 v[78:79], v15 offset:3136
    s_waitcnt vmcnt(14) lgkmcnt(8)
    v_mfma_f32_32x32x16_bf16 v[32:47], v[88:91], v[172:175], v[32:47]
    ds_read_b64_tr_b16 v[80:81], v14 offset:4096
    ds_read_b64_tr_b16 v[82:83], v14 offset:5120
    buffer_load_dwordx4 v[168:171], v5, s[16:19], s50 offen offset:2048 sc1
    v_mfma_f32_32x32x16_bf16 v[48:63], v[92:95], v[172:175], v[48:63]
    ds_read_b64_tr_b16 v[84:85], v15 offset:4160
    ds_read_b64_tr_b16 v[86:87], v15 offset:5184
    s_waitcnt vmcnt(14) lgkmcnt(8)
    v_mfma_f32_32x32x16_bf16 v[176:191], v[64:67], v[112:115], v[176:191]
    ds_read_b64_tr_b16 v[88:89], v14 offset:6144
    ds_read_b64_tr_b16 v[90:91], v14 offset:7168
    buffer_load_dwordx4 v[172:175], v5, s[16:19], s50 offen offset:3072 sc1
    s_add_u32 s50, s50, 4096
    v_mfma_f32_32x32x16_bf16 v[192:207], v[68:71], v[112:115], v[192:207]
    ds_read_b64_tr_b16 v[92:93], v15 offset:6208
    ds_read_b64_tr_b16 v[94:95], v15 offset:7232
    s_waitcnt vmcnt(14) lgkmcnt(8)
    v_mfma_f32_32x32x16_bf16 v[176:191], v[72:75], v[116:119], v[176:191]
    ds_read_b64_tr_b16 v[64:65], v14 offset:8192
    ds_read_b64_tr_b16 v[66:67], v14 offset:9216
    buffer_load_dwordx4 v[112:115], v5, s[16:19], s50 offen offset:0 sc1
    v_mfma_f32_32x32x16_bf16 v[192:207], v[76:79], v[116:119], v[192:207]
    ds_read_b64_tr_b16 v[68:69], v15 offset:8256
    ds_read_b64_tr_b16 v[70:71], v15 offset:9280
    s_waitcnt vmcnt(14) lgkmcnt(8)
    v_mfma_f32_32x32x16_bf16 v[176:191], v[80:83], v[120:123], v[176:191]
    ds_read_b64_tr_b16 v[72:73], v14 offset:10240
    ds_read_b64_tr_b16 v[74:75], v14 offset:11264
    buffer_load_dwordx4 v[116:119], v5, s[16:19], s50 offen offset:1024 sc1
    v_mfma_f32_32x32x16_bf16 v[192:207], v[84:87], v[120:123], v[192:207]
    ds_read_b64_tr_b16 v[76:77], v15 offset:10304
    ds_read_b64_tr_b16 v[78:79], v15 offset:11328
    s_waitcnt vmcnt(14) lgkmcnt(8)
    v_mfma_f32_32x32x16_bf16 v[176:191], v[88:91], v[124:127], v[176:191]
    ds_read_b64_tr_b16 v[80:81], v14 offset:12288
    ds_read_b64_tr_b16 v[82:83], v14 offset:13312
    buffer_load_dwordx4 v[120:123], v5, s[16:19], s50 offen offset:2048 sc1
    v_mfma_f32_32x32x16_bf16 v[192:207], v[92:95], v[124:127], v[192:207]
    ds_read_b64_tr_b16 v[84:85], v15 offset:12352
    ds_read_b64_tr_b16 v[86:87], v15 offset:13376
    s_waitcnt vmcnt(14) lgkmcnt(8)
    v_mfma_f32_32x32x16_bf16 v[176:191], v[64:67], v[128:131], v[176:191]
    ds_read_b64_tr_b16 v[88:89], v14 offset:14336
    ds_read_b64_tr_b16 v[90:91], v14 offset:15360
    buffer_load_dwordx4 v[124:127], v5, s[16:19], s50 offen offset:3072 sc1
    s_add_u32 s50, s50, 4096
    v_mfma_f32_32x32x16_bf16 v[192:207], v[68:71], v[128:131], v[192:207]
    ds_read_b64_tr_b16 v[92:93], v15 offset:14400
    ds_read_b64_tr_b16 v[94:95], v15 offset:15424
    s_waitcnt vmcnt(14) lgkmcnt(8)
    v_mfma_f32_32x32x16_bf16 v[176:191], v[72:75], v[132:135], v[176:191]
    ds_read_b64_tr_b16 v[64:65], v14 offset:16384
    ds_read_b64_tr_b16 v[66:67], v14 offset:17408
    buffer_load_dwordx4 v[128:131], v5, s[16:19], s50 offen offset:0 sc1
    v_mfma_f32_32x32x16_bf16 v[192:207], v[76:79], v[132:135], v[192:207]
    ds_read_b64_tr_b16 v[68:69], v15 offset:16448
    ds_read_b64_tr_b16 v[70:71], v15 offset:17472
    s_waitcnt vmcnt(14) lgkmcnt(8)
    v_mfma_f32_32x32x16_bf16 v[176:191], v[80:83], v[136:139], v[176:191]
    ds_read_b64_tr_b16 v[72:73], v14 offset:18432
    ds_read_b64_tr_b16 v[74:75], v14 offset:19456
    buffer_load_dwordx4 v[132:135], v5, s[16:19], s50 offen offset:1024 sc1
    v_mfma_f32_32x32x16_bf16 v[192:207], v[84:87], v[136:139], v[192:207]
    ds_read_b64_tr_b16 v[76:77], v15 offset:18496
    ds_read_b64_tr_b16 v[78:79], v15 offset:19520
    s_waitcnt vmcnt(14) lgkmcnt(8)
    v_mfma_f32_32x32x16_bf16 v[176:191], v[88:91], v[140:143], v[176:191]
    ds_read_b64_tr_b16 v[80:81], v14 offset:20480
    ds_read_b64_tr_b16 v[82:83], v14 offset:21504
    buffer_load_dwordx4 v[136:139], v5, s[16:19], s50 offen offset:2048 sc1
    v_mfma_f32_32x32x16_bf16 v[192:207], v[92:95], v[140:143], v[192:207]
    ds_read_b64_tr_b16 v[84:85], v15 offset:20544
    ds_read_b64_tr_b16 v[86:87], v15 offset:21568
    s_waitcnt vmcnt(14) lgkmcnt(8)
    v_mfma_f32_32x32x16_bf16 v[176:191], v[64:67], v[144:147], v[176:191]
    ds_read_b64_tr_b16 v[88:89], v14 offset:22528
    ds_read_b64_tr_b16 v[90:91], v14 offset:23552
    buffer_load_dwordx4 v[140:143], v5, s[16:19], s50 offen offset:3072 sc1
    s_add_u32 s50, s50, 4096
    v_mfma_f32_32x32x16_bf16 v[192:207], v[68:71], v[144:147], v[192:207]
    ds_read_b64_tr_b16 v[92:93], v15 offset:22592
    ds_read_b64_tr_b16 v[94:95], v15 offset:23616
    s_waitcnt vmcnt(14) lgkmcnt(8)
    v_mfma_f32_32x32x16_bf16 v[176:191], v[72:75], v[148:151], v[176:191]
    ds_read_b64_tr_b16 v[64:65], v14 offset:24576
    ds_read_b64_tr_b16 v[66:67], v14 offset:25600
    buffer_load_dwordx4 v[144:147], v5, s[16:19], s50 offen offset:0 sc1
    v_mfma_f32_32x32x16_bf16 v[192:207], v[76:79], v[148:151], v[192:207]
    ds_read_b64_tr_b16 v[68:69], v15 offset:24640
    ds_read_b64_tr_b16 v[70:71], v15 offset:25664
    s_waitcnt vmcnt(14) lgkmcnt(8)
    v_mfma_f32_32x32x16_bf16 v[176:191], v[80:83], v[152:155], v[176:191]
    ds_read_b64_tr_b16 v[72:73], v14 offset:26624
    ds_read_b64_tr_b16 v[74:75], v14 offset:27648
    buffer_load_dwordx4 v[148:151], v5, s[16:19], s50 offen offset:1024 sc1
    v_mfma_f32_32x32x16_bf16 v[192:207], v[84:87], v[152:155], v[192:207]
    ds_read_b64_tr_b16 v[76:77], v15 offset:26688
    ds_read_b64_tr_b16 v[78:79], v15 offset:27712
    s_waitcnt vmcnt(14) lgkmcnt(8)
    v_mfma_f32_32x32x16_bf16 v[176:191], v[88:91], v[156:159], v[176:191]
    ds_read_b64_tr_b16 v[80:81], v14 offset:28672
    ds_read_b64_tr_b16 v[82:83], v14 offset:29696
    buffer_load_dwordx4 v[152:155], v5, s[16:19], s50 offen offset:2048 sc1
    v_mfma_f32_32x32x16_bf16 v[192:207], v[92:95], v[156:159], v[192:207]
    ds_read_b64_tr_b16 v[84:85], v15 offset:28736
    ds_read_b64_tr_b16 v[86:87], v15 offset:29760
    s_waitcnt vmcnt(14) lgkmcnt(8)
    v_mfma_f32_32x32x16_bf16 v[176:191], v[64:67], v[160:163], v[176:191]
    ds_read_b64_tr_b16 v[88:89], v14 offset:30720
    ds_read_b64_tr_b16 v[90:91], v14 offset:31744
    buffer_load_dwordx4 v[156:159], v5, s[16:19], s50 offen offset:3072 sc1
    s_add_u32 s50, s50, 4096
    v_mfma_f32_32x32x16_bf16 v[192:207], v[68:71], v[160:163], v[192:207]
    ds_read_b64_tr_b16 v[92:93], v15 offset:30784
    ds_read_b64_tr_b16 v[94:95], v15 offset:31808
    s_waitcnt vmcnt(14) lgkmcnt(8)
    v_mfma_f32_32x32x16_bf16 v[176:191], v[72:75], v[164:167], v[176:191]
    ds_read_b64_tr_b16 v[64:65], v14 offset:32768
    ds_read_b64_tr_b16 v[66:67], v14 offset:33792
    buffer_load_dwordx4 v[160:163], v5, s[16:19], s50 offen offset:0 sc1
    v_mfma_f32_32x32x16_bf16 v[192:207], v[76:79], v[164:167], v[192:207]
    ds_read_b64_tr_b16 v[68:69], v15 offset:32832
    ds_read_b64_tr_b16 v[70:71], v15 offset:33856
    s_waitcnt vmcnt(14) lgkmcnt(8)
    v_mfma_f32_32x32x16_bf16 v[176:191], v[80:83], v[168:171], v[176:191]
    ds_read_b64_tr_b16 v[72:73], v14 offset:34816
    ds_read_b64_tr_b16 v[74:75], v14 offset:35840
    buffer_load_dwordx4 v[164:167], v5, s[16:19], s50 offen offset:1024 sc1
    v_mfma_f32_32x32x16_bf16 v[192:207], v[84:87], v[168:171], v[192:207]
    ds_read_b64_tr_b16 v[76:77], v15 offset:34880
    ds_read_b64_tr_b16 v[78:79], v15 offset:35904
    s_waitcnt vmcnt(14) lgkmcnt(8)
    v_mfma_f32_32x32x16_bf16 v[176:191], v[88:91], v[172:175], v[176:191]
    ds_read_b64_tr_b16 v[80:81], v14 offset:36864
    ds_read_b64_tr_b16 v[82:83], v14 offset:37888
    buffer_load_dwordx4 v[168:171], v5, s[16:19], s50 offen offset:2048 sc1
    v_mfma_f32_32x32x16_bf16 v[192:207], v[92:95], v[172:175], v[192:207]
    ds_read_b64_tr_b16 v[84:85], v15 offset:36928
    ds_read_b64_tr_b16 v[86:87], v15 offset:37952
    s_waitcnt vmcnt(14) lgkmcnt(8)
    v_mfma_f32_32x32x16_bf16 v[176:191], v[64:67], v[112:115], v[176:191]
    ds_read_b64_tr_b16 v[88:89], v14 offset:38912
    ds_read_b64_tr_b16 v[90:91], v14 offset:39936
    buffer_load_dwordx4 v[172:175], v5, s[16:19], s50 offen offset:3072 sc1
    s_add_u32 s50, s50, 4096
    v_mfma_f32_32x32x16_bf16 v[192:207], v[68:71], v[112:115], v[192:207]
    ds_read_b64_tr_b16 v[92:93], v15 offset:38976
    ds_read_b64_tr_b16 v[94:95], v15 offset:40000
    s_waitcnt vmcnt(14) lgkmcnt(8)
    v_mfma_f32_32x32x16_bf16 v[176:191], v[72:75], v[116:119], v[176:191]
    ds_read_b64_tr_b16 v[64:65], v14 offset:40960
    ds_read_b64_tr_b16 v[66:67], v14 offset:41984
    v_mfma_f32_32x32x16_bf16 v[192:207], v[76:79], v[116:119], v[192:207]
    ds_read_b64_tr_b16 v[68:69], v15 offset:41024
    ds_read_b64_tr_b16 v[70:71], v15 offset:42048
    s_waitcnt vmcnt(13) lgkmcnt(8)
    v_mfma_f32_32x32x16_bf16 v[176:191], v[80:83], v[120:123], v[176:191]
    ds_read_b64_tr_b16 v[72:73], v14 offset:43008
    ds_read_b64_tr_b16 v[74:75], v14 offset:44032
    v_mfma_f32_32x32x16_bf16 v[192:207], v[84:87], v[120:123], v[192:207]
    ds_read_b64_tr_b16 v[76:77], v15 offset:43072
    ds_read_b64_tr_b16 v[78:79], v15 offset:44096
    s_waitcnt vmcnt(12) lgkmcnt(8)
    v_mfma_f32_32x32x16_bf16 v[176:191], v[88:91], v[124:127], v[176:191]
    ds_read_b64_tr_b16 v[80:81], v14 offset:45056
    ds_read_b64_tr_b16 v[82:83], v14 offset:46080
    v_mfma_f32_32x32x16_bf16 v[192:207], v[92:95], v[124:127], v[192:207]
    ds_read_b64_tr_b16 v[84:85], v15 offset:45120
    ds_read_b64_tr_b16 v[86:87], v15 offset:46144
    s_waitcnt vmcnt(11) lgkmcnt(8)
    v_mfma_f32_32x32x16_bf16 v[176:191], v[64:67], v[128:131], v[176:191]
    ds_read_b64_tr_b16 v[88:89], v14 offset:47104
    ds_read_b64_tr_b16 v[90:91], v14 offset:48128
    v_mfma_f32_32x32x16_bf16 v[192:207], v[68:71], v[128:131], v[192:207]
    ds_read_b64_tr_b16 v[92:93], v15 offset:47168
    ds_read_b64_tr_b16 v[94:95], v15 offset:48192
    s_waitcnt vmcnt(10) lgkmcnt(8)
    v_mfma_f32_32x32x16_bf16 v[176:191], v[72:75], v[132:135], v[176:191]
    ds_read_b64_tr_b16 v[64:65], v14 offset:49152
    ds_read_b64_tr_b16 v[66:67], v14 offset:50176
    v_mfma_f32_32x32x16_bf16 v[192:207], v[76:79], v[132:135], v[192:207]
    ds_read_b64_tr_b16 v[68:69], v15 offset:49216
    ds_read_b64_tr_b16 v[70:71], v15 offset:50240
    s_waitcnt vmcnt(9) lgkmcnt(8)
    v_mfma_f32_32x32x16_bf16 v[176:191], v[80:83], v[136:139], v[176:191]
    ds_read_b64_tr_b16 v[72:73], v14 offset:51200
    ds_read_b64_tr_b16 v[74:75], v14 offset:52224
    v_mfma_f32_32x32x16_bf16 v[192:207], v[84:87], v[136:139], v[192:207]
    ds_read_b64_tr_b16 v[76:77], v15 offset:51264
    ds_read_b64_tr_b16 v[78:79], v15 offset:52288
    s_waitcnt vmcnt(8) lgkmcnt(8)
    v_mfma_f32_32x32x16_bf16 v[176:191], v[88:91], v[140:143], v[176:191]
    ds_read_b64_tr_b16 v[80:81], v14 offset:53248
    ds_read_b64_tr_b16 v[82:83], v14 offset:54272
    v_mfma_f32_32x32x16_bf16 v[192:207], v[92:95], v[140:143], v[192:207]
    ds_read_b64_tr_b16 v[84:85], v15 offset:53312
    ds_read_b64_tr_b16 v[86:87], v15 offset:54336
    s_waitcnt vmcnt(7) lgkmcnt(8)
    v_mfma_f32_32x32x16_bf16 v[176:191], v[64:67], v[144:147], v[176:191]
    ds_read_b64_tr_b16 v[88:89], v14 offset:55296
    ds_read_b64_tr_b16 v[90:91], v14 offset:56320
    v_mfma_f32_32x32x16_bf16 v[192:207], v[68:71], v[144:147], v[192:207]
    ds_read_b64_tr_b16 v[92:93], v15 offset:55360
    ds_read_b64_tr_b16 v[94:95], v15 offset:56384
    s_waitcnt vmcnt(6) lgkmcnt(8)
    v_mfma_f32_32x32x16_bf16 v[176:191], v[72:75], v[148:151], v[176:191]
    ds_read_b64_tr_b16 v[64:65], v14 offset:57344
    ds_read_b64_tr_b16 v[66:67], v14 offset:58368
    v_mfma_f32_32x32x16_bf16 v[192:207], v[76:79], v[148:151], v[192:207]
    ds_read_b64_tr_b16 v[68:69], v15 offset:57408
    ds_read_b64_tr_b16 v[70:71], v15 offset:58432
    s_waitcnt vmcnt(5) lgkmcnt(8)
    v_mfma_f32_32x32x16_bf16 v[176:191], v[80:83], v[152:155], v[176:191]
    ds_read_b64_tr_b16 v[72:73], v14 offset:59392
    ds_read_b64_tr_b16 v[74:75], v14 offset:60416
    v_mfma_f32_32x32x16_bf16 v[192:207], v[84:87], v[152:155], v[192:207]
    ds_read_b64_tr_b16 v[76:77], v15 offset:59456
    ds_read_b64_tr_b16 v[78:79], v15 offset:60480
    s_waitcnt vmcnt(4) lgkmcnt(8)
    v_mfma_f32_32x32x16_bf16 v[176:191], v[88:91], v[156:159], v[176:191]
    ds_read_b64_tr_b16 v[80:81], v14 offset:61440
    ds_read_b64_tr_b16 v[82:83], v14 offset:62464
    v_mfma_f32_32x32x16_bf16 v[192:207], v[92:95], v[156:159], v[192:207]
    ds_read_b64_tr_b16 v[84:85], v15 offset:61504
    ds_read_b64_tr_b16 v[86:87], v15 offset:62528
    s_waitcnt vmcnt(3) lgkmcnt(8)
    v_mfma_f32_32x32x16_bf16 v[176:191], v[64:67], v[160:163], v[176:191]
    ds_read_b64_tr_b16 v[88:89], v14 offset:63488
    ds_read_b64_tr_b16 v[90:91], v14 offset:64512
    v_mfma_f32_32x32x16_bf16 v[192:207], v[68:71], v[160:163], v[192:207]
    ds_read_b64_tr_b16 v[92:93], v15 offset:63552
    ds_read_b64_tr_b16 v[94:95], v15 offset:64576
    s_waitcnt vmcnt(2) lgkmcnt(8)
    v_mfma_f32_32x32x16_bf16 v[176:191], v[72:75], v[164:167], v[176:191]
    v_mfma_f32_32x32x16_bf16 v[192:207], v[76:79], v[164:167], v[192:207]
    s_waitcnt vmcnt(1) lgkmcnt(4)
    v_mfma_f32_32x32x16_bf16 v[176:191], v[80:83], v[168:171], v[176:191]
    v_mfma_f32_32x32x16_bf16 v[192:207], v[84:87], v[168:171], v[192:207]
    s_waitcnt vmcnt(0) lgkmcnt(0)
    v_mfma_f32_32x32x16_bf16 v[176:191], v[88:91], v[172:175], v[176:191]
    v_mfma_f32_32x32x16_bf16 v[192:207], v[92:95], v[172:175], v[192:207]
    s_cmp_eq_u32 s9, 3
    s_nop 1
    s_cbranch_scc1 c_wo_fin
    s_add_u32 s58, s58, 4194304
    s_nop 7
    v_pk_add_f32 v[32:33], v[32:33], v[176:177]
    v_pk_add_f32 v[34:35], v[34:35], v[178:179]
    v_pk_add_f32 v[36:37], v[36:37], v[180:181]
    v_pk_add_f32 v[38:39], v[38:39], v[182:183]
    v_cvt_pk_bf16_f32 v96, v32, v33
    v_cvt_pk_bf16_f32 v97, v34, v35
    v_cvt_pk_bf16_f32 v98, v36, v37
    v_cvt_pk_bf16_f32 v99, v38, v39
    buffer_store_dwordx4 v[96:99], v5, s[12:15], s58 offen offset:0 sc1
    v_pk_add_f32 v[40:41], v[40:41], v[184:185]
    v_pk_add_f32 v[42:43], v[42:43], v[186:187]
    v_pk_add_f32 v[44:45], v[44:45], v[188:189]
    v_pk_add_f32 v[46:47], v[46:47], v[190:191]
    v_cvt_pk_bf16_f32 v100, v40, v41
    v_cvt_pk_bf16_f32 v101, v42, v43
    v_cvt_pk_bf16_f32 v102, v44, v45
    v_cvt_pk_bf16_f32 v103, v46, v47
    buffer_store_dwordx4 v[100:103], v5, s[12:15], s58 offen offset:1024 sc1
    v_pk_add_f32 v[48:49], v[48:49], v[192:193]
    v_pk_add_f32 v[50:51], v[50:51], v[194:195]
    v_pk_add_f32 v[52:53], v[52:53], v[196:197]
    v_pk_add_f32 v[54:55], v[54:55], v[198:199]
    v_cvt_pk_bf16_f32 v104, v48, v49
    v_cvt_pk_bf16_f32 v105, v50, v51
    v_cvt_pk_bf16_f32 v106, v52, v53
    v_cvt_pk_bf16_f32 v107, v54, v55
    buffer_store_dwordx4 v[104:107], v5, s[12:15], s58 offen offset:2048 sc1
    v_pk_add_f32 v[56:57], v[56:57], v[200:201]
    v_pk_add_f32 v[58:59], v[58:59], v[202:203]
    v_pk_add_f32 v[60:61], v[60:61], v[204:205]
    v_pk_add_f32 v[62:63], v[62:63], v[206:207]
    v_cvt_pk_bf16_f32 v108, v56, v57
    v_cvt_pk_bf16_f32 v109, v58, v59
    v_cvt_pk_bf16_f32 v110, v60, v61
    v_cvt_pk_bf16_f32 v111, v62, v63
    buffer_store_dwordx4 v[108:111], v5, s[12:15], s58 offen offset:3072 sc1
    s_barrier
c_wo_stat:
    s_mov_b32 s55, 0x3f803f80
    v_dot2_f32_bf16 v18, v96, s55, 0
    v_dot2_f32_bf16 v19, v96, v96, 0
    v_dot2_f32_bf16 v20, v97, s55, 0
    v_dot2_f32_bf16 v21, v97, v97, 0
    v_dot2_f32_bf16 v18, v98, s55, v18
    v_dot2_f32_bf16 v19, v98, v98, v19
    v_dot2_f32_bf16 v20, v99, s55, v20
    v_dot2_f32_bf16 v21, v99, v99, v21
    v_dot2_f32_bf16 v18, v100, s55, v18
    v_dot2_f32_bf16 v19, v100, v100, v19
    v_dot2_f32_bf16 v20, v101, s55, v20
    v_dot2_f32_bf16 v21, v101, v101, v21
    v_dot2_f32_bf16 v18, v102, s55, v18
    v_dot2_f32_bf16 v19, v102, v102, v19
    v_dot2_f32_bf16 v20, v103, s55, v20
    v_dot2_f32_bf16 v21, v103, v103, v21
    v_dot2_f32_bf16 v18, v104, s55, v18
    v_dot2_f32_bf16 v19, v104, v104, v19
    v_dot2_f32_bf16 v20, v105, s55, v20
    v_dot2_f32_bf16 v21, v105, v105, v21
    v_dot2_f32_bf16 v18, v106, s55, v18
    v_dot2_f32_bf16 v19, v106, v106, v19
    v_dot2_f32_bf16 v20, v107, s55, v20
    v_dot2_f32_bf16 v21, v107, v107, v21
    v_dot2_f32_bf16 v18, v108, s55, v18
    v_dot2_f32_bf16 v19, v108, v108, v19
    v_dot2_f32_bf16 v20, v109, s55, v20
    v_dot2_f32_bf16 v21, v109, v109, v21
    v_dot2_f32_bf16 v18, v110, s55, v18
    v_dot2_f32_bf16 v19, v110, v110, v19
    v_dot2_f32_bf16 v20, v111, s55, v20
    v_dot2_f32_bf16 v21, v111, v111, v21
    v_lshlrev_b32 v16, 3, v1
    s_lshl_b32 s3, s48, 12
    s_lshl_b32 s55, s7, 8
    s_add_u32 s3, s3, s55
    v_permlane32_swap_b32 v18, v20
    v_permlane32_swap_b32 v19, v21
    s_lshl_b32 s55, s9, 18
    v_pk_add_f32 v[18:19], v[18:19], v[20:21]
    s_add_u32 s3, s3, s55
    s_add_u32 s3, s3, 63176704
    v_permlane32_swap_b32 v18, v20
    v_permlane32_swap_b32 v19, v21
    v_pk_add_f32 v[18:19], v[18:19], v[20:21]
    s_mov_b32 exec_hi, 0
    buffer_store_dwordx2 v[18:19], v16, s[12:15], s3 offen sc1
    s_mov_b64 exec, -1
    s_cmp_lg_u32 s9, -1
    s_cbranch_scc1 c_wo_pub
    v_mov_b32 v24, 159492
non_7:
    ds_read_b32 v25, v24
    s_waitcnt lgkmcnt(0)
    v_readfirstlane_b32 s10, v25
    s_cmp_eq_u32 s10, 0
    s_cbranch_scc1 non_7
c_wo_pub:
    s_mul_i32 s55, s9, 786432
    s_add_u32 s55, s55, 66060288
    v_and_b32 v24, 63, v0
    s_and_b32 s56, s11, 0xe0
    v_lshrrev_b32 v25, 5, v24
    v_add_u32 v24, s56, v24
    v_and_b32 v24, 255, v24
    v_lshlrev_b32 v24, 10, v24
    v_lshl_add_u32 v24, v25, 8, v24
    s_bfe_u32 s56, s11, 0x20003
    s_and_b32 s57, s11, 7
    s_lshl_b32 s56, s56, 7
    s_lshl_b32 s57, s57, 2
    s_add_u32 s55, s55, s56
    s_add_u32 s55, s55, s57
    s_and_b32 s57, s6, s9
    s_bfe_i32 s57, s57, 0x10000
    v_mov_b32 v25, 159488
    v_mov_b32 v26, 1
    v_mov_b32 v27, s10
    s_mov_b64 exec, 1
    s_waitcnt vmcnt(0)
    ds_add_rtn_u32 v26, v25, v26
    s_waitcnt lgkmcnt(0)
    v_readfirstlane_b32 s56, v26
    s_and_b32 s56, s56, 3
    s_cmp_lg_u32 s56, 3
    s_cbranch_scc1 pub_8
    s_mov_b32 exec_lo, -1
    s_mov_b32 exec_hi, s57
    buffer_store_dword v27, v24, s[12:15], s55 offen sc1
pub_8:
    s_mov_b64 exec, -1
    s_cmp_eq_u32 s9, -1
    s_cbranch_scc1 c_wo_pub3
    s_barrier
c_wo_pub3:
    s_add_u32 s9, s9, 1
    s_bitcmp1_b32 s9, 0
    s_cbranch_scc1 c_qkvB
    s_branch c_qkvA
c_wo_fin:
    s_mov_b32 s28, s44
    s_mov_b32 s29, s45
    s_mov_b32 s30, 4194304
    s_mov_b32 s31, 0x00020000
    s_lshl_b32 s3, s48, 16
    s_lshl_b32 s55, s7, 7
    s_add_u32 s3, s3, s55
    v_pk_add_f32 v[32:33], v[32:33], v[176:177]
    v_pk_add_f32 v[34:35], v[34:35], v[178:179]
    v_pk_add_f32 v[36:37], v[36:37], v[180:181]
    v_pk_add_f32 v[38:39], v[38:39], v[182:183]
    v_cvt_pk_bf16_f32 v96, v32, v33
    v_cvt_pk_bf16_f32 v97, v34, v35
    v_cvt_pk_bf16_f32 v98, v36, v37
    v_cvt_pk_bf16_f32 v99, v38, v39
    ds_write_b64 v8, v[96:97] offset:0
    ds_write_b64 v8, v[98:99] offset:16
    v_pk_add_f32 v[40:41], v[40:41], v[184:185]
    v_pk_add_f32 v[42:43], v[42:43], v[186:187]
    v_pk_add_f32 v[44:45], v[44:45], v[188:189]
    v_pk_add_f32 v[46:47], v[46:47], v[190:191]
    v_cvt_pk_bf16_f32 v100, v40, v41
    v_cvt_pk_bf16_f32 v101, v42, v43
    v_cvt_pk_bf16_f32 v102, v44, v45
    v_cvt_pk_bf16_f32 v103, v46, v47
    ds_write_b64 v8, v[100:101] offset:32
    ds_write_b64 v8, v[102:103] offset:48
    v_pk_add_f32 v[48:49], v[48:49], v[192:193]
    v_pk_add_f32 v[50:51], v[50:51], v[194:195]
    v_pk_add_f32 v[52:53], v[52:53], v[196:197]
    v_pk_add_f32 v[54:55], v[54:55], v[198:199]
    v_cvt_pk_bf16_f32 v104, v48, v49
    v_cvt_pk_bf16_f32 v105, v50, v51
    v_cvt_pk_bf16_f32 v106, v52, v53
    v_cvt_pk_bf16_f32 v107, v54, v55
    ds_write_b64 v8, v[104:105] offset:64
    ds_write_b64 v8, v[106:107] offset:80
    v_pk_add_f32 v[56:57], v[56:57], v[200:201]
    v_pk_add_f32 v[58:59], v[58:59], v[202:203]
    v_pk_add_f32 v[60:61], v[60:61], v[204:205]
    v_pk_add_f32 v[62:63], v[62:63], v[206:207]
    v_cvt_pk_bf16_f32 v108, v56, v57
    v_cvt_pk_bf16_f32 v109, v58, v59
    v_cvt_pk_bf16_f32 v110, v60, v61
    v_cvt_pk_bf16_f32 v111, v62, v63
    ds_write_b64 v8, v[108:109] offset:96
    ds_write_b64 v8, v[110:111] offset:112
    s_waitcnt lgkmcnt(0)
    ds_read_b128 v[32:35], v9 offset:0
    ds_read_b128 v[36:39], v9 offset:1152
    ds_read_b128 v[40:43], v9 offset:2304
    ds_read_b128 v[44:47], v9 offset:3456
    s_waitcnt lgkmcnt(3)
    buffer_store_dwordx4 v[32:35], v10, s[28:31], s3 offen sc1
    s_add_u32 s3, s3, 16384
    s_waitcnt lgkmcnt(2)
    buffer_store_dwordx4 v[36:39], v10, s[28:31], s3 offen sc1
    s_add_u32 s3, s3, 16384
    s_waitcnt lgkmcnt(1)
    buffer_store_dwordx4 v[40:43], v10, s[28:31], s3 offen sc1
    s_add_u32 s3, s3, 16384
    s_waitcnt lgkmcnt(0)
    buffer_store_dwordx4 v[44:47], v10, s[28:31], s3 offen sc1
    s_add_u32 s3, s3, 16384
    s_branch k_exit
c_prep_tail:
    s_lshl_b32 s56, s7, 12
    s_add_u32 s58, s55, s56
    v_lshlrev_b32 v5, 4, v1
    s_lshl_b32 s3, s8, 12
    s_add_u32 s3, s3, 131072
    v_lshrrev_b32 v18, 1, v17
    v_lshlrev_b32 v18, 10, v18
    v_lshl_add_u32 v18, v16, 4, v18
    v_and_b32 v17, 1, v17
    v_lshl_add_u32 v18, v17, 3, v18
    v_add_u32 v18, s3, v18
    v_add_u32 v19, s3, v5
    s_waitcnt vmcnt(3)
    ds_write_b64 v18, v[32:33] offset:0
    ds_write_b64 v18, v[34:35] offset:512
    s_waitcnt vmcnt(2)
    ds_write_b64 v18, v[36:37] offset:128
    ds_write_b64 v18, v[38:39] offset:640
    s_waitcnt vmcnt(1)
    ds_write_b64 v18, v[40:41] offset:256
    ds_write_b64 v18, v[42:43] offset:768
    s_waitcnt vmcnt(0)
    ds_write_b64 v18, v[44:45] offset:384
    ds_write_b64 v18, v[46:47] offset:896
    s_waitcnt lgkmcnt(0)
    ds_read_b128 v[96:99], v19 offset:0
    ds_read_b128 v[100:103], v19 offset:1024
    ds_read_b128 v[104:107], v19 offset:2048
    ds_read_b128 v[108:111], v19 offset:3072
    s_waitcnt lgkmcnt(3)
    buffer_store_dwordx4 v[96:99], v5, s[12:15], s58 offen offset:0 sc1
    s_waitcnt lgkmcnt(2)
    buffer_store_dwordx4 v[100:103], v5, s[12:15], s58 offen offset:1024 sc1
    s_waitcnt lgkmcnt(1)
    buffer_store_dwordx4 v[104:107], v5, s[12:15], s58 offen offset:2048 sc1
    s_waitcnt lgkmcnt(0)
    buffer_store_dwordx4 v[108:111], v5, s[12:15], s58 offen offset:3072 sc1
    s_branch c_wo_stat
.p2align 6
c_qkvB:
    v_and_b32 v1, 63, v0
    v_lshrrev_b32 v2, 6, v0
    v_lshlrev_b32 v5, 4, v1
    v_lshrrev_b32 v3, 5, v1
    v_and_b32 v4, 15, v0
    v_bfe_u32 v7, v1, 4, 1
    v_lshl_add_u32 v6, v7, 5, v4
    v_lshlrev_b32 v6, 4, v6
    v_lshl_add_u32 v6, v3, 10, v6
    s_lshr_b32 s48, s6, 1
    s_lshl_b32 s48, s48, 2
    s_add_u32 s48, s48, s8
    s_lshl_b32 s55, s48, 17
    s_lshl_b32 s56, s9, 22
    s_add_u32 s55, s55, s56
    s_add_u32 s16, s4, s55
    s_addc_u32 s17, s5, 0
    s_mov_b32 s18, 65536
    s_mov_b32 s19, 0x00020000
    s_add_u32 s56, s55, 65536
    s_add_u32 s20, s4, s56
    s_addc_u32 s21, s5, 0
    s_mov_b32 s22, 65536
    s_mov_b32 s23, 0x00020000
    s_lshl_b32 s49, s7, 12
    s_add_u32 s49, s49, s55
    s_and_b32 s56, s6, 1
    s_lshl_b32 s56, s56, 11
    s_add_u32 s49, s49, s56
    s_add_u32 s49, s49, 16777216
    s_movk_i32 s54, 4096
    v_lshrrev_b32 v16, 2, v4
    v_lshl_add_u32 v18, v7, 2, v16
    v_lshl_add_u32 v18, v3, 4, v18
    v_lshlrev_b32 v18, 6, v18
    v_and_b32 v17, 3, v4
    v_lshl_add_u32 v18, v17, 3, v18
    v_lshl_add_u32 v26, v7, 5, v18
    v_xor_b32 v27, 32, v26
    v_mov_b32 v24, v26
    v_mov_b32 v25, v27
    v_and_b32 v18, 0x30, v1
    v_add_u32 v10, 155648, v18
    v_lshlrev_b32 v11, 2, v4
    v_add_u32 v11, 155648, v11
    v_lshl_add_u32 v8, v2, 8, v11
    v_lshl_add_u32 v9, v2, 8, v10
    s_lshr_b32 s3, s8, 1
    s_and_b32 s55, s8, 1
    s_lshl_b32 s3, s3, 14
    s_lshl_b32 s55, s55, 12
    s_add_u32 s3, s3, s55
    s_add_u32 s3, s3, 81920
    v_lshl_add_u32 v12, v3, 5, v4
    v_lshlrev_b32 v12, 4, v12
    v_lshl_add_u32 v12, v7, 10, v12
    v_add_u32 v12, s3, v12
    v_add_u32 v13, s3, v5
    s_lshr_b32 s84, s9, 1
    s_lshl_b32 s84, s84, 23
    s_lshl_b32 s3, s7, 19
    s_add_u32 s84, s84, s3
    s_and_b32 s3, s6, 1
    s_lshl_b32 s3, s3, 18
    s_add_u32 s84, s84, s3
    s_add_u32 s84, s84, 33554432
    s_lshr_b32 s86, s6, 1
    s_lshl_b32 s3, s86, 15
    s_add_u32 s84, s84, s3
    s_sub_u32 s84, s84, 81920
    s_add_u32 s85, s84, 8192
    s_mul_i32 s53, s9, 786432
    s_add_u32 s53, s53, 66322432
    s_and_b32 s3, s11, 31
    s_lshl_b32 s3, s3, 10
    s_add_u32 s53, s53, s3
    s_lshr_b32 s3, s86, 1
    s_lshl_b32 s3, s3, 7
    s_add_u32 s53, s53, s3
    s_and_b32 s3, s86, 1
    s_lshl_b32 s3, s3, 2
    s_add_u32 s3, s3, s8
    s_lshl_b32 s3, s3, 2
    s_add_u32 s53, s53, s3
    v_lshlrev_b32 v28, 15, v1
    v_mov_b32 v29, s10
    v_mov_b32 v32, 0
    v_mov_b32 v33, 0
    v_mov_b32 v34, 0
    v_mov_b32 v35, 0
    v_mov_b32 v36, 0
    v_mov_b32 v37, 0
    v_mov_b32 v38, 0
    v_mov_b32 v39, 0
    v_mov_b32 v40, 0
    v_mov_b32 v41, 0
    v_mov_b32 v42, 0
    v_mov_b32 v43, 0
    v_mov_b32 v44, 0
    v_mov_b32 v45, 0
    v_mov_b32 v46, 0
    v_mov_b32 v47, 0
    v_mov_b32 v48, 0
    v_mov_b32 v49, 0
    v_mov_b32 v50, 0
    v_mov_b32 v51, 0
    v_mov_b32 v52, 0
    v_mov_b32 v53, 0
    v_mov_b32 v54, 0
    v_mov_b32 v55, 0
    v_mov_b32 v56, 0
    v_mov_b32 v57, 0
    v_mov_b32 v58, 0
    v_mov_b32 v59, 0
    v_mov_b32 v60, 0
    v_mov_b32 v61, 0
    v_mov_b32 v62, 0
    v_mov_b32 v63, 0
    v_mov_b32 v64, 0
    v_mov_b32 v65, 0
    v_mov_b32 v66, 0
    v_mov_b32 v67, 0
    v_mov_b32 v68, 0
    v_mov_b32 v69, 0
    v_mov_b32 v70, 0
    v_mov_b32 v71, 0
    v_mov_b32 v72, 0
    v_mov_b32 v73, 0
    v_mov_b32 v74, 0
    v_mov_b32 v75, 0
    v_mov_b32 v76, 0
    v_mov_b32 v77, 0
    v_mov_b32 v78, 0
    v_mov_b32 v79, 0
    v_mov_b32 v80, 0
    v_mov_b32 v81, 0
    v_mov_b32 v82, 0
    v_mov_b32 v83, 0
    v_mov_b32 v84, 0
    v_mov_b32 v85, 0
    v_mov_b32 v86, 0
    v_mov_b32 v87, 0
    v_mov_b32 v88, 0
    v_mov_b32 v89, 0
    v_mov_b32 v90, 0
    v_mov_b32 v91, 0
    v_mov_b32 v92, 0
    v_mov_b32 v93, 0
    v_mov_b32 v94, 0
    v_mov_b32 v95, 0
    v_mov_b32 v96, 0
    v_mov_b32 v97, 0
    v_mov_b32 v98, 0
    v_mov_b32 v99, 0
    v_mov_b32 v100, 0
    v_mov_b32 v101, 0
    v_mov_b32 v102, 0
    v_mov_b32 v103, 0
    v_mov_b32 v104, 0
    v_mov_b32 v105, 0
    v_mov_b32 v106, 0
    v_mov_b32 v107, 0
    v_mov_b32 v108, 0
    v_mov_b32 v109, 0
    v_mov_b32 v110, 0
    v_mov_b32 v111, 0
    v_mov_b32 v112, 0
    v_mov_b32 v113, 0
    v_mov_b32 v114, 0
    v_mov_b32 v115, 0
    v_mov_b32 v116, 0
    v_mov_b32 v117, 0
    v_mov_b32 v118, 0
    v_mov_b32 v119, 0
    v_mov_b32 v120, 0
    v_mov_b32 v121, 0
    v_mov_b32 v122, 0
    v_mov_b32 v123, 0
    v_mov_b32 v124, 0
    v_mov_b32 v125, 0
    v_mov_b32 v126, 0
    v_mov_b32 v127, 0
    s_mov_b32 s50, 8192
    s_mov_b32 s58, 6144
    s_mov_b32 s51, 12288
    s_mov_b32 s59, 10240
    s_mov_b32 s52, 0
    s_mul_i32 s60, s9, 786432
    s_add_u32 s60, s60, 65273856
    s_lshl_b32 s61, s11, 10
    s_add_u32 s60, s60, s61
    s_and_b32 s61, s8, 2
    s_lshl_b32 s61, s61, 7
    s_add_u32 s60, s60, s61
    s_add_u32 s61, s60, 128
    s_mov_b32 s98, s10
    s_mov_b32 s99, s10
    s_mov_b32 s3, 0x100000
cp_9:
    s_load_dwordx8 s[64:71], s[4:5], s60 glc
    s_load_dwordx8 s[72:79], s[4:5], s61 glc
    s_sub_u32 s3, s3, 1
    s_cbranch_scc1 cp_9_ok
    s_waitcnt lgkmcnt(0)
    s_xor_b64 s[100:101], s[64:65], s[98:99]
    s_xor_b64 s[64:65], s[66:67], s[98:99]
    s_or_b64 s[100:101], s[100:101], s[64:65]
    s_xor_b64 s[64:65], s[68:69], s[98:99]
    s_or_b64 s[100:101], s[100:101], s[64:65]
    s_xor_b64 s[64:65], s[70:71], s[98:99]
    s_or_b64 s[100:101], s[100:101], s[64:65]
    s_xor_b64 s[64:65], s[72:73], s[98:99]
    s_or_b64 s[100:101], s[100:101], s[64:65]
    s_xor_b64 s[64:65], s[74:75], s[98:99]
    s_or_b64 s[100:101], s[100:101], s[64:65]
    s_xor_b64 s[64:65], s[76:77], s[98:99]
    s_or_b64 s[100:101], s[100:101], s[64:65]
    s_xor_b64 s[64:65], s[78:79], s[98:99]
    s_or_b64 s[100:101], s[100:101], s[64:65]
    s_cbranch_scc1 cp_9
cp_9_ok:
    s_waitcnt lgkmcnt(0)
    buffer_load_dwordx4 v[152:155], v6, s[16:19], 0 offen offset:0 sc1
    buffer_load_dwordx4 v[156:159], v6, s[16:19], 0 offen offset:256 sc1
    buffer_load_dwordx4 v[160:163], v6, s[20:23], 0 offen offset:0 sc1
    buffer_load_dwordx4 v[164:167], v6, s[20:23], 0 offen offset:256 sc1
    buffer_load_dwordx4 v[168:171], v6, s[16:19], 0 offen offset:2048 sc1
    buffer_load_dwordx4 v[172:175], v6, s[16:19], 0 offen offset:2304 sc1
    buffer_load_dwordx4 v[176:179], v6, s[20:23], 0 offen offset:2048 sc1
    buffer_load_dwordx4 v[180:183], v6, s[20:23], 0 offen offset:2304 sc1
    s_barrier
    ds_read_b64_tr_b16 v[128:129], v24 offset:0
    ds_read_b64_tr_b16 v[130:131], v24 offset:512
    ds_read_b64_tr_b16 v[132:133], v25 offset:0
    ds_read_b64_tr_b16 v[134:135], v25 offset:512
    ds_read_b64_tr_b16 v[136:137], v24 offset:8192
    ds_read_b64_tr_b16 v[138:139], v24 offset:8704
    ds_read_b64_tr_b16 v[140:141], v25 offset:8192
    ds_read_b64_tr_b16 v[142:143], v25 offset:8704
    ds_read_b64_tr_b16 v[144:145], v24 offset:16384
    ds_read_b64_tr_b16 v[146:147], v24 offset:16896
    buffer_load_dwordx4 a[0:3], v6, s[16:19], s54 offen offset:0 sc1
    buffer_load_dwordx4 a[4:7], v6, s[16:19], s54 offen offset:256 sc1
    buffer_load_dwordx4 a[8:11], v6, s[20:23], s54 offen offset:0 sc1
    buffer_load_dwordx4 a[12:15], v6, s[20:23], s54 offen offset:256 sc1
    buffer_load_dwordx4 a[16:19], v6, s[16:19], s54 offen offset:2048 sc1
    buffer_load_dwordx4 a[20:23], v6, s[16:19], s54 offen offset:2304 sc1
    s_mov_b32 s54, 7
.p2align 3
c_qkvB_loop:
    s_waitcnt vmcnt(12) lgkmcnt(8)
    v_mfma_f32_16x16x32_bf16 v[32:35], v[128:131], v[152:155], v[32:35]
    ds_read_b64_tr_b16 v[148:149], v25 offset:16384
    buffer_load_dwordx4 a[24:27], v6, s[20:23], s58 offen offset:0 sc1
    v_mfma_f32_16x16x32_bf16 v[36:39], v[128:131], v[156:159], v[36:39]
    ds_read_b64_tr_b16 v[150:151], v25 offset:16896
    s_waitcnt lgkmcnt(8)
    v_mfma_f32_16x16x32_bf16 v[52:55], v[132:135], v[156:159], v[52:55]
    v_mfma_f32_16x16x32_bf16 v[48:51], v[132:135], v[152:155], v[48:51]
    s_waitcnt lgkmcnt(6)
    v_mfma_f32_16x16x32_bf16 v[64:67], v[136:139], v[152:155], v[64:67]
    v_mfma_f32_16x16x32_bf16 v[68:71], v[136:139], v[156:159], v[68:71]
    s_waitcnt lgkmcnt(4)
    v_mfma_f32_16x16x32_bf16 v[84:87], v[140:143], v[156:159], v[84:87]
    buffer_load_dwordx4 a[28:31], v6, s[20:23], s58 offen offset:256 sc1
    v_mfma_f32_16x16x32_bf16 v[80:83], v[140:143], v[152:155], v[80:83]
    s_waitcnt lgkmcnt(2)
    v_mfma_f32_16x16x32_bf16 v[96:99], v[152:155], v[144:147], v[96:99]
    v_mfma_f32_16x16x32_bf16 v[100:103], v[156:159], v[144:147], v[100:103]
    s_waitcnt lgkmcnt(0)
    v_mfma_f32_16x16x32_bf16 v[116:119], v[156:159], v[148:151], v[116:119]
    v_mfma_f32_16x16x32_bf16 v[112:115], v[152:155], v[148:151], v[112:115]
    s_waitcnt vmcnt(12)
    v_mfma_f32_16x16x32_bf16 v[40:43], v[128:131], v[160:163], v[40:43]
    buffer_load_dwordx4 v[152:155], v6, s[16:19], s50 offen offset:0 sc1
    v_mfma_f32_16x16x32_bf16 v[44:47], v[128:131], v[164:167], v[44:47]
    v_mfma_f32_16x16x32_bf16 v[60:63], v[132:135], v[164:167], v[60:63]
    ds_read_b64_tr_b16 v[128:129], v24 offset:2048
    v_mfma_f32_16x16x32_bf16 v[56:59], v[132:135], v[160:163], v[56:59]
    ds_read_b64_tr_b16 v[130:131], v24 offset:2560
    v_mfma_f32_16x16x32_bf16 v[72:75], v[136:139], v[160:163], v[72:75]
    ds_read_b64_tr_b16 v[132:133], v25 offset:2048
    v_mfma_f32_16x16x32_bf16 v[76:79], v[136:139], v[164:167], v[76:79]
    ds_read_b64_tr_b16 v[134:135], v25 offset:2560
    v_mfma_f32_16x16x32_bf16 v[92:95], v[140:143], v[164:167], v[92:95]
    ds_read_b64_tr_b16 v[136:137], v24 offset:10240
    buffer_load_dwordx4 v[156:159], v6, s[16:19], s50 offen offset:256 sc1
    v_mfma_f32_16x16x32_bf16 v[88:91], v[140:143], v[160:163], v[88:91]
    ds_read_b64_tr_b16 v[138:139], v24 offset:10752
    v_mfma_f32_16x16x32_bf16 v[104:107], v[160:163], v[144:147], v[104:107]
    ds_read_b64_tr_b16 v[140:141], v25 offset:10240
    v_mfma_f32_16x16x32_bf16 v[108:111], v[164:167], v[144:147], v[108:111]
    ds_read_b64_tr_b16 v[142:143], v25 offset:10752
    v_mfma_f32_16x16x32_bf16 v[124:127], v[164:167], v[148:151], v[124:127]
    ds_read_b64_tr_b16 v[144:145], v24 offset:18432
    v_mfma_f32_16x16x32_bf16 v[120:123], v[160:163], v[148:151], v[120:123]
    ds_read_b64_tr_b16 v[146:147], v24 offset:18944
    s_waitcnt vmcnt(12) lgkmcnt(8)
    v_mfma_f32_16x16x32_bf16 v[32:35], v[128:131], v[168:171], v[32:35]
    ds_read_b64_tr_b16 v[148:149], v25 offset:18432
    buffer_load_dwordx4 v[160:163], v6, s[20:23], s58 offen offset:2048 sc1
    v_mfma_f32_16x16x32_bf16 v[36:39], v[128:131], v[172:175], v[36:39]
    ds_read_b64_tr_b16 v[150:151], v25 offset:18944
    s_waitcnt lgkmcnt(8)
    v_mfma_f32_16x16x32_bf16 v[52:55], v[132:135], v[172:175], v[52:55]
    v_mfma_f32_16x16x32_bf16 v[48:51], v[132:135], v[168:171], v[48:51]
    s_waitcnt lgkmcnt(6)
    v_mfma_f32_16x16x32_bf16 v[64:67], v[136:139], v[168:171], v[64:67]
    v_mfma_f32_16x16x32_bf16 v[68:71], v[136:139], v[172:175], v[68:71]
    s_waitcnt lgkmcnt(4)
    v_mfma_f32_16x16x32_bf16 v[84:87], v[140:143], v[172:175], v[84:87]
    buffer_load_dwordx4 v[164:167], v6, s[20:23], s58 offen offset:2304 sc1
    v_mfma_f32_16x16x32_bf16 v[80:83], v[140:143], v[168:171], v[80:83]
    s_waitcnt lgkmcnt(2)
    v_mfma_f32_16x16x32_bf16 v[96:99], v[168:171], v[144:147], v[96:99]
    v_mfma_f32_16x16x32_bf16 v[100:103], v[172:175], v[144:147], v[100:103]
    s_waitcnt lgkmcnt(0)
    v_mfma_f32_16x16x32_bf16 v[116:119], v[172:175], v[148:151], v[116:119]
    v_mfma_f32_16x16x32_bf16 v[112:115], v[168:171], v[148:151], v[112:115]
    s_waitcnt vmcnt(12)
    v_mfma_f32_16x16x32_bf16 v[40:43], v[128:131], v[176:179], v[40:43]
    buffer_load_dwordx4 v[168:171], v6, s[16:19], s50 offen offset:2048 sc1
    v_mfma_f32_16x16x32_bf16 v[44:47], v[128:131], v[180:183], v[44:47]
    v_mfma_f32_16x16x32_bf16 v[60:63], v[132:135], v[180:183], v[60:63]
    ds_read_b64_tr_b16 v[128:129], v24 offset:4096
    v_mfma_f32_16x16x32_bf16 v[56:59], v[132:135], v[176:179], v[56:59]
    ds_read_b64_tr_b16 v[130:131], v24 offset:4608
    v_mfma_f32_16x16x32_bf16 v[72:75], v[136:139], v[176:179], v[72:75]
    ds_read_b64_tr_b16 v[132:133], v25 offset:4096
    v_mfma_f32_16x16x32_bf16 v[76:79], v[136:139], v[180:183], v[76:79]
    ds_read_b64_tr_b16 v[134:135], v25 offset:4608
    v_mfma_f32_16x16x32_bf16 v[92:95], v[140:143], v[180:183], v[92:95]
    ds_read_b64_tr_b16 v[136:137], v24 offset:12288
    buffer_load_dwordx4 v[172:175], v6, s[16:19], s50 offen offset:2304 sc1
    v_mfma_f32_16x16x32_bf16 v[88:91], v[140:143], v[176:179], v[88:91]
    ds_read_b64_tr_b16 v[138:139], v24 offset:12800
    v_mfma_f32_16x16x32_bf16 v[104:107], v[176:179], v[144:147], v[104:107]
    ds_read_b64_tr_b16 v[140:141], v25 offset:12288
    v_mfma_f32_16x16x32_bf16 v[108:111], v[180:183], v[144:147], v[108:111]
    ds_read_b64_tr_b16 v[142:143], v25 offset:12800
    v_mfma_f32_16x16x32_bf16 v[124:127], v[180:183], v[148:151], v[124:127]
    ds_read_b64_tr_b16 v[144:145], v24 offset:20480
    v_mfma_f32_16x16x32_bf16 v[120:123], v[176:179], v[148:151], v[120:123]
    ds_read_b64_tr_b16 v[146:147], v24 offset:20992
    s_waitcnt vmcnt(12) lgkmcnt(8)
    v_mfma_f32_16x16x32_bf16 v[32:35], v[128:131], a[0:3], v[32:35]
    ds_read_b64_tr_b16 v[148:149], v25 offset:20480
    buffer_load_dwordx4 v[176:179], v6, s[20:23], s59 offen offset:0 sc1
    v_mfma_f32_16x16x32_bf16 v[36:39], v[128:131], a[4:7], v[36:39]
    ds_read_b64_tr_b16 v[150:151], v25 offset:20992
    s_waitcnt lgkmcnt(8)
    v_mfma_f32_16x16x32_bf16 v[52:55], v[132:135], a[4:7], v[52:55]
    s_add_u32 s58, s58, 8192
    v_mfma_f32_16x16x32_bf16 v[48:51], v[132:135], a[0:3], v[48:51]
    s_waitcnt lgkmcnt(6)
    v_mfma_f32_16x16x32_bf16 v[64:67], v[136:139], a[0:3], v[64:67]
    s_add_u32 s50, s50, 8192
    v_mfma_f32_16x16x32_bf16 v[68:71], v[136:139], a[4:7], v[68:71]
    s_waitcnt lgkmcnt(4)
    v_mfma_f32_16x16x32_bf16 v[84:87], v[140:143], a[4:7], v[84:87]
    buffer_load_dwordx4 v[180:183], v6, s[20:23], s59 offen offset:256 sc1
    v_mfma_f32_16x16x32_bf16 v[80:83], v[140:143], a[0:3], v[80:83]
    s_waitcnt lgkmcnt(2)
    v_mfma_f32_16x16x32_bf16 v[96:99], a[0:3], v[144:147], v[96:99]
    s_add_u32 s52, s52, 24576
    v_mfma_f32_16x16x32_bf16 v[100:103], a[4:7], v[144:147], v[100:103]
    s_cmp_eq_u32 s52, 147456
    s_waitcnt lgkmcnt(0)
    v_mfma_f32_16x16x32_bf16 v[116:119], a[4:7], v[148:151], v[116:119]
    s_cselect_b32 s52, 0, s52
    v_mfma_f32_16x16x32_bf16 v[112:115], a[0:3], v[148:151], v[112:115]
    s_waitcnt vmcnt(12)
    v_mfma_f32_16x16x32_bf16 v[40:43], v[128:131], a[8:11], v[40:43]
    buffer_load_dwordx4 a[0:3], v6, s[16:19], s51 offen offset:0 sc1
    v_mfma_f32_16x16x32_bf16 v[44:47], v[128:131], a[12:15], v[44:47]
    s_sub_u32 s54, s54, 1
    v_mfma_f32_16x16x32_bf16 v[60:63], v[132:135], a[12:15], v[60:63]
    ds_read_b64_tr_b16 v[128:129], v24 offset:6144
    v_mfma_f32_16x16x32_bf16 v[56:59], v[132:135], a[8:11], v[56:59]
    ds_read_b64_tr_b16 v[130:131], v24 offset:6656
    v_mfma_f32_16x16x32_bf16 v[72:75], v[136:139], a[8:11], v[72:75]
    ds_read_b64_tr_b16 v[132:133], v25 offset:6144
    v_mfma_f32_16x16x32_bf16 v[76:79], v[136:139], a[12:15], v[76:79]
    ds_read_b64_tr_b16 v[134:135], v25 offset:6656
    v_mfma_f32_16x16x32_bf16 v[92:95], v[140:143], a[12:15], v[92:95]
    ds_read_b64_tr_b16 v[136:137], v24 offset:14336
    buffer_load_dwordx4 a[4:7], v6, s[16:19], s51 offen offset:256 sc1
    v_mfma_f32_16x16x32_bf16 v[88:91], v[140:143], a[8:11], v[88:91]
    ds_read_b64_tr_b16 v[138:139], v24 offset:14848
    v_mfma_f32_16x16x32_bf16 v[104:107], a[8:11], v[144:147], v[104:107]
    ds_read_b64_tr_b16 v[140:141], v25 offset:14336
    v_mfma_f32_16x16x32_bf16 v[108:111], a[12:15], v[144:147], v[108:111]
    ds_read_b64_tr_b16 v[142:143], v25 offset:14848
    v_mfma_f32_16x16x32_bf16 v[124:127], a[12:15], v[148:151], v[124:127]
    ds_read_b64_tr_b16 v[144:145], v24 offset:22528
    v_mfma_f32_16x16x32_bf16 v[120:123], a[8:11], v[148:151], v[120:123]
    ds_read_b64_tr_b16 v[146:147], v24 offset:23040
    s_waitcnt vmcnt(12) lgkmcnt(8)
    v_mfma_f32_16x16x32_bf16 v[32:35], v[128:131], a[16:19], v[32:35]
    ds_read_b64_tr_b16 v[148:149], v25 offset:22528
    buffer_load_dwordx4 a[8:11], v6, s[20:23], s59 offen offset:2048 sc1
    v_mfma_f32_16x16x32_bf16 v[36:39], v[128:131], a[20:23], v[36:39]
    ds_read_b64_tr_b16 v[150:151], v25 offset:23040
    s_waitcnt lgkmcnt(8)
    v_mfma_f32_16x16x32_bf16 v[52:55], v[132:135], a[20:23], v[52:55]
    v_add_u32 v24, s52, v26
    v_mfma_f32_16x16x32_bf16 v[48:51], v[132:135], a[16:19], v[48:51]
    s_waitcnt lgkmcnt(6)
    v_mfma_f32_16x16x32_bf16 v[64:67], v[136:139], a[16:19], v[64:67]
    v_add_u32 v25, s52, v27
    v_mfma_f32_16x16x32_bf16 v[68:71], v[136:139], a[20:23], v[68:71]
    s_waitcnt lgkmcnt(4)
    v_mfma_f32_16x16x32_bf16 v[84:87], v[140:143], a[20:23], v[84:87]
    buffer_load_dwordx4 a[12:15], v6, s[20:23], s59 offen offset:2304 sc1
    v_mfma_f32_16x16x32_bf16 v[80:83], v[140:143], a[16:19], v[80:83]
    s_waitcnt lgkmcnt(2)
    v_mfma_f32_16x16x32_bf16 v[96:99], a[16:19], v[144:147], v[96:99]
    s_add_u32 s59, s59, 8192
    v_mfma_f32_16x16x32_bf16 v[100:103], a[20:23], v[144:147], v[100:103]
    s_waitcnt lgkmcnt(0)
    v_mfma_f32_16x16x32_bf16 v[116:119], a[20:23], v[148:151], v[116:119]
    v_mfma_f32_16x16x32_bf16 v[112:115], a[16:19], v[148:151], v[112:115]
    s_barrier
    s_waitcnt vmcnt(12)
    v_mfma_f32_16x16x32_bf16 v[40:43], v[128:131], a[24:27], v[40:43]
    buffer_load_dwordx4 a[16:19], v6, s[16:19], s51 offen offset:2048 sc1
    v_mfma_f32_16x16x32_bf16 v[44:47], v[128:131], a[28:31], v[44:47]
    v_mfma_f32_16x16x32_bf16 v[60:63], v[132:135], a[28:31], v[60:63]
    ds_read_b64_tr_b16 v[128:129], v24 offset:0
    v_mfma_f32_16x16x32_bf16 v[56:59], v[132:135], a[24:27], v[56:59]
    ds_read_b64_tr_b16 v[130:131], v24 offset:512
    v_mfma_f32_16x16x32_bf16 v[72:75], v[136:139], a[24:27], v[72:75]
    ds_read_b64_tr_b16 v[132:133], v25 offset:0
    v_mfma_f32_16x16x32_bf16 v[76:79], v[136:139], a[28:31], v[76:79]
    ds_read_b64_tr_b16 v[134:135], v25 offset:512
    v_mfma_f32_16x16x32_bf16 v[92:95], v[140:143], a[28:31], v[92:95]
    ds_read_b64_tr_b16 v[136:137], v24 offset:8192
    buffer_load_dwordx4 a[20:23], v6, s[16:19], s51 offen offset:2304 sc1
    v_mfma_f32_16x16x32_bf16 v[88:91], v[140:143], a[24:27], v[88:91]
    ds_read_b64_tr_b16 v[138:139], v24 offset:8704
    v_mfma_f32_16x16x32_bf16 v[104:107], a[24:27], v[144:147], v[104:107]
    ds_read_b64_tr_b16 v[140:141], v25 offset:8192
    s_add_u32 s51, s51, 8192
    v_mfma_f32_16x16x32_bf16 v[108:111], a[28:31], v[144:147], v[108:111]
    ds_read_b64_tr_b16 v[142:143], v25 offset:8704
    v_mfma_f32_16x16x32_bf16 v[124:127], a[28:31], v[148:151], v[124:127]
    ds_read_b64_tr_b16 v[144:145], v24 offset:16384
    s_cmp_lg_u32 s54, 0
    v_mfma_f32_16x16x32_bf16 v[120:123], a[24:27], v[148:151], v[120:123]
    ds_read_b64_tr_b16 v[146:147], v24 offset:16896
    s_cbranch_scc1 c_qkvB_loop
    s_waitcnt vmcnt(12) lgkmcnt(8)
    v_mfma_f32_16x16x32_bf16 v[32:35], v[128:131], v[152:155], v[32:35]
    ds_read_b64_tr_b16 v[148:149], v25 offset:16384
    buffer_load_dwordx4 a[24:27], v6, s[20:23], s58 offen offset:0 sc1
    v_mfma_f32_16x16x32_bf16 v[36:39], v[128:131], v[156:159], v[36:39]
    ds_read_b64_tr_b16 v[150:151], v25 offset:16896
    s_waitcnt lgkmcnt(8)
    v_mfma_f32_16x16x32_bf16 v[52:55], v[132:135], v[156:159], v[52:55]
    ds_read_b32 v184, v8 offset:1280
    v_mfma_f32_16x16x32_bf16 v[48:51], v[132:135], v[152:155], v[48:51]
    ds_read_b32 v186, v8 offset:1344
    s_waitcnt lgkmcnt(8)
    v_mfma_f32_16x16x32_bf16 v[64:67], v[136:139], v[152:155], v[64:67]
    ds_read_b32 v188, v8 offset:1408
    v_mfma_f32_16x16x32_bf16 v[68:71], v[136:139], v[156:159], v[68:71]
    s_waitcnt lgkmcnt(7)
    v_mfma_f32_16x16x32_bf16 v[84:87], v[140:143], v[156:159], v[84:87]
    buffer_load_dwordx4 a[28:31], v6, s[20:23], s58 offen offset:256 sc1
    ds_read_b32 v190, v8 offset:1472
    v_mfma_f32_16x16x32_bf16 v[80:83], v[140:143], v[152:155], v[80:83]
    ds_read_b128 v[212:215], v10 offset:512
    s_waitcnt lgkmcnt(7)
    v_mfma_f32_16x16x32_bf16 v[96:99], v[152:155], v[144:147], v[96:99]
    ds_read_b128 v[216:219], v10 offset:576
    v_mfma_f32_16x16x32_bf16 v[100:103], v[156:159], v[144:147], v[100:103]
    s_waitcnt lgkmcnt(6)
    v_mfma_f32_16x16x32_bf16 v[116:119], v[156:159], v[148:151], v[116:119]
    v_mfma_f32_16x16x32_bf16 v[112:115], v[152:155], v[148:151], v[112:115]
    s_waitcnt vmcnt(12)
    v_mfma_f32_16x16x32_bf16 v[40:43], v[128:131], v[160:163], v[40:43]
    s_waitcnt lgkmcnt(0)
    v_fma_f32 v64, -v184, v212, v64
    v_fma_f32 v65, -v184, v213, v65
    v_mfma_f32_16x16x32_bf16 v[44:47], v[128:131], v[164:167], v[44:47]
    v_fma_f32 v66, -v184, v214, v66
    v_mfma_f32_16x16x32_bf16 v[60:63], v[132:135], v[164:167], v[60:63]
    ds_read_b64_tr_b16 v[128:129], v24 offset:2048
    v_fma_f32 v67, -v184, v215, v67
    v_mfma_f32_16x16x32_bf16 v[56:59], v[132:135], v[160:163], v[56:59]
    ds_read_b64_tr_b16 v[130:131], v24 offset:2560
    v_fma_f32 v68, -v186, v212, v68
    v_fma_f32 v69, -v186, v213, v69
    v_mfma_f32_16x16x32_bf16 v[72:75], v[136:139], v[160:163], v[72:75]
    ds_read_b64_tr_b16 v[132:133], v25 offset:2048
    v_fma_f32 v70, -v186, v214, v70
    v_mfma_f32_16x16x32_bf16 v[76:79], v[136:139], v[164:167], v[76:79]
    ds_read_b64_tr_b16 v[134:135], v25 offset:2560
    v_fma_f32 v71, -v186, v215, v71
    v_mfma_f32_16x16x32_bf16 v[92:95], v[140:143], v[164:167], v[92:95]
    ds_read_b64_tr_b16 v[136:137], v24 offset:10240
    v_fma_f32 v80, -v184, v216, v80
    v_fma_f32 v81, -v184, v217, v81
    v_mfma_f32_16x16x32_bf16 v[88:91], v[140:143], v[160:163], v[88:91]
    ds_read_b64_tr_b16 v[138:139], v24 offset:10752
    v_fma_f32 v82, -v184, v218, v82
    v_mfma_f32_16x16x32_bf16 v[104:107], v[160:163], v[144:147], v[104:107]
    ds_read_b64_tr_b16 v[140:141], v25 offset:10240
    v_fma_f32 v83, -v184, v219, v83
    v_mfma_f32_16x16x32_bf16 v[108:111], v[164:167], v[144:147], v[108:111]
    ds_read_b64_tr_b16 v[142:143], v25 offset:10752
    v_fma_f32 v84, -v186, v216, v84
    v_fma_f32 v85, -v186, v217, v85
    v_mfma_f32_16x16x32_bf16 v[124:127], v[164:167], v[148:151], v[124:127]
    ds_read_b64_tr_b16 v[144:145], v24 offset:18432
    v_fma_f32 v86, -v186, v218, v86
    v_mfma_f32_16x16x32_bf16 v[120:123], v[160:163], v[148:151], v[120:123]
    ds_read_b64_tr_b16 v[146:147], v24 offset:18944
    v_fma_f32 v87, -v186, v219, v87
    s_waitcnt vmcnt(10) lgkmcnt(8)
    v_mfma_f32_16x16x32_bf16 v[32:35], v[128:131], v[168:171], v[32:35]
    ds_read_b64_tr_b16 v[148:149], v25 offset:18432
    v_fma_f32 v72, -v188, v212, v72
    v_fma_f32 v73, -v188, v213, v73
    v_mfma_f32_16x16x32_bf16 v[36:39], v[128:131], v[172:175], v[36:39]
    ds_read_b64_tr_b16 v[150:151], v25 offset:18944
    v_fma_f32 v74, -v188, v214, v74
    s_waitcnt lgkmcnt(8)
    v_mfma_f32_16x16x32_bf16 v[52:55], v[132:135], v[172:175], v[52:55]
    v_fma_f32 v75, -v188, v215, v75
    ds_read_b128 v[152:155], v10 offset:384
    v_mfma_f32_16x16x32_bf16 v[48:51], v[132:135], v[168:171], v[48:51]
    v_fma_f32 v76, -v190, v212, v76
    v_fma_f32 v77, -v190, v213, v77
    ds_read_b128 v[156:159], v10 offset:448
    s_waitcnt lgkmcnt(8)
    v_mfma_f32_16x16x32_bf16 v[64:67], v[136:139], v[168:171], v[64:67]
    v_fma_f32 v78, -v190, v214, v78
    ds_read_b32 v185, v8 offset:2816
    v_mfma_f32_16x16x32_bf16 v[68:71], v[136:139], v[172:175], v[68:71]
    v_fma_f32 v79, -v190, v215, v79
    s_waitcnt lgkmcnt(7)
    v_mfma_f32_16x16x32_bf16 v[84:87], v[140:143], v[172:175], v[84:87]
    v_fma_f32 v88, -v188, v216, v88
    v_fma_f32 v89, -v188, v217, v89
    ds_read_b32 v187, v8 offset:2880
    v_mfma_f32_16x16x32_bf16 v[80:83], v[140:143], v[168:171], v[80:83]
    v_fma_f32 v90, -v188, v218, v90
    ds_read_b32 v189, v8 offset:2944
    s_waitcnt lgkmcnt(7)
    v_mfma_f32_16x16x32_bf16 v[96:99], v[168:171], v[144:147], v[96:99]
    v_fma_f32 v91, -v188, v219, v91
    ds_read_b32 v191, v8 offset:3008
    v_mfma_f32_16x16x32_bf16 v[100:103], v[172:175], v[144:147], v[100:103]
    v_fma_f32 v92, -v190, v216, v92
    v_fma_f32 v93, -v190, v217, v93
    s_waitcnt lgkmcnt(6)
    v_mfma_f32_16x16x32_bf16 v[116:119], v[172:175], v[148:151], v[116:119]
    v_fma_f32 v94, -v190, v218, v94
    v_mfma_f32_16x16x32_bf16 v[112:115], v[168:171], v[148:151], v[112:115]
    v_fma_f32 v95, -v190, v219, v95
    s_waitcnt vmcnt(8)
    v_mfma_f32_16x16x32_bf16 v[40:43], v[128:131], v[176:179], v[40:43]
    s_waitcnt lgkmcnt(0)
    v_fma_f32 v32, -v184, v152, v32
    v_fma_f32 v33, -v184, v153, v33
    v_mfma_f32_16x16x32_bf16 v[44:47], v[128:131], v[180:183], v[44:47]
    v_fma_f32 v34, -v184, v154, v34
    v_mfma_f32_16x16x32_bf16 v[60:63], v[132:135], v[180:183], v[60:63]
    ds_read_b64_tr_b16 v[128:129], v24 offset:4096
    v_fma_f32 v35, -v184, v155, v35
    v_fma_f32 v36, -v186, v152, v36
    v_mfma_f32_16x16x32_bf16 v[56:59], v[132:135], v[176:179], v[56:59]
    ds_read_b64_tr_b16 v[130:131], v24 offset:4608
    v_fma_f32 v37, -v186, v153, v37
    v_mfma_f32_16x16x32_bf16 v[72:75], v[136:139], v[176:179], v[72:75]
    ds_read_b64_tr_b16 v[132:133], v25 offset:4096
    v_fma_f32 v38, -v186, v154, v38
    v_fma_f32 v39, -v186, v155, v39
    v_mfma_f32_16x16x32_bf16 v[76:79], v[136:139], v[180:183], v[76:79]
    ds_read_b64_tr_b16 v[134:135], v25 offset:4608
    v_fma_f32 v48, -v184, v156, v48
    v_mfma_f32_16x16x32_bf16 v[92:95], v[140:143], v[180:183], v[92:95]
    ds_read_b64_tr_b16 v[136:137], v24 offset:12288
    v_fma_f32 v49, -v184, v157, v49
    v_fma_f32 v50, -v184, v158, v50
    v_mfma_f32_16x16x32_bf16 v[88:91], v[140:143], v[176:179], v[88:91]
    ds_read_b64_tr_b16 v[138:139], v24 offset:12800
    v_fma_f32 v51, -v184, v159, v51
    v_mfma_f32_16x16x32_bf16 v[104:107], v[176:179], v[144:147], v[104:107]
    ds_read_b64_tr_b16 v[140:141], v25 offset:12288
    v_fma_f32 v52, -v186, v156, v52
    v_fma_f32 v53, -v186, v157, v53
    v_mfma_f32_16x16x32_bf16 v[108:111], v[180:183], v[144:147], v[108:111]
    ds_read_b64_tr_b16 v[142:143], v25 offset:12800
    v_fma_f32 v54, -v186, v158, v54
    v_mfma_f32_16x16x32_bf16 v[124:127], v[180:183], v[148:151], v[124:127]
    ds_read_b64_tr_b16 v[144:145], v24 offset:20480
    v_fma_f32 v55, -v186, v159, v55
    v_mfma_f32_16x16x32_bf16 v[120:123], v[176:179], v[148:151], v[120:123]
    ds_read_b64_tr_b16 v[146:147], v24 offset:20992
    s_waitcnt vmcnt(6) lgkmcnt(8)
    v_mfma_f32_16x16x32_bf16 v[32:35], v[128:131], a[0:3], v[32:35]
    ds_read_b64_tr_b16 v[148:149], v25 offset:20480
    v_fma_f32 v40, -v188, v152, v40
    v_fma_f32 v41, -v188, v153, v41
    v_mfma_f32_16x16x32_bf16 v[36:39], v[128:131], a[4:7], v[36:39]
    ds_read_b64_tr_b16 v[150:151], v25 offset:20992
    v_fma_f32 v42, -v188, v154, v42
    s_waitcnt lgkmcnt(8)
    v_mfma_f32_16x16x32_bf16 v[52:55], v[132:135], a[4:7], v[52:55]
    v_fma_f32 v43, -v188, v155, v43
    v_fma_f32 v44, -v190, v152, v44
    ds_read_b128 v[168:171], v9 offset:1280
    v_mfma_f32_16x16x32_bf16 v[48:51], v[132:135], a[0:3], v[48:51]
    v_fma_f32 v45, -v190, v153, v45
    ds_read_b128 v[172:175], v9 offset:1344
    s_waitcnt lgkmcnt(8)
    v_mfma_f32_16x16x32_bf16 v[64:67], v[136:139], a[0:3], v[64:67]
    v_fma_f32 v46, -v190, v154, v46
    v_fma_f32 v47, -v190, v155, v47
    v_mfma_f32_16x16x32_bf16 v[68:71], v[136:139], a[4:7], v[68:71]
    v_fma_f32 v56, -v188, v156, v56
    ds_read_b128 v[176:179], v9 offset:1408
    s_waitcnt lgkmcnt(7)
    v_mfma_f32_16x16x32_bf16 v[84:87], v[140:143], a[4:7], v[84:87]
    v_fma_f32 v57, -v188, v157, v57
    v_fma_f32 v58, -v188, v158, v58
    ds_read_b128 v[180:183], v9 offset:1472
    v_mfma_f32_16x16x32_bf16 v[80:83], v[140:143], a[0:3], v[80:83]
    v_fma_f32 v59, -v188, v159, v59
    s_waitcnt lgkmcnt(6)
    v_mfma_f32_16x16x32_bf16 v[96:99], a[0:3], v[144:147], v[96:99]
    v_fma_f32 v60, -v190, v156, v60
    v_fma_f32 v61, -v190, v157, v61
    ds_read2_b32 v[220:221], v11 offset0:160 offset1:176
    v_mfma_f32_16x16x32_bf16 v[100:103], a[4:7], v[144:147], v[100:103]
    v_fma_f32 v62, -v190, v158, v62
    s_waitcnt lgkmcnt(5)
    v_mfma_f32_16x16x32_bf16 v[116:119], a[4:7], v[148:151], v[116:119]
    v_fma_f32 v63, -v190, v159, v63
    v_mfma_f32_16x16x32_bf16 v[112:115], a[0:3], v[148:151], v[112:115]
    s_waitcnt vmcnt(4)
    v_mfma_f32_16x16x32_bf16 v[40:43], v[128:131], a[8:11], v[40:43]
    v_mfma_f32_16x16x32_bf16 v[44:47], v[128:131], a[12:15], v[44:47]
    s_waitcnt lgkmcnt(0)
    v_fma_f32 v96, -v168, v220, v96
    v_fma_f32 v97, -v169, v220, v97
    v_mfma_f32_16x16x32_bf16 v[60:63], v[132:135], a[12:15], v[60:63]
    ds_read_b64_tr_b16 v[128:129], v24 offset:6144
    v_fma_f32 v98, -v170, v220, v98
    v_mfma_f32_16x16x32_bf16 v[56:59], v[132:135], a[8:11], v[56:59]
    ds_read_b64_tr_b16 v[130:131], v24 offset:6656
    v_fma_f32 v99, -v171, v220, v99
    v_fma_f32 v100, -v172, v220, v100
    v_mfma_f32_16x16x32_bf16 v[72:75], v[136:139], a[8:11], v[72:75]
    ds_read_b64_tr_b16 v[132:133], v25 offset:6144
    v_fma_f32 v101, -v173, v220, v101
    v_mfma_f32_16x16x32_bf16 v[76:79], v[136:139], a[12:15], v[76:79]
    ds_read_b64_tr_b16 v[134:135], v25 offset:6656
    v_fma_f32 v102, -v174, v220, v102
    v_fma_f32 v103, -v175, v220, v103
    v_mfma_f32_16x16x32_bf16 v[92:95], v[140:143], a[12:15], v[92:95]
    ds_read_b64_tr_b16 v[136:137], v24 offset:14336
    v_fma_f32 v112, -v168, v221, v112
    v_mfma_f32_16x16x32_bf16 v[88:91], v[140:143], a[8:11], v[88:91]
    ds_read_b64_tr_b16 v[138:139], v24 offset:14848
    v_fma_f32 v113, -v169, v221, v113
    v_fma_f32 v114, -v170, v221, v114
    v_mfma_f32_16x16x32_bf16 v[104:107], a[8:11], v[144:147], v[104:107]
    ds_read_b64_tr_b16 v[140:141], v25 offset:14336
    v_fma_f32 v115, -v171, v221, v115
    v_mfma_f32_16x16x32_bf16 v[108:111], a[12:15], v[144:147], v[108:111]
    ds_read_b64_tr_b16 v[142:143], v25 offset:14848
    v_fma_f32 v116, -v172, v221, v116
    v_fma_f32 v117, -v173, v221, v117
    v_mfma_f32_16x16x32_bf16 v[124:127], a[12:15], v[148:151], v[124:127]
    ds_read_b64_tr_b16 v[144:145], v24 offset:22528
    v_fma_f32 v118, -v174, v221, v118
    v_mfma_f32_16x16x32_bf16 v[120:123], a[8:11], v[148:151], v[120:123]
    ds_read_b64_tr_b16 v[146:147], v24 offset:23040
    v_fma_f32 v119, -v175, v221, v119
    s_waitcnt vmcnt(2) lgkmcnt(8)
    v_mfma_f32_16x16x32_bf16 v[32:35], v[128:131], a[16:19], v[32:35]
    ds_read_b64_tr_b16 v[148:149], v25 offset:22528
    v_mfma_f32_16x16x32_bf16 v[36:39], v[128:131], a[20:23], v[36:39]
    ds_read_b64_tr_b16 v[150:151], v25 offset:23040
    v_fma_f32 v104, -v176, v220, v104
    v_fma_f32 v105, -v177, v220, v105
    s_waitcnt lgkmcnt(8)
    v_mfma_f32_16x16x32_bf16 v[52:55], v[132:135], a[20:23], v[52:55]
    v_fma_f32 v106, -v178, v220, v106
    ds_read_b128 v[152:155], v9 offset:2816
    v_mfma_f32_16x16x32_bf16 v[48:51], v[132:135], a[16:19], v[48:51]
    v_fma_f32 v107, -v179, v220, v107
    v_fma_f32 v108, -v180, v220, v108
    s_waitcnt lgkmcnt(7)
    v_mfma_f32_16x16x32_bf16 v[64:67], v[136:139], a[16:19], v[64:67]
    v_fma_f32 v109, -v181, v220, v109
    ds_read_b128 v[156:159], v9 offset:2880
    v_mfma_f32_16x16x32_bf16 v[68:71], v[136:139], a[20:23], v[68:71]
    v_fma_f32 v110, -v182, v220, v110
    v_fma_f32 v111, -v183, v220, v111
    s_waitcnt lgkmcnt(6)
    v_mfma_f32_16x16x32_bf16 v[84:87], v[140:143], a[20:23], v[84:87]
    v_fma_f32 v120, -v176, v221, v120
    ds_read_b128 v[160:163], v9 offset:2944
    v_mfma_f32_16x16x32_bf16 v[80:83], v[140:143], a[16:19], v[80:83]
    v_fma_f32 v121, -v177, v221, v121
    v_fma_f32 v122, -v178, v221, v122
    s_waitcnt lgkmcnt(5)
    v_mfma_f32_16x16x32_bf16 v[96:99], a[16:19], v[144:147], v[96:99]
    v_fma_f32 v123, -v179, v221, v123
    ds_read_b128 v[164:167], v9 offset:3008
    v_mfma_f32_16x16x32_bf16 v[100:103], a[20:23], v[144:147], v[100:103]
    v_fma_f32 v124, -v180, v221, v124
    v_fma_f32 v125, -v181, v221, v125
    s_waitcnt lgkmcnt(4)
    v_mfma_f32_16x16x32_bf16 v[116:119], a[20:23], v[148:151], v[116:119]
    v_fma_f32 v126, -v182, v221, v126
    v_mfma_f32_16x16x32_bf16 v[112:115], a[16:19], v[148:151], v[112:115]
    v_fma_f32 v127, -v183, v221, v127
    s_barrier
    s_waitcnt vmcnt(0)
    v_mfma_f32_16x16x32_bf16 v[40:43], v[128:131], a[24:27], v[40:43]
    v_mul_f32 v64, v185, v64
    v_mul_f32 v65, v185, v65
    v_mfma_f32_16x16x32_bf16 v[44:47], v[128:131], a[28:31], v[44:47]
    v_mul_f32 v66, v185, v66
    v_mul_f32 v67, v185, v67
    v_mfma_f32_16x16x32_bf16 v[60:63], v[132:135], a[28:31], v[60:63]
    v_mul_f32 v80, v185, v80
    v_mul_f32 v81, v185, v81
    v_mfma_f32_16x16x32_bf16 v[56:59], v[132:135], a[24:27], v[56:59]
    v_mul_f32 v82, v185, v82
    v_mul_f32 v83, v185, v83
    v_mfma_f32_16x16x32_bf16 v[72:75], v[136:139], a[24:27], v[72:75]
    v_cvt_pk_bf16_f32 v64, v64, v65
    v_cvt_pk_bf16_f32 v65, v66, v67
    v_mfma_f32_16x16x32_bf16 v[76:79], v[136:139], a[28:31], v[76:79]
    v_cvt_pk_bf16_f32 v66, v80, v81
    v_cvt_pk_bf16_f32 v67, v82, v83
    v_mfma_f32_16x16x32_bf16 v[92:95], v[140:143], a[28:31], v[92:95]
    v_mul_f32 v68, v187, v68
    v_mul_f32 v69, v187, v69
    v_mfma_f32_16x16x32_bf16 v[88:91], v[140:143], a[24:27], v[88:91]
    v_mul_f32 v70, v187, v70
    v_mul_f32 v71, v187, v71
    v_mfma_f32_16x16x32_bf16 v[104:107], a[24:27], v[144:147], v[104:107]
    v_mul_f32 v84, v187, v84
    v_mul_f32 v85, v187, v85
    v_mfma_f32_16x16x32_bf16 v[108:111], a[28:31], v[144:147], v[108:111]
    v_mul_f32 v86, v187, v86
    v_mul_f32 v87, v187, v87
    v_mfma_f32_16x16x32_bf16 v[124:127], a[28:31], v[148:151], v[124:127]
    v_cvt_pk_bf16_f32 v68, v68, v69
    v_cvt_pk_bf16_f32 v69, v70, v71
    v_mfma_f32_16x16x32_bf16 v[120:123], a[24:27], v[148:151], v[120:123]
    v_cvt_pk_bf16_f32 v70, v84, v85
    v_cvt_pk_bf16_f32 v71, v86, v87
    buffer_store_dwordx4 v[64:67], v12, s[12:15], s84 offen offset:0 sc1
    ds_write_b128 v12, v[64:67] offset:0
    buffer_store_dwordx4 v[68:71], v12, s[12:15], s84 offen offset:256 sc1
    ds_write_b128 v12, v[68:71] offset:256
    v_pk_mul_f32 v[72:73], v[188:189], v[72:73] op_sel:[1,0] op_sel_hi:[1,1]
    v_pk_mul_f32 v[74:75], v[188:189], v[74:75] op_sel:[1,0] op_sel_hi:[1,1]
    v_pk_mul_f32 v[88:89], v[188:189], v[88:89] op_sel:[1,0] op_sel_hi:[1,1]
    v_pk_mul_f32 v[90:91], v[188:189], v[90:91] op_sel:[1,0] op_sel_hi:[1,1]
    v_cvt_pk_bf16_f32 v72, v72, v73
    v_cvt_pk_bf16_f32 v73, v74, v75
    v_cvt_pk_bf16_f32 v74, v88, v89
    v_cvt_pk_bf16_f32 v75, v90, v91
    buffer_store_dwordx4 v[72:75], v12, s[12:15], s84 offen offset:2048 sc1
    ds_write_b128 v12, v[72:75] offset:2048
    v_pk_mul_f32 v[76:77], v[190:191], v[76:77] op_sel:[1,0] op_sel_hi:[1,1]
    v_pk_mul_f32 v[78:79], v[190:191], v[78:79] op_sel:[1,0] op_sel_hi:[1,1]
    v_pk_mul_f32 v[92:93], v[190:191], v[92:93] op_sel:[1,0] op_sel_hi:[1,1]
    v_pk_mul_f32 v[94:95], v[190:191], v[94:95] op_sel:[1,0] op_sel_hi:[1,1]
    v_cvt_pk_bf16_f32 v76, v76, v77
    v_cvt_pk_bf16_f32 v77, v78, v79
    v_cvt_pk_bf16_f32 v78, v92, v93
    v_cvt_pk_bf16_f32 v79, v94, v95
    buffer_store_dwordx4 v[76:79], v12, s[12:15], s84 offen offset:2304 sc1
    ds_write_b128 v12, v[76:79] offset:2304
    s_waitcnt lgkmcnt(4)
    v_pk_mul_f32 v[96:97], v[152:153], v[96:97]
    v_pk_mul_f32 v[98:99], v[154:155], v[98:99]
    v_pk_mul_f32 v[112:113], v[152:153], v[112:113]
    v_pk_mul_f32 v[114:115], v[154:155], v[114:115]
    v_cvt_pk_bf16_f32 v96, v96, v97
    v_cvt_pk_bf16_f32 v97, v98, v99
    v_cvt_pk_bf16_f32 v98, v112, v113
    v_cvt_pk_bf16_f32 v99, v114, v115
    v_mul_f32 v185, 0x3e8293ee, v185
    v_permlane16_swap_b32 v96, v98
    v_permlane16_swap_b32 v97, v99
    buffer_store_dwordx4 v[96:99], v13, s[12:15], s85 offen offset:0 sc1
    ds_write_b128 v13, v[96:99] offset:8192
    v_pk_mul_f32 v[100:101], v[156:157], v[100:101]
    v_pk_mul_f32 v[102:103], v[158:159], v[102:103]
    v_pk_mul_f32 v[116:117], v[156:157], v[116:117]
    v_pk_mul_f32 v[118:119], v[158:159], v[118:119]
    v_cvt_pk_bf16_f32 v100, v100, v101
    v_cvt_pk_bf16_f32 v101, v102, v103
    v_cvt_pk_bf16_f32 v102, v116, v117
    v_cvt_pk_bf16_f32 v103, v118, v119
    v_mul_f32 v187, 0x3e8293ee, v187
    v_permlane16_swap_b32 v100, v102
    v_permlane16_swap_b32 v101, v103
    buffer_store_dwordx4 v[100:103], v13, s[12:15], s85 offen offset:1024 sc1
    ds_write_b128 v13, v[100:103] offset:9216
    v_pk_mul_f32 v[104:105], v[160:161], v[104:105]
    v_pk_mul_f32 v[106:107], v[162:163], v[106:107]
    v_pk_mul_f32 v[120:121], v[160:161], v[120:121]
    v_pk_mul_f32 v[122:123], v[162:163], v[122:123]
    v_cvt_pk_bf16_f32 v104, v104, v105
    v_cvt_pk_bf16_f32 v105, v106, v107
    v_cvt_pk_bf16_f32 v106, v120, v121
    v_cvt_pk_bf16_f32 v107, v122, v123
    v_mul_f32 v189, 0x3e8293ee, v189
    v_permlane16_swap_b32 v104, v106
    v_permlane16_swap_b32 v105, v107
    buffer_store_dwordx4 v[104:107], v13, s[12:15], s85 offen offset:2048 sc1
    ds_write_b128 v13, v[104:107] offset:10240
    v_pk_mul_f32 v[108:109], v[164:165], v[108:109]
    v_pk_mul_f32 v[110:111], v[166:167], v[110:111]
    v_pk_mul_f32 v[124:125], v[164:165], v[124:125]
    v_pk_mul_f32 v[126:127], v[166:167], v[126:127]
    v_cvt_pk_bf16_f32 v108, v108, v109
    v_cvt_pk_bf16_f32 v109, v110, v111
    v_cvt_pk_bf16_f32 v110, v124, v125
    v_cvt_pk_bf16_f32 v111, v126, v127
    v_mul_f32 v191, 0x3e8293ee, v191
    v_permlane16_swap_b32 v108, v110
    v_permlane16_swap_b32 v109, v111
    buffer_store_dwordx4 v[108:111], v13, s[12:15], s85 offen offset:3072 sc1
    ds_write_b128 v13, v[108:111] offset:11264
    v_add_u32 v24, 81920, v5
    s_waitcnt lgkmcnt(0)
    s_barrier
    ds_read_b128 v[128:131], v24 offset:0
    ds_read_b128 v[132:135], v24 offset:1024
    ds_read_b128 v[136:139], v24 offset:2048
    ds_read_b128 v[140:143], v24 offset:3072
    v_pk_mul_f32 v[32:33], v[184:185], v[32:33] op_sel:[1,0] op_sel_hi:[1,1]
    v_pk_mul_f32 v[34:35], v[184:185], v[34:35] op_sel:[1,0] op_sel_hi:[1,1]
    v_pk_mul_f32 v[48:49], v[184:185], v[48:49] op_sel:[1,0] op_sel_hi:[1,1]
    v_pk_mul_f32 v[50:51], v[184:185], v[50:51] op_sel:[1,0] op_sel_hi:[1,1]
    v_cvt_pk_bf16_f32 v8, v32, v33
    v_cvt_pk_bf16_f32 v9, v34, v35
    v_cvt_pk_bf16_f32 v10, v48, v49
    v_cvt_pk_bf16_f32 v11, v50, v51
    v_pk_mul_f32 v[36:37], v[186:187], v[36:37] op_sel:[1,0] op_sel_hi:[1,1]
    v_pk_mul_f32 v[38:39], v[186:187], v[38:39] op_sel:[1,0] op_sel_hi:[1,1]
    v_pk_mul_f32 v[52:53], v[186:187], v[52:53] op_sel:[1,0] op_sel_hi:[1,1]
    v_pk_mul_f32 v[54:55], v[186:187], v[54:55] op_sel:[1,0] op_sel_hi:[1,1]
    v_cvt_pk_bf16_f32 v12, v36, v37
    v_cvt_pk_bf16_f32 v13, v38, v39
    v_cvt_pk_bf16_f32 v14, v52, v53
    v_cvt_pk_bf16_f32 v15, v54, v55
    v_pk_mul_f32 v[40:41], v[188:189], v[40:41] op_sel:[1,0] op_sel_hi:[1,1]
    v_pk_mul_f32 v[42:43], v[188:189], v[42:43] op_sel:[1,0] op_sel_hi:[1,1]
    v_pk_mul_f32 v[56:57], v[188:189], v[56:57] op_sel:[1,0] op_sel_hi:[1,1]
    v_pk_mul_f32 v[58:59], v[188:189], v[58:59] op_sel:[1,0] op_sel_hi:[1,1]
    v_cvt_pk_bf16_f32 v16, v40, v41
    v_cvt_pk_bf16_f32 v17, v42, v43
    v_cvt_pk_bf16_f32 v18, v56, v57
    v_cvt_pk_bf16_f32 v19, v58, v59
    v_pk_mul_f32 v[44:45], v[190:191], v[44:45] op_sel:[1,0] op_sel_hi:[1,1]
    v_pk_mul_f32 v[46:47], v[190:191], v[46:47] op_sel:[1,0] op_sel_hi:[1,1]
    v_pk_mul_f32 v[60:61], v[190:191], v[60:61] op_sel:[1,0] op_sel_hi:[1,1]
    v_pk_mul_f32 v[62:63], v[190:191], v[62:63] op_sel:[1,0] op_sel_hi:[1,1]
    v_cvt_pk_bf16_f32 v20, v44, v45
    v_cvt_pk_bf16_f32 v21, v46, v47
    v_cvt_pk_bf16_f32 v22, v60, v61
    v_cvt_pk_bf16_f32 v23, v62, v63
    v_permlane16_swap_b32 v8, v12
    v_permlane16_swap_b32 v9, v13
    v_permlane16_swap_b32 v10, v14
    v_permlane16_swap_b32 v11, v15
    v_permlane16_swap_b32 v16, v20
    v_permlane16_swap_b32 v17, v21
    v_permlane16_swap_b32 v18, v22
    v_permlane16_swap_b32 v19, v23
    s_waitcnt lgkmcnt(0)
    v_mfma_f32_32x32x16_bf16 v[64:79], v[128:131], v[8:11], 0
    v_mfma_f32_32x32x16_bf16 v[64:79], v[132:135], v[12:15], v[64:79]
    v_and_b32 v25, 7, v1
    v_mov_b32 v26, 0x3f803f80
    v_cmp_eq_u32 vcc, 0, v25
    s_nop 1
    v_cndmask_b32 v200, 0, v26, vcc
    v_cndmask_b32 v201, 0, v26, vcc
    v_cmp_eq_u32 vcc, 4, v25
    s_nop 1
    v_cndmask_b32 v202, 0, v26, vcc
    v_cndmask_b32 v203, 0, v26, vcc
    v_mov_b32 v204, 0xdddddddd
    v_mov_b32 v160, 0
    v_mov_b32 v161, 0
    v_mov_b32 v162, 0
    v_mov_b32 v163, 0
    v_mov_b32 v164, 0
    v_mov_b32 v165, 0
    v_mov_b32 v166, 0
    v_mov_b32 v167, 0
    v_mov_b32 v168, 0
    v_mov_b32 v169, 0
    v_mov_b32 v170, 0
    v_mov_b32 v171, 0
    v_mov_b32 v172, 0
    v_mov_b32 v173, 0
    v_mov_b32 v174, 0
    v_mov_b32 v175, 0
    v_mov_b32 v192, 0
    v_mov_b32 v193, 0
    v_mov_b32 v194, 0
    v_mov_b32 v195, 0
    v_mov_b32 v176, 0
    v_mov_b32 v177, 0
    v_mov_b32 v178, 0
    v_mov_b32 v179, 0
    v_mov_b32 v180, 0
    v_mov_b32 v181, 0
    v_mov_b32 v182, 0
    v_mov_b32 v183, 0
    v_mov_b32 v184, 0
    v_mov_b32 v185, 0
    v_mov_b32 v186, 0
    v_mov_b32 v187, 0
    v_mov_b32 v188, 0
    v_mov_b32 v189, 0
    v_mov_b32 v190, 0
    v_mov_b32 v191, 0
    v_mov_b32 v196, 0
    v_mov_b32 v197, 0
    v_mov_b32 v198, 0
    v_mov_b32 v199, 0
    v_mov_b32 v112, 0
    v_mov_b32 v113, 0
    v_mov_b32 v114, 0
    v_mov_b32 v115, 0
    v_mov_b32 v116, 0
    v_mov_b32 v117, 0
    v_mov_b32 v118, 0
    v_mov_b32 v119, 0
    v_mov_b32 v120, 0
    v_mov_b32 v121, 0
    v_mov_b32 v122, 0
    v_mov_b32 v123, 0
    v_mov_b32 v124, 0
    v_mov_b32 v125, 0
    v_mov_b32 v126, 0
    v_mov_b32 v127, 0
    v_mov_b32 v152, 0
    v_mov_b32 v153, 0
    v_mov_b32 v154, 0
    v_mov_b32 v155, 0
    v_mov_b32 v156, 0
    v_mov_b32 v157, 0
    v_mov_b32 v158, 0
    v_mov_b32 v159, 0
    s_mov_b32 s54, 4
    s_mov_b64 exec, 0xff
    s_waitcnt vmcnt(0)
    buffer_store_dword v29, v28, s[12:15], s53 offen sc1
    s_mov_b64 exec, -1
.p2align 3
c_attn_loop:
    v_mfma_f32_32x32x16_bf16 v[80:95], v[128:131], v[16:19], 0
    v_exp_f32 v64, v64
    v_exp_f32 v65, v65
    v_exp_f32 v66, v66
    v_mfma_f32_32x32x16_bf16 v[80:95], v[132:135], v[20:23], v[80:95]
    v_exp_f32 v67, v67
    v_exp_f32 v68, v68
    v_exp_f32 v69, v69
    v_smfmac_f32_32x32x32_bf16 v[176:191], v[152:155], v[112:119], v204
    s_waitcnt lgkmcnt(0)
    v_exp_f32 v70, v70
    v_exp_f32 v71, v71
    v_exp_f32 v72, v72
    v_smfmac_f32_16x16x64_bf16 v[196:199], v[200:203], v[112:119], v204
    ds_read_b128 v[144:147], v24 offset:8192
    v_exp_f32 v73, v73
    v_exp_f32 v74, v74
    v_smfmac_f32_32x32x32_bf16 v[176:191], v[156:159], v[120:127], v204
    v_exp_f32 v75, v75
    v_exp_f32 v76, v76
    v_exp_f32 v77, v77
    v_smfmac_f32_16x16x64_bf16 v[196:199], v[200:203], v[120:127], v204
    ds_read_b128 v[148:151], v24 offset:9216
    v_exp_f32 v78, v78
    v_exp_f32 v79, v79
    v_mfma_f32_32x32x16_bf16 v[96:111], v[136:139], v[8:11], 0
    v_exp_f32 v80, v80
    v_exp_f32 v81, v81
    v_exp_f32 v82, v82
    v_mfma_f32_32x32x16_bf16 v[96:111], v[140:143], v[12:15], v[96:111]
    s_waitcnt lgkmcnt(1)
    v_exp_f32 v83, v83
    v_exp_f32 v84, v84
    v_exp_f32 v85, v85
    v_smfmac_f32_32x32x32_bf16 v[160:175], v[144:147], v[64:71], v204
    s_waitcnt lgkmcnt(0)
    v_exp_f32 v86, v86
    v_exp_f32 v87, v87
    v_exp_f32 v88, v88
    v_smfmac_f32_16x16x64_bf16 v[192:195], v[200:203], v[64:71], v204
    ds_read_b128 v[128:131], v24 offset:4096
    v_exp_f32 v89, v89
    v_exp_f32 v90, v90
    v_smfmac_f32_32x32x32_bf16 v[160:175], v[148:151], v[72:79], v204
    v_exp_f32 v91, v91
    v_exp_f32 v92, v92
    v_exp_f32 v93, v93
    v_smfmac_f32_16x16x64_bf16 v[192:195], v[200:203], v[72:79], v204
    ds_read_b128 v[132:135], v24 offset:5120
    v_exp_f32 v94, v94
    v_exp_f32 v95, v95
    v_mfma_f32_32x32x16_bf16 v[112:127], v[136:139], v[16:19], 0
    v_exp_f32 v96, v96
    v_exp_f32 v97, v97
    v_exp_f32 v98, v98
    v_mfma_f32_32x32x16_bf16 v[112:127], v[140:143], v[20:23], v[112:127]
    v_exp_f32 v99, v99
    v_exp_f32 v100, v100
    v_exp_f32 v101, v101
    v_smfmac_f32_32x32x32_bf16 v[176:191], v[144:147], v[80:87], v204
    s_waitcnt lgkmcnt(0)
    v_exp_f32 v102, v102
    v_exp_f32 v103, v103
    v_exp_f32 v104, v104
    v_smfmac_f32_16x16x64_bf16 v[196:199], v[200:203], v[80:87], v204
    ds_read_b128 v[152:155], v24 offset:10240
    v_exp_f32 v105, v105
    v_exp_f32 v106, v106
    v_smfmac_f32_32x32x32_bf16 v[176:191], v[148:151], v[88:95], v204
    v_exp_f32 v107, v107
    v_exp_f32 v108, v108
    v_exp_f32 v109, v109
    v_smfmac_f32_16x16x64_bf16 v[196:199], v[200:203], v[88:95], v204
    ds_read_b128 v[156:159], v24 offset:11264
    v_exp_f32 v110, v110
    v_exp_f32 v111, v111
    v_mfma_f32_32x32x16_bf16 v[64:79], v[128:131], v[8:11], 0
    v_exp_f32 v112, v112
    v_exp_f32 v113, v113
    v_exp_f32 v114, v114
    v_mfma_f32_32x32x16_bf16 v[64:79], v[132:135], v[12:15], v[64:79]
    s_waitcnt lgkmcnt(1)
    v_exp_f32 v115, v115
    v_exp_f32 v116, v116
    v_exp_f32 v117, v117
    v_smfmac_f32_32x32x32_bf16 v[160:175], v[152:155], v[96:103], v204
    s_waitcnt lgkmcnt(0)
    v_exp_f32 v118, v118
    v_exp_f32 v119, v119
    v_exp_f32 v120, v120
    v_smfmac_f32_16x16x64_bf16 v[192:195], v[200:203], v[96:103], v204
    ds_read_b128 v[136:139], v24 offset:6144
    v_exp_f32 v121, v121
    v_exp_f32 v122, v122
    v_smfmac_f32_32x32x32_bf16 v[160:175], v[156:159], v[104:111], v204
    v_exp_f32 v123, v123
    v_exp_f32 v124, v124
    v_exp_f32 v125, v125
    v_smfmac_f32_16x16x64_bf16 v[192:195], v[200:203], v[104:111], v204
    ds_read_b128 v[140:143], v24 offset:7168
    v_exp_f32 v126, v126
    v_exp_f32 v127, v127
    v_mfma_f32_32x32x16_bf16 v[80:95], v[128:131], v[16:19], 0
    s_cmp_eq_u32 s54, 4
    v_exp_f32 v64, v64
    v_exp_f32 v65, v65
    v_exp_f32 v66, v66
    v_mfma_f32_32x32x16_bf16 v[80:95], v[132:135], v[20:23], v[80:95]
    v_exp_f32 v67, v67
    v_exp_f32 v68, v68
    v_exp_f32 v69, v69
    v_smfmac_f32_32x32x32_bf16 v[176:191], v[152:155], v[112:119], v204
    s_waitcnt lgkmcnt(0)
    v_exp_f32 v70, v70
    v_exp_f32 v71, v71
    v_exp_f32 v72, v72
    v_smfmac_f32_16x16x64_bf16 v[196:199], v[200:203], v[112:119], v204
    ds_read_b128 v[144:147], v24 offset:12288
    v_exp_f32 v73, v73
    v_exp_f32 v74, v74
    v_smfmac_f32_32x32x32_bf16 v[176:191], v[156:159], v[120:127], v204
    v_exp_f32 v75, v75
    v_exp_f32 v76, v76
    v_exp_f32 v77, v77
    v_smfmac_f32_16x16x64_bf16 v[196:199], v[200:203], v[120:127], v204
    ds_read_b128 v[148:151], v24 offset:13312
    v_exp_f32 v78, v78
    v_exp_f32 v79, v79
    v_mfma_f32_32x32x16_bf16 v[96:111], v[136:139], v[8:11], 0
    s_cbranch_scc1 c_attn_nobar
    s_barrier
c_attn_nobar:
    v_exp_f32 v80, v80
    v_exp_f32 v81, v81
    v_exp_f32 v82, v82
    v_mfma_f32_32x32x16_bf16 v[96:111], v[140:143], v[12:15], v[96:111]
    s_waitcnt lgkmcnt(1)
    v_exp_f32 v83, v83
    v_exp_f32 v84, v84
    v_exp_f32 v85, v85
    v_smfmac_f32_32x32x32_bf16 v[160:175], v[144:147], v[64:71], v204
    s_waitcnt lgkmcnt(0)
    v_exp_f32 v86, v86
    v_exp_f32 v87, v87
    v_exp_f32 v88, v88
    v_smfmac_f32_16x16x64_bf16 v[192:195], v[200:203], v[64:71], v204
    ds_read_b128 v[128:131], v24 offset:16384
    v_exp_f32 v89, v89
    v_exp_f32 v90, v90
    v_smfmac_f32_32x32x32_bf16 v[160:175], v[148:151], v[72:79], v204
    v_exp_f32 v91, v91
    v_exp_f32 v92, v92
    v_exp_f32 v93, v93
    v_smfmac_f32_16x16x64_bf16 v[192:195], v[200:203], v[72:79], v204
    ds_read_b128 v[132:135], v24 offset:17408
    v_exp_f32 v94, v94
    v_exp_f32 v95, v95
    v_mfma_f32_32x32x16_bf16 v[112:127], v[136:139], v[16:19], 0
    v_exp_f32 v96, v96
    v_exp_f32 v97, v97
    v_exp_f32 v98, v98
    v_mfma_f32_32x32x16_bf16 v[112:127], v[140:143], v[20:23], v[112:127]
    v_exp_f32 v99, v99
    v_exp_f32 v100, v100
    v_exp_f32 v101, v101
    v_smfmac_f32_32x32x32_bf16 v[176:191], v[144:147], v[80:87], v204
    s_waitcnt lgkmcnt(0)
    v_exp_f32 v102, v102
    v_exp_f32 v103, v103
    v_exp_f32 v104, v104
    v_smfmac_f32_16x16x64_bf16 v[196:199], v[200:203], v[80:87], v204
    ds_read_b128 v[152:155], v24 offset:14336
    v_exp_f32 v105, v105
    v_exp_f32 v106, v106
    v_smfmac_f32_32x32x32_bf16 v[176:191], v[148:151], v[88:95], v204
    v_exp_f32 v107, v107
    v_exp_f32 v108, v108
    v_exp_f32 v109, v109
    v_smfmac_f32_16x16x64_bf16 v[196:199], v[200:203], v[88:95], v204
    ds_read_b128 v[156:159], v24 offset:15360
    v_exp_f32 v110, v110
    v_exp_f32 v111, v111
    v_mfma_f32_32x32x16_bf16 v[64:79], v[128:131], v[8:11], 0
    v_exp_f32 v112, v112
    v_exp_f32 v113, v113
    v_exp_f32 v114, v114
    v_mfma_f32_32x32x16_bf16 v[64:79], v[132:135], v[12:15], v[64:79]
    s_waitcnt lgkmcnt(1)
    v_exp_f32 v115, v115
    v_exp_f32 v116, v116
    v_exp_f32 v117, v117
    v_smfmac_f32_32x32x32_bf16 v[160:175], v[152:155], v[96:103], v204
    s_waitcnt lgkmcnt(0)
    v_exp_f32 v118, v118
    v_exp_f32 v119, v119
    v_exp_f32 v120, v120
    v_smfmac_f32_16x16x64_bf16 v[192:195], v[200:203], v[96:103], v204
    ds_read_b128 v[136:139], v24 offset:18432
    v_exp_f32 v121, v121
    v_exp_f32 v122, v122
    v_smfmac_f32_32x32x32_bf16 v[160:175], v[156:159], v[104:111], v204
    v_exp_f32 v123, v123
    v_exp_f32 v124, v124
    v_exp_f32 v125, v125
    v_smfmac_f32_16x16x64_bf16 v[192:195], v[200:203], v[104:111], v204
    ds_read_b128 v[140:143], v24 offset:19456
    v_exp_f32 v126, v126
    v_exp_f32 v127, v127
    v_mfma_f32_32x32x16_bf16 v[80:95], v[128:131], v[16:19], 0
    v_exp_f32 v64, v64
    v_exp_f32 v65, v65
    v_exp_f32 v66, v66
    v_mfma_f32_32x32x16_bf16 v[80:95], v[132:135], v[20:23], v[80:95]
    v_exp_f32 v67, v67
    v_exp_f32 v68, v68
    v_exp_f32 v69, v69
    v_smfmac_f32_32x32x32_bf16 v[176:191], v[152:155], v[112:119], v204
    s_waitcnt lgkmcnt(0)
    v_exp_f32 v70, v70
    v_exp_f32 v71, v71
    v_exp_f32 v72, v72
    v_smfmac_f32_16x16x64_bf16 v[196:199], v[200:203], v[112:119], v204
    ds_read_b128 v[144:147], v24 offset:24576
    v_exp_f32 v73, v73
    v_exp_f32 v74, v74
    v_smfmac_f32_32x32x32_bf16 v[176:191], v[156:159], v[120:127], v204
    v_exp_f32 v75, v75
    v_exp_f32 v76, v76
    v_exp_f32 v77, v77
    v_smfmac_f32_16x16x64_bf16 v[196:199], v[200:203], v[120:127], v204
    ds_read_b128 v[148:151], v24 offset:25600
    v_exp_f32 v78, v78
    v_exp_f32 v79, v79
    v_mfma_f32_32x32x16_bf16 v[96:111], v[136:139], v[8:11], 0
    v_exp_f32 v80, v80
    v_exp_f32 v81, v81
    v_exp_f32 v82, v82
    v_mfma_f32_32x32x16_bf16 v[96:111], v[140:143], v[12:15], v[96:111]
    s_waitcnt lgkmcnt(1)
    v_exp_f32 v83, v83
    v_exp_f32 v84, v84
    v_exp_f32 v85, v85
    v_smfmac_f32_32x32x32_bf16 v[160:175], v[144:147], v[64:71], v204
    s_waitcnt lgkmcnt(0)
    v_exp_f32 v86, v86
    v_exp_f32 v87, v87
    v_exp_f32 v88, v88
    v_smfmac_f32_16x16x64_bf16 v[192:195], v[200:203], v[64:71], v204
    ds_read_b128 v[128:131], v24 offset:20480
    v_exp_f32 v89, v89
    v_exp_f32 v90, v90
    v_smfmac_f32_32x32x32_bf16 v[160:175], v[148:151], v[72:79], v204
    v_exp_f32 v91, v91
    v_exp_f32 v92, v92
    v_exp_f32 v93, v93
    v_smfmac_f32_16x16x64_bf16 v[192:195], v[200:203], v[72:79], v204
    ds_read_b128 v[132:135], v24 offset:21504
    v_exp_f32 v94, v94
    v_exp_f32 v95, v95
    v_mfma_f32_32x32x16_bf16 v[112:127], v[136:139], v[16:19], 0
    v_exp_f32 v96, v96
    v_exp_f32 v97, v97
    v_exp_f32 v98, v98
    v_mfma_f32_32x32x16_bf16 v[112:127], v[140:143], v[20:23], v[112:127]
    v_exp_f32 v99, v99
    v_exp_f32 v100, v100
    v_exp_f32 v101, v101
    v_smfmac_f32_32x32x32_bf16 v[176:191], v[144:147], v[80:87], v204
    s_waitcnt lgkmcnt(0)
    v_exp_f32 v102, v102
    v_exp_f32 v103, v103
    v_exp_f32 v104, v104
    v_smfmac_f32_16x16x64_bf16 v[196:199], v[200:203], v[80:87], v204
    ds_read_b128 v[152:155], v24 offset:26624
    v_exp_f32 v105, v105
    v_exp_f32 v106, v106
    v_smfmac_f32_32x32x32_bf16 v[176:191], v[148:151], v[88:95], v204
    v_exp_f32 v107, v107
    v_exp_f32 v108, v108
    v_exp_f32 v109, v109
    v_smfmac_f32_16x16x64_bf16 v[196:199], v[200:203], v[88:95], v204
    ds_read_b128 v[156:159], v24 offset:27648
    v_exp_f32 v110, v110
    v_exp_f32 v111, v111
    v_mfma_f32_32x32x16_bf16 v[64:79], v[128:131], v[8:11], 0
    v_exp_f32 v112, v112
    v_exp_f32 v113, v113
    v_exp_f32 v114, v114
    v_mfma_f32_32x32x16_bf16 v[64:79], v[132:135], v[12:15], v[64:79]
    s_waitcnt lgkmcnt(1)
    v_exp_f32 v115, v115
    v_exp_f32 v116, v116
    v_exp_f32 v117, v117
    v_smfmac_f32_32x32x32_bf16 v[160:175], v[152:155], v[96:103], v204
    s_waitcnt lgkmcnt(0)
    v_exp_f32 v118, v118
    v_exp_f32 v119, v119
    v_exp_f32 v120, v120
    v_smfmac_f32_16x16x64_bf16 v[192:195], v[200:203], v[96:103], v204
    ds_read_b128 v[136:139], v24 offset:22528
    v_exp_f32 v121, v121
    v_exp_f32 v122, v122
    v_smfmac_f32_32x32x32_bf16 v[160:175], v[156:159], v[104:111], v204
    v_exp_f32 v123, v123
    v_exp_f32 v124, v124
    v_exp_f32 v125, v125
    v_smfmac_f32_16x16x64_bf16 v[192:195], v[200:203], v[104:111], v204
    ds_read_b128 v[140:143], v24 offset:23552
    v_exp_f32 v126, v126
    v_exp_f32 v127, v127
    v_mfma_f32_32x32x16_bf16 v[80:95], v[128:131], v[16:19], 0
    v_exp_f32 v64, v64
    v_exp_f32 v65, v65
    v_exp_f32 v66, v66
    v_mfma_f32_32x32x16_bf16 v[80:95], v[132:135], v[20:23], v[80:95]
    v_exp_f32 v67, v67
    v_exp_f32 v68, v68
    v_exp_f32 v69, v69
    v_smfmac_f32_32x32x32_bf16 v[176:191], v[152:155], v[112:119], v204
    s_waitcnt lgkmcnt(0)
    v_exp_f32 v70, v70
    v_exp_f32 v71, v71
    v_exp_f32 v72, v72
    v_smfmac_f32_16x16x64_bf16 v[196:199], v[200:203], v[112:119], v204
    ds_read_b128 v[144:147], v24 offset:28672
    v_exp_f32 v73, v73
    v_exp_f32 v74, v74
    v_smfmac_f32_32x32x32_bf16 v[176:191], v[156:159], v[120:127], v204
    v_exp_f32 v75, v75
    v_exp_f32 v76, v76
    v_exp_f32 v77, v77
    v_smfmac_f32_16x16x64_bf16 v[196:199], v[200:203], v[120:127], v204
    ds_read_b128 v[148:151], v24 offset:29696
    v_exp_f32 v78, v78
    v_exp_f32 v79, v79
    v_mfma_f32_32x32x16_bf16 v[96:111], v[136:139], v[8:11], 0
    s_barrier
    v_exp_f32 v80, v80
    v_exp_f32 v81, v81
    v_exp_f32 v82, v82
    v_mfma_f32_32x32x16_bf16 v[96:111], v[140:143], v[12:15], v[96:111]
    s_waitcnt lgkmcnt(1)
    v_exp_f32 v83, v83
    v_exp_f32 v84, v84
    v_exp_f32 v85, v85
    v_smfmac_f32_32x32x32_bf16 v[160:175], v[144:147], v[64:71], v204
    s_waitcnt lgkmcnt(0)
    v_exp_f32 v86, v86
    v_exp_f32 v87, v87
    v_exp_f32 v88, v88
    v_smfmac_f32_16x16x64_bf16 v[192:195], v[200:203], v[64:71], v204
    ds_read_b128 v[128:131], v24 offset:32768
    v_exp_f32 v89, v89
    v_exp_f32 v90, v90
    v_smfmac_f32_32x32x32_bf16 v[160:175], v[148:151], v[72:79], v204
    v_exp_f32 v91, v91
    v_exp_f32 v92, v92
    v_exp_f32 v93, v93
    v_smfmac_f32_16x16x64_bf16 v[192:195], v[200:203], v[72:79], v204
    ds_read_b128 v[132:135], v24 offset:33792
    v_exp_f32 v94, v94
    v_exp_f32 v95, v95
    v_mfma_f32_32x32x16_bf16 v[112:127], v[136:139], v[16:19], 0
    v_exp_f32 v96, v96
    v_exp_f32 v97, v97
    v_exp_f32 v98, v98
    v_mfma_f32_32x32x16_bf16 v[112:127], v[140:143], v[20:23], v[112:127]
    v_exp_f32 v99, v99
    v_exp_f32 v100, v100
    v_exp_f32 v101, v101
    v_smfmac_f32_32x32x32_bf16 v[176:191], v[144:147], v[80:87], v204
    s_waitcnt lgkmcnt(0)
    v_exp_f32 v102, v102
    v_exp_f32 v103, v103
    v_exp_f32 v104, v104
    v_smfmac_f32_16x16x64_bf16 v[196:199], v[200:203], v[80:87], v204
    ds_read_b128 v[152:155], v24 offset:30720
    v_exp_f32 v105, v105
    v_exp_f32 v106, v106
    v_smfmac_f32_32x32x32_bf16 v[176:191], v[148:151], v[88:95], v204
    v_exp_f32 v107, v107
    v_exp_f32 v108, v108
    v_exp_f32 v109, v109
    v_smfmac_f32_16x16x64_bf16 v[196:199], v[200:203], v[88:95], v204
    ds_read_b128 v[156:159], v24 offset:31744
    v_exp_f32 v110, v110
    v_exp_f32 v111, v111
    v_mfma_f32_32x32x16_bf16 v[64:79], v[128:131], v[8:11], 0
    v_exp_f32 v112, v112
    v_exp_f32 v113, v113
    v_exp_f32 v114, v114
    v_mfma_f32_32x32x16_bf16 v[64:79], v[132:135], v[12:15], v[64:79]
    s_waitcnt lgkmcnt(1)
    v_exp_f32 v115, v115
    v_exp_f32 v116, v116
    v_exp_f32 v117, v117
    v_smfmac_f32_32x32x32_bf16 v[160:175], v[152:155], v[96:103], v204
    s_waitcnt lgkmcnt(0)
    v_exp_f32 v118, v118
    v_exp_f32 v119, v119
    v_exp_f32 v120, v120
    v_smfmac_f32_16x16x64_bf16 v[192:195], v[200:203], v[96:103], v204
    ds_read_b128 v[136:139], v24 offset:34816
    v_exp_f32 v121, v121
    v_exp_f32 v122, v122
    v_smfmac_f32_32x32x32_bf16 v[160:175], v[156:159], v[104:111], v204
    v_exp_f32 v123, v123
    v_exp_f32 v124, v124
    v_exp_f32 v125, v125
    v_smfmac_f32_16x16x64_bf16 v[192:195], v[200:203], v[104:111], v204
    ds_read_b128 v[140:143], v24 offset:35840
    v_exp_f32 v126, v126
    v_exp_f32 v127, v127
    v_mfma_f32_32x32x16_bf16 v[80:95], v[128:131], v[16:19], 0
    v_exp_f32 v64, v64
    v_exp_f32 v65, v65
    v_exp_f32 v66, v66
    v_mfma_f32_32x32x16_bf16 v[80:95], v[132:135], v[20:23], v[80:95]
    v_exp_f32 v67, v67
    v_exp_f32 v68, v68
    v_exp_f32 v69, v69
    v_smfmac_f32_32x32x32_bf16 v[176:191], v[152:155], v[112:119], v204
    s_waitcnt lgkmcnt(0)
    v_exp_f32 v70, v70
    v_exp_f32 v71, v71
    v_exp_f32 v72, v72
    v_smfmac_f32_16x16x64_bf16 v[196:199], v[200:203], v[112:119], v204
    ds_read_b128 v[144:147], v24 offset:40960
    v_exp_f32 v73, v73
    v_exp_f32 v74, v74
    v_smfmac_f32_32x32x32_bf16 v[176:191], v[156:159], v[120:127], v204
    v_exp_f32 v75, v75
    v_exp_f32 v76, v76
    v_exp_f32 v77, v77
    v_smfmac_f32_16x16x64_bf16 v[196:199], v[200:203], v[120:127], v204
    ds_read_b128 v[148:151], v24 offset:41984
    v_exp_f32 v78, v78
    v_exp_f32 v79, v79
    v_mfma_f32_32x32x16_bf16 v[96:111], v[136:139], v[8:11], 0
    v_exp_f32 v80, v80
    v_exp_f32 v81, v81
    v_exp_f32 v82, v82
    v_mfma_f32_32x32x16_bf16 v[96:111], v[140:143], v[12:15], v[96:111]
    s_waitcnt lgkmcnt(1)
    v_exp_f32 v83, v83
    v_exp_f32 v84, v84
    v_exp_f32 v85, v85
    v_smfmac_f32_32x32x32_bf16 v[160:175], v[144:147], v[64:71], v204
    s_waitcnt lgkmcnt(0)
    v_exp_f32 v86, v86
    v_exp_f32 v87, v87
    v_exp_f32 v88, v88
    v_smfmac_f32_16x16x64_bf16 v[192:195], v[200:203], v[64:71], v204
    ds_read_b128 v[128:131], v24 offset:36864
    v_exp_f32 v89, v89
    v_exp_f32 v90, v90
    v_smfmac_f32_32x32x32_bf16 v[160:175], v[148:151], v[72:79], v204
    v_exp_f32 v91, v91
    v_exp_f32 v92, v92
    v_exp_f32 v93, v93
    v_smfmac_f32_16x16x64_bf16 v[192:195], v[200:203], v[72:79], v204
    ds_read_b128 v[132:135], v24 offset:37888
    v_exp_f32 v94, v94
    v_exp_f32 v95, v95
    v_mfma_f32_32x32x16_bf16 v[112:127], v[136:139], v[16:19], 0
    v_exp_f32 v96, v96
    v_exp_f32 v97, v97
    v_exp_f32 v98, v98
    v_mfma_f32_32x32x16_bf16 v[112:127], v[140:143], v[20:23], v[112:127]
    v_exp_f32 v99, v99
    v_exp_f32 v100, v100
    v_exp_f32 v101, v101
    v_smfmac_f32_32x32x32_bf16 v[176:191], v[144:147], v[80:87], v204
    s_waitcnt lgkmcnt(0)
    v_exp_f32 v102, v102
    v_exp_f32 v103, v103
    v_exp_f32 v104, v104
    v_smfmac_f32_16x16x64_bf16 v[196:199], v[200:203], v[80:87], v204
    ds_read_b128 v[152:155], v24 offset:43008
    v_exp_f32 v105, v105
    v_exp_f32 v106, v106
    v_smfmac_f32_32x32x32_bf16 v[176:191], v[148:151], v[88:95], v204
    v_exp_f32 v107, v107
    v_exp_f32 v108, v108
    v_exp_f32 v109, v109
    v_smfmac_f32_16x16x64_bf16 v[196:199], v[200:203], v[88:95], v204
    ds_read_b128 v[156:159], v24 offset:44032
    v_exp_f32 v110, v110
    v_exp_f32 v111, v111
    v_mfma_f32_32x32x16_bf16 v[64:79], v[128:131], v[8:11], 0
    v_exp_f32 v112, v112
    v_exp_f32 v113, v113
    v_exp_f32 v114, v114
    v_mfma_f32_32x32x16_bf16 v[64:79], v[132:135], v[12:15], v[64:79]
    s_waitcnt lgkmcnt(1)
    v_exp_f32 v115, v115
    v_exp_f32 v116, v116
    v_exp_f32 v117, v117
    v_smfmac_f32_32x32x32_bf16 v[160:175], v[152:155], v[96:103], v204
    s_waitcnt lgkmcnt(0)
    v_exp_f32 v118, v118
    v_exp_f32 v119, v119
    v_exp_f32 v120, v120
    v_smfmac_f32_16x16x64_bf16 v[192:195], v[200:203], v[96:103], v204
    ds_read_b128 v[136:139], v24 offset:38912
    v_exp_f32 v121, v121
    v_exp_f32 v122, v122
    v_smfmac_f32_32x32x32_bf16 v[160:175], v[156:159], v[104:111], v204
    v_exp_f32 v123, v123
    v_exp_f32 v124, v124
    v_exp_f32 v125, v125
    v_smfmac_f32_16x16x64_bf16 v[192:195], v[200:203], v[104:111], v204
    ds_read_b128 v[140:143], v24 offset:39936
    v_exp_f32 v126, v126
    v_exp_f32 v127, v127
    v_mfma_f32_32x32x16_bf16 v[80:95], v[128:131], v[16:19], 0
    v_exp_f32 v64, v64
    v_exp_f32 v65, v65
    v_exp_f32 v66, v66
    v_mfma_f32_32x32x16_bf16 v[80:95], v[132:135], v[20:23], v[80:95]
    v_exp_f32 v67, v67
    v_exp_f32 v68, v68
    v_exp_f32 v69, v69
    v_smfmac_f32_32x32x32_bf16 v[176:191], v[152:155], v[112:119], v204
    s_waitcnt lgkmcnt(0)
    v_exp_f32 v70, v70
    v_exp_f32 v71, v71
    v_exp_f32 v72, v72
    v_smfmac_f32_16x16x64_bf16 v[196:199], v[200:203], v[112:119], v204
    ds_read_b128 v[144:147], v24 offset:45056
    v_exp_f32 v73, v73
    v_exp_f32 v74, v74
    v_smfmac_f32_32x32x32_bf16 v[176:191], v[156:159], v[120:127], v204
    v_exp_f32 v75, v75
    v_exp_f32 v76, v76
    v_exp_f32 v77, v77
    v_smfmac_f32_16x16x64_bf16 v[196:199], v[200:203], v[120:127], v204
    ds_read_b128 v[148:151], v24 offset:46080
    v_exp_f32 v78, v78
    v_exp_f32 v79, v79
    v_mfma_f32_32x32x16_bf16 v[96:111], v[136:139], v[8:11], 0
    s_barrier
    v_exp_f32 v80, v80
    v_exp_f32 v81, v81
    v_exp_f32 v82, v82
    v_mfma_f32_32x32x16_bf16 v[96:111], v[140:143], v[12:15], v[96:111]
    s_waitcnt lgkmcnt(1)
    v_exp_f32 v83, v83
    v_exp_f32 v84, v84
    v_exp_f32 v85, v85
    v_smfmac_f32_32x32x32_bf16 v[160:175], v[144:147], v[64:71], v204
    s_waitcnt lgkmcnt(0)
    v_exp_f32 v86, v86
    v_exp_f32 v87, v87
    v_exp_f32 v88, v88
    v_smfmac_f32_16x16x64_bf16 v[192:195], v[200:203], v[64:71], v204
    ds_read_b128 v[128:131], v24 offset:49152
    v_exp_f32 v89, v89
    v_exp_f32 v90, v90
    v_smfmac_f32_32x32x32_bf16 v[160:175], v[148:151], v[72:79], v204
    v_exp_f32 v91, v91
    v_exp_f32 v92, v92
    v_exp_f32 v93, v93
    v_smfmac_f32_16x16x64_bf16 v[192:195], v[200:203], v[72:79], v204
    ds_read_b128 v[132:135], v24 offset:50176
    v_exp_f32 v94, v94
    v_exp_f32 v95, v95
    v_mfma_f32_32x32x16_bf16 v[112:127], v[136:139], v[16:19], 0
    v_exp_f32 v96, v96
    v_exp_f32 v97, v97
    v_exp_f32 v98, v98
    v_mfma_f32_32x32x16_bf16 v[112:127], v[140:143], v[20:23], v[112:127]
    v_exp_f32 v99, v99
    v_exp_f32 v100, v100
    v_exp_f32 v101, v101
    v_smfmac_f32_32x32x32_bf16 v[176:191], v[144:147], v[80:87], v204
    s_waitcnt lgkmcnt(0)
    v_exp_f32 v102, v102
    v_exp_f32 v103, v103
    v_exp_f32 v104, v104
    v_smfmac_f32_16x16x64_bf16 v[196:199], v[200:203], v[80:87], v204
    ds_read_b128 v[152:155], v24 offset:47104
    v_exp_f32 v105, v105
    v_exp_f32 v106, v106
    v_smfmac_f32_32x32x32_bf16 v[176:191], v[148:151], v[88:95], v204
    v_exp_f32 v107, v107
    v_exp_f32 v108, v108
    v_exp_f32 v109, v109
    v_smfmac_f32_16x16x64_bf16 v[196:199], v[200:203], v[88:95], v204
    ds_read_b128 v[156:159], v24 offset:48128
    v_exp_f32 v110, v110
    v_exp_f32 v111, v111
    v_mfma_f32_32x32x16_bf16 v[64:79], v[128:131], v[8:11], 0
    v_exp_f32 v112, v112
    v_exp_f32 v113, v113
    v_exp_f32 v114, v114
    v_mfma_f32_32x32x16_bf16 v[64:79], v[132:135], v[12:15], v[64:79]
    s_waitcnt lgkmcnt(1)
    v_exp_f32 v115, v115
    v_exp_f32 v116, v116
    v_exp_f32 v117, v117
    v_smfmac_f32_32x32x32_bf16 v[160:175], v[152:155], v[96:103], v204
    s_waitcnt lgkmcnt(0)
    v_exp_f32 v118, v118
    v_exp_f32 v119, v119
    v_exp_f32 v120, v120
    v_smfmac_f32_16x16x64_bf16 v[192:195], v[200:203], v[96:103], v204
    ds_read_b128 v[136:139], v24 offset:51200
    v_exp_f32 v121, v121
    v_exp_f32 v122, v122
    v_smfmac_f32_32x32x32_bf16 v[160:175], v[156:159], v[104:111], v204
    v_exp_f32 v123, v123
    v_exp_f32 v124, v124
    v_exp_f32 v125, v125
    v_smfmac_f32_16x16x64_bf16 v[192:195], v[200:203], v[104:111], v204
    ds_read_b128 v[140:143], v24 offset:52224
    v_exp_f32 v126, v126
    v_exp_f32 v127, v127
    v_mfma_f32_32x32x16_bf16 v[80:95], v[128:131], v[16:19], 0
    v_exp_f32 v64, v64
    v_exp_f32 v65, v65
    v_exp_f32 v66, v66
    v_mfma_f32_32x32x16_bf16 v[80:95], v[132:135], v[20:23], v[80:95]
    v_exp_f32 v67, v67
    v_exp_f32 v68, v68
    v_exp_f32 v69, v69
    v_smfmac_f32_32x32x32_bf16 v[176:191], v[152:155], v[112:119], v204
    s_waitcnt lgkmcnt(0)
    v_exp_f32 v70, v70
    v_exp_f32 v71, v71
    v_exp_f32 v72, v72
    v_smfmac_f32_16x16x64_bf16 v[196:199], v[200:203], v[112:119], v204
    ds_read_b128 v[144:147], v24 offset:57344
    v_exp_f32 v73, v73
    v_exp_f32 v74, v74
    v_smfmac_f32_32x32x32_bf16 v[176:191], v[156:159], v[120:127], v204
    v_exp_f32 v75, v75
    v_exp_f32 v76, v76
    v_exp_f32 v77, v77
    v_smfmac_f32_16x16x64_bf16 v[196:199], v[200:203], v[120:127], v204
    ds_read_b128 v[148:151], v24 offset:58368
    v_exp_f32 v78, v78
    v_exp_f32 v79, v79
    v_mfma_f32_32x32x16_bf16 v[96:111], v[136:139], v[8:11], 0
    v_exp_f32 v80, v80
    v_exp_f32 v81, v81
    v_exp_f32 v82, v82
    v_mfma_f32_32x32x16_bf16 v[96:111], v[140:143], v[12:15], v[96:111]
    s_waitcnt lgkmcnt(1)
    v_exp_f32 v83, v83
    v_exp_f32 v84, v84
    v_exp_f32 v85, v85
    v_smfmac_f32_32x32x32_bf16 v[160:175], v[144:147], v[64:71], v204
    s_waitcnt lgkmcnt(0)
    v_exp_f32 v86, v86
    v_exp_f32 v87, v87
    v_exp_f32 v88, v88
    v_smfmac_f32_16x16x64_bf16 v[192:195], v[200:203], v[64:71], v204
    ds_read_b128 v[128:131], v24 offset:53248
    v_exp_f32 v89, v89
    v_exp_f32 v90, v90
    v_smfmac_f32_32x32x32_bf16 v[160:175], v[148:151], v[72:79], v204
    v_exp_f32 v91, v91
    v_exp_f32 v92, v92
    v_exp_f32 v93, v93
    v_smfmac_f32_16x16x64_bf16 v[192:195], v[200:203], v[72:79], v204
    ds_read_b128 v[132:135], v24 offset:54272
    v_exp_f32 v94, v94
    v_exp_f32 v95, v95
    v_mfma_f32_32x32x16_bf16 v[112:127], v[136:139], v[16:19], 0
    v_exp_f32 v96, v96
    v_exp_f32 v97, v97
    v_exp_f32 v98, v98
    v_mfma_f32_32x32x16_bf16 v[112:127], v[140:143], v[20:23], v[112:127]
    v_exp_f32 v99, v99
    v_exp_f32 v100, v100
    v_exp_f32 v101, v101
    v_smfmac_f32_32x32x32_bf16 v[176:191], v[144:147], v[80:87], v204
    s_waitcnt lgkmcnt(0)
    v_exp_f32 v102, v102
    v_exp_f32 v103, v103
    v_exp_f32 v104, v104
    v_smfmac_f32_16x16x64_bf16 v[196:199], v[200:203], v[80:87], v204
    ds_read_b128 v[152:155], v24 offset:59392
    v_exp_f32 v105, v105
    v_exp_f32 v106, v106
    v_smfmac_f32_32x32x32_bf16 v[176:191], v[148:151], v[88:95], v204
    v_exp_f32 v107, v107
    v_exp_f32 v108, v108
    v_exp_f32 v109, v109
    v_smfmac_f32_16x16x64_bf16 v[196:199], v[200:203], v[88:95], v204
    ds_read_b128 v[156:159], v24 offset:60416
    v_exp_f32 v110, v110
    v_exp_f32 v111, v111
    v_mfma_f32_32x32x16_bf16 v[64:79], v[128:131], v[8:11], 0
    v_exp_f32 v112, v112
    v_exp_f32 v113, v113
    v_exp_f32 v114, v114
    v_mfma_f32_32x32x16_bf16 v[64:79], v[132:135], v[12:15], v[64:79]
    s_waitcnt lgkmcnt(1)
    v_exp_f32 v115, v115
    v_exp_f32 v116, v116
    v_exp_f32 v117, v117
    v_smfmac_f32_32x32x32_bf16 v[160:175], v[152:155], v[96:103], v204
    s_waitcnt lgkmcnt(0)
    v_exp_f32 v118, v118
    v_exp_f32 v119, v119
    v_exp_f32 v120, v120
    v_smfmac_f32_16x16x64_bf16 v[192:195], v[200:203], v[96:103], v204
    ds_read_b128 v[136:139], v24 offset:55296
    v_exp_f32 v121, v121
    v_exp_f32 v122, v122
    v_smfmac_f32_32x32x32_bf16 v[160:175], v[156:159], v[104:111], v204
    v_exp_f32 v123, v123
    v_exp_f32 v124, v124
    v_exp_f32 v125, v125
    v_smfmac_f32_16x16x64_bf16 v[192:195], v[200:203], v[104:111], v204
    ds_read_b128 v[140:143], v24 offset:56320
    v_exp_f32 v126, v126
    v_exp_f32 v127, v127
    v_mfma_f32_32x32x16_bf16 v[80:95], v[128:131], v[16:19], 0
    v_exp_f32 v64, v64
    v_exp_f32 v65, v65
    v_exp_f32 v66, v66
    v_mfma_f32_32x32x16_bf16 v[80:95], v[132:135], v[20:23], v[80:95]
    v_exp_f32 v67, v67
    v_exp_f32 v68, v68
    v_exp_f32 v69, v69
    v_smfmac_f32_32x32x32_bf16 v[176:191], v[152:155], v[112:119], v204
    s_waitcnt lgkmcnt(0)
    v_exp_f32 v70, v70
    v_exp_f32 v71, v71
    v_exp_f32 v72, v72
    v_smfmac_f32_16x16x64_bf16 v[196:199], v[200:203], v[112:119], v204
    ds_read_b128 v[144:147], v24 offset:61440
    v_exp_f32 v73, v73
    v_exp_f32 v74, v74
    v_smfmac_f32_32x32x32_bf16 v[176:191], v[156:159], v[120:127], v204
    v_exp_f32 v75, v75
    v_exp_f32 v76, v76
    v_exp_f32 v77, v77
    v_smfmac_f32_16x16x64_bf16 v[196:199], v[200:203], v[120:127], v204
    ds_read_b128 v[148:151], v24 offset:62464
    v_exp_f32 v78, v78
    v_exp_f32 v79, v79
    v_mfma_f32_32x32x16_bf16 v[96:111], v[136:139], v[8:11], 0
    s_barrier
    v_exp_f32 v80, v80
    v_exp_f32 v81, v81
    v_exp_f32 v82, v82
    v_mfma_f32_32x32x16_bf16 v[96:111], v[140:143], v[12:15], v[96:111]
    s_waitcnt lgkmcnt(1)
    v_exp_f32 v83, v83
    v_exp_f32 v84, v84
    v_exp_f32 v85, v85
    v_smfmac_f32_32x32x32_bf16 v[160:175], v[144:147], v[64:71], v204
    s_waitcnt lgkmcnt(0)
    v_exp_f32 v86, v86
    v_exp_f32 v87, v87
    v_exp_f32 v88, v88
    v_smfmac_f32_16x16x64_bf16 v[192:195], v[200:203], v[64:71], v204
    ds_read_b128 v[128:131], v24 offset:0
    v_exp_f32 v89, v89
    v_exp_f32 v90, v90
    v_smfmac_f32_32x32x32_bf16 v[160:175], v[148:151], v[72:79], v204
    v_exp_f32 v91, v91
    v_exp_f32 v92, v92
    v_exp_f32 v93, v93
    v_smfmac_f32_16x16x64_bf16 v[192:195], v[200:203], v[72:79], v204
    ds_read_b128 v[132:135], v24 offset:1024
    v_exp_f32 v94, v94
    v_exp_f32 v95, v95
    v_mfma_f32_32x32x16_bf16 v[112:127], v[136:139], v[16:19], 0
    v_exp_f32 v96, v96
    v_exp_f32 v97, v97
    v_exp_f32 v98, v98
    v_mfma_f32_32x32x16_bf16 v[112:127], v[140:143], v[20:23], v[112:127]
    v_exp_f32 v99, v99
    v_exp_f32 v100, v100
    v_exp_f32 v101, v101
    v_smfmac_f32_32x32x32_bf16 v[176:191], v[144:147], v[80:87], v204
    s_waitcnt lgkmcnt(0)
    v_exp_f32 v102, v102
    v_exp_f32 v103, v103
    v_exp_f32 v104, v104
    v_smfmac_f32_16x16x64_bf16 v[196:199], v[200:203], v[80:87], v204
    ds_read_b128 v[152:155], v24 offset:63488
    v_exp_f32 v105, v105
    v_exp_f32 v106, v106
    v_smfmac_f32_32x32x32_bf16 v[176:191], v[148:151], v[88:95], v204
    v_exp_f32 v107, v107
    v_exp_f32 v108, v108
    v_exp_f32 v109, v109
    v_smfmac_f32_16x16x64_bf16 v[196:199], v[200:203], v[88:95], v204
    ds_read_b128 v[156:159], v24 offset:64512
    v_exp_f32 v110, v110
    v_exp_f32 v111, v111
    v_mfma_f32_32x32x16_bf16 v[64:79], v[128:131], v[8:11], 0
    s_sub_u32 s54, s54, 1
    v_exp_f32 v112, v112
    v_exp_f32 v113, v113
    v_exp_f32 v114, v114
    v_mfma_f32_32x32x16_bf16 v[64:79], v[132:135], v[12:15], v[64:79]
    s_waitcnt lgkmcnt(1)
    v_exp_f32 v115, v115
    v_exp_f32 v116, v116
    v_exp_f32 v117, v117
    v_smfmac_f32_32x32x32_bf16 v[160:175], v[152:155], v[96:103], v204
    s_waitcnt lgkmcnt(0)
    v_exp_f32 v118, v118
    v_exp_f32 v119, v119
    v_exp_f32 v120, v120
    v_smfmac_f32_16x16x64_bf16 v[192:195], v[200:203], v[96:103], v204
    ds_read_b128 v[136:139], v24 offset:2048
    v_exp_f32 v121, v121
    v_exp_f32 v122, v122
    v_smfmac_f32_32x32x32_bf16 v[160:175], v[156:159], v[104:111], v204
    s_cmp_lg_u32 s54, 0
    v_exp_f32 v123, v123
    v_exp_f32 v124, v124
    v_exp_f32 v125, v125
    v_smfmac_f32_16x16x64_bf16 v[192:195], v[200:203], v[104:111], v204
    ds_read_b128 v[140:143], v24 offset:3072
    v_exp_f32 v126, v126
    v_exp_f32 v127, v127
    s_cbranch_scc1 c_attn_loop
    v_smfmac_f32_16x16x64_bf16 v[196:199], v[200:203], v[112:119], v204
    v_smfmac_f32_16x16x64_bf16 v[196:199], v[200:203], v[120:127], v204
    v_smfmac_f32_32x32x32_bf16 v[176:191], v[152:155], v[112:119], v204
    v_smfmac_f32_32x32x32_bf16 v[176:191], v[156:159], v[120:127], v204
    v_mov_b32 v25, 0x5f000000
    v_mov_b32 v26, 0x2b800000
    v_cmp_lt_f32 s[56:57], v192, v25
    v_cmp_gt_f32 vcc, v192, v26
    s_and_b64 s[56:57], s[56:57], vcc
    s_nop 0
    v_cmp_lt_f32 vcc, v196, v25
    s_and_b64 s[56:57], s[56:57], vcc
    v_cmp_gt_f32 vcc, v196, v26
    s_and_b64 s[56:57], s[56:57], vcc
    s_cmp_lg_u64 s[56:57], -1
    s_cbranch_scc1 c_attn_slow
c_attn_fin:
    s_lshl_b32 s3, s48, 17
    s_lshl_b32 s55, s7, 12
    s_add_u32 s3, s3, s55
    s_and_b32 s55, s6, 1
    s_lshl_b32 s55, s55, 11
    s_add_u32 s3, s3, s55
    s_lshl_b32 s55, s9, 22
    s_add_u32 s3, s3, s55
    s_add_u32 s3, s3, 16777216
    v_rcp_f32 v192, v192
    s_nop 0
    v_pk_mul_f32 v[160:161], v[192:193], v[160:161] op_sel_hi:[0,1]
    v_pk_mul_f32 v[162:163], v[192:193], v[162:163] op_sel_hi:[0,1]
    v_pk_mul_f32 v[164:165], v[192:193], v[164:165] op_sel_hi:[0,1]
    v_pk_mul_f32 v[166:167], v[192:193], v[166:167] op_sel_hi:[0,1]
    v_pk_mul_f32 v[168:169], v[192:193], v[168:169] op_sel_hi:[0,1]
    v_pk_mul_f32 v[170:171], v[192:193], v[170:171] op_sel_hi:[0,1]
    v_pk_mul_f32 v[172:173], v[192:193], v[172:173] op_sel_hi:[0,1]
    v_pk_mul_f32 v[174:175], v[192:193], v[174:175] op_sel_hi:[0,1]
    v_cvt_pk_bf16_f32 v160, v160, v161
    v_cvt_pk_bf16_f32 v161, v162, v163
    v_cvt_pk_bf16_f32 v162, v164, v165
    v_cvt_pk_bf16_f32 v163, v166, v167
    v_cvt_pk_bf16_f32 v164, v168, v169
    v_cvt_pk_bf16_f32 v165, v170, v171
    v_cvt_pk_bf16_f32 v166, v172, v173
    v_cvt_pk_bf16_f32 v167, v174, v175
    buffer_store_dwordx4 v[160:163], v5, s[12:15], s3 offen offset:0 sc1
    buffer_store_dwordx4 v[164:167], v5, s[12:15], s3 offen offset:1024 sc1
    s_add_u32 s3, s3, 65536
    v_rcp_f32 v196, v196
    s_nop 0
    v_pk_mul_f32 v[176:177], v[196:197], v[176:177] op_sel_hi:[0,1]
    v_pk_mul_f32 v[178:179], v[196:197], v[178:179] op_sel_hi:[0,1]
    v_pk_mul_f32 v[180:181], v[196:197], v[180:181] op_sel_hi:[0,1]
    v_pk_mul_f32 v[182:183], v[196:197], v[182:183] op_sel_hi:[0,1]
    v_pk_mul_f32 v[184:185], v[196:197], v[184:185] op_sel_hi:[0,1]
    v_pk_mul_f32 v[186:187], v[196:197], v[186:187] op_sel_hi:[0,1]
    v_pk_mul_f32 v[188:189], v[196:197], v[188:189] op_sel_hi:[0,1]
    v_pk_mul_f32 v[190:191], v[196:197], v[190:191] op_sel_hi:[0,1]
    v_cvt_pk_bf16_f32 v176, v176, v177
    v_cvt_pk_bf16_f32 v177, v178, v179
    v_cvt_pk_bf16_f32 v178, v180, v181
    v_cvt_pk_bf16_f32 v179, v182, v183
    v_cvt_pk_bf16_f32 v180, v184, v185
    v_cvt_pk_bf16_f32 v181, v186, v187
    v_cvt_pk_bf16_f32 v182, v188, v189
    v_cvt_pk_bf16_f32 v183, v190, v191
    buffer_store_dwordx4 v[176:179], v5, s[12:15], s3 offen offset:0 sc1
    buffer_store_dwordx4 v[180:183], v5, s[12:15], s3 offen offset:1024 sc1
    s_add_u32 s3, s3, 65536
    s_branch c_wo
.p2align 6
h_first_tail:
    s_waitcnt vmcnt(0)
    s_sub_u32 s50, s50, 8000
    s_load_dword s10, s[46:47], 0
    s_waitcnt lgkmcnt(0)
    s_sub_u32 s51, s10, s50
    s_and_b32 s3, s10, 1
    s_cselect_b32 s51, s51, -1
    s_cmp_ge_i32 s51, 0
    s_cbranch_scc1 h_first_non_ok
    s_load_dword s10, s[46:47], 128
    s_waitcnt lgkmcnt(0)
    s_sub_u32 s51, s10, s50
    s_and_b32 s3, s10, 1
    s_cselect_b32 s51, s51, -1
    s_cmp_ge_i32 s51, 0
    s_cbranch_scc1 h_first_non_ok
    s_load_dword s10, s[46:47], 64
    s_waitcnt lgkmcnt(0)
    s_sub_u32 s51, s10, s50
    s_and_b32 s3, s10, 1
    s_cselect_b32 s51, s51, -1
    s_cmp_ge_i32 s51, 0
    s_cbranch_scc1 h_first_non_ok
    s_load_dword s10, s[46:47], 192
    s_waitcnt lgkmcnt(0)
    s_sub_u32 s51, s10, s50
    s_and_b32 s3, s10, 1
    s_cselect_b32 s51, s51, -1
    s_cmp_ge_i32 s51, 0
    s_cbranch_scc1 h_first_non_ok
    s_mov_b32 s58, 0
    s_and_b32 s57, s2, 0xc0
h_first_non:
    s_load_dword s10, s[46:47], s57 glc
    s_waitcnt lgkmcnt(0)
    s_sub_u32 s51, s10, s50
    s_and_b32 s3, s10, 1
    s_cselect_b32 s51, s51, -1
    s_cmp_ge_i32 s51, 0
    s_cbranch_scc1 h_first_non_ok
    s_add_u32 s58, s58, 1
    s_cmp_gt_u32 s58, 100
    s_cselect_b32 s50, s10, s50
    s_cmp_lt_u32 s58, 0x100000
    s_cbranch_scc1 h_first_non
    s_mov_b32 s10, 1
h_first_non_ok:
    v_mov_b32 v12, s10
    ds_write_b32 v10, v12 offset:4
    v_lshlrev_b32 v13, 7, v1
    s_lshl_b32 s50, s2, 13
    s_mov_b32 s28, s36
    s_mov_b32 s29, s37
    s_mov_b32 s30, 2097152
    s_mov_b32 s31, 0x00020000
    buffer_load_dword v14, v13, s[28:31], s50 offen
    s_mov_b32 s9, 0
h_qkvA:
    s_mul_i32 s98, s9, 786432
    s_add_u32 s98, s98, 65273856
    s_lshl_b32 s99, s11, 10
    s_add_u32 s98, s98, s99
    s_add_u32 s96, s4, s98
    s_addc_u32 s97, s5, 0
    s_mov_b32 s98, s10
    s_mov_b32 s99, s10
    v_and_b32 v1, 63, v0
    v_lshlrev_b32 v5, 4, v1
    v_and_b32 v20, 15, v1
    v_lshrrev_b32 v11, 4, v1
    v_min_u32 v11, 2, v11
    v_lshlrev_b32 v21, 3, v20
    v_lshl_add_u32 v12, v11, 7, v21
    v_add_u32 v12, 155648, v12
    v_lshl_add_u32 v11, v11, 16, v21
    v_mov_b32 v10, 159496
    s_add_u32 s3, s9, 1
    v_mov_b32 v13, s3
    s_and_b32 s3, s6, 14
    s_lshl_b32 s3, s3, 2
    s_sub_u32 s3, s3, 1
    s_max_i32 s3, s3, 0
    s_lshl_b32 s3, s3, 16
    s_lshl_b32 s48, s9, 22
    s_add_u32 s3, s3, s48
    s_add_u32 s20, s4, s3
    s_addc_u32 s21, s5, 0
    s_mov_b32 s22, 65536
    s_mov_b32 s23, 0x00020000
    s_cmp_lt_u32 s6, 2
    s_cselect_b32 s22, 0, s22
    s_cselect_b32 s3, 0, 512
    s_add_u32 s96, s96, s3
    s_addc_u32 s97, s97, 0
    v_bfe_u32 v21, v1, 4, 1
    v_lshl_add_u32 v6, v21, 5, v20
    v_lshlrev_b32 v6, 4, v6
    v_lshrrev_b32 v21, 5, v1
    v_lshl_add_u32 v6, v21, 10, v6
    v_add_u32 v6, 256, v6
    v_add_u32 v16, 49152, v5
    s_cmp_eq_u32 s9, 0
    s_cbranch_scc1 h_qkvA_noend
    s_barrier
    s_cmp_lt_u32 s9, 2
    s_cbranch_scc1 c4_11
    ds_write_b128 v16, v[64:67] offset:0
    ds_write_b128 v16, v[68:71] offset:1024
    ds_write_b128 v16, v[72:75] offset:2048
    ds_write_b128 v16, v[76:79] offset:3072
    ds_write_b128 v16, v[80:83] offset:4096
    ds_write_b128 v16, v[84:87] offset:5120
    ds_write_b128 v16, v[88:91] offset:6144
    ds_write_b128 v16, v[92:95] offset:7168
    ds_write_b128 v16, v[96:99] offset:8192
    ds_write_b128 v16, v[100:103] offset:9216
    ds_write_b128 v16, v[104:107] offset:10240
    ds_write_b128 v16, v[108:111] offset:11264
    ds_write_b128 v16, v[112:115] offset:12288
    ds_write_b128 v16, v[116:119] offset:13312
    ds_write_b128 v16, v[120:123] offset:14336
    ds_write_b128 v16, v[124:127] offset:15360
    ds_write_b128 v16, v[128:131] offset:16384
    ds_write_b128 v16, v[132:135] offset:17408
    ds_write_b128 v16, v[136:139] offset:18432
    ds_write_b128 v16, v[140:143] offset:19456
    ds_write_b128 v16, v[144:147] offset:20480
    ds_write_b128 v16, v[148:151] offset:21504
    ds_write_b128 v16, v[152:155] offset:22528
    ds_write_b128 v16, v[156:159] offset:23552
    s_waitcnt lgkmcnt(0)
c4_11:
    s_barrier
h_qkvA_noend:
    s_mov_b32 s3, 0x100000
poll_12:
    s_load_dwordx8 s[80:87], s[96:97], 0 glc
    s_load_dwordx8 s[88:95], s[96:97], 128 glc
    s_sub_u32 s3, s3, 1
    s_cbranch_scc1 poll_12_ok
    s_waitcnt lgkmcnt(0)
    s_xor_b64 s[100:101], s[80:81], s[98:99]
    s_xor_b64 s[80:81], s[82:83], s[98:99]
    s_or_b64 s[100:101], s[100:101], s[80:81]
    s_xor_b64 s[80:81], s[84:85], s[98:99]
    s_or_b64 s[100:101], s[100:101], s[80:81]
    s_xor_b64 s[80:81], s[86:87], s[98:99]
    s_or_b64 s[100:101], s[100:101], s[80:81]
    s_xor_b64 s[80:81], s[88:89], s[98:99]
    s_or_b64 s[100:101], s[100:101], s[80:81]
    s_xor_b64 s[80:81], s[90:91], s[98:99]
    s_or_b64 s[100:101], s[100:101], s[80:81]
    s_xor_b64 s[80:81], s[92:93], s[98:99]
    s_or_b64 s[100:101], s[100:101], s[80:81]
    s_xor_b64 s[80:81], s[94:95], s[98:99]
    s_or_b64 s[100:101], s[100:101], s[80:81]
    s_cbranch_scc1 poll_12
poll_12_ok:
    s_waitcnt lgkmcnt(0)
    ds_write_b32 v10, v13
    s_mov_b32 m0, 147456
    s_mov_b32 s48, 0
    buffer_load_dwordx4 v6, s[20:23], s48 offen sc1 lds
    s_mov_b32 m0, 148480
    s_mov_b32 s48, 2048
    buffer_load_dwordx4 v6, s[20:23], s48 offen sc1 lds
    s_mov_b32 m0, 149504
    s_mov_b32 s48, 4096
    buffer_load_dwordx4 v6, s[20:23], s48 offen sc1 lds
    s_mov_b32 m0, 150528
    s_mov_b32 s48, 6144
    buffer_load_dwordx4 v6, s[20:23], s48 offen sc1 lds
    s_mov_b32 m0, 151552
    s_mov_b32 s48, 8192
    buffer_load_dwordx4 v6, s[20:23], s48 offen sc1 lds
    s_mov_b32 m0, 152576
    s_mov_b32 s48, 10240
    buffer_load_dwordx4 v6, s[20:23], s48 offen sc1 lds
    s_mov_b32 m0, 153600
    s_mov_b32 s48, 12288
    buffer_load_dwordx4 v6, s[20:23], s48 offen sc1 lds
    s_mov_b32 m0, 154624
    s_mov_b32 s48, 14336
    buffer_load_dwordx4 v6, s[20:23], s48 offen sc1 lds
    s_lshl_b32 s56, s7, 12
    s_and_b32 s57, s6, 1
    s_lshl_b32 s57, s57, 7
    s_add_u32 s56, s56, s57
    s_add_u32 s56, s56, 63963136
    v_lshlrev_b32 v15, 7, v1
    s_lshr_b32 s59, s2, 3
    s_mul_i32 s59, s59, 3
    s_lshr_b32 s59, s59, 5
    s_lshl_b32 s3, s9, 4
    s_add_u32 s59, s59, s3
    s_waitcnt vmcnt(4)
    s_barrier
    s_waitcnt vmcnt(0)
    s_barrier
    s_mov_b32 m0, 147456
    s_mov_b32 s48, 16384
    buffer_load_dwordx4 v6, s[20:23], s48 offen sc1 lds
    s_mov_b32 m0, 148480
    s_mov_b32 s48, 18432
    buffer_load_dwordx4 v6, s[20:23], s48 offen sc1 lds
    s_mov_b32 m0, 149504
    s_mov_b32 s48, 20480
    buffer_load_dwordx4 v6, s[20:23], s48 offen sc1 lds
    s_mov_b32 m0, 150528
    s_mov_b32 s48, 22528
    buffer_load_dwordx4 v6, s[20:23], s48 offen sc1 lds
    s_waitcnt vmcnt(0)
    s_waitcnt vmcnt(0)
    s_barrier
    s_mov_b32 m0, 151552
    s_mov_b32 s48, 24576
    buffer_load_dwordx4 v6, s[20:23], s48 offen sc1 lds
    s_mov_b32 m0, 152576
    s_mov_b32 s48, 26624
    buffer_load_dwordx4 v6, s[20:23], s48 offen sc1 lds
    s_mov_b32 m0, 153600
    s_mov_b32 s48, 28672
    buffer_load_dwordx4 v6, s[20:23], s48 offen sc1 lds
    s_mov_b32 m0, 154624
    s_mov_b32 s48, 30720
    buffer_load_dwordx4 v6, s[20:23], s48 offen sc1 lds
    s_cmp_ge_u32 s9, 2
    s_cbranch_scc1 cs_14
    buffer_load_dwordx2 v[32:33], v11, s[12:15], s56 offen offset:0 sc1
    buffer_load_dwordx2 v[34:35], v11, s[12:15], s56 offen offset:256 sc1
    buffer_load_dwordx2 v[36:37], v11, s[12:15], s56 offen offset:512 sc1
    buffer_load_dwordx2 v[38:39], v11, s[12:15], s56 offen offset:768 sc1
    buffer_load_dwordx2 v[40:41], v11, s[12:15], s56 offen offset:1024 sc1
    buffer_load_dwordx2 v[42:43], v11, s[12:15], s56 offen offset:1280 sc1
    buffer_load_dwordx2 v[44:45], v11, s[12:15], s56 offen offset:1536 sc1
    buffer_load_dwordx2 v[46:47], v11, s[12:15], s56 offen offset:1792 sc1
    buffer_load_dwordx2 v[48:49], v11, s[12:15], s56 offen offset:2048 sc1
    buffer_load_dwordx2 v[50:51], v11, s[12:15], s56 offen offset:2304 sc1
    buffer_load_dwordx2 v[52:53], v11, s[12:15], s56 offen offset:2560 sc1
    buffer_load_dwordx2 v[54:55], v11, s[12:15], s56 offen offset:2816 sc1
cs_14:
    s_waitcnt vmcnt(0)
    s_waitcnt vmcnt(12)
    s_barrier
    s_mov_b32 m0, 147456
    s_mov_b32 s48, 32768
    buffer_load_dwordx4 v6, s[20:23], s48 offen sc1 lds
    s_mov_b32 m0, 148480
    s_mov_b32 s48, 34816
    buffer_load_dwordx4 v6, s[20:23], s48 offen sc1 lds
    s_mov_b32 m0, 149504
    s_mov_b32 s48, 36864
    buffer_load_dwordx4 v6, s[20:23], s48 offen sc1 lds
    s_mov_b32 m0, 150528
    s_mov_b32 s48, 38912
    buffer_load_dwordx4 v6, s[20:23], s48 offen sc1 lds
    s_cmp_ge_u32 s9, 2
    s_cbranch_scc1 cs_15
    buffer_load_dwordx2 v[56:57], v11, s[12:15], s56 offen offset:3072 sc1
    buffer_load_dwordx2 v[58:59], v11, s[12:15], s56 offen offset:3328 sc1
    buffer_load_dwordx2 v[60:61], v11, s[12:15], s56 offen offset:3584 sc1
    buffer_load_dwordx2 v[62:63], v11, s[12:15], s56 offen offset:3840 sc1
cs_15:
    s_waitcnt vmcnt(0)
    s_waitcnt vmcnt(4)
    s_barrier
    s_mov_b32 m0, 151552
    s_mov_b32 s48, 40960
    buffer_load_dwordx4 v6, s[20:23], s48 offen sc1 lds
    s_mov_b32 m0, 152576
    s_mov_b32 s48, 43008
    buffer_load_dwordx4 v6, s[20:23], s48 offen sc1 lds
    s_mov_b32 m0, 153600
    s_mov_b32 s48, 45056
    buffer_load_dwordx4 v6, s[20:23], s48 offen sc1 lds
    s_mov_b32 m0, 154624
    s_mov_b32 s48, 47104
    buffer_load_dwordx4 v6, s[20:23], s48 offen sc1 lds
    s_cmp_ge_u32 s9, 2
    s_cbranch_scc1 c4_16
    ds_read_b128 v[64:67], v16 offset:0
    ds_read_b128 v[68:71], v16 offset:1024
    ds_read_b128 v[72:75], v16 offset:2048
    ds_read_b128 v[76:79], v16 offset:3072
    ds_read_b128 v[80:83], v16 offset:4096
    ds_read_b128 v[84:87], v16 offset:5120
    ds_read_b128 v[88:91], v16 offset:6144
    ds_read_b128 v[92:95], v16 offset:7168
    ds_read_b128 v[96:99], v16 offset:8192
    ds_read_b128 v[100:103], v16 offset:9216
    ds_read_b128 v[104:107], v16 offset:10240
    ds_read_b128 v[108:111], v16 offset:11264
    ds_read_b128 v[112:115], v16 offset:12288
    ds_read_b128 v[116:119], v16 offset:13312
    ds_read_b128 v[120:123], v16 offset:14336
    ds_read_b128 v[124:127], v16 offset:15360
    ds_read_b128 v[128:131], v16 offset:16384
    ds_read_b128 v[132:135], v16 offset:17408
    ds_read_b128 v[136:139], v16 offset:18432
    ds_read_b128 v[140:143], v16 offset:19456
    ds_read_b128 v[144:147], v16 offset:20480
    ds_read_b128 v[148:151], v16 offset:21504
    ds_read_b128 v[152:155], v16 offset:22528
    ds_read_b128 v[156:159], v16 offset:23552
    s_waitcnt lgkmcnt(0)
c4_16:
    s_cmp_ge_u32 s9, 2
    s_cbranch_scc1 cs_17
    s_waitcnt vmcnt(4)
    v_add_f32 v32, v32, v48
    v_add_f32 v33, v33, v49
    v_add_f32 v34, v34, v50
    v_add_f32 v35, v35, v51
    v_add_f32 v36, v36, v52
    v_add_f32 v37, v37, v53
    v_add_f32 v38, v38, v54
    v_add_f32 v39, v39, v55
    v_add_f32 v40, v40, v56
    v_add_f32 v41, v41, v57
    v_add_f32 v42, v42, v58
    v_add_f32 v43, v43, v59
cs_17:
    s_waitcnt vmcnt(0)
    s_waitcnt vmcnt(0)
    s_barrier
    s_mov_b32 m0, 147456
    s_mov_b32 s48, 49152
    buffer_load_dwordx4 v6, s[20:23], s48 offen sc1 lds
    s_mov_b32 m0, 148480
    s_mov_b32 s48, 51200
    buffer_load_dwordx4 v6, s[20:23], s48 offen sc1 lds
    s_mov_b32 m0, 149504
    s_mov_b32 s48, 53248
    buffer_load_dwordx4 v6, s[20:23], s48 offen sc1 lds
    s_mov_b32 m0, 150528
    s_mov_b32 s48, 55296
    buffer_load_dwordx4 v6, s[20:23], s48 offen sc1 lds
    s_cmp_ge_u32 s9, 2
    s_cbranch_scc1 cs_18
    v_add_f32 v44, v44, v60
    v_add_f32 v45, v45, v61
    v_add_f32 v46, v46, v62
    v_add_f32 v47, v47, v63
    v_add_f32 v32, v32, v40
    v_add_f32 v33, v33, v41
    v_add_f32 v34, v34, v42
    v_add_f32 v35, v35, v43
    v_add_f32 v36, v36, v44
    v_add_f32 v37, v37, v45
    v_add_f32 v38, v38, v46
    v_add_f32 v39, v39, v47
cs_18:
    s_waitcnt vmcnt(0)
    s_waitcnt vmcnt(0)
    s_barrier
    s_mov_b32 m0, 151552
    s_mov_b32 s48, 57344
    buffer_load_dwordx4 v6, s[20:23], s48 offen sc1 lds
    s_mov_b32 m0, 152576
    s_mov_b32 s48, 59392
    buffer_load_dwordx4 v6, s[20:23], s48 offen sc1 lds
    s_mov_b32 m0, 153600
    s_mov_b32 s48, 61440
    buffer_load_dwordx4 v6, s[20:23], s48 offen sc1 lds
    s_mov_b32 m0, 154624
    s_mov_b32 s48, 63488
    buffer_load_dwordx4 v6, s[20:23], s48 offen sc1 lds
    s_cmp_ge_u32 s9, 2
    s_cbranch_scc1 cs_19
    v_add_f32 v32, v32, v36
    v_add_f32 v33, v33, v37
    v_add_f32 v34, v34, v38
    v_add_f32 v35, v35, v39
    v_add_f32 v32, v32, v34
    v_add_f32 v33, v33, v35
    ds_write_b64 v12, v[32:33]
    s_waitcnt lgkmcnt(0)
cs_19:
    s_waitcnt vmcnt(0)
    s_waitcnt vmcnt(0)
    s_barrier
    s_barrier
    s_barrier
    s_branch h_wo
h_qkvB:
    s_mul_i32 s98, s9, 786432
    s_add_u32 s98, s98, 65273856
    s_lshl_b32 s99, s11, 10
    s_add_u32 s98, s98, s99
    s_add_u32 s96, s4, s98
    s_addc_u32 s97, s5, 0
    s_mov_b32 s98, s10
    s_mov_b32 s99, s10
    v_and_b32 v1, 63, v0
    v_lshlrev_b32 v5, 4, v1
    v_and_b32 v20, 15, v1
    v_lshrrev_b32 v11, 4, v1
    v_min_u32 v11, 2, v11
    v_lshlrev_b32 v21, 3, v20
    v_lshl_add_u32 v12, v11, 7, v21
    v_add_u32 v12, 156032, v12
    v_lshl_add_u32 v11, v11, 16, v21
    v_mov_b32 v10, 159496
    s_add_u32 s3, s9, 1
    v_mov_b32 v13, s3
    v_add_u32 v16, 49152, v5
    s_barrier
    s_cmp_lt_u32 s9, 2
    s_cbranch_scc1 c4_22
    ds_write_b128 v16, v[160:163] offset:0
    ds_write_b128 v16, v[164:167] offset:1024
    ds_write_b128 v16, v[168:171] offset:2048
    ds_write_b128 v16, v[172:175] offset:3072
    ds_write_b128 v16, v[176:179] offset:4096
    ds_write_b128 v16, v[180:183] offset:5120
    ds_write_b128 v16, v[184:187] offset:6144
    ds_write_b128 v16, v[188:191] offset:7168
    ds_write_b128 v16, v[192:195] offset:8192
    ds_write_b128 v16, v[196:199] offset:9216
    ds_write_b128 v16, v[200:203] offset:10240
    ds_write_b128 v16, v[204:207] offset:11264
    ds_write_b128 v16, v[208:211] offset:12288
    ds_write_b128 v16, v[212:215] offset:13312
    ds_write_b128 v16, v[216:219] offset:14336
    ds_write_b128 v16, v[220:223] offset:15360
    ds_write_b128 v16, a[0:3] offset:16384
    ds_write_b128 v16, a[4:7] offset:17408
    ds_write_b128 v16, a[8:11] offset:18432
    ds_write_b128 v16, a[12:15] offset:19456
    ds_write_b128 v16, a[16:19] offset:20480
    ds_write_b128 v16, a[20:23] offset:21504
    ds_write_b128 v16, a[24:27] offset:22528
    ds_write_b128 v16, a[28:31] offset:23552
    s_waitcnt lgkmcnt(0)
c4_22:
    s_barrier
    s_mov_b32 s3, 0x100000
poll_23:
    s_load_dwordx8 s[88:95], s[96:97], 0 glc
    s_sub_u32 s3, s3, 1
    s_cbranch_scc1 poll_23_ok
    s_waitcnt lgkmcnt(0)
    s_xor_b64 s[100:101], s[88:89], s[98:99]
    s_xor_b64 s[88:89], s[90:91], s[98:99]
    s_or_b64 s[100:101], s[100:101], s[88:89]
    s_xor_b64 s[88:89], s[92:93], s[98:99]
    s_or_b64 s[100:101], s[100:101], s[88:89]
    s_xor_b64 s[88:89], s[94:95], s[98:99]
    s_or_b64 s[100:101], s[100:101], s[88:89]
    s_cbranch_scc1 poll_23
poll_23_ok:
    s_waitcnt lgkmcnt(0)
    ds_write_b32 v10, v13
    s_lshl_b32 s56, s7, 12
    s_and_b32 s57, s6, 1
    s_lshl_b32 s57, s57, 7
    s_add_u32 s56, s56, s57
    s_add_u32 s56, s56, 64159744
    s_barrier
    s_barrier
    s_barrier
    s_cmp_ge_u32 s9, 2
    s_cbranch_scc1 cs_25
    buffer_load_dwordx2 v[32:33], v11, s[12:15], s56 offen offset:0 sc1
    buffer_load_dwordx2 v[34:35], v11, s[12:15], s56 offen offset:256 sc1
    buffer_load_dwordx2 v[36:37], v11, s[12:15], s56 offen offset:512 sc1
    buffer_load_dwordx2 v[38:39], v11, s[12:15], s56 offen offset:768 sc1
    buffer_load_dwordx2 v[40:41], v11, s[12:15], s56 offen offset:1024 sc1
    buffer_load_dwordx2 v[42:43], v11, s[12:15], s56 offen offset:1280 sc1
    buffer_load_dwordx2 v[44:45], v11, s[12:15], s56 offen offset:1536 sc1
    buffer_load_dwordx2 v[46:47], v11, s[12:15], s56 offen offset:1792 sc1
    buffer_load_dwordx2 v[48:49], v11, s[12:15], s56 offen offset:2048 sc1
    buffer_load_dwordx2 v[50:51], v11, s[12:15], s56 offen offset:2304 sc1
    buffer_load_dwordx2 v[52:53], v11, s[12:15], s56 offen offset:2560 sc1
    buffer_load_dwordx2 v[54:55], v11, s[12:15], s56 offen offset:2816 sc1
cs_25:
    s_barrier
    s_cmp_ge_u32 s9, 2
    s_cbranch_scc1 cs_26
    buffer_load_dwordx2 v[56:57], v11, s[12:15], s56 offen offset:3072 sc1
    buffer_load_dwordx2 v[58:59], v11, s[12:15], s56 offen offset:3328 sc1
    buffer_load_dwordx2 v[60:61], v11, s[12:15], s56 offen offset:3584 sc1
    buffer_load_dwordx2 v[62:63], v11, s[12:15], s56 offen offset:3840 sc1
cs_26:
    s_barrier
    s_cmp_ge_u32 s9, 2
    s_cbranch_scc1 c4_27
    ds_read_b128 v[160:163], v16 offset:0
    ds_read_b128 v[164:167], v16 offset:1024
    ds_read_b128 v[168:171], v16 offset:2048
    ds_read_b128 v[172:175], v16 offset:3072
    ds_read_b128 v[176:179], v16 offset:4096
    ds_read_b128 v[180:183], v16 offset:5120
    ds_read_b128 v[184:187], v16 offset:6144
    ds_read_b128 v[188:191], v16 offset:7168
    ds_read_b128 v[192:195], v16 offset:8192
    ds_read_b128 v[196:199], v16 offset:9216
    ds_read_b128 v[200:203], v16 offset:10240
    ds_read_b128 v[204:207], v16 offset:11264
    ds_read_b128 v[208:211], v16 offset:12288
    ds_read_b128 v[212:215], v16 offset:13312
    ds_read_b128 v[216:219], v16 offset:14336
    ds_read_b128 v[220:223], v16 offset:15360
    ds_read_b128 a[0:3], v16 offset:16384
    ds_read_b128 a[4:7], v16 offset:17408
    ds_read_b128 a[8:11], v16 offset:18432
    ds_read_b128 a[12:15], v16 offset:19456
    ds_read_b128 a[16:19], v16 offset:20480
    ds_read_b128 a[20:23], v16 offset:21504
    ds_read_b128 a[24:27], v16 offset:22528
    ds_read_b128 a[28:31], v16 offset:23552
    s_waitcnt lgkmcnt(0)
c4_27:
    s_cmp_ge_u32 s9, 2
    s_cbranch_scc1 cs_28
    s_waitcnt vmcnt(0)
    v_add_f32 v32, v32, v48
    v_add_f32 v33, v33, v49
    v_add_f32 v34, v34, v50
    v_add_f32 v35, v35, v51
    v_add_f32 v36, v36, v52
    v_add_f32 v37, v37, v53
    v_add_f32 v38, v38, v54
    v_add_f32 v39, v39, v55
    v_add_f32 v40, v40, v56
    v_add_f32 v41, v41, v57
    v_add_f32 v42, v42, v58
    v_add_f32 v43, v43, v59
cs_28:
    s_barrier
    s_cmp_ge_u32 s9, 2
    s_cbranch_scc1 cs_29
    v_add_f32 v44, v44, v60
    v_add_f32 v45, v45, v61
    v_add_f32 v46, v46, v62
    v_add_f32 v47, v47, v63
    v_add_f32 v32, v32, v40
    v_add_f32 v33, v33, v41
    v_add_f32 v34, v34, v42
    v_add_f32 v35, v35, v43
    v_add_f32 v36, v36, v44
    v_add_f32 v37, v37, v45
    v_add_f32 v38, v38, v46
    v_add_f32 v39, v39, v47
cs_29:
    s_barrier
    s_cmp_ge_u32 s9, 2
    s_cbranch_scc1 cs_30
    v_add_f32 v32, v32, v36
    v_add_f32 v33, v33, v37
    v_add_f32 v34, v34, v38
    v_add_f32 v35, v35, v39
    v_add_f32 v32, v32, v34
    v_add_f32 v33, v33, v35
    ds_write_b64 v12, v[32:33]
    s_waitcnt lgkmcnt(0)
cs_30:
    s_barrier
    s_barrier
    s_branch s_attn
.p2align 6
l_first_tail:
    s_mov_b32 s28, s40
    s_mov_b32 s29, s41
    s_mov_b32 s30, 6291456
    s_mov_b32 s31, 0x00020000
    v_lshlrev_b32 v14, 6, v20
    v_lshrrev_b32 v22, 5, v1
    v_bfe_u32 v23, v1, 1, 1
    v_xor_b32 v22, v22, v23
    v_lshl_add_u32 v14, v22, 5, v14
    v_and_b32 v22, 1, v1
    v_lshl_add_u32 v14, v22, 4, v14
    v_bfe_u32 v23, v1, 2, 1
    v_mul_u32_u24 v23, 196608, v23
    v_add_u32 v14, v14, v23
    v_lshlrev_b32 v22, 4, v22
    v_mov_b32 v23, 0x3f80
    v_lshlrev_b32 v23, v22, v23
    v_bfe_u32 v22, v1, 1, 3
    v_cmp_eq_u32 vcc, 0, v22
    s_nop 1
    v_cndmask_b32 v24, 0, v23, vcc
    v_cmp_eq_u32 vcc, 1, v22
    s_nop 1
    v_cndmask_b32 v25, 0, v23, vcc
    v_cmp_eq_u32 vcc, 2, v22
    s_nop 1
    v_cndmask_b32 v26, 0, v23, vcc
    v_cmp_eq_u32 vcc, 3, v22
    s_nop 1
    v_cndmask_b32 v27, 0, v23, vcc
    v_lshlrev_b32 v15, 5, v21
    v_and_b32 v22, 16, v1
    v_add_u32 v15, v15, v22
    v_lshlrev_b32 v16, 14, v1
    s_mov_b32 s9, 0
    s_lshr_b32 s55, s63, 4
    s_and_b32 s56, s63, 15
    s_lshl_b32 s57, s56, 4
    s_lshr_b32 s58, s62, 1
    s_add_u32 s57, s57, s58
    s_mul_i32 s57, s57, 3
    s_add_u32 s57, s57, s55
    s_lshl_b32 s57, s57, 13
    s_and_b32 s58, s62, 1
    s_lshl_b32 s58, s58, 12
    s_add_u32 s57, s57, s58
    s_add_u32 s57, s57, 50331648
    s_lshl_b32 s54, s61, 8
    s_add_u32 s54, s54, 63963136
    s_lshl_b32 s56, s56, 10
    s_lshl_b32 s55, s55, 7
    s_add_u32 s55, s55, s56
    s_lshl_b32 s56, s62, 2
    s_add_u32 s55, s55, s56
    s_add_u32 s55, s55, 64487424
    s_waitcnt vmcnt(7)
    buffer_store_dwordx4 v[160:163], v14, s[12:15], s57 offen offset:0 sc1
    v_mfma_f32_16x16x32_bf16 v[28:31], v[24:27], v[160:163], 0
    s_waitcnt vmcnt(7)
    buffer_store_dwordx4 v[164:167], v14, s[12:15], s57 offen offset:512 sc1
    v_mfma_f32_16x16x32_bf16 v[28:31], v[24:27], v[164:167], v[28:31]
    s_waitcnt vmcnt(7)
    buffer_store_dwordx4 v[168:171], v14, s[12:15], s57 offen offset:1024 sc1
    v_mfma_f32_16x16x32_bf16 v[28:31], v[24:27], v[168:171], v[28:31]
    s_waitcnt vmcnt(7)
    buffer_store_dwordx4 v[172:175], v14, s[12:15], s57 offen offset:1536 sc1
    v_mfma_f32_16x16x32_bf16 v[28:31], v[24:27], v[172:175], v[28:31]
    s_waitcnt vmcnt(7)
    buffer_store_dwordx4 v[176:179], v14, s[12:15], s57 offen offset:2048 sc1
    v_mfma_f32_16x16x32_bf16 v[28:31], v[24:27], v[176:179], v[28:31]
    s_waitcnt vmcnt(7)
    buffer_store_dwordx4 v[180:183], v14, s[12:15], s57 offen offset:2560 sc1
    v_mfma_f32_16x16x32_bf16 v[28:31], v[24:27], v[180:183], v[28:31]
    s_waitcnt vmcnt(7)
    buffer_store_dwordx4 v[184:187], v14, s[12:15], s57 offen offset:3072 sc1
    v_mfma_f32_16x16x32_bf16 v[28:31], v[24:27], v[184:187], v[28:31]
    s_waitcnt vmcnt(7)
    buffer_store_dwordx4 v[188:191], v14, s[12:15], s57 offen offset:3584 sc1
    v_mfma_f32_16x16x32_bf16 v[28:31], v[24:27], v[188:191], v[28:31]
    s_nop 7
    v_add_f32_dpp v28, v28, v28 row_ror:8 row_mask:0xf bank_mask:0xf
    v_add_f32_dpp v29, v29, v29 row_ror:8 row_mask:0xf bank_mask:0xf
    v_add_f32_dpp v30, v30, v30 row_ror:8 row_mask:0xf bank_mask:0xf
    v_add_f32_dpp v31, v31, v31 row_ror:8 row_mask:0xf bank_mask:0xf
    s_mov_b64 exec, 0x00ff00ff
    buffer_store_dwordx4 v[28:31], v15, s[12:15], s54 offen sc1
    s_mov_b64 exec, -1
    s_add_u32 s57, s57, 6291456
    s_add_u32 s54, s54, 196608
    v_mov_b32 v8, 159492
non_33:
    ds_read_b32 v9, v8
    s_waitcnt lgkmcnt(0)
    v_readfirstlane_b32 s10, v9
    s_cmp_eq_u32 s10, 0
    s_cbranch_scc1 non_33
    s_mov_b64 exec, 0xffff
    s_waitcnt vmcnt(0)
    buffer_store_dword v9, v16, s[12:15], s55 offen offset:0 sc1
    s_mov_b64 exec, -1
    s_add_u32 s53, s52, 0
    buffer_load_dwordx4 v[192:195], v12, s[28:31], s53 offen nt
    s_add_u32 s53, s52, 49152
    buffer_load_dwordx4 v[196:199], v12, s[28:31], s53 offen nt
    s_add_u32 s53, s52, 98304
    buffer_load_dwordx4 v[200:203], v12, s[28:31], s53 offen nt
    s_add_u32 s53, s52, 147456
    buffer_load_dwordx4 v[204:207], v12, s[28:31], s53 offen nt
    s_add_u32 s53, s52, 196608
    buffer_load_dwordx4 v[208:211], v12, s[28:31], s53 offen nt
    s_add_u32 s53, s52, 245760
    buffer_load_dwordx4 v[212:215], v12, s[28:31], s53 offen nt
    s_add_u32 s53, s52, 294912
    buffer_load_dwordx4 v[216:219], v12, s[28:31], s53 offen nt
    s_add_u32 s53, s52, 344064
    buffer_load_dwordx4 v[220:223], v12, s[28:31], s53 offen nt
    s_mov_b32 s58, s52
    s_lshr_b32 s60, s2, 3
    s_mul_i32 s60, s60, 3
    s_lshr_b32 s60, s60, 5
    s_add_u32 s60, s60, 1
    s_branch l_qkv2
l_qkv:
    s_mov_b32 s60, 0
l_qkv2:
    v_and_b32 v1, 63, v0
    v_lshlrev_b32 v5, 4, v1
    s_sub_u32 s51, s8, 5
    s_lshl_b32 s48, s51, 13
    s_and_b32 s53, s9, 1
    s_lshl_b32 s52, s53, 4
    s_add_u32 s49, s7, s52
    s_lshl_b32 s49, s49, 1
    s_and_b32 s52, s6, 1
    s_add_u32 s49, s49, s52
    s_mul_i32 s49, s49, 196608
    s_add_u32 s49, s49, s48
    s_add_u32 s49, s49, 50331648
    v_mov_b32 v13, 159496
    s_mov_b32 s50, 0
    v_lshrrev_b32 v10, 2, v1
    v_and_b32 v11, 3, v1
    v_lshlrev_b32 v10, 8, v10
    v_lshl_add_u32 v10, v11, 4, v10
    v_lshlrev_b32 v7, 5, v11
    v_lshlrev_b32 v11, 2, v1
    v_add_u32 v11, 155648, v11
    s_lshr_b32 s59, s11, 2
    s_lshl_b32 s59, s59, 12
    s_and_b32 s3, s11, 3
    s_lshl_b32 s3, s3, 6
    s_add_u32 s59, s59, s3
    s_lshl_b32 s3, s9, 18
    s_add_u32 s59, s59, s3
    s_add_u32 s59, s59, 62914560
    s_lshl_b32 s56, s9, 15
    s_add_u32 s56, s56, 64749568
    v_mov_b32 v41, s10
    v_mov_b32 v43, s10
    v_mov_b32 v45, s10
    v_mov_b32 v47, s10
    v_and_b32 v6, 0xff, v5
    s_lshl_b32 s3, s7, 7
    v_lshrrev_b32 v20, 3, v1
    v_lshlrev_b32 v21, 11, v20
    v_lshrrev_b32 v22, 2, v1
    v_lshrrev_b32 v23, 4, v1
    v_xor_b32 v22, v22, v23
    v_and_b32 v22, 1, v22
    v_lshl_add_u32 v21, v22, 6, v21
    v_and_b32 v22, 3, v1
    v_lshl_add_u32 v21, v22, 4, v21
    v_add_u32 v17, s3, v21
    s_lshl_b32 s3, s51, 13
    s_add_u32 s3, s3, 73728
    v_add_u32 v3, s3, v5
    s_cmp_lg_u32 s9, 0
    s_cbranch_scc1 l_qkv_tiled
    s_lshl_b32 s53, s8, 7
    s_lshl_b32 s52, s11, 10
    s_add_u32 s53, s53, s52
    s_add_u32 s53, s53, 64486784
    s_add_u32 s96, s4, s53
    s_addc_u32 s97, s5, 0
    s_mov_b32 s98, s10
    s_mov_b32 s99, s10
    s_mov_b32 s3, 0x100000
poll_34:
    s_load_dwordx16 s[80:95], s[96:97], 0 glc
    s_sub_u32 s3, s3, 1
    s_cbranch_scc1 poll_34_ok
    s_waitcnt lgkmcnt(0)
    s_xor_b64 s[100:101], s[80:81], s[98:99]
    s_xor_b64 s[80:81], s[82:83], s[98:99]
    s_or_b64 s[100:101], s[100:101], s[80:81]
    s_xor_b64 s[80:81], s[84:85], s[98:99]
    s_or_b64 s[100:101], s[100:101], s[80:81]
    s_xor_b64 s[80:81], s[86:87], s[98:99]
    s_or_b64 s[100:101], s[100:101], s[80:81]
    s_xor_b64 s[80:81], s[88:89], s[98:99]
    s_or_b64 s[100:101], s[100:101], s[80:81]
    s_xor_b64 s[80:81], s[90:91], s[98:99]
    s_or_b64 s[100:101], s[100:101], s[80:81]
    s_xor_b64 s[80:81], s[92:93], s[98:99]
    s_or_b64 s[100:101], s[100:101], s[80:81]
    s_xor_b64 s[80:81], s[94:95], s[98:99]
    s_or_b64 s[100:101], s[100:101], s[80:81]
    s_cbranch_scc1 poll_34
poll_34_ok:
    s_waitcnt lgkmcnt(0)
    s_branch l_qkv_fill
l_qkv_tiled:
    s_barrier
    s_cmp_lt_u32 s9, 2
    s_cbranch_scc1 l_qkv_nocache
    s_bitcmp1_b32 s9, 0
    s_cbranch_scc1 l_qkv_c_b
    ds_write_b128 v3, v[64:67] offset:0
    ds_write_b128 v3, v[68:71] offset:1024
    ds_write_b128 v3, v[72:75] offset:2048
    ds_write_b128 v3, v[76:79] offset:3072
    ds_write_b128 v3, v[80:83] offset:4096
    ds_write_b128 v3, v[84:87] offset:5120
    ds_write_b128 v3, v[88:91] offset:6144
    ds_write_b128 v3, v[92:95] offset:7168
    ds_write_b128 v3, v[96:99] offset:24576
    ds_write_b128 v3, v[100:103] offset:25600
    ds_write_b128 v3, v[104:107] offset:26624
    ds_write_b128 v3, v[108:111] offset:27648
    ds_write_b128 v3, v[112:115] offset:28672
    ds_write_b128 v3, v[116:119] offset:29696
    ds_write_b128 v3, v[120:123] offset:30720
    ds_write_b128 v3, v[124:127] offset:31744
    ds_write_b128 v3, v[128:131] offset:49152
    ds_write_b128 v3, v[132:135] offset:50176
    ds_write_b128 v3, v[136:139] offset:51200
    ds_write_b128 v3, v[140:143] offset:52224
    ds_write_b128 v3, v[144:147] offset:53248
    ds_write_b128 v3, v[148:151] offset:54272
    ds_write_b128 v3, v[152:155] offset:55296
    ds_write_b128 v3, v[156:159] offset:56320
    s_branch l_qkv_c_w
l_qkv_c_b:
    ds_write_b128 v3, v[160:163] offset:0
    ds_write_b128 v3, v[164:167] offset:1024
    ds_write_b128 v3, v[168:171] offset:2048
    ds_write_b128 v3, v[172:175] offset:3072
    ds_write_b128 v3, v[176:179] offset:4096
    ds_write_b128 v3, v[180:183] offset:5120
    ds_write_b128 v3, v[184:187] offset:6144
    ds_write_b128 v3, v[188:191] offset:7168
    ds_write_b128 v3, v[192:195] offset:24576
    ds_write_b128 v3, v[196:199] offset:25600
    ds_write_b128 v3, v[200:203] offset:26624
    ds_write_b128 v3, v[204:207] offset:27648
    ds_write_b128 v3, v[208:211] offset:28672
    ds_write_b128 v3, v[212:215] offset:29696
    ds_write_b128 v3, v[216:219] offset:30720
    ds_write_b128 v3, v[220:223] offset:31744
    ds_write_b128 v3, a[0:3] offset:49152
    ds_write_b128 v3, a[4:7] offset:50176
    ds_write_b128 v3, a[8:11] offset:51200
    ds_write_b128 v3, a[12:15] offset:52224
    ds_write_b128 v3, a[16:19] offset:53248
    ds_write_b128 v3, a[20:23] offset:54272
    ds_write_b128 v3, a[24:27] offset:55296
    ds_write_b128 v3, a[28:31] offset:56320
l_qkv_c_w:
    s_waitcnt lgkmcnt(0)
    s_barrier
    s_mov_b32 m0, s48
    s_add_u32 s50, s50, 1
    buffer_load_dwordx4 v5, s[12:15], s49 offen offset:0 sc1 lds
    buffer_load_dwordx4 v5, s[12:15], s49 offen offset:1024 sc1 lds
    buffer_load_dwordx4 v5, s[12:15], s49 offen offset:2048 sc1 lds
    buffer_load_dwordx4 v5, s[12:15], s49 offen offset:3072 sc1 lds
    s_add_u32 s49, s49, 4096
    s_bitcmp1_b32 s50, 0
    s_cselect_b32 s3, 0, 16384
    s_add_u32 s48, s48, s3
    s_add_u32 s49, s49, s3
    s_cmp_eq_u32 s50, 12
    s_cselect_b32 s3, 4294819840, 0
    s_add_u32 s48, s48, 4096
    s_add_u32 s48, s48, s3
    s_mov_b32 m0, s48
    s_add_u32 s50, s50, 1
    buffer_load_dwordx4 v5, s[12:15], s49 offen offset:0 sc1 lds
    buffer_load_dwordx4 v5, s[12:15], s49 offen offset:1024 sc1 lds
    buffer_load_dwordx4 v5, s[12:15], s49 offen offset:2048 sc1 lds
    buffer_load_dwordx4 v5, s[12:15], s49 offen offset:3072 sc1 lds
    s_add_u32 s49, s49, 4096
    s_bitcmp1_b32 s50, 0
    s_cselect_b32 s3, 0, 16384
    s_add_u32 s48, s48, s3
    s_add_u32 s49, s49, s3
    s_cmp_eq_u32 s50, 12
    s_cselect_b32 s3, 4294819840, 0
    s_add_u32 s48, s48, 4096
    s_add_u32 s48, s48, s3
    s_mov_b32 m0, s48
    s_add_u32 s50, s50, 1
    buffer_load_dwordx4 v5, s[12:15], s49 offen offset:0 sc1 lds
    buffer_load_dwordx4 v5, s[12:15], s49 offen offset:1024 sc1 lds
    buffer_load_dwordx4 v5, s[12:15], s49 offen offset:2048 sc1 lds
    buffer_load_dwordx4 v5, s[12:15], s49 offen offset:3072 sc1 lds
    s_add_u32 s49, s49, 4096
    s_bitcmp1_b32 s50, 0
    s_cselect_b32 s3, 0, 16384
    s_add_u32 s48, s48, s3
    s_add_u32 s49, s49, s3
    s_cmp_eq_u32 s50, 12
    s_cselect_b32 s3, 4294819840, 0
    s_add_u32 s48, s48, 4096
    s_add_u32 s48, s48, s3
    s_mov_b32 m0, s48
    s_add_u32 s50, s50, 1
    buffer_load_dwordx4 v5, s[12:15], s49 offen offset:0 sc1 lds
    buffer_load_dwordx4 v5, s[12:15], s49 offen offset:1024 sc1 lds
    buffer_load_dwordx4 v5, s[12:15], s49 offen offset:2048 sc1 lds
    buffer_load_dwordx4 v5, s[12:15], s49 offen offset:3072 sc1 lds
    s_add_u32 s49, s49, 4096
    s_bitcmp1_b32 s50, 0
    s_cselect_b32 s3, 0, 16384
    s_add_u32 s48, s48, s3
    s_add_u32 s49, s49, s3
    s_cmp_eq_u32 s50, 12
    s_cselect_b32 s3, 4294819840, 0
    s_add_u32 s48, s48, 4096
    s_add_u32 s48, s48, s3
    s_mov_b32 s50, 12
    s_add_u32 s49, s49, 98304
    s_lshl_b32 s48, s51, 13
    s_waitcnt vmcnt(8)
    s_barrier
    s_waitcnt vmcnt(0)
    s_branch l_qkv_gone
l_qkv_nocache:
    s_barrier
l_qkv_fill:
    s_mov_b32 m0, s48
    s_add_u32 s50, s50, 1
    buffer_load_dwordx4 v5, s[12:15], s49 offen offset:0 sc1 lds
    buffer_load_dwordx4 v5, s[12:15], s49 offen offset:1024 sc1 lds
    buffer_load_dwordx4 v5, s[12:15], s49 offen offset:2048 sc1 lds
    buffer_load_dwordx4 v5, s[12:15], s49 offen offset:3072 sc1 lds
    s_add_u32 s49, s49, 4096
    s_bitcmp1_b32 s50, 0
    s_cselect_b32 s3, 0, 16384
    s_add_u32 s48, s48, s3
    s_add_u32 s49, s49, s3
    s_cmp_eq_u32 s50, 12
    s_cselect_b32 s3, 4294819840, 0
    s_add_u32 s48, s48, 4096
    s_add_u32 s48, s48, s3
l_qkv_fill1:
    s_mov_b32 m0, s48
    s_add_u32 s50, s50, 1
    buffer_load_dwordx4 v5, s[12:15], s49 offen offset:0 sc1 lds
    buffer_load_dwordx4 v5, s[12:15], s49 offen offset:1024 sc1 lds
    buffer_load_dwordx4 v5, s[12:15], s49 offen offset:2048 sc1 lds
    buffer_load_dwordx4 v5, s[12:15], s49 offen offset:3072 sc1 lds
    s_add_u32 s49, s49, 4096
    s_bitcmp1_b32 s50, 0
    s_cselect_b32 s3, 0, 16384
    s_add_u32 s48, s48, s3
    s_add_u32 s49, s49, s3
    s_cmp_eq_u32 s50, 12
    s_cselect_b32 s3, 4294819840, 0
    s_add_u32 s48, s48, 4096
    s_add_u32 s48, s48, s3
l_qkv_fill2:
    s_add_u32 s52, s9, 1
    s_mov_b32 m0, s48
    s_add_u32 s50, s50, 1
    buffer_load_dwordx4 v5, s[12:15], s49 offen offset:0 sc1 lds
    s_waitcnt vmcnt(10)
    buffer_load_dwordx4 v5, s[12:15], s49 offen offset:1024 sc1 lds
    s_waitcnt vmcnt(10)
    buffer_load_dwordx4 v5, s[12:15], s49 offen offset:2048 sc1 lds
    s_waitcnt vmcnt(10)
    buffer_load_dwordx4 v5, s[12:15], s49 offen offset:3072 sc1 lds
    s_waitcnt vmcnt(10)
    s_add_u32 s49, s49, 4096
    s_bitcmp1_b32 s50, 0
    s_cselect_b32 s3, 0, 16384
    s_add_u32 s48, s48, s3
    s_add_u32 s49, s49, s3
    s_cmp_eq_u32 s50, 12
    s_cselect_b32 s3, 4294819840, 0
    s_add_u32 s48, s48, 4096
    s_add_u32 s48, s48, s3
l_qkv_pre:
    s_mov_b32 m0, s48
    s_add_u32 s50, s50, 1
    buffer_load_dwordx4 v5, s[12:15], s49 offen offset:0 sc1 lds
    s_waitcnt vmcnt(10)
    buffer_load_dwordx4 v5, s[12:15], s49 offen offset:1024 sc1 lds
    s_waitcnt vmcnt(10)
    buffer_load_dwordx4 v5, s[12:15], s49 offen offset:2048 sc1 lds
    s_waitcnt vmcnt(10)
    buffer_load_dwordx4 v5, s[12:15], s49 offen offset:3072 sc1 lds
    s_waitcnt vmcnt(10)
    s_add_u32 s49, s49, 4096
    s_bitcmp1_b32 s50, 0
    s_cselect_b32 s3, 0, 16384
    s_add_u32 s48, s48, s3
    s_add_u32 s49, s49, s3
    s_cmp_eq_u32 s50, 12
    s_cselect_b32 s3, 4294819840, 0
    s_add_u32 s48, s48, 4096
    s_add_u32 s48, s48, s3
    ds_read_b32 v8, v13
    s_cmp_ge_u32 s50, 12
    s_cbranch_scc1 l_qkv_go
    s_waitcnt lgkmcnt(0)
    v_readfirstlane_b32 s3, v8
    s_cmp_lg_u32 s3, s52
    s_cbranch_scc1 l_qkv_pre
    s_cmp_ge_u32 s50, 5
    s_cbranch_scc1 l_qkv_go
    s_waitcnt vmcnt(8)
l_qkv_go:
    s_waitcnt lgkmcnt(0)
    s_barrier
l_qkv_gone:
    s_bitcmp0_b32 s50, 0
    s_cbranch_scc1 l_qkv_even
    s_mov_b32 m0, s48
    s_add_u32 s50, s50, 1
    buffer_load_dwordx4 v5, s[12:15], s49 offen offset:0 sc1 lds
    buffer_load_dwordx4 v5, s[12:15], s49 offen offset:1024 sc1 lds
    buffer_load_dwordx4 v5, s[12:15], s49 offen offset:2048 sc1 lds
    buffer_load_dwordx4 v5, s[12:15], s49 offen offset:3072 sc1 lds
    s_add_u32 s49, s49, 4096
    s_bitcmp1_b32 s50, 0
    s_cselect_b32 s3, 0, 16384
    s_add_u32 s48, s48, s3
    s_add_u32 s49, s49, s3
    s_cmp_eq_u32 s50, 12
    s_cselect_b32 s3, 4294819840, 0
    s_add_u32 s48, s48, 4096
    s_add_u32 s48, s48, s3
l_qkv_even:
    s_cmp_gt_u32 s50, 11
    s_cbranch_scc1 stg_35
    s_mov_b32 m0, s48
    s_add_u32 s50, s50, 1
    buffer_load_dwordx4 v5, s[12:15], s49 offen offset:0 sc1 lds
    buffer_load_dwordx4 v5, s[12:15], s49 offen offset:1024 sc1 lds
    buffer_load_dwordx4 v5, s[12:15], s49 offen offset:2048 sc1 lds
    buffer_load_dwordx4 v5, s[12:15], s49 offen offset:3072 sc1 lds
    s_add_u32 s49, s49, 4096
    s_bitcmp1_b32 s50, 0
    s_cselect_b32 s3, 0, 16384
    s_add_u32 s48, s48, s3
    s_add_u32 s49, s49, s3
    s_cmp_eq_u32 s50, 12
    s_cselect_b32 s3, 4294819840, 0
    s_add_u32 s48, s48, 4096
    s_add_u32 s48, s48, s3
    s_cmp_ge_u32 s9, 2
    s_cbranch_scc1 stg_35
stg_35:
    s_cmp_lg_u32 s51, 0
    s_cbranch_scc1 role_36
    buffer_load_dwordx4 v[32:35], v10, s[12:15], s59 offen sc1
role_36:
    s_lshr_b32 s3, s9, 1
    s_andn2_b32 s3, s50, s3
    s_bitcmp0_b32 s3, 0
    s_cbranch_scc1 str_37
    s_waitcnt vmcnt(1)
    s_mov_b32 m0, s48
    s_add_u32 s50, s50, 1
    buffer_load_dwordx4 v5, s[12:15], s49 offen offset:0 sc1 lds
    buffer_load_dwordx4 v5, s[12:15], s49 offen offset:1024 sc1 lds
    buffer_load_dwordx4 v5, s[12:15], s49 offen offset:2048 sc1 lds
    buffer_load_dwordx4 v5, s[12:15], s49 offen offset:3072 sc1 lds
    s_add_u32 s49, s49, 4096
    s_bitcmp1_b32 s50, 0
    s_cselect_b32 s3, 0, 16384
    s_add_u32 s48, s48, s3
    s_add_u32 s49, s49, s3
    s_cmp_eq_u32 s50, 12
    s_cselect_b32 s3, 4294819840, 0
    s_add_u32 s48, s48, 4096
    s_add_u32 s48, s48, s3
str_37:
    s_waitcnt vmcnt(8)
    s_barrier
    s_waitcnt vmcnt(0)
l_qkv_b0:
    s_cmp_gt_u32 s50, 13
    s_cbranch_scc1 stg_38
    s_mov_b32 m0, s48
    s_add_u32 s50, s50, 1
    buffer_load_dwordx4 v5, s[12:15], s49 offen offset:0 sc1 lds
    buffer_load_dwordx4 v5, s[12:15], s49 offen offset:1024 sc1 lds
    buffer_load_dwordx4 v5, s[12:15], s49 offen offset:2048 sc1 lds
    buffer_load_dwordx4 v5, s[12:15], s49 offen offset:3072 sc1 lds
    s_add_u32 s49, s49, 4096
    s_bitcmp1_b32 s50, 0
    s_cselect_b32 s3, 0, 16384
    s_add_u32 s48, s48, s3
    s_add_u32 s49, s49, s3
    s_cmp_eq_u32 s50, 12
    s_cselect_b32 s3, 4294819840, 0
    s_add_u32 s48, s48, 4096
    s_add_u32 s48, s48, s3
    s_cmp_ge_u32 s9, 2
    s_cbranch_scc1 stg_38
stg_38:
    s_cmp_eq_u32 s60, 0
    s_cbranch_scc1 ub_39
    buffer_store_dwordx4 v[192:195], v14, s[12:15], s57 offen offset:0 sc1
    v_mfma_f32_16x16x32_bf16 v[28:31], v[24:27], v[192:195], 0
    buffer_store_dwordx4 v[196:199], v14, s[12:15], s57 offen offset:512 sc1
    v_mfma_f32_16x16x32_bf16 v[28:31], v[24:27], v[196:199], v[28:31]
ub_39:
    s_cmp_lg_u32 s51, 0
    s_cbranch_scc1 role_40
    v_add_f32_dpp v32, v32, v32 row_ror:4 row_mask:0xf bank_mask:0xf
    v_add_f32_dpp v33, v33, v33 row_ror:4 row_mask:0xf bank_mask:0xf
    v_add_f32_dpp v34, v34, v34 row_ror:4 row_mask:0xf bank_mask:0xf
    v_add_f32_dpp v35, v35, v35 row_ror:4 row_mask:0xf bank_mask:0xf
    v_add_f32_dpp v32, v32, v32 row_ror:8 row_mask:0xf bank_mask:0xf
    v_add_f32_dpp v33, v33, v33 row_ror:8 row_mask:0xf bank_mask:0xf
    v_add_f32_dpp v34, v34, v34 row_ror:8 row_mask:0xf bank_mask:0xf
    v_add_f32_dpp v35, v35, v35 row_ror:8 row_mask:0xf bank_mask:0xf
    v_mov_b32 v36, v32
    v_mov_b32 v37, v33
    v_mov_b32 v38, v34
    v_mov_b32 v39, v35
    v_permlane16_swap_b32 v32, v36
    v_permlane16_swap_b32 v33, v37
    v_permlane16_swap_b32 v34, v38
    v_permlane16_swap_b32 v35, v39
    v_add_f32 v32, v32, v36
    v_add_f32 v33, v33, v37
    v_add_f32 v34, v34, v38
    v_add_f32 v35, v35, v39
    v_mov_b32 v36, v32
    v_mov_b32 v37, v33
    v_mov_b32 v38, v34
    v_mov_b32 v39, v35
    v_permlane32_swap_b32 v32, v36
    v_permlane32_swap_b32 v33, v37
    v_permlane32_swap_b32 v34, v38
    v_permlane32_swap_b32 v35, v39
    v_add_f32 v40, v32, v36
    v_add_f32 v42, v33, v37
    v_add_f32 v44, v34, v38
    v_add_f32 v46, v35, v39
role_40:
    s_lshr_b32 s3, s9, 1
    s_andn2_b32 s3, s50, s3
    s_bitcmp0_b32 s3, 0
    s_cbranch_scc1 str_41
    s_waitcnt vmcnt(1)
    s_mov_b32 m0, s48
    s_add_u32 s50, s50, 1
    buffer_load_dwordx4 v5, s[12:15], s49 offen offset:0 sc1 lds
    buffer_load_dwordx4 v5, s[12:15], s49 offen offset:1024 sc1 lds
    buffer_load_dwordx4 v5, s[12:15], s49 offen offset:2048 sc1 lds
    buffer_load_dwordx4 v5, s[12:15], s49 offen offset:3072 sc1 lds
    s_add_u32 s49, s49, 4096
    s_bitcmp1_b32 s50, 0
    s_cselect_b32 s3, 0, 16384
    s_add_u32 s48, s48, s3
    s_add_u32 s49, s49, s3
    s_cmp_eq_u32 s50, 12
    s_cselect_b32 s3, 4294819840, 0
    s_add_u32 s48, s48, 4096
    s_add_u32 s48, s48, s3
str_41:
    s_waitcnt vmcnt(8)
    s_barrier
    s_cmp_gt_u32 s50, 15
    s_cbranch_scc1 stg_42
    s_mov_b32 m0, s48
    s_add_u32 s50, s50, 1
    buffer_load_dwordx4 v5, s[12:15], s49 offen offset:0 sc1 lds
    buffer_load_dwordx4 v5, s[12:15], s49 offen offset:1024 sc1 lds
    buffer_load_dwordx4 v5, s[12:15], s49 offen offset:2048 sc1 lds
    buffer_load_dwordx4 v5, s[12:15], s49 offen offset:3072 sc1 lds
    s_add_u32 s49, s49, 4096
    s_bitcmp1_b32 s50, 0
    s_cselect_b32 s3, 0, 16384
    s_add_u32 s48, s48, s3
    s_add_u32 s49, s49, s3
    s_cmp_eq_u32 s50, 12
    s_cselect_b32 s3, 4294819840, 0
    s_add_u32 s48, s48, 4096
    s_add_u32 s48, s48, s3
    s_cmp_ge_u32 s9, 2
    s_cbranch_scc1 stg_42
stg_42:
    s_cmp_eq_u32 s60, 0
    s_cbranch_scc1 ub_43
    buffer_store_dwordx4 v[200:203], v14, s[12:15], s57 offen offset:1024 sc1
    v_mfma_f32_16x16x32_bf16 v[28:31], v[24:27], v[200:203], v[28:31]
    buffer_store_dwordx4 v[204:207], v14, s[12:15], s57 offen offset:1536 sc1
    v_mfma_f32_16x16x32_bf16 v[28:31], v[24:27], v[204:207], v[28:31]
ub_43:
    s_cmp_lg_u32 s51, 0
    s_cbranch_scc1 role_44
    v_mul_f32 v40, 0x3a800000, v40
    v_mul_f32 v44, 0x3a800000, v44
    v_mul_f32 v42, 0x3a800000, v42
    v_mul_f32 v46, 0x3a800000, v46
    v_fma_f32 v42, -v40, v40, v42
    v_fma_f32 v46, -v44, v44, v46
    v_max_f32 v42, 0, v42
    v_max_f32 v46, 0, v46
    v_add_f32 v42, 0x3727c5ac, v42
    v_add_f32 v46, 0x3727c5ac, v46
    v_rsq_f32 v42, v42
    v_rsq_f32 v46, v46
    s_lshl_b32 s3, s11, 7
    s_add_u32 s3, s3, s56
    s_mov_b64 exec, 0xf
    buffer_store_dwordx4 v[40:43], v7, s[12:15], s3 offen offset:0 sc1
    buffer_store_dwordx4 v[44:47], v7, s[12:15], s3 offen offset:16 sc1
    s_mov_b64 exec, -1
role_44:
    s_lshr_b32 s3, s9, 1
    s_andn2_b32 s3, s50, s3
    s_bitcmp0_b32 s3, 0
    s_cbranch_scc1 str_45
    s_waitcnt vmcnt(1)
    s_mov_b32 m0, s48
    s_add_u32 s50, s50, 1
    buffer_load_dwordx4 v5, s[12:15], s49 offen offset:0 sc1 lds
    buffer_load_dwordx4 v5, s[12:15], s49 offen offset:1024 sc1 lds
    buffer_load_dwordx4 v5, s[12:15], s49 offen offset:2048 sc1 lds
    buffer_load_dwordx4 v5, s[12:15], s49 offen offset:3072 sc1 lds
    s_add_u32 s49, s49, 4096
    s_bitcmp1_b32 s50, 0
    s_cselect_b32 s3, 0, 16384
    s_add_u32 s48, s48, s3
    s_add_u32 s49, s49, s3
    s_cmp_eq_u32 s50, 12
    s_cselect_b32 s3, 4294819840, 0
    s_add_u32 s48, s48, 4096
    s_add_u32 s48, s48, s3
str_45:
    s_waitcnt vmcnt(8)
    s_barrier
    s_cmp_gt_u32 s50, 15
    s_cbranch_scc1 stg_46
    s_mov_b32 m0, s48
    s_add_u32 s50, s50, 1
    buffer_load_dwordx4 v5, s[12:15], s49 offen offset:0 sc1 lds
    buffer_load_dwordx4 v5, s[12:15], s49 offen offset:1024 sc1 lds
    buffer_load_dwordx4 v5, s[12:15], s49 offen offset:2048 sc1 lds
    buffer_load_dwordx4 v5, s[12:15], s49 offen offset:3072 sc1 lds
    s_add_u32 s49, s49, 4096
    s_bitcmp1_b32 s50, 0
    s_cselect_b32 s3, 0, 16384
    s_add_u32 s48, s48, s3
    s_add_u32 s49, s49, s3
    s_cmp_eq_u32 s50, 12
    s_cselect_b32 s3, 4294819840, 0
    s_add_u32 s48, s48, 4096
    s_add_u32 s48, s48, s3
    s_cmp_ge_u32 s9, 2
    s_cbranch_scc1 stg_46
stg_46:
    s_cmp_eq_u32 s60, 0
    s_cbranch_scc1 ub_47
    buffer_store_dwordx4 v[208:211], v14, s[12:15], s57 offen offset:2048 sc1
    v_mfma_f32_16x16x32_bf16 v[28:31], v[24:27], v[208:211], v[28:31]
    buffer_store_dwordx4 v[212:215], v14, s[12:15], s57 offen offset:2560 sc1
    v_mfma_f32_16x16x32_bf16 v[28:31], v[24:27], v[212:215], v[28:31]
ub_47:
    s_lshr_b32 s3, s9, 1
    s_andn2_b32 s3, s50, s3
    s_bitcmp0_b32 s3, 0
    s_cbranch_scc1 str_48
    s_waitcnt vmcnt(1)
    s_mov_b32 m0, s48
    s_add_u32 s50, s50, 1
    buffer_load_dwordx4 v5, s[12:15], s49 offen offset:0 sc1 lds
    buffer_load_dwordx4 v5, s[12:15], s49 offen offset:1024 sc1 lds
    buffer_load_dwordx4 v5, s[12:15], s49 offen offset:2048 sc1 lds
    buffer_load_dwordx4 v5, s[12:15], s49 offen offset:3072 sc1 lds
    s_add_u32 s49, s49, 4096
    s_bitcmp1_b32 s50, 0
    s_cselect_b32 s3, 0, 16384
    s_add_u32 s48, s48, s3
    s_add_u32 s49, s49, s3
    s_cmp_eq_u32 s50, 12
    s_cselect_b32 s3, 4294819840, 0
    s_add_u32 s48, s48, 4096
    s_add_u32 s48, s48, s3
str_48:
    s_waitcnt vmcnt(8)
    s_barrier
    s_cmp_gt_u32 s50, 15
    s_cbranch_scc1 stg_49
    s_mov_b32 m0, s48
    s_add_u32 s50, s50, 1
    buffer_load_dwordx4 v5, s[12:15], s49 offen offset:0 sc1 lds
    buffer_load_dwordx4 v5, s[12:15], s49 offen offset:1024 sc1 lds
    buffer_load_dwordx4 v5, s[12:15], s49 offen offset:2048 sc1 lds
    buffer_load_dwordx4 v5, s[12:15], s49 offen offset:3072 sc1 lds
    s_add_u32 s49, s49, 4096
    s_bitcmp1_b32 s50, 0
    s_cselect_b32 s3, 0, 16384
    s_add_u32 s48, s48, s3
    s_add_u32 s49, s49, s3
    s_cmp_eq_u32 s50, 12
    s_cselect_b32 s3, 4294819840, 0
    s_add_u32 s48, s48, 4096
    s_add_u32 s48, s48, s3
    s_cmp_ge_u32 s9, 2
    s_cbranch_scc1 stg_49
stg_49:
    s_cmp_eq_u32 s60, 0
    s_cbranch_scc1 ub_50
    buffer_store_dwordx4 v[216:219], v14, s[12:15], s57 offen offset:3072 sc1
    v_mfma_f32_16x16x32_bf16 v[28:31], v[24:27], v[216:219], v[28:31]
    buffer_store_dwordx4 v[220:223], v14, s[12:15], s57 offen offset:3584 sc1
    v_mfma_f32_16x16x32_bf16 v[28:31], v[24:27], v[220:223], v[28:31]
ub_50:
    s_cmp_ge_u32 s9, 2
    s_cbranch_scc1 wc_51
    s_bitcmp1_b32 s9, 0
    s_cbranch_scc1 wc_51_b
    ds_read_b128 v[64:67], v3 offset:0
    ds_read_b128 v[68:71], v3 offset:1024
    ds_read_b128 v[72:75], v3 offset:2048
    ds_read_b128 v[76:79], v3 offset:3072
    ds_read_b128 v[80:83], v3 offset:4096
    ds_read_b128 v[84:87], v3 offset:5120
    ds_read_b128 v[88:91], v3 offset:6144
    ds_read_b128 v[92:95], v3 offset:7168
    s_branch wc_51_w
wc_51_b:
    ds_read_b128 v[160:163], v3 offset:0
    ds_read_b128 v[164:167], v3 offset:1024
    ds_read_b128 v[168:171], v3 offset:2048
    ds_read_b128 v[172:175], v3 offset:3072
    ds_read_b128 v[176:179], v3 offset:4096
    ds_read_b128 v[180:183], v3 offset:5120
    ds_read_b128 v[184:187], v3 offset:6144
    ds_read_b128 v[188:191], v3 offset:7168
wc_51_w:
    s_waitcnt lgkmcnt(0)
wc_51:
    s_cmp_lg_u32 s51, 1
    s_cbranch_scc1 role_52
    s_and_b32 s52, s11, 0xe0
    s_lshl_b32 s52, s52, 7
    s_add_u32 s52, s52, s56
    s_lshr_b32 s3, s6, 1
    s_min_u32 s3, s3, 1
    s_andn2_b32 s3, s3, s9
    s_lshl_b32 s3, s3, 8
    s_sub_u32 s53, s52, s3
    buffer_load_dwordx4 v[32:35], v5, s[12:15], s52 offen offset:0 sc1
    buffer_load_dwordx4 v[36:39], v5, s[12:15], s52 offen offset:1024 sc1
    buffer_load_dwordx4 v[40:43], v5, s[12:15], s52 offen offset:2048 sc1
    buffer_load_dwordx4 v[44:47], v5, s[12:15], s52 offen offset:3072 sc1
    buffer_load_dwordx4 v[48:51], v6, s[12:15], s53 offen sc1
role_52:
    s_lshr_b32 s3, s9, 1
    s_andn2_b32 s3, s50, s3
    s_bitcmp0_b32 s3, 0
    s_cbranch_scc1 str_53
    s_waitcnt vmcnt(1)
    s_mov_b32 m0, s48
    s_add_u32 s50, s50, 1
    buffer_load_dwordx4 v5, s[12:15], s49 offen offset:0 sc1 lds
    buffer_load_dwordx4 v5, s[12:15], s49 offen offset:1024 sc1 lds
    buffer_load_dwordx4 v5, s[12:15], s49 offen offset:2048 sc1 lds
    buffer_load_dwordx4 v5, s[12:15], s49 offen offset:3072 sc1 lds
    s_add_u32 s49, s49, 4096
    s_bitcmp1_b32 s50, 0
    s_cselect_b32 s3, 0, 16384
    s_add_u32 s48, s48, s3
    s_add_u32 s49, s49, s3
    s_cmp_eq_u32 s50, 12
    s_cselect_b32 s3, 4294819840, 0
    s_add_u32 s48, s48, 4096
    s_add_u32 s48, s48, s3
str_53:
    s_waitcnt vmcnt(8)
    s_barrier
    s_waitcnt vmcnt(0)
    s_cmp_gt_u32 s50, 15
    s_cbranch_scc1 stg_54
    s_mov_b32 m0, s48
    s_add_u32 s50, s50, 1
    buffer_load_dwordx4 v5, s[12:15], s49 offen offset:0 sc1 lds
    buffer_load_dwordx4 v5, s[12:15], s49 offen offset:1024 sc1 lds
    buffer_load_dwordx4 v5, s[12:15], s49 offen offset:2048 sc1 lds
    buffer_load_dwordx4 v5, s[12:15], s49 offen offset:3072 sc1 lds
    s_add_u32 s49, s49, 4096
    s_bitcmp1_b32 s50, 0
    s_cselect_b32 s3, 0, 16384
    s_add_u32 s48, s48, s3
    s_add_u32 s49, s49, s3
    s_cmp_eq_u32 s50, 12
    s_cselect_b32 s3, 4294819840, 0
    s_add_u32 s48, s48, 4096
    s_add_u32 s48, s48, s3
    s_cmp_ge_u32 s9, 2
    s_cbranch_scc1 stg_54
stg_54:
    s_cmp_eq_u32 s60, 0
    s_cbranch_scc1 ub_55
    v_add_f32_dpp v28, v28, v28 row_ror:8 row_mask:0xf bank_mask:0xf
    v_add_f32_dpp v29, v29, v29 row_ror:8 row_mask:0xf bank_mask:0xf
    v_add_f32_dpp v30, v30, v30 row_ror:8 row_mask:0xf bank_mask:0xf
    v_add_f32_dpp v31, v31, v31 row_ror:8 row_mask:0xf bank_mask:0xf
    s_mov_b64 exec, 0x00ff00ff
    buffer_store_dwordx4 v[28:31], v15, s[12:15], s54 offen sc1
    s_mov_b64 exec, -1
ub_55:
    s_cmp_ge_u32 s9, 2
    s_cbranch_scc1 wc_56
    s_bitcmp1_b32 s9, 0
    s_cbranch_scc1 wc_56_b
    ds_read_b128 v[96:99], v3 offset:24576
    ds_read_b128 v[100:103], v3 offset:25600
    ds_read_b128 v[104:107], v3 offset:26624
    ds_read_b128 v[108:111], v3 offset:27648
    ds_read_b128 v[112:115], v3 offset:28672
    ds_read_b128 v[116:119], v3 offset:29696
    ds_read_b128 v[120:123], v3 offset:30720
    ds_read_b128 v[124:127], v3 offset:31744
    s_branch wc_56_w
wc_56_b:
    ds_read_b128 v[192:195], v3 offset:24576
    ds_read_b128 v[196:199], v3 offset:25600
    ds_read_b128 v[200:203], v3 offset:26624
    ds_read_b128 v[204:207], v3 offset:27648
    ds_read_b128 v[208:211], v3 offset:28672
    ds_read_b128 v[212:215], v3 offset:29696
    ds_read_b128 v[216:219], v3 offset:30720
    ds_read_b128 v[220:223], v3 offset:31744
wc_56_w:
    s_waitcnt lgkmcnt(0)
wc_56:
    s_cmp_lg_u32 s51, 1
    s_cbranch_scc1 role_57
    s_mov_b32 s3, 0x100000
l_st_chk:
    v_cmp_ne_u32 s[64:65], s10, v33
    v_cmp_ne_u32 vcc, s10, v35
    s_or_b64 s[64:65], s[64:65], vcc
    v_cmp_ne_u32 vcc, s10, v37
    s_or_b64 s[64:65], s[64:65], vcc
    v_cmp_ne_u32 vcc, s10, v39
    s_or_b64 s[64:65], s[64:65], vcc
    v_cmp_ne_u32 vcc, s10, v41
    s_or_b64 s[64:65], s[64:65], vcc
    v_cmp_ne_u32 vcc, s10, v43
    s_or_b64 s[64:65], s[64:65], vcc
    v_cmp_ne_u32 vcc, s10, v45
    s_or_b64 s[64:65], s[64:65], vcc
    v_cmp_ne_u32 vcc, s10, v47
    s_or_b64 s[64:65], s[64:65], vcc
    v_cmp_ne_u32 vcc, s10, v49
    s_or_b64 s[64:65], s[64:65], vcc
    v_cmp_ne_u32 vcc, s10, v51
    s_or_b64 s[64:65], s[64:65], vcc
    s_cbranch_scc0 l_st_ok
    s_sub_u32 s3, s3, 1
    s_cbranch_scc0 l_st_again
l_st_ok:
    ds_write_b32 v11, v32 offset:1280
    ds_write_b32 v11, v34 offset:2816
    ds_write_b32 v11, v36 offset:1536
    ds_write_b32 v11, v38 offset:3072
    ds_write_b32 v11, v40 offset:1792
    ds_write_b32 v11, v42 offset:3328
    ds_write_b32 v11, v44 offset:2048
    ds_write_b32 v11, v46 offset:3584
    s_mov_b64 exec, 0xffff
    ds_write_b32 v11, v48 offset:1216
    ds_write_b32 v11, v50 offset:2752
    s_mov_b64 exec, -1
    s_waitcnt lgkmcnt(0)
role_57:
    s_lshr_b32 s3, s9, 1
    s_andn2_b32 s3, s50, s3
    s_bitcmp0_b32 s3, 0
    s_cbranch_scc1 str_58
    s_waitcnt vmcnt(1)
    s_mov_b32 m0, s48
    s_add_u32 s50, s50, 1
    buffer_load_dwordx4 v5, s[12:15], s49 offen offset:0 sc1 lds
    buffer_load_dwordx4 v5, s[12:15], s49 offen offset:1024 sc1 lds
    buffer_load_dwordx4 v5, s[12:15], s49 offen offset:2048 sc1 lds
    buffer_load_dwordx4 v5, s[12:15], s49 offen offset:3072 sc1 lds
    s_add_u32 s49, s49, 4096
    s_bitcmp1_b32 s50, 0
    s_cselect_b32 s3, 0, 16384
    s_add_u32 s48, s48, s3
    s_add_u32 s49, s49, s3
    s_cmp_eq_u32 s50, 12
    s_cselect_b32 s3, 4294819840, 0
    s_add_u32 s48, s48, 4096
    s_add_u32 s48, s48, s3
str_58:
    s_add_u32 s61, s51, 48
    s_bitcmp1_b32 s9, 0
    s_cbranch_scc1 wo_59
    s_mov_b32 s24, s36
    s_mov_b32 s25, s37
    s_mov_b32 s26, 2097152
    s_mov_b32 s27, 0x00020000
    s_and_b32 s3, s7, 7
    s_cmp_eq_u32 s3, 3
    s_cbranch_scc0 wo_59
    s_cmp_eq_u32 s9, 0
    s_cbranch_scc1 wo_59
wop_60:
    s_lshl_b32 m0, s61, 10
    s_lshr_b32 s3, s61, 1
    s_xor_b32 s3, s3, s61
    s_and_b32 s3, s3, 1
    s_mul_i32 s3, s3, 3
    s_xor_b32 s3, s3, s61
    s_lshl_b32 s3, s3, 14
    buffer_load_dwordx4 v17, s[24:27], s3 offen lds
    s_add_u32 s61, s61, 3
    s_waitcnt vmcnt(4)
    s_cmp_lt_u32 s61, 66
    s_cbranch_scc1 wop_60
wo_59:
    s_waitcnt vmcnt(8)
    s_barrier
    s_cmp_eq_u32 s60, 0
    s_cbranch_scc1 ub_61
    s_waitcnt vmcnt(0)
    s_mov_b64 exec, 0xffff
    buffer_store_dword v9, v16, s[12:15], s55 offen offset:384 sc1
    s_mov_b64 exec, -1
ub_61:
    s_cmp_ge_u32 s9, 2
    s_cbranch_scc1 wc_62
    s_bitcmp1_b32 s9, 0
    s_cbranch_scc1 wc_62_b
    ds_read_b128 v[128:131], v3 offset:49152
    ds_read_b128 v[132:135], v3 offset:50176
    ds_read_b128 v[136:139], v3 offset:51200
    ds_read_b128 v[140:143], v3 offset:52224
    ds_read_b128 v[144:147], v3 offset:53248
    ds_read_b128 v[148:151], v3 offset:54272
    ds_read_b128 v[152:155], v3 offset:55296
    ds_read_b128 v[156:159], v3 offset:56320
    s_branch wc_62_w
wc_62_b:
    ds_read_b128 a[0:3], v3 offset:49152
    ds_read_b128 a[4:7], v3 offset:50176
    ds_read_b128 a[8:11], v3 offset:51200
    ds_read_b128 a[12:15], v3 offset:52224
    ds_read_b128 a[16:19], v3 offset:53248
    ds_read_b128 a[20:23], v3 offset:54272
    ds_read_b128 a[24:27], v3 offset:55296
    ds_read_b128 a[28:31], v3 offset:56320
wc_62_w:
    s_waitcnt lgkmcnt(0)
wc_62:
    s_bitcmp1_b32 s9, 0
    s_cbranch_scc1 wo_63
    s_mov_b32 s24, s36
    s_mov_b32 s25, s37
    s_mov_b32 s26, 2097152
    s_mov_b32 s27, 0x00020000
    s_and_b32 s3, s7, 7
    s_cmp_eq_u32 s3, 3
    s_cbranch_scc0 wo_63
    s_cmp_eq_u32 s9, 0
    s_cbranch_scc1 wo_63
wop_64:
    s_lshl_b32 m0, s61, 10
    s_lshr_b32 s3, s61, 1
    s_xor_b32 s3, s3, s61
    s_and_b32 s3, s3, 1
    s_mul_i32 s3, s3, 3
    s_xor_b32 s3, s3, s61
    s_lshl_b32 s3, s3, 14
    buffer_load_dwordx4 v17, s[24:27], s3 offen lds
    s_add_u32 s61, s61, 3
    s_waitcnt vmcnt(4)
    s_cmp_lt_u32 s61, 84
    s_cbranch_scc1 wop_64
wo_63:
    s_waitcnt vmcnt(0)
    s_barrier
    s_bitcmp1_b32 s9, 0
    s_cbranch_scc1 wo_65
    s_mov_b32 s24, s36
    s_mov_b32 s25, s37
    s_mov_b32 s26, 2097152
    s_mov_b32 s27, 0x00020000
    s_and_b32 s3, s7, 7
    s_cmp_eq_u32 s3, 3
    s_cselect_b32 s62, 27, 48
    s_cselect_b32 s63, 12, 24
    s_add_u32 s62, s62, s61
    s_sub_u32 s62, s62, s51
    s_add_u32 s63, s63, s62
wop_66:
    s_lshl_b32 m0, s61, 10
    s_lshr_b32 s3, s61, 1
    s_xor_b32 s3, s3, s61
    s_and_b32 s3, s3, 1
    s_mul_i32 s3, s3, 3
    s_xor_b32 s3, s3, s61
    s_lshl_b32 s3, s3, 14
    buffer_load_dwordx4 v17, s[24:27], s3 offen lds
    s_add_u32 s61, s61, 3
    s_waitcnt vmcnt(7)
    s_cmp_lt_u32 s61, s62
    s_cbranch_scc1 wop_66
wo_65:
    s_barrier
    s_bitcmp1_b32 s9, 0
    s_cbranch_scc1 s_attn
    s_mov_b32 s24, s36
    s_mov_b32 s25, s37
    s_mov_b32 s26, 2097152
    s_mov_b32 s27, 0x00020000
wop_67:
    s_lshl_b32 m0, s61, 10
    s_lshr_b32 s3, s61, 1
    s_xor_b32 s3, s3, s61
    s_and_b32 s3, s3, 1
    s_mul_i32 s3, s3, 3
    s_xor_b32 s3, s3, s61
    s_lshl_b32 s3, s3, 14
    buffer_load_dwordx4 v17, s[24:27], s3 offen lds
    s_add_u32 s61, s61, 3
    s_waitcnt vmcnt(7)
    s_cmp_lt_u32 s61, s63
    s_cbranch_scc1 wop_67
    s_barrier
wop_68:
    s_lshl_b32 m0, s61, 10
    s_lshr_b32 s3, s61, 1
    s_xor_b32 s3, s3, s61
    s_and_b32 s3, s3, 1
    s_mul_i32 s3, s3, 3
    s_xor_b32 s3, s3, s61
    s_lshl_b32 s3, s3, 14
    buffer_load_dwordx4 v17, s[24:27], s3 offen lds
    s_add_u32 s61, s61, 3
    s_waitcnt vmcnt(7)
    s_cmp_lt_u32 s61, 128
    s_cbranch_scc1 wop_68
    s_mov_b32 s61, s51
wop_69:
    s_lshl_b32 m0, s61, 10
    s_lshr_b32 s3, s61, 1
    s_xor_b32 s3, s3, s61
    s_and_b32 s3, s3, 1
    s_mul_i32 s3, s3, 3
    s_xor_b32 s3, s3, s61
    s_lshl_b32 s3, s3, 14
    buffer_load_dwordx4 v17, s[24:27], s3 offen lds
    s_add_u32 s61, s61, 3
    s_waitcnt vmcnt(7)
    s_cmp_lt_u32 s61, 48
    s_cbranch_scc1 wop_69
    s_branch l_wo
l_st_again:
    buffer_load_dwordx4 v[32:35], v5, s[12:15], s52 offen offset:0 sc1
    buffer_load_dwordx4 v[36:39], v5, s[12:15], s52 offen offset:1024 sc1
    buffer_load_dwordx4 v[40:43], v5, s[12:15], s52 offen offset:2048 sc1
    buffer_load_dwordx4 v[44:47], v5, s[12:15], s52 offen offset:3072 sc1
    buffer_load_dwordx4 v[48:51], v6, s[12:15], s53 offen sc1
    s_waitcnt vmcnt(0)
    s_branch l_st_chk
.p2align 6
h_wo:
l_wo:
    s_mul_i32 s98, s9, 786432
    s_add_u32 s98, s98, 65798144
    s_lshl_b32 s99, s11, 10
    s_add_u32 s98, s98, s99
    s_add_u32 s96, s4, s98
    s_addc_u32 s97, s5, 0
    s_mov_b32 s98, s10
    s_mov_b32 s99, s10
    s_sub_u32 s59, s8, 4
    s_lshl_b32 s60, s59, 7
    s_add_u32 s96, s96, s60
    s_addc_u32 s97, s97, 0
    s_lshl_b32 s60, s9, 2
    s_add_u32 s60, s60, 159504
    v_mov_b32 v10, s60
    s_lshl_b32 s60, 1, s59
    v_mov_b32 v11, s60
    v_lshlrev_b32 v13, 4, v11
    s_mov_b64 exec, 1
    s_waitcnt vmcnt(0)
    ds_or_b32 v10, v13
    s_mov_b32 s3, 0x100000
poll_70:
    s_load_dwordx8 s[88:95], s[96:97], 0 glc
    s_sub_u32 s3, s3, 1
    s_cbranch_scc1 poll_70_ok
    s_waitcnt lgkmcnt(0)
    s_xor_b64 s[100:101], s[88:89], s[98:99]
    s_xor_b64 s[88:89], s[90:91], s[98:99]
    s_or_b64 s[100:101], s[100:101], s[88:89]
    s_xor_b64 s[88:89], s[92:93], s[98:99]
    s_or_b64 s[100:101], s[100:101], s[88:89]
    s_xor_b64 s[88:89], s[94:95], s[98:99]
    s_or_b64 s[100:101], s[100:101], s[88:89]
    s_cbranch_scc1 poll_70
poll_70_ok:
    s_waitcnt lgkmcnt(0)
    ds_or_b32 v10, v11
    s_mov_b64 exec, -1
    s_setprio 0
    s_waitcnt lgkmcnt(0)
    s_cmp_eq_u32 s8, 4
    s_cbranch_scc1 l_wo_end
    s_cmp_lg_u32 s9, 0
    s_cbranch_scc1 l_wo_end
    s_lshl_b32 s53, s8, 7
    s_lshl_b32 s52, s11, 10
    s_add_u32 s53, s53, s52
    s_add_u32 s53, s53, 64487168
    s_add_u32 s96, s4, s53
    s_addc_u32 s97, s5, 0
    s_mov_b32 s98, s10
    s_mov_b32 s99, s10
    s_mov_b32 s3, 0x100000
poll_71:
    s_load_dwordx16 s[80:95], s[96:97], 0 glc
    s_sub_u32 s3, s3, 1
    s_cbranch_scc1 poll_71_ok
    s_waitcnt lgkmcnt(0)
    s_xor_b64 s[100:101], s[80:81], s[98:99]
    s_xor_b64 s[80:81], s[82:83], s[98:99]
    s_or_b64 s[100:101], s[100:101], s[80:81]
    s_xor_b64 s[80:81], s[84:85], s[98:99]
    s_or_b64 s[100:101], s[100:101], s[80:81]
    s_xor_b64 s[80:81], s[86:87], s[98:99]
    s_or_b64 s[100:101], s[100:101], s[80:81]
    s_xor_b64 s[80:81], s[88:89], s[98:99]
    s_or_b64 s[100:101], s[100:101], s[80:81]
    s_xor_b64 s[80:81], s[90:91], s[98:99]
    s_or_b64 s[100:101], s[100:101], s[80:81]
    s_xor_b64 s[80:81], s[92:93], s[98:99]
    s_or_b64 s[100:101], s[100:101], s[80:81]
    s_xor_b64 s[80:81], s[94:95], s[98:99]
    s_or_b64 s[100:101], s[100:101], s[80:81]
    s_cbranch_scc1 poll_71
poll_71_ok:
    s_waitcnt lgkmcnt(0)
l_wo_end:
    s_add_u32 s9, s9, 1
    s_cmp_lg_u32 s9, 4
    s_cbranch_scc1 l_wo_next
    s_branch k_exit
l_wo_next:
    s_cmp_lg_u32 s8, 4
    s_cbranch_scc1 l_qkv
    s_cmp_eq_u32 s9, 2
    s_cbranch_scc1 h_qkvA
    s_branch h_qkvB
.p2align 6
s_attn:
    s_sub_u32 s48, s8, 4
    s_lshl_b32 s3, s7, 7
    v_lshrrev_b32 v20, 3, v1
    v_lshlrev_b32 v21, 11, v20
    v_lshrrev_b32 v22, 2, v1
    v_lshrrev_b32 v23, 4, v1
    v_xor_b32 v22, v22, v23
    v_and_b32 v22, 1, v22
    v_lshl_add_u32 v21, v22, 6, v21
    v_and_b32 v22, 3, v1
    v_lshl_add_u32 v21, v22, 4, v21
    v_add_u32 v7, s3, v21
    s_mov_b32 s24, s42
    s_mov_b32 s25, s43
    s_mov_b32 s26, 2097152
    s_mov_b32 s27, 0x00020000
    s_lshr_b32 s49, s9, 1
    s_lshl_b32 s49, s49, 23
    s_lshl_b32 s52, s7, 19
    s_add_u32 s49, s49, s52
    s_and_b32 s52, s6, 1
    s_lshl_b32 s52, s52, 18
    s_add_u32 s49, s49, s52
    s_add_u32 s49, s49, 33554432
    s_lshr_b32 s61, s6, 1
    s_mul_i32 s54, s9, 786432
    s_add_u32 s54, s54, 66322432
    s_lshl_b32 s55, s11, 10
    s_add_u32 s54, s54, s55
    s_add_u32 s52, s4, s54
    s_addc_u32 s53, s5, 0
    s_mov_b32 s54, s10
    s_mov_b32 s55, s10
    s_lshl_b32 s51, s48, 11
    s_add_u32 s49, s49, s51
    s_add_u32 s51, s51, 81920
    s_mov_b32 s60, s48
    s_setprio 3
    s_barrier
    s_lshl_b32 s58, 1, s61
    s_mov_b32 s57, 0
    s_add_u32 s62, s61, 1
    s_and_b32 s62, s62, 7
    s_lshl_b32 s50, s62, 15
    s_add_u32 s50, s50, s49
    s_lshr_b32 s63, s62, 1
    s_lshl_b32 s63, s63, 7
    s_and_b32 s62, s62, 1
    s_lshl_b32 s62, s62, 4
    s_add_u32 s62, s62, s63
    s_mov_b32 s58, 0x100000
need_72:
    s_load_dwordx4 s[64:67], s[52:53], s62 glc
    s_sub_u32 s58, s58, 1
    s_cbranch_scc1 need_72_ok
    s_waitcnt lgkmcnt(0)
need_72_t:
    s_cmp_ge_u32 s48, 2
    s_cselect_b32 s63, s65, s64
    s_cmp_lg_u32 s63, s10
    s_cbranch_scc1 need_72
need_72_ok:
    s_waitcnt lgkmcnt(0)
    s_add_u32 m0, s51, 32768
    s_nop 0
    buffer_load_dwordx4 v5, s[12:15], s50 offen offset:0 sc1 lds
    buffer_load_dwordx4 v5, s[12:15], s50 offen offset:1024 sc1 lds
    s_add_u32 s50, s50, 8192
    s_add_u32 m0, s51, 40960
    s_nop 0
    buffer_load_dwordx4 v5, s[12:15], s50 offen offset:0 sc1 lds
    buffer_load_dwordx4 v5, s[12:15], s50 offen offset:1024 sc1 lds
    s_add_u32 s50, s50, 8192
    s_branch need_73_t
need_73:
    s_load_dwordx4 s[64:67], s[52:53], s62 glc
    s_sub_u32 s58, s58, 1
    s_cbranch_scc1 need_73_ok
    s_waitcnt lgkmcnt(0)
need_73_t:
    s_cmp_ge_u32 s48, 2
    s_cselect_b32 s63, s67, s66
    s_cmp_lg_u32 s63, s10
    s_cbranch_scc1 need_73
need_73_ok:
    s_waitcnt lgkmcnt(0)
    s_add_u32 m0, s51, 49152
    s_nop 0
    buffer_load_dwordx4 v5, s[12:15], s50 offen offset:0 sc1 lds
    buffer_load_dwordx4 v5, s[12:15], s50 offen offset:1024 sc1 lds
    s_add_u32 s50, s50, 8192
    s_add_u32 m0, s51, 57344
    s_nop 0
    buffer_load_dwordx4 v5, s[12:15], s50 offen offset:0 sc1 lds
    buffer_load_dwordx4 v5, s[12:15], s50 offen offset:1024 sc1 lds
    s_add_u32 s50, s50, 8192
    s_waitcnt vmcnt(4)
    s_barrier
    s_add_u32 s62, s61, 2
    s_and_b32 s62, s62, 7
    s_lshl_b32 s50, s62, 15
    s_add_u32 s50, s50, s49
    s_lshr_b32 s63, s62, 1
    s_lshl_b32 s63, s63, 7
    s_and_b32 s62, s62, 1
    s_lshl_b32 s62, s62, 4
    s_add_u32 s62, s62, s63
    s_mov_b32 s58, 0x100000
need_74:
    s_load_dwordx4 s[64:67], s[52:53], s62 glc
    s_sub_u32 s58, s58, 1
    s_cbranch_scc1 need_74_ok
    s_waitcnt lgkmcnt(0)
need_74_t:
    s_cmp_ge_u32 s48, 2
    s_cselect_b32 s63, s65, s64
    s_cmp_lg_u32 s63, s10
    s_cbranch_scc1 need_74
need_74_ok:
    s_waitcnt lgkmcnt(0)
    s_add_u32 m0, s51, 0
    s_nop 0
    buffer_load_dwordx4 v5, s[12:15], s50 offen offset:0 sc1 lds
    buffer_load_dwordx4 v5, s[12:15], s50 offen offset:1024 sc1 lds
    s_add_u32 s50, s50, 8192
    s_add_u32 m0, s51, 8192
    s_nop 0
    buffer_load_dwordx4 v5, s[12:15], s50 offen offset:0 sc1 lds
    buffer_load_dwordx4 v5, s[12:15], s50 offen offset:1024 sc1 lds
    s_add_u32 s50, s50, 8192
    s_waitcnt vmcnt(4)
    s_barrier
    s_branch need_75_t
need_75:
    s_load_dwordx4 s[64:67], s[52:53], s62 glc
    s_sub_u32 s58, s58, 1
    s_cbranch_scc1 need_75_ok
    s_waitcnt lgkmcnt(0)
need_75_t:
    s_cmp_ge_u32 s48, 2
    s_cselect_b32 s63, s67, s66
    s_cmp_lg_u32 s63, s10
    s_cbranch_scc1 need_75
need_75_ok:
    s_waitcnt lgkmcnt(0)
    s_add_u32 m0, s51, 16384
    s_nop 0
    buffer_load_dwordx4 v5, s[12:15], s50 offen offset:0 sc1 lds
    buffer_load_dwordx4 v5, s[12:15], s50 offen offset:1024 sc1 lds
    s_add_u32 s50, s50, 8192
    s_add_u32 m0, s51, 24576
    s_nop 0
    buffer_load_dwordx4 v5, s[12:15], s50 offen offset:0 sc1 lds
    buffer_load_dwordx4 v5, s[12:15], s50 offen offset:1024 sc1 lds
    s_add_u32 s50, s50, 8192
    s_waitcnt vmcnt(4)
    s_barrier
    s_add_u32 s62, s61, 3
    s_and_b32 s62, s62, 7
    s_lshl_b32 s50, s62, 15
    s_add_u32 s50, s50, s49
    s_lshr_b32 s63, s62, 1
    s_lshl_b32 s63, s63, 7
    s_and_b32 s62, s62, 1
    s_lshl_b32 s62, s62, 4
    s_add_u32 s62, s62, s63
    s_mov_b32 s58, 0x100000
need_76:
    s_load_dwordx4 s[64:67], s[52:53], s62 glc
    s_sub_u32 s58, s58, 1
    s_cbranch_scc1 need_76_ok
    s_waitcnt lgkmcnt(0)
need_76_t:
    s_cmp_ge_u32 s48, 2
    s_cselect_b32 s63, s65, s64
    s_cmp_lg_u32 s63, s10
    s_cbranch_scc1 need_76
need_76_ok:
    s_waitcnt lgkmcnt(0)
    s_add_u32 m0, s51, 32768
    s_nop 0
    buffer_load_dwordx4 v5, s[12:15], s50 offen offset:0 sc1 lds
    buffer_load_dwordx4 v5, s[12:15], s50 offen offset:1024 sc1 lds
    s_add_u32 s50, s50, 8192
    s_add_u32 m0, s51, 40960
    s_nop 0
    buffer_load_dwordx4 v5, s[12:15], s50 offen offset:0 sc1 lds
    buffer_load_dwordx4 v5, s[12:15], s50 offen offset:1024 sc1 lds
    s_add_u32 s50, s50, 8192
    s_lshl_b32 m0, s60, 10
    s_lshl_b32 s3, s60, 14
    buffer_load_dwordx4 v7, s[24:27], s3 offen lds
    s_add_u32 s60, s60, 4
    s_lshl_b32 m0, s60, 10
    s_lshl_b32 s3, s60, 14
    buffer_load_dwordx4 v7, s[24:27], s3 offen lds
    s_add_u32 s60, s60, 4
    s_waitcnt vmcnt(6)
    s_barrier
    s_branch need_77_t
need_77:
    s_load_dwordx4 s[64:67], s[52:53], s62 glc
    s_sub_u32 s58, s58, 1
    s_cbranch_scc1 need_77_ok
    s_waitcnt lgkmcnt(0)
need_77_t:
    s_cmp_ge_u32 s48, 2
    s_cselect_b32 s63, s67, s66
    s_cmp_lg_u32 s63, s10
    s_cbranch_scc1 need_77
need_77_ok:
    s_waitcnt lgkmcnt(0)
    s_add_u32 m0, s51, 49152
    s_nop 0
    buffer_load_dwordx4 v5, s[12:15], s50 offen offset:0 sc1 lds
    buffer_load_dwordx4 v5, s[12:15], s50 offen offset:1024 sc1 lds
    s_add_u32 s50, s50, 8192
    s_add_u32 m0, s51, 57344
    s_nop 0
    buffer_load_dwordx4 v5, s[12:15], s50 offen offset:0 sc1 lds
    buffer_load_dwordx4 v5, s[12:15], s50 offen offset:1024 sc1 lds
    s_add_u32 s50, s50, 8192
    s_lshl_b32 m0, s60, 10
    s_lshl_b32 s3, s60, 14
    buffer_load_dwordx4 v7, s[24:27], s3 offen lds
    s_add_u32 s60, s60, 4
    s_lshl_b32 m0, s60, 10
    s_lshl_b32 s3, s60, 14
    buffer_load_dwordx4 v7, s[24:27], s3 offen lds
    s_add_u32 s60, s60, 4
    s_waitcnt vmcnt(8)
    s_barrier
    s_add_u32 s62, s61, 4
    s_and_b32 s62, s62, 7
    s_lshl_b32 s50, s62, 15
    s_add_u32 s50, s50, s49
    s_lshr_b32 s63, s62, 1
    s_lshl_b32 s63, s63, 7
    s_and_b32 s62, s62, 1
    s_lshl_b32 s62, s62, 4
    s_add_u32 s62, s62, s63
    s_mov_b32 s58, 0x100000
need_78:
    s_load_dwordx4 s[64:67], s[52:53], s62 glc
    s_sub_u32 s58, s58, 1
    s_cbranch_scc1 need_78_ok
    s_waitcnt lgkmcnt(0)
need_78_t:
    s_cmp_ge_u32 s48, 2
    s_cselect_b32 s63, s65, s64
    s_cmp_lg_u32 s63, s10
    s_cbranch_scc1 need_78
need_78_ok:
    s_waitcnt lgkmcnt(0)
    s_add_u32 m0, s51, 0
    s_nop 0
    buffer_load_dwordx4 v5, s[12:15], s50 offen offset:0 sc1 lds
    buffer_load_dwordx4 v5, s[12:15], s50 offen offset:1024 sc1 lds
    s_add_u32 s50, s50, 8192
    s_add_u32 m0, s51, 8192
    s_nop 0
    buffer_load_dwordx4 v5, s[12:15], s50 offen offset:0 sc1 lds
    buffer_load_dwordx4 v5, s[12:15], s50 offen offset:1024 sc1 lds
    s_add_u32 s50, s50, 8192
    s_lshl_b32 m0, s60, 10
    s_lshl_b32 s3, s60, 14
    buffer_load_dwordx4 v7, s[24:27], s3 offen lds
    s_add_u32 s60, s60, 4
    s_lshl_b32 m0, s60, 10
    s_lshl_b32 s3, s60, 14
    buffer_load_dwordx4 v7, s[24:27], s3 offen lds
    s_add_u32 s60, s60, 4
    s_waitcnt vmcnt(8)
    s_barrier
    s_branch need_79_t
need_79:
    s_load_dwordx4 s[64:67], s[52:53], s62 glc
    s_sub_u32 s58, s58, 1
    s_cbranch_scc1 need_79_ok
    s_waitcnt lgkmcnt(0)
need_79_t:
    s_cmp_ge_u32 s48, 2
    s_cselect_b32 s63, s67, s66
    s_cmp_lg_u32 s63, s10
    s_cbranch_scc1 need_79
need_79_ok:
    s_waitcnt lgkmcnt(0)
    s_add_u32 m0, s51, 16384
    s_nop 0
    buffer_load_dwordx4 v5, s[12:15], s50 offen offset:0 sc1 lds
    buffer_load_dwordx4 v5, s[12:15], s50 offen offset:1024 sc1 lds
    s_add_u32 s50, s50, 8192
    s_add_u32 m0, s51, 24576
    s_nop 0
    buffer_load_dwordx4 v5, s[12:15], s50 offen offset:0 sc1 lds
    buffer_load_dwordx4 v5, s[12:15], s50 offen offset:1024 sc1 lds
    s_add_u32 s50, s50, 8192
    s_lshl_b32 m0, s60, 10
    s_lshl_b32 s3, s60, 14
    buffer_load_dwordx4 v7, s[24:27], s3 offen lds
    s_add_u32 s60, s60, 4
    s_lshl_b32 m0, s60, 10
    s_lshl_b32 s3, s60, 14
    buffer_load_dwordx4 v7, s[24:27], s3 offen lds
    s_add_u32 s60, s60, 4
    s_waitcnt vmcnt(8)
    s_barrier
    s_add_u32 s62, s61, 5
    s_and_b32 s62, s62, 7
    s_lshl_b32 s50, s62, 15
    s_add_u32 s50, s50, s49
    s_lshr_b32 s63, s62, 1
    s_lshl_b32 s63, s63, 7
    s_and_b32 s62, s62, 1
    s_lshl_b32 s62, s62, 4
    s_add_u32 s62, s62, s63
    s_mov_b32 s58, 0x100000
need_80:
    s_load_dwordx4 s[64:67], s[52:53], s62 glc
    s_sub_u32 s58, s58, 1
    s_cbranch_scc1 need_80_ok
    s_waitcnt lgkmcnt(0)
need_80_t:
    s_cmp_ge_u32 s48, 2
    s_cselect_b32 s63, s65, s64
    s_cmp_lg_u32 s63, s10
    s_cbranch_scc1 need_80
need_80_ok:
    s_waitcnt lgkmcnt(0)
    s_add_u32 m0, s51, 32768
    s_nop 0
    buffer_load_dwordx4 v5, s[12:15], s50 offen offset:0 sc1 lds
    buffer_load_dwordx4 v5, s[12:15], s50 offen offset:1024 sc1 lds
    s_add_u32 s50, s50, 8192
    s_add_u32 m0, s51, 40960
    s_nop 0
    buffer_load_dwordx4 v5, s[12:15], s50 offen offset:0 sc1 lds
    buffer_load_dwordx4 v5, s[12:15], s50 offen offset:1024 sc1 lds
    s_add_u32 s50, s50, 8192
    s_lshl_b32 m0, s60, 10
    s_lshl_b32 s3, s60, 14
    buffer_load_dwordx4 v7, s[24:27], s3 offen lds
    s_add_u32 s60, s60, 4
    s_lshl_b32 m0, s60, 10
    s_lshl_b32 s3, s60, 14
    buffer_load_dwordx4 v7, s[24:27], s3 offen lds
    s_add_u32 s60, s60, 4
    s_waitcnt vmcnt(8)
    s_barrier
    s_branch need_81_t
need_81:
    s_load_dwordx4 s[64:67], s[52:53], s62 glc
    s_sub_u32 s58, s58, 1
    s_cbranch_scc1 need_81_ok
    s_waitcnt lgkmcnt(0)
need_81_t:
    s_cmp_ge_u32 s48, 2
    s_cselect_b32 s63, s67, s66
    s_cmp_lg_u32 s63, s10
    s_cbranch_scc1 need_81
need_81_ok:
    s_waitcnt lgkmcnt(0)
    s_add_u32 m0, s51, 49152
    s_nop 0
    buffer_load_dwordx4 v5, s[12:15], s50 offen offset:0 sc1 lds
    buffer_load_dwordx4 v5, s[12:15], s50 offen offset:1024 sc1 lds
    s_add_u32 s50, s50, 8192
    s_add_u32 m0, s51, 57344
    s_nop 0
    buffer_load_dwordx4 v5, s[12:15], s50 offen offset:0 sc1 lds
    buffer_load_dwordx4 v5, s[12:15], s50 offen offset:1024 sc1 lds
    s_add_u32 s50, s50, 8192
    s_lshl_b32 m0, s60, 10
    s_lshl_b32 s3, s60, 14
    buffer_load_dwordx4 v7, s[24:27], s3 offen lds
    s_add_u32 s60, s60, 4
    s_lshl_b32 m0, s60, 10
    s_lshl_b32 s3, s60, 14
    buffer_load_dwordx4 v7, s[24:27], s3 offen lds
    s_add_u32 s60, s60, 4
    s_waitcnt vmcnt(8)
    s_barrier
    s_add_u32 s62, s61, 6
    s_and_b32 s62, s62, 7
    s_lshl_b32 s50, s62, 15
    s_add_u32 s50, s50, s49
    s_lshr_b32 s63, s62, 1
    s_lshl_b32 s63, s63, 7
    s_and_b32 s62, s62, 1
    s_lshl_b32 s62, s62, 4
    s_add_u32 s62, s62, s63
    s_mov_b32 s58, 0x100000
need_82:
    s_load_dwordx4 s[64:67], s[52:53], s62 glc
    s_sub_u32 s58, s58, 1
    s_cbranch_scc1 need_82_ok
    s_waitcnt lgkmcnt(0)
need_82_t:
    s_cmp_ge_u32 s48, 2
    s_cselect_b32 s63, s65, s64
    s_cmp_lg_u32 s63, s10
    s_cbranch_scc1 need_82
need_82_ok:
    s_waitcnt lgkmcnt(0)
    s_add_u32 m0, s51, 0
    s_nop 0
    buffer_load_dwordx4 v5, s[12:15], s50 offen offset:0 sc1 lds
    buffer_load_dwordx4 v5, s[12:15], s50 offen offset:1024 sc1 lds
    s_add_u32 s50, s50, 8192
    s_add_u32 m0, s51, 8192
    s_nop 0
    buffer_load_dwordx4 v5, s[12:15], s50 offen offset:0 sc1 lds
    buffer_load_dwordx4 v5, s[12:15], s50 offen offset:1024 sc1 lds
    s_add_u32 s50, s50, 8192
    s_lshl_b32 m0, s60, 10
    s_lshl_b32 s3, s60, 14
    buffer_load_dwordx4 v7, s[24:27], s3 offen lds
    s_add_u32 s60, s60, 4
    s_lshl_b32 m0, s60, 10
    s_lshl_b32 s3, s60, 14
    buffer_load_dwordx4 v7, s[24:27], s3 offen lds
    s_add_u32 s60, s60, 4
    s_waitcnt vmcnt(8)
    s_barrier
    s_branch need_83_t
need_83:
    s_load_dwordx4 s[64:67], s[52:53], s62 glc
    s_sub_u32 s58, s58, 1
    s_cbranch_scc1 need_83_ok
    s_waitcnt lgkmcnt(0)
need_83_t:
    s_cmp_ge_u32 s48, 2
    s_cselect_b32 s63, s67, s66
    s_cmp_lg_u32 s63, s10
    s_cbranch_scc1 need_83
need_83_ok:
    s_waitcnt lgkmcnt(0)
    s_add_u32 m0, s51, 16384
    s_nop 0
    buffer_load_dwordx4 v5, s[12:15], s50 offen offset:0 sc1 lds
    buffer_load_dwordx4 v5, s[12:15], s50 offen offset:1024 sc1 lds
    s_add_u32 s50, s50, 8192
    s_add_u32 m0, s51, 24576
    s_nop 0
    buffer_load_dwordx4 v5, s[12:15], s50 offen offset:0 sc1 lds
    buffer_load_dwordx4 v5, s[12:15], s50 offen offset:1024 sc1 lds
    s_add_u32 s50, s50, 8192
    s_lshl_b32 m0, s60, 10
    s_lshl_b32 s3, s60, 14
    buffer_load_dwordx4 v7, s[24:27], s3 offen lds
    s_add_u32 s60, s60, 4
    s_lshl_b32 m0, s60, 10
    s_lshl_b32 s3, s60, 14
    buffer_load_dwordx4 v7, s[24:27], s3 offen lds
    s_add_u32 s60, s60, 4
    s_waitcnt vmcnt(8)
    s_barrier
    s_add_u32 s62, s61, 7
    s_and_b32 s62, s62, 7
    s_lshl_b32 s50, s62, 15
    s_add_u32 s50, s50, s49
    s_lshr_b32 s63, s62, 1
    s_lshl_b32 s63, s63, 7
    s_and_b32 s62, s62, 1
    s_lshl_b32 s62, s62, 4
    s_add_u32 s62, s62, s63
    s_mov_b32 s58, 0x100000
need_84:
    s_load_dwordx4 s[64:67], s[52:53], s62 glc
    s_sub_u32 s58, s58, 1
    s_cbranch_scc1 need_84_ok
    s_waitcnt lgkmcnt(0)
need_84_t:
    s_cmp_ge_u32 s48, 2
    s_cselect_b32 s63, s65, s64
    s_cmp_lg_u32 s63, s10
    s_cbranch_scc1 need_84
need_84_ok:
    s_waitcnt lgkmcnt(0)
    s_add_u32 m0, s51, 32768
    s_nop 0
    buffer_load_dwordx4 v5, s[12:15], s50 offen offset:0 sc1 lds
    buffer_load_dwordx4 v5, s[12:15], s50 offen offset:1024 sc1 lds
    s_add_u32 s50, s50, 8192
    s_add_u32 m0, s51, 40960
    s_nop 0
    buffer_load_dwordx4 v5, s[12:15], s50 offen offset:0 sc1 lds
    buffer_load_dwordx4 v5, s[12:15], s50 offen offset:1024 sc1 lds
    s_add_u32 s50, s50, 8192
    s_lshl_b32 m0, s60, 10
    s_lshl_b32 s3, s60, 14
    buffer_load_dwordx4 v7, s[24:27], s3 offen lds
    s_add_u32 s60, s60, 4
    s_lshl_b32 m0, s60, 10
    s_lshl_b32 s3, s60, 14
    buffer_load_dwordx4 v7, s[24:27], s3 offen lds
    s_add_u32 s60, s60, 4
    s_waitcnt vmcnt(8)
    s_barrier
    s_branch need_85_t
need_85:
    s_load_dwordx4 s[64:67], s[52:53], s62 glc
    s_sub_u32 s58, s58, 1
    s_cbranch_scc1 need_85_ok
    s_waitcnt lgkmcnt(0)
need_85_t:
    s_cmp_ge_u32 s48, 2
    s_cselect_b32 s63, s67, s66
    s_cmp_lg_u32 s63, s10
    s_cbranch_scc1 need_85
need_85_ok:
    s_waitcnt lgkmcnt(0)
    s_add_u32 m0, s51, 49152
    s_nop 0
    buffer_load_dwordx4 v5, s[12:15], s50 offen offset:0 sc1 lds
    buffer_load_dwordx4 v5, s[12:15], s50 offen offset:1024 sc1 lds
    s_add_u32 s50, s50, 8192
    s_add_u32 m0, s51, 57344
    s_nop 0
    buffer_load_dwordx4 v5, s[12:15], s50 offen offset:0 sc1 lds
    buffer_load_dwordx4 v5, s[12:15], s50 offen offset:1024 sc1 lds
    s_add_u32 s50, s50, 8192
    s_lshl_b32 m0, s60, 10
    s_lshl_b32 s3, s60, 14
    buffer_load_dwordx4 v7, s[24:27], s3 offen lds
    s_add_u32 s60, s60, 4
    s_lshl_b32 m0, s60, 10
    s_lshl_b32 s3, s60, 14
    buffer_load_dwordx4 v7, s[24:27], s3 offen lds
    s_add_u32 s60, s60, 4
    s_waitcnt vmcnt(8)
    s_barrier
    s_lshl_b32 m0, s60, 10
    s_lshl_b32 s3, s60, 14
    buffer_load_dwordx4 v7, s[24:27], s3 offen lds
    s_add_u32 s60, s60, 4
    s_lshl_b32 m0, s60, 10
    s_lshl_b32 s3, s60, 14
    buffer_load_dwordx4 v7, s[24:27], s3 offen lds
    s_add_u32 s60, s60, 4
    s_lshl_b32 m0, s60, 10
    s_lshl_b32 s3, s60, 14
    buffer_load_dwordx4 v7, s[24:27], s3 offen lds
    s_add_u32 s60, s60, 4
    s_lshl_b32 m0, s60, 10
    s_lshl_b32 s3, s60, 14
    buffer_load_dwordx4 v7, s[24:27], s3 offen lds
    s_add_u32 s60, s60, 4
    s_waitcnt vmcnt(6)
    s_barrier
    s_lshl_b32 m0, s60, 10
    s_lshl_b32 s3, s60, 14
    buffer_load_dwordx4 v7, s[24:27], s3 offen lds
    s_add_u32 s60, s60, 4
    s_lshl_b32 m0, s60, 10
    s_lshl_b32 s3, s60, 14
    buffer_load_dwordx4 v7, s[24:27], s3 offen lds
    s_add_u32 s60, s60, 4
    s_lshl_b32 m0, s60, 10
    s_lshl_b32 s3, s60, 14
    buffer_load_dwordx4 v7, s[24:27], s3 offen lds
    s_add_u32 s60, s60, 4
    s_lshl_b32 m0, s60, 10
    s_lshl_b32 s3, s60, 14
    buffer_load_dwordx4 v7, s[24:27], s3 offen lds
    s_add_u32 s60, s60, 4
    s_barrier
    s_lshl_b32 m0, s60, 10
    s_lshl_b32 s3, s60, 14
    buffer_load_dwordx4 v7, s[24:27], s3 offen lds
    s_add_u32 s60, s60, 4
    s_lshl_b32 m0, s60, 10
    s_lshl_b32 s3, s60, 14
    buffer_load_dwordx4 v7, s[24:27], s3 offen lds
    s_add_u32 s60, s60, 4
    s_lshl_b32 m0, s60, 10
    s_lshl_b32 s3, s60, 14
    buffer_load_dwordx4 v7, s[24:27], s3 offen lds
    s_add_u32 s60, s60, 4
    s_lshl_b32 m0, s60, 10
    s_lshl_b32 s3, s60, 14
    buffer_load_dwordx4 v7, s[24:27], s3 offen lds
    s_add_u32 s60, s60, 4
    s_cmp_eq_u32 s8, 4
    s_cbranch_scc1 h_wo
    s_branch l_wo
.p2align 6
c_attn_slow:
    s_waitcnt lgkmcnt(0)
    s_lshr_b32 s56, s9, 1
    s_lshl_b32 s56, s56, 23
    s_lshl_b32 s55, s7, 19
    s_add_u32 s56, s56, s55
    s_and_b32 s55, s6, 1
    s_lshl_b32 s55, s55, 18
    s_add_u32 s56, s56, s55
    s_add_u32 s56, s56, 33554432
    v_mov_b32 v28, 0xff800000
    v_mov_b32 v30, 0xff800000
    s_mov_b32 s57, 0
c_attn_slow1:
    s_lshr_b32 s55, s57, 2
    s_lshl_b32 s55, s55, 14
    s_and_b32 s58, s57, 3
    s_lshl_b32 s58, s58, 11
    s_add_u32 s55, s55, s58
    s_add_u32 s55, s55, s56
    buffer_load_dwordx4 v[128:131], v5, s[12:15], s55 offen offset:0 sc1
    buffer_load_dwordx4 v[132:135], v5, s[12:15], s55 offen offset:1024 sc1
    s_waitcnt vmcnt(0)
    v_mfma_f32_32x32x16_bf16 v[64:79], v[128:131], v[8:11], 0
    v_mfma_f32_32x32x16_bf16 v[80:95], v[128:131], v[16:19], 0
    v_mfma_f32_32x32x16_bf16 v[64:79], v[132:135], v[12:15], v[64:79]
    v_mfma_f32_32x32x16_bf16 v[80:95], v[132:135], v[20:23], v[80:95]
    s_nop 10
    v_max3_f32 v28, v28, v64, v65
    v_max3_f32 v28, v28, v66, v67
    v_max3_f32 v28, v28, v68, v69
    v_max3_f32 v28, v28, v70, v71
    v_max3_f32 v28, v28, v72, v73
    v_max3_f32 v28, v28, v74, v75
    v_max3_f32 v28, v28, v76, v77
    v_max3_f32 v28, v28, v78, v79
    v_max3_f32 v30, v30, v80, v81
    v_max3_f32 v30, v30, v82, v83
    v_max3_f32 v30, v30, v84, v85
    v_max3_f32 v30, v30, v86, v87
    v_max3_f32 v30, v30, v88, v89
    v_max3_f32 v30, v30, v90, v91
    v_max3_f32 v30, v30, v92, v93
    v_max3_f32 v30, v30, v94, v95
    s_add_u32 s57, s57, 1
    s_cmp_lt_u32 s57, 64
    s_cbranch_scc1 c_attn_slow1
    v_mov_b32 v29, v28
    s_nop 1
    v_permlane32_swap_b32 v28, v29
    v_max_f32 v28, v28, v29
    v_sub_f32 v96, 0, v28
    v_sub_f32 v97, 0, v28
    v_sub_f32 v98, 0, v28
    v_sub_f32 v99, 0, v28
    v_sub_f32 v100, 0, v28
    v_sub_f32 v101, 0, v28
    v_sub_f32 v102, 0, v28
    v_sub_f32 v103, 0, v28
    v_sub_f32 v104, 0, v28
    v_sub_f32 v105, 0, v28
    v_sub_f32 v106, 0, v28
    v_sub_f32 v107, 0, v28
    v_sub_f32 v108, 0, v28
    v_sub_f32 v109, 0, v28
    v_sub_f32 v110, 0, v28
    v_sub_f32 v111, 0, v28
    v_mov_b32 v160, 0
    v_mov_b32 v161, 0
    v_mov_b32 v162, 0
    v_mov_b32 v163, 0
    v_mov_b32 v164, 0
    v_mov_b32 v165, 0
    v_mov_b32 v166, 0
    v_mov_b32 v167, 0
    v_mov_b32 v168, 0
    v_mov_b32 v169, 0
    v_mov_b32 v170, 0
    v_mov_b32 v171, 0
    v_mov_b32 v172, 0
    v_mov_b32 v173, 0
    v_mov_b32 v174, 0
    v_mov_b32 v175, 0
    v_mov_b32 v192, 0
    v_mov_b32 v193, 0
    v_mov_b32 v194, 0
    v_mov_b32 v195, 0
    v_mov_b32 v31, v30
    s_nop 1
    v_permlane32_swap_b32 v30, v31
    v_max_f32 v30, v30, v31
    v_sub_f32 v112, 0, v30
    v_sub_f32 v113, 0, v30
    v_sub_f32 v114, 0, v30
    v_sub_f32 v115, 0, v30
    v_sub_f32 v116, 0, v30
    v_sub_f32 v117, 0, v30
    v_sub_f32 v118, 0, v30
    v_sub_f32 v119, 0, v30
    v_sub_f32 v120, 0, v30
    v_sub_f32 v121, 0, v30
    v_sub_f32 v122, 0, v30
    v_sub_f32 v123, 0, v30
    v_sub_f32 v124, 0, v30
    v_sub_f32 v125, 0, v30
    v_sub_f32 v126, 0, v30
    v_sub_f32 v127, 0, v30
    v_mov_b32 v176, 0
    v_mov_b32 v177, 0
    v_mov_b32 v178, 0
    v_mov_b32 v179, 0
    v_mov_b32 v180, 0
    v_mov_b32 v181, 0
    v_mov_b32 v182, 0
    v_mov_b32 v183, 0
    v_mov_b32 v184, 0
    v_mov_b32 v185, 0
    v_mov_b32 v186, 0
    v_mov_b32 v187, 0
    v_mov_b32 v188, 0
    v_mov_b32 v189, 0
    v_mov_b32 v190, 0
    v_mov_b32 v191, 0
    v_mov_b32 v196, 0
    v_mov_b32 v197, 0
    v_mov_b32 v198, 0
    v_mov_b32 v199, 0
    s_mov_b32 s57, 0
c_attn_slow2:
    s_lshr_b32 s55, s57, 2
    s_lshl_b32 s55, s55, 14
    s_and_b32 s58, s57, 3
    s_lshl_b32 s58, s58, 11
    s_add_u32 s55, s55, s58
    s_add_u32 s55, s55, s56
    buffer_load_dwordx4 v[128:131], v5, s[12:15], s55 offen offset:0 sc1
    buffer_load_dwordx4 v[132:135], v5, s[12:15], s55 offen offset:1024 sc1
    s_add_u32 s55, s55, 8192
    buffer_load_dwordx4 v[144:147], v5, s[12:15], s55 offen offset:0 sc1
    buffer_load_dwordx4 v[148:151], v5, s[12:15], s55 offen offset:1024 sc1
    s_waitcnt vmcnt(0)
    v_mfma_f32_32x32x16_bf16 v[64:79], v[128:131], v[8:11], v[96:111]
    v_mfma_f32_32x32x16_bf16 v[80:95], v[128:131], v[16:19], v[112:127]
    v_mfma_f32_32x32x16_bf16 v[64:79], v[132:135], v[12:15], v[64:79]
    v_mfma_f32_32x32x16_bf16 v[80:95], v[132:135], v[20:23], v[80:95]
    s_nop 10
    v_exp_f32 v64, v64
    v_exp_f32 v65, v65
    v_exp_f32 v66, v66
    v_exp_f32 v67, v67
    v_exp_f32 v68, v68
    v_exp_f32 v69, v69
    v_exp_f32 v70, v70
    v_exp_f32 v71, v71
    v_exp_f32 v72, v72
    v_exp_f32 v73, v73
    v_exp_f32 v74, v74
    v_exp_f32 v75, v75
    v_exp_f32 v76, v76
    v_exp_f32 v77, v77
    v_exp_f32 v78, v78
    v_exp_f32 v79, v79
    v_exp_f32 v80, v80
    v_exp_f32 v81, v81
    v_exp_f32 v82, v82
    v_exp_f32 v83, v83
    v_exp_f32 v84, v84
    v_exp_f32 v85, v85
    v_exp_f32 v86, v86
    v_exp_f32 v87, v87
    v_exp_f32 v88, v88
    v_exp_f32 v89, v89
    v_exp_f32 v90, v90
    v_exp_f32 v91, v91
    v_exp_f32 v92, v92
    v_exp_f32 v93, v93
    v_exp_f32 v94, v94
    v_exp_f32 v95, v95
    v_smfmac_f32_32x32x32_bf16 v[160:175], v[144:147], v[64:71], v204
    v_smfmac_f32_16x16x64_bf16 v[192:195], v[200:203], v[64:71], v204
    v_smfmac_f32_32x32x32_bf16 v[160:175], v[148:151], v[72:79], v204
    v_smfmac_f32_16x16x64_bf16 v[192:195], v[200:203], v[72:79], v204
    v_smfmac_f32_32x32x32_bf16 v[176:191], v[144:147], v[80:87], v204
    v_smfmac_f32_16x16x64_bf16 v[196:199], v[200:203], v[80:87], v204
    v_smfmac_f32_32x32x32_bf16 v[176:191], v[148:151], v[88:95], v204
    v_smfmac_f32_16x16x64_bf16 v[196:199], v[200:203], v[88:95], v204
    s_add_u32 s57, s57, 1
    s_cmp_lt_u32 s57, 64
    s_nop 15
    s_cbranch_scc1 c_attn_slow2
    s_branch c_attn_fin
    s_endpgm
k_end:
.section .rodata,"a"
.p2align 6
.amdhsa_kernel interleave_layers__sliding_local_dilated__softmax_full_mha__prompt_kernel
  .amdhsa_next_free_vgpr 256
  .amdhsa_next_free_sgpr 102
  .amdhsa_accum_offset 224
  .amdhsa_group_segment_fixed_size 0
  .amdhsa_kernarg_size 72
  .amdhsa_user_sgpr_count 2
  .amdhsa_user_sgpr_kernarg_segment_ptr 1
  .amdhsa_system_sgpr_workgroup_id_x 1
.end_amdhsa_kernel
```

```asm
; @launch grid=(256,1,1) block=(512,1,1) lds=159744
.amdgcn_target "amdgcn-amd-amdhsa--gfx950"
.text
.globl interleave_layers__sliding_local_dilated__softmax_full_mha__prompt_kernel
.type interleave_layers__sliding_local_dilated__softmax_full_mha__prompt_kernel,@function
.p2align 8
interleave_layers__sliding_local_dilated__softmax_full_mha__prompt_kernel:
    s_cmp_ge_u32 s2, 256
    s_cbranch_scc1 k_exit2
    s_load_dwordx16 s[32:47], s[0:1], 0
    s_load_dwordx2 s[4:5], s[0:1], 64
    v_lshrrev_b32 v2, 6, v0
    v_and_b32 v1, 63, v0
    v_mov_b32 v12, 0
    v_mov_b32 v14, 0
    v_mov_b32 v15, 0
    v_mov_b32 v16, 0
    v_readfirstlane_b32 s8, v2
    s_and_b32 s3, s2, 1
    s_lshl_b32 s3, s3, 3
    s_bfe_u32 s6, s2, 0x30003
    s_add_u32 s6, s3, s6
    s_bfe_u32 s3, s2, 0x20001
    s_lshl_b32 s3, s3, 2
    s_lshr_b32 s7, s2, 6
    s_add_u32 s7, s3, s7
    s_lshl_b32 s11, s6, 4
    s_add_u32 s11, s11, s7
    s_mov_b32 s9, -1
    s_mov_b32 s96, 0
    s_mov_b32 s10, 0
    s_cmp_lt_u32 s8, 4
    s_cbranch_scc1 c_prep
    s_cmp_eq_u32 s8, 4
    s_cbranch_scc1 h_first
k_heads:
l_first:
    s_sub_u32 s51, s8, 5
    s_mul_i32 s61, s51, 0
    s_add_u32 s61, s61, s2
    s_and_b32 s61, s61, 255
    s_lshl_b32 s3, s51, 8
    s_add_u32 s61, s61, s3
    s_and_b32 s62, s61, 15
    s_lshr_b32 s63, s61, 4
    v_lshrrev_b32 v20, 3, v1
    v_mul_u32_u24 v12, 6144, v20
    v_and_b32 v21, 7, v1
    v_lshl_add_u32 v12, v21, 4, v12
    s_mul_i32 s52, s62, 393216
    s_lshl_b32 s56, s63, 7
    s_add_u32 s52, s52, s56
    s_waitcnt lgkmcnt(0)
    s_mov_b32 s12, s4
    s_mov_b32 s13, s5
    s_mov_b32 s14, 71303168
    s_mov_b32 s15, 0x00020000
    s_mov_b32 s20, s34
    s_mov_b32 s21, s35
    s_mov_b32 s22, 6291456
    s_mov_b32 s23, 0x00020000
    s_add_u32 s53, s52, 0
    buffer_load_dwordx4 v[160:163], v12, s[20:23], s53 offen nt
    s_add_u32 s53, s52, 49152
    buffer_load_dwordx4 v[164:167], v12, s[20:23], s53 offen nt
    s_add_u32 s53, s52, 98304
    buffer_load_dwordx4 v[168:171], v12, s[20:23], s53 offen nt
    s_add_u32 s53, s52, 147456
    buffer_load_dwordx4 v[172:175], v12, s[20:23], s53 offen nt
    s_add_u32 s53, s52, 196608
    buffer_load_dwordx4 v[176:179], v12, s[20:23], s53 offen nt
    s_add_u32 s53, s52, 245760
    buffer_load_dwordx4 v[180:183], v12, s[20:23], s53 offen nt
    s_add_u32 s53, s52, 294912
    buffer_load_dwordx4 v[184:187], v12, s[20:23], s53 offen nt
    s_add_u32 s53, s52, 344064
    buffer_load_dwordx4 v[188:191], v12, s[20:23], s53 offen nt
    s_barrier
    s_branch l_first_tail
c_prep:
    s_lshl_b32 s48, s6, 2
    s_add_u32 s48, s48, s8
    v_lshrrev_b32 v16, 3, v1
    v_and_b32 v17, 7, v1
    v_lshlrev_b32 v18, 11, v16
    v_lshl_add_u32 v18, v17, 4, v18
    s_lshl_b32 s55, s48, 16
    s_lshl_b32 s56, s7, 7
    s_add_u32 s3, s55, s56
    s_waitcnt lgkmcnt(0)
    s_mov_b32 s12, s4
    s_mov_b32 s13, s5
    s_mov_b32 s14, 71303168
    s_mov_b32 s15, 0x00020000
    s_mov_b32 s28, s32
    s_mov_b32 s29, s33
    s_mov_b32 s30, 4194304
    s_mov_b32 s31, 0x00020000
    buffer_load_dwordx4 v[32:35], v18, s[28:31], s3 offen nt
    s_add_u32 s3, s3, 16384
    buffer_load_dwordx4 v[36:39], v18, s[28:31], s3 offen nt
    s_add_u32 s3, s3, 16384
    buffer_load_dwordx4 v[40:43], v18, s[28:31], s3 offen nt
    s_add_u32 s3, s3, 16384
    buffer_load_dwordx4 v[44:47], v18, s[28:31], s3 offen nt
    s_add_u32 s3, s3, 16384
    s_barrier
    s_branch c_prep_tail
h_first:
    s_memrealtime s[50:51]
    s_getpc_b64 s[52:53]
pc_10:
    s_sub_u32 s52, s52, pc_10-interleave_layers__sliding_local_dilated__softmax_full_mha__prompt_kernel
    s_subb_u32 s53, s53, 0
    s_lshr_b32 s3, s2, 3
    s_lshl_b32 s3, s3, 11
    v_and_b32 v18, 15, v0
    v_lshl_add_u32 v18, v18, 7, s3
    v_min_u32 v18, k_end-interleave_layers__sliding_local_dilated__softmax_full_mha__prompt_kernel-4, v18
    v_mov_b32 v19, s53
    v_add_co_u32 v18, vcc, s52, v18
    s_nop 1
    v_addc_co_u32 v19, vcc, 0, v19, vcc
    s_mov_b64 exec, 0xffff
    global_load_dword v18, v[18:19], off
    s_mov_b64 exec, -1
    s_waitcnt lgkmcnt(0)
    s_mov_b32 s12, s4
    s_mov_b32 s13, s5
    s_mov_b32 s14, 71303168
    s_mov_b32 s15, 0x00020000
    s_cmp_lg_u32 s2, 0
    s_cbranch_scc1 h_first_nonon
    s_mov_b32 s16, s46
    s_mov_b32 s17, s47
    s_mov_b32 s18, 256
    s_mov_b32 s19, 0x00020000
    v_lshlrev_b32 v14, 6, v1
    s_or_b32 s50, s50, 1
    v_mov_b32 v13, s50
    buffer_store_dword v13, v14, s[16:19], 0 offen sc1
h_first_nonon:
    v_mov_b32 v8, 0
    v_mov_b32 v9, 0
    v_mov_b32 v10, 159488
    ds_write_b64 v10, v[8:9]
    ds_write_b64 v10, v[8:9] offset:8
    ds_write_b64 v10, v[8:9] offset:16
    ds_write_b64 v10, v[8:9] offset:24
    s_waitcnt lgkmcnt(0)
    s_barrier
    s_branch h_first_tail
k_exit:
k_exit2:
    s_endpgm
.p2align 6
c_qkvA:
    v_and_b32 v1, 63, v0
    v_lshrrev_b32 v2, 6, v0
    v_lshlrev_b32 v5, 4, v1
    v_lshrrev_b32 v3, 5, v1
    v_and_b32 v4, 15, v0
    v_bfe_u32 v7, v1, 4, 1
    v_lshl_add_u32 v6, v7, 5, v4
    v_lshlrev_b32 v6, 4, v6
    v_lshl_add_u32 v6, v3, 10, v6
    s_lshr_b32 s48, s6, 1
    s_lshl_b32 s48, s48, 2
    s_add_u32 s48, s48, s8
    s_lshl_b32 s55, s48, 17
    s_lshl_b32 s56, s9, 22
    s_add_u32 s55, s55, s56
    s_add_u32 s16, s4, s55
    s_addc_u32 s17, s5, 0
    s_mov_b32 s18, 65536
    s_mov_b32 s19, 0x00020000
    s_add_u32 s56, s55, 65536
    s_add_u32 s20, s4, s56
    s_addc_u32 s21, s5, 0
    s_mov_b32 s22, 65536
    s_mov_b32 s23, 0x00020000
    s_lshl_b32 s49, s7, 12
    s_add_u32 s49, s49, s55
    s_and_b32 s56, s6, 1
    s_lshl_b32 s56, s56, 11
    s_add_u32 s49, s49, s56
    s_add_u32 s49, s49, 16777216
    s_movk_i32 s54, 4096
    v_lshrrev_b32 v16, 2, v4
    v_lshl_add_u32 v18, v7, 2, v16
    v_lshl_add_u32 v18, v3, 4, v18
    v_lshlrev_b32 v18, 6, v18
    v_and_b32 v17, 3, v4
    v_lshl_add_u32 v18, v17, 3, v18
    v_lshl_add_u32 v26, v7, 5, v18
    v_xor_b32 v27, 32, v26
    v_mov_b32 v24, v26
    v_mov_b32 v25, v27
    v_and_b32 v18, 0x30, v1
    v_add_u32 v10, 155648, v18
    v_lshlrev_b32 v11, 2, v4
    v_add_u32 v11, 155648, v11
    v_lshl_add_u32 v8, v2, 8, v11
    v_lshl_add_u32 v9, v2, 8, v10
    s_lshr_b32 s3, s8, 1
    s_and_b32 s55, s8, 1
    s_lshl_b32 s56, s55, 5
    v_xor_b32 v29, s56, v26
    s_lshl_b32 s56, s3, 13
    s_add_u32 s56, s56, 8192
    v_add_u32 v29, s56, v29
    v_mov_b32 v28, v29
    v_add_u32 v30, 147456, v5
    v_lshl_add_u32 v14, v2, 6, v10
    v_lshl_add_u32 v12, v2, 11, v5
    v_add_u32 v12, 131072, v12
    v_lshlrev_b32 v16, 8, v16
    v_lshl_add_u32 v16, v18, 2, v16
    v_lshl_add_u32 v16, v17, 1, v16
    v_add_u32 v16, 1024, v16
    v_cmp_gt_u32 vcc, 2, v2
    s_nop 1
    v_cndmask_b32 v13, v16, v5, vcc
    s_lshl_b32 s56, s55, 3
    s_add_u32 s56, s56, 131072
    v_add_u32 v13, s56, v13
    v_lshrrev_b32 v18, 2, v18
    v_sub_u32 v18, v4, v18
    v_mov_b32 v19, 0xf149f2ca
    v_add_u32 v16, 0x0, v18
    v_and_b32 v16, 0xfffffff1, v16
    v_cmp_eq_u32 vcc, 0, v16
    s_nop 1
    v_cndmask_b32 v196, v19, 0, vcc
    v_add_u32 v16, 0xffffffff, v18
    v_and_b32 v16, 0xfffffff1, v16
    v_cmp_eq_u32 vcc, 0, v16
    s_nop 1
    v_cndmask_b32 v197, v19, 0, vcc
    v_add_u32 v16, 0xfffffffe, v18
    v_and_b32 v16, 0xfffffff1, v16
    v_cmp_eq_u32 vcc, 0, v16
    s_nop 1
    v_cndmask_b32 v198, v19, 0, vcc
    v_add_u32 v16, 0xfffffffd, v18
    v_and_b32 v16, 0xfffffff1, v16
    v_cmp_eq_u32 vcc, 0, v16
    s_nop 1
    v_cndmask_b32 v199, v19, 0, vcc
    v_add_u32 v16, 0x10, v18
    v_and_b32 v16, 0xfffffff1, v16
    v_cmp_eq_u32 vcc, 0, v16
    s_nop 1
    v_cndmask_b32 v200, v19, 0, vcc
    v_add_u32 v16, 0xf, v18
    v_and_b32 v16, 0xfffffff1, v16
    v_cmp_eq_u32 vcc, 0, v16
    s_nop 1
    v_cndmask_b32 v201, v19, 0, vcc
    v_add_u32 v16, 0xe, v18
    v_and_b32 v16, 0xfffffff1, v16
    v_cmp_eq_u32 vcc, 0, v16
    s_nop 1
    v_cndmask_b32 v202, v19, 0, vcc
    v_add_u32 v16, 0xd, v18
    v_and_b32 v16, 0xfffffff1, v16
    v_cmp_eq_u32 vcc, 0, v16
    s_nop 1
    v_cndmask_b32 v203, v19, 0, vcc
    s_cmp_eq_u32 s48, 0
    s_cselect_b64 vcc, -1, 0
    v_cndmask_b32 v204, v200, v19, vcc
    v_cndmask_b32 v205, v201, v19, vcc
    v_cndmask_b32 v206, v202, v19, vcc
    v_cndmask_b32 v207, v203, v19, vcc
    v_mov_b32 v208, 0x3f803f80
    v_mov_b32 v209, 0x3f803f80
    v_mov_b32 v210, 0x3f803f80
    v_mov_b32 v211, 0x3f803f80
    v_mov_b32 v184, 0
    v_mov_b32 v185, 0
    v_mov_b32 v186, 0
    v_mov_b32 v187, 0
    v_mov_b32 v188, 0
    v_mov_b32 v189, 0
    v_mov_b32 v190, 0
    v_mov_b32 v191, 0
    v_mov_b32 v192, 0
    v_mov_b32 v193, 0
    v_mov_b32 v194, 0
    v_mov_b32 v195, 0
    v_mov_b32 v32, 0
    v_mov_b32 v33, 0
    v_mov_b32 v34, 0
    v_mov_b32 v35, 0
    v_mov_b32 v36, 0
    v_mov_b32 v37, 0
    v_mov_b32 v38, 0
    v_mov_b32 v39, 0
    v_mov_b32 v40, 0
    v_mov_b32 v41, 0
    v_mov_b32 v42, 0
    v_mov_b32 v43, 0
    v_mov_b32 v44, 0
    v_mov_b32 v45, 0
    v_mov_b32 v46, 0
    v_mov_b32 v47, 0
    v_mov_b32 v48, 0
    v_mov_b32 v49, 0
    v_mov_b32 v50, 0
    v_mov_b32 v51, 0
    v_mov_b32 v52, 0
    v_mov_b32 v53, 0
    v_mov_b32 v54, 0
    v_mov_b32 v55, 0
    v_mov_b32 v56, 0
    v_mov_b32 v57, 0
    v_mov_b32 v58, 0
    v_mov_b32 v59, 0
    v_mov_b32 v60, 0
    v_mov_b32 v61, 0
    v_mov_b32 v62, 0
    v_mov_b32 v63, 0
    v_mov_b32 v64, 0
    v_mov_b32 v65, 0
    v_mov_b32 v66, 0
    v_mov_b32 v67, 0
    v_mov_b32 v68, 0
    v_mov_b32 v69, 0
    v_mov_b32 v70, 0
    v_mov_b32 v71, 0
    v_mov_b32 v72, 0
    v_mov_b32 v73, 0
    v_mov_b32 v74, 0
    v_mov_b32 v75, 0
    v_mov_b32 v76, 0
    v_mov_b32 v77, 0
    v_mov_b32 v78, 0
    v_mov_b32 v79, 0
    v_mov_b32 v80, 0
    v_mov_b32 v81, 0
    v_mov_b32 v82, 0
    v_mov_b32 v83, 0
    v_mov_b32 v84, 0
    v_mov_b32 v85, 0
    v_mov_b32 v86, 0
    v_mov_b32 v87, 0
    v_mov_b32 v88, 0
    v_mov_b32 v89, 0
    v_mov_b32 v90, 0
    v_mov_b32 v91, 0
    v_mov_b32 v92, 0
    v_mov_b32 v93, 0
    v_mov_b32 v94, 0
    v_mov_b32 v95, 0
    v_mov_b32 v96, 0
    v_mov_b32 v97, 0
    v_mov_b32 v98, 0
    v_mov_b32 v99, 0
    v_mov_b32 v100, 0
    v_mov_b32 v101, 0
    v_mov_b32 v102, 0
    v_mov_b32 v103, 0
    v_mov_b32 v104, 0
    v_mov_b32 v105, 0
    v_mov_b32 v106, 0
    v_mov_b32 v107, 0
    v_mov_b32 v108, 0
    v_mov_b32 v109, 0
    v_mov_b32 v110, 0
    v_mov_b32 v111, 0
    v_mov_b32 v112, 0
    v_mov_b32 v113, 0
    v_mov_b32 v114, 0
    v_mov_b32 v115, 0
    v_mov_b32 v116, 0
    v_mov_b32 v117, 0
    v_mov_b32 v118, 0
    v_mov_b32 v119, 0
    v_mov_b32 v120, 0
    v_mov_b32 v121, 0
    v_mov_b32 v122, 0
    v_mov_b32 v123, 0
    v_mov_b32 v124, 0
    v_mov_b32 v125, 0
    v_mov_b32 v126, 0
    v_mov_b32 v127, 0
    s_mov_b32 s50, 8192
    s_mov_b32 s58, 6144
    s_mov_b32 s51, 12288
    s_mov_b32 s59, 10240
    s_mov_b32 s52, 0
    s_mul_i32 s60, s9, 786432
    s_add_u32 s60, s60, 65273856
    s_lshl_b32 s61, s11, 10
    s_add_u32 s60, s60, s61
    s_and_b32 s61, s8, 2
    s_lshl_b32 s61, s61, 7
    s_add_u32 s60, s60, s61
    s_add_u32 s61, s60, 128
    s_mov_b32 s98, s10
    s_mov_b32 s99, s10
    s_mov_b32 s3, 0x100000
cp_1:
    s_load_dwordx8 s[64:71], s[4:5], s60 glc
    s_load_dwordx8 s[72:79], s[4:5], s61 glc
    s_sub_u32 s3, s3, 1
    s_cbranch_scc1 cp_1_ok
    s_waitcnt lgkmcnt(0)
    s_xor_b64 s[100:101], s[64:65], s[98:99]
    s_xor_b64 s[64:65], s[66:67], s[98:99]
    s_or_b64 s[100:101], s[100:101], s[64:65]
    s_xor_b64 s[64:65], s[68:69], s[98:99]
    s_or_b64 s[100:101], s[100:101], s[64:65]
    s_xor_b64 s[64:65], s[70:71], s[98:99]
    s_or_b64 s[100:101], s[100:101], s[64:65]
    s_xor_b64 s[64:65], s[72:73], s[98:99]
    s_or_b64 s[100:101], s[100:101], s[64:65]
    s_xor_b64 s[64:65], s[74:75], s[98:99]
    s_or_b64 s[100:101], s[100:101], s[64:65]
    s_xor_b64 s[64:65], s[76:77], s[98:99]
    s_or_b64 s[100:101], s[100:101], s[64:65]
    s_xor_b64 s[64:65], s[78:79], s[98:99]
    s_or_b64 s[100:101], s[100:101], s[64:65]
    s_cbranch_scc1 cp_1
cp_1_ok:
    s_waitcnt lgkmcnt(0)
    buffer_load_dwordx4 v[152:155], v6, s[16:19], 0 offen offset:0 sc1
    buffer_load_dwordx4 v[156:159], v6, s[16:19], 0 offen offset:256 sc1
    buffer_load_dwordx4 v[160:163], v6, s[20:23], 0 offen offset:0 sc1
    buffer_load_dwordx4 v[164:167], v6, s[20:23], 0 offen offset:256 sc1
    buffer_load_dwordx4 v[168:171], v6, s[16:19], 0 offen offset:2048 sc1
    buffer_load_dwordx4 v[172:175], v6, s[16:19], 0 offen offset:2304 sc1
    buffer_load_dwordx4 v[176:179], v6, s[20:23], 0 offen offset:2048 sc1
    buffer_load_dwordx4 v[180:183], v6, s[20:23], 0 offen offset:2304 sc1
    s_barrier
    ds_read_b64_tr_b16 v[128:129], v24 offset:0
    ds_read_b64_tr_b16 v[130:131], v24 offset:512
    ds_read_b64_tr_b16 v[132:133], v25 offset:0
    ds_read_b64_tr_b16 v[134:135], v25 offset:512
    ds_read_b64_tr_b16 v[136:137], v24 offset:8192
    ds_read_b64_tr_b16 v[138:139], v24 offset:8704
    ds_read_b64_tr_b16 v[140:141], v25 offset:8192
    ds_read_b64_tr_b16 v[142:143], v25 offset:8704
    ds_read_b64_tr_b16 v[144:145], v24 offset:16384
    ds_read_b64_tr_b16 v[146:147], v24 offset:16896
    buffer_load_dwordx4 a[0:3], v6, s[16:19], s54 offen offset:0 sc1
    buffer_load_dwordx4 a[4:7], v6, s[16:19], s54 offen offset:256 sc1
    buffer_load_dwordx4 a[8:11], v6, s[20:23], s54 offen offset:0 sc1
    buffer_load_dwordx4 a[12:15], v6, s[20:23], s54 offen offset:256 sc1
    buffer_load_dwordx4 a[16:19], v6, s[16:19], s54 offen offset:2048 sc1
    buffer_load_dwordx4 a[20:23], v6, s[16:19], s54 offen offset:2304 sc1
    s_mov_b32 s54, 7
.p2align 3
c_qkvA_loop:
    s_waitcnt vmcnt(12) lgkmcnt(8)
    v_mfma_f32_16x16x32_bf16 v[184:187], v[188:191], v[192:195], v[184:187]
    v_mfma_f32_16x16x32_bf16 v[32:35], v[128:131], v[152:155], v[32:35]
    ds_read_b64_tr_b16 v[148:149], v25 offset:16384
    buffer_load_dwordx4 a[24:27], v6, s[20:23], s58 offen offset:0 sc1
    v_mfma_f32_16x16x32_bf16 v[36:39], v[128:131], v[156:159], v[36:39]
    ds_read_b64_tr_b16 v[150:151], v25 offset:16896
    s_waitcnt lgkmcnt(8)
    v_mfma_f32_16x16x32_bf16 v[52:55], v[132:135], v[156:159], v[52:55]
    v_mfma_f32_16x16x32_bf16 v[48:51], v[132:135], v[152:155], v[48:51]
    ds_read_b64_tr_b16 v[188:189], v28 offset:0
    s_waitcnt lgkmcnt(7)
    v_mfma_f32_16x16x32_bf16 v[64:67], v[136:139], v[152:155], v[64:67]
    v_mfma_f32_16x16x32_bf16 v[68:71], v[136:139], v[156:159], v[68:71]
    ds_read_b64_tr_b16 v[190:191], v28 offset:512
    s_waitcnt lgkmcnt(6)
    v_mfma_f32_16x16x32_bf16 v[84:87], v[140:143], v[156:159], v[84:87]
    buffer_load_dwordx4 a[28:31], v6, s[20:23], s58 offen offset:256 sc1
    v_mfma_f32_16x16x32_bf16 v[80:83], v[140:143], v[152:155], v[80:83]
    ds_read_b128 v[192:195], v30 offset:0
    s_waitcnt lgkmcnt(5)
    v_mfma_f32_16x16x32_bf16 v[96:99], v[152:155], v[144:147], v[96:99]
    v_mfma_f32_16x16x32_bf16 v[100:103], v[156:159], v[144:147], v[100:103]
    s_waitcnt lgkmcnt(3)
    v_mfma_f32_16x16x32_bf16 v[116:119], v[156:159], v[148:151], v[116:119]
    v_mfma_f32_16x16x32_bf16 v[112:115], v[152:155], v[148:151], v[112:115]
    s_waitcnt vmcnt(12)
    v_mfma_f32_16x16x32_bf16 v[40:43], v[128:131], v[160:163], v[40:43]
    buffer_load_dwordx4 v[152:155], v6, s[16:19], s50 offen offset:0 sc1
    v_mfma_f32_16x16x32_bf16 v[44:47], v[128:131], v[164:167], v[44:47]
    v_mfma_f32_16x16x32_bf16 v[60:63], v[132:135], v[164:167], v[60:63]
    ds_read_b64_tr_b16 v[128:129], v24 offset:2048
    v_mfma_f32_16x16x32_bf16 v[56:59], v[132:135], v[160:163], v[56:59]
    ds_read_b64_tr_b16 v[130:131], v24 offset:2560
    v_mfma_f32_16x16x32_bf16 v[72:75], v[136:139], v[160:163], v[72:75]
    ds_read_b64_tr_b16 v[132:133], v25 offset:2048
    v_mfma_f32_16x16x32_bf16 v[76:79], v[136:139], v[164:167], v[76:79]
    ds_read_b64_tr_b16 v[134:135], v25 offset:2560
    v_mfma_f32_16x16x32_bf16 v[92:95], v[140:143], v[164:167], v[92:95]
    ds_read_b64_tr_b16 v[136:137], v24 offset:10240
    buffer_load_dwordx4 v[156:159], v6, s[16:19], s50 offen offset:256 sc1
    v_mfma_f32_16x16x32_bf16 v[88:91], v[140:143], v[160:163], v[88:91]
    ds_read_b64_tr_b16 v[138:139], v24 offset:10752
    v_mfma_f32_16x16x32_bf16 v[104:107], v[160:163], v[144:147], v[104:107]
    ds_read_b64_tr_b16 v[140:141], v25 offset:10240
    v_mfma_f32_16x16x32_bf16 v[108:111], v[164:167], v[144:147], v[108:111]
    ds_read_b64_tr_b16 v[142:143], v25 offset:10752
    v_mfma_f32_16x16x32_bf16 v[124:127], v[164:167], v[148:151], v[124:127]
    ds_read_b64_tr_b16 v[144:145], v24 offset:18432
    v_mfma_f32_16x16x32_bf16 v[120:123], v[160:163], v[148:151], v[120:123]
    ds_read_b64_tr_b16 v[146:147], v24 offset:18944
    s_waitcnt vmcnt(12) lgkmcnt(8)
    v_mfma_f32_16x16x32_bf16 v[184:187], v[188:191], v[192:195], v[184:187]
    v_mfma_f32_16x16x32_bf16 v[32:35], v[128:131], v[168:171], v[32:35]
    ds_read_b64_tr_b16 v[148:149], v25 offset:18432
    buffer_load_dwordx4 v[160:163], v6, s[20:23], s58 offen offset:2048 sc1
    v_mfma_f32_16x16x32_bf16 v[36:39], v[128:131], v[172:175], v[36:39]
    ds_read_b64_tr_b16 v[150:151], v25 offset:18944
    s_waitcnt lgkmcnt(8)
    v_mfma_f32_16x16x32_bf16 v[52:55], v[132:135], v[172:175], v[52:55]
    v_mfma_f32_16x16x32_bf16 v[48:51], v[132:135], v[168:171], v[48:51]
    ds_read_b64_tr_b16 v[188:189], v28 offset:2048
    s_waitcnt lgkmcnt(7)
    v_mfma_f32_16x16x32_bf16 v[64:67], v[136:139], v[168:171], v[64:67]
    v_mfma_f32_16x16x32_bf16 v[68:71], v[136:139], v[172:175], v[68:71]
    ds_read_b64_tr_b16 v[190:191], v28 offset:2560
    s_waitcnt lgkmcnt(6)
    v_mfma_f32_16x16x32_bf16 v[84:87], v[140:143], v[172:175], v[84:87]
    buffer_load_dwordx4 v[164:167], v6, s[20:23], s58 offen offset:2304 sc1
    v_mfma_f32_16x16x32_bf16 v[80:83], v[140:143], v[168:171], v[80:83]
    ds_read_b128 v[192:195], v30 offset:1024
    s_waitcnt lgkmcnt(5)
    v_mfma_f32_16x16x32_bf16 v[96:99], v[168:171], v[144:147], v[96:99]
    v_mfma_f32_16x16x32_bf16 v[100:103], v[172:175], v[144:147], v[100:103]
    s_waitcnt lgkmcnt(3)
    v_mfma_f32_16x16x32_bf16 v[116:119], v[172:175], v[148:151], v[116:119]
    v_mfma_f32_16x16x32_bf16 v[112:115], v[168:171], v[148:151], v[112:115]
    s_waitcnt vmcnt(12)
    v_mfma_f32_16x16x32_bf16 v[40:43], v[128:131], v[176:179], v[40:43]
    buffer_load_dwordx4 v[168:171], v6, s[16:19], s50 offen offset:2048 sc1
    v_mfma_f32_16x16x32_bf16 v[44:47], v[128:131], v[180:183], v[44:47]
    v_mfma_f32_16x16x32_bf16 v[60:63], v[132:135], v[180:183], v[60:63]
    ds_read_b64_tr_b16 v[128:129], v24 offset:4096
    v_mfma_f32_16x16x32_bf16 v[56:59], v[132:135], v[176:179], v[56:59]
    ds_read_b64_tr_b16 v[130:131], v24 offset:4608
    v_mfma_f32_16x16x32_bf16 v[72:75], v[136:139], v[176:179], v[72:75]
    ds_read_b64_tr_b16 v[132:133], v25 offset:4096
    v_mfma_f32_16x16x32_bf16 v[76:79], v[136:139], v[180:183], v[76:79]
    ds_read_b64_tr_b16 v[134:135], v25 offset:4608
    v_mfma_f32_16x16x32_bf16 v[92:95], v[140:143], v[180:183], v[92:95]
    ds_read_b64_tr_b16 v[136:137], v24 offset:12288
    buffer_load_dwordx4 v[172:175], v6, s[16:19], s50 offen offset:2304 sc1
    v_mfma_f32_16x16x32_bf16 v[88:91], v[140:143], v[176:179], v[88:91]
    ds_read_b64_tr_b16 v[138:139], v24 offset:12800
    v_mfma_f32_16x16x32_bf16 v[104:107], v[176:179], v[144:147], v[104:107]
    ds_read_b64_tr_b16 v[140:141], v25 offset:12288
    v_mfma_f32_16x16x32_bf16 v[108:111], v[180:183], v[144:147], v[108:111]
    ds_read_b64_tr_b16 v[142:143], v25 offset:12800
    v_mfma_f32_16x16x32_bf16 v[124:127], v[180:183], v[148:151], v[124:127]
    ds_read_b64_tr_b16 v[144:145], v24 offset:20480
    v_mfma_f32_16x16x32_bf16 v[120:123], v[176:179], v[148:151], v[120:123]
    ds_read_b64_tr_b16 v[146:147], v24 offset:20992
    s_waitcnt vmcnt(12) lgkmcnt(8)
    v_mfma_f32_16x16x32_bf16 v[184:187], v[188:191], v[192:195], v[184:187]
    v_mfma_f32_16x16x32_bf16 v[32:35], v[128:131], a[0:3], v[32:35]
    ds_read_b64_tr_b16 v[148:149], v25 offset:20480
    buffer_load_dwordx4 v[176:179], v6, s[20:23], s59 offen offset:0 sc1
    v_mfma_f32_16x16x32_bf16 v[36:39], v[128:131], a[4:7], v[36:39]
    ds_read_b64_tr_b16 v[150:151], v25 offset:20992
    s_waitcnt lgkmcnt(8)
    v_mfma_f32_16x16x32_bf16 v[52:55], v[132:135], a[4:7], v[52:55]
    s_add_u32 s58, s58, 8192
    v_mfma_f32_16x16x32_bf16 v[48:51], v[132:135], a[0:3], v[48:51]
    ds_read_b64_tr_b16 v[188:189], v28 offset:4096
    s_waitcnt lgkmcnt(7)
    v_mfma_f32_16x16x32_bf16 v[64:67], v[136:139], a[0:3], v[64:67]
    s_add_u32 s50, s50, 8192
    v_mfma_f32_16x16x32_bf16 v[68:71], v[136:139], a[4:7], v[68:71]
    ds_read_b64_tr_b16 v[190:191], v28 offset:4608
    s_waitcnt lgkmcnt(6)
    v_mfma_f32_16x16x32_bf16 v[84:87], v[140:143], a[4:7], v[84:87]
    buffer_load_dwordx4 v[180:183], v6, s[20:23], s59 offen offset:256 sc1
    v_mfma_f32_16x16x32_bf16 v[80:83], v[140:143], a[0:3], v[80:83]
    ds_read_b128 v[192:195], v30 offset:2048
    s_waitcnt lgkmcnt(5)
    v_mfma_f32_16x16x32_bf16 v[96:99], a[0:3], v[144:147], v[96:99]
    s_add_u32 s52, s52, 24576
    v_mfma_f32_16x16x32_bf16 v[100:103], a[4:7], v[144:147], v[100:103]
    s_cmp_eq_u32 s52, 147456
    s_waitcnt lgkmcnt(3)
    v_mfma_f32_16x16x32_bf16 v[116:119], a[4:7], v[148:151], v[116:119]
    s_cselect_b32 s52, 0, s52
    v_mfma_f32_16x16x32_bf16 v[112:115], a[0:3], v[148:151], v[112:115]
    s_waitcnt vmcnt(12)
    v_mfma_f32_16x16x32_bf16 v[40:43], v[128:131], a[8:11], v[40:43]
    buffer_load_dwordx4 a[0:3], v6, s[16:19], s51 offen offset:0 sc1
    v_mfma_f32_16x16x32_bf16 v[44:47], v[128:131], a[12:15], v[44:47]
    s_sub_u32 s54, s54, 1
    v_mfma_f32_16x16x32_bf16 v[60:63], v[132:135], a[12:15], v[60:63]
    ds_read_b64_tr_b16 v[128:129], v24 offset:6144
    v_mfma_f32_16x16x32_bf16 v[56:59], v[132:135], a[8:11], v[56:59]
    ds_read_b64_tr_b16 v[130:131], v24 offset:6656
    v_mfma_f32_16x16x32_bf16 v[72:75], v[136:139], a[8:11], v[72:75]
    ds_read_b64_tr_b16 v[132:133], v25 offset:6144
    v_mfma_f32_16x16x32_bf16 v[76:79], v[136:139], a[12:15], v[76:79]
    ds_read_b64_tr_b16 v[134:135], v25 offset:6656
    v_mfma_f32_16x16x32_bf16 v[92:95], v[140:143], a[12:15], v[92:95]
    ds_read_b64_tr_b16 v[136:137], v24 offset:14336
    buffer_load_dwordx4 a[4:7], v6, s[16:19], s51 offen offset:256 sc1
    v_mfma_f32_16x16x32_bf16 v[88:91], v[140:143], a[8:11], v[88:91]
    ds_read_b64_tr_b16 v[138:139], v24 offset:14848
    v_mfma_f32_16x16x32_bf16 v[104:107], a[8:11], v[144:147], v[104:107]
    ds_read_b64_tr_b16 v[140:141], v25 offset:14336
    v_mfma_f32_16x16x32_bf16 v[108:111], a[12:15], v[144:147], v[108:111]
    ds_read_b64_tr_b16 v[142:143], v25 offset:14848
    v_mfma_f32_16x16x32_bf16 v[124:127], a[12:15], v[148:151], v[124:127]
    ds_read_b64_tr_b16 v[144:145], v24 offset:22528
    v_mfma_f32_16x16x32_bf16 v[120:123], a[8:11], v[148:151], v[120:123]
    ds_read_b64_tr_b16 v[146:147], v24 offset:23040
    s_waitcnt vmcnt(12) lgkmcnt(8)
    v_mfma_f32_16x16x32_bf16 v[184:187], v[188:191], v[192:195], v[184:187]
    v_mfma_f32_16x16x32_bf16 v[32:35], v[128:131], a[16:19], v[32:35]
    ds_read_b64_tr_b16 v[148:149], v25 offset:22528
    buffer_load_dwordx4 a[8:11], v6, s[20:23], s59 offen offset:2048 sc1
    v_mfma_f32_16x16x32_bf16 v[36:39], v[128:131], a[20:23], v[36:39]
    ds_read_b64_tr_b16 v[150:151], v25 offset:23040
    s_waitcnt lgkmcnt(8)
    v_mfma_f32_16x16x32_bf16 v[52:55], v[132:135], a[20:23], v[52:55]
    v_add_u32 v24, s52, v26
    v_mfma_f32_16x16x32_bf16 v[48:51], v[132:135], a[16:19], v[48:51]
    ds_read_b64_tr_b16 v[188:189], v28 offset:6144
    s_waitcnt lgkmcnt(7)
    v_mfma_f32_16x16x32_bf16 v[64:67], v[136:139], a[16:19], v[64:67]
    v_add_u32 v25, s52, v27
    v_mfma_f32_16x16x32_bf16 v[68:71], v[136:139], a[20:23], v[68:71]
    ds_read_b64_tr_b16 v[190:191], v28 offset:6656
    s_waitcnt lgkmcnt(6)
    v_mfma_f32_16x16x32_bf16 v[84:87], v[140:143], a[20:23], v[84:87]
    buffer_load_dwordx4 a[12:15], v6, s[20:23], s59 offen offset:2304 sc1
    v_mfma_f32_16x16x32_bf16 v[80:83], v[140:143], a[16:19], v[80:83]
    ds_read_b128 v[192:195], v30 offset:3072
    s_waitcnt lgkmcnt(5)
    v_mfma_f32_16x16x32_bf16 v[96:99], a[16:19], v[144:147], v[96:99]
    s_add_u32 s59, s59, 8192
    v_mfma_f32_16x16x32_bf16 v[100:103], a[20:23], v[144:147], v[100:103]
    v_add_u32 v28, s52, v29
    s_waitcnt lgkmcnt(3)
    v_mfma_f32_16x16x32_bf16 v[116:119], a[20:23], v[148:151], v[116:119]
    s_waitcnt lgkmcnt(0)
    v_mfma_f32_16x16x32_bf16 v[112:115], a[16:19], v[148:151], v[112:115]
    s_barrier
    s_waitcnt vmcnt(12)
    v_mfma_f32_16x16x32_bf16 v[40:43], v[128:131], a[24:27], v[40:43]
    buffer_load_dwordx4 a[16:19], v6, s[16:19], s51 offen offset:2048 sc1
    v_mfma_f32_16x16x32_bf16 v[44:47], v[128:131], a[28:31], v[44:47]
    v_xor_b32 v30, 4096, v30
    v_mfma_f32_16x16x32_bf16 v[60:63], v[132:135], a[28:31], v[60:63]
    ds_read_b64_tr_b16 v[128:129], v24 offset:0
    v_mfma_f32_16x16x32_bf16 v[56:59], v[132:135], a[24:27], v[56:59]
    ds_read_b64_tr_b16 v[130:131], v24 offset:512
    v_mfma_f32_16x16x32_bf16 v[72:75], v[136:139], a[24:27], v[72:75]
    ds_read_b64_tr_b16 v[132:133], v25 offset:0
    v_mfma_f32_16x16x32_bf16 v[76:79], v[136:139], a[28:31], v[76:79]
    ds_read_b64_tr_b16 v[134:135], v25 offset:512
    v_mfma_f32_16x16x32_bf16 v[92:95], v[140:143], a[28:31], v[92:95]
    ds_read_b64_tr_b16 v[136:137], v24 offset:8192
    buffer_load_dwordx4 a[20:23], v6, s[16:19], s51 offen offset:2304 sc1
    v_mfma_f32_16x16x32_bf16 v[88:91], v[140:143], a[24:27], v[88:91]
    ds_read_b64_tr_b16 v[138:139], v24 offset:8704
    v_mfma_f32_16x16x32_bf16 v[104:107], a[24:27], v[144:147], v[104:107]
    ds_read_b64_tr_b16 v[140:141], v25 offset:8192
    s_add_u32 s51, s51, 8192
    v_mfma_f32_16x16x32_bf16 v[108:111], a[28:31], v[144:147], v[108:111]
    ds_read_b64_tr_b16 v[142:143], v25 offset:8704
    v_mfma_f32_16x16x32_bf16 v[124:127], a[28:31], v[148:151], v[124:127]
    ds_read_b64_tr_b16 v[144:145], v24 offset:16384
    s_cmp_lg_u32 s54, 0
    v_mfma_f32_16x16x32_bf16 v[120:123], a[24:27], v[148:151], v[120:123]
    ds_read_b64_tr_b16 v[146:147], v24 offset:16896
    s_cbranch_scc1 c_qkvA_loop
    s_waitcnt vmcnt(12) lgkmcnt(8)
    v_mfma_f32_16x16x32_bf16 v[184:187], v[188:191], v[192:195], v[184:187]
    v_mfma_f32_16x16x32_bf16 v[32:35], v[128:131], v[152:155], v[32:35]
    ds_read_b64_tr_b16 v[148:149], v25 offset:16384
    buffer_load_dwordx4 a[24:27], v6, s[20:23], s58 offen offset:0 sc1
    v_mfma_f32_16x16x32_bf16 v[36:39], v[128:131], v[156:159], v[36:39]
    ds_read_b64_tr_b16 v[150:151], v25 offset:16896
    s_waitcnt lgkmcnt(8)
    v_mfma_f32_16x16x32_bf16 v[52:55], v[132:135], v[156:159], v[52:55]
    ds_read_b32 v16, v8 offset:1280
    v_mfma_f32_16x16x32_bf16 v[48:51], v[132:135], v[152:155], v[48:51]
    ds_read_b64_tr_b16 v[188:189], v28 offset:0
    ds_read_b32 v18, v8 offset:1344
    s_waitcnt lgkmcnt(9)
    v_mfma_f32_16x16x32_bf16 v[64:67], v[136:139], v[152:155], v[64:67]
    ds_read_b32 v20, v8 offset:1408
    v_mfma_f32_16x16x32_bf16 v[68:71], v[136:139], v[156:159], v[68:71]
    ds_read_b64_tr_b16 v[190:191], v28 offset:512
    s_waitcnt lgkmcnt(9)
    v_mfma_f32_16x16x32_bf16 v[84:87], v[140:143], v[156:159], v[84:87]
    buffer_load_dwordx4 a[28:31], v6, s[20:23], s58 offen offset:256 sc1
    ds_read_b32 v22, v8 offset:1472
    v_mfma_f32_16x16x32_bf16 v[80:83], v[140:143], v[152:155], v[80:83]
    ds_read_b128 v[192:195], v30 offset:0
    ds_read_b128 v[212:215], v10 offset:128
    s_waitcnt lgkmcnt(10)
    v_mfma_f32_16x16x32_bf16 v[96:99], v[152:155], v[144:147], v[96:99]
    ds_read_b128 v[216:219], v10 offset:192
    v_mfma_f32_16x16x32_bf16 v[100:103], v[156:159], v[144:147], v[100:103]
    s_waitcnt lgkmcnt(9)
    v_mfma_f32_16x16x32_bf16 v[116:119], v[156:159], v[148:151], v[116:119]
    v_mfma_f32_16x16x32_bf16 v[112:115], v[152:155], v[148:151], v[112:115]
    s_waitcnt vmcnt(12)
    v_mfma_f32_16x16x32_bf16 v[40:43], v[128:131], v[160:163], v[40:43]
    s_waitcnt lgkmcnt(0)
    v_fma_f32 v64, -v16, v212, v64
    v_fma_f32 v65, -v16, v213, v65
    v_mfma_f32_16x16x32_bf16 v[44:47], v[128:131], v[164:167], v[44:47]
    v_fma_f32 v66, -v16, v214, v66
    v_mfma_f32_16x16x32_bf16 v[60:63], v[132:135], v[164:167], v[60:63]
    ds_read_b64_tr_b16 v[128:129], v24 offset:2048
    v_fma_f32 v67, -v16, v215, v67
    v_mfma_f32_16x16x32_bf16 v[56:59], v[132:135], v[160:163], v[56:59]
    ds_read_b64_tr_b16 v[130:131], v24 offset:2560
    v_fma_f32 v68, -v18, v212, v68
    v_fma_f32 v69, -v18, v213, v69
    v_mfma_f32_16x16x32_bf16 v[72:75], v[136:139], v[160:163], v[72:75]
    ds_read_b64_tr_b16 v[132:133], v25 offset:2048
    v_fma_f32 v70, -v18, v214, v70
    v_mfma_f32_16x16x32_bf16 v[76:79], v[136:139], v[164:167], v[76:79]
    ds_read_b64_tr_b16 v[134:135], v25 offset:2560
    v_fma_f32 v71, -v18, v215, v71
    v_mfma_f32_16x16x32_bf16 v[92:95], v[140:143], v[164:167], v[92:95]
    ds_read_b64_tr_b16 v[136:137], v24 offset:10240
    v_fma_f32 v80, -v16, v216, v80
    v_fma_f32 v81, -v16, v217, v81
    v_mfma_f32_16x16x32_bf16 v[88:91], v[140:143], v[160:163], v[88:91]
    ds_read_b64_tr_b16 v[138:139], v24 offset:10752
    v_fma_f32 v82, -v16, v218, v82
    v_mfma_f32_16x16x32_bf16 v[104:107], v[160:163], v[144:147], v[104:107]
    ds_read_b64_tr_b16 v[140:141], v25 offset:10240
    v_fma_f32 v83, -v16, v219, v83
    v_mfma_f32_16x16x32_bf16 v[108:111], v[164:167], v[144:147], v[108:111]
    ds_read_b64_tr_b16 v[142:143], v25 offset:10752
    v_fma_f32 v84, -v18, v216, v84
    v_fma_f32 v85, -v18, v217, v85
    v_mfma_f32_16x16x32_bf16 v[124:127], v[164:167], v[148:151], v[124:127]
    ds_read_b64_tr_b16 v[144:145], v24 offset:18432
    v_fma_f32 v86, -v18, v218, v86
    v_mfma_f32_16x16x32_bf16 v[120:123], v[160:163], v[148:151], v[120:123]
    ds_read_b64_tr_b16 v[146:147], v24 offset:18944
    v_fma_f32 v87, -v18, v219, v87
    s_waitcnt vmcnt(10) lgkmcnt(8)
    v_mfma_f32_16x16x32_bf16 v[184:187], v[188:191], v[192:195], v[184:187]
    v_mfma_f32_16x16x32_bf16 v[32:35], v[128:131], v[168:171], v[32:35]
    ds_read_b64_tr_b16 v[148:149], v25 offset:18432
    v_fma_f32 v72, -v20, v212, v72
    v_fma_f32 v73, -v20, v213, v73
    v_mfma_f32_16x16x32_bf16 v[36:39], v[128:131], v[172:175], v[36:39]
    ds_read_b64_tr_b16 v[150:151], v25 offset:18944
    v_fma_f32 v74, -v20, v214, v74
    s_waitcnt lgkmcnt(8)
    v_mfma_f32_16x16x32_bf16 v[52:55], v[132:135], v[172:175], v[52:55]
    v_fma_f32 v75, -v20, v215, v75
    ds_read_b128 v[152:155], v10 offset:0
    v_mfma_f32_16x16x32_bf16 v[48:51], v[132:135], v[168:171], v[48:51]
    ds_read_b64_tr_b16 v[188:189], v28 offset:2048
    v_fma_f32 v76, -v22, v212, v76
    v_fma_f32 v77, -v22, v213, v77
    ds_read_b128 v[156:159], v10 offset:64
    s_waitcnt lgkmcnt(9)
    v_mfma_f32_16x16x32_bf16 v[64:67], v[136:139], v[168:171], v[64:67]
    v_fma_f32 v78, -v22, v214, v78
    ds_read_b32 v17, v8 offset:2816
    v_mfma_f32_16x16x32_bf16 v[68:71], v[136:139], v[172:175], v[68:71]
    ds_read_b64_tr_b16 v[190:191], v28 offset:2560
    v_fma_f32 v79, -v22, v215, v79
    s_waitcnt lgkmcnt(9)
    v_mfma_f32_16x16x32_bf16 v[84:87], v[140:143], v[172:175], v[84:87]
    v_fma_f32 v88, -v20, v216, v88
    v_fma_f32 v89, -v20, v217, v89
    ds_read_b32 v19, v8 offset:2880
    v_mfma_f32_16x16x32_bf16 v[80:83], v[140:143], v[168:171], v[80:83]
    ds_read_b128 v[192:195], v30 offset:1024
    v_fma_f32 v90, -v20, v218, v90
    ds_read_b32 v21, v8 offset:2944
    s_waitcnt lgkmcnt(10)
    v_mfma_f32_16x16x32_bf16 v[96:99], v[168:171], v[144:147], v[96:99]
    v_fma_f32 v91, -v20, v219, v91
    ds_read_b32 v23, v8 offset:3008
    v_mfma_f32_16x16x32_bf16 v[100:103], v[172:175], v[144:147], v[100:103]
    v_fma_f32 v92, -v22, v216, v92
    v_fma_f32 v93, -v22, v217, v93
    s_waitcnt lgkmcnt(9)
    v_mfma_f32_16x16x32_bf16 v[116:119], v[172:175], v[148:151], v[116:119]
    v_fma_f32 v94, -v22, v218, v94
    v_mfma_f32_16x16x32_bf16 v[112:115], v[168:171], v[148:151], v[112:115]
    v_fma_f32 v95, -v22, v219, v95
    s_waitcnt vmcnt(8)
    v_mfma_f32_16x16x32_bf16 v[40:43], v[128:131], v[176:179], v[40:43]
    s_waitcnt lgkmcnt(0)
    v_fma_f32 v32, -v16, v152, v32
    v_fma_f32 v33, -v16, v153, v33
    v_mfma_f32_16x16x32_bf16 v[44:47], v[128:131], v[180:183], v[44:47]
    v_fma_f32 v34, -v16, v154, v34
    v_mfma_f32_16x16x32_bf16 v[60:63], v[132:135], v[180:183], v[60:63]
    ds_read_b64_tr_b16 v[128:129], v24 offset:4096
    v_fma_f32 v35, -v16, v155, v35
    v_fma_f32 v36, -v18, v152, v36
    v_mfma_f32_16x16x32_bf16 v[56:59], v[132:135], v[176:179], v[56:59]
    ds_read_b64_tr_b16 v[130:131], v24 offset:4608
    v_fma_f32 v37, -v18, v153, v37
    v_mfma_f32_16x16x32_bf16 v[72:75], v[136:139], v[176:179], v[72:75]
    ds_read_b64_tr_b16 v[132:133], v25 offset:4096
    v_fma_f32 v38, -v18, v154, v38
    v_fma_f32 v39, -v18, v155, v39
    v_mfma_f32_16x16x32_bf16 v[76:79], v[136:139], v[180:183], v[76:79]
    ds_read_b64_tr_b16 v[134:135], v25 offset:4608
    v_fma_f32 v48, -v16, v156, v48
    v_mfma_f32_16x16x32_bf16 v[92:95], v[140:143], v[180:183], v[92:95]
    ds_read_b64_tr_b16 v[136:137], v24 offset:12288
    v_fma_f32 v49, -v16, v157, v49
    v_fma_f32 v50, -v16, v158, v50
    v_mfma_f32_16x16x32_bf16 v[88:91], v[140:143], v[176:179], v[88:91]
    ds_read_b64_tr_b16 v[138:139], v24 offset:12800
    v_fma_f32 v51, -v16, v159, v51
    v_mfma_f32_16x16x32_bf16 v[104:107], v[176:179], v[144:147], v[104:107]
    ds_read_b64_tr_b16 v[140:141], v25 offset:12288
    v_fma_f32 v52, -v18, v156, v52
    v_fma_f32 v53, -v18, v157, v53
    v_mfma_f32_16x16x32_bf16 v[108:111], v[180:183], v[144:147], v[108:111]
    ds_read_b64_tr_b16 v[142:143], v25 offset:12800
    v_fma_f32 v54, -v18, v158, v54
    v_mfma_f32_16x16x32_bf16 v[124:127], v[180:183], v[148:151], v[124:127]
    ds_read_b64_tr_b16 v[144:145], v24 offset:20480
    v_fma_f32 v55, -v18, v159, v55
    v_mfma_f32_16x16x32_bf16 v[120:123], v[176:179], v[148:151], v[120:123]
    ds_read_b64_tr_b16 v[146:147], v24 offset:20992
    s_waitcnt vmcnt(6) lgkmcnt(8)
    v_mfma_f32_16x16x32_bf16 v[184:187], v[188:191], v[192:195], v[184:187]
    v_mfma_f32_16x16x32_bf16 v[32:35], v[128:131], a[0:3], v[32:35]
    ds_read_b64_tr_b16 v[148:149], v25 offset:20480
    v_fma_f32 v40, -v20, v152, v40
    v_fma_f32 v41, -v20, v153, v41
    v_mfma_f32_16x16x32_bf16 v[36:39], v[128:131], a[4:7], v[36:39]
    ds_read_b64_tr_b16 v[150:151], v25 offset:20992
    v_fma_f32 v42, -v20, v154, v42
    s_waitcnt lgkmcnt(8)
    v_mfma_f32_16x16x32_bf16 v[52:55], v[132:135], a[4:7], v[52:55]
    v_fma_f32 v43, -v20, v155, v43
    v_fma_f32 v44, -v22, v152, v44
    ds_read_b128 v[168:171], v9 offset:1280
    v_mfma_f32_16x16x32_bf16 v[48:51], v[132:135], a[0:3], v[48:51]
    ds_read_b64_tr_b16 v[188:189], v28 offset:4096
    v_fma_f32 v45, -v22, v153, v45
    ds_read_b128 v[172:175], v9 offset:1344
    s_waitcnt lgkmcnt(9)
    v_mfma_f32_16x16x32_bf16 v[64:67], v[136:139], a[0:3], v[64:67]
    v_fma_f32 v46, -v22, v154, v46
    v_fma_f32 v47, -v22, v155, v47
    v_mfma_f32_16x16x32_bf16 v[68:71], v[136:139], a[4:7], v[68:71]
    ds_read_b64_tr_b16 v[190:191], v28 offset:4608
    v_fma_f32 v56, -v20, v156, v56
    ds_read_b128 v[176:179], v9 offset:1408
    s_waitcnt lgkmcnt(9)
    v_mfma_f32_16x16x32_bf16 v[84:87], v[140:143], a[4:7], v[84:87]
    v_fma_f32 v57, -v20, v157, v57
    v_fma_f32 v58, -v20, v158, v58
    ds_read_b128 v[180:183], v9 offset:1472
    v_mfma_f32_16x16x32_bf16 v[80:83], v[140:143], a[0:3], v[80:83]
    ds_read_b128 v[192:195], v30 offset:2048
    v_fma_f32 v59, -v20, v159, v59
    s_waitcnt lgkmcnt(9)
    v_mfma_f32_16x16x32_bf16 v[96:99], a[0:3], v[144:147], v[96:99]
    v_fma_f32 v60, -v22, v156, v60
    v_fma_f32 v61, -v22, v157, v61
    ds_read2_b32 v[220:221], v11 offset0:64 offset1:80
    v_mfma_f32_16x16x32_bf16 v[100:103], a[4:7], v[144:147], v[100:103]
    v_fma_f32 v62, -v22, v158, v62
    s_waitcnt lgkmcnt(8)
    v_mfma_f32_16x16x32_bf16 v[116:119], a[4:7], v[148:151], v[116:119]
    v_fma_f32 v63, -v22, v159, v63
    v_mfma_f32_16x16x32_bf16 v[112:115], a[0:3], v[148:151], v[112:115]
    s_waitcnt vmcnt(4)
    v_mfma_f32_16x16x32_bf16 v[40:43], v[128:131], a[8:11], v[40:43]
    v_mfma_f32_16x16x32_bf16 v[44:47], v[128:131], a[12:15], v[44:47]
    s_waitcnt lgkmcnt(0)
    v_fma_f32 v96, -v168, v220, v96
    v_fma_f32 v97, -v169, v220, v97
    v_mfma_f32_16x16x32_bf16 v[60:63], v[132:135], a[12:15], v[60:63]
    ds_read_b64_tr_b16 v[128:129], v24 offset:6144
    v_fma_f32 v98, -v170, v220, v98
    v_mfma_f32_16x16x32_bf16 v[56:59], v[132:135], a[8:11], v[56:59]
    ds_read_b64_tr_b16 v[130:131], v24 offset:6656
    v_fma_f32 v99, -v171, v220, v99
    v_fma_f32 v100, -v172, v220, v100
    v_mfma_f32_16x16x32_bf16 v[72:75], v[136:139], a[8:11], v[72:75]
    ds_read_b64_tr_b16 v[132:133], v25 offset:6144
    v_fma_f32 v101, -v173, v220, v101
    v_mfma_f32_16x16x32_bf16 v[76:79], v[136:139], a[12:15], v[76:79]
    ds_read_b64_tr_b16 v[134:135], v25 offset:6656
    v_fma_f32 v102, -v174, v220, v102
    v_fma_f32 v103, -v175, v220, v103
    v_mfma_f32_16x16x32_bf16 v[92:95], v[140:143], a[12:15], v[92:95]
    ds_read_b64_tr_b16 v[136:137], v24 offset:14336
    v_fma_f32 v112, -v168, v221, v112
    v_mfma_f32_16x16x32_bf16 v[88:91], v[140:143], a[8:11], v[88:91]
    ds_read_b64_tr_b16 v[138:139], v24 offset:14848
    v_fma_f32 v113, -v169, v221, v113
    v_fma_f32 v114, -v170, v221, v114
    v_mfma_f32_16x16x32_bf16 v[104:107], a[8:11], v[144:147], v[104:107]
    ds_read_b64_tr_b16 v[140:141], v25 offset:14336
    v_fma_f32 v115, -v171, v221, v115
    v_mfma_f32_16x16x32_bf16 v[108:111], a[12:15], v[144:147], v[108:111]
    ds_read_b64_tr_b16 v[142:143], v25 offset:14848
    v_fma_f32 v116, -v172, v221, v116
    v_fma_f32 v117, -v173, v221, v117
    v_mfma_f32_16x16x32_bf16 v[124:127], a[12:15], v[148:151], v[124:127]
    ds_read_b64_tr_b16 v[144:145], v24 offset:22528
    v_fma_f32 v118, -v174, v221, v118
    v_mfma_f32_16x16x32_bf16 v[120:123], a[8:11], v[148:151], v[120:123]
    ds_read_b64_tr_b16 v[146:147], v24 offset:23040
    v_fma_f32 v119, -v175, v221, v119
    s_waitcnt vmcnt(2) lgkmcnt(8)
    v_mfma_f32_16x16x32_bf16 v[184:187], v[188:191], v[192:195], v[184:187]
    v_mfma_f32_16x16x32_bf16 v[32:35], v[128:131], a[16:19], v[32:35]
    ds_read_b64_tr_b16 v[148:149], v25 offset:22528
    v_mfma_f32_16x16x32_bf16 v[36:39], v[128:131], a[20:23], v[36:39]
    ds_read_b64_tr_b16 v[150:151], v25 offset:23040
    v_fma_f32 v104, -v176, v220, v104
    v_fma_f32 v105, -v177, v220, v105
    s_waitcnt lgkmcnt(8)
    v_mfma_f32_16x16x32_bf16 v[52:55], v[132:135], a[20:23], v[52:55]
    v_fma_f32 v106, -v178, v220, v106
    ds_read_b128 v[152:155], v9 offset:2816
    v_mfma_f32_16x16x32_bf16 v[48:51], v[132:135], a[16:19], v[48:51]
    ds_read_b64_tr_b16 v[188:189], v28 offset:6144
    v_fma_f32 v107, -v179, v220, v107
    v_fma_f32 v108, -v180, v220, v108
    ds_read_b128 v[156:159], v9 offset:2880
    s_waitcnt lgkmcnt(9)
    v_mfma_f32_16x16x32_bf16 v[64:67], v[136:139], a[16:19], v[64:67]
    v_fma_f32 v109, -v181, v220, v109
    ds_read_b128 v[160:163], v9 offset:2944
    v_mfma_f32_16x16x32_bf16 v[68:71], v[136:139], a[20:23], v[68:71]
    ds_read_b64_tr_b16 v[190:191], v28 offset:6656
    v_fma_f32 v110, -v182, v220, v110
    v_fma_f32 v111, -v183, v220, v111
    ds_read_b128 v[164:167], v9 offset:3008
    s_waitcnt lgkmcnt(10)
    v_mfma_f32_16x16x32_bf16 v[84:87], v[140:143], a[20:23], v[84:87]
    v_fma_f32 v120, -v176, v221, v120
    ds_read_b128 v[212:215], v14 offset:128
    v_mfma_f32_16x16x32_bf16 v[80:83], v[140:143], a[16:19], v[80:83]
    ds_read_b128 v[192:195], v30 offset:3072
    v_fma_f32 v121, -v177, v221, v121
    v_fma_f32 v122, -v178, v221, v122
    ds_read_b32 v222, v11 offset:1216
    s_waitcnt lgkmcnt(11)
    v_mfma_f32_16x16x32_bf16 v[96:99], a[16:19], v[144:147], v[96:99]
    v_fma_f32 v123, -v179, v221, v123
    ds_read_b32 v223, v11 offset:2752
    v_mfma_f32_16x16x32_bf16 v[100:103], a[20:23], v[144:147], v[100:103]
    v_fma_f32 v124, -v180, v221, v124
    v_fma_f32 v125, -v181, v221, v125
    s_waitcnt lgkmcnt(10)
    v_mfma_f32_16x16x32_bf16 v[116:119], a[20:23], v[148:151], v[116:119]
    v_fma_f32 v126, -v182, v221, v126
    s_waitcnt lgkmcnt(2)
    v_mfma_f32_16x16x32_bf16 v[112:115], a[16:19], v[148:151], v[112:115]
    v_fma_f32 v127, -v183, v221, v127
    s_barrier
    s_waitcnt vmcnt(0)
    v_mfma_f32_16x16x32_bf16 v[40:43], v[128:131], a[24:27], v[40:43]
    v_mul_f32 v64, v17, v64
    v_mul_f32 v65, v17, v65
    v_mfma_f32_16x16x32_bf16 v[44:47], v[128:131], a[28:31], v[44:47]
    v_mul_f32 v66, v17, v66
    v_mul_f32 v67, v17, v67
    v_mfma_f32_16x16x32_bf16 v[60:63], v[132:135], a[28:31], v[60:63]
    v_mul_f32 v80, v17, v80
    v_mul_f32 v81, v17, v81
    v_mfma_f32_16x16x32_bf16 v[56:59], v[132:135], a[24:27], v[56:59]
    v_mul_f32 v82, v17, v82
    v_mul_f32 v83, v17, v83
    v_mfma_f32_16x16x32_bf16 v[72:75], v[136:139], a[24:27], v[72:75]
    v_cvt_pk_bf16_f32 v64, v64, v65
    v_cvt_pk_bf16_f32 v65, v66, v67
    v_mfma_f32_16x16x32_bf16 v[76:79], v[136:139], a[28:31], v[76:79]
    v_cvt_pk_bf16_f32 v66, v80, v81
    v_cvt_pk_bf16_f32 v67, v82, v83
    v_mfma_f32_16x16x32_bf16 v[92:95], v[140:143], a[28:31], v[92:95]
    v_mul_f32 v68, v19, v68
    v_mul_f32 v69, v19, v69
    v_mfma_f32_16x16x32_bf16 v[88:91], v[140:143], a[24:27], v[88:91]
    v_mul_f32 v70, v19, v70
    v_mul_f32 v71, v19, v71
    v_mfma_f32_16x16x32_bf16 v[104:107], a[24:27], v[144:147], v[104:107]
    v_mul_f32 v84, v19, v84
    v_mul_f32 v85, v19, v85
    v_mfma_f32_16x16x32_bf16 v[108:111], a[28:31], v[144:147], v[108:111]
    v_mul_f32 v86, v19, v86
    v_mul_f32 v87, v19, v87
    v_mfma_f32_16x16x32_bf16 v[124:127], a[28:31], v[148:151], v[124:127]
    v_cvt_pk_bf16_f32 v68, v68, v69
    v_cvt_pk_bf16_f32 v69, v70, v71
    v_mfma_f32_16x16x32_bf16 v[120:123], a[24:27], v[148:151], v[120:123]
    v_cvt_pk_bf16_f32 v70, v84, v85
    v_cvt_pk_bf16_f32 v71, v86, v87
    v_mfma_f32_16x16x32_bf16 v[184:187], v[188:191], v[192:195], v[184:187]
    v_pk_mul_f32 v[72:73], v[20:21], v[72:73] op_sel:[1,0] op_sel_hi:[1,1]
    v_pk_mul_f32 v[74:75], v[20:21], v[74:75] op_sel:[1,0] op_sel_hi:[1,1]
    v_pk_mul_f32 v[88:89], v[20:21], v[88:89] op_sel:[1,0] op_sel_hi:[1,1]
    v_pk_mul_f32 v[90:91], v[20:21], v[90:91] op_sel:[1,0] op_sel_hi:[1,1]
    v_cvt_pk_bf16_f32 v72, v72, v73
    v_cvt_pk_bf16_f32 v73, v74, v75
    v_cvt_pk_bf16_f32 v74, v88, v89
    v_cvt_pk_bf16_f32 v75, v90, v91
    v_pk_mul_f32 v[76:77], v[22:23], v[76:77] op_sel:[1,0] op_sel_hi:[1,1]
    v_pk_mul_f32 v[78:79], v[22:23], v[78:79] op_sel:[1,0] op_sel_hi:[1,1]
    v_pk_mul_f32 v[92:93], v[22:23], v[92:93] op_sel:[1,0] op_sel_hi:[1,1]
    v_pk_mul_f32 v[94:95], v[22:23], v[94:95] op_sel:[1,0] op_sel_hi:[1,1]
    v_cvt_pk_bf16_f32 v76, v76, v77
    v_cvt_pk_bf16_f32 v77, v78, v79
    v_cvt_pk_bf16_f32 v78, v92, v93
    v_cvt_pk_bf16_f32 v79, v94, v95
    ds_write_b128 v12, v[76:79] offset:2048
    s_waitcnt lgkmcnt(1)
    v_pk_mul_f32 v[96:97], v[152:153], v[96:97]
    v_pk_mul_f32 v[98:99], v[154:155], v[98:99]
    v_pk_mul_f32 v[112:113], v[152:153], v[112:113]
    v_pk_mul_f32 v[114:115], v[154:155], v[114:115]
    v_cvt_pk_bf16_f32 v99, v98, v99
    v_cvt_pk_bf16_f32 v98, v96, v97
    v_cvt_pk_bf16_f32 v115, v114, v115
    v_cvt_pk_bf16_f32 v114, v112, v113
    v_pk_mul_f32 v[100:101], v[156:157], v[100:101]
    v_pk_mul_f32 v[102:103], v[158:159], v[102:103]
    v_pk_mul_f32 v[116:117], v[156:157], v[116:117]
    v_pk_mul_f32 v[118:119], v[158:159], v[118:119]
    v_cvt_pk_bf16_f32 v100, v100, v101
    v_cvt_pk_bf16_f32 v101, v102, v103
    v_cvt_pk_bf16_f32 v116, v116, v117
    v_cvt_pk_bf16_f32 v117, v118, v119
    v_pk_mul_f32 v[104:105], v[160:161], v[104:105]
    v_pk_mul_f32 v[106:107], v[162:163], v[106:107]
    v_pk_mul_f32 v[120:121], v[160:161], v[120:121]
    v_pk_mul_f32 v[122:123], v[162:163], v[122:123]
    v_cvt_pk_bf16_f32 v102, v104, v105
    v_cvt_pk_bf16_f32 v103, v106, v107
    v_cvt_pk_bf16_f32 v118, v120, v121
    v_cvt_pk_bf16_f32 v119, v122, v123
    v_pk_mul_f32 v[108:109], v[164:165], v[108:109]
    v_pk_mul_f32 v[110:111], v[166:167], v[110:111]
    v_pk_mul_f32 v[124:125], v[164:165], v[124:125]
    v_pk_mul_f32 v[126:127], v[166:167], v[126:127]
    v_cvt_pk_bf16_f32 v104, v108, v109
    v_cvt_pk_bf16_f32 v105, v110, v111
    v_cvt_pk_bf16_f32 v120, v124, v125
    v_cvt_pk_bf16_f32 v121, v126, v127
    ds_write_b64 v12, v[104:105] offset:3072
    ds_write_b64 v12, v[120:121] offset:3080
    v_pk_fma_f32 v[184:185], v[222:223], v[212:213], v[184:185] op_sel_hi:[0,1,1] neg_lo:[1,0,0] neg_hi:[1,0,0]
    v_pk_fma_f32 v[186:187], v[222:223], v[214:215], v[186:187] op_sel_hi:[0,1,1] neg_lo:[1,0,0] neg_hi:[1,0,0]
    v_pk_mul_f32 v[184:185], v[222:223], v[184:185] op_sel:[1,0] op_sel_hi:[1,1]
    v_pk_mul_f32 v[186:187], v[222:223], v[186:187] op_sel:[1,0] op_sel_hi:[1,1]
    v_cvt_pk_bf16_f32 v184, v184, v185
    v_cvt_pk_bf16_f32 v185, v186, v187
    s_cmp_ge_u32 s8, 2
    s_cbranch_scc1 c_qkvA_hv
    ds_write_b64 v13, v[184:185]
    s_branch c_qkvA_hd
c_qkvA_hv:
    ds_write_b16 v13, v184 offset:0
    ds_write_b16_d16_hi v13, v184 offset:16
    ds_write_b16 v13, v185 offset:32
    ds_write_b16_d16_hi v13, v185 offset:48
c_qkvA_hd:
    v_cvt_pk_bf16_f32 v44, v44, v45
    v_cvt_pk_bf16_f32 v45, v46, v47
    v_cvt_pk_bf16_f32 v46, v60, v61
    v_cvt_pk_bf16_f32 v47, v62, v63
    v_mul_f32 v23, 0x3e8293ee, v23
    v_cvt_pk_bf16_f32 v40, v40, v41
    v_mfma_f32_16x16x32_bf16 v[156:159], v[76:79], v[44:47], v[196:199]
    v_cvt_pk_bf16_f32 v41, v42, v43
    v_cvt_pk_bf16_f32 v42, v56, v57
    v_mfma_f32_16x16x32_bf16 v[152:155], v[72:75], v[44:47], v[200:203]
    v_cvt_pk_bf16_f32 v43, v58, v59
    v_mul_f32 v21, 0x3e8293ee, v21
    s_waitcnt lgkmcnt(0)
    s_barrier
    ds_read_b128 v[172:175], v12
    ds_read_b64 v[96:97], v12 offset:1024
    ds_read_b64 v[112:113], v12 offset:1032
    v_mfma_f32_16x16x32_bf16 v[148:151], v[72:75], v[40:43], v[196:199]
    v_cvt_pk_bf16_f32 v36, v36, v37
    v_cvt_pk_bf16_f32 v37, v38, v39
    v_mfma_f32_16x16x32_bf16 v[144:147], v[68:71], v[40:43], v[200:203]
    v_cvt_pk_bf16_f32 v38, v52, v53
    v_cvt_pk_bf16_f32 v39, v54, v55
    v_mul_f32 v19, 0x3e8293ee, v19
    v_cvt_pk_bf16_f32 v32, v32, v33
    v_mfma_f32_16x16x32_bf16 v[140:143], v[68:71], v[36:39], v[196:199]
    v_cvt_pk_bf16_f32 v33, v34, v35
    v_cvt_pk_bf16_f32 v34, v48, v49
    v_mfma_f32_16x16x32_bf16 v[136:139], v[64:67], v[36:39], v[200:203]
    v_cvt_pk_bf16_f32 v35, v50, v51
    v_mul_f32 v17, 0x3e8293ee, v17
    v_max3_f32 v179, v152, v153, v154
    s_waitcnt lgkmcnt(2)
    v_mfma_f32_16x16x32_bf16 v[132:135], v[64:67], v[32:35], v[196:199]
    v_max3_f32 v179, v179, v155, v156
    v_max3_f32 v179, v179, v157, v158
    v_mfma_f32_16x16x32_bf16 v[128:131], v[172:175], v[32:35], v[204:207]
    v_max_f32 v179, v179, v159
    v_mov_b32 v183, v179
    v_max3_f32 v178, v144, v145, v146
    v_max3_f32 v178, v178, v147, v148
    v_max3_f32 v178, v178, v149, v150
    v_max_f32 v178, v178, v151
    v_mov_b32 v182, v178
    v_max3_f32 v177, v136, v137, v138
    v_max3_f32 v177, v177, v139, v140
    v_max3_f32 v177, v177, v141, v142
    v_max_f32 v177, v177, v143
    v_mov_b32 v181, v177
    v_permlane32_swap_b32 v179, v183
    v_permlane32_swap_b32 v178, v182
    v_permlane32_swap_b32 v177, v181
    v_max3_f32 v176, v128, v129, v130
    v_max3_f32 v176, v176, v131, v132
    v_max3_f32 v176, v176, v133, v134
    v_max_f32 v176, v176, v135
    v_mov_b32 v180, v176
    v_max_f32 v179, v179, v183
    v_max_f32 v178, v178, v182
    v_max_f32 v177, v177, v181
    v_permlane32_swap_b32 v176, v180
    v_mov_b32 v183, v179
    v_mov_b32 v182, v178
    v_mov_b32 v181, v177
    v_max_f32 v176, v176, v180
    v_mov_b32 v180, v176
    v_permlane16_swap_b32 v179, v183
    v_permlane16_swap_b32 v178, v182
    v_permlane16_swap_b32 v177, v181
    v_permlane16_swap_b32 v176, v180
    v_max_f32 v179, v179, v183
    v_max_f32 v178, v178, v182
    v_max_f32 v177, v177, v181
    v_max_f32 v176, v176, v180
    v_mul_f32_e64 v22, -v179, v23
    v_mul_f32_e64 v20, -v178, v21
    v_mul_f32_e64 v18, -v177, v19
    v_mul_f32_e64 v16, -v176, v17
    s_waitcnt lgkmcnt(0)
    s_add_u32 s51, s49, 65536
    v_pk_fma_f32 v[152:153], v[152:153], v[22:23], v[22:23] op_sel:[0,1,0] op_sel_hi:[1,1,0]
    v_pk_fma_f32 v[154:155], v[154:155], v[22:23], v[22:23] op_sel:[0,1,0] op_sel_hi:[1,1,0]
    v_pk_fma_f32 v[156:157], v[156:157], v[22:23], v[22:23] op_sel:[0,1,0] op_sel_hi:[1,1,0]
    v_pk_fma_f32 v[158:159], v[158:159], v[22:23], v[22:23] op_sel:[0,1,0] op_sel_hi:[1,1,0]
    v_pk_fma_f32 v[144:145], v[144:145], v[20:21], v[20:21] op_sel:[0,1,0] op_sel_hi:[1,1,0]
    v_pk_fma_f32 v[146:147], v[146:147], v[20:21], v[20:21] op_sel:[0,1,0] op_sel_hi:[1,1,0]
    v_pk_fma_f32 v[148:149], v[148:149], v[20:21], v[20:21] op_sel:[0,1,0] op_sel_hi:[1,1,0]
    v_pk_fma_f32 v[150:151], v[150:151], v[20:21], v[20:21] op_sel:[0,1,0] op_sel_hi:[1,1,0]
    v_pk_fma_f32 v[136:137], v[136:137], v[18:19], v[18:19] op_sel:[0,1,0] op_sel_hi:[1,1,0]
    v_pk_fma_f32 v[138:139], v[138:139], v[18:19], v[18:19] op_sel:[0,1,0] op_sel_hi:[1,1,0]
    v_pk_fma_f32 v[140:141], v[140:141], v[18:19], v[18:19] op_sel:[0,1,0] op_sel_hi:[1,1,0]
    v_pk_fma_f32 v[142:143], v[142:143], v[18:19], v[18:19] op_sel:[0,1,0] op_sel_hi:[1,1,0]
    v_pk_fma_f32 v[128:129], v[128:129], v[16:17], v[16:17] op_sel:[0,1,0] op_sel_hi:[1,1,0]
    v_pk_fma_f32 v[130:131], v[130:131], v[16:17], v[16:17] op_sel:[0,1,0] op_sel_hi:[1,1,0]
    v_pk_fma_f32 v[132:133], v[132:133], v[16:17], v[16:17] op_sel:[0,1,0] op_sel_hi:[1,1,0]
    v_pk_fma_f32 v[134:135], v[134:135], v[16:17], v[16:17] op_sel:[0,1,0] op_sel_hi:[1,1,0]
    v_exp_f32 v152, v152
    v_exp_f32 v153, v153
    v_exp_f32 v154, v154
    v_exp_f32 v155, v155
    v_exp_f32 v156, v156
    v_exp_f32 v157, v157
    v_exp_f32 v158, v158
    v_exp_f32 v159, v159
    v_cvt_pk_bf16_f32 v172, v152, v153
    v_cvt_pk_bf16_f32 v173, v154, v155
    v_cvt_pk_bf16_f32 v174, v156, v157
    v_cvt_pk_bf16_f32 v175, v158, v159
    v_exp_f32 v144, v144
    v_exp_f32 v145, v145
    v_mfma_f32_16x16x32_bf16 v[92:95], v[208:211], v[172:175], 0
    v_exp_f32 v146, v146
    v_mfma_f32_16x16x32_bf16 v[60:63], v[102:105], v[172:175], 0
    v_exp_f32 v147, v147
    v_mfma_f32_16x16x32_bf16 v[76:79], v[118:121], v[172:175], 0
    v_exp_f32 v148, v148
    v_exp_f32 v149, v149
    v_exp_f32 v150, v150
    v_exp_f32 v151, v151
    v_rcp_f32 v92, v92
    v_cvt_pk_bf16_f32 v168, v144, v145
    v_cvt_pk_bf16_f32 v169, v146, v147
    v_cvt_pk_bf16_f32 v170, v148, v149
    v_cvt_pk_bf16_f32 v171, v150, v151
    v_pk_mul_f32 v[60:61], v[92:93], v[60:61] op_sel_hi:[0,1]
    v_pk_mul_f32 v[62:63], v[92:93], v[62:63] op_sel_hi:[0,1]
    v_pk_mul_f32 v[76:77], v[92:93], v[76:77] op_sel_hi:[0,1]
    v_pk_mul_f32 v[78:79], v[92:93], v[78:79] op_sel_hi:[0,1]
    v_cvt_pk_bf16_f32 v60, v60, v61
    v_cvt_pk_bf16_f32 v61, v62, v63
    v_cvt_pk_bf16_f32 v62, v76, v77
    v_cvt_pk_bf16_f32 v63, v78, v79
    buffer_store_dwordx4 v[60:63], v6, s[12:15], s51 offen offset:256 sc1
    v_exp_f32 v136, v136
    v_exp_f32 v137, v137
    v_mfma_f32_16x16x32_bf16 v[88:91], v[208:211], v[168:171], 0
    v_exp_f32 v138, v138
    v_mfma_f32_16x16x32_bf16 v[56:59], v[100:103], v[168:171], 0
    v_exp_f32 v139, v139
    v_mfma_f32_16x16x32_bf16 v[72:75], v[116:119], v[168:171], 0
    v_exp_f32 v140, v140
    v_exp_f32 v141, v141
    v_exp_f32 v142, v142
    v_exp_f32 v143, v143
    v_rcp_f32 v88, v88
    v_cvt_pk_bf16_f32 v164, v136, v137
    v_cvt_pk_bf16_f32 v165, v138, v139
    v_cvt_pk_bf16_f32 v166, v140, v141
    v_cvt_pk_bf16_f32 v167, v142, v143
    v_pk_mul_f32 v[56:57], v[88:89], v[56:57] op_sel_hi:[0,1]
    v_pk_mul_f32 v[58:59], v[88:89], v[58:59] op_sel_hi:[0,1]
    v_pk_mul_f32 v[72:73], v[88:89], v[72:73] op_sel_hi:[0,1]
    v_pk_mul_f32 v[74:75], v[88:89], v[74:75] op_sel_hi:[0,1]
    v_cvt_pk_bf16_f32 v56, v56, v57
    v_cvt_pk_bf16_f32 v57, v58, v59
    v_cvt_pk_bf16_f32 v58, v72, v73
    v_cvt_pk_bf16_f32 v59, v74, v75
    buffer_store_dwordx4 v[56:59], v6, s[12:15], s51 offen offset:0 sc1
    v_exp_f32 v128, v128
    v_exp_f32 v129, v129
    v_mfma_f32_16x16x32_bf16 v[84:87], v[208:211], v[164:167], 0
    v_exp_f32 v130, v130
    v_mfma_f32_16x16x32_bf16 v[52:55], v[98:101], v[164:167], 0
    v_exp_f32 v131, v131
    v_mfma_f32_16x16x32_bf16 v[68:71], v[114:117], v[164:167], 0
    v_exp_f32 v132, v132
    v_exp_f32 v133, v133
    v_exp_f32 v134, v134
    v_exp_f32 v135, v135
    v_rcp_f32 v84, v84
    v_cvt_pk_bf16_f32 v160, v128, v129
    v_cvt_pk_bf16_f32 v161, v130, v131
    v_cvt_pk_bf16_f32 v162, v132, v133
    v_cvt_pk_bf16_f32 v163, v134, v135
    v_pk_mul_f32 v[52:53], v[84:85], v[52:53] op_sel_hi:[0,1]
    v_pk_mul_f32 v[54:55], v[84:85], v[54:55] op_sel_hi:[0,1]
    v_mfma_f32_16x16x32_bf16 v[80:83], v[208:211], v[160:163], 0
    v_pk_mul_f32 v[68:69], v[84:85], v[68:69] op_sel_hi:[0,1]
    v_pk_mul_f32 v[70:71], v[84:85], v[70:71] op_sel_hi:[0,1]
    v_mfma_f32_16x16x32_bf16 v[48:51], v[96:99], v[160:163], 0
    v_cvt_pk_bf16_f32 v52, v52, v53
    v_cvt_pk_bf16_f32 v53, v54, v55
    v_mfma_f32_16x16x32_bf16 v[64:67], v[112:115], v[160:163], 0
    v_cvt_pk_bf16_f32 v54, v68, v69
    v_cvt_pk_bf16_f32 v55, v70, v71
    buffer_store_dwordx4 v[52:55], v6, s[12:15], s49 offen offset:256 sc1
    v_rcp_f32 v80, v80
    s_nop 0
    v_pk_mul_f32 v[48:49], v[80:81], v[48:49] op_sel_hi:[0,1]
    v_pk_mul_f32 v[50:51], v[80:81], v[50:51] op_sel_hi:[0,1]
    s_nop 0
    v_pk_mul_f32 v[64:65], v[80:81], v[64:65] op_sel_hi:[0,1]
    v_pk_mul_f32 v[66:67], v[80:81], v[66:67] op_sel_hi:[0,1]
    v_cvt_pk_bf16_f32 v48, v48, v49
    v_cvt_pk_bf16_f32 v49, v50, v51
    v_cvt_pk_bf16_f32 v50, v64, v65
    v_cvt_pk_bf16_f32 v51, v66, v67
    buffer_store_dwordx4 v[48:51], v6, s[12:15], s49 offen offset:0 sc1
    s_branch c_wo
.p2align 6
c_wo:
    v_and_b32 v1, 63, v0
    v_lshrrev_b32 v2, 6, v0
    v_lshlrev_b32 v5, 4, v1
    v_lshrrev_b32 v3, 5, v1
    s_lshl_b32 s48, s6, 2
    s_add_u32 s48, s48, s8
    s_lshl_b32 s55, s48, 16
    s_lshl_b32 s56, s9, 22
    s_add_u32 s55, s55, s56
    s_lshl_b32 s56, s7, 12
    s_add_u32 s58, s55, s56
    s_add_u32 s55, s55, 16777216
    s_add_u32 s16, s4, s55
    s_addc_u32 s17, s5, 0
    s_mov_b32 s18, 65536
    s_mov_b32 s19, 0x00020000
    s_lshl_b32 s60, s9, 2
    s_add_u32 s60, s60, 159504
    v_mov_b32 v28, s60
    s_mul_i32 s55, s9, 786432
    s_add_u32 s55, s55, 65798144
    v_and_b32 v24, 63, v0
    s_and_b32 s56, s11, 0xe0
    v_lshrrev_b32 v25, 5, v24
    v_add_u32 v24, s56, v24
    v_and_b32 v24, 255, v24
    v_lshlrev_b32 v24, 10, v24
    v_lshl_add_u32 v24, v25, 8, v24
    s_bfe_u32 s56, s11, 0x20003
    s_and_b32 s57, s11, 7
    s_lshl_b32 s56, s56, 7
    s_lshl_b32 s57, s57, 2
    s_add_u32 s55, s55, s56
    s_add_u32 s55, s55, s57
    v_mov_b32 v25, 159488
    v_mov_b32 v26, 1
    v_mov_b32 v27, s10
    v_and_b32 v4, 15, v0
    v_bfe_u32 v17, v1, 4, 1
    v_lshl_add_u32 v6, v17, 5, v4
    v_lshlrev_b32 v6, 4, v6
    v_lshl_add_u32 v6, v3, 10, v6
    v_lshrrev_b32 v16, 2, v4
    v_lshl_add_u32 v16, v17, 2, v16
    v_lshl_add_u32 v16, v3, 4, v16
    v_lshlrev_b32 v16, 7, v16
    v_and_b32 v18, 3, v4
    v_lshl_add_u32 v16, v18, 3, v16
    v_lshrrev_b32 v18, 3, v4
    v_lshl_add_u32 v18, v18, 1, v17
    v_lshl_add_u32 v12, v18, 5, v16
    ds_read_b32 v29, v28
    buffer_load_dwordx4 v[96:99], v6, s[12:15], s58 offen offset:0 sc1
    buffer_load_dwordx4 v[100:103], v6, s[12:15], s58 offen offset:256 sc1
    buffer_load_dwordx4 v[104:107], v6, s[12:15], s58 offen offset:2048 sc1
    buffer_load_dwordx4 v[108:111], v6, s[12:15], s58 offen offset:2304 sc1
    s_waitcnt lgkmcnt(0)
    v_readfirstlane_b32 s60, v29
    s_lshr_b32 s51, s60, 2
    s_and_b32 s51, s51, s60
    s_and_b32 s51, s51, 3
    s_cmp_eq_u32 s51, 0
    s_cbranch_scc1 c_wo_late
    s_and_b32 s52, s51, 1
    s_xor_b32 s52, s52, 1
    s_lshl_b32 s50, s52, 15
    buffer_load_dwordx4 v[112:115], v6, s[16:19], s50 offen offset:0 sc1
    buffer_load_dwordx4 v[116:119], v6, s[16:19], s50 offen offset:256 sc1
    buffer_load_dwordx4 v[120:123], v6, s[16:19], s50 offen offset:2048 sc1
    buffer_load_dwordx4 v[124:127], v6, s[16:19], s50 offen offset:2304 sc1
    s_add_u32 s50, s50, 4096
    buffer_load_dwordx4 v[128:131], v6, s[16:19], s50 offen offset:0 sc1
    s_mov_b64 exec, 1
    s_waitcnt vmcnt(9)
    ds_add_rtn_u32 v26, v25, v26
    s_waitcnt lgkmcnt(0)
    v_readfirstlane_b32 s56, v26
    s_and_b32 s56, s56, 3
    s_cmp_lg_u32 s56, 3
    s_cbranch_scc1 pub_2
    s_mov_b32 exec_lo, -1
    buffer_store_dword v27, v24, s[12:15], s55 offen sc1
pub_2:
    s_mov_b64 exec, -1
    s_branch c_wo_run
c_wo_late:
    s_mov_b64 exec, 1
    s_waitcnt vmcnt(4)
    ds_add_rtn_u32 v26, v25, v26
    s_waitcnt lgkmcnt(0)
    v_readfirstlane_b32 s56, v26
    s_and_b32 s56, s56, 3
    s_cmp_lg_u32 s56, 3
    s_cbranch_scc1 pub_3
    s_mov_b32 exec_lo, -1
    buffer_store_dword v27, v24, s[12:15], s55 offen sc1
pub_3:
    s_mov_b64 exec, -1
    s_branch wp_4_t
wp_4:
    ds_read_b32 v29, v28
    s_waitcnt lgkmcnt(0)
    v_readfirstlane_b32 s60, v29
    s_lshr_b32 s51, s60, 2
    s_and_b32 s51, s51, s60
    s_and_b32 s51, s51, 3
wp_4_t:
    s_cmp_lg_u32 s51, 0
    s_cbranch_scc0 wp_4
    s_and_b32 s52, s51, 1
    s_xor_b32 s52, s52, 1
    s_lshl_b32 s50, s52, 15
    buffer_load_dwordx4 v[112:115], v6, s[16:19], s50 offen offset:0 sc1
    buffer_load_dwordx4 v[116:119], v6, s[16:19], s50 offen offset:256 sc1
    buffer_load_dwordx4 v[120:123], v6, s[16:19], s50 offen offset:2048 sc1
    buffer_load_dwordx4 v[124:127], v6, s[16:19], s50 offen offset:2304 sc1
    s_add_u32 s50, s50, 4096
    buffer_load_dwordx4 v[128:131], v6, s[16:19], s50 offen offset:0 sc1
c_wo_run:
    buffer_load_dwordx4 v[132:135], v6, s[16:19], s50 offen offset:256 sc1
    buffer_load_dwordx4 v[136:139], v6, s[16:19], s50 offen offset:2048 sc1
    buffer_load_dwordx4 v[140:143], v6, s[16:19], s50 offen offset:2304 sc1
    s_add_u32 s50, s50, 4096
    s_lshl_b32 s3, s52, 16
    v_add_u32 v12, s3, v12
    v_xor_b32 v13, 32, v12
    v_xor_b32 v14, 64, v12
    v_xor_b32 v15, 96, v12
    s_cmp_eq_u32 s52, 0
    s_mov_b32 s3, 0x0c0c0c0c
    s_cselect_b32 s53, 0x01000c0c, s3
    s_cselect_b32 s54, 0x03020c0c, s3
    s_cselect_b32 s59, s3, 0x01000c0c
    s_cselect_b32 s97, s3, 0x03020c0c
    s_branch wp_5_t
wp_5:
    ds_read_b32 v29, v28
    s_waitcnt lgkmcnt(0)
    v_readfirstlane_b32 s60, v29
    s_lshr_b32 s51, s60, 2
    s_and_b32 s51, s51, s60
    s_and_b32 s51, s51, 3
wp_5_t:
    s_cmp_ge_u32 s60, 0xf0
    s_cbranch_scc0 wp_5
    ds_read_b64_tr_b16 v[64:65], v12 offset:0
    ds_read_b64_tr_b16 v[66:67], v12 offset:1024
    ds_read_b64_tr_b16 v[68:69], v13 offset:0
    ds_read_b64_tr_b16 v[70:71], v13 offset:1024
    ds_read_b64_tr_b16 v[72:73], v14 offset:0
    ds_read_b64_tr_b16 v[74:75], v14 offset:1024
    ds_read_b64_tr_b16 v[76:77], v15 offset:0
    ds_read_b64_tr_b16 v[78:79], v15 offset:1024
    ds_read_b64_tr_b16 v[80:81], v12 offset:4096
    ds_read_b64_tr_b16 v[82:83], v12 offset:5120
    ds_read_b64_tr_b16 v[84:85], v13 offset:4096
    ds_read_b64_tr_b16 v[86:87], v13 offset:5120
    ds_read_b64_tr_b16 v[88:89], v14 offset:4096
    ds_read_b64_tr_b16 v[90:91], v14 offset:5120
    s_waitcnt vmcnt(8)
    v_perm_b32 v32, v96, v96, s53
    v_perm_b32 v33, v96, v96, s54
    v_perm_b32 v34, v97, v97, s53
    v_perm_b32 v35, v97, v97, s54
    v_perm_b32 v36, v98, v98, s53
    v_perm_b32 v37, v98, v98, s54
    v_perm_b32 v38, v99, v99, s53
    v_perm_b32 v39, v99, v99, s54
    v_perm_b32 v40, v100, v100, s53
    v_perm_b32 v41, v100, v100, s54
    v_perm_b32 v42, v101, v101, s53
    v_perm_b32 v43, v101, v101, s54
    v_perm_b32 v44, v102, v102, s53
    v_perm_b32 v45, v102, v102, s54
    v_perm_b32 v46, v103, v103, s53
    v_perm_b32 v47, v103, v103, s54
    v_perm_b32 v48, v104, v104, s53
    v_perm_b32 v49, v104, v104, s54
    v_perm_b32 v50, v105, v105, s53
    v_perm_b32 v51, v105, v105, s54
    v_perm_b32 v52, v106, v106, s53
    v_perm_b32 v53, v106, v106, s54
    v_perm_b32 v54, v107, v107, s53
    v_perm_b32 v55, v107, v107, s54
    v_perm_b32 v56, v108, v108, s53
    v_perm_b32 v57, v108, v108, s54
    v_perm_b32 v58, v109, v109, s53
    v_perm_b32 v59, v109, v109, s54
    v_perm_b32 v60, v110, v110, s53
    v_perm_b32 v61, v110, v110, s54
    v_perm_b32 v62, v111, v111, s53
    v_perm_b32 v63, v111, v111, s54
    buffer_load_dwordx4 v[144:147], v6, s[16:19], s50 offen offset:0 sc1
    buffer_load_dwordx4 v[148:151], v6, s[16:19], s50 offen offset:256 sc1
    buffer_load_dwordx4 v[152:155], v6, s[16:19], s50 offen offset:2048 sc1
    buffer_load_dwordx4 v[156:159], v6, s[16:19], s50 offen offset:2304 sc1
    s_add_u32 s50, s50, 4096
    buffer_load_dwordx4 v[160:163], v6, s[16:19], s50 offen offset:0 sc1
    buffer_load_dwordx4 v[164:167], v6, s[16:19], s50 offen offset:256 sc1
    s_waitcnt vmcnt(12) lgkmcnt(10)
    v_mfma_f32_16x16x32_bf16 v[32:35], v[64:67], v[112:115], v[32:35]
    ds_read_b64_tr_b16 v[92:93], v15 offset:4096
    v_mfma_f32_16x16x32_bf16 v[40:43], v[64:67], v[116:119], v[40:43]
    ds_read_b64_tr_b16 v[94:95], v15 offset:5120
    v_perm_b32 v176, v96, v96, s59
    v_mfma_f32_16x16x32_bf16 v[44:47], v[68:71], v[116:119], v[44:47]
    ds_read_b64_tr_b16 v[64:65], v12 offset:8192
    buffer_load_dwordx4 v[168:171], v6, s[16:19], s50 offen offset:2048 sc1
    v_mfma_f32_16x16x32_bf16 v[36:39], v[68:71], v[112:115], v[36:39]
    ds_read_b64_tr_b16 v[66:67], v12 offset:9216
    v_perm_b32 v177, v96, v96, s97
    s_waitcnt lgkmcnt(10)
    v_mfma_f32_16x16x32_bf16 v[48:51], v[72:75], v[112:115], v[48:51]
    ds_read_b64_tr_b16 v[68:69], v13 offset:8192
    v_mfma_f32_16x16x32_bf16 v[56:59], v[72:75], v[116:119], v[56:59]
    ds_read_b64_tr_b16 v[70:71], v13 offset:9216
    v_perm_b32 v178, v97, v97, s59
    v_mfma_f32_16x16x32_bf16 v[60:63], v[76:79], v[116:119], v[60:63]
    ds_read_b64_tr_b16 v[72:73], v14 offset:8192
    buffer_load_dwordx4 v[172:175], v6, s[16:19], s50 offen offset:2304 sc1
    s_add_u32 s50, s50, 4096
    v_mfma_f32_16x16x32_bf16 v[52:55], v[76:79], v[112:115], v[52:55]
    ds_read_b64_tr_b16 v[74:75], v14 offset:9216
    s_waitcnt vmcnt(12) lgkmcnt(10)
    v_mfma_f32_16x16x32_bf16 v[32:35], v[80:83], v[120:123], v[32:35]
    ds_read_b64_tr_b16 v[76:77], v15 offset:8192
    v_mfma_f32_16x16x32_bf16 v[40:43], v[80:83], v[124:127], v[40:43]
    ds_read_b64_tr_b16 v[78:79], v15 offset:9216
    v_perm_b32 v179, v97, v97, s97
    v_mfma_f32_16x16x32_bf16 v[44:47], v[84:87], v[124:127], v[44:47]
    ds_read_b64_tr_b16 v[80:81], v12 offset:12288
    buffer_load_dwordx4 v[112:115], v6, s[16:19], s50 offen offset:0 sc1
    v_mfma_f32_16x16x32_bf16 v[36:39], v[84:87], v[120:123], v[36:39]
    ds_read_b64_tr_b16 v[82:83], v12 offset:13312
    v_perm_b32 v180, v98, v98, s59
    s_waitcnt lgkmcnt(10)
    v_mfma_f32_16x16x32_bf16 v[48:51], v[88:91], v[120:123], v[48:51]
    ds_read_b64_tr_b16 v[84:85], v13 offset:12288
    v_mfma_f32_16x16x32_bf16 v[56:59], v[88:91], v[124:127], v[56:59]
    ds_read_b64_tr_b16 v[86:87], v13 offset:13312
    v_perm_b32 v181, v98, v98, s97
    v_mfma_f32_16x16x32_bf16 v[60:63], v[92:95], v[124:127], v[60:63]
    ds_read_b64_tr_b16 v[88:89], v14 offset:12288
    buffer_load_dwordx4 v[116:119], v6, s[16:19], s50 offen offset:256 sc1
    v_mfma_f32_16x16x32_bf16 v[52:55], v[92:95], v[120:123], v[52:55]
    ds_read_b64_tr_b16 v[90:91], v14 offset:13312
    s_waitcnt vmcnt(12) lgkmcnt(10)
    v_mfma_f32_16x16x32_bf16 v[32:35], v[64:67], v[128:131], v[32:35]
    ds_read_b64_tr_b16 v[92:93], v15 offset:12288
    v_mfma_f32_16x16x32_bf16 v[40:43], v[64:67], v[132:135], v[40:43]
    ds_read_b64_tr_b16 v[94:95], v15 offset:13312
    v_perm_b32 v182, v99, v99, s59
    v_mfma_f32_16x16x32_bf16 v[44:47], v[68:71], v[132:135], v[44:47]
    ds_read_b64_tr_b16 v[64:65], v12 offset:16384
    buffer_load_dwordx4 v[120:123], v6, s[16:19], s50 offen offset:2048 sc1
    v_mfma_f32_16x16x32_bf16 v[36:39], v[68:71], v[128:131], v[36:39]
    ds_read_b64_tr_b16 v[66:67], v12 offset:17408
    v_perm_b32 v183, v99, v99, s97
    s_waitcnt lgkmcnt(10)
    v_mfma_f32_16x16x32_bf16 v[48:51], v[72:75], v[128:131], v[48:51]
    ds_read_b64_tr_b16 v[68:69], v13 offset:16384
    v_mfma_f32_16x16x32_bf16 v[56:59], v[72:75], v[132:135], v[56:59]
    ds_read_b64_tr_b16 v[70:71], v13 offset:17408
    v_perm_b32 v184, v100, v100, s59
    v_mfma_f32_16x16x32_bf16 v[60:63], v[76:79], v[132:135], v[60:63]
    ds_read_b64_tr_b16 v[72:73], v14 offset:16384
    buffer_load_dwordx4 v[124:127], v6, s[16:19], s50 offen offset:2304 sc1
    s_add_u32 s50, s50, 4096
    v_mfma_f32_16x16x32_bf16 v[52:55], v[76:79], v[128:131], v[52:55]
    ds_read_b64_tr_b16 v[74:75], v14 offset:17408
    s_waitcnt vmcnt(12) lgkmcnt(10)
    v_mfma_f32_16x16x32_bf16 v[32:35], v[80:83], v[136:139], v[32:35]
    ds_read_b64_tr_b16 v[76:77], v15 offset:16384
    v_mfma_f32_16x16x32_bf16 v[40:43], v[80:83], v[140:143], v[40:43]
    ds_read_b64_tr_b16 v[78:79], v15 offset:17408
    v_perm_b32 v185, v100, v100, s97
    v_mfma_f32_16x16x32_bf16 v[44:47], v[84:87], v[140:143], v[44:47]
    ds_read_b64_tr_b16 v[80:81], v12 offset:20480
    buffer_load_dwordx4 v[128:131], v6, s[16:19], s50 offen offset:0 sc1
    v_mfma_f32_16x16x32_bf16 v[36:39], v[84:87], v[136:139], v[36:39]
    ds_read_b64_tr_b16 v[82:83], v12 offset:21504
    v_perm_b32 v186, v101, v101, s59
    s_waitcnt lgkmcnt(10)
    v_mfma_f32_16x16x32_bf16 v[48:51], v[88:91], v[136:139], v[48:51]
    ds_read_b64_tr_b16 v[84:85], v13 offset:20480
    v_mfma_f32_16x16x32_bf16 v[56:59], v[88:91], v[140:143], v[56:59]
    ds_read_b64_tr_b16 v[86:87], v13 offset:21504
    v_perm_b32 v187, v101, v101, s97
    v_mfma_f32_16x16x32_bf16 v[60:63], v[92:95], v[140:143], v[60:63]
    ds_read_b64_tr_b16 v[88:89], v14 offset:20480
    buffer_load_dwordx4 v[132:135], v6, s[16:19], s50 offen offset:256 sc1
    v_mfma_f32_16x16x32_bf16 v[52:55], v[92:95], v[136:139], v[52:55]
    ds_read_b64_tr_b16 v[90:91], v14 offset:21504
    s_waitcnt vmcnt(12) lgkmcnt(10)
    v_mfma_f32_16x16x32_bf16 v[32:35], v[64:67], v[144:147], v[32:35]
    ds_read_b64_tr_b16 v[92:93], v15 offset:20480
    v_mfma_f32_16x16x32_bf16 v[40:43], v[64:67], v[148:151], v[40:43]
    ds_read_b64_tr_b16 v[94:95], v15 offset:21504
    v_perm_b32 v188, v102, v102, s59
    v_mfma_f32_16x16x32_bf16 v[44:47], v[68:71], v[148:151], v[44:47]
    ds_read_b64_tr_b16 v[64:65], v12 offset:24576
    buffer_load_dwordx4 v[136:139], v6, s[16:19], s50 offen offset:2048 sc1
    v_mfma_f32_16x16x32_bf16 v[36:39], v[68:71], v[144:147], v[36:39]
    ds_read_b64_tr_b16 v[66:67], v12 offset:25600
    v_perm_b32 v189, v102, v102, s97
    s_waitcnt lgkmcnt(10)
    v_mfma_f32_16x16x32_bf16 v[48:51], v[72:75], v[144:147], v[48:51]
    ds_read_b64_tr_b16 v[68:69], v13 offset:24576
    v_mfma_f32_16x16x32_bf16 v[56:59], v[72:75], v[148:151], v[56:59]
    ds_read_b64_tr_b16 v[70:71], v13 offset:25600
    v_perm_b32 v190, v103, v103, s59
    v_mfma_f32_16x16x32_bf16 v[60:63], v[76:79], v[148:151], v[60:63]
    ds_read_b64_tr_b16 v[72:73], v14 offset:24576
    buffer_load_dwordx4 v[140:143], v6, s[16:19], s50 offen offset:2304 sc1
    s_add_u32 s50, s50, 4096
    v_mfma_f32_16x16x32_bf16 v[52:55], v[76:79], v[144:147], v[52:55]
    ds_read_b64_tr_b16 v[74:75], v14 offset:25600
    s_waitcnt vmcnt(12) lgkmcnt(10)
    v_mfma_f32_16x16x32_bf16 v[32:35], v[80:83], v[152:155], v[32:35]
    ds_read_b64_tr_b16 v[76:77], v15 offset:24576
    v_mfma_f32_16x16x32_bf16 v[40:43], v[80:83], v[156:159], v[40:43]
    ds_read_b64_tr_b16 v[78:79], v15 offset:25600
    v_perm_b32 v191, v103, v103, s97
    v_mfma_f32_16x16x32_bf16 v[44:47], v[84:87], v[156:159], v[44:47]
    ds_read_b64_tr_b16 v[80:81], v12 offset:28672
    buffer_load_dwordx4 v[144:147], v6, s[16:19], s50 offen offset:0 sc1
    v_mfma_f32_16x16x32_bf16 v[36:39], v[84:87], v[152:155], v[36:39]
    ds_read_b64_tr_b16 v[82:83], v12 offset:29696
    v_perm_b32 v192, v104, v104, s59
    s_waitcnt lgkmcnt(10)
    v_mfma_f32_16x16x32_bf16 v[48:51], v[88:91], v[152:155], v[48:51]
    ds_read_b64_tr_b16 v[84:85], v13 offset:28672
    v_mfma_f32_16x16x32_bf16 v[56:59], v[88:91], v[156:159], v[56:59]
    ds_read_b64_tr_b16 v[86:87], v13 offset:29696
    v_perm_b32 v193, v104, v104, s97
    v_mfma_f32_16x16x32_bf16 v[60:63], v[92:95], v[156:159], v[60:63]
    ds_read_b64_tr_b16 v[88:89], v14 offset:28672
    buffer_load_dwordx4 v[148:151], v6, s[16:19], s50 offen offset:256 sc1
    v_mfma_f32_16x16x32_bf16 v[52:55], v[92:95], v[152:155], v[52:55]
    ds_read_b64_tr_b16 v[90:91], v14 offset:29696
    s_waitcnt vmcnt(12) lgkmcnt(10)
    v_mfma_f32_16x16x32_bf16 v[32:35], v[64:67], v[160:163], v[32:35]
    ds_read_b64_tr_b16 v[92:93], v15 offset:28672
    v_mfma_f32_16x16x32_bf16 v[40:43], v[64:67], v[164:167], v[40:43]
    ds_read_b64_tr_b16 v[94:95], v15 offset:29696
    v_perm_b32 v194, v105, v105, s59
    v_mfma_f32_16x16x32_bf16 v[44:47], v[68:71], v[164:167], v[44:47]
    ds_read_b64_tr_b16 v[64:65], v12 offset:32768
    buffer_load_dwordx4 v[152:155], v6, s[16:19], s50 offen offset:2048 sc1
    v_mfma_f32_16x16x32_bf16 v[36:39], v[68:71], v[160:163], v[36:39]
    ds_read_b64_tr_b16 v[66:67], v12 offset:33792
    v_perm_b32 v195, v105, v105, s97
    s_waitcnt lgkmcnt(10)
    v_mfma_f32_16x16x32_bf16 v[48:51], v[72:75], v[160:163], v[48:51]
    ds_read_b64_tr_b16 v[68:69], v13 offset:32768
    v_mfma_f32_16x16x32_bf16 v[56:59], v[72:75], v[164:167], v[56:59]
    ds_read_b64_tr_b16 v[70:71], v13 offset:33792
    v_perm_b32 v196, v106, v106, s59
    v_mfma_f32_16x16x32_bf16 v[60:63], v[76:79], v[164:167], v[60:63]
    ds_read_b64_tr_b16 v[72:73], v14 offset:32768
    buffer_load_dwordx4 v[156:159], v6, s[16:19], s50 offen offset:2304 sc1
    s_add_u32 s50, s50, 4096
    v_mfma_f32_16x16x32_bf16 v[52:55], v[76:79], v[160:163], v[52:55]
    ds_read_b64_tr_b16 v[74:75], v14 offset:33792
    s_waitcnt vmcnt(12) lgkmcnt(10)
    v_mfma_f32_16x16x32_bf16 v[32:35], v[80:83], v[168:171], v[32:35]
    ds_read_b64_tr_b16 v[76:77], v15 offset:32768
    v_mfma_f32_16x16x32_bf16 v[40:43], v[80:83], v[172:175], v[40:43]
    ds_read_b64_tr_b16 v[78:79], v15 offset:33792
    v_perm_b32 v197, v106, v106, s97
    v_mfma_f32_16x16x32_bf16 v[44:47], v[84:87], v[172:175], v[44:47]
    ds_read_b64_tr_b16 v[80:81], v12 offset:36864
    buffer_load_dwordx4 v[160:163], v6, s[16:19], s50 offen offset:0 sc1
    v_mfma_f32_16x16x32_bf16 v[36:39], v[84:87], v[168:171], v[36:39]
    ds_read_b64_tr_b16 v[82:83], v12 offset:37888
    v_perm_b32 v198, v107, v107, s59
    s_waitcnt lgkmcnt(10)
    v_mfma_f32_16x16x32_bf16 v[48:51], v[88:91], v[168:171], v[48:51]
    ds_read_b64_tr_b16 v[84:85], v13 offset:36864
    v_mfma_f32_16x16x32_bf16 v[56:59], v[88:91], v[172:175], v[56:59]
    ds_read_b64_tr_b16 v[86:87], v13 offset:37888
    v_perm_b32 v199, v107, v107, s97
    v_mfma_f32_16x16x32_bf16 v[60:63], v[92:95], v[172:175], v[60:63]
    ds_read_b64_tr_b16 v[88:89], v14 offset:36864
    buffer_load_dwordx4 v[164:167], v6, s[16:19], s50 offen offset:256 sc1
    v_mfma_f32_16x16x32_bf16 v[52:55], v[92:95], v[168:171], v[52:55]
    ds_read_b64_tr_b16 v[90:91], v14 offset:37888
    s_waitcnt vmcnt(12) lgkmcnt(10)
    v_mfma_f32_16x16x32_bf16 v[32:35], v[64:67], v[112:115], v[32:35]
    ds_read_b64_tr_b16 v[92:93], v15 offset:36864
    v_mfma_f32_16x16x32_bf16 v[40:43], v[64:67], v[116:119], v[40:43]
    ds_read_b64_tr_b16 v[94:95], v15 offset:37888
    v_perm_b32 v200, v108, v108, s59
    v_mfma_f32_16x16x32_bf16 v[44:47], v[68:71], v[116:119], v[44:47]
    ds_read_b64_tr_b16 v[64:65], v12 offset:40960
    buffer_load_dwordx4 v[168:171], v6, s[16:19], s50 offen offset:2048 sc1
    v_mfma_f32_16x16x32_bf16 v[36:39], v[68:71], v[112:115], v[36:39]
    ds_read_b64_tr_b16 v[66:67], v12 offset:41984
    v_perm_b32 v201, v108, v108, s97
    s_waitcnt lgkmcnt(10)
    v_mfma_f32_16x16x32_bf16 v[48:51], v[72:75], v[112:115], v[48:51]
    ds_read_b64_tr_b16 v[68:69], v13 offset:40960
    v_mfma_f32_16x16x32_bf16 v[56:59], v[72:75], v[116:119], v[56:59]
    ds_read_b64_tr_b16 v[70:71], v13 offset:41984
    v_perm_b32 v202, v109, v109, s59
    v_mfma_f32_16x16x32_bf16 v[60:63], v[76:79], v[116:119], v[60:63]
    ds_read_b64_tr_b16 v[72:73], v14 offset:40960
    buffer_load_dwordx4 v[172:175], v6, s[16:19], s50 offen offset:2304 sc1
    s_add_u32 s50, s50, 4096
    v_mfma_f32_16x16x32_bf16 v[52:55], v[76:79], v[112:115], v[52:55]
    ds_read_b64_tr_b16 v[74:75], v14 offset:41984
    s_waitcnt vmcnt(12) lgkmcnt(10)
    v_mfma_f32_16x16x32_bf16 v[32:35], v[80:83], v[120:123], v[32:35]
    ds_read_b64_tr_b16 v[76:77], v15 offset:40960
    v_mfma_f32_16x16x32_bf16 v[40:43], v[80:83], v[124:127], v[40:43]
    ds_read_b64_tr_b16 v[78:79], v15 offset:41984
    v_perm_b32 v203, v109, v109, s97
    v_mfma_f32_16x16x32_bf16 v[44:47], v[84:87], v[124:127], v[44:47]
    ds_read_b64_tr_b16 v[80:81], v12 offset:45056
    s_branch wp_6_t
wp_6:
    ds_read_b32 v29, v28
    s_waitcnt lgkmcnt(0)
    v_readfirstlane_b32 s60, v29
    s_lshr_b32 s51, s60, 2
    s_and_b32 s51, s51, s60
    s_and_b32 s51, s51, 3
wp_6_t:
    s_cmp_eq_u32 s51, 3
    s_cbranch_scc0 wp_6
    s_lshl_b32 s50, s52, 15
    s_xor_b32 s50, s50, 32768
    buffer_load_dwordx4 v[112:115], v6, s[16:19], s50 offen offset:0 sc1
    v_mfma_f32_16x16x32_bf16 v[36:39], v[84:87], v[120:123], v[36:39]
    ds_read_b64_tr_b16 v[82:83], v12 offset:46080
    v_perm_b32 v204, v110, v110, s59
    s_waitcnt lgkmcnt(10)
    v_mfma_f32_16x16x32_bf16 v[48:51], v[88:91], v[120:123], v[48:51]
    ds_read_b64_tr_b16 v[84:85], v13 offset:45056
    v_mfma_f32_16x16x32_bf16 v[56:59], v[88:91], v[124:127], v[56:59]
    ds_read_b64_tr_b16 v[86:87], v13 offset:46080
    v_perm_b32 v205, v110, v110, s97
    v_mfma_f32_16x16x32_bf16 v[60:63], v[92:95], v[124:127], v[60:63]
    ds_read_b64_tr_b16 v[88:89], v14 offset:45056
    buffer_load_dwordx4 v[116:119], v6, s[16:19], s50 offen offset:256 sc1
    v_mfma_f32_16x16x32_bf16 v[52:55], v[92:95], v[120:123], v[52:55]
    ds_read_b64_tr_b16 v[90:91], v14 offset:46080
    s_waitcnt vmcnt(12) lgkmcnt(10)
    v_mfma_f32_16x16x32_bf16 v[32:35], v[64:67], v[128:131], v[32:35]
    ds_read_b64_tr_b16 v[92:93], v15 offset:45056
    v_mfma_f32_16x16x32_bf16 v[40:43], v[64:67], v[132:135], v[40:43]
    ds_read_b64_tr_b16 v[94:95], v15 offset:46080
    v_perm_b32 v206, v111, v111, s59
    v_mfma_f32_16x16x32_bf16 v[44:47], v[68:71], v[132:135], v[44:47]
    ds_read_b64_tr_b16 v[64:65], v12 offset:49152
    buffer_load_dwordx4 v[120:123], v6, s[16:19], s50 offen offset:2048 sc1
    v_mfma_f32_16x16x32_bf16 v[36:39], v[68:71], v[128:131], v[36:39]
    ds_read_b64_tr_b16 v[66:67], v12 offset:50176
    v_perm_b32 v207, v111, v111, s97
    s_waitcnt lgkmcnt(10)
    v_mfma_f32_16x16x32_bf16 v[48:51], v[72:75], v[128:131], v[48:51]
    ds_read_b64_tr_b16 v[68:69], v13 offset:49152
    v_mfma_f32_16x16x32_bf16 v[56:59], v[72:75], v[132:135], v[56:59]
    ds_read_b64_tr_b16 v[70:71], v13 offset:50176
    v_mul_u32_u24 v8, 144, v4
    v_mfma_f32_16x16x32_bf16 v[60:63], v[76:79], v[132:135], v[60:63]
    ds_read_b64_tr_b16 v[72:73], v14 offset:49152
    buffer_load_dwordx4 v[124:127], v6, s[16:19], s50 offen offset:2304 sc1
    s_add_u32 s50, s50, 4096
    v_mfma_f32_16x16x32_bf16 v[52:55], v[76:79], v[128:131], v[52:55]
    ds_read_b64_tr_b16 v[74:75], v14 offset:50176
    s_waitcnt vmcnt(12) lgkmcnt(10)
    v_mfma_f32_16x16x32_bf16 v[32:35], v[80:83], v[136:139], v[32:35]
    ds_read_b64_tr_b16 v[76:77], v15 offset:49152
    v_mfma_f32_16x16x32_bf16 v[40:43], v[80:83], v[140:143], v[40:43]
    ds_read_b64_tr_b16 v[78:79], v15 offset:50176
    v_lshrrev_b32 v11, 4, v1
    v_mfma_f32_16x16x32_bf16 v[44:47], v[84:87], v[140:143], v[44:47]
    ds_read_b64_tr_b16 v[80:81], v12 offset:53248
    buffer_load_dwordx4 v[128:131], v6, s[16:19], s50 offen offset:0 sc1
    v_mfma_f32_16x16x32_bf16 v[36:39], v[84:87], v[136:139], v[36:39]
    ds_read_b64_tr_b16 v[82:83], v12 offset:54272
    v_lshl_add_u32 v8, v11, 3, v8
    s_waitcnt lgkmcnt(10)
    v_mfma_f32_16x16x32_bf16 v[48:51], v[88:91], v[136:139], v[48:51]
    ds_read_b64_tr_b16 v[84:85], v13 offset:53248
    v_mfma_f32_16x16x32_bf16 v[56:59], v[88:91], v[140:143], v[56:59]
    ds_read_b64_tr_b16 v[86:87], v13 offset:54272
    v_mul_u32_u24 v7, 4608, v2
    v_mfma_f32_16x16x32_bf16 v[60:63], v[92:95], v[140:143], v[60:63]
    ds_read_b64_tr_b16 v[88:89], v14 offset:53248
    buffer_load_dwordx4 v[132:135], v6, s[16:19], s50 offen offset:256 sc1
    v_mfma_f32_16x16x32_bf16 v[52:55], v[92:95], v[136:139], v[52:55]
    ds_read_b64_tr_b16 v[90:91], v14 offset:54272
    s_waitcnt vmcnt(12) lgkmcnt(10)
    v_mfma_f32_16x16x32_bf16 v[32:35], v[64:67], v[144:147], v[32:35]
    ds_read_b64_tr_b16 v[92:93], v15 offset:53248
    v_mfma_f32_16x16x32_bf16 v[40:43], v[64:67], v[148:151], v[40:43]
    ds_read_b64_tr_b16 v[94:95], v15 offset:54272
    v_add_u32 v7, 131072, v7
    v_mfma_f32_16x16x32_bf16 v[44:47], v[68:71], v[148:151], v[44:47]
    ds_read_b64_tr_b16 v[64:65], v12 offset:57344
    buffer_load_dwordx4 v[136:139], v6, s[16:19], s50 offen offset:2048 sc1
    v_mfma_f32_16x16x32_bf16 v[36:39], v[68:71], v[144:147], v[36:39]
    ds_read_b64_tr_b16 v[66:67], v12 offset:58368
    v_add_u32 v8, v8, v7
    s_waitcnt lgkmcnt(10)
    v_mfma_f32_16x16x32_bf16 v[48:51], v[72:75], v[144:147], v[48:51]
    ds_read_b64_tr_b16 v[68:69], v13 offset:57344
    v_mfma_f32_16x16x32_bf16 v[56:59], v[72:75], v[148:151], v[56:59]
    ds_read_b64_tr_b16 v[70:71], v13 offset:58368
    v_lshrrev_b32 v10, 3, v1
    v_mfma_f32_16x16x32_bf16 v[60:63], v[76:79], v[148:151], v[60:63]
    ds_read_b64_tr_b16 v[72:73], v14 offset:57344
    buffer_load_dwordx4 v[140:143], v6, s[16:19], s50 offen offset:2304 sc1
    s_add_u32 s50, s50, 4096
    v_mfma_f32_16x16x32_bf16 v[52:55], v[76:79], v[144:147], v[52:55]
    ds_read_b64_tr_b16 v[74:75], v14 offset:58368
    s_waitcnt vmcnt(12) lgkmcnt(10)
    v_mfma_f32_16x16x32_bf16 v[32:35], v[80:83], v[152:155], v[32:35]
    ds_read_b64_tr_b16 v[76:77], v15 offset:57344
    v_mfma_f32_16x16x32_bf16 v[40:43], v[80:83], v[156:159], v[40:43]
    ds_read_b64_tr_b16 v[78:79], v15 offset:58368
    v_and_b32 v11, 7, v1
    v_mfma_f32_16x16x32_bf16 v[44:47], v[84:87], v[156:159], v[44:47]
    ds_read_b64_tr_b16 v[80:81], v12 offset:61440
    buffer_load_dwordx4 v[144:147], v6, s[16:19], s50 offen offset:0 sc1
    v_mfma_f32_16x16x32_bf16 v[36:39], v[84:87], v[152:155], v[36:39]
    ds_read_b64_tr_b16 v[82:83], v12 offset:62464
    v_mul_u32_u24 v9, 144, v10
    s_waitcnt lgkmcnt(10)
    v_mfma_f32_16x16x32_bf16 v[48:51], v[88:91], v[152:155], v[48:51]
    ds_read_b64_tr_b16 v[84:85], v13 offset:61440
    v_mfma_f32_16x16x32_bf16 v[56:59], v[88:91], v[156:159], v[56:59]
    ds_read_b64_tr_b16 v[86:87], v13 offset:62464
    v_lshl_add_u32 v9, v11, 4, v9
    v_mfma_f32_16x16x32_bf16 v[60:63], v[92:95], v[156:159], v[60:63]
    ds_read_b64_tr_b16 v[88:89], v14 offset:61440
    buffer_load_dwordx4 v[148:151], v6, s[16:19], s50 offen offset:256 sc1
    v_mfma_f32_16x16x32_bf16 v[52:55], v[92:95], v[152:155], v[52:55]
    ds_read_b64_tr_b16 v[90:91], v14 offset:62464
    s_waitcnt vmcnt(12) lgkmcnt(10)
    v_mfma_f32_16x16x32_bf16 v[32:35], v[64:67], v[160:163], v[32:35]
    ds_read_b64_tr_b16 v[92:93], v15 offset:61440
    v_mfma_f32_16x16x32_bf16 v[40:43], v[64:67], v[164:167], v[40:43]
    ds_read_b64_tr_b16 v[94:95], v15 offset:62464
    v_add_u32 v9, v9, v7
    v_mfma_f32_16x16x32_bf16 v[44:47], v[68:71], v[164:167], v[44:47]
    v_xor_b32 v12, 0x10000, v12
    ds_read_b64_tr_b16 v[64:65], v12 offset:0
    buffer_load_dwordx4 v[152:155], v6, s[16:19], s50 offen offset:2048 sc1
    v_mfma_f32_16x16x32_bf16 v[36:39], v[68:71], v[160:163], v[36:39]
    ds_read_b64_tr_b16 v[66:67], v12 offset:1024
    v_lshlrev_b32 v10, 11, v10
    s_waitcnt lgkmcnt(10)
    v_mfma_f32_16x16x32_bf16 v[48:51], v[72:75], v[160:163], v[48:51]
    v_xor_b32 v13, 0x10000, v13
    ds_read_b64_tr_b16 v[68:69], v13 offset:0
    v_mfma_f32_16x16x32_bf16 v[56:59], v[72:75], v[164:167], v[56:59]
    ds_read_b64_tr_b16 v[70:71], v13 offset:1024
    v_lshl_add_u32 v10, v11, 4, v10
    v_mfma_f32_16x16x32_bf16 v[60:63], v[76:79], v[164:167], v[60:63]
    v_xor_b32 v14, 0x10000, v14
    ds_read_b64_tr_b16 v[72:73], v14 offset:0
    buffer_load_dwordx4 v[156:159], v6, s[16:19], s50 offen offset:2304 sc1
    s_add_u32 s50, s50, 4096
    v_mfma_f32_16x16x32_bf16 v[52:55], v[76:79], v[160:163], v[52:55]
    ds_read_b64_tr_b16 v[74:75], v14 offset:1024
    s_waitcnt vmcnt(12) lgkmcnt(10)
    v_mfma_f32_16x16x32_bf16 v[32:35], v[80:83], v[168:171], v[32:35]
    v_xor_b32 v15, 0x10000, v15
    ds_read_b64_tr_b16 v[76:77], v15 offset:0
    v_mfma_f32_16x16x32_bf16 v[40:43], v[80:83], v[172:175], v[40:43]
    ds_read_b64_tr_b16 v[78:79], v15 offset:1024
    v_mfma_f32_16x16x32_bf16 v[44:47], v[84:87], v[172:175], v[44:47]
    ds_read_b64_tr_b16 v[80:81], v12 offset:4096
    buffer_load_dwordx4 v[160:163], v6, s[16:19], s50 offen offset:0 sc1
    v_mfma_f32_16x16x32_bf16 v[36:39], v[84:87], v[168:171], v[36:39]
    ds_read_b64_tr_b16 v[82:83], v12 offset:5120
    s_waitcnt lgkmcnt(10)
    v_mfma_f32_16x16x32_bf16 v[48:51], v[88:91], v[168:171], v[48:51]
    ds_read_b64_tr_b16 v[84:85], v13 offset:4096
    v_mfma_f32_16x16x32_bf16 v[56:59], v[88:91], v[172:175], v[56:59]
    ds_read_b64_tr_b16 v[86:87], v13 offset:5120
    v_mfma_f32_16x16x32_bf16 v[60:63], v[92:95], v[172:175], v[60:63]
    ds_read_b64_tr_b16 v[88:89], v14 offset:4096
    buffer_load_dwordx4 v[164:167], v6, s[16:19], s50 offen offset:256 sc1
    v_mfma_f32_16x16x32_bf16 v[52:55], v[92:95], v[168:171], v[52:55]
    ds_read_b64_tr_b16 v[90:91], v14 offset:5120
    s_waitcnt vmcnt(12) lgkmcnt(10)
    v_mfma_f32_16x16x32_bf16 v[176:179], v[64:67], v[112:115], v[176:179]
    ds_read_b64_tr_b16 v[92:93], v15 offset:4096
    v_mfma_f32_16x16x32_bf16 v[184:187], v[64:67], v[116:119], v[184:187]
    ds_read_b64_tr_b16 v[94:95], v15 offset:5120
    v_mfma_f32_16x16x32_bf16 v[188:191], v[68:71], v[116:119], v[188:191]
    ds_read_b64_tr_b16 v[64:65], v12 offset:8192
    buffer_load_dwordx4 v[168:171], v6, s[16:19], s50 offen offset:2048 sc1
    v_mfma_f32_16x16x32_bf16 v[180:183], v[68:71], v[112:115], v[180:183]
    ds_read_b64_tr_b16 v[66:67], v12 offset:9216
    s_waitcnt lgkmcnt(10)
    v_mfma_f32_16x16x32_bf16 v[192:195], v[72:75], v[112:115], v[192:195]
    ds_read_b64_tr_b16 v[68:69], v13 offset:8192
    v_mfma_f32_16x16x32_bf16 v[200:203], v[72:75], v[116:119], v[200:203]
    ds_read_b64_tr_b16 v[70:71], v13 offset:9216
    v_mfma_f32_16x16x32_bf16 v[204:207], v[76:79], v[116:119], v[204:207]
    ds_read_b64_tr_b16 v[72:73], v14 offset:8192
    buffer_load_dwordx4 v[172:175], v6, s[16:19], s50 offen offset:2304 sc1
    s_add_u32 s50, s50, 4096
    v_mfma_f32_16x16x32_bf16 v[196:199], v[76:79], v[112:115], v[196:199]
    ds_read_b64_tr_b16 v[74:75], v14 offset:9216
    s_waitcnt vmcnt(12) lgkmcnt(10)
    v_mfma_f32_16x16x32_bf16 v[176:179], v[80:83], v[120:123], v[176:179]
    ds_read_b64_tr_b16 v[76:77], v15 offset:8192
    v_mfma_f32_16x16x32_bf16 v[184:187], v[80:83], v[124:127], v[184:187]
    ds_read_b64_tr_b16 v[78:79], v15 offset:9216
    v_mfma_f32_16x16x32_bf16 v[188:191], v[84:87], v[124:127], v[188:191]
    ds_read_b64_tr_b16 v[80:81], v12 offset:12288
    buffer_load_dwordx4 v[112:115], v6, s[16:19], s50 offen offset:0 sc1
    v_mfma_f32_16x16x32_bf16 v[180:183], v[84:87], v[120:123], v[180:183]
    ds_read_b64_tr_b16 v[82:83], v12 offset:13312
    s_waitcnt lgkmcnt(10)
    v_mfma_f32_16x16x32_bf16 v[192:195], v[88:91], v[120:123], v[192:195]
    ds_read_b64_tr_b16 v[84:85], v13 offset:12288
    v_mfma_f32_16x16x32_bf16 v[200:203], v[88:91], v[124:127], v[200:203]
    ds_read_b64_tr_b16 v[86:87], v13 offset:13312
    v_mfma_f32_16x16x32_bf16 v[204:207], v[92:95], v[124:127], v[204:207]
    ds_read_b64_tr_b16 v[88:89], v14 offset:12288
    buffer_load_dwordx4 v[116:119], v6, s[16:19], s50 offen offset:256 sc1
    v_mfma_f32_16x16x32_bf16 v[196:199], v[92:95], v[120:123], v[196:199]
    ds_read_b64_tr_b16 v[90:91], v14 offset:13312
    s_waitcnt vmcnt(12) lgkmcnt(10)
    v_mfma_f32_16x16x32_bf16 v[176:179], v[64:67], v[128:131], v[176:179]
    ds_read_b64_tr_b16 v[92:93], v15 offset:12288
    v_mfma_f32_16x16x32_bf16 v[184:187], v[64:67], v[132:135], v[184:187]
    ds_read_b64_tr_b16 v[94:95], v15 offset:13312
    v_mfma_f32_16x16x32_bf16 v[188:191], v[68:71], v[132:135], v[188:191]
    ds_read_b64_tr_b16 v[64:65], v12 offset:16384
    buffer_load_dwordx4 v[120:123], v6, s[16:19], s50 offen offset:2048 sc1
    v_mfma_f32_16x16x32_bf16 v[180:183], v[68:71], v[128:131], v[180:183]
    ds_read_b64_tr_b16 v[66:67], v12 offset:17408
    s_waitcnt lgkmcnt(10)
    v_mfma_f32_16x16x32_bf16 v[192:195], v[72:75], v[128:131], v[192:195]
    ds_read_b64_tr_b16 v[68:69], v13 offset:16384
    v_mfma_f32_16x16x32_bf16 v[200:203], v[72:75], v[132:135], v[200:203]
    ds_read_b64_tr_b16 v[70:71], v13 offset:17408
    v_mfma_f32_16x16x32_bf16 v[204:207], v[76:79], v[132:135], v[204:207]
    ds_read_b64_tr_b16 v[72:73], v14 offset:16384
    buffer_load_dwordx4 v[124:127], v6, s[16:19], s50 offen offset:2304 sc1
    s_add_u32 s50, s50, 4096
    v_mfma_f32_16x16x32_bf16 v[196:199], v[76:79], v[128:131], v[196:199]
    ds_read_b64_tr_b16 v[74:75], v14 offset:17408
    s_waitcnt vmcnt(12) lgkmcnt(10)
    v_mfma_f32_16x16x32_bf16 v[176:179], v[80:83], v[136:139], v[176:179]
    ds_read_b64_tr_b16 v[76:77], v15 offset:16384
    v_mfma_f32_16x16x32_bf16 v[184:187], v[80:83], v[140:143], v[184:187]
    ds_read_b64_tr_b16 v[78:79], v15 offset:17408
    v_mfma_f32_16x16x32_bf16 v[188:191], v[84:87], v[140:143], v[188:191]
    ds_read_b64_tr_b16 v[80:81], v12 offset:20480
    buffer_load_dwordx4 v[128:131], v6, s[16:19], s50 offen offset:0 sc1
    v_mfma_f32_16x16x32_bf16 v[180:183], v[84:87], v[136:139], v[180:183]
    ds_read_b64_tr_b16 v[82:83], v12 offset:21504
    s_waitcnt lgkmcnt(10)
    v_mfma_f32_16x16x32_bf16 v[192:195], v[88:91], v[136:139], v[192:195]
    ds_read_b64_tr_b16 v[84:85], v13 offset:20480
    v_mfma_f32_16x16x32_bf16 v[200:203], v[88:91], v[140:143], v[200:203]
    ds_read_b64_tr_b16 v[86:87], v13 offset:21504
    v_mfma_f32_16x16x32_bf16 v[204:207], v[92:95], v[140:143], v[204:207]
    ds_read_b64_tr_b16 v[88:89], v14 offset:20480
    buffer_load_dwordx4 v[132:135], v6, s[16:19], s50 offen offset:256 sc1
    v_mfma_f32_16x16x32_bf16 v[196:199], v[92:95], v[136:139], v[196:199]
    ds_read_b64_tr_b16 v[90:91], v14 offset:21504
    s_waitcnt vmcnt(12) lgkmcnt(10)
    v_mfma_f32_16x16x32_bf16 v[176:179], v[64:67], v[144:147], v[176:179]
    ds_read_b64_tr_b16 v[92:93], v15 offset:20480
    v_mfma_f32_16x16x32_bf16 v[184:187], v[64:67], v[148:151], v[184:187]
    ds_read_b64_tr_b16 v[94:95], v15 offset:21504
    v_mfma_f32_16x16x32_bf16 v[188:191], v[68:71], v[148:151], v[188:191]
    ds_read_b64_tr_b16 v[64:65], v12 offset:24576
    buffer_load_dwordx4 v[136:139], v6, s[16:19], s50 offen offset:2048 sc1
    v_mfma_f32_16x16x32_bf16 v[180:183], v[68:71], v[144:147], v[180:183]
    ds_read_b64_tr_b16 v[66:67], v12 offset:25600
    s_waitcnt lgkmcnt(10)
    v_mfma_f32_16x16x32_bf16 v[192:195], v[72:75], v[144:147], v[192:195]
    ds_read_b64_tr_b16 v[68:69], v13 offset:24576
    v_mfma_f32_16x16x32_bf16 v[200:203], v[72:75], v[148:151], v[200:203]
    ds_read_b64_tr_b16 v[70:71], v13 offset:25600
    v_mfma_f32_16x16x32_bf16 v[204:207], v[76:79], v[148:151], v[204:207]
    ds_read_b64_tr_b16 v[72:73], v14 offset:24576
    buffer_load_dwordx4 v[140:143], v6, s[16:19], s50 offen offset:2304 sc1
    s_add_u32 s50, s50, 4096
    v_mfma_f32_16x16x32_bf16 v[196:199], v[76:79], v[144:147], v[196:199]
    ds_read_b64_tr_b16 v[74:75], v14 offset:25600
    s_waitcnt vmcnt(12) lgkmcnt(10)
    v_mfma_f32_16x16x32_bf16 v[176:179], v[80:83], v[152:155], v[176:179]
    ds_read_b64_tr_b16 v[76:77], v15 offset:24576
    v_mfma_f32_16x16x32_bf16 v[184:187], v[80:83], v[156:159], v[184:187]
    ds_read_b64_tr_b16 v[78:79], v15 offset:25600
    v_mfma_f32_16x16x32_bf16 v[188:191], v[84:87], v[156:159], v[188:191]
    ds_read_b64_tr_b16 v[80:81], v12 offset:28672
    buffer_load_dwordx4 v[144:147], v6, s[16:19], s50 offen offset:0 sc1
    v_mfma_f32_16x16x32_bf16 v[180:183], v[84:87], v[152:155], v[180:183]
    ds_read_b64_tr_b16 v[82:83], v12 offset:29696
    s_waitcnt lgkmcnt(10)
    v_mfma_f32_16x16x32_bf16 v[192:195], v[88:91], v[152:155], v[192:195]
    ds_read_b64_tr_b16 v[84:85], v13 offset:28672
    v_mfma_f32_16x16x32_bf16 v[200:203], v[88:91], v[156:159], v[200:203]
    ds_read_b64_tr_b16 v[86:87], v13 offset:29696
    v_mfma_f32_16x16x32_bf16 v[204:207], v[92:95], v[156:159], v[204:207]
    ds_read_b64_tr_b16 v[88:89], v14 offset:28672
    buffer_load_dwordx4 v[148:151], v6, s[16:19], s50 offen offset:256 sc1
    v_mfma_f32_16x16x32_bf16 v[196:199], v[92:95], v[152:155], v[196:199]
    ds_read_b64_tr_b16 v[90:91], v14 offset:29696
    s_waitcnt vmcnt(12) lgkmcnt(10)
    v_mfma_f32_16x16x32_bf16 v[176:179], v[64:67], v[160:163], v[176:179]
    ds_read_b64_tr_b16 v[92:93], v15 offset:28672
    v_mfma_f32_16x16x32_bf16 v[184:187], v[64:67], v[164:167], v[184:187]
    ds_read_b64_tr_b16 v[94:95], v15 offset:29696
    v_mfma_f32_16x16x32_bf16 v[188:191], v[68:71], v[164:167], v[188:191]
    ds_read_b64_tr_b16 v[64:65], v12 offset:32768
    buffer_load_dwordx4 v[152:155], v6, s[16:19], s50 offen offset:2048 sc1
    v_mfma_f32_16x16x32_bf16 v[180:183], v[68:71], v[160:163], v[180:183]
    ds_read_b64_tr_b16 v[66:67], v12 offset:33792
    s_waitcnt lgkmcnt(10)
    v_mfma_f32_16x16x32_bf16 v[192:195], v[72:75], v[160:163], v[192:195]
    ds_read_b64_tr_b16 v[68:69], v13 offset:32768
    v_mfma_f32_16x16x32_bf16 v[200:203], v[72:75], v[164:167], v[200:203]
    ds_read_b64_tr_b16 v[70:71], v13 offset:33792
    v_mfma_f32_16x16x32_bf16 v[204:207], v[76:79], v[164:167], v[204:207]
    ds_read_b64_tr_b16 v[72:73], v14 offset:32768
    buffer_load_dwordx4 v[156:159], v6, s[16:19], s50 offen offset:2304 sc1
    s_add_u32 s50, s50, 4096
    v_mfma_f32_16x16x32_bf16 v[196:199], v[76:79], v[160:163], v[196:199]
    ds_read_b64_tr_b16 v[74:75], v14 offset:33792
    s_waitcnt vmcnt(12) lgkmcnt(10)
    v_mfma_f32_16x16x32_bf16 v[176:179], v[80:83], v[168:171], v[176:179]
    ds_read_b64_tr_b16 v[76:77], v15 offset:32768
    v_mfma_f32_16x16x32_bf16 v[184:187], v[80:83], v[172:175], v[184:187]
    ds_read_b64_tr_b16 v[78:79], v15 offset:33792
    v_mfma_f32_16x16x32_bf16 v[188:191], v[84:87], v[172:175], v[188:191]
    ds_read_b64_tr_b16 v[80:81], v12 offset:36864
    buffer_load_dwordx4 v[160:163], v6, s[16:19], s50 offen offset:0 sc1
    v_mfma_f32_16x16x32_bf16 v[180:183], v[84:87], v[168:171], v[180:183]
    ds_read_b64_tr_b16 v[82:83], v12 offset:37888
    s_waitcnt lgkmcnt(10)
    v_mfma_f32_16x16x32_bf16 v[192:195], v[88:91], v[168:171], v[192:195]
    ds_read_b64_tr_b16 v[84:85], v13 offset:36864
    v_mfma_f32_16x16x32_bf16 v[200:203], v[88:91], v[172:175], v[200:203]
    ds_read_b64_tr_b16 v[86:87], v13 offset:37888
    v_mfma_f32_16x16x32_bf16 v[204:207], v[92:95], v[172:175], v[204:207]
    ds_read_b64_tr_b16 v[88:89], v14 offset:36864
    buffer_load_dwordx4 v[164:167], v6, s[16:19], s50 offen offset:256 sc1
    v_mfma_f32_16x16x32_bf16 v[196:199], v[92:95], v[168:171], v[196:199]
    ds_read_b64_tr_b16 v[90:91], v14 offset:37888
    s_waitcnt vmcnt(12) lgkmcnt(10)
    v_mfma_f32_16x16x32_bf16 v[176:179], v[64:67], v[112:115], v[176:179]
    ds_read_b64_tr_b16 v[92:93], v15 offset:36864
    v_mfma_f32_16x16x32_bf16 v[184:187], v[64:67], v[116:119], v[184:187]
    ds_read_b64_tr_b16 v[94:95], v15 offset:37888
    v_mfma_f32_16x16x32_bf16 v[188:191], v[68:71], v[116:119], v[188:191]
    ds_read_b64_tr_b16 v[64:65], v12 offset:40960
    buffer_load_dwordx4 v[168:171], v6, s[16:19], s50 offen offset:2048 sc1
    v_mfma_f32_16x16x32_bf16 v[180:183], v[68:71], v[112:115], v[180:183]
    ds_read_b64_tr_b16 v[66:67], v12 offset:41984
    s_waitcnt lgkmcnt(10)
    v_mfma_f32_16x16x32_bf16 v[192:195], v[72:75], v[112:115], v[192:195]
    ds_read_b64_tr_b16 v[68:69], v13 offset:40960
    v_mfma_f32_16x16x32_bf16 v[200:203], v[72:75], v[116:119], v[200:203]
    ds_read_b64_tr_b16 v[70:71], v13 offset:41984
    v_mfma_f32_16x16x32_bf16 v[204:207], v[76:79], v[116:119], v[204:207]
    ds_read_b64_tr_b16 v[72:73], v14 offset:40960
    buffer_load_dwordx4 v[172:175], v6, s[16:19], s50 offen offset:2304 sc1
    s_add_u32 s50, s50, 4096
    v_mfma_f32_16x16x32_bf16 v[196:199], v[76:79], v[112:115], v[196:199]
    ds_read_b64_tr_b16 v[74:75], v14 offset:41984
    s_waitcnt vmcnt(12) lgkmcnt(10)
    v_mfma_f32_16x16x32_bf16 v[176:179], v[80:83], v[120:123], v[176:179]
    ds_read_b64_tr_b16 v[76:77], v15 offset:40960
    v_mfma_f32_16x16x32_bf16 v[184:187], v[80:83], v[124:127], v[184:187]
    ds_read_b64_tr_b16 v[78:79], v15 offset:41984
    v_mfma_f32_16x16x32_bf16 v[188:191], v[84:87], v[124:127], v[188:191]
    ds_read_b64_tr_b16 v[80:81], v12 offset:45056
    v_mfma_f32_16x16x32_bf16 v[180:183], v[84:87], v[120:123], v[180:183]
    ds_read_b64_tr_b16 v[82:83], v12 offset:46080
    s_waitcnt lgkmcnt(10)
    v_mfma_f32_16x16x32_bf16 v[192:195], v[88:91], v[120:123], v[192:195]
    ds_read_b64_tr_b16 v[84:85], v13 offset:45056
    v_mfma_f32_16x16x32_bf16 v[200:203], v[88:91], v[124:127], v[200:203]
    ds_read_b64_tr_b16 v[86:87], v13 offset:46080
    v_mfma_f32_16x16x32_bf16 v[204:207], v[92:95], v[124:127], v[204:207]
    ds_read_b64_tr_b16 v[88:89], v14 offset:45056
    v_mfma_f32_16x16x32_bf16 v[196:199], v[92:95], v[120:123], v[196:199]
    ds_read_b64_tr_b16 v[90:91], v14 offset:46080
    s_waitcnt vmcnt(10) lgkmcnt(10)
    v_mfma_f32_16x16x32_bf16 v[176:179], v[64:67], v[128:131], v[176:179]
    ds_read_b64_tr_b16 v[92:93], v15 offset:45056
    v_mfma_f32_16x16x32_bf16 v[184:187], v[64:67], v[132:135], v[184:187]
    ds_read_b64_tr_b16 v[94:95], v15 offset:46080
    v_mfma_f32_16x16x32_bf16 v[188:191], v[68:71], v[132:135], v[188:191]
    ds_read_b64_tr_b16 v[64:65], v12 offset:49152
    v_mfma_f32_16x16x32_bf16 v[180:183], v[68:71], v[128:131], v[180:183]
    ds_read_b64_tr_b16 v[66:67], v12 offset:50176
    s_waitcnt lgkmcnt(10)
    v_mfma_f32_16x16x32_bf16 v[192:195], v[72:75], v[128:131], v[192:195]
    ds_read_b64_tr_b16 v[68:69], v13 offset:49152
    v_mfma_f32_16x16x32_bf16 v[200:203], v[72:75], v[132:135], v[200:203]
    ds_read_b64_tr_b16 v[70:71], v13 offset:50176
    v_mfma_f32_16x16x32_bf16 v[204:207], v[76:79], v[132:135], v[204:207]
    ds_read_b64_tr_b16 v[72:73], v14 offset:49152
    v_mfma_f32_16x16x32_bf16 v[196:199], v[76:79], v[128:131], v[196:199]
    ds_read_b64_tr_b16 v[74:75], v14 offset:50176
    s_waitcnt vmcnt(8) lgkmcnt(10)
    v_mfma_f32_16x16x32_bf16 v[176:179], v[80:83], v[136:139], v[176:179]
    ds_read_b64_tr_b16 v[76:77], v15 offset:49152
    v_mfma_f32_16x16x32_bf16 v[184:187], v[80:83], v[140:143], v[184:187]
    ds_read_b64_tr_b16 v[78:79], v15 offset:50176
    v_mfma_f32_16x16x32_bf16 v[188:191], v[84:87], v[140:143], v[188:191]
    ds_read_b64_tr_b16 v[80:81], v12 offset:53248
    v_mfma_f32_16x16x32_bf16 v[180:183], v[84:87], v[136:139], v[180:183]
    ds_read_b64_tr_b16 v[82:83], v12 offset:54272
    s_waitcnt lgkmcnt(10)
    v_mfma_f32_16x16x32_bf16 v[192:195], v[88:91], v[136:139], v[192:195]
    ds_read_b64_tr_b16 v[84:85], v13 offset:53248
    v_mfma_f32_16x16x32_bf16 v[200:203], v[88:91], v[140:143], v[200:203]
    ds_read_b64_tr_b16 v[86:87], v13 offset:54272
    v_mfma_f32_16x16x32_bf16 v[204:207], v[92:95], v[140:143], v[204:207]
    ds_read_b64_tr_b16 v[88:89], v14 offset:53248
    v_mfma_f32_16x16x32_bf16 v[196:199], v[92:95], v[136:139], v[196:199]
    ds_read_b64_tr_b16 v[90:91], v14 offset:54272
    s_waitcnt vmcnt(6) lgkmcnt(10)
    v_mfma_f32_16x16x32_bf16 v[176:179], v[64:67], v[144:147], v[176:179]
    ds_read_b64_tr_b16 v[92:93], v15 offset:53248
    v_mfma_f32_16x16x32_bf16 v[184:187], v[64:67], v[148:151], v[184:187]
    ds_read_b64_tr_b16 v[94:95], v15 offset:54272
    v_mfma_f32_16x16x32_bf16 v[188:191], v[68:71], v[148:151], v[188:191]
    ds_read_b64_tr_b16 v[64:65], v12 offset:57344
    v_mfma_f32_16x16x32_bf16 v[180:183], v[68:71], v[144:147], v[180:183]
    ds_read_b64_tr_b16 v[66:67], v12 offset:58368
    s_waitcnt lgkmcnt(10)
    v_mfma_f32_16x16x32_bf16 v[192:195], v[72:75], v[144:147], v[192:195]
    ds_read_b64_tr_b16 v[68:69], v13 offset:57344
    v_mfma_f32_16x16x32_bf16 v[200:203], v[72:75], v[148:151], v[200:203]
    ds_read_b64_tr_b16 v[70:71], v13 offset:58368
    v_mfma_f32_16x16x32_bf16 v[204:207], v[76:79], v[148:151], v[204:207]
    ds_read_b64_tr_b16 v[72:73], v14 offset:57344
    v_mfma_f32_16x16x32_bf16 v[196:199], v[76:79], v[144:147], v[196:199]
    ds_read_b64_tr_b16 v[74:75], v14 offset:58368
    s_waitcnt vmcnt(4) lgkmcnt(10)
    v_mfma_f32_16x16x32_bf16 v[176:179], v[80:83], v[152:155], v[176:179]
    ds_read_b64_tr_b16 v[76:77], v15 offset:57344
    v_mfma_f32_16x16x32_bf16 v[184:187], v[80:83], v[156:159], v[184:187]
    ds_read_b64_tr_b16 v[78:79], v15 offset:58368
    v_mfma_f32_16x16x32_bf16 v[188:191], v[84:87], v[156:159], v[188:191]
    ds_read_b64_tr_b16 v[80:81], v12 offset:61440
    v_mfma_f32_16x16x32_bf16 v[180:183], v[84:87], v[152:155], v[180:183]
    ds_read_b64_tr_b16 v[82:83], v12 offset:62464
    s_waitcnt lgkmcnt(10)
    v_mfma_f32_16x16x32_bf16 v[192:195], v[88:91], v[152:155], v[192:195]
    ds_read_b64_tr_b16 v[84:85], v13 offset:61440
    v_mfma_f32_16x16x32_bf16 v[200:203], v[88:91], v[156:159], v[200:203]
    ds_read_b64_tr_b16 v[86:87], v13 offset:62464
    v_mfma_f32_16x16x32_bf16 v[204:207], v[92:95], v[156:159], v[204:207]
    ds_read_b64_tr_b16 v[88:89], v14 offset:61440
    v_mfma_f32_16x16x32_bf16 v[196:199], v[92:95], v[152:155], v[196:199]
    ds_read_b64_tr_b16 v[90:91], v14 offset:62464
    s_waitcnt vmcnt(2) lgkmcnt(10)
    v_mfma_f32_16x16x32_bf16 v[176:179], v[64:67], v[160:163], v[176:179]
    ds_read_b64_tr_b16 v[92:93], v15 offset:61440
    v_mfma_f32_16x16x32_bf16 v[184:187], v[64:67], v[164:167], v[184:187]
    ds_read_b64_tr_b16 v[94:95], v15 offset:62464
    v_mfma_f32_16x16x32_bf16 v[188:191], v[68:71], v[164:167], v[188:191]
    v_mfma_f32_16x16x32_bf16 v[180:183], v[68:71], v[160:163], v[180:183]
    s_waitcnt lgkmcnt(8)
    v_mfma_f32_16x16x32_bf16 v[192:195], v[72:75], v[160:163], v[192:195]
    v_mfma_f32_16x16x32_bf16 v[200:203], v[72:75], v[164:167], v[200:203]
    v_mfma_f32_16x16x32_bf16 v[204:207], v[76:79], v[164:167], v[204:207]
    v_mfma_f32_16x16x32_bf16 v[196:199], v[76:79], v[160:163], v[196:199]
    s_waitcnt vmcnt(0) lgkmcnt(4)
    v_mfma_f32_16x16x32_bf16 v[176:179], v[80:83], v[168:171], v[176:179]
    v_mfma_f32_16x16x32_bf16 v[184:187], v[80:83], v[172:175], v[184:187]
    v_mfma_f32_16x16x32_bf16 v[188:191], v[84:87], v[172:175], v[188:191]
    v_mfma_f32_16x16x32_bf16 v[180:183], v[84:87], v[168:171], v[180:183]
    s_waitcnt lgkmcnt(0)
    v_mfma_f32_16x16x32_bf16 v[192:195], v[88:91], v[168:171], v[192:195]
    v_mfma_f32_16x16x32_bf16 v[200:203], v[88:91], v[172:175], v[200:203]
    v_mfma_f32_16x16x32_bf16 v[204:207], v[92:95], v[172:175], v[204:207]
    v_mfma_f32_16x16x32_bf16 v[196:199], v[92:95], v[168:171], v[196:199]
    s_cmp_eq_u32 s9, 3
    s_cbranch_scc1 c_wo_fin
    s_add_u32 s58, s58, 4194304
    v_pk_add_f32 v[32:33], v[32:33], v[176:177]
    v_pk_add_f32 v[34:35], v[34:35], v[178:179]
    v_pk_add_f32 v[36:37], v[36:37], v[180:181]
    v_pk_add_f32 v[38:39], v[38:39], v[182:183]
    v_cvt_pk_bf16_f32 v96, v32, v33
    v_cvt_pk_bf16_f32 v97, v34, v35
    v_cvt_pk_bf16_f32 v98, v36, v37
    v_cvt_pk_bf16_f32 v99, v38, v39
    buffer_store_dwordx4 v[96:99], v6, s[12:15], s58 offen offset:0 sc1
    v_pk_add_f32 v[40:41], v[40:41], v[184:185]
    v_pk_add_f32 v[42:43], v[42:43], v[186:187]
    v_pk_add_f32 v[44:45], v[44:45], v[188:189]
    v_pk_add_f32 v[46:47], v[46:47], v[190:191]
    v_cvt_pk_bf16_f32 v100, v40, v41
    v_cvt_pk_bf16_f32 v101, v42, v43
    v_cvt_pk_bf16_f32 v102, v44, v45
    v_cvt_pk_bf16_f32 v103, v46, v47
    buffer_store_dwordx4 v[100:103], v6, s[12:15], s58 offen offset:256 sc1
    v_pk_add_f32 v[48:49], v[48:49], v[192:193]
    v_pk_add_f32 v[50:51], v[50:51], v[194:195]
    v_pk_add_f32 v[52:53], v[52:53], v[196:197]
    v_pk_add_f32 v[54:55], v[54:55], v[198:199]
    v_cvt_pk_bf16_f32 v104, v48, v49
    v_cvt_pk_bf16_f32 v105, v50, v51
    v_cvt_pk_bf16_f32 v106, v52, v53
    v_cvt_pk_bf16_f32 v107, v54, v55
    buffer_store_dwordx4 v[104:107], v6, s[12:15], s58 offen offset:2048 sc1
    v_pk_add_f32 v[56:57], v[56:57], v[200:201]
    v_pk_add_f32 v[58:59], v[58:59], v[202:203]
    v_pk_add_f32 v[60:61], v[60:61], v[204:205]
    v_pk_add_f32 v[62:63], v[62:63], v[206:207]
    v_cvt_pk_bf16_f32 v108, v56, v57
    v_cvt_pk_bf16_f32 v109, v58, v59
    v_cvt_pk_bf16_f32 v110, v60, v61
    v_cvt_pk_bf16_f32 v111, v62, v63
    buffer_store_dwordx4 v[108:111], v6, s[12:15], s58 offen offset:2304 sc1
    s_barrier
c_wo_stat:
    s_mov_b32 s55, 0x3f803f80
    v_dot2_f32_bf16 v18, v96, s55, 0
    v_dot2_f32_bf16 v19, v96, v96, 0
    v_dot2_f32_bf16 v20, v100, s55, 0
    v_dot2_f32_bf16 v21, v100, v100, 0
    v_dot2_f32_bf16 v18, v97, s55, v18
    v_dot2_f32_bf16 v19, v97, v97, v19
    v_dot2_f32_bf16 v20, v101, s55, v20
    v_dot2_f32_bf16 v21, v101, v101, v21
    v_dot2_f32_bf16 v18, v98, s55, v18
    v_dot2_f32_bf16 v19, v98, v98, v19
    v_dot2_f32_bf16 v20, v102, s55, v20
    v_dot2_f32_bf16 v21, v102, v102, v21
    v_dot2_f32_bf16 v18, v99, s55, v18
    v_dot2_f32_bf16 v19, v99, v99, v19
    v_dot2_f32_bf16 v20, v103, s55, v20
    v_dot2_f32_bf16 v21, v103, v103, v21
    v_dot2_f32_bf16 v18, v104, s55, v18
    v_dot2_f32_bf16 v19, v104, v104, v19
    v_dot2_f32_bf16 v20, v108, s55, v20
    v_dot2_f32_bf16 v21, v108, v108, v21
    v_dot2_f32_bf16 v18, v105, s55, v18
    v_dot2_f32_bf16 v19, v105, v105, v19
    v_dot2_f32_bf16 v20, v109, s55, v20
    v_dot2_f32_bf16 v21, v109, v109, v21
    v_dot2_f32_bf16 v18, v106, s55, v18
    v_dot2_f32_bf16 v19, v106, v106, v19
    v_dot2_f32_bf16 v20, v110, s55, v20
    v_dot2_f32_bf16 v21, v110, v110, v21
    v_dot2_f32_bf16 v18, v107, s55, v18
    v_dot2_f32_bf16 v19, v107, v107, v19
    v_dot2_f32_bf16 v20, v111, s55, v20
    v_dot2_f32_bf16 v21, v111, v111, v21
    v_lshlrev_b32 v16, 3, v1
    s_lshl_b32 s3, s48, 12
    s_lshl_b32 s55, s7, 8
    s_add_u32 s3, s3, s55
    v_permlane16_swap_b32 v18, v20
    v_permlane16_swap_b32 v19, v21
    s_lshl_b32 s55, s9, 18
    v_pk_add_f32 v[18:19], v[18:19], v[20:21]
    s_add_u32 s3, s3, s55
    s_add_u32 s3, s3, 63176704
    v_permlane32_swap_b32 v18, v20
    v_permlane32_swap_b32 v19, v21
    v_pk_add_f32 v[18:19], v[18:19], v[20:21]
    s_mov_b32 exec_hi, 0
    buffer_store_dwordx2 v[18:19], v16, s[12:15], s3 offen sc1
    s_mov_b64 exec, -1
    s_cmp_lg_u32 s9, -1
    s_cbranch_scc1 c_wo_pub
    v_mov_b32 v24, 159492
non_7:
    ds_read_b32 v25, v24
    s_waitcnt lgkmcnt(0)
    v_readfirstlane_b32 s10, v25
    s_cmp_eq_u32 s10, 0
    s_cbranch_scc1 non_7
c_wo_pub:
    s_mul_i32 s55, s9, 786432
    s_add_u32 s55, s55, 66060288
    v_and_b32 v24, 63, v0
    s_and_b32 s56, s11, 0xe0
    v_lshrrev_b32 v25, 5, v24
    v_add_u32 v24, s56, v24
    v_and_b32 v24, 255, v24
    v_lshlrev_b32 v24, 10, v24
    v_lshl_add_u32 v24, v25, 8, v24
    s_bfe_u32 s56, s11, 0x20003
    s_and_b32 s57, s11, 7
    s_lshl_b32 s56, s56, 7
    s_lshl_b32 s57, s57, 2
    s_add_u32 s55, s55, s56
    s_add_u32 s55, s55, s57
    s_and_b32 s57, s6, s9
    s_bfe_i32 s57, s57, 0x10000
    v_mov_b32 v25, 159488
    v_mov_b32 v26, 1
    v_mov_b32 v27, s10
    s_mov_b64 exec, 1
    s_waitcnt vmcnt(0)
    ds_add_rtn_u32 v26, v25, v26
    s_waitcnt lgkmcnt(0)
    v_readfirstlane_b32 s56, v26
    s_and_b32 s56, s56, 3
    s_cmp_lg_u32 s56, 3
    s_cbranch_scc1 pub_8
    s_mov_b32 exec_lo, -1
    s_mov_b32 exec_hi, s57
    buffer_store_dword v27, v24, s[12:15], s55 offen sc1
pub_8:
    s_mov_b64 exec, -1
    s_cmp_eq_u32 s9, -1
    s_cbranch_scc1 c_wo_pub3
    s_barrier
c_wo_pub3:
    s_add_u32 s9, s9, 1
    s_bitcmp1_b32 s9, 0
    s_cbranch_scc1 c_qkvB
    s_branch c_qkvA
c_wo_fin:
    s_mov_b32 s28, s44
    s_mov_b32 s29, s45
    s_mov_b32 s30, 4194304
    s_mov_b32 s31, 0x00020000
    s_lshl_b32 s3, s48, 16
    s_lshl_b32 s55, s7, 7
    s_add_u32 s3, s3, s55
    v_pk_add_f32 v[32:33], v[32:33], v[176:177]
    v_pk_add_f32 v[34:35], v[34:35], v[178:179]
    v_pk_add_f32 v[36:37], v[36:37], v[180:181]
    v_pk_add_f32 v[38:39], v[38:39], v[182:183]
    v_cvt_pk_bf16_f32 v96, v32, v33
    v_cvt_pk_bf16_f32 v97, v34, v35
    v_cvt_pk_bf16_f32 v98, v36, v37
    v_cvt_pk_bf16_f32 v99, v38, v39
    ds_write_b64 v8, v[96:97] offset:0
    ds_write_b64 v8, v[98:99] offset:32
    v_pk_add_f32 v[40:41], v[40:41], v[184:185]
    v_pk_add_f32 v[42:43], v[42:43], v[186:187]
    v_pk_add_f32 v[44:45], v[44:45], v[188:189]
    v_pk_add_f32 v[46:47], v[46:47], v[190:191]
    v_cvt_pk_bf16_f32 v100, v40, v41
    v_cvt_pk_bf16_f32 v101, v42, v43
    v_cvt_pk_bf16_f32 v102, v44, v45
    v_cvt_pk_bf16_f32 v103, v46, v47
    ds_write_b64 v8, v[100:101] offset:2304
    ds_write_b64 v8, v[102:103] offset:2336
    v_pk_add_f32 v[48:49], v[48:49], v[192:193]
    v_pk_add_f32 v[50:51], v[50:51], v[194:195]
    v_pk_add_f32 v[52:53], v[52:53], v[196:197]
    v_pk_add_f32 v[54:55], v[54:55], v[198:199]
    v_cvt_pk_bf16_f32 v104, v48, v49
    v_cvt_pk_bf16_f32 v105, v50, v51
    v_cvt_pk_bf16_f32 v106, v52, v53
    v_cvt_pk_bf16_f32 v107, v54, v55
    ds_write_b64 v8, v[104:105] offset:64
    ds_write_b64 v8, v[106:107] offset:96
    v_pk_add_f32 v[56:57], v[56:57], v[200:201]
    v_pk_add_f32 v[58:59], v[58:59], v[202:203]
    v_pk_add_f32 v[60:61], v[60:61], v[204:205]
    v_pk_add_f32 v[62:63], v[62:63], v[206:207]
    v_cvt_pk_bf16_f32 v108, v56, v57
    v_cvt_pk_bf16_f32 v109, v58, v59
    v_cvt_pk_bf16_f32 v110, v60, v61
    v_cvt_pk_bf16_f32 v111, v62, v63
    ds_write_b64 v8, v[108:109] offset:2368
    ds_write_b64 v8, v[110:111] offset:2400
    s_waitcnt lgkmcnt(0)
    ds_read_b128 v[32:35], v9 offset:0
    ds_read_b128 v[36:39], v9 offset:1152
    ds_read_b128 v[40:43], v9 offset:2304
    ds_read_b128 v[44:47], v9 offset:3456
    s_waitcnt lgkmcnt(3)
    buffer_store_dwordx4 v[32:35], v10, s[28:31], s3 offen sc1
    s_add_u32 s3, s3, 16384
    s_waitcnt lgkmcnt(2)
    buffer_store_dwordx4 v[36:39], v10, s[28:31], s3 offen sc1
    s_add_u32 s3, s3, 16384
    s_waitcnt lgkmcnt(1)
    buffer_store_dwordx4 v[40:43], v10, s[28:31], s3 offen sc1
    s_add_u32 s3, s3, 16384
    s_waitcnt lgkmcnt(0)
    buffer_store_dwordx4 v[44:47], v10, s[28:31], s3 offen sc1
    s_add_u32 s3, s3, 16384
    s_branch k_exit
c_prep_tail:
    s_lshl_b32 s56, s7, 12
    s_add_u32 s58, s55, s56
    s_lshl_b32 s3, s8, 12
    s_add_u32 s3, s3, 131072
    v_lshrrev_b32 v18, 2, v17
    v_and_b32 v19, 1, v17
    v_lshl_add_u32 v18, v18, 1, v19
    v_lshlrev_b32 v18, 10, v18
    v_lshl_add_u32 v18, v16, 4, v18
    v_bfe_u32 v17, v17, 1, 1
    v_lshl_add_u32 v18, v17, 3, v18
    v_add_u32 v18, s3, v18
    v_and_b32 v16, 15, v1
    v_bfe_u32 v17, v1, 4, 1
    v_lshl_add_u32 v6, v17, 5, v16
    v_lshlrev_b32 v6, 4, v6
    v_lshrrev_b32 v17, 5, v1
    v_lshl_add_u32 v6, v17, 10, v6
    v_add_u32 v19, s3, v6
    s_waitcnt vmcnt(3)
    ds_write_b64 v18, v[32:33] offset:0
    ds_write_b64 v18, v[34:35] offset:512
    s_waitcnt vmcnt(2)
    ds_write_b64 v18, v[36:37] offset:128
    ds_write_b64 v18, v[38:39] offset:640
    s_waitcnt vmcnt(1)
    ds_write_b64 v18, v[40:41] offset:256
    ds_write_b64 v18, v[42:43] offset:768
    s_waitcnt vmcnt(0)
    ds_write_b64 v18, v[44:45] offset:384
    ds_write_b64 v18, v[46:47] offset:896
    s_waitcnt lgkmcnt(0)
    ds_read_b128 v[96:99], v19 offset:0
    ds_read_b128 v[100:103], v19 offset:256
    ds_read_b128 v[104:107], v19 offset:2048
    ds_read_b128 v[108:111], v19 offset:2304
    s_waitcnt lgkmcnt(3)
    buffer_store_dwordx4 v[96:99], v6, s[12:15], s58 offen offset:0 sc1
    s_waitcnt lgkmcnt(2)
    buffer_store_dwordx4 v[100:103], v6, s[12:15], s58 offen offset:256 sc1
    s_waitcnt lgkmcnt(1)
    buffer_store_dwordx4 v[104:107], v6, s[12:15], s58 offen offset:2048 sc1
    s_waitcnt lgkmcnt(0)
    buffer_store_dwordx4 v[108:111], v6, s[12:15], s58 offen offset:2304 sc1
    s_branch c_wo_stat
.p2align 6
c_qkvB:
    v_and_b32 v1, 63, v0
    v_lshrrev_b32 v2, 6, v0
    v_lshlrev_b32 v5, 4, v1
    v_lshrrev_b32 v3, 5, v1
    v_and_b32 v4, 15, v0
    v_bfe_u32 v7, v1, 4, 1
    v_lshl_add_u32 v6, v7, 5, v4
    v_lshlrev_b32 v6, 4, v6
    v_lshl_add_u32 v6, v3, 10, v6
    s_lshr_b32 s48, s6, 1
    s_lshl_b32 s48, s48, 2
    s_add_u32 s48, s48, s8
    s_lshl_b32 s55, s48, 17
    s_lshl_b32 s56, s9, 22
    s_add_u32 s55, s55, s56
    s_add_u32 s16, s4, s55
    s_addc_u32 s17, s5, 0
    s_mov_b32 s18, 65536
    s_mov_b32 s19, 0x00020000
    s_add_u32 s56, s55, 65536
    s_add_u32 s20, s4, s56
    s_addc_u32 s21, s5, 0
    s_mov_b32 s22, 65536
    s_mov_b32 s23, 0x00020000
    s_lshl_b32 s49, s7, 12
    s_add_u32 s49, s49, s55
    s_and_b32 s56, s6, 1
    s_lshl_b32 s56, s56, 11
    s_add_u32 s49, s49, s56
    s_add_u32 s49, s49, 16777216
    s_movk_i32 s54, 4096
    v_lshrrev_b32 v16, 2, v4
    v_lshl_add_u32 v18, v7, 2, v16
    v_lshl_add_u32 v18, v3, 4, v18
    v_lshlrev_b32 v18, 6, v18
    v_and_b32 v17, 3, v4
    v_lshl_add_u32 v18, v17, 3, v18
    v_lshl_add_u32 v26, v7, 5, v18
    v_xor_b32 v27, 32, v26
    v_mov_b32 v24, v26
    v_mov_b32 v25, v27
    v_and_b32 v18, 0x30, v1
    v_add_u32 v10, 155648, v18
    v_lshlrev_b32 v11, 2, v4
    v_add_u32 v11, 155648, v11
    v_lshl_add_u32 v8, v2, 8, v11
    v_lshl_add_u32 v9, v2, 8, v10
    s_lshr_b32 s3, s8, 1
    s_and_b32 s55, s8, 1
    s_lshl_b32 s3, s3, 14
    s_lshl_b32 s55, s55, 12
    s_add_u32 s3, s3, s55
    s_add_u32 s3, s3, 81920
    v_lshl_add_u32 v12, v3, 5, v4
    v_lshlrev_b32 v12, 4, v12
    v_lshl_add_u32 v12, v7, 10, v12
    v_add_u32 v12, s3, v12
    v_add_u32 v13, s3, v5
    s_lshr_b32 s84, s9, 1
    s_lshl_b32 s84, s84, 23
    s_lshl_b32 s3, s7, 19
    s_add_u32 s84, s84, s3
    s_and_b32 s3, s6, 1
    s_lshl_b32 s3, s3, 18
    s_add_u32 s84, s84, s3
    s_add_u32 s84, s84, 33554432
    s_lshr_b32 s86, s6, 1
    s_lshl_b32 s3, s86, 15
    s_add_u32 s84, s84, s3
    s_sub_u32 s84, s84, 81920
    s_add_u32 s85, s84, 8192
    s_mul_i32 s53, s9, 786432
    s_add_u32 s53, s53, 66322432
    s_and_b32 s3, s11, 31
    s_lshl_b32 s3, s3, 10
    s_add_u32 s53, s53, s3
    s_lshr_b32 s3, s86, 1
    s_lshl_b32 s3, s3, 7
    s_add_u32 s53, s53, s3
    s_and_b32 s3, s86, 1
    s_lshl_b32 s3, s3, 2
    s_add_u32 s3, s3, s8
    s_lshl_b32 s3, s3, 2
    s_add_u32 s53, s53, s3
    v_lshlrev_b32 v28, 15, v1
    v_mov_b32 v29, s10
    v_mov_b32 v32, 0
    v_mov_b32 v33, 0
    v_mov_b32 v34, 0
    v_mov_b32 v35, 0
    v_mov_b32 v36, 0
    v_mov_b32 v37, 0
    v_mov_b32 v38, 0
    v_mov_b32 v39, 0
    v_mov_b32 v40, 0
    v_mov_b32 v41, 0
    v_mov_b32 v42, 0
    v_mov_b32 v43, 0
    v_mov_b32 v44, 0
    v_mov_b32 v45, 0
    v_mov_b32 v46, 0
    v_mov_b32 v47, 0
    v_mov_b32 v48, 0
    v_mov_b32 v49, 0
    v_mov_b32 v50, 0
    v_mov_b32 v51, 0
    v_mov_b32 v52, 0
    v_mov_b32 v53, 0
    v_mov_b32 v54, 0
    v_mov_b32 v55, 0
    v_mov_b32 v56, 0
    v_mov_b32 v57, 0
    v_mov_b32 v58, 0
    v_mov_b32 v59, 0
    v_mov_b32 v60, 0
    v_mov_b32 v61, 0
    v_mov_b32 v62, 0
    v_mov_b32 v63, 0
    v_mov_b32 v64, 0
    v_mov_b32 v65, 0
    v_mov_b32 v66, 0
    v_mov_b32 v67, 0
    v_mov_b32 v68, 0
    v_mov_b32 v69, 0
    v_mov_b32 v70, 0
    v_mov_b32 v71, 0
    v_mov_b32 v72, 0
    v_mov_b32 v73, 0
    v_mov_b32 v74, 0
    v_mov_b32 v75, 0
    v_mov_b32 v76, 0
    v_mov_b32 v77, 0
    v_mov_b32 v78, 0
    v_mov_b32 v79, 0
    v_mov_b32 v80, 0
    v_mov_b32 v81, 0
    v_mov_b32 v82, 0
    v_mov_b32 v83, 0
    v_mov_b32 v84, 0
    v_mov_b32 v85, 0
    v_mov_b32 v86, 0
    v_mov_b32 v87, 0
    v_mov_b32 v88, 0
    v_mov_b32 v89, 0
    v_mov_b32 v90, 0
    v_mov_b32 v91, 0
    v_mov_b32 v92, 0
    v_mov_b32 v93, 0
    v_mov_b32 v94, 0
    v_mov_b32 v95, 0
    v_mov_b32 v96, 0
    v_mov_b32 v97, 0
    v_mov_b32 v98, 0
    v_mov_b32 v99, 0
    v_mov_b32 v100, 0
    v_mov_b32 v101, 0
    v_mov_b32 v102, 0
    v_mov_b32 v103, 0
    v_mov_b32 v104, 0
    v_mov_b32 v105, 0
    v_mov_b32 v106, 0
    v_mov_b32 v107, 0
    v_mov_b32 v108, 0
    v_mov_b32 v109, 0
    v_mov_b32 v110, 0
    v_mov_b32 v111, 0
    v_mov_b32 v112, 0
    v_mov_b32 v113, 0
    v_mov_b32 v114, 0
    v_mov_b32 v115, 0
    v_mov_b32 v116, 0
    v_mov_b32 v117, 0
    v_mov_b32 v118, 0
    v_mov_b32 v119, 0
    v_mov_b32 v120, 0
    v_mov_b32 v121, 0
    v_mov_b32 v122, 0
    v_mov_b32 v123, 0
    v_mov_b32 v124, 0
    v_mov_b32 v125, 0
    v_mov_b32 v126, 0
    v_mov_b32 v127, 0
    s_mov_b32 s50, 8192
    s_mov_b32 s58, 6144
    s_mov_b32 s51, 12288
    s_mov_b32 s59, 10240
    s_mov_b32 s52, 0
    s_mul_i32 s60, s9, 786432
    s_add_u32 s60, s60, 65273856
    s_lshl_b32 s61, s11, 10
    s_add_u32 s60, s60, s61
    s_and_b32 s61, s8, 2
    s_lshl_b32 s61, s61, 7
    s_add_u32 s60, s60, s61
    s_add_u32 s61, s60, 128
    s_mov_b32 s98, s10
    s_mov_b32 s99, s10
    s_mov_b32 s3, 0x100000
cp_9:
    s_load_dwordx8 s[64:71], s[4:5], s60 glc
    s_load_dwordx8 s[72:79], s[4:5], s61 glc
    s_sub_u32 s3, s3, 1
    s_cbranch_scc1 cp_9_ok
    s_waitcnt lgkmcnt(0)
    s_xor_b64 s[100:101], s[64:65], s[98:99]
    s_xor_b64 s[64:65], s[66:67], s[98:99]
    s_or_b64 s[100:101], s[100:101], s[64:65]
    s_xor_b64 s[64:65], s[68:69], s[98:99]
    s_or_b64 s[100:101], s[100:101], s[64:65]
    s_xor_b64 s[64:65], s[70:71], s[98:99]
    s_or_b64 s[100:101], s[100:101], s[64:65]
    s_xor_b64 s[64:65], s[72:73], s[98:99]
    s_or_b64 s[100:101], s[100:101], s[64:65]
    s_xor_b64 s[64:65], s[74:75], s[98:99]
    s_or_b64 s[100:101], s[100:101], s[64:65]
    s_xor_b64 s[64:65], s[76:77], s[98:99]
    s_or_b64 s[100:101], s[100:101], s[64:65]
    s_xor_b64 s[64:65], s[78:79], s[98:99]
    s_or_b64 s[100:101], s[100:101], s[64:65]
    s_cbranch_scc1 cp_9
cp_9_ok:
    s_waitcnt lgkmcnt(0)
    buffer_load_dwordx4 v[152:155], v6, s[16:19], 0 offen offset:0 sc1
    buffer_load_dwordx4 v[156:159], v6, s[16:19], 0 offen offset:256 sc1
    buffer_load_dwordx4 v[160:163], v6, s[20:23], 0 offen offset:0 sc1
    buffer_load_dwordx4 v[164:167], v6, s[20:23], 0 offen offset:256 sc1
    buffer_load_dwordx4 v[168:171], v6, s[16:19], 0 offen offset:2048 sc1
    buffer_load_dwordx4 v[172:175], v6, s[16:19], 0 offen offset:2304 sc1
    buffer_load_dwordx4 v[176:179], v6, s[20:23], 0 offen offset:2048 sc1
    buffer_load_dwordx4 v[180:183], v6, s[20:23], 0 offen offset:2304 sc1
    s_barrier
    ds_read_b64_tr_b16 v[128:129], v24 offset:0
    ds_read_b64_tr_b16 v[130:131], v24 offset:512
    ds_read_b64_tr_b16 v[132:133], v25 offset:0
    ds_read_b64_tr_b16 v[134:135], v25 offset:512
    ds_read_b64_tr_b16 v[136:137], v24 offset:8192
    ds_read_b64_tr_b16 v[138:139], v24 offset:8704
    ds_read_b64_tr_b16 v[140:141], v25 offset:8192
    ds_read_b64_tr_b16 v[142:143], v25 offset:8704
    ds_read_b64_tr_b16 v[144:145], v24 offset:16384
    ds_read_b64_tr_b16 v[146:147], v24 offset:16896
    buffer_load_dwordx4 a[0:3], v6, s[16:19], s54 offen offset:0 sc1
    buffer_load_dwordx4 a[4:7], v6, s[16:19], s54 offen offset:256 sc1
    buffer_load_dwordx4 a[8:11], v6, s[20:23], s54 offen offset:0 sc1
    buffer_load_dwordx4 a[12:15], v6, s[20:23], s54 offen offset:256 sc1
    buffer_load_dwordx4 a[16:19], v6, s[16:19], s54 offen offset:2048 sc1
    buffer_load_dwordx4 a[20:23], v6, s[16:19], s54 offen offset:2304 sc1
    s_mov_b32 s54, 7
.p2align 3
c_qkvB_loop:
    s_waitcnt vmcnt(12) lgkmcnt(8)
    v_mfma_f32_16x16x32_bf16 v[32:35], v[128:131], v[152:155], v[32:35]
    ds_read_b64_tr_b16 v[148:149], v25 offset:16384
    buffer_load_dwordx4 a[24:27], v6, s[20:23], s58 offen offset:0 sc1
    v_mfma_f32_16x16x32_bf16 v[36:39], v[128:131], v[156:159], v[36:39]
    ds_read_b64_tr_b16 v[150:151], v25 offset:16896
    s_waitcnt lgkmcnt(8)
    v_mfma_f32_16x16x32_bf16 v[52:55], v[132:135], v[156:159], v[52:55]
    v_mfma_f32_16x16x32_bf16 v[48:51], v[132:135], v[152:155], v[48:51]
    s_waitcnt lgkmcnt(6)
    v_mfma_f32_16x16x32_bf16 v[64:67], v[136:139], v[152:155], v[64:67]
    v_mfma_f32_16x16x32_bf16 v[68:71], v[136:139], v[156:159], v[68:71]
    s_waitcnt lgkmcnt(4)
    v_mfma_f32_16x16x32_bf16 v[84:87], v[140:143], v[156:159], v[84:87]
    buffer_load_dwordx4 a[28:31], v6, s[20:23], s58 offen offset:256 sc1
    v_mfma_f32_16x16x32_bf16 v[80:83], v[140:143], v[152:155], v[80:83]
    s_waitcnt lgkmcnt(2)
    v_mfma_f32_16x16x32_bf16 v[96:99], v[152:155], v[144:147], v[96:99]
    v_mfma_f32_16x16x32_bf16 v[100:103], v[156:159], v[144:147], v[100:103]
    s_waitcnt lgkmcnt(0)
    v_mfma_f32_16x16x32_bf16 v[116:119], v[156:159], v[148:151], v[116:119]
    v_mfma_f32_16x16x32_bf16 v[112:115], v[152:155], v[148:151], v[112:115]
    s_waitcnt vmcnt(12)
    v_mfma_f32_16x16x32_bf16 v[40:43], v[128:131], v[160:163], v[40:43]
    buffer_load_dwordx4 v[152:155], v6, s[16:19], s50 offen offset:0 sc1
    v_mfma_f32_16x16x32_bf16 v[44:47], v[128:131], v[164:167], v[44:47]
    v_mfma_f32_16x16x32_bf16 v[60:63], v[132:135], v[164:167], v[60:63]
    ds_read_b64_tr_b16 v[128:129], v24 offset:2048
    v_mfma_f32_16x16x32_bf16 v[56:59], v[132:135], v[160:163], v[56:59]
    ds_read_b64_tr_b16 v[130:131], v24 offset:2560
    v_mfma_f32_16x16x32_bf16 v[72:75], v[136:139], v[160:163], v[72:75]
    ds_read_b64_tr_b16 v[132:133], v25 offset:2048
    v_mfma_f32_16x16x32_bf16 v[76:79], v[136:139], v[164:167], v[76:79]
    ds_read_b64_tr_b16 v[134:135], v25 offset:2560
    v_mfma_f32_16x16x32_bf16 v[92:95], v[140:143], v[164:167], v[92:95]
    ds_read_b64_tr_b16 v[136:137], v24 offset:10240
    buffer_load_dwordx4 v[156:159], v6, s[16:19], s50 offen offset:256 sc1
    v_mfma_f32_16x16x32_bf16 v[88:91], v[140:143], v[160:163], v[88:91]
    ds_read_b64_tr_b16 v[138:139], v24 offset:10752
    v_mfma_f32_16x16x32_bf16 v[104:107], v[160:163], v[144:147], v[104:107]
    ds_read_b64_tr_b16 v[140:141], v25 offset:10240
    v_mfma_f32_16x16x32_bf16 v[108:111], v[164:167], v[144:147], v[108:111]
    ds_read_b64_tr_b16 v[142:143], v25 offset:10752
    v_mfma_f32_16x16x32_bf16 v[124:127], v[164:167], v[148:151], v[124:127]
    ds_read_b64_tr_b16 v[144:145], v24 offset:18432
    v_mfma_f32_16x16x32_bf16 v[120:123], v[160:163], v[148:151], v[120:123]
    ds_read_b64_tr_b16 v[146:147], v24 offset:18944
    s_waitcnt vmcnt(12) lgkmcnt(8)
    v_mfma_f32_16x16x32_bf16 v[32:35], v[128:131], v[168:171], v[32:35]
    ds_read_b64_tr_b16 v[148:149], v25 offset:18432
    buffer_load_dwordx4 v[160:163], v6, s[20:23], s58 offen offset:2048 sc1
    v_mfma_f32_16x16x32_bf16 v[36:39], v[128:131], v[172:175], v[36:39]
    ds_read_b64_tr_b16 v[150:151], v25 offset:18944
    s_waitcnt lgkmcnt(8)
    v_mfma_f32_16x16x32_bf16 v[52:55], v[132:135], v[172:175], v[52:55]
    v_mfma_f32_16x16x32_bf16 v[48:51], v[132:135], v[168:171], v[48:51]
    s_waitcnt lgkmcnt(6)
    v_mfma_f32_16x16x32_bf16 v[64:67], v[136:139], v[168:171], v[64:67]
    v_mfma_f32_16x16x32_bf16 v[68:71], v[136:139], v[172:175], v[68:71]
    s_waitcnt lgkmcnt(4)
    v_mfma_f32_16x16x32_bf16 v[84:87], v[140:143], v[172:175], v[84:87]
    buffer_load_dwordx4 v[164:167], v6, s[20:23], s58 offen offset:2304 sc1
    v_mfma_f32_16x16x32_bf16 v[80:83], v[140:143], v[168:171], v[80:83]
    s_waitcnt lgkmcnt(2)
    v_mfma_f32_16x16x32_bf16 v[96:99], v[168:171], v[144:147], v[96:99]
    v_mfma_f32_16x16x32_bf16 v[100:103], v[172:175], v[144:147], v[100:103]
    s_waitcnt lgkmcnt(0)
    v_mfma_f32_16x16x32_bf16 v[116:119], v[172:175], v[148:151], v[116:119]
    v_mfma_f32_16x16x32_bf16 v[112:115], v[168:171], v[148:151], v[112:115]
    s_waitcnt vmcnt(12)
    v_mfma_f32_16x16x32_bf16 v[40:43], v[128:131], v[176:179], v[40:43]
    buffer_load_dwordx4 v[168:171], v6, s[16:19], s50 offen offset:2048 sc1
    v_mfma_f32_16x16x32_bf16 v[44:47], v[128:131], v[180:183], v[44:47]
    v_mfma_f32_16x16x32_bf16 v[60:63], v[132:135], v[180:183], v[60:63]
    ds_read_b64_tr_b16 v[128:129], v24 offset:4096
    v_mfma_f32_16x16x32_bf16 v[56:59], v[132:135], v[176:179], v[56:59]
    ds_read_b64_tr_b16 v[130:131], v24 offset:4608
    v_mfma_f32_16x16x32_bf16 v[72:75], v[136:139], v[176:179], v[72:75]
    ds_read_b64_tr_b16 v[132:133], v25 offset:4096
    v_mfma_f32_16x16x32_bf16 v[76:79], v[136:139], v[180:183], v[76:79]
    ds_read_b64_tr_b16 v[134:135], v25 offset:4608
    v_mfma_f32_16x16x32_bf16 v[92:95], v[140:143], v[180:183], v[92:95]
    ds_read_b64_tr_b16 v[136:137], v24 offset:12288
    buffer_load_dwordx4 v[172:175], v6, s[16:19], s50 offen offset:2304 sc1
    v_mfma_f32_16x16x32_bf16 v[88:91], v[140:143], v[176:179], v[88:91]
    ds_read_b64_tr_b16 v[138:139], v24 offset:12800
    v_mfma_f32_16x16x32_bf16 v[104:107], v[176:179], v[144:147], v[104:107]
    ds_read_b64_tr_b16 v[140:141], v25 offset:12288
    v_mfma_f32_16x16x32_bf16 v[108:111], v[180:183], v[144:147], v[108:111]
    ds_read_b64_tr_b16 v[142:143], v25 offset:12800
    v_mfma_f32_16x16x32_bf16 v[124:127], v[180:183], v[148:151], v[124:127]
    ds_read_b64_tr_b16 v[144:145], v24 offset:20480
    v_mfma_f32_16x16x32_bf16 v[120:123], v[176:179], v[148:151], v[120:123]
    ds_read_b64_tr_b16 v[146:147], v24 offset:20992
    s_waitcnt vmcnt(12) lgkmcnt(8)
    v_mfma_f32_16x16x32_bf16 v[32:35], v[128:131], a[0:3], v[32:35]
    ds_read_b64_tr_b16 v[148:149], v25 offset:20480
    buffer_load_dwordx4 v[176:179], v6, s[20:23], s59 offen offset:0 sc1
    v_mfma_f32_16x16x32_bf16 v[36:39], v[128:131], a[4:7], v[36:39]
    ds_read_b64_tr_b16 v[150:151], v25 offset:20992
    s_waitcnt lgkmcnt(8)
    v_mfma_f32_16x16x32_bf16 v[52:55], v[132:135], a[4:7], v[52:55]
    s_add_u32 s58, s58, 8192
    v_mfma_f32_16x16x32_bf16 v[48:51], v[132:135], a[0:3], v[48:51]
    s_waitcnt lgkmcnt(6)
    v_mfma_f32_16x16x32_bf16 v[64:67], v[136:139], a[0:3], v[64:67]
    s_add_u32 s50, s50, 8192
    v_mfma_f32_16x16x32_bf16 v[68:71], v[136:139], a[4:7], v[68:71]
    s_waitcnt lgkmcnt(4)
    v_mfma_f32_16x16x32_bf16 v[84:87], v[140:143], a[4:7], v[84:87]
    buffer_load_dwordx4 v[180:183], v6, s[20:23], s59 offen offset:256 sc1
    v_mfma_f32_16x16x32_bf16 v[80:83], v[140:143], a[0:3], v[80:83]
    s_waitcnt lgkmcnt(2)
    v_mfma_f32_16x16x32_bf16 v[96:99], a[0:3], v[144:147], v[96:99]
    s_add_u32 s52, s52, 24576
    v_mfma_f32_16x16x32_bf16 v[100:103], a[4:7], v[144:147], v[100:103]
    s_cmp_eq_u32 s52, 147456
    s_waitcnt lgkmcnt(0)
    v_mfma_f32_16x16x32_bf16 v[116:119], a[4:7], v[148:151], v[116:119]
    s_cselect_b32 s52, 0, s52
    v_mfma_f32_16x16x32_bf16 v[112:115], a[0:3], v[148:151], v[112:115]
    s_waitcnt vmcnt(12)
    v_mfma_f32_16x16x32_bf16 v[40:43], v[128:131], a[8:11], v[40:43]
    buffer_load_dwordx4 a[0:3], v6, s[16:19], s51 offen offset:0 sc1
    v_mfma_f32_16x16x32_bf16 v[44:47], v[128:131], a[12:15], v[44:47]
    s_sub_u32 s54, s54, 1
    v_mfma_f32_16x16x32_bf16 v[60:63], v[132:135], a[12:15], v[60:63]
    ds_read_b64_tr_b16 v[128:129], v24 offset:6144
    v_mfma_f32_16x16x32_bf16 v[56:59], v[132:135], a[8:11], v[56:59]
    ds_read_b64_tr_b16 v[130:131], v24 offset:6656
    v_mfma_f32_16x16x32_bf16 v[72:75], v[136:139], a[8:11], v[72:75]
    ds_read_b64_tr_b16 v[132:133], v25 offset:6144
    v_mfma_f32_16x16x32_bf16 v[76:79], v[136:139], a[12:15], v[76:79]
    ds_read_b64_tr_b16 v[134:135], v25 offset:6656
    v_mfma_f32_16x16x32_bf16 v[92:95], v[140:143], a[12:15], v[92:95]
    ds_read_b64_tr_b16 v[136:137], v24 offset:14336
    buffer_load_dwordx4 a[4:7], v6, s[16:19], s51 offen offset:256 sc1
    v_mfma_f32_16x16x32_bf16 v[88:91], v[140:143], a[8:11], v[88:91]
    ds_read_b64_tr_b16 v[138:139], v24 offset:14848
    v_mfma_f32_16x16x32_bf16 v[104:107], a[8:11], v[144:147], v[104:107]
    ds_read_b64_tr_b16 v[140:141], v25 offset:14336
    v_mfma_f32_16x16x32_bf16 v[108:111], a[12:15], v[144:147], v[108:111]
    ds_read_b64_tr_b16 v[142:143], v25 offset:14848
    v_mfma_f32_16x16x32_bf16 v[124:127], a[12:15], v[148:151], v[124:127]
    ds_read_b64_tr_b16 v[144:145], v24 offset:22528
    v_mfma_f32_16x16x32_bf16 v[120:123], a[8:11], v[148:151], v[120:123]
    ds_read_b64_tr_b16 v[146:147], v24 offset:23040
    s_waitcnt vmcnt(12) lgkmcnt(8)
    v_mfma_f32_16x16x32_bf16 v[32:35], v[128:131], a[16:19], v[32:35]
    ds_read_b64_tr_b16 v[148:149], v25 offset:22528
    buffer_load_dwordx4 a[8:11], v6, s[20:23], s59 offen offset:2048 sc1
    v_mfma_f32_16x16x32_bf16 v[36:39], v[128:131], a[20:23], v[36:39]
    ds_read_b64_tr_b16 v[150:151], v25 offset:23040
    s_waitcnt lgkmcnt(8)
    v_mfma_f32_16x16x32_bf16 v[52:55], v[132:135], a[20:23], v[52:55]
    v_add_u32 v24, s52, v26
    v_mfma_f32_16x16x32_bf16 v[48:51], v[132:135], a[16:19], v[48:51]
    s_waitcnt lgkmcnt(6)
    v_mfma_f32_16x16x32_bf16 v[64:67], v[136:139], a[16:19], v[64:67]
    v_add_u32 v25, s52, v27
    v_mfma_f32_16x16x32_bf16 v[68:71], v[136:139], a[20:23], v[68:71]
    s_waitcnt lgkmcnt(4)
    v_mfma_f32_16x16x32_bf16 v[84:87], v[140:143], a[20:23], v[84:87]
    buffer_load_dwordx4 a[12:15], v6, s[20:23], s59 offen offset:2304 sc1
    v_mfma_f32_16x16x32_bf16 v[80:83], v[140:143], a[16:19], v[80:83]
    s_waitcnt lgkmcnt(2)
    v_mfma_f32_16x16x32_bf16 v[96:99], a[16:19], v[144:147], v[96:99]
    s_add_u32 s59, s59, 8192
    v_mfma_f32_16x16x32_bf16 v[100:103], a[20:23], v[144:147], v[100:103]
    s_waitcnt lgkmcnt(0)
    v_mfma_f32_16x16x32_bf16 v[116:119], a[20:23], v[148:151], v[116:119]
    v_mfma_f32_16x16x32_bf16 v[112:115], a[16:19], v[148:151], v[112:115]
    s_barrier
    s_waitcnt vmcnt(12)
    v_mfma_f32_16x16x32_bf16 v[40:43], v[128:131], a[24:27], v[40:43]
    buffer_load_dwordx4 a[16:19], v6, s[16:19], s51 offen offset:2048 sc1
    v_mfma_f32_16x16x32_bf16 v[44:47], v[128:131], a[28:31], v[44:47]
    v_mfma_f32_16x16x32_bf16 v[60:63], v[132:135], a[28:31], v[60:63]
    ds_read_b64_tr_b16 v[128:129], v24 offset:0
    v_mfma_f32_16x16x32_bf16 v[56:59], v[132:135], a[24:27], v[56:59]
    ds_read_b64_tr_b16 v[130:131], v24 offset:512
    v_mfma_f32_16x16x32_bf16 v[72:75], v[136:139], a[24:27], v[72:75]
    ds_read_b64_tr_b16 v[132:133], v25 offset:0
    v_mfma_f32_16x16x32_bf16 v[76:79], v[136:139], a[28:31], v[76:79]
    ds_read_b64_tr_b16 v[134:135], v25 offset:512
    v_mfma_f32_16x16x32_bf16 v[92:95], v[140:143], a[28:31], v[92:95]
    ds_read_b64_tr_b16 v[136:137], v24 offset:8192
    buffer_load_dwordx4 a[20:23], v6, s[16:19], s51 offen offset:2304 sc1
    v_mfma_f32_16x16x32_bf16 v[88:91], v[140:143], a[24:27], v[88:91]
    ds_read_b64_tr_b16 v[138:139], v24 offset:8704
    v_mfma_f32_16x16x32_bf16 v[104:107], a[24:27], v[144:147], v[104:107]
    ds_read_b64_tr_b16 v[140:141], v25 offset:8192
    s_add_u32 s51, s51, 8192
    v_mfma_f32_16x16x32_bf16 v[108:111], a[28:31], v[144:147], v[108:111]
    ds_read_b64_tr_b16 v[142:143], v25 offset:8704
    v_mfma_f32_16x16x32_bf16 v[124:127], a[28:31], v[148:151], v[124:127]
    ds_read_b64_tr_b16 v[144:145], v24 offset:16384
    s_cmp_lg_u32 s54, 0
    v_mfma_f32_16x16x32_bf16 v[120:123], a[24:27], v[148:151], v[120:123]
    ds_read_b64_tr_b16 v[146:147], v24 offset:16896
    s_cbranch_scc1 c_qkvB_loop
    s_waitcnt vmcnt(12) lgkmcnt(8)
    v_mfma_f32_16x16x32_bf16 v[32:35], v[128:131], v[152:155], v[32:35]
    ds_read_b64_tr_b16 v[148:149], v25 offset:16384
    buffer_load_dwordx4 a[24:27], v6, s[20:23], s58 offen offset:0 sc1
    v_mfma_f32_16x16x32_bf16 v[36:39], v[128:131], v[156:159], v[36:39]
    ds_read_b64_tr_b16 v[150:151], v25 offset:16896
    s_waitcnt lgkmcnt(8)
    v_mfma_f32_16x16x32_bf16 v[52:55], v[132:135], v[156:159], v[52:55]
    ds_read_b32 v184, v8 offset:1280
    v_mfma_f32_16x16x32_bf16 v[48:51], v[132:135], v[152:155], v[48:51]
    ds_read_b32 v186, v8 offset:1344
    s_waitcnt lgkmcnt(8)
    v_mfma_f32_16x16x32_bf16 v[64:67], v[136:139], v[152:155], v[64:67]
    ds_read_b32 v188, v8 offset:1408
    v_mfma_f32_16x16x32_bf16 v[68:71], v[136:139], v[156:159], v[68:71]
    s_waitcnt lgkmcnt(7)
    v_mfma_f32_16x16x32_bf16 v[84:87], v[140:143], v[156:159], v[84:87]
    buffer_load_dwordx4 a[28:31], v6, s[20:23], s58 offen offset:256 sc1
    ds_read_b32 v190, v8 offset:1472
    v_mfma_f32_16x16x32_bf16 v[80:83], v[140:143], v[152:155], v[80:83]
    ds_read_b128 v[212:215], v10 offset:512
    s_waitcnt lgkmcnt(7)
    v_mfma_f32_16x16x32_bf16 v[96:99], v[152:155], v[144:147], v[96:99]
    ds_read_b128 v[216:219], v10 offset:576
    v_mfma_f32_16x16x32_bf16 v[100:103], v[156:159], v[144:147], v[100:103]
    s_waitcnt lgkmcnt(6)
    v_mfma_f32_16x16x32_bf16 v[116:119], v[156:159], v[148:151], v[116:119]
    v_mfma_f32_16x16x32_bf16 v[112:115], v[152:155], v[148:151], v[112:115]
    s_waitcnt vmcnt(12)
    v_mfma_f32_16x16x32_bf16 v[40:43], v[128:131], v[160:163], v[40:43]
    s_waitcnt lgkmcnt(0)
    v_fma_f32 v64, -v184, v212, v64
    v_fma_f32 v65, -v184, v213, v65
    v_mfma_f32_16x16x32_bf16 v[44:47], v[128:131], v[164:167], v[44:47]
    v_fma_f32 v66, -v184, v214, v66
    v_mfma_f32_16x16x32_bf16 v[60:63], v[132:135], v[164:167], v[60:63]
    ds_read_b64_tr_b16 v[128:129], v24 offset:2048
    v_fma_f32 v67, -v184, v215, v67
    v_mfma_f32_16x16x32_bf16 v[56:59], v[132:135], v[160:163], v[56:59]
    ds_read_b64_tr_b16 v[130:131], v24 offset:2560
    v_fma_f32 v68, -v186, v212, v68
    v_fma_f32 v69, -v186, v213, v69
    v_mfma_f32_16x16x32_bf16 v[72:75], v[136:139], v[160:163], v[72:75]
    ds_read_b64_tr_b16 v[132:133], v25 offset:2048
    v_fma_f32 v70, -v186, v214, v70
    v_mfma_f32_16x16x32_bf16 v[76:79], v[136:139], v[164:167], v[76:79]
    ds_read_b64_tr_b16 v[134:135], v25 offset:2560
    v_fma_f32 v71, -v186, v215, v71
    v_mfma_f32_16x16x32_bf16 v[92:95], v[140:143], v[164:167], v[92:95]
    ds_read_b64_tr_b16 v[136:137], v24 offset:10240
    v_fma_f32 v80, -v184, v216, v80
    v_fma_f32 v81, -v184, v217, v81
    v_mfma_f32_16x16x32_bf16 v[88:91], v[140:143], v[160:163], v[88:91]
    ds_read_b64_tr_b16 v[138:139], v24 offset:10752
    v_fma_f32 v82, -v184, v218, v82
    v_mfma_f32_16x16x32_bf16 v[104:107], v[160:163], v[144:147], v[104:107]
    ds_read_b64_tr_b16 v[140:141], v25 offset:10240
    v_fma_f32 v83, -v184, v219, v83
    v_mfma_f32_16x16x32_bf16 v[108:111], v[164:167], v[144:147], v[108:111]
    ds_read_b64_tr_b16 v[142:143], v25 offset:10752
    v_fma_f32 v84, -v186, v216, v84
    v_fma_f32 v85, -v186, v217, v85
    v_mfma_f32_16x16x32_bf16 v[124:127], v[164:167], v[148:151], v[124:127]
    ds_read_b64_tr_b16 v[144:145], v24 offset:18432
    v_fma_f32 v86, -v186, v218, v86
    v_mfma_f32_16x16x32_bf16 v[120:123], v[160:163], v[148:151], v[120:123]
    ds_read_b64_tr_b16 v[146:147], v24 offset:18944
    v_fma_f32 v87, -v186, v219, v87
    s_waitcnt vmcnt(10) lgkmcnt(8)
    v_mfma_f32_16x16x32_bf16 v[32:35], v[128:131], v[168:171], v[32:35]
    ds_read_b64_tr_b16 v[148:149], v25 offset:18432
    v_fma_f32 v72, -v188, v212, v72
    v_fma_f32 v73, -v188, v213, v73
    v_mfma_f32_16x16x32_bf16 v[36:39], v[128:131], v[172:175], v[36:39]
    ds_read_b64_tr_b16 v[150:151], v25 offset:18944
    v_fma_f32 v74, -v188, v214, v74
    s_waitcnt lgkmcnt(8)
    v_mfma_f32_16x16x32_bf16 v[52:55], v[132:135], v[172:175], v[52:55]
    v_fma_f32 v75, -v188, v215, v75
    ds_read_b128 v[152:155], v10 offset:384
    v_mfma_f32_16x16x32_bf16 v[48:51], v[132:135], v[168:171], v[48:51]
    v_fma_f32 v76, -v190, v212, v76
    v_fma_f32 v77, -v190, v213, v77
    ds_read_b128 v[156:159], v10 offset:448
    s_waitcnt lgkmcnt(8)
    v_mfma_f32_16x16x32_bf16 v[64:67], v[136:139], v[168:171], v[64:67]
    v_fma_f32 v78, -v190, v214, v78
    ds_read_b32 v185, v8 offset:2816
    v_mfma_f32_16x16x32_bf16 v[68:71], v[136:139], v[172:175], v[68:71]
    v_fma_f32 v79, -v190, v215, v79
    s_waitcnt lgkmcnt(7)
    v_mfma_f32_16x16x32_bf16 v[84:87], v[140:143], v[172:175], v[84:87]
    v_fma_f32 v88, -v188, v216, v88
    v_fma_f32 v89, -v188, v217, v89
    ds_read_b32 v187, v8 offset:2880
    v_mfma_f32_16x16x32_bf16 v[80:83], v[140:143], v[168:171], v[80:83]
    v_fma_f32 v90, -v188, v218, v90
    ds_read_b32 v189, v8 offset:2944
    s_waitcnt lgkmcnt(7)
    v_mfma_f32_16x16x32_bf16 v[96:99], v[168:171], v[144:147], v[96:99]
    v_fma_f32 v91, -v188, v219, v91
    ds_read_b32 v191, v8 offset:3008
    v_mfma_f32_16x16x32_bf16 v[100:103], v[172:175], v[144:147], v[100:103]
    v_fma_f32 v92, -v190, v216, v92
    v_fma_f32 v93, -v190, v217, v93
    s_waitcnt lgkmcnt(6)
    v_mfma_f32_16x16x32_bf16 v[116:119], v[172:175], v[148:151], v[116:119]
    v_fma_f32 v94, -v190, v218, v94
    v_mfma_f32_16x16x32_bf16 v[112:115], v[168:171], v[148:151], v[112:115]
    v_fma_f32 v95, -v190, v219, v95
    s_waitcnt vmcnt(8)
    v_mfma_f32_16x16x32_bf16 v[40:43], v[128:131], v[176:179], v[40:43]
    s_waitcnt lgkmcnt(0)
    v_fma_f32 v32, -v184, v152, v32
    v_fma_f32 v33, -v184, v153, v33
    v_mfma_f32_16x16x32_bf16 v[44:47], v[128:131], v[180:183], v[44:47]
    v_fma_f32 v34, -v184, v154, v34
    v_mfma_f32_16x16x32_bf16 v[60:63], v[132:135], v[180:183], v[60:63]
    ds_read_b64_tr_b16 v[128:129], v24 offset:4096
    v_fma_f32 v35, -v184, v155, v35
    v_fma_f32 v36, -v186, v152, v36
    v_mfma_f32_16x16x32_bf16 v[56:59], v[132:135], v[176:179], v[56:59]
    ds_read_b64_tr_b16 v[130:131], v24 offset:4608
    v_fma_f32 v37, -v186, v153, v37
    v_mfma_f32_16x16x32_bf16 v[72:75], v[136:139], v[176:179], v[72:75]
    ds_read_b64_tr_b16 v[132:133], v25 offset:4096
    v_fma_f32 v38, -v186, v154, v38
    v_fma_f32 v39, -v186, v155, v39
    v_mfma_f32_16x16x32_bf16 v[76:79], v[136:139], v[180:183], v[76:79]
    ds_read_b64_tr_b16 v[134:135], v25 offset:4608
    v_fma_f32 v48, -v184, v156, v48
    v_mfma_f32_16x16x32_bf16 v[92:95], v[140:143], v[180:183], v[92:95]
    ds_read_b64_tr_b16 v[136:137], v24 offset:12288
    v_fma_f32 v49, -v184, v157, v49
    v_fma_f32 v50, -v184, v158, v50
    v_mfma_f32_16x16x32_bf16 v[88:91], v[140:143], v[176:179], v[88:91]
    ds_read_b64_tr_b16 v[138:139], v24 offset:12800
    v_fma_f32 v51, -v184, v159, v51
    v_mfma_f32_16x16x32_bf16 v[104:107], v[176:179], v[144:147], v[104:107]
    ds_read_b64_tr_b16 v[140:141], v25 offset:12288
    v_fma_f32 v52, -v186, v156, v52
    v_fma_f32 v53, -v186, v157, v53
    v_mfma_f32_16x16x32_bf16 v[108:111], v[180:183], v[144:147], v[108:111]
    ds_read_b64_tr_b16 v[142:143], v25 offset:12800
    v_fma_f32 v54, -v186, v158, v54
    v_mfma_f32_16x16x32_bf16 v[124:127], v[180:183], v[148:151], v[124:127]
    ds_read_b64_tr_b16 v[144:145], v24 offset:20480
    v_fma_f32 v55, -v186, v159, v55
    v_mfma_f32_16x16x32_bf16 v[120:123], v[176:179], v[148:151], v[120:123]
    ds_read_b64_tr_b16 v[146:147], v24 offset:20992
    s_waitcnt vmcnt(6) lgkmcnt(8)
    v_mfma_f32_16x16x32_bf16 v[32:35], v[128:131], a[0:3], v[32:35]
    ds_read_b64_tr_b16 v[148:149], v25 offset:20480
    v_fma_f32 v40, -v188, v152, v40
    v_fma_f32 v41, -v188, v153, v41
    v_mfma_f32_16x16x32_bf16 v[36:39], v[128:131], a[4:7], v[36:39]
    ds_read_b64_tr_b16 v[150:151], v25 offset:20992
    v_fma_f32 v42, -v188, v154, v42
    s_waitcnt lgkmcnt(8)
    v_mfma_f32_16x16x32_bf16 v[52:55], v[132:135], a[4:7], v[52:55]
    v_fma_f32 v43, -v188, v155, v43
    v_fma_f32 v44, -v190, v152, v44
    ds_read_b128 v[168:171], v9 offset:1280
    v_mfma_f32_16x16x32_bf16 v[48:51], v[132:135], a[0:3], v[48:51]
    v_fma_f32 v45, -v190, v153, v45
    ds_read_b128 v[172:175], v9 offset:1344
    s_waitcnt lgkmcnt(8)
    v_mfma_f32_16x16x32_bf16 v[64:67], v[136:139], a[0:3], v[64:67]
    v_fma_f32 v46, -v190, v154, v46
    v_fma_f32 v47, -v190, v155, v47
    v_mfma_f32_16x16x32_bf16 v[68:71], v[136:139], a[4:7], v[68:71]
    v_fma_f32 v56, -v188, v156, v56
    ds_read_b128 v[176:179], v9 offset:1408
    s_waitcnt lgkmcnt(7)
    v_mfma_f32_16x16x32_bf16 v[84:87], v[140:143], a[4:7], v[84:87]
    v_fma_f32 v57, -v188, v157, v57
    v_fma_f32 v58, -v188, v158, v58
    ds_read_b128 v[180:183], v9 offset:1472
    v_mfma_f32_16x16x32_bf16 v[80:83], v[140:143], a[0:3], v[80:83]
    v_fma_f32 v59, -v188, v159, v59
    s_waitcnt lgkmcnt(6)
    v_mfma_f32_16x16x32_bf16 v[96:99], a[0:3], v[144:147], v[96:99]
    v_fma_f32 v60, -v190, v156, v60
    v_fma_f32 v61, -v190, v157, v61
    ds_read2_b32 v[220:221], v11 offset0:160 offset1:176
    v_mfma_f32_16x16x32_bf16 v[100:103], a[4:7], v[144:147], v[100:103]
    v_fma_f32 v62, -v190, v158, v62
    s_waitcnt lgkmcnt(5)
    v_mfma_f32_16x16x32_bf16 v[116:119], a[4:7], v[148:151], v[116:119]
    v_fma_f32 v63, -v190, v159, v63
    v_mfma_f32_16x16x32_bf16 v[112:115], a[0:3], v[148:151], v[112:115]
    s_waitcnt vmcnt(4)
    v_mfma_f32_16x16x32_bf16 v[40:43], v[128:131], a[8:11], v[40:43]
    v_mfma_f32_16x16x32_bf16 v[44:47], v[128:131], a[12:15], v[44:47]
    s_waitcnt lgkmcnt(0)
    v_fma_f32 v96, -v168, v220, v96
    v_fma_f32 v97, -v169, v220, v97
    v_mfma_f32_16x16x32_bf16 v[60:63], v[132:135], a[12:15], v[60:63]
    ds_read_b64_tr_b16 v[128:129], v24 offset:6144
    v_fma_f32 v98, -v170, v220, v98
    v_mfma_f32_16x16x32_bf16 v[56:59], v[132:135], a[8:11], v[56:59]
    ds_read_b64_tr_b16 v[130:131], v24 offset:6656
    v_fma_f32 v99, -v171, v220, v99
    v_fma_f32 v100, -v172, v220, v100
    v_mfma_f32_16x16x32_bf16 v[72:75], v[136:139], a[8:11], v[72:75]
    ds_read_b64_tr_b16 v[132:133], v25 offset:6144
    v_fma_f32 v101, -v173, v220, v101
    v_mfma_f32_16x16x32_bf16 v[76:79], v[136:139], a[12:15], v[76:79]
    ds_read_b64_tr_b16 v[134:135], v25 offset:6656
    v_fma_f32 v102, -v174, v220, v102
    v_fma_f32 v103, -v175, v220, v103
    v_mfma_f32_16x16x32_bf16 v[92:95], v[140:143], a[12:15], v[92:95]
    ds_read_b64_tr_b16 v[136:137], v24 offset:14336
    v_fma_f32 v112, -v168, v221, v112
    v_mfma_f32_16x16x32_bf16 v[88:91], v[140:143], a[8:11], v[88:91]
    ds_read_b64_tr_b16 v[138:139], v24 offset:14848
    v_fma_f32 v113, -v169, v221, v113
    v_fma_f32 v114, -v170, v221, v114
    v_mfma_f32_16x16x32_bf16 v[104:107], a[8:11], v[144:147], v[104:107]
    ds_read_b64_tr_b16 v[140:141], v25 offset:14336
    v_fma_f32 v115, -v171, v221, v115
    v_mfma_f32_16x16x32_bf16 v[108:111], a[12:15], v[144:147], v[108:111]
    ds_read_b64_tr_b16 v[142:143], v25 offset:14848
    v_fma_f32 v116, -v172, v221, v116
    v_fma_f32 v117, -v173, v221, v117
    v_mfma_f32_16x16x32_bf16 v[124:127], a[12:15], v[148:151], v[124:127]
    ds_read_b64_tr_b16 v[144:145], v24 offset:22528
    v_fma_f32 v118, -v174, v221, v118
    v_mfma_f32_16x16x32_bf16 v[120:123], a[8:11], v[148:151], v[120:123]
    ds_read_b64_tr_b16 v[146:147], v24 offset:23040
    v_fma_f32 v119, -v175, v221, v119
    s_waitcnt vmcnt(2) lgkmcnt(8)
    v_mfma_f32_16x16x32_bf16 v[32:35], v[128:131], a[16:19], v[32:35]
    ds_read_b64_tr_b16 v[148:149], v25 offset:22528
    v_mfma_f32_16x16x32_bf16 v[36:39], v[128:131], a[20:23], v[36:39]
    ds_read_b64_tr_b16 v[150:151], v25 offset:23040
    v_fma_f32 v104, -v176, v220, v104
    v_fma_f32 v105, -v177, v220, v105
    s_waitcnt lgkmcnt(8)
    v_mfma_f32_16x16x32_bf16 v[52:55], v[132:135], a[20:23], v[52:55]
    v_fma_f32 v106, -v178, v220, v106
    ds_read_b128 v[152:155], v9 offset:2816
    v_mfma_f32_16x16x32_bf16 v[48:51], v[132:135], a[16:19], v[48:51]
    v_fma_f32 v107, -v179, v220, v107
    v_fma_f32 v108, -v180, v220, v108
    s_waitcnt lgkmcnt(7)
    v_mfma_f32_16x16x32_bf16 v[64:67], v[136:139], a[16:19], v[64:67]
    v_fma_f32 v109, -v181, v220, v109
    ds_read_b128 v[156:159], v9 offset:2880
    v_mfma_f32_16x16x32_bf16 v[68:71], v[136:139], a[20:23], v[68:71]
    v_fma_f32 v110, -v182, v220, v110
    v_fma_f32 v111, -v183, v220, v111
    s_waitcnt lgkmcnt(6)
    v_mfma_f32_16x16x32_bf16 v[84:87], v[140:143], a[20:23], v[84:87]
    v_fma_f32 v120, -v176, v221, v120
    ds_read_b128 v[160:163], v9 offset:2944
    v_mfma_f32_16x16x32_bf16 v[80:83], v[140:143], a[16:19], v[80:83]
    v_fma_f32 v121, -v177, v221, v121
    v_fma_f32 v122, -v178, v221, v122
    s_waitcnt lgkmcnt(5)
    v_mfma_f32_16x16x32_bf16 v[96:99], a[16:19], v[144:147], v[96:99]
    v_fma_f32 v123, -v179, v221, v123
    ds_read_b128 v[164:167], v9 offset:3008
    v_mfma_f32_16x16x32_bf16 v[100:103], a[20:23], v[144:147], v[100:103]
    v_fma_f32 v124, -v180, v221, v124
    v_fma_f32 v125, -v181, v221, v125
    s_waitcnt lgkmcnt(4)
    v_mfma_f32_16x16x32_bf16 v[116:119], a[20:23], v[148:151], v[116:119]
    v_fma_f32 v126, -v182, v221, v126
    v_mfma_f32_16x16x32_bf16 v[112:115], a[16:19], v[148:151], v[112:115]
    v_fma_f32 v127, -v183, v221, v127
    s_barrier
    s_waitcnt vmcnt(0)
    v_mfma_f32_16x16x32_bf16 v[40:43], v[128:131], a[24:27], v[40:43]
    v_mul_f32 v64, v185, v64
    v_mul_f32 v65, v185, v65
    v_mfma_f32_16x16x32_bf16 v[44:47], v[128:131], a[28:31], v[44:47]
    v_mul_f32 v66, v185, v66
    v_mul_f32 v67, v185, v67
    v_mfma_f32_16x16x32_bf16 v[60:63], v[132:135], a[28:31], v[60:63]
    v_mul_f32 v80, v185, v80
    v_mul_f32 v81, v185, v81
    v_mfma_f32_16x16x32_bf16 v[56:59], v[132:135], a[24:27], v[56:59]
    v_mul_f32 v82, v185, v82
    v_mul_f32 v83, v185, v83
    v_mfma_f32_16x16x32_bf16 v[72:75], v[136:139], a[24:27], v[72:75]
    v_cvt_pk_bf16_f32 v64, v64, v65
    v_cvt_pk_bf16_f32 v65, v66, v67
    v_mfma_f32_16x16x32_bf16 v[76:79], v[136:139], a[28:31], v[76:79]
    v_cvt_pk_bf16_f32 v66, v80, v81
    v_cvt_pk_bf16_f32 v67, v82, v83
    v_mfma_f32_16x16x32_bf16 v[92:95], v[140:143], a[28:31], v[92:95]
    v_mul_f32 v68, v187, v68
    v_mul_f32 v69, v187, v69
    v_mfma_f32_16x16x32_bf16 v[88:91], v[140:143], a[24:27], v[88:91]
    v_mul_f32 v70, v187, v70
    v_mul_f32 v71, v187, v71
    v_mfma_f32_16x16x32_bf16 v[104:107], a[24:27], v[144:147], v[104:107]
    v_mul_f32 v84, v187, v84
    v_mul_f32 v85, v187, v85
    v_mfma_f32_16x16x32_bf16 v[108:111], a[28:31], v[144:147], v[108:111]
    v_mul_f32 v86, v187, v86
    v_mul_f32 v87, v187, v87
    v_mfma_f32_16x16x32_bf16 v[124:127], a[28:31], v[148:151], v[124:127]
    v_cvt_pk_bf16_f32 v68, v68, v69
    v_cvt_pk_bf16_f32 v69, v70, v71
    v_mfma_f32_16x16x32_bf16 v[120:123], a[24:27], v[148:151], v[120:123]
    v_cvt_pk_bf16_f32 v70, v84, v85
    v_cvt_pk_bf16_f32 v71, v86, v87
    buffer_store_dwordx4 v[64:67], v12, s[12:15], s84 offen offset:0 sc1
    ds_write_b128 v12, v[64:67] offset:0
    buffer_store_dwordx4 v[68:71], v12, s[12:15], s84 offen offset:256 sc1
    ds_write_b128 v12, v[68:71] offset:256
    v_pk_mul_f32 v[72:73], v[188:189], v[72:73] op_sel:[1,0] op_sel_hi:[1,1]
    v_pk_mul_f32 v[74:75], v[188:189], v[74:75] op_sel:[1,0] op_sel_hi:[1,1]
    v_pk_mul_f32 v[88:89], v[188:189], v[88:89] op_sel:[1,0] op_sel_hi:[1,1]
    v_pk_mul_f32 v[90:91], v[188:189], v[90:91] op_sel:[1,0] op_sel_hi:[1,1]
    v_cvt_pk_bf16_f32 v72, v72, v73
    v_cvt_pk_bf16_f32 v73, v74, v75
    v_cvt_pk_bf16_f32 v74, v88, v89
    v_cvt_pk_bf16_f32 v75, v90, v91
    buffer_store_dwordx4 v[72:75], v12, s[12:15], s84 offen offset:2048 sc1
    ds_write_b128 v12, v[72:75] offset:2048
    v_pk_mul_f32 v[76:77], v[190:191], v[76:77] op_sel:[1,0] op_sel_hi:[1,1]
    v_pk_mul_f32 v[78:79], v[190:191], v[78:79] op_sel:[1,0] op_sel_hi:[1,1]
    v_pk_mul_f32 v[92:93], v[190:191], v[92:93] op_sel:[1,0] op_sel_hi:[1,1]
    v_pk_mul_f32 v[94:95], v[190:191], v[94:95] op_sel:[1,0] op_sel_hi:[1,1]
    v_cvt_pk_bf16_f32 v76, v76, v77
    v_cvt_pk_bf16_f32 v77, v78, v79
    v_cvt_pk_bf16_f32 v78, v92, v93
    v_cvt_pk_bf16_f32 v79, v94, v95
    buffer_store_dwordx4 v[76:79], v12, s[12:15], s84 offen offset:2304 sc1
    ds_write_b128 v12, v[76:79] offset:2304
    s_waitcnt lgkmcnt(4)
    v_pk_mul_f32 v[96:97], v[152:153], v[96:97]
    v_pk_mul_f32 v[98:99], v[154:155], v[98:99]
    v_pk_mul_f32 v[112:113], v[152:153], v[112:113]
    v_pk_mul_f32 v[114:115], v[154:155], v[114:115]
    v_cvt_pk_bf16_f32 v96, v96, v97
    v_cvt_pk_bf16_f32 v97, v98, v99
    v_cvt_pk_bf16_f32 v98, v112, v113
    v_cvt_pk_bf16_f32 v99, v114, v115
    v_mul_f32 v185, 0x3e8293ee, v185
    v_permlane16_swap_b32 v96, v98
    v_permlane16_swap_b32 v97, v99
    buffer_store_dwordx4 v[96:99], v13, s[12:15], s85 offen offset:0 sc1
    ds_write_b128 v13, v[96:99] offset:8192
    v_pk_mul_f32 v[100:101], v[156:157], v[100:101]
    v_pk_mul_f32 v[102:103], v[158:159], v[102:103]
    v_pk_mul_f32 v[116:117], v[156:157], v[116:117]
    v_pk_mul_f32 v[118:119], v[158:159], v[118:119]
    v_cvt_pk_bf16_f32 v100, v100, v101
    v_cvt_pk_bf16_f32 v101, v102, v103
    v_cvt_pk_bf16_f32 v102, v116, v117
    v_cvt_pk_bf16_f32 v103, v118, v119
    v_mul_f32 v187, 0x3e8293ee, v187
    v_permlane16_swap_b32 v100, v102
    v_permlane16_swap_b32 v101, v103
    buffer_store_dwordx4 v[100:103], v13, s[12:15], s85 offen offset:1024 sc1
    ds_write_b128 v13, v[100:103] offset:9216
    v_pk_mul_f32 v[104:105], v[160:161], v[104:105]
    v_pk_mul_f32 v[106:107], v[162:163], v[106:107]
    v_pk_mul_f32 v[120:121], v[160:161], v[120:121]
    v_pk_mul_f32 v[122:123], v[162:163], v[122:123]
    v_cvt_pk_bf16_f32 v104, v104, v105
    v_cvt_pk_bf16_f32 v105, v106, v107
    v_cvt_pk_bf16_f32 v106, v120, v121
    v_cvt_pk_bf16_f32 v107, v122, v123
    v_mul_f32 v189, 0x3e8293ee, v189
    v_permlane16_swap_b32 v104, v106
    v_permlane16_swap_b32 v105, v107
    buffer_store_dwordx4 v[104:107], v13, s[12:15], s85 offen offset:2048 sc1
    ds_write_b128 v13, v[104:107] offset:10240
    v_pk_mul_f32 v[108:109], v[164:165], v[108:109]
    v_pk_mul_f32 v[110:111], v[166:167], v[110:111]
    v_pk_mul_f32 v[124:125], v[164:165], v[124:125]
    v_pk_mul_f32 v[126:127], v[166:167], v[126:127]
    v_cvt_pk_bf16_f32 v108, v108, v109
    v_cvt_pk_bf16_f32 v109, v110, v111
    v_cvt_pk_bf16_f32 v110, v124, v125
    v_cvt_pk_bf16_f32 v111, v126, v127
    v_mul_f32 v191, 0x3e8293ee, v191
    v_permlane16_swap_b32 v108, v110
    v_permlane16_swap_b32 v109, v111
    buffer_store_dwordx4 v[108:111], v13, s[12:15], s85 offen offset:3072 sc1
    ds_write_b128 v13, v[108:111] offset:11264
    v_add_u32 v24, 81920, v5
    s_waitcnt lgkmcnt(0)
    s_barrier
    ds_read_b128 v[128:131], v24 offset:0
    ds_read_b128 v[132:135], v24 offset:1024
    ds_read_b128 v[136:139], v24 offset:2048
    ds_read_b128 v[140:143], v24 offset:3072
    v_pk_mul_f32 v[32:33], v[184:185], v[32:33] op_sel:[1,0] op_sel_hi:[1,1]
    v_pk_mul_f32 v[34:35], v[184:185], v[34:35] op_sel:[1,0] op_sel_hi:[1,1]
    v_pk_mul_f32 v[48:49], v[184:185], v[48:49] op_sel:[1,0] op_sel_hi:[1,1]
    v_pk_mul_f32 v[50:51], v[184:185], v[50:51] op_sel:[1,0] op_sel_hi:[1,1]
    v_cvt_pk_bf16_f32 v8, v32, v33
    v_cvt_pk_bf16_f32 v9, v34, v35
    v_cvt_pk_bf16_f32 v10, v48, v49
    v_cvt_pk_bf16_f32 v11, v50, v51
    v_pk_mul_f32 v[36:37], v[186:187], v[36:37] op_sel:[1,0] op_sel_hi:[1,1]
    v_pk_mul_f32 v[38:39], v[186:187], v[38:39] op_sel:[1,0] op_sel_hi:[1,1]
    v_pk_mul_f32 v[52:53], v[186:187], v[52:53] op_sel:[1,0] op_sel_hi:[1,1]
    v_pk_mul_f32 v[54:55], v[186:187], v[54:55] op_sel:[1,0] op_sel_hi:[1,1]
    v_cvt_pk_bf16_f32 v12, v36, v37
    v_cvt_pk_bf16_f32 v13, v38, v39
    v_cvt_pk_bf16_f32 v14, v52, v53
    v_cvt_pk_bf16_f32 v15, v54, v55
    v_pk_mul_f32 v[40:41], v[188:189], v[40:41] op_sel:[1,0] op_sel_hi:[1,1]
    v_pk_mul_f32 v[42:43], v[188:189], v[42:43] op_sel:[1,0] op_sel_hi:[1,1]
    v_pk_mul_f32 v[56:57], v[188:189], v[56:57] op_sel:[1,0] op_sel_hi:[1,1]
    v_pk_mul_f32 v[58:59], v[188:189], v[58:59] op_sel:[1,0] op_sel_hi:[1,1]
    v_cvt_pk_bf16_f32 v16, v40, v41
    v_cvt_pk_bf16_f32 v17, v42, v43
    v_cvt_pk_bf16_f32 v18, v56, v57
    v_cvt_pk_bf16_f32 v19, v58, v59
    v_pk_mul_f32 v[44:45], v[190:191], v[44:45] op_sel:[1,0] op_sel_hi:[1,1]
    v_pk_mul_f32 v[46:47], v[190:191], v[46:47] op_sel:[1,0] op_sel_hi:[1,1]
    v_pk_mul_f32 v[60:61], v[190:191], v[60:61] op_sel:[1,0] op_sel_hi:[1,1]
    v_pk_mul_f32 v[62:63], v[190:191], v[62:63] op_sel:[1,0] op_sel_hi:[1,1]
    v_cvt_pk_bf16_f32 v20, v44, v45
    v_cvt_pk_bf16_f32 v21, v46, v47
    v_cvt_pk_bf16_f32 v22, v60, v61
    v_cvt_pk_bf16_f32 v23, v62, v63
    v_permlane16_swap_b32 v8, v12
    v_permlane16_swap_b32 v9, v13
    v_permlane16_swap_b32 v10, v14
    v_permlane16_swap_b32 v11, v15
    v_permlane16_swap_b32 v16, v20
    v_permlane16_swap_b32 v17, v21
    v_permlane16_swap_b32 v18, v22
    v_permlane16_swap_b32 v19, v23
    s_waitcnt lgkmcnt(0)
    v_mfma_f32_32x32x16_bf16 v[64:79], v[128:131], v[8:11], 0
    v_mfma_f32_32x32x16_bf16 v[64:79], v[132:135], v[12:15], v[64:79]
    v_and_b32 v25, 7, v1
    v_mov_b32 v26, 0x3f803f80
    v_cmp_eq_u32 vcc, 0, v25
    s_nop 1
    v_cndmask_b32 v200, 0, v26, vcc
    v_cndmask_b32 v201, 0, v26, vcc
    v_cmp_eq_u32 vcc, 4, v25
    s_nop 1
    v_cndmask_b32 v202, 0, v26, vcc
    v_cndmask_b32 v203, 0, v26, vcc
    v_mov_b32 v204, 0xdddddddd
    v_mov_b32 v160, 0
    v_mov_b32 v161, 0
    v_mov_b32 v162, 0
    v_mov_b32 v163, 0
    v_mov_b32 v164, 0
    v_mov_b32 v165, 0
    v_mov_b32 v166, 0
    v_mov_b32 v167, 0
    v_mov_b32 v168, 0
    v_mov_b32 v169, 0
    v_mov_b32 v170, 0
    v_mov_b32 v171, 0
    v_mov_b32 v172, 0
    v_mov_b32 v173, 0
    v_mov_b32 v174, 0
    v_mov_b32 v175, 0
    v_mov_b32 v192, 0
    v_mov_b32 v193, 0
    v_mov_b32 v194, 0
    v_mov_b32 v195, 0
    v_mov_b32 v176, 0
    v_mov_b32 v177, 0
    v_mov_b32 v178, 0
    v_mov_b32 v179, 0
    v_mov_b32 v180, 0
    v_mov_b32 v181, 0
    v_mov_b32 v182, 0
    v_mov_b32 v183, 0
    v_mov_b32 v184, 0
    v_mov_b32 v185, 0
    v_mov_b32 v186, 0
    v_mov_b32 v187, 0
    v_mov_b32 v188, 0
    v_mov_b32 v189, 0
    v_mov_b32 v190, 0
    v_mov_b32 v191, 0
    v_mov_b32 v196, 0
    v_mov_b32 v197, 0
    v_mov_b32 v198, 0
    v_mov_b32 v199, 0
    v_mov_b32 v112, 0
    v_mov_b32 v113, 0
    v_mov_b32 v114, 0
    v_mov_b32 v115, 0
    v_mov_b32 v116, 0
    v_mov_b32 v117, 0
    v_mov_b32 v118, 0
    v_mov_b32 v119, 0
    v_mov_b32 v120, 0
    v_mov_b32 v121, 0
    v_mov_b32 v122, 0
    v_mov_b32 v123, 0
    v_mov_b32 v124, 0
    v_mov_b32 v125, 0
    v_mov_b32 v126, 0
    v_mov_b32 v127, 0
    v_mov_b32 v152, 0
    v_mov_b32 v153, 0
    v_mov_b32 v154, 0
    v_mov_b32 v155, 0
    v_mov_b32 v156, 0
    v_mov_b32 v157, 0
    v_mov_b32 v158, 0
    v_mov_b32 v159, 0
    s_mov_b32 s54, 4
    s_mov_b64 exec, 0xff
    s_waitcnt vmcnt(0)
    buffer_store_dword v29, v28, s[12:15], s53 offen sc1
    s_mov_b64 exec, -1
.p2align 3
c_attn_loop:
    v_mfma_f32_32x32x16_bf16 v[80:95], v[128:131], v[16:19], 0
    v_exp_f32 v64, v64
    v_exp_f32 v65, v65
    v_exp_f32 v66, v66
    v_mfma_f32_32x32x16_bf16 v[80:95], v[132:135], v[20:23], v[80:95]
    v_exp_f32 v67, v67
    v_exp_f32 v68, v68
    v_exp_f32 v69, v69
    v_smfmac_f32_32x32x32_bf16 v[176:191], v[152:155], v[112:119], v204
    s_waitcnt lgkmcnt(0)
    v_exp_f32 v70, v70
    v_exp_f32 v71, v71
    v_exp_f32 v72, v72
    v_smfmac_f32_16x16x64_bf16 v[196:199], v[200:203], v[112:119], v204
    ds_read_b128 v[144:147], v24 offset:8192
    v_exp_f32 v73, v73
    v_exp_f32 v74, v74
    v_smfmac_f32_32x32x32_bf16 v[176:191], v[156:159], v[120:127], v204
    v_exp_f32 v75, v75
    v_exp_f32 v76, v76
    v_exp_f32 v77, v77
    v_smfmac_f32_16x16x64_bf16 v[196:199], v[200:203], v[120:127], v204
    ds_read_b128 v[148:151], v24 offset:9216
    v_exp_f32 v78, v78
    v_exp_f32 v79, v79
    v_mfma_f32_32x32x16_bf16 v[96:111], v[136:139], v[8:11], 0
    v_exp_f32 v80, v80
    v_exp_f32 v81, v81
    v_exp_f32 v82, v82
    v_mfma_f32_32x32x16_bf16 v[96:111], v[140:143], v[12:15], v[96:111]
    s_waitcnt lgkmcnt(1)
    v_exp_f32 v83, v83
    v_exp_f32 v84, v84
    v_exp_f32 v85, v85
    v_smfmac_f32_32x32x32_bf16 v[160:175], v[144:147], v[64:71], v204
    s_waitcnt lgkmcnt(0)
    v_exp_f32 v86, v86
    v_exp_f32 v87, v87
    v_exp_f32 v88, v88
    v_smfmac_f32_16x16x64_bf16 v[192:195], v[200:203], v[64:71], v204
    ds_read_b128 v[128:131], v24 offset:4096
    v_exp_f32 v89, v89
    v_exp_f32 v90, v90
    v_smfmac_f32_32x32x32_bf16 v[160:175], v[148:151], v[72:79], v204
    v_exp_f32 v91, v91
    v_exp_f32 v92, v92
    v_exp_f32 v93, v93
    v_smfmac_f32_16x16x64_bf16 v[192:195], v[200:203], v[72:79], v204
    ds_read_b128 v[132:135], v24 offset:5120
    v_exp_f32 v94, v94
    v_exp_f32 v95, v95
    v_mfma_f32_32x32x16_bf16 v[112:127], v[136:139], v[16:19], 0
    v_exp_f32 v96, v96
    v_exp_f32 v97, v97
    v_exp_f32 v98, v98
    v_mfma_f32_32x32x16_bf16 v[112:127], v[140:143], v[20:23], v[112:127]
    v_exp_f32 v99, v99
    v_exp_f32 v100, v100
    v_exp_f32 v101, v101
    v_smfmac_f32_32x32x32_bf16 v[176:191], v[144:147], v[80:87], v204
    s_waitcnt lgkmcnt(0)
    v_exp_f32 v102, v102
    v_exp_f32 v103, v103
    v_exp_f32 v104, v104
    v_smfmac_f32_16x16x64_bf16 v[196:199], v[200:203], v[80:87], v204
    ds_read_b128 v[152:155], v24 offset:10240
    v_exp_f32 v105, v105
    v_exp_f32 v106, v106
    v_smfmac_f32_32x32x32_bf16 v[176:191], v[148:151], v[88:95], v204
    v_exp_f32 v107, v107
    v_exp_f32 v108, v108
    v_exp_f32 v109, v109
    v_smfmac_f32_16x16x64_bf16 v[196:199], v[200:203], v[88:95], v204
    ds_read_b128 v[156:159], v24 offset:11264
    v_exp_f32 v110, v110
    v_exp_f32 v111, v111
    v_mfma_f32_32x32x16_bf16 v[64:79], v[128:131], v[8:11], 0
    v_exp_f32 v112, v112
    v_exp_f32 v113, v113
    v_exp_f32 v114, v114
    v_mfma_f32_32x32x16_bf16 v[64:79], v[132:135], v[12:15], v[64:79]
    s_waitcnt lgkmcnt(1)
    v_exp_f32 v115, v115
    v_exp_f32 v116, v116
    v_exp_f32 v117, v117
    v_smfmac_f32_32x32x32_bf16 v[160:175], v[152:155], v[96:103], v204
    s_waitcnt lgkmcnt(0)
    v_exp_f32 v118, v118
    v_exp_f32 v119, v119
    v_exp_f32 v120, v120
    v_smfmac_f32_16x16x64_bf16 v[192:195], v[200:203], v[96:103], v204
    ds_read_b128 v[136:139], v24 offset:6144
    v_exp_f32 v121, v121
    v_exp_f32 v122, v122
    v_smfmac_f32_32x32x32_bf16 v[160:175], v[156:159], v[104:111], v204
    v_exp_f32 v123, v123
    v_exp_f32 v124, v124
    v_exp_f32 v125, v125
    v_smfmac_f32_16x16x64_bf16 v[192:195], v[200:203], v[104:111], v204
    ds_read_b128 v[140:143], v24 offset:7168
    v_exp_f32 v126, v126
    v_exp_f32 v127, v127
    v_mfma_f32_32x32x16_bf16 v[80:95], v[128:131], v[16:19], 0
    s_cmp_eq_u32 s54, 4
    v_exp_f32 v64, v64
    v_exp_f32 v65, v65
    v_exp_f32 v66, v66
    v_mfma_f32_32x32x16_bf16 v[80:95], v[132:135], v[20:23], v[80:95]
    v_exp_f32 v67, v67
    v_exp_f32 v68, v68
    v_exp_f32 v69, v69
    v_smfmac_f32_32x32x32_bf16 v[176:191], v[152:155], v[112:119], v204
    s_waitcnt lgkmcnt(0)
    v_exp_f32 v70, v70
    v_exp_f32 v71, v71
    v_exp_f32 v72, v72
    v_smfmac_f32_16x16x64_bf16 v[196:199], v[200:203], v[112:119], v204
    ds_read_b128 v[144:147], v24 offset:12288
    v_exp_f32 v73, v73
    v_exp_f32 v74, v74
    v_smfmac_f32_32x32x32_bf16 v[176:191], v[156:159], v[120:127], v204
    v_exp_f32 v75, v75
    v_exp_f32 v76, v76
    v_exp_f32 v77, v77
    v_smfmac_f32_16x16x64_bf16 v[196:199], v[200:203], v[120:127], v204
    ds_read_b128 v[148:151], v24 offset:13312
    v_exp_f32 v78, v78
    v_exp_f32 v79, v79
    v_mfma_f32_32x32x16_bf16 v[96:111], v[136:139], v[8:11], 0
    s_cbranch_scc1 c_attn_nobar
    s_barrier
c_attn_nobar:
    v_exp_f32 v80, v80
    v_exp_f32 v81, v81
    v_exp_f32 v82, v82
    v_mfma_f32_32x32x16_bf16 v[96:111], v[140:143], v[12:15], v[96:111]
    s_waitcnt lgkmcnt(1)
    v_exp_f32 v83, v83
    v_exp_f32 v84, v84
    v_exp_f32 v85, v85
    v_smfmac_f32_32x32x32_bf16 v[160:175], v[144:147], v[64:71], v204
    s_waitcnt lgkmcnt(0)
    v_exp_f32 v86, v86
    v_exp_f32 v87, v87
    v_exp_f32 v88, v88
    v_smfmac_f32_16x16x64_bf16 v[192:195], v[200:203], v[64:71], v204
    ds_read_b128 v[128:131], v24 offset:16384
    v_exp_f32 v89, v89
    v_exp_f32 v90, v90
    v_smfmac_f32_32x32x32_bf16 v[160:175], v[148:151], v[72:79], v204
    v_exp_f32 v91, v91
    v_exp_f32 v92, v92
    v_exp_f32 v93, v93
    v_smfmac_f32_16x16x64_bf16 v[192:195], v[200:203], v[72:79], v204
    ds_read_b128 v[132:135], v24 offset:17408
    v_exp_f32 v94, v94
    v_exp_f32 v95, v95
    v_mfma_f32_32x32x16_bf16 v[112:127], v[136:139], v[16:19], 0
    v_exp_f32 v96, v96
    v_exp_f32 v97, v97
    v_exp_f32 v98, v98
    v_mfma_f32_32x32x16_bf16 v[112:127], v[140:143], v[20:23], v[112:127]
    v_exp_f32 v99, v99
    v_exp_f32 v100, v100
    v_exp_f32 v101, v101
    v_smfmac_f32_32x32x32_bf16 v[176:191], v[144:147], v[80:87], v204
    s_waitcnt lgkmcnt(0)
    v_exp_f32 v102, v102
    v_exp_f32 v103, v103
    v_exp_f32 v104, v104
    v_smfmac_f32_16x16x64_bf16 v[196:199], v[200:203], v[80:87], v204
    ds_read_b128 v[152:155], v24 offset:14336
    v_exp_f32 v105, v105
    v_exp_f32 v106, v106
    v_smfmac_f32_32x32x32_bf16 v[176:191], v[148:151], v[88:95], v204
    v_exp_f32 v107, v107
    v_exp_f32 v108, v108
    v_exp_f32 v109, v109
    v_smfmac_f32_16x16x64_bf16 v[196:199], v[200:203], v[88:95], v204
    ds_read_b128 v[156:159], v24 offset:15360
    v_exp_f32 v110, v110
    v_exp_f32 v111, v111
    v_mfma_f32_32x32x16_bf16 v[64:79], v[128:131], v[8:11], 0
    v_exp_f32 v112, v112
    v_exp_f32 v113, v113
    v_exp_f32 v114, v114
    v_mfma_f32_32x32x16_bf16 v[64:79], v[132:135], v[12:15], v[64:79]
    s_waitcnt lgkmcnt(1)
    v_exp_f32 v115, v115
    v_exp_f32 v116, v116
    v_exp_f32 v117, v117
    v_smfmac_f32_32x32x32_bf16 v[160:175], v[152:155], v[96:103], v204
    s_waitcnt lgkmcnt(0)
    v_exp_f32 v118, v118
    v_exp_f32 v119, v119
    v_exp_f32 v120, v120
    v_smfmac_f32_16x16x64_bf16 v[192:195], v[200:203], v[96:103], v204
    ds_read_b128 v[136:139], v24 offset:18432
    v_exp_f32 v121, v121
    v_exp_f32 v122, v122
    v_smfmac_f32_32x32x32_bf16 v[160:175], v[156:159], v[104:111], v204
    v_exp_f32 v123, v123
    v_exp_f32 v124, v124
    v_exp_f32 v125, v125
    v_smfmac_f32_16x16x64_bf16 v[192:195], v[200:203], v[104:111], v204
    ds_read_b128 v[140:143], v24 offset:19456
    v_exp_f32 v126, v126
    v_exp_f32 v127, v127
    v_mfma_f32_32x32x16_bf16 v[80:95], v[128:131], v[16:19], 0
    v_exp_f32 v64, v64
    v_exp_f32 v65, v65
    v_exp_f32 v66, v66
    v_mfma_f32_32x32x16_bf16 v[80:95], v[132:135], v[20:23], v[80:95]
    v_exp_f32 v67, v67
    v_exp_f32 v68, v68
    v_exp_f32 v69, v69
    v_smfmac_f32_32x32x32_bf16 v[176:191], v[152:155], v[112:119], v204
    s_waitcnt lgkmcnt(0)
    v_exp_f32 v70, v70
    v_exp_f32 v71, v71
    v_exp_f32 v72, v72
    v_smfmac_f32_16x16x64_bf16 v[196:199], v[200:203], v[112:119], v204
    ds_read_b128 v[144:147], v24 offset:24576
    v_exp_f32 v73, v73
    v_exp_f32 v74, v74
    v_smfmac_f32_32x32x32_bf16 v[176:191], v[156:159], v[120:127], v204
    v_exp_f32 v75, v75
    v_exp_f32 v76, v76
    v_exp_f32 v77, v77
    v_smfmac_f32_16x16x64_bf16 v[196:199], v[200:203], v[120:127], v204
    ds_read_b128 v[148:151], v24 offset:25600
    v_exp_f32 v78, v78
    v_exp_f32 v79, v79
    v_mfma_f32_32x32x16_bf16 v[96:111], v[136:139], v[8:11], 0
    v_exp_f32 v80, v80
    v_exp_f32 v81, v81
    v_exp_f32 v82, v82
    v_mfma_f32_32x32x16_bf16 v[96:111], v[140:143], v[12:15], v[96:111]
    s_waitcnt lgkmcnt(1)
    v_exp_f32 v83, v83
    v_exp_f32 v84, v84
    v_exp_f32 v85, v85
    v_smfmac_f32_32x32x32_bf16 v[160:175], v[144:147], v[64:71], v204
    s_waitcnt lgkmcnt(0)
    v_exp_f32 v86, v86
    v_exp_f32 v87, v87
    v_exp_f32 v88, v88
    v_smfmac_f32_16x16x64_bf16 v[192:195], v[200:203], v[64:71], v204
    ds_read_b128 v[128:131], v24 offset:20480
    v_exp_f32 v89, v89
    v_exp_f32 v90, v90
    v_smfmac_f32_32x32x32_bf16 v[160:175], v[148:151], v[72:79], v204
    v_exp_f32 v91, v91
    v_exp_f32 v92, v92
    v_exp_f32 v93, v93
    v_smfmac_f32_16x16x64_bf16 v[192:195], v[200:203], v[72:79], v204
    ds_read_b128 v[132:135], v24 offset:21504
    v_exp_f32 v94, v94
    v_exp_f32 v95, v95
    v_mfma_f32_32x32x16_bf16 v[112:127], v[136:139], v[16:19], 0
    v_exp_f32 v96, v96
    v_exp_f32 v97, v97
    v_exp_f32 v98, v98
    v_mfma_f32_32x32x16_bf16 v[112:127], v[140:143], v[20:23], v[112:127]
    v_exp_f32 v99, v99
    v_exp_f32 v100, v100
    v_exp_f32 v101, v101
    v_smfmac_f32_32x32x32_bf16 v[176:191], v[144:147], v[80:87], v204
    s_waitcnt lgkmcnt(0)
    v_exp_f32 v102, v102
    v_exp_f32 v103, v103
    v_exp_f32 v104, v104
    v_smfmac_f32_16x16x64_bf16 v[196:199], v[200:203], v[80:87], v204
    ds_read_b128 v[152:155], v24 offset:26624
    v_exp_f32 v105, v105
    v_exp_f32 v106, v106
    v_smfmac_f32_32x32x32_bf16 v[176:191], v[148:151], v[88:95], v204
    v_exp_f32 v107, v107
    v_exp_f32 v108, v108
    v_exp_f32 v109, v109
    v_smfmac_f32_16x16x64_bf16 v[196:199], v[200:203], v[88:95], v204
    ds_read_b128 v[156:159], v24 offset:27648
    v_exp_f32 v110, v110
    v_exp_f32 v111, v111
    v_mfma_f32_32x32x16_bf16 v[64:79], v[128:131], v[8:11], 0
    v_exp_f32 v112, v112
    v_exp_f32 v113, v113
    v_exp_f32 v114, v114
    v_mfma_f32_32x32x16_bf16 v[64:79], v[132:135], v[12:15], v[64:79]
    s_waitcnt lgkmcnt(1)
    v_exp_f32 v115, v115
    v_exp_f32 v116, v116
    v_exp_f32 v117, v117
    v_smfmac_f32_32x32x32_bf16 v[160:175], v[152:155], v[96:103], v204
    s_waitcnt lgkmcnt(0)
    v_exp_f32 v118, v118
    v_exp_f32 v119, v119
    v_exp_f32 v120, v120
    v_smfmac_f32_16x16x64_bf16 v[192:195], v[200:203], v[96:103], v204
    ds_read_b128 v[136:139], v24 offset:22528
    v_exp_f32 v121, v121
    v_exp_f32 v122, v122
    v_smfmac_f32_32x32x32_bf16 v[160:175], v[156:159], v[104:111], v204
    v_exp_f32 v123, v123
    v_exp_f32 v124, v124
    v_exp_f32 v125, v125
    v_smfmac_f32_16x16x64_bf16 v[192:195], v[200:203], v[104:111], v204
    ds_read_b128 v[140:143], v24 offset:23552
    v_exp_f32 v126, v126
    v_exp_f32 v127, v127
    v_mfma_f32_32x32x16_bf16 v[80:95], v[128:131], v[16:19], 0
    v_exp_f32 v64, v64
    v_exp_f32 v65, v65
    v_exp_f32 v66, v66
    v_mfma_f32_32x32x16_bf16 v[80:95], v[132:135], v[20:23], v[80:95]
    v_exp_f32 v67, v67
    v_exp_f32 v68, v68
    v_exp_f32 v69, v69
    v_smfmac_f32_32x32x32_bf16 v[176:191], v[152:155], v[112:119], v204
    s_waitcnt lgkmcnt(0)
    v_exp_f32 v70, v70
    v_exp_f32 v71, v71
    v_exp_f32 v72, v72
    v_smfmac_f32_16x16x64_bf16 v[196:199], v[200:203], v[112:119], v204
    ds_read_b128 v[144:147], v24 offset:28672
    v_exp_f32 v73, v73
    v_exp_f32 v74, v74
    v_smfmac_f32_32x32x32_bf16 v[176:191], v[156:159], v[120:127], v204
    v_exp_f32 v75, v75
    v_exp_f32 v76, v76
    v_exp_f32 v77, v77
    v_smfmac_f32_16x16x64_bf16 v[196:199], v[200:203], v[120:127], v204
    ds_read_b128 v[148:151], v24 offset:29696
    v_exp_f32 v78, v78
    v_exp_f32 v79, v79
    v_mfma_f32_32x32x16_bf16 v[96:111], v[136:139], v[8:11], 0
    s_barrier
    v_exp_f32 v80, v80
    v_exp_f32 v81, v81
    v_exp_f32 v82, v82
    v_mfma_f32_32x32x16_bf16 v[96:111], v[140:143], v[12:15], v[96:111]
    s_waitcnt lgkmcnt(1)
    v_exp_f32 v83, v83
    v_exp_f32 v84, v84
    v_exp_f32 v85, v85
    v_smfmac_f32_32x32x32_bf16 v[160:175], v[144:147], v[64:71], v204
    s_waitcnt lgkmcnt(0)
    v_exp_f32 v86, v86
    v_exp_f32 v87, v87
    v_exp_f32 v88, v88
    v_smfmac_f32_16x16x64_bf16 v[192:195], v[200:203], v[64:71], v204
    ds_read_b128 v[128:131], v24 offset:32768
    v_exp_f32 v89, v89
    v_exp_f32 v90, v90
    v_smfmac_f32_32x32x32_bf16 v[160:175], v[148:151], v[72:79], v204
    v_exp_f32 v91, v91
    v_exp_f32 v92, v92
    v_exp_f32 v93, v93
    v_smfmac_f32_16x16x64_bf16 v[192:195], v[200:203], v[72:79], v204
    ds_read_b128 v[132:135], v24 offset:33792
    v_exp_f32 v94, v94
    v_exp_f32 v95, v95
    v_mfma_f32_32x32x16_bf16 v[112:127], v[136:139], v[16:19], 0
    v_exp_f32 v96, v96
    v_exp_f32 v97, v97
    v_exp_f32 v98, v98
    v_mfma_f32_32x32x16_bf16 v[112:127], v[140:143], v[20:23], v[112:127]
    v_exp_f32 v99, v99
    v_exp_f32 v100, v100
    v_exp_f32 v101, v101
    v_smfmac_f32_32x32x32_bf16 v[176:191], v[144:147], v[80:87], v204
    s_waitcnt lgkmcnt(0)
    v_exp_f32 v102, v102
    v_exp_f32 v103, v103
    v_exp_f32 v104, v104
    v_smfmac_f32_16x16x64_bf16 v[196:199], v[200:203], v[80:87], v204
    ds_read_b128 v[152:155], v24 offset:30720
    v_exp_f32 v105, v105
    v_exp_f32 v106, v106
    v_smfmac_f32_32x32x32_bf16 v[176:191], v[148:151], v[88:95], v204
    v_exp_f32 v107, v107
    v_exp_f32 v108, v108
    v_exp_f32 v109, v109
    v_smfmac_f32_16x16x64_bf16 v[196:199], v[200:203], v[88:95], v204
    ds_read_b128 v[156:159], v24 offset:31744
    v_exp_f32 v110, v110
    v_exp_f32 v111, v111
    v_mfma_f32_32x32x16_bf16 v[64:79], v[128:131], v[8:11], 0
    v_exp_f32 v112, v112
    v_exp_f32 v113, v113
    v_exp_f32 v114, v114
    v_mfma_f32_32x32x16_bf16 v[64:79], v[132:135], v[12:15], v[64:79]
    s_waitcnt lgkmcnt(1)
    v_exp_f32 v115, v115
    v_exp_f32 v116, v116
    v_exp_f32 v117, v117
    v_smfmac_f32_32x32x32_bf16 v[160:175], v[152:155], v[96:103], v204
    s_waitcnt lgkmcnt(0)
    v_exp_f32 v118, v118
    v_exp_f32 v119, v119
    v_exp_f32 v120, v120
    v_smfmac_f32_16x16x64_bf16 v[192:195], v[200:203], v[96:103], v204
    ds_read_b128 v[136:139], v24 offset:34816
    v_exp_f32 v121, v121
    v_exp_f32 v122, v122
    v_smfmac_f32_32x32x32_bf16 v[160:175], v[156:159], v[104:111], v204
    v_exp_f32 v123, v123
    v_exp_f32 v124, v124
    v_exp_f32 v125, v125
    v_smfmac_f32_16x16x64_bf16 v[192:195], v[200:203], v[104:111], v204
    ds_read_b128 v[140:143], v24 offset:35840
    v_exp_f32 v126, v126
    v_exp_f32 v127, v127
    v_mfma_f32_32x32x16_bf16 v[80:95], v[128:131], v[16:19], 0
    v_exp_f32 v64, v64
    v_exp_f32 v65, v65
    v_exp_f32 v66, v66
    v_mfma_f32_32x32x16_bf16 v[80:95], v[132:135], v[20:23], v[80:95]
    v_exp_f32 v67, v67
    v_exp_f32 v68, v68
    v_exp_f32 v69, v69
    v_smfmac_f32_32x32x32_bf16 v[176:191], v[152:155], v[112:119], v204
    s_waitcnt lgkmcnt(0)
    v_exp_f32 v70, v70
    v_exp_f32 v71, v71
    v_exp_f32 v72, v72
    v_smfmac_f32_16x16x64_bf16 v[196:199], v[200:203], v[112:119], v204
    ds_read_b128 v[144:147], v24 offset:40960
    v_exp_f32 v73, v73
    v_exp_f32 v74, v74
    v_smfmac_f32_32x32x32_bf16 v[176:191], v[156:159], v[120:127], v204
    v_exp_f32 v75, v75
    v_exp_f32 v76, v76
    v_exp_f32 v77, v77
    v_smfmac_f32_16x16x64_bf16 v[196:199], v[200:203], v[120:127], v204
    ds_read_b128 v[148:151], v24 offset:41984
    v_exp_f32 v78, v78
    v_exp_f32 v79, v79
    v_mfma_f32_32x32x16_bf16 v[96:111], v[136:139], v[8:11], 0
    v_exp_f32 v80, v80
    v_exp_f32 v81, v81
    v_exp_f32 v82, v82
    v_mfma_f32_32x32x16_bf16 v[96:111], v[140:143], v[12:15], v[96:111]
    s_waitcnt lgkmcnt(1)
    v_exp_f32 v83, v83
    v_exp_f32 v84, v84
    v_exp_f32 v85, v85
    v_smfmac_f32_32x32x32_bf16 v[160:175], v[144:147], v[64:71], v204
    s_waitcnt lgkmcnt(0)
    v_exp_f32 v86, v86
    v_exp_f32 v87, v87
    v_exp_f32 v88, v88
    v_smfmac_f32_16x16x64_bf16 v[192:195], v[200:203], v[64:71], v204
    ds_read_b128 v[128:131], v24 offset:36864
    v_exp_f32 v89, v89
    v_exp_f32 v90, v90
    v_smfmac_f32_32x32x32_bf16 v[160:175], v[148:151], v[72:79], v204
    v_exp_f32 v91, v91
    v_exp_f32 v92, v92
    v_exp_f32 v93, v93
    v_smfmac_f32_16x16x64_bf16 v[192:195], v[200:203], v[72:79], v204
    ds_read_b128 v[132:135], v24 offset:37888
    v_exp_f32 v94, v94
    v_exp_f32 v95, v95
    v_mfma_f32_32x32x16_bf16 v[112:127], v[136:139], v[16:19], 0
    v_exp_f32 v96, v96
    v_exp_f32 v97, v97
    v_exp_f32 v98, v98
    v_mfma_f32_32x32x16_bf16 v[112:127], v[140:143], v[20:23], v[112:127]
    v_exp_f32 v99, v99
    v_exp_f32 v100, v100
    v_exp_f32 v101, v101
    v_smfmac_f32_32x32x32_bf16 v[176:191], v[144:147], v[80:87], v204
    s_waitcnt lgkmcnt(0)
    v_exp_f32 v102, v102
    v_exp_f32 v103, v103
    v_exp_f32 v104, v104
    v_smfmac_f32_16x16x64_bf16 v[196:199], v[200:203], v[80:87], v204
    ds_read_b128 v[152:155], v24 offset:43008
    v_exp_f32 v105, v105
    v_exp_f32 v106, v106
    v_smfmac_f32_32x32x32_bf16 v[176:191], v[148:151], v[88:95], v204
    v_exp_f32 v107, v107
    v_exp_f32 v108, v108
    v_exp_f32 v109, v109
    v_smfmac_f32_16x16x64_bf16 v[196:199], v[200:203], v[88:95], v204
    ds_read_b128 v[156:159], v24 offset:44032
    v_exp_f32 v110, v110
    v_exp_f32 v111, v111
    v_mfma_f32_32x32x16_bf16 v[64:79], v[128:131], v[8:11], 0
    v_exp_f32 v112, v112
    v_exp_f32 v113, v113
    v_exp_f32 v114, v114
    v_mfma_f32_32x32x16_bf16 v[64:79], v[132:135], v[12:15], v[64:79]
    s_waitcnt lgkmcnt(1)
    v_exp_f32 v115, v115
    v_exp_f32 v116, v116
    v_exp_f32 v117, v117
    v_smfmac_f32_32x32x32_bf16 v[160:175], v[152:155], v[96:103], v204
    s_waitcnt lgkmcnt(0)
    v_exp_f32 v118, v118
    v_exp_f32 v119, v119
    v_exp_f32 v120, v120
    v_smfmac_f32_16x16x64_bf16 v[192:195], v[200:203], v[96:103], v204
    ds_read_b128 v[136:139], v24 offset:38912
    v_exp_f32 v121, v121
    v_exp_f32 v122, v122
    v_smfmac_f32_32x32x32_bf16 v[160:175], v[156:159], v[104:111], v204
    v_exp_f32 v123, v123
    v_exp_f32 v124, v124
    v_exp_f32 v125, v125
    v_smfmac_f32_16x16x64_bf16 v[192:195], v[200:203], v[104:111], v204
    ds_read_b128 v[140:143], v24 offset:39936
    v_exp_f32 v126, v126
    v_exp_f32 v127, v127
    v_mfma_f32_32x32x16_bf16 v[80:95], v[128:131], v[16:19], 0
    v_exp_f32 v64, v64
    v_exp_f32 v65, v65
    v_exp_f32 v66, v66
    v_mfma_f32_32x32x16_bf16 v[80:95], v[132:135], v[20:23], v[80:95]
    v_exp_f32 v67, v67
    v_exp_f32 v68, v68
    v_exp_f32 v69, v69
    v_smfmac_f32_32x32x32_bf16 v[176:191], v[152:155], v[112:119], v204
    s_waitcnt lgkmcnt(0)
    v_exp_f32 v70, v70
    v_exp_f32 v71, v71
    v_exp_f32 v72, v72
    v_smfmac_f32_16x16x64_bf16 v[196:199], v[200:203], v[112:119], v204
    ds_read_b128 v[144:147], v24 offset:45056
    v_exp_f32 v73, v73
    v_exp_f32 v74, v74
    v_smfmac_f32_32x32x32_bf16 v[176:191], v[156:159], v[120:127], v204
    v_exp_f32 v75, v75
    v_exp_f32 v76, v76
    v_exp_f32 v77, v77
    v_smfmac_f32_16x16x64_bf16 v[196:199], v[200:203], v[120:127], v204
    ds_read_b128 v[148:151], v24 offset:46080
    v_exp_f32 v78, v78
    v_exp_f32 v79, v79
    v_mfma_f32_32x32x16_bf16 v[96:111], v[136:139], v[8:11], 0
    s_barrier
    v_exp_f32 v80, v80
    v_exp_f32 v81, v81
    v_exp_f32 v82, v82
    v_mfma_f32_32x32x16_bf16 v[96:111], v[140:143], v[12:15], v[96:111]
    s_waitcnt lgkmcnt(1)
    v_exp_f32 v83, v83
    v_exp_f32 v84, v84
    v_exp_f32 v85, v85
    v_smfmac_f32_32x32x32_bf16 v[160:175], v[144:147], v[64:71], v204
    s_waitcnt lgkmcnt(0)
    v_exp_f32 v86, v86
    v_exp_f32 v87, v87
    v_exp_f32 v88, v88
    v_smfmac_f32_16x16x64_bf16 v[192:195], v[200:203], v[64:71], v204
    ds_read_b128 v[128:131], v24 offset:49152
    v_exp_f32 v89, v89
    v_exp_f32 v90, v90
    v_smfmac_f32_32x32x32_bf16 v[160:175], v[148:151], v[72:79], v204
    v_exp_f32 v91, v91
    v_exp_f32 v92, v92
    v_exp_f32 v93, v93
    v_smfmac_f32_16x16x64_bf16 v[192:195], v[200:203], v[72:79], v204
    ds_read_b128 v[132:135], v24 offset:50176
    v_exp_f32 v94, v94
    v_exp_f32 v95, v95
    v_mfma_f32_32x32x16_bf16 v[112:127], v[136:139], v[16:19], 0
    v_exp_f32 v96, v96
    v_exp_f32 v97, v97
    v_exp_f32 v98, v98
    v_mfma_f32_32x32x16_bf16 v[112:127], v[140:143], v[20:23], v[112:127]
    v_exp_f32 v99, v99
    v_exp_f32 v100, v100
    v_exp_f32 v101, v101
    v_smfmac_f32_32x32x32_bf16 v[176:191], v[144:147], v[80:87], v204
    s_waitcnt lgkmcnt(0)
    v_exp_f32 v102, v102
    v_exp_f32 v103, v103
    v_exp_f32 v104, v104
    v_smfmac_f32_16x16x64_bf16 v[196:199], v[200:203], v[80:87], v204
    ds_read_b128 v[152:155], v24 offset:47104
    v_exp_f32 v105, v105
    v_exp_f32 v106, v106
    v_smfmac_f32_32x32x32_bf16 v[176:191], v[148:151], v[88:95], v204
    v_exp_f32 v107, v107
    v_exp_f32 v108, v108
    v_exp_f32 v109, v109
    v_smfmac_f32_16x16x64_bf16 v[196:199], v[200:203], v[88:95], v204
    ds_read_b128 v[156:159], v24 offset:48128
    v_exp_f32 v110, v110
    v_exp_f32 v111, v111
    v_mfma_f32_32x32x16_bf16 v[64:79], v[128:131], v[8:11], 0
    v_exp_f32 v112, v112
    v_exp_f32 v113, v113
    v_exp_f32 v114, v114
    v_mfma_f32_32x32x16_bf16 v[64:79], v[132:135], v[12:15], v[64:79]
    s_waitcnt lgkmcnt(1)
    v_exp_f32 v115, v115
    v_exp_f32 v116, v116
    v_exp_f32 v117, v117
    v_smfmac_f32_32x32x32_bf16 v[160:175], v[152:155], v[96:103], v204
    s_waitcnt lgkmcnt(0)
    v_exp_f32 v118, v118
    v_exp_f32 v119, v119
    v_exp_f32 v120, v120
    v_smfmac_f32_16x16x64_bf16 v[192:195], v[200:203], v[96:103], v204
    ds_read_b128 v[136:139], v24 offset:51200
    v_exp_f32 v121, v121
    v_exp_f32 v122, v122
    v_smfmac_f32_32x32x32_bf16 v[160:175], v[156:159], v[104:111], v204
    v_exp_f32 v123, v123
    v_exp_f32 v124, v124
    v_exp_f32 v125, v125
    v_smfmac_f32_16x16x64_bf16 v[192:195], v[200:203], v[104:111], v204
    ds_read_b128 v[140:143], v24 offset:52224
    v_exp_f32 v126, v126
    v_exp_f32 v127, v127
    v_mfma_f32_32x32x16_bf16 v[80:95], v[128:131], v[16:19], 0
    v_exp_f32 v64, v64
    v_exp_f32 v65, v65
    v_exp_f32 v66, v66
    v_mfma_f32_32x32x16_bf16 v[80:95], v[132:135], v[20:23], v[80:95]
    v_exp_f32 v67, v67
    v_exp_f32 v68, v68
    v_exp_f32 v69, v69
    v_smfmac_f32_32x32x32_bf16 v[176:191], v[152:155], v[112:119], v204
    s_waitcnt lgkmcnt(0)
    v_exp_f32 v70, v70
    v_exp_f32 v71, v71
    v_exp_f32 v72, v72
    v_smfmac_f32_16x16x64_bf16 v[196:199], v[200:203], v[112:119], v204
    ds_read_b128 v[144:147], v24 offset:57344
    v_exp_f32 v73, v73
    v_exp_f32 v74, v74
    v_smfmac_f32_32x32x32_bf16 v[176:191], v[156:159], v[120:127], v204
    v_exp_f32 v75, v75
    v_exp_f32 v76, v76
    v_exp_f32 v77, v77
    v_smfmac_f32_16x16x64_bf16 v[196:199], v[200:203], v[120:127], v204
    ds_read_b128 v[148:151], v24 offset:58368
    v_exp_f32 v78, v78
    v_exp_f32 v79, v79
    v_mfma_f32_32x32x16_bf16 v[96:111], v[136:139], v[8:11], 0
    v_exp_f32 v80, v80
    v_exp_f32 v81, v81
    v_exp_f32 v82, v82
    v_mfma_f32_32x32x16_bf16 v[96:111], v[140:143], v[12:15], v[96:111]
    s_waitcnt lgkmcnt(1)
    v_exp_f32 v83, v83
    v_exp_f32 v84, v84
    v_exp_f32 v85, v85
    v_smfmac_f32_32x32x32_bf16 v[160:175], v[144:147], v[64:71], v204
    s_waitcnt lgkmcnt(0)
    v_exp_f32 v86, v86
    v_exp_f32 v87, v87
    v_exp_f32 v88, v88
    v_smfmac_f32_16x16x64_bf16 v[192:195], v[200:203], v[64:71], v204
    ds_read_b128 v[128:131], v24 offset:53248
    v_exp_f32 v89, v89
    v_exp_f32 v90, v90
    v_smfmac_f32_32x32x32_bf16 v[160:175], v[148:151], v[72:79], v204
    v_exp_f32 v91, v91
    v_exp_f32 v92, v92
    v_exp_f32 v93, v93
    v_smfmac_f32_16x16x64_bf16 v[192:195], v[200:203], v[72:79], v204
    ds_read_b128 v[132:135], v24 offset:54272
    v_exp_f32 v94, v94
    v_exp_f32 v95, v95
    v_mfma_f32_32x32x16_bf16 v[112:127], v[136:139], v[16:19], 0
    v_exp_f32 v96, v96
    v_exp_f32 v97, v97
    v_exp_f32 v98, v98
    v_mfma_f32_32x32x16_bf16 v[112:127], v[140:143], v[20:23], v[112:127]
    v_exp_f32 v99, v99
    v_exp_f32 v100, v100
    v_exp_f32 v101, v101
    v_smfmac_f32_32x32x32_bf16 v[176:191], v[144:147], v[80:87], v204
    s_waitcnt lgkmcnt(0)
    v_exp_f32 v102, v102
    v_exp_f32 v103, v103
    v_exp_f32 v104, v104
    v_smfmac_f32_16x16x64_bf16 v[196:199], v[200:203], v[80:87], v204
    ds_read_b128 v[152:155], v24 offset:59392
    v_exp_f32 v105, v105
    v_exp_f32 v106, v106
    v_smfmac_f32_32x32x32_bf16 v[176:191], v[148:151], v[88:95], v204
    v_exp_f32 v107, v107
    v_exp_f32 v108, v108
    v_exp_f32 v109, v109
    v_smfmac_f32_16x16x64_bf16 v[196:199], v[200:203], v[88:95], v204
    ds_read_b128 v[156:159], v24 offset:60416
    v_exp_f32 v110, v110
    v_exp_f32 v111, v111
    v_mfma_f32_32x32x16_bf16 v[64:79], v[128:131], v[8:11], 0
    v_exp_f32 v112, v112
    v_exp_f32 v113, v113
    v_exp_f32 v114, v114
    v_mfma_f32_32x32x16_bf16 v[64:79], v[132:135], v[12:15], v[64:79]
    s_waitcnt lgkmcnt(1)
    v_exp_f32 v115, v115
    v_exp_f32 v116, v116
    v_exp_f32 v117, v117
    v_smfmac_f32_32x32x32_bf16 v[160:175], v[152:155], v[96:103], v204
    s_waitcnt lgkmcnt(0)
    v_exp_f32 v118, v118
    v_exp_f32 v119, v119
    v_exp_f32 v120, v120
    v_smfmac_f32_16x16x64_bf16 v[192:195], v[200:203], v[96:103], v204
    ds_read_b128 v[136:139], v24 offset:55296
    v_exp_f32 v121, v121
    v_exp_f32 v122, v122
    v_smfmac_f32_32x32x32_bf16 v[160:175], v[156:159], v[104:111], v204
    v_exp_f32 v123, v123
    v_exp_f32 v124, v124
    v_exp_f32 v125, v125
    v_smfmac_f32_16x16x64_bf16 v[192:195], v[200:203], v[104:111], v204
    ds_read_b128 v[140:143], v24 offset:56320
    v_exp_f32 v126, v126
    v_exp_f32 v127, v127
    v_mfma_f32_32x32x16_bf16 v[80:95], v[128:131], v[16:19], 0
    v_exp_f32 v64, v64
    v_exp_f32 v65, v65
    v_exp_f32 v66, v66
    v_mfma_f32_32x32x16_bf16 v[80:95], v[132:135], v[20:23], v[80:95]
    v_exp_f32 v67, v67
    v_exp_f32 v68, v68
    v_exp_f32 v69, v69
    v_smfmac_f32_32x32x32_bf16 v[176:191], v[152:155], v[112:119], v204
    s_waitcnt lgkmcnt(0)
    v_exp_f32 v70, v70
    v_exp_f32 v71, v71
    v_exp_f32 v72, v72
    v_smfmac_f32_16x16x64_bf16 v[196:199], v[200:203], v[112:119], v204
    ds_read_b128 v[144:147], v24 offset:61440
    v_exp_f32 v73, v73
    v_exp_f32 v74, v74
    v_smfmac_f32_32x32x32_bf16 v[176:191], v[156:159], v[120:127], v204
    v_exp_f32 v75, v75
    v_exp_f32 v76, v76
    v_exp_f32 v77, v77
    v_smfmac_f32_16x16x64_bf16 v[196:199], v[200:203], v[120:127], v204
    ds_read_b128 v[148:151], v24 offset:62464
    v_exp_f32 v78, v78
    v_exp_f32 v79, v79
    v_mfma_f32_32x32x16_bf16 v[96:111], v[136:139], v[8:11], 0
    s_barrier
    v_exp_f32 v80, v80
    v_exp_f32 v81, v81
    v_exp_f32 v82, v82
    v_mfma_f32_32x32x16_bf16 v[96:111], v[140:143], v[12:15], v[96:111]
    s_waitcnt lgkmcnt(1)
    v_exp_f32 v83, v83
    v_exp_f32 v84, v84
    v_exp_f32 v85, v85
    v_smfmac_f32_32x32x32_bf16 v[160:175], v[144:147], v[64:71], v204
    s_waitcnt lgkmcnt(0)
    v_exp_f32 v86, v86
    v_exp_f32 v87, v87
    v_exp_f32 v88, v88
    v_smfmac_f32_16x16x64_bf16 v[192:195], v[200:203], v[64:71], v204
    ds_read_b128 v[128:131], v24 offset:0
    v_exp_f32 v89, v89
    v_exp_f32 v90, v90
    v_smfmac_f32_32x32x32_bf16 v[160:175], v[148:151], v[72:79], v204
    v_exp_f32 v91, v91
    v_exp_f32 v92, v92
    v_exp_f32 v93, v93
    v_smfmac_f32_16x16x64_bf16 v[192:195], v[200:203], v[72:79], v204
    ds_read_b128 v[132:135], v24 offset:1024
    v_exp_f32 v94, v94
    v_exp_f32 v95, v95
    v_mfma_f32_32x32x16_bf16 v[112:127], v[136:139], v[16:19], 0
    v_exp_f32 v96, v96
    v_exp_f32 v97, v97
    v_exp_f32 v98, v98
    v_mfma_f32_32x32x16_bf16 v[112:127], v[140:143], v[20:23], v[112:127]
    v_exp_f32 v99, v99
    v_exp_f32 v100, v100
    v_exp_f32 v101, v101
    v_smfmac_f32_32x32x32_bf16 v[176:191], v[144:147], v[80:87], v204
    s_waitcnt lgkmcnt(0)
    v_exp_f32 v102, v102
    v_exp_f32 v103, v103
    v_exp_f32 v104, v104
    v_smfmac_f32_16x16x64_bf16 v[196:199], v[200:203], v[80:87], v204
    ds_read_b128 v[152:155], v24 offset:63488
    v_exp_f32 v105, v105
    v_exp_f32 v106, v106
    v_smfmac_f32_32x32x32_bf16 v[176:191], v[148:151], v[88:95], v204
    v_exp_f32 v107, v107
    v_exp_f32 v108, v108
    v_exp_f32 v109, v109
    v_smfmac_f32_16x16x64_bf16 v[196:199], v[200:203], v[88:95], v204
    ds_read_b128 v[156:159], v24 offset:64512
    v_exp_f32 v110, v110
    v_exp_f32 v111, v111
    v_mfma_f32_32x32x16_bf16 v[64:79], v[128:131], v[8:11], 0
    s_sub_u32 s54, s54, 1
    v_exp_f32 v112, v112
    v_exp_f32 v113, v113
    v_exp_f32 v114, v114
    v_mfma_f32_32x32x16_bf16 v[64:79], v[132:135], v[12:15], v[64:79]
    s_waitcnt lgkmcnt(1)
    v_exp_f32 v115, v115
    v_exp_f32 v116, v116
    v_exp_f32 v117, v117
    v_smfmac_f32_32x32x32_bf16 v[160:175], v[152:155], v[96:103], v204
    s_waitcnt lgkmcnt(0)
    v_exp_f32 v118, v118
    v_exp_f32 v119, v119
    v_exp_f32 v120, v120
    v_smfmac_f32_16x16x64_bf16 v[192:195], v[200:203], v[96:103], v204
    ds_read_b128 v[136:139], v24 offset:2048
    v_exp_f32 v121, v121
    v_exp_f32 v122, v122
    v_smfmac_f32_32x32x32_bf16 v[160:175], v[156:159], v[104:111], v204
    s_cmp_lg_u32 s54, 0
    v_exp_f32 v123, v123
    v_exp_f32 v124, v124
    v_exp_f32 v125, v125
    v_smfmac_f32_16x16x64_bf16 v[192:195], v[200:203], v[104:111], v204
    ds_read_b128 v[140:143], v24 offset:3072
    v_exp_f32 v126, v126
    v_exp_f32 v127, v127
    s_cbranch_scc1 c_attn_loop
    v_smfmac_f32_16x16x64_bf16 v[196:199], v[200:203], v[112:119], v204
    v_smfmac_f32_16x16x64_bf16 v[196:199], v[200:203], v[120:127], v204
    v_smfmac_f32_32x32x32_bf16 v[176:191], v[152:155], v[112:119], v204
    v_smfmac_f32_32x32x32_bf16 v[176:191], v[156:159], v[120:127], v204
    v_mov_b32 v25, 0x5f000000
    v_mov_b32 v26, 0x2b800000
    v_cmp_lt_f32 s[56:57], v192, v25
    v_cmp_gt_f32 vcc, v192, v26
    s_and_b64 s[56:57], s[56:57], vcc
    s_nop 0
    v_cmp_lt_f32 vcc, v196, v25
    s_and_b64 s[56:57], s[56:57], vcc
    v_cmp_gt_f32 vcc, v196, v26
    s_and_b64 s[56:57], s[56:57], vcc
    s_cmp_lg_u64 s[56:57], -1
    s_cbranch_scc1 c_attn_slow
c_attn_fin:
    s_lshl_b32 s3, s48, 17
    s_lshl_b32 s55, s7, 12
    s_add_u32 s3, s3, s55
    s_and_b32 s55, s6, 1
    s_lshl_b32 s55, s55, 11
    s_add_u32 s3, s3, s55
    s_lshl_b32 s55, s9, 22
    s_add_u32 s3, s3, s55
    s_add_u32 s3, s3, 16777216
    v_rcp_f32 v192, v192
    s_nop 0
    v_pk_mul_f32 v[160:161], v[192:193], v[160:161] op_sel_hi:[0,1]
    v_pk_mul_f32 v[162:163], v[192:193], v[162:163] op_sel_hi:[0,1]
    v_pk_mul_f32 v[164:165], v[192:193], v[164:165] op_sel_hi:[0,1]
    v_pk_mul_f32 v[166:167], v[192:193], v[166:167] op_sel_hi:[0,1]
    v_pk_mul_f32 v[168:169], v[192:193], v[168:169] op_sel_hi:[0,1]
    v_pk_mul_f32 v[170:171], v[192:193], v[170:171] op_sel_hi:[0,1]
    v_pk_mul_f32 v[172:173], v[192:193], v[172:173] op_sel_hi:[0,1]
    v_pk_mul_f32 v[174:175], v[192:193], v[174:175] op_sel_hi:[0,1]
    v_cvt_pk_bf16_f32 v160, v160, v161
    v_cvt_pk_bf16_f32 v161, v162, v163
    v_cvt_pk_bf16_f32 v162, v164, v165
    v_cvt_pk_bf16_f32 v163, v166, v167
    v_cvt_pk_bf16_f32 v164, v168, v169
    v_cvt_pk_bf16_f32 v165, v170, v171
    v_cvt_pk_bf16_f32 v166, v172, v173
    v_cvt_pk_bf16_f32 v167, v174, v175
    buffer_store_dwordx4 v[160:163], v5, s[12:15], s3 offen offset:0 sc1
    buffer_store_dwordx4 v[164:167], v5, s[12:15], s3 offen offset:1024 sc1
    s_add_u32 s3, s3, 65536
    v_rcp_f32 v196, v196
    s_nop 0
    v_pk_mul_f32 v[176:177], v[196:197], v[176:177] op_sel_hi:[0,1]
    v_pk_mul_f32 v[178:179], v[196:197], v[178:179] op_sel_hi:[0,1]
    v_pk_mul_f32 v[180:181], v[196:197], v[180:181] op_sel_hi:[0,1]
    v_pk_mul_f32 v[182:183], v[196:197], v[182:183] op_sel_hi:[0,1]
    v_pk_mul_f32 v[184:185], v[196:197], v[184:185] op_sel_hi:[0,1]
    v_pk_mul_f32 v[186:187], v[196:197], v[186:187] op_sel_hi:[0,1]
    v_pk_mul_f32 v[188:189], v[196:197], v[188:189] op_sel_hi:[0,1]
    v_pk_mul_f32 v[190:191], v[196:197], v[190:191] op_sel_hi:[0,1]
    v_cvt_pk_bf16_f32 v176, v176, v177
    v_cvt_pk_bf16_f32 v177, v178, v179
    v_cvt_pk_bf16_f32 v178, v180, v181
    v_cvt_pk_bf16_f32 v179, v182, v183
    v_cvt_pk_bf16_f32 v180, v184, v185
    v_cvt_pk_bf16_f32 v181, v186, v187
    v_cvt_pk_bf16_f32 v182, v188, v189
    v_cvt_pk_bf16_f32 v183, v190, v191
    buffer_store_dwordx4 v[176:179], v5, s[12:15], s3 offen offset:0 sc1
    buffer_store_dwordx4 v[180:183], v5, s[12:15], s3 offen offset:1024 sc1
    s_add_u32 s3, s3, 65536
    s_branch c_wo
.p2align 6
h_first_tail:
    s_waitcnt vmcnt(0)
    s_sub_u32 s50, s50, 8000
    s_load_dword s10, s[46:47], 0
    s_waitcnt lgkmcnt(0)
    s_sub_u32 s51, s10, s50
    s_and_b32 s3, s10, 1
    s_cselect_b32 s51, s51, -1
    s_cmp_ge_i32 s51, 0
    s_cbranch_scc1 h_first_non_ok
    s_load_dword s10, s[46:47], 128
    s_waitcnt lgkmcnt(0)
    s_sub_u32 s51, s10, s50
    s_and_b32 s3, s10, 1
    s_cselect_b32 s51, s51, -1
    s_cmp_ge_i32 s51, 0
    s_cbranch_scc1 h_first_non_ok
    s_load_dword s10, s[46:47], 64
    s_waitcnt lgkmcnt(0)
    s_sub_u32 s51, s10, s50
    s_and_b32 s3, s10, 1
    s_cselect_b32 s51, s51, -1
    s_cmp_ge_i32 s51, 0
    s_cbranch_scc1 h_first_non_ok
    s_load_dword s10, s[46:47], 192
    s_waitcnt lgkmcnt(0)
    s_sub_u32 s51, s10, s50
    s_and_b32 s3, s10, 1
    s_cselect_b32 s51, s51, -1
    s_cmp_ge_i32 s51, 0
    s_cbranch_scc1 h_first_non_ok
    s_mov_b32 s58, 0
    s_and_b32 s57, s2, 0xc0
h_first_non:
    s_load_dword s10, s[46:47], s57 glc
    s_waitcnt lgkmcnt(0)
    s_sub_u32 s51, s10, s50
    s_and_b32 s3, s10, 1
    s_cselect_b32 s51, s51, -1
    s_cmp_ge_i32 s51, 0
    s_cbranch_scc1 h_first_non_ok
    s_add_u32 s58, s58, 1
    s_cmp_gt_u32 s58, 100
    s_cselect_b32 s50, s10, s50
    s_cmp_lt_u32 s58, 0x100000
    s_cbranch_scc1 h_first_non
    s_mov_b32 s10, 1
h_first_non_ok:
    v_mov_b32 v12, s10
    ds_write_b32 v10, v12 offset:4
    v_lshlrev_b32 v13, 7, v1
    s_lshl_b32 s50, s2, 13
    s_mov_b32 s28, s36
    s_mov_b32 s29, s37
    s_mov_b32 s30, 2097152
    s_mov_b32 s31, 0x00020000
    buffer_load_dword v14, v13, s[28:31], s50 offen
    s_mov_b32 s9, 0
h_qkvA:
    s_mul_i32 s98, s9, 786432
    s_add_u32 s98, s98, 65273856
    s_lshl_b32 s99, s11, 10
    s_add_u32 s98, s98, s99
    s_add_u32 s96, s4, s98
    s_addc_u32 s97, s5, 0
    s_mov_b32 s98, s10
    s_mov_b32 s99, s10
    v_and_b32 v1, 63, v0
    v_lshlrev_b32 v5, 4, v1
    v_and_b32 v20, 15, v1
    v_lshrrev_b32 v11, 4, v1
    v_min_u32 v11, 2, v11
    v_lshlrev_b32 v21, 3, v20
    v_lshl_add_u32 v12, v11, 7, v21
    v_add_u32 v12, 155648, v12
    v_lshl_add_u32 v11, v11, 16, v21
    v_mov_b32 v10, 159496
    s_add_u32 s3, s9, 1
    v_mov_b32 v13, s3
    s_and_b32 s3, s6, 14
    s_lshl_b32 s3, s3, 2
    s_sub_u32 s3, s3, 1
    s_max_i32 s3, s3, 0
    s_lshl_b32 s3, s3, 16
    s_lshl_b32 s48, s9, 22
    s_add_u32 s3, s3, s48
    s_add_u32 s20, s4, s3
    s_addc_u32 s21, s5, 0
    s_mov_b32 s22, 65536
    s_mov_b32 s23, 0x00020000
    s_cmp_lt_u32 s6, 2
    s_cselect_b32 s22, 0, s22
    s_cselect_b32 s3, 0, 512
    s_add_u32 s96, s96, s3
    s_addc_u32 s97, s97, 0
    v_bfe_u32 v21, v1, 4, 1
    v_lshl_add_u32 v6, v21, 5, v20
    v_lshlrev_b32 v6, 4, v6
    v_lshrrev_b32 v21, 5, v1
    v_lshl_add_u32 v6, v21, 10, v6
    v_add_u32 v6, 256, v6
    v_add_u32 v16, 49152, v5
    s_cmp_eq_u32 s9, 0
    s_cbranch_scc1 h_qkvA_noend
    s_barrier
    s_cmp_lt_u32 s9, 2
    s_cbranch_scc1 c4_11
    ds_write_b128 v16, v[64:67] offset:0
    ds_write_b128 v16, v[68:71] offset:1024
    ds_write_b128 v16, v[72:75] offset:2048
    ds_write_b128 v16, v[76:79] offset:3072
    ds_write_b128 v16, v[80:83] offset:4096
    ds_write_b128 v16, v[84:87] offset:5120
    ds_write_b128 v16, v[88:91] offset:6144
    ds_write_b128 v16, v[92:95] offset:7168
    ds_write_b128 v16, v[96:99] offset:8192
    ds_write_b128 v16, v[100:103] offset:9216
    ds_write_b128 v16, v[104:107] offset:10240
    ds_write_b128 v16, v[108:111] offset:11264
    ds_write_b128 v16, v[112:115] offset:12288
    ds_write_b128 v16, v[116:119] offset:13312
    ds_write_b128 v16, v[120:123] offset:14336
    ds_write_b128 v16, v[124:127] offset:15360
    ds_write_b128 v16, v[128:131] offset:16384
    ds_write_b128 v16, v[132:135] offset:17408
    ds_write_b128 v16, v[136:139] offset:18432
    ds_write_b128 v16, v[140:143] offset:19456
    ds_write_b128 v16, v[144:147] offset:20480
    ds_write_b128 v16, v[148:151] offset:21504
    ds_write_b128 v16, v[152:155] offset:22528
    ds_write_b128 v16, v[156:159] offset:23552
    s_waitcnt lgkmcnt(0)
c4_11:
    s_barrier
h_qkvA_noend:
    s_mov_b32 s3, 0x100000
poll_12:
    s_load_dwordx8 s[80:87], s[96:97], 0 glc
    s_load_dwordx8 s[88:95], s[96:97], 128 glc
    s_sub_u32 s3, s3, 1
    s_cbranch_scc1 poll_12_ok
    s_waitcnt lgkmcnt(0)
    s_xor_b64 s[100:101], s[80:81], s[98:99]
    s_xor_b64 s[80:81], s[82:83], s[98:99]
    s_or_b64 s[100:101], s[100:101], s[80:81]
    s_xor_b64 s[80:81], s[84:85], s[98:99]
    s_or_b64 s[100:101], s[100:101], s[80:81]
    s_xor_b64 s[80:81], s[86:87], s[98:99]
    s_or_b64 s[100:101], s[100:101], s[80:81]
    s_xor_b64 s[80:81], s[88:89], s[98:99]
    s_or_b64 s[100:101], s[100:101], s[80:81]
    s_xor_b64 s[80:81], s[90:91], s[98:99]
    s_or_b64 s[100:101], s[100:101], s[80:81]
    s_xor_b64 s[80:81], s[92:93], s[98:99]
    s_or_b64 s[100:101], s[100:101], s[80:81]
    s_xor_b64 s[80:81], s[94:95], s[98:99]
    s_or_b64 s[100:101], s[100:101], s[80:81]
    s_cbranch_scc1 poll_12
poll_12_ok:
    s_waitcnt lgkmcnt(0)
    ds_write_b32 v10, v13
    s_mov_b32 m0, 147456
    s_mov_b32 s48, 0
    buffer_load_dwordx4 v6, s[20:23], s48 offen sc1 lds
    s_mov_b32 m0, 148480
    s_mov_b32 s48, 2048
    buffer_load_dwordx4 v6, s[20:23], s48 offen sc1 lds
    s_mov_b32 m0, 149504
    s_mov_b32 s48, 4096
    buffer_load_dwordx4 v6, s[20:23], s48 offen sc1 lds
    s_mov_b32 m0, 150528
    s_mov_b32 s48, 6144
    buffer_load_dwordx4 v6, s[20:23], s48 offen sc1 lds
    s_mov_b32 m0, 151552
    s_mov_b32 s48, 8192
    buffer_load_dwordx4 v6, s[20:23], s48 offen sc1 lds
    s_mov_b32 m0, 152576
    s_mov_b32 s48, 10240
    buffer_load_dwordx4 v6, s[20:23], s48 offen sc1 lds
    s_mov_b32 m0, 153600
    s_mov_b32 s48, 12288
    buffer_load_dwordx4 v6, s[20:23], s48 offen sc1 lds
    s_mov_b32 m0, 154624
    s_mov_b32 s48, 14336
    buffer_load_dwordx4 v6, s[20:23], s48 offen sc1 lds
    s_lshl_b32 s56, s7, 12
    s_and_b32 s57, s6, 1
    s_lshl_b32 s57, s57, 7
    s_add_u32 s56, s56, s57
    s_add_u32 s56, s56, 63963136
    v_lshlrev_b32 v15, 7, v1
    s_lshr_b32 s59, s2, 3
    s_mul_i32 s59, s59, 3
    s_lshr_b32 s59, s59, 5
    s_lshl_b32 s3, s9, 4
    s_add_u32 s59, s59, s3
    s_waitcnt vmcnt(4)
    s_barrier
    s_waitcnt vmcnt(0)
    s_barrier
    s_mov_b32 m0, 147456
    s_mov_b32 s48, 16384
    buffer_load_dwordx4 v6, s[20:23], s48 offen sc1 lds
    s_mov_b32 m0, 148480
    s_mov_b32 s48, 18432
    buffer_load_dwordx4 v6, s[20:23], s48 offen sc1 lds
    s_mov_b32 m0, 149504
    s_mov_b32 s48, 20480
    buffer_load_dwordx4 v6, s[20:23], s48 offen sc1 lds
    s_mov_b32 m0, 150528
    s_mov_b32 s48, 22528
    buffer_load_dwordx4 v6, s[20:23], s48 offen sc1 lds
    s_waitcnt vmcnt(0)
    s_waitcnt vmcnt(0)
    s_barrier
    s_mov_b32 m0, 151552
    s_mov_b32 s48, 24576
    buffer_load_dwordx4 v6, s[20:23], s48 offen sc1 lds
    s_mov_b32 m0, 152576
    s_mov_b32 s48, 26624
    buffer_load_dwordx4 v6, s[20:23], s48 offen sc1 lds
    s_mov_b32 m0, 153600
    s_mov_b32 s48, 28672
    buffer_load_dwordx4 v6, s[20:23], s48 offen sc1 lds
    s_mov_b32 m0, 154624
    s_mov_b32 s48, 30720
    buffer_load_dwordx4 v6, s[20:23], s48 offen sc1 lds
    s_cmp_ge_u32 s9, 2
    s_cbranch_scc1 cs_14
    buffer_load_dwordx2 v[32:33], v11, s[12:15], s56 offen offset:0 sc1
    buffer_load_dwordx2 v[34:35], v11, s[12:15], s56 offen offset:256 sc1
    buffer_load_dwordx2 v[36:37], v11, s[12:15], s56 offen offset:512 sc1
    buffer_load_dwordx2 v[38:39], v11, s[12:15], s56 offen offset:768 sc1
    buffer_load_dwordx2 v[40:41], v11, s[12:15], s56 offen offset:1024 sc1
    buffer_load_dwordx2 v[42:43], v11, s[12:15], s56 offen offset:1280 sc1
    buffer_load_dwordx2 v[44:45], v11, s[12:15], s56 offen offset:1536 sc1
    buffer_load_dwordx2 v[46:47], v11, s[12:15], s56 offen offset:1792 sc1
    buffer_load_dwordx2 v[48:49], v11, s[12:15], s56 offen offset:2048 sc1
    buffer_load_dwordx2 v[50:51], v11, s[12:15], s56 offen offset:2304 sc1
    buffer_load_dwordx2 v[52:53], v11, s[12:15], s56 offen offset:2560 sc1
    buffer_load_dwordx2 v[54:55], v11, s[12:15], s56 offen offset:2816 sc1
cs_14:
    s_waitcnt vmcnt(0)
    s_waitcnt vmcnt(12)
    s_barrier
    s_mov_b32 m0, 147456
    s_mov_b32 s48, 32768
    buffer_load_dwordx4 v6, s[20:23], s48 offen sc1 lds
    s_mov_b32 m0, 148480
    s_mov_b32 s48, 34816
    buffer_load_dwordx4 v6, s[20:23], s48 offen sc1 lds
    s_mov_b32 m0, 149504
    s_mov_b32 s48, 36864
    buffer_load_dwordx4 v6, s[20:23], s48 offen sc1 lds
    s_mov_b32 m0, 150528
    s_mov_b32 s48, 38912
    buffer_load_dwordx4 v6, s[20:23], s48 offen sc1 lds
    s_cmp_ge_u32 s9, 2
    s_cbranch_scc1 cs_15
    buffer_load_dwordx2 v[56:57], v11, s[12:15], s56 offen offset:3072 sc1
    buffer_load_dwordx2 v[58:59], v11, s[12:15], s56 offen offset:3328 sc1
    buffer_load_dwordx2 v[60:61], v11, s[12:15], s56 offen offset:3584 sc1
    buffer_load_dwordx2 v[62:63], v11, s[12:15], s56 offen offset:3840 sc1
cs_15:
    s_waitcnt vmcnt(0)
    s_waitcnt vmcnt(4)
    s_barrier
    s_mov_b32 m0, 151552
    s_mov_b32 s48, 40960
    buffer_load_dwordx4 v6, s[20:23], s48 offen sc1 lds
    s_mov_b32 m0, 152576
    s_mov_b32 s48, 43008
    buffer_load_dwordx4 v6, s[20:23], s48 offen sc1 lds
    s_mov_b32 m0, 153600
    s_mov_b32 s48, 45056
    buffer_load_dwordx4 v6, s[20:23], s48 offen sc1 lds
    s_mov_b32 m0, 154624
    s_mov_b32 s48, 47104
    buffer_load_dwordx4 v6, s[20:23], s48 offen sc1 lds
    s_cmp_ge_u32 s9, 2
    s_cbranch_scc1 c4_16
    ds_read_b128 v[64:67], v16 offset:0
    ds_read_b128 v[68:71], v16 offset:1024
    ds_read_b128 v[72:75], v16 offset:2048
    ds_read_b128 v[76:79], v16 offset:3072
    ds_read_b128 v[80:83], v16 offset:4096
    ds_read_b128 v[84:87], v16 offset:5120
    ds_read_b128 v[88:91], v16 offset:6144
    ds_read_b128 v[92:95], v16 offset:7168
    ds_read_b128 v[96:99], v16 offset:8192
    ds_read_b128 v[100:103], v16 offset:9216
    ds_read_b128 v[104:107], v16 offset:10240
    ds_read_b128 v[108:111], v16 offset:11264
    ds_read_b128 v[112:115], v16 offset:12288
    ds_read_b128 v[116:119], v16 offset:13312
    ds_read_b128 v[120:123], v16 offset:14336
    ds_read_b128 v[124:127], v16 offset:15360
    ds_read_b128 v[128:131], v16 offset:16384
    ds_read_b128 v[132:135], v16 offset:17408
    ds_read_b128 v[136:139], v16 offset:18432
    ds_read_b128 v[140:143], v16 offset:19456
    ds_read_b128 v[144:147], v16 offset:20480
    ds_read_b128 v[148:151], v16 offset:21504
    ds_read_b128 v[152:155], v16 offset:22528
    ds_read_b128 v[156:159], v16 offset:23552
    s_waitcnt lgkmcnt(0)
c4_16:
    s_cmp_ge_u32 s9, 2
    s_cbranch_scc1 cs_17
    s_waitcnt vmcnt(4)
    v_add_f32 v32, v32, v48
    v_add_f32 v33, v33, v49
    v_add_f32 v34, v34, v50
    v_add_f32 v35, v35, v51
    v_add_f32 v36, v36, v52
    v_add_f32 v37, v37, v53
    v_add_f32 v38, v38, v54
    v_add_f32 v39, v39, v55
    v_add_f32 v40, v40, v56
    v_add_f32 v41, v41, v57
    v_add_f32 v42, v42, v58
    v_add_f32 v43, v43, v59
cs_17:
    s_waitcnt vmcnt(0)
    s_waitcnt vmcnt(0)
    s_barrier
    s_mov_b32 m0, 147456
    s_mov_b32 s48, 49152
    buffer_load_dwordx4 v6, s[20:23], s48 offen sc1 lds
    s_mov_b32 m0, 148480
    s_mov_b32 s48, 51200
    buffer_load_dwordx4 v6, s[20:23], s48 offen sc1 lds
    s_mov_b32 m0, 149504
    s_mov_b32 s48, 53248
    buffer_load_dwordx4 v6, s[20:23], s48 offen sc1 lds
    s_mov_b32 m0, 150528
    s_mov_b32 s48, 55296
    buffer_load_dwordx4 v6, s[20:23], s48 offen sc1 lds
    s_cmp_ge_u32 s9, 2
    s_cbranch_scc1 cs_18
    v_add_f32 v44, v44, v60
    v_add_f32 v45, v45, v61
    v_add_f32 v46, v46, v62
    v_add_f32 v47, v47, v63
    v_add_f32 v32, v32, v40
    v_add_f32 v33, v33, v41
    v_add_f32 v34, v34, v42
    v_add_f32 v35, v35, v43
    v_add_f32 v36, v36, v44
    v_add_f32 v37, v37, v45
    v_add_f32 v38, v38, v46
    v_add_f32 v39, v39, v47
cs_18:
    s_waitcnt vmcnt(0)
    s_waitcnt vmcnt(0)
    s_barrier
    s_mov_b32 m0, 151552
    s_mov_b32 s48, 57344
    buffer_load_dwordx4 v6, s[20:23], s48 offen sc1 lds
    s_mov_b32 m0, 152576
    s_mov_b32 s48, 59392
    buffer_load_dwordx4 v6, s[20:23], s48 offen sc1 lds
    s_mov_b32 m0, 153600
    s_mov_b32 s48, 61440
    buffer_load_dwordx4 v6, s[20:23], s48 offen sc1 lds
    s_mov_b32 m0, 154624
    s_mov_b32 s48, 63488
    buffer_load_dwordx4 v6, s[20:23], s48 offen sc1 lds
    s_cmp_ge_u32 s9, 2
    s_cbranch_scc1 cs_19
    v_add_f32 v32, v32, v36
    v_add_f32 v33, v33, v37
    v_add_f32 v34, v34, v38
    v_add_f32 v35, v35, v39
    v_add_f32 v32, v32, v34
    v_add_f32 v33, v33, v35
    ds_write_b64 v12, v[32:33]
    s_waitcnt lgkmcnt(0)
cs_19:
    s_waitcnt vmcnt(0)
    s_waitcnt vmcnt(0)
    s_barrier
    s_barrier
    s_barrier
    s_branch h_wo
h_qkvB:
    s_mul_i32 s98, s9, 786432
    s_add_u32 s98, s98, 65273856
    s_lshl_b32 s99, s11, 10
    s_add_u32 s98, s98, s99
    s_add_u32 s96, s4, s98
    s_addc_u32 s97, s5, 0
    s_mov_b32 s98, s10
    s_mov_b32 s99, s10
    v_and_b32 v1, 63, v0
    v_lshlrev_b32 v5, 4, v1
    v_and_b32 v20, 15, v1
    v_lshrrev_b32 v11, 4, v1
    v_min_u32 v11, 2, v11
    v_lshlrev_b32 v21, 3, v20
    v_lshl_add_u32 v12, v11, 7, v21
    v_add_u32 v12, 156032, v12
    v_lshl_add_u32 v11, v11, 16, v21
    v_mov_b32 v10, 159496
    s_add_u32 s3, s9, 1
    v_mov_b32 v13, s3
    v_add_u32 v16, 49152, v5
    s_barrier
    s_cmp_lt_u32 s9, 2
    s_cbranch_scc1 c4_22
    ds_write_b128 v16, v[160:163] offset:0
    ds_write_b128 v16, v[164:167] offset:1024
    ds_write_b128 v16, v[168:171] offset:2048
    ds_write_b128 v16, v[172:175] offset:3072
    ds_write_b128 v16, v[176:179] offset:4096
    ds_write_b128 v16, v[180:183] offset:5120
    ds_write_b128 v16, v[184:187] offset:6144
    ds_write_b128 v16, v[188:191] offset:7168
    ds_write_b128 v16, v[192:195] offset:8192
    ds_write_b128 v16, v[196:199] offset:9216
    ds_write_b128 v16, v[200:203] offset:10240
    ds_write_b128 v16, v[204:207] offset:11264
    ds_write_b128 v16, v[208:211] offset:12288
    ds_write_b128 v16, v[212:215] offset:13312
    ds_write_b128 v16, v[216:219] offset:14336
    ds_write_b128 v16, v[220:223] offset:15360
    ds_write_b128 v16, a[0:3] offset:16384
    ds_write_b128 v16, a[4:7] offset:17408
    ds_write_b128 v16, a[8:11] offset:18432
    ds_write_b128 v16, a[12:15] offset:19456
    ds_write_b128 v16, a[16:19] offset:20480
    ds_write_b128 v16, a[20:23] offset:21504
    ds_write_b128 v16, a[24:27] offset:22528
    ds_write_b128 v16, a[28:31] offset:23552
    s_waitcnt lgkmcnt(0)
c4_22:
    s_barrier
    s_mov_b32 s3, 0x100000
poll_23:
    s_load_dwordx8 s[88:95], s[96:97], 0 glc
    s_sub_u32 s3, s3, 1
    s_cbranch_scc1 poll_23_ok
    s_waitcnt lgkmcnt(0)
    s_xor_b64 s[100:101], s[88:89], s[98:99]
    s_xor_b64 s[88:89], s[90:91], s[98:99]
    s_or_b64 s[100:101], s[100:101], s[88:89]
    s_xor_b64 s[88:89], s[92:93], s[98:99]
    s_or_b64 s[100:101], s[100:101], s[88:89]
    s_xor_b64 s[88:89], s[94:95], s[98:99]
    s_or_b64 s[100:101], s[100:101], s[88:89]
    s_cbranch_scc1 poll_23
poll_23_ok:
    s_waitcnt lgkmcnt(0)
    ds_write_b32 v10, v13
    s_lshl_b32 s56, s7, 12
    s_and_b32 s57, s6, 1
    s_lshl_b32 s57, s57, 7
    s_add_u32 s56, s56, s57
    s_add_u32 s56, s56, 64159744
    s_barrier
    s_barrier
    s_barrier
    s_cmp_ge_u32 s9, 2
    s_cbranch_scc1 cs_25
    buffer_load_dwordx2 v[32:33], v11, s[12:15], s56 offen offset:0 sc1
    buffer_load_dwordx2 v[34:35], v11, s[12:15], s56 offen offset:256 sc1
    buffer_load_dwordx2 v[36:37], v11, s[12:15], s56 offen offset:512 sc1
    buffer_load_dwordx2 v[38:39], v11, s[12:15], s56 offen offset:768 sc1
    buffer_load_dwordx2 v[40:41], v11, s[12:15], s56 offen offset:1024 sc1
    buffer_load_dwordx2 v[42:43], v11, s[12:15], s56 offen offset:1280 sc1
    buffer_load_dwordx2 v[44:45], v11, s[12:15], s56 offen offset:1536 sc1
    buffer_load_dwordx2 v[46:47], v11, s[12:15], s56 offen offset:1792 sc1
    buffer_load_dwordx2 v[48:49], v11, s[12:15], s56 offen offset:2048 sc1
    buffer_load_dwordx2 v[50:51], v11, s[12:15], s56 offen offset:2304 sc1
    buffer_load_dwordx2 v[52:53], v11, s[12:15], s56 offen offset:2560 sc1
    buffer_load_dwordx2 v[54:55], v11, s[12:15], s56 offen offset:2816 sc1
cs_25:
    s_barrier
    s_cmp_ge_u32 s9, 2
    s_cbranch_scc1 cs_26
    buffer_load_dwordx2 v[56:57], v11, s[12:15], s56 offen offset:3072 sc1
    buffer_load_dwordx2 v[58:59], v11, s[12:15], s56 offen offset:3328 sc1
    buffer_load_dwordx2 v[60:61], v11, s[12:15], s56 offen offset:3584 sc1
    buffer_load_dwordx2 v[62:63], v11, s[12:15], s56 offen offset:3840 sc1
cs_26:
    s_barrier
    s_cmp_ge_u32 s9, 2
    s_cbranch_scc1 c4_27
    ds_read_b128 v[160:163], v16 offset:0
    ds_read_b128 v[164:167], v16 offset:1024
    ds_read_b128 v[168:171], v16 offset:2048
    ds_read_b128 v[172:175], v16 offset:3072
    ds_read_b128 v[176:179], v16 offset:4096
    ds_read_b128 v[180:183], v16 offset:5120
    ds_read_b128 v[184:187], v16 offset:6144
    ds_read_b128 v[188:191], v16 offset:7168
    ds_read_b128 v[192:195], v16 offset:8192
    ds_read_b128 v[196:199], v16 offset:9216
    ds_read_b128 v[200:203], v16 offset:10240
    ds_read_b128 v[204:207], v16 offset:11264
    ds_read_b128 v[208:211], v16 offset:12288
    ds_read_b128 v[212:215], v16 offset:13312
    ds_read_b128 v[216:219], v16 offset:14336
    ds_read_b128 v[220:223], v16 offset:15360
    ds_read_b128 a[0:3], v16 offset:16384
    ds_read_b128 a[4:7], v16 offset:17408
    ds_read_b128 a[8:11], v16 offset:18432
    ds_read_b128 a[12:15], v16 offset:19456
    ds_read_b128 a[16:19], v16 offset:20480
    ds_read_b128 a[20:23], v16 offset:21504
    ds_read_b128 a[24:27], v16 offset:22528
    ds_read_b128 a[28:31], v16 offset:23552
    s_waitcnt lgkmcnt(0)
c4_27:
    s_cmp_ge_u32 s9, 2
    s_cbranch_scc1 cs_28
    s_waitcnt vmcnt(0)
    v_add_f32 v32, v32, v48
    v_add_f32 v33, v33, v49
    v_add_f32 v34, v34, v50
    v_add_f32 v35, v35, v51
    v_add_f32 v36, v36, v52
    v_add_f32 v37, v37, v53
    v_add_f32 v38, v38, v54
    v_add_f32 v39, v39, v55
    v_add_f32 v40, v40, v56
    v_add_f32 v41, v41, v57
    v_add_f32 v42, v42, v58
    v_add_f32 v43, v43, v59
cs_28:
    s_barrier
    s_cmp_ge_u32 s9, 2
    s_cbranch_scc1 cs_29
    v_add_f32 v44, v44, v60
    v_add_f32 v45, v45, v61
    v_add_f32 v46, v46, v62
    v_add_f32 v47, v47, v63
    v_add_f32 v32, v32, v40
    v_add_f32 v33, v33, v41
    v_add_f32 v34, v34, v42
    v_add_f32 v35, v35, v43
    v_add_f32 v36, v36, v44
    v_add_f32 v37, v37, v45
    v_add_f32 v38, v38, v46
    v_add_f32 v39, v39, v47
cs_29:
    s_barrier
    s_cmp_ge_u32 s9, 2
    s_cbranch_scc1 cs_30
    v_add_f32 v32, v32, v36
    v_add_f32 v33, v33, v37
    v_add_f32 v34, v34, v38
    v_add_f32 v35, v35, v39
    v_add_f32 v32, v32, v34
    v_add_f32 v33, v33, v35
    ds_write_b64 v12, v[32:33]
    s_waitcnt lgkmcnt(0)
cs_30:
    s_barrier
    s_barrier
    s_branch s_attn
.p2align 6
l_first_tail:
    s_mov_b32 s28, s40
    s_mov_b32 s29, s41
    s_mov_b32 s30, 6291456
    s_mov_b32 s31, 0x00020000
    v_lshlrev_b32 v14, 6, v20
    v_lshrrev_b32 v22, 5, v1
    v_bfe_u32 v23, v1, 1, 1
    v_xor_b32 v22, v22, v23
    v_lshl_add_u32 v14, v22, 5, v14
    v_and_b32 v22, 1, v1
    v_lshl_add_u32 v14, v22, 4, v14
    v_bfe_u32 v23, v1, 2, 1
    v_mul_u32_u24 v23, 196608, v23
    v_add_u32 v14, v14, v23
    v_lshlrev_b32 v22, 4, v22
    v_mov_b32 v23, 0x3f80
    v_lshlrev_b32 v23, v22, v23
    v_bfe_u32 v22, v1, 1, 3
    v_cmp_eq_u32 vcc, 0, v22
    s_nop 1
    v_cndmask_b32 v24, 0, v23, vcc
    v_cmp_eq_u32 vcc, 1, v22
    s_nop 1
    v_cndmask_b32 v25, 0, v23, vcc
    v_cmp_eq_u32 vcc, 2, v22
    s_nop 1
    v_cndmask_b32 v26, 0, v23, vcc
    v_cmp_eq_u32 vcc, 3, v22
    s_nop 1
    v_cndmask_b32 v27, 0, v23, vcc
    v_lshlrev_b32 v15, 5, v21
    v_and_b32 v22, 16, v1
    v_add_u32 v15, v15, v22
    v_lshlrev_b32 v16, 14, v1
    s_mov_b32 s9, 0
    s_lshr_b32 s55, s63, 4
    s_and_b32 s56, s63, 15
    s_lshl_b32 s57, s56, 4
    s_lshr_b32 s58, s62, 1
    s_add_u32 s57, s57, s58
    s_mul_i32 s57, s57, 3
    s_add_u32 s57, s57, s55
    s_lshl_b32 s57, s57, 13
    s_and_b32 s58, s62, 1
    s_lshl_b32 s58, s58, 12
    s_add_u32 s57, s57, s58
    s_add_u32 s57, s57, 50331648
    s_lshl_b32 s54, s61, 8
    s_add_u32 s54, s54, 63963136
    s_lshl_b32 s56, s56, 10
    s_lshl_b32 s55, s55, 7
    s_add_u32 s55, s55, s56
    s_lshl_b32 s56, s62, 2
    s_add_u32 s55, s55, s56
    s_add_u32 s55, s55, 64487424
    s_waitcnt vmcnt(7)
    buffer_store_dwordx4 v[160:163], v14, s[12:15], s57 offen offset:0 sc1
    v_mfma_f32_16x16x32_bf16 v[28:31], v[24:27], v[160:163], 0
    s_waitcnt vmcnt(7)
    buffer_store_dwordx4 v[164:167], v14, s[12:15], s57 offen offset:1024 sc1
    v_mfma_f32_16x16x32_bf16 v[28:31], v[24:27], v[164:167], v[28:31]
    s_waitcnt vmcnt(7)
    buffer_store_dwordx4 v[168:171], v14, s[12:15], s57 offen offset:512 sc1
    v_mfma_f32_16x16x32_bf16 v[28:31], v[24:27], v[168:171], v[28:31]
    s_waitcnt vmcnt(7)
    buffer_store_dwordx4 v[172:175], v14, s[12:15], s57 offen offset:1536 sc1
    v_mfma_f32_16x16x32_bf16 v[28:31], v[24:27], v[172:175], v[28:31]
    s_waitcnt vmcnt(7)
    buffer_store_dwordx4 v[176:179], v14, s[12:15], s57 offen offset:2048 sc1
    v_mfma_f32_16x16x32_bf16 v[28:31], v[24:27], v[176:179], v[28:31]
    s_waitcnt vmcnt(7)
    buffer_store_dwordx4 v[180:183], v14, s[12:15], s57 offen offset:3072 sc1
    v_mfma_f32_16x16x32_bf16 v[28:31], v[24:27], v[180:183], v[28:31]
    s_waitcnt vmcnt(7)
    buffer_store_dwordx4 v[184:187], v14, s[12:15], s57 offen offset:2560 sc1
    v_mfma_f32_16x16x32_bf16 v[28:31], v[24:27], v[184:187], v[28:31]
    s_waitcnt vmcnt(7)
    buffer_store_dwordx4 v[188:191], v14, s[12:15], s57 offen offset:3584 sc1
    v_mfma_f32_16x16x32_bf16 v[28:31], v[24:27], v[188:191], v[28:31]
    s_nop 7
    v_add_f32_dpp v28, v28, v28 row_ror:8 row_mask:0xf bank_mask:0xf
    v_add_f32_dpp v29, v29, v29 row_ror:8 row_mask:0xf bank_mask:0xf
    v_add_f32_dpp v30, v30, v30 row_ror:8 row_mask:0xf bank_mask:0xf
    v_add_f32_dpp v31, v31, v31 row_ror:8 row_mask:0xf bank_mask:0xf
    s_mov_b64 exec, 0x00ff00ff
    buffer_store_dwordx4 v[28:31], v15, s[12:15], s54 offen sc1
    s_mov_b64 exec, -1
    s_add_u32 s57, s57, 6291456
    s_add_u32 s54, s54, 196608
    v_mov_b32 v8, 159492
non_33:
    ds_read_b32 v9, v8
    s_waitcnt lgkmcnt(0)
    v_readfirstlane_b32 s10, v9
    s_cmp_eq_u32 s10, 0
    s_cbranch_scc1 non_33
    s_mov_b64 exec, 0xffff
    s_waitcnt vmcnt(0)
    buffer_store_dword v9, v16, s[12:15], s55 offen offset:0 sc1
    s_mov_b64 exec, -1
    s_add_u32 s53, s52, 0
    buffer_load_dwordx4 v[192:195], v12, s[28:31], s53 offen nt
    s_add_u32 s53, s52, 49152
    buffer_load_dwordx4 v[196:199], v12, s[28:31], s53 offen nt
    s_add_u32 s53, s52, 98304
    buffer_load_dwordx4 v[200:203], v12, s[28:31], s53 offen nt
    s_add_u32 s53, s52, 147456
    buffer_load_dwordx4 v[204:207], v12, s[28:31], s53 offen nt
    s_add_u32 s53, s52, 196608
    buffer_load_dwordx4 v[208:211], v12, s[28:31], s53 offen nt
    s_add_u32 s53, s52, 245760
    buffer_load_dwordx4 v[212:215], v12, s[28:31], s53 offen nt
    s_add_u32 s53, s52, 294912
    buffer_load_dwordx4 v[216:219], v12, s[28:31], s53 offen nt
    s_add_u32 s53, s52, 344064
    buffer_load_dwordx4 v[220:223], v12, s[28:31], s53 offen nt
    s_mov_b32 s58, s52
    s_lshr_b32 s60, s2, 3
    s_mul_i32 s60, s60, 3
    s_lshr_b32 s60, s60, 5
    s_add_u32 s60, s60, 1
    s_branch l_qkv2
l_qkv:
    s_mov_b32 s60, 0
l_qkv2:
    v_and_b32 v1, 63, v0
    v_lshlrev_b32 v5, 4, v1
    s_sub_u32 s51, s8, 5
    s_lshl_b32 s48, s51, 13
    s_and_b32 s53, s9, 1
    s_lshl_b32 s52, s53, 4
    s_add_u32 s49, s7, s52
    s_lshl_b32 s49, s49, 1
    s_and_b32 s52, s6, 1
    s_add_u32 s49, s49, s52
    s_mul_i32 s49, s49, 196608
    s_add_u32 s49, s49, s48
    s_add_u32 s49, s49, 50331648
    v_mov_b32 v13, 159496
    s_mov_b32 s50, 0
    v_lshrrev_b32 v10, 2, v1
    v_and_b32 v11, 3, v1
    v_lshlrev_b32 v10, 8, v10
    v_lshl_add_u32 v10, v11, 4, v10
    v_lshlrev_b32 v7, 5, v11
    v_lshlrev_b32 v11, 2, v1
    v_add_u32 v11, 155648, v11
    s_lshr_b32 s59, s11, 2
    s_lshl_b32 s59, s59, 12
    s_and_b32 s3, s11, 3
    s_lshl_b32 s3, s3, 6
    s_add_u32 s59, s59, s3
    s_lshl_b32 s3, s9, 18
    s_add_u32 s59, s59, s3
    s_add_u32 s59, s59, 62914560
    s_lshl_b32 s56, s9, 15
    s_add_u32 s56, s56, 64749568
    v_mov_b32 v41, s10
    v_mov_b32 v43, s10
    v_mov_b32 v45, s10
    v_mov_b32 v47, s10
    v_and_b32 v6, 0xff, v5
    s_lshl_b32 s3, s7, 7
    v_lshrrev_b32 v20, 3, v1
    v_lshlrev_b32 v21, 11, v20
    v_and_b32 v22, 2, v20
    v_lshrrev_b32 v23, 2, v20
    v_or_b32 v22, v22, v23
    v_bfe_u32 v23, v1, 1, 2
    v_xor_b32 v22, v22, v23
    v_lshl_add_u32 v21, v22, 5, v21
    v_and_b32 v22, 1, v1
    v_lshl_add_u32 v21, v22, 4, v21
    v_add_u32 v17, s3, v21
    s_lshl_b32 s3, s51, 13
    s_add_u32 s3, s3, 73728
    v_add_u32 v3, s3, v5
    s_cmp_lg_u32 s9, 0
    s_cbranch_scc1 l_qkv_tiled
    s_lshl_b32 s53, s8, 7
    s_lshl_b32 s52, s11, 10
    s_add_u32 s53, s53, s52
    s_add_u32 s53, s53, 64486784
    s_add_u32 s96, s4, s53
    s_addc_u32 s97, s5, 0
    s_mov_b32 s98, s10
    s_mov_b32 s99, s10
    s_mov_b32 s3, 0x100000
poll_34:
    s_load_dwordx16 s[80:95], s[96:97], 0 glc
    s_sub_u32 s3, s3, 1
    s_cbranch_scc1 poll_34_ok
    s_waitcnt lgkmcnt(0)
    s_xor_b64 s[100:101], s[80:81], s[98:99]
    s_xor_b64 s[80:81], s[82:83], s[98:99]
    s_or_b64 s[100:101], s[100:101], s[80:81]
    s_xor_b64 s[80:81], s[84:85], s[98:99]
    s_or_b64 s[100:101], s[100:101], s[80:81]
    s_xor_b64 s[80:81], s[86:87], s[98:99]
    s_or_b64 s[100:101], s[100:101], s[80:81]
    s_xor_b64 s[80:81], s[88:89], s[98:99]
    s_or_b64 s[100:101], s[100:101], s[80:81]
    s_xor_b64 s[80:81], s[90:91], s[98:99]
    s_or_b64 s[100:101], s[100:101], s[80:81]
    s_xor_b64 s[80:81], s[92:93], s[98:99]
    s_or_b64 s[100:101], s[100:101], s[80:81]
    s_xor_b64 s[80:81], s[94:95], s[98:99]
    s_or_b64 s[100:101], s[100:101], s[80:81]
    s_cbranch_scc1 poll_34
poll_34_ok:
    s_waitcnt lgkmcnt(0)
    s_branch l_qkv_fill
l_qkv_tiled:
    s_barrier
    s_cmp_lt_u32 s9, 2
    s_cbranch_scc1 l_qkv_nocache
    s_bitcmp1_b32 s9, 0
    s_cbranch_scc1 l_qkv_c_b
    ds_write_b128 v3, v[64:67] offset:0
    ds_write_b128 v3, v[68:71] offset:1024
    ds_write_b128 v3, v[72:75] offset:2048
    ds_write_b128 v3, v[76:79] offset:3072
    ds_write_b128 v3, v[80:83] offset:4096
    ds_write_b128 v3, v[84:87] offset:5120
    ds_write_b128 v3, v[88:91] offset:6144
    ds_write_b128 v3, v[92:95] offset:7168
    ds_write_b128 v3, v[96:99] offset:24576
    ds_write_b128 v3, v[100:103] offset:25600
    ds_write_b128 v3, v[104:107] offset:26624
    ds_write_b128 v3, v[108:111] offset:27648
    ds_write_b128 v3, v[112:115] offset:28672
    ds_write_b128 v3, v[116:119] offset:29696
    ds_write_b128 v3, v[120:123] offset:30720
    ds_write_b128 v3, v[124:127] offset:31744
    ds_write_b128 v3, v[128:131] offset:49152
    ds_write_b128 v3, v[132:135] offset:50176
    ds_write_b128 v3, v[136:139] offset:51200
    ds_write_b128 v3, v[140:143] offset:52224
    ds_write_b128 v3, v[144:147] offset:53248
    ds_write_b128 v3, v[148:151] offset:54272
    ds_write_b128 v3, v[152:155] offset:55296
    ds_write_b128 v3, v[156:159] offset:56320
    s_branch l_qkv_c_w
l_qkv_c_b:
    ds_write_b128 v3, v[160:163] offset:0
    ds_write_b128 v3, v[164:167] offset:1024
    ds_write_b128 v3, v[168:171] offset:2048
    ds_write_b128 v3, v[172:175] offset:3072
    ds_write_b128 v3, v[176:179] offset:4096
    ds_write_b128 v3, v[180:183] offset:5120
    ds_write_b128 v3, v[184:187] offset:6144
    ds_write_b128 v3, v[188:191] offset:7168
    ds_write_b128 v3, v[192:195] offset:24576
    ds_write_b128 v3, v[196:199] offset:25600
    ds_write_b128 v3, v[200:203] offset:26624
    ds_write_b128 v3, v[204:207] offset:27648
    ds_write_b128 v3, v[208:211] offset:28672
    ds_write_b128 v3, v[212:215] offset:29696
    ds_write_b128 v3, v[216:219] offset:30720
    ds_write_b128 v3, v[220:223] offset:31744
    ds_write_b128 v3, a[0:3] offset:49152
    ds_write_b128 v3, a[4:7] offset:50176
    ds_write_b128 v3, a[8:11] offset:51200
    ds_write_b128 v3, a[12:15] offset:52224
    ds_write_b128 v3, a[16:19] offset:53248
    ds_write_b128 v3, a[20:23] offset:54272
    ds_write_b128 v3, a[24:27] offset:55296
    ds_write_b128 v3, a[28:31] offset:56320
l_qkv_c_w:
    s_waitcnt lgkmcnt(0)
    s_barrier
    s_mov_b32 m0, s48
    s_add_u32 s50, s50, 1
    buffer_load_dwordx4 v5, s[12:15], s49 offen offset:0 sc1 lds
    buffer_load_dwordx4 v5, s[12:15], s49 offen offset:1024 sc1 lds
    buffer_load_dwordx4 v5, s[12:15], s49 offen offset:2048 sc1 lds
    buffer_load_dwordx4 v5, s[12:15], s49 offen offset:3072 sc1 lds
    s_add_u32 s49, s49, 4096
    s_bitcmp1_b32 s50, 0
    s_cselect_b32 s3, 0, 16384
    s_add_u32 s48, s48, s3
    s_add_u32 s49, s49, s3
    s_cmp_eq_u32 s50, 12
    s_cselect_b32 s3, 4294819840, 0
    s_add_u32 s48, s48, 4096
    s_add_u32 s48, s48, s3
    s_mov_b32 m0, s48
    s_add_u32 s50, s50, 1
    buffer_load_dwordx4 v5, s[12:15], s49 offen offset:0 sc1 lds
    buffer_load_dwordx4 v5, s[12:15], s49 offen offset:1024 sc1 lds
    buffer_load_dwordx4 v5, s[12:15], s49 offen offset:2048 sc1 lds
    buffer_load_dwordx4 v5, s[12:15], s49 offen offset:3072 sc1 lds
    s_add_u32 s49, s49, 4096
    s_bitcmp1_b32 s50, 0
    s_cselect_b32 s3, 0, 16384
    s_add_u32 s48, s48, s3
    s_add_u32 s49, s49, s3
    s_cmp_eq_u32 s50, 12
    s_cselect_b32 s3, 4294819840, 0
    s_add_u32 s48, s48, 4096
    s_add_u32 s48, s48, s3
    s_mov_b32 m0, s48
    s_add_u32 s50, s50, 1
    buffer_load_dwordx4 v5, s[12:15], s49 offen offset:0 sc1 lds
    buffer_load_dwordx4 v5, s[12:15], s49 offen offset:1024 sc1 lds
    buffer_load_dwordx4 v5, s[12:15], s49 offen offset:2048 sc1 lds
    buffer_load_dwordx4 v5, s[12:15], s49 offen offset:3072 sc1 lds
    s_add_u32 s49, s49, 4096
    s_bitcmp1_b32 s50, 0
    s_cselect_b32 s3, 0, 16384
    s_add_u32 s48, s48, s3
    s_add_u32 s49, s49, s3
    s_cmp_eq_u32 s50, 12
    s_cselect_b32 s3, 4294819840, 0
    s_add_u32 s48, s48, 4096
    s_add_u32 s48, s48, s3
    s_mov_b32 m0, s48
    s_add_u32 s50, s50, 1
    buffer_load_dwordx4 v5, s[12:15], s49 offen offset:0 sc1 lds
    buffer_load_dwordx4 v5, s[12:15], s49 offen offset:1024 sc1 lds
    buffer_load_dwordx4 v5, s[12:15], s49 offen offset:2048 sc1 lds
    buffer_load_dwordx4 v5, s[12:15], s49 offen offset:3072 sc1 lds
    s_add_u32 s49, s49, 4096
    s_bitcmp1_b32 s50, 0
    s_cselect_b32 s3, 0, 16384
    s_add_u32 s48, s48, s3
    s_add_u32 s49, s49, s3
    s_cmp_eq_u32 s50, 12
    s_cselect_b32 s3, 4294819840, 0
    s_add_u32 s48, s48, 4096
    s_add_u32 s48, s48, s3
    s_mov_b32 s50, 12
    s_add_u32 s49, s49, 98304
    s_lshl_b32 s48, s51, 13
    s_waitcnt vmcnt(8)
    s_barrier
    s_waitcnt vmcnt(0)
    s_branch l_qkv_gone
l_qkv_nocache:
    s_barrier
l_qkv_fill:
    s_mov_b32 m0, s48
    s_add_u32 s50, s50, 1
    buffer_load_dwordx4 v5, s[12:15], s49 offen offset:0 sc1 lds
    buffer_load_dwordx4 v5, s[12:15], s49 offen offset:1024 sc1 lds
    buffer_load_dwordx4 v5, s[12:15], s49 offen offset:2048 sc1 lds
    buffer_load_dwordx4 v5, s[12:15], s49 offen offset:3072 sc1 lds
    s_add_u32 s49, s49, 4096
    s_bitcmp1_b32 s50, 0
    s_cselect_b32 s3, 0, 16384
    s_add_u32 s48, s48, s3
    s_add_u32 s49, s49, s3
    s_cmp_eq_u32 s50, 12
    s_cselect_b32 s3, 4294819840, 0
    s_add_u32 s48, s48, 4096
    s_add_u32 s48, s48, s3
l_qkv_fill1:
    s_mov_b32 m0, s48
    s_add_u32 s50, s50, 1
    buffer_load_dwordx4 v5, s[12:15], s49 offen offset:0 sc1 lds
    buffer_load_dwordx4 v5, s[12:15], s49 offen offset:1024 sc1 lds
    buffer_load_dwordx4 v5, s[12:15], s49 offen offset:2048 sc1 lds
    buffer_load_dwordx4 v5, s[12:15], s49 offen offset:3072 sc1 lds
    s_add_u32 s49, s49, 4096
    s_bitcmp1_b32 s50, 0
    s_cselect_b32 s3, 0, 16384
    s_add_u32 s48, s48, s3
    s_add_u32 s49, s49, s3
    s_cmp_eq_u32 s50, 12
    s_cselect_b32 s3, 4294819840, 0
    s_add_u32 s48, s48, 4096
    s_add_u32 s48, s48, s3
l_qkv_fill2:
    s_add_u32 s52, s9, 1
    s_mov_b32 m0, s48
    s_add_u32 s50, s50, 1
    buffer_load_dwordx4 v5, s[12:15], s49 offen offset:0 sc1 lds
    s_waitcnt vmcnt(10)
    buffer_load_dwordx4 v5, s[12:15], s49 offen offset:1024 sc1 lds
    s_waitcnt vmcnt(10)
    buffer_load_dwordx4 v5, s[12:15], s49 offen offset:2048 sc1 lds
    s_waitcnt vmcnt(10)
    buffer_load_dwordx4 v5, s[12:15], s49 offen offset:3072 sc1 lds
    s_waitcnt vmcnt(10)
    s_add_u32 s49, s49, 4096
    s_bitcmp1_b32 s50, 0
    s_cselect_b32 s3, 0, 16384
    s_add_u32 s48, s48, s3
    s_add_u32 s49, s49, s3
    s_cmp_eq_u32 s50, 12
    s_cselect_b32 s3, 4294819840, 0
    s_add_u32 s48, s48, 4096
    s_add_u32 s48, s48, s3
l_qkv_pre:
    s_mov_b32 m0, s48
    s_add_u32 s50, s50, 1
    buffer_load_dwordx4 v5, s[12:15], s49 offen offset:0 sc1 lds
    s_waitcnt vmcnt(10)
    buffer_load_dwordx4 v5, s[12:15], s49 offen offset:1024 sc1 lds
    s_waitcnt vmcnt(10)
    buffer_load_dwordx4 v5, s[12:15], s49 offen offset:2048 sc1 lds
    s_waitcnt vmcnt(10)
    buffer_load_dwordx4 v5, s[12:15], s49 offen offset:3072 sc1 lds
    s_waitcnt vmcnt(10)
    s_add_u32 s49, s49, 4096
    s_bitcmp1_b32 s50, 0
    s_cselect_b32 s3, 0, 16384
    s_add_u32 s48, s48, s3
    s_add_u32 s49, s49, s3
    s_cmp_eq_u32 s50, 12
    s_cselect_b32 s3, 4294819840, 0
    s_add_u32 s48, s48, 4096
    s_add_u32 s48, s48, s3
    ds_read_b32 v8, v13
    s_cmp_ge_u32 s50, 12
    s_cbranch_scc1 l_qkv_go
    s_waitcnt lgkmcnt(0)
    v_readfirstlane_b32 s3, v8
    s_cmp_lg_u32 s3, s52
    s_cbranch_scc1 l_qkv_pre
    s_cmp_ge_u32 s50, 5
    s_cbranch_scc1 l_qkv_go
    s_waitcnt vmcnt(8)
l_qkv_go:
    s_waitcnt lgkmcnt(0)
    s_barrier
l_qkv_gone:
    s_bitcmp0_b32 s50, 0
    s_cbranch_scc1 l_qkv_even
    s_mov_b32 m0, s48
    s_add_u32 s50, s50, 1
    buffer_load_dwordx4 v5, s[12:15], s49 offen offset:0 sc1 lds
    buffer_load_dwordx4 v5, s[12:15], s49 offen offset:1024 sc1 lds
    buffer_load_dwordx4 v5, s[12:15], s49 offen offset:2048 sc1 lds
    buffer_load_dwordx4 v5, s[12:15], s49 offen offset:3072 sc1 lds
    s_add_u32 s49, s49, 4096
    s_bitcmp1_b32 s50, 0
    s_cselect_b32 s3, 0, 16384
    s_add_u32 s48, s48, s3
    s_add_u32 s49, s49, s3
    s_cmp_eq_u32 s50, 12
    s_cselect_b32 s3, 4294819840, 0
    s_add_u32 s48, s48, 4096
    s_add_u32 s48, s48, s3
l_qkv_even:
    s_cmp_gt_u32 s50, 11
    s_cbranch_scc1 stg_35
    s_mov_b32 m0, s48
    s_add_u32 s50, s50, 1
    buffer_load_dwordx4 v5, s[12:15], s49 offen offset:0 sc1 lds
    buffer_load_dwordx4 v5, s[12:15], s49 offen offset:1024 sc1 lds
    buffer_load_dwordx4 v5, s[12:15], s49 offen offset:2048 sc1 lds
    buffer_load_dwordx4 v5, s[12:15], s49 offen offset:3072 sc1 lds
    s_add_u32 s49, s49, 4096
    s_bitcmp1_b32 s50, 0
    s_cselect_b32 s3, 0, 16384
    s_add_u32 s48, s48, s3
    s_add_u32 s49, s49, s3
    s_cmp_eq_u32 s50, 12
    s_cselect_b32 s3, 4294819840, 0
    s_add_u32 s48, s48, 4096
    s_add_u32 s48, s48, s3
    s_cmp_ge_u32 s9, 2
    s_cbranch_scc1 stg_35
stg_35:
    s_cmp_lg_u32 s51, 0
    s_cbranch_scc1 role_36
    buffer_load_dwordx4 v[32:35], v10, s[12:15], s59 offen sc1
role_36:
    s_lshr_b32 s3, s9, 1
    s_andn2_b32 s3, s50, s3
    s_bitcmp0_b32 s3, 0
    s_cbranch_scc1 str_37
    s_waitcnt vmcnt(1)
    s_mov_b32 m0, s48
    s_add_u32 s50, s50, 1
    buffer_load_dwordx4 v5, s[12:15], s49 offen offset:0 sc1 lds
    buffer_load_dwordx4 v5, s[12:15], s49 offen offset:1024 sc1 lds
    buffer_load_dwordx4 v5, s[12:15], s49 offen offset:2048 sc1 lds
    buffer_load_dwordx4 v5, s[12:15], s49 offen offset:3072 sc1 lds
    s_add_u32 s49, s49, 4096
    s_bitcmp1_b32 s50, 0
    s_cselect_b32 s3, 0, 16384
    s_add_u32 s48, s48, s3
    s_add_u32 s49, s49, s3
    s_cmp_eq_u32 s50, 12
    s_cselect_b32 s3, 4294819840, 0
    s_add_u32 s48, s48, 4096
    s_add_u32 s48, s48, s3
str_37:
    s_waitcnt vmcnt(8)
    s_barrier
    s_waitcnt vmcnt(0)
l_qkv_b0:
    s_cmp_gt_u32 s50, 13
    s_cbranch_scc1 stg_38
    s_mov_b32 m0, s48
    s_add_u32 s50, s50, 1
    buffer_load_dwordx4 v5, s[12:15], s49 offen offset:0 sc1 lds
    buffer_load_dwordx4 v5, s[12:15], s49 offen offset:1024 sc1 lds
    buffer_load_dwordx4 v5, s[12:15], s49 offen offset:2048 sc1 lds
    buffer_load_dwordx4 v5, s[12:15], s49 offen offset:3072 sc1 lds
    s_add_u32 s49, s49, 4096
    s_bitcmp1_b32 s50, 0
    s_cselect_b32 s3, 0, 16384
    s_add_u32 s48, s48, s3
    s_add_u32 s49, s49, s3
    s_cmp_eq_u32 s50, 12
    s_cselect_b32 s3, 4294819840, 0
    s_add_u32 s48, s48, 4096
    s_add_u32 s48, s48, s3
    s_cmp_ge_u32 s9, 2
    s_cbranch_scc1 stg_38
stg_38:
    s_cmp_eq_u32 s60, 0
    s_cbranch_scc1 ub_39
    buffer_store_dwordx4 v[192:195], v14, s[12:15], s57 offen offset:0 sc1
    v_mfma_f32_16x16x32_bf16 v[28:31], v[24:27], v[192:195], 0
    buffer_store_dwordx4 v[196:199], v14, s[12:15], s57 offen offset:1024 sc1
    v_mfma_f32_16x16x32_bf16 v[28:31], v[24:27], v[196:199], v[28:31]
ub_39:
    s_cmp_lg_u32 s51, 0
    s_cbranch_scc1 role_40
    v_add_f32_dpp v32, v32, v32 row_ror:4 row_mask:0xf bank_mask:0xf
    v_add_f32_dpp v33, v33, v33 row_ror:4 row_mask:0xf bank_mask:0xf
    v_add_f32_dpp v34, v34, v34 row_ror:4 row_mask:0xf bank_mask:0xf
    v_add_f32_dpp v35, v35, v35 row_ror:4 row_mask:0xf bank_mask:0xf
    v_add_f32_dpp v32, v32, v32 row_ror:8 row_mask:0xf bank_mask:0xf
    v_add_f32_dpp v33, v33, v33 row_ror:8 row_mask:0xf bank_mask:0xf
    v_add_f32_dpp v34, v34, v34 row_ror:8 row_mask:0xf bank_mask:0xf
    v_add_f32_dpp v35, v35, v35 row_ror:8 row_mask:0xf bank_mask:0xf
    v_mov_b32 v36, v32
    v_mov_b32 v37, v33
    v_mov_b32 v38, v34
    v_mov_b32 v39, v35
    v_permlane16_swap_b32 v32, v36
    v_permlane16_swap_b32 v33, v37
    v_permlane16_swap_b32 v34, v38
    v_permlane16_swap_b32 v35, v39
    v_add_f32 v32, v32, v36
    v_add_f32 v33, v33, v37
    v_add_f32 v34, v34, v38
    v_add_f32 v35, v35, v39
    v_mov_b32 v36, v32
    v_mov_b32 v37, v33
    v_mov_b32 v38, v34
    v_mov_b32 v39, v35
    v_permlane32_swap_b32 v32, v36
    v_permlane32_swap_b32 v33, v37
    v_permlane32_swap_b32 v34, v38
    v_permlane32_swap_b32 v35, v39
    v_add_f32 v40, v32, v36
    v_add_f32 v42, v33, v37
    v_add_f32 v44, v34, v38
    v_add_f32 v46, v35, v39
role_40:
    s_lshr_b32 s3, s9, 1
    s_andn2_b32 s3, s50, s3
    s_bitcmp0_b32 s3, 0
    s_cbranch_scc1 str_41
    s_waitcnt vmcnt(1)
    s_mov_b32 m0, s48
    s_add_u32 s50, s50, 1
    buffer_load_dwordx4 v5, s[12:15], s49 offen offset:0 sc1 lds
    buffer_load_dwordx4 v5, s[12:15], s49 offen offset:1024 sc1 lds
    buffer_load_dwordx4 v5, s[12:15], s49 offen offset:2048 sc1 lds
    buffer_load_dwordx4 v5, s[12:15], s49 offen offset:3072 sc1 lds
    s_add_u32 s49, s49, 4096
    s_bitcmp1_b32 s50, 0
    s_cselect_b32 s3, 0, 16384
    s_add_u32 s48, s48, s3
    s_add_u32 s49, s49, s3
    s_cmp_eq_u32 s50, 12
    s_cselect_b32 s3, 4294819840, 0
    s_add_u32 s48, s48, 4096
    s_add_u32 s48, s48, s3
str_41:
    s_waitcnt vmcnt(8)
    s_barrier
    s_cmp_gt_u32 s50, 15
    s_cbranch_scc1 stg_42
    s_mov_b32 m0, s48
    s_add_u32 s50, s50, 1
    buffer_load_dwordx4 v5, s[12:15], s49 offen offset:0 sc1 lds
    buffer_load_dwordx4 v5, s[12:15], s49 offen offset:1024 sc1 lds
    buffer_load_dwordx4 v5, s[12:15], s49 offen offset:2048 sc1 lds
    buffer_load_dwordx4 v5, s[12:15], s49 offen offset:3072 sc1 lds
    s_add_u32 s49, s49, 4096
    s_bitcmp1_b32 s50, 0
    s_cselect_b32 s3, 0, 16384
    s_add_u32 s48, s48, s3
    s_add_u32 s49, s49, s3
    s_cmp_eq_u32 s50, 12
    s_cselect_b32 s3, 4294819840, 0
    s_add_u32 s48, s48, 4096
    s_add_u32 s48, s48, s3
    s_cmp_ge_u32 s9, 2
    s_cbranch_scc1 stg_42
stg_42:
    s_cmp_eq_u32 s60, 0
    s_cbranch_scc1 ub_43
    buffer_store_dwordx4 v[200:203], v14, s[12:15], s57 offen offset:512 sc1
    v_mfma_f32_16x16x32_bf16 v[28:31], v[24:27], v[200:203], v[28:31]
    buffer_store_dwordx4 v[204:207], v14, s[12:15], s57 offen offset:1536 sc1
    v_mfma_f32_16x16x32_bf16 v[28:31], v[24:27], v[204:207], v[28:31]
ub_43:
    s_cmp_lg_u32 s51, 0
    s_cbranch_scc1 role_44
    v_mul_f32 v40, 0x3a800000, v40
    v_mul_f32 v44, 0x3a800000, v44
    v_mul_f32 v42, 0x3a800000, v42
    v_mul_f32 v46, 0x3a800000, v46
    v_fma_f32 v42, -v40, v40, v42
    v_fma_f32 v46, -v44, v44, v46
    v_max_f32 v42, 0, v42
    v_max_f32 v46, 0, v46
    v_add_f32 v42, 0x3727c5ac, v42
    v_add_f32 v46, 0x3727c5ac, v46
    v_rsq_f32 v42, v42
    v_rsq_f32 v46, v46
    s_lshl_b32 s3, s11, 7
    s_add_u32 s3, s3, s56
    s_mov_b64 exec, 0xf
    buffer_store_dwordx4 v[40:43], v7, s[12:15], s3 offen offset:0 sc1
    buffer_store_dwordx4 v[44:47], v7, s[12:15], s3 offen offset:16 sc1
    s_mov_b64 exec, -1
role_44:
    s_lshr_b32 s3, s9, 1
    s_andn2_b32 s3, s50, s3
    s_bitcmp0_b32 s3, 0
    s_cbranch_scc1 str_45
    s_waitcnt vmcnt(1)
    s_mov_b32 m0, s48
    s_add_u32 s50, s50, 1
    buffer_load_dwordx4 v5, s[12:15], s49 offen offset:0 sc1 lds
    buffer_load_dwordx4 v5, s[12:15], s49 offen offset:1024 sc1 lds
    buffer_load_dwordx4 v5, s[12:15], s49 offen offset:2048 sc1 lds
    buffer_load_dwordx4 v5, s[12:15], s49 offen offset:3072 sc1 lds
    s_add_u32 s49, s49, 4096
    s_bitcmp1_b32 s50, 0
    s_cselect_b32 s3, 0, 16384
    s_add_u32 s48, s48, s3
    s_add_u32 s49, s49, s3
    s_cmp_eq_u32 s50, 12
    s_cselect_b32 s3, 4294819840, 0
    s_add_u32 s48, s48, 4096
    s_add_u32 s48, s48, s3
str_45:
    s_waitcnt vmcnt(8)
    s_barrier
    s_cmp_gt_u32 s50, 15
    s_cbranch_scc1 stg_46
    s_mov_b32 m0, s48
    s_add_u32 s50, s50, 1
    buffer_load_dwordx4 v5, s[12:15], s49 offen offset:0 sc1 lds
    buffer_load_dwordx4 v5, s[12:15], s49 offen offset:1024 sc1 lds
    buffer_load_dwordx4 v5, s[12:15], s49 offen offset:2048 sc1 lds
    buffer_load_dwordx4 v5, s[12:15], s49 offen offset:3072 sc1 lds
    s_add_u32 s49, s49, 4096
    s_bitcmp1_b32 s50, 0
    s_cselect_b32 s3, 0, 16384
    s_add_u32 s48, s48, s3
    s_add_u32 s49, s49, s3
    s_cmp_eq_u32 s50, 12
    s_cselect_b32 s3, 4294819840, 0
    s_add_u32 s48, s48, 4096
    s_add_u32 s48, s48, s3
    s_cmp_ge_u32 s9, 2
    s_cbranch_scc1 stg_46
stg_46:
    s_cmp_eq_u32 s60, 0
    s_cbranch_scc1 ub_47
    buffer_store_dwordx4 v[208:211], v14, s[12:15], s57 offen offset:2048 sc1
    v_mfma_f32_16x16x32_bf16 v[28:31], v[24:27], v[208:211], v[28:31]
    buffer_store_dwordx4 v[212:215], v14, s[12:15], s57 offen offset:3072 sc1
    v_mfma_f32_16x16x32_bf16 v[28:31], v[24:27], v[212:215], v[28:31]
ub_47:
    s_lshr_b32 s3, s9, 1
    s_andn2_b32 s3, s50, s3
    s_bitcmp0_b32 s3, 0
    s_cbranch_scc1 str_48
    s_waitcnt vmcnt(1)
    s_mov_b32 m0, s48
    s_add_u32 s50, s50, 1
    buffer_load_dwordx4 v5, s[12:15], s49 offen offset:0 sc1 lds
    buffer_load_dwordx4 v5, s[12:15], s49 offen offset:1024 sc1 lds
    buffer_load_dwordx4 v5, s[12:15], s49 offen offset:2048 sc1 lds
    buffer_load_dwordx4 v5, s[12:15], s49 offen offset:3072 sc1 lds
    s_add_u32 s49, s49, 4096
    s_bitcmp1_b32 s50, 0
    s_cselect_b32 s3, 0, 16384
    s_add_u32 s48, s48, s3
    s_add_u32 s49, s49, s3
    s_cmp_eq_u32 s50, 12
    s_cselect_b32 s3, 4294819840, 0
    s_add_u32 s48, s48, 4096
    s_add_u32 s48, s48, s3
str_48:
    s_waitcnt vmcnt(8)
    s_barrier
    s_cmp_gt_u32 s50, 15
    s_cbranch_scc1 stg_49
    s_mov_b32 m0, s48
    s_add_u32 s50, s50, 1
    buffer_load_dwordx4 v5, s[12:15], s49 offen offset:0 sc1 lds
    buffer_load_dwordx4 v5, s[12:15], s49 offen offset:1024 sc1 lds
    buffer_load_dwordx4 v5, s[12:15], s49 offen offset:2048 sc1 lds
    buffer_load_dwordx4 v5, s[12:15], s49 offen offset:3072 sc1 lds
    s_add_u32 s49, s49, 4096
    s_bitcmp1_b32 s50, 0
    s_cselect_b32 s3, 0, 16384
    s_add_u32 s48, s48, s3
    s_add_u32 s49, s49, s3
    s_cmp_eq_u32 s50, 12
    s_cselect_b32 s3, 4294819840, 0
    s_add_u32 s48, s48, 4096
    s_add_u32 s48, s48, s3
    s_cmp_ge_u32 s9, 2
    s_cbranch_scc1 stg_49
stg_49:
    s_cmp_eq_u32 s60, 0
    s_cbranch_scc1 ub_50
    buffer_store_dwordx4 v[216:219], v14, s[12:15], s57 offen offset:2560 sc1
    v_mfma_f32_16x16x32_bf16 v[28:31], v[24:27], v[216:219], v[28:31]
    buffer_store_dwordx4 v[220:223], v14, s[12:15], s57 offen offset:3584 sc1
    v_mfma_f32_16x16x32_bf16 v[28:31], v[24:27], v[220:223], v[28:31]
ub_50:
    s_cmp_ge_u32 s9, 2
    s_cbranch_scc1 wc_51
    s_bitcmp1_b32 s9, 0
    s_cbranch_scc1 wc_51_b
    ds_read_b128 v[64:67], v3 offset:0
    ds_read_b128 v[68:71], v3 offset:1024
    ds_read_b128 v[72:75], v3 offset:2048
    ds_read_b128 v[76:79], v3 offset:3072
    ds_read_b128 v[80:83], v3 offset:4096
    ds_read_b128 v[84:87], v3 offset:5120
    ds_read_b128 v[88:91], v3 offset:6144
    ds_read_b128 v[92:95], v3 offset:7168
    s_branch wc_51_w
wc_51_b:
    ds_read_b128 v[160:163], v3 offset:0
    ds_read_b128 v[164:167], v3 offset:1024
    ds_read_b128 v[168:171], v3 offset:2048
    ds_read_b128 v[172:175], v3 offset:3072
    ds_read_b128 v[176:179], v3 offset:4096
    ds_read_b128 v[180:183], v3 offset:5120
    ds_read_b128 v[184:187], v3 offset:6144
    ds_read_b128 v[188:191], v3 offset:7168
wc_51_w:
    s_waitcnt lgkmcnt(0)
wc_51:
    s_cmp_lg_u32 s51, 1
    s_cbranch_scc1 role_52
    s_and_b32 s52, s11, 0xe0
    s_lshl_b32 s52, s52, 7
    s_add_u32 s52, s52, s56
    s_lshr_b32 s3, s6, 1
    s_min_u32 s3, s3, 1
    s_andn2_b32 s3, s3, s9
    s_lshl_b32 s3, s3, 8
    s_sub_u32 s53, s52, s3
    buffer_load_dwordx4 v[32:35], v5, s[12:15], s52 offen offset:0 sc1
    buffer_load_dwordx4 v[36:39], v5, s[12:15], s52 offen offset:1024 sc1
    buffer_load_dwordx4 v[40:43], v5, s[12:15], s52 offen offset:2048 sc1
    buffer_load_dwordx4 v[44:47], v5, s[12:15], s52 offen offset:3072 sc1
    buffer_load_dwordx4 v[48:51], v6, s[12:15], s53 offen sc1
role_52:
    s_lshr_b32 s3, s9, 1
    s_andn2_b32 s3, s50, s3
    s_bitcmp0_b32 s3, 0
    s_cbranch_scc1 str_53
    s_waitcnt vmcnt(1)
    s_mov_b32 m0, s48
    s_add_u32 s50, s50, 1
    buffer_load_dwordx4 v5, s[12:15], s49 offen offset:0 sc1 lds
    buffer_load_dwordx4 v5, s[12:15], s49 offen offset:1024 sc1 lds
    buffer_load_dwordx4 v5, s[12:15], s49 offen offset:2048 sc1 lds
    buffer_load_dwordx4 v5, s[12:15], s49 offen offset:3072 sc1 lds
    s_add_u32 s49, s49, 4096
    s_bitcmp1_b32 s50, 0
    s_cselect_b32 s3, 0, 16384
    s_add_u32 s48, s48, s3
    s_add_u32 s49, s49, s3
    s_cmp_eq_u32 s50, 12
    s_cselect_b32 s3, 4294819840, 0
    s_add_u32 s48, s48, 4096
    s_add_u32 s48, s48, s3
str_53:
    s_waitcnt vmcnt(8)
    s_barrier
    s_waitcnt vmcnt(0)
    s_cmp_gt_u32 s50, 15
    s_cbranch_scc1 stg_54
    s_mov_b32 m0, s48
    s_add_u32 s50, s50, 1
    buffer_load_dwordx4 v5, s[12:15], s49 offen offset:0 sc1 lds
    buffer_load_dwordx4 v5, s[12:15], s49 offen offset:1024 sc1 lds
    buffer_load_dwordx4 v5, s[12:15], s49 offen offset:2048 sc1 lds
    buffer_load_dwordx4 v5, s[12:15], s49 offen offset:3072 sc1 lds
    s_add_u32 s49, s49, 4096
    s_bitcmp1_b32 s50, 0
    s_cselect_b32 s3, 0, 16384
    s_add_u32 s48, s48, s3
    s_add_u32 s49, s49, s3
    s_cmp_eq_u32 s50, 12
    s_cselect_b32 s3, 4294819840, 0
    s_add_u32 s48, s48, 4096
    s_add_u32 s48, s48, s3
    s_cmp_ge_u32 s9, 2
    s_cbranch_scc1 stg_54
stg_54:
    s_cmp_eq_u32 s60, 0
    s_cbranch_scc1 ub_55
    v_add_f32_dpp v28, v28, v28 row_ror:8 row_mask:0xf bank_mask:0xf
    v_add_f32_dpp v29, v29, v29 row_ror:8 row_mask:0xf bank_mask:0xf
    v_add_f32_dpp v30, v30, v30 row_ror:8 row_mask:0xf bank_mask:0xf
    v_add_f32_dpp v31, v31, v31 row_ror:8 row_mask:0xf bank_mask:0xf
    s_mov_b64 exec, 0x00ff00ff
    buffer_store_dwordx4 v[28:31], v15, s[12:15], s54 offen sc1
    s_mov_b64 exec, -1
ub_55:
    s_cmp_ge_u32 s9, 2
    s_cbranch_scc1 wc_56
    s_bitcmp1_b32 s9, 0
    s_cbranch_scc1 wc_56_b
    ds_read_b128 v[96:99], v3 offset:24576
    ds_read_b128 v[100:103], v3 offset:25600
    ds_read_b128 v[104:107], v3 offset:26624
    ds_read_b128 v[108:111], v3 offset:27648
    ds_read_b128 v[112:115], v3 offset:28672
    ds_read_b128 v[116:119], v3 offset:29696
    ds_read_b128 v[120:123], v3 offset:30720
    ds_read_b128 v[124:127], v3 offset:31744
    s_branch wc_56_w
wc_56_b:
    ds_read_b128 v[192:195], v3 offset:24576
    ds_read_b128 v[196:199], v3 offset:25600
    ds_read_b128 v[200:203], v3 offset:26624
    ds_read_b128 v[204:207], v3 offset:27648
    ds_read_b128 v[208:211], v3 offset:28672
    ds_read_b128 v[212:215], v3 offset:29696
    ds_read_b128 v[216:219], v3 offset:30720
    ds_read_b128 v[220:223], v3 offset:31744
wc_56_w:
    s_waitcnt lgkmcnt(0)
wc_56:
    s_cmp_lg_u32 s51, 1
    s_cbranch_scc1 role_57
    s_mov_b32 s3, 0x100000
l_st_chk:
    v_cmp_ne_u32 s[64:65], s10, v33
    v_cmp_ne_u32 vcc, s10, v35
    s_or_b64 s[64:65], s[64:65], vcc
    v_cmp_ne_u32 vcc, s10, v37
    s_or_b64 s[64:65], s[64:65], vcc
    v_cmp_ne_u32 vcc, s10, v39
    s_or_b64 s[64:65], s[64:65], vcc
    v_cmp_ne_u32 vcc, s10, v41
    s_or_b64 s[64:65], s[64:65], vcc
    v_cmp_ne_u32 vcc, s10, v43
    s_or_b64 s[64:65], s[64:65], vcc
    v_cmp_ne_u32 vcc, s10, v45
    s_or_b64 s[64:65], s[64:65], vcc
    v_cmp_ne_u32 vcc, s10, v47
    s_or_b64 s[64:65], s[64:65], vcc
    v_cmp_ne_u32 vcc, s10, v49
    s_or_b64 s[64:65], s[64:65], vcc
    v_cmp_ne_u32 vcc, s10, v51
    s_or_b64 s[64:65], s[64:65], vcc
    s_cbranch_scc0 l_st_ok
    s_sub_u32 s3, s3, 1
    s_cbranch_scc0 l_st_again
l_st_ok:
    ds_write_b32 v11, v32 offset:1280
    ds_write_b32 v11, v34 offset:2816
    ds_write_b32 v11, v36 offset:1536
    ds_write_b32 v11, v38 offset:3072
    ds_write_b32 v11, v40 offset:1792
    ds_write_b32 v11, v42 offset:3328
    ds_write_b32 v11, v44 offset:2048
    ds_write_b32 v11, v46 offset:3584
    s_mov_b64 exec, 0xffff
    ds_write_b32 v11, v48 offset:1216
    ds_write_b32 v11, v50 offset:2752
    s_mov_b64 exec, -1
    s_waitcnt lgkmcnt(0)
role_57:
    s_lshr_b32 s3, s9, 1
    s_andn2_b32 s3, s50, s3
    s_bitcmp0_b32 s3, 0
    s_cbranch_scc1 str_58
    s_waitcnt vmcnt(1)
    s_mov_b32 m0, s48
    s_add_u32 s50, s50, 1
    buffer_load_dwordx4 v5, s[12:15], s49 offen offset:0 sc1 lds
    buffer_load_dwordx4 v5, s[12:15], s49 offen offset:1024 sc1 lds
    buffer_load_dwordx4 v5, s[12:15], s49 offen offset:2048 sc1 lds
    buffer_load_dwordx4 v5, s[12:15], s49 offen offset:3072 sc1 lds
    s_add_u32 s49, s49, 4096
    s_bitcmp1_b32 s50, 0
    s_cselect_b32 s3, 0, 16384
    s_add_u32 s48, s48, s3
    s_add_u32 s49, s49, s3
    s_cmp_eq_u32 s50, 12
    s_cselect_b32 s3, 4294819840, 0
    s_add_u32 s48, s48, 4096
    s_add_u32 s48, s48, s3
str_58:
    s_add_u32 s61, s51, 48
    s_bitcmp1_b32 s9, 0
    s_cbranch_scc1 wo_59
    s_mov_b32 s24, s36
    s_mov_b32 s25, s37
    s_mov_b32 s26, 2097152
    s_mov_b32 s27, 0x00020000
    s_and_b32 s3, s7, 7
    s_cmp_eq_u32 s3, 3
    s_cbranch_scc0 wo_59
    s_cmp_eq_u32 s9, 0
    s_cbranch_scc1 wo_59
wop_60:
    s_lshl_b32 m0, s61, 10
    s_lshr_b32 s3, s61, 1
    s_xor_b32 s3, s3, s61
    s_and_b32 s3, s3, 1
    s_mul_i32 s3, s3, 3
    s_xor_b32 s3, s3, s61
    s_lshl_b32 s3, s3, 14
    buffer_load_dwordx4 v17, s[24:27], s3 offen lds
    s_add_u32 s61, s61, 3
    s_waitcnt vmcnt(4)
    s_cmp_lt_u32 s61, 66
    s_cbranch_scc1 wop_60
wo_59:
    s_waitcnt vmcnt(8)
    s_barrier
    s_cmp_eq_u32 s60, 0
    s_cbranch_scc1 ub_61
    s_waitcnt vmcnt(0)
    s_mov_b64 exec, 0xffff
    buffer_store_dword v9, v16, s[12:15], s55 offen offset:384 sc1
    s_mov_b64 exec, -1
ub_61:
    s_cmp_ge_u32 s9, 2
    s_cbranch_scc1 wc_62
    s_bitcmp1_b32 s9, 0
    s_cbranch_scc1 wc_62_b
    ds_read_b128 v[128:131], v3 offset:49152
    ds_read_b128 v[132:135], v3 offset:50176
    ds_read_b128 v[136:139], v3 offset:51200
    ds_read_b128 v[140:143], v3 offset:52224
    ds_read_b128 v[144:147], v3 offset:53248
    ds_read_b128 v[148:151], v3 offset:54272
    ds_read_b128 v[152:155], v3 offset:55296
    ds_read_b128 v[156:159], v3 offset:56320
    s_branch wc_62_w
wc_62_b:
    ds_read_b128 a[0:3], v3 offset:49152
    ds_read_b128 a[4:7], v3 offset:50176
    ds_read_b128 a[8:11], v3 offset:51200
    ds_read_b128 a[12:15], v3 offset:52224
    ds_read_b128 a[16:19], v3 offset:53248
    ds_read_b128 a[20:23], v3 offset:54272
    ds_read_b128 a[24:27], v3 offset:55296
    ds_read_b128 a[28:31], v3 offset:56320
wc_62_w:
    s_waitcnt lgkmcnt(0)
wc_62:
    s_bitcmp1_b32 s9, 0
    s_cbranch_scc1 wo_63
    s_mov_b32 s24, s36
    s_mov_b32 s25, s37
    s_mov_b32 s26, 2097152
    s_mov_b32 s27, 0x00020000
    s_and_b32 s3, s7, 7
    s_cmp_eq_u32 s3, 3
    s_cbranch_scc0 wo_63
    s_cmp_eq_u32 s9, 0
    s_cbranch_scc1 wo_63
wop_64:
    s_lshl_b32 m0, s61, 10
    s_lshr_b32 s3, s61, 1
    s_xor_b32 s3, s3, s61
    s_and_b32 s3, s3, 1
    s_mul_i32 s3, s3, 3
    s_xor_b32 s3, s3, s61
    s_lshl_b32 s3, s3, 14
    buffer_load_dwordx4 v17, s[24:27], s3 offen lds
    s_add_u32 s61, s61, 3
    s_waitcnt vmcnt(4)
    s_cmp_lt_u32 s61, 84
    s_cbranch_scc1 wop_64
wo_63:
    s_waitcnt vmcnt(0)
    s_barrier
    s_bitcmp1_b32 s9, 0
    s_cbranch_scc1 wo_65
    s_mov_b32 s24, s36
    s_mov_b32 s25, s37
    s_mov_b32 s26, 2097152
    s_mov_b32 s27, 0x00020000
    s_and_b32 s3, s7, 7
    s_cmp_eq_u32 s3, 3
    s_cselect_b32 s62, 27, 48
    s_cselect_b32 s63, 12, 24
    s_add_u32 s62, s62, s61
    s_sub_u32 s62, s62, s51
    s_add_u32 s63, s63, s62
wop_66:
    s_lshl_b32 m0, s61, 10
    s_lshr_b32 s3, s61, 1
    s_xor_b32 s3, s3, s61
    s_and_b32 s3, s3, 1
    s_mul_i32 s3, s3, 3
    s_xor_b32 s3, s3, s61
    s_lshl_b32 s3, s3, 14
    buffer_load_dwordx4 v17, s[24:27], s3 offen lds
    s_add_u32 s61, s61, 3
    s_waitcnt vmcnt(7)
    s_cmp_lt_u32 s61, s62
    s_cbranch_scc1 wop_66
wo_65:
    s_barrier
    s_bitcmp1_b32 s9, 0
    s_cbranch_scc1 s_attn
    s_mov_b32 s24, s36
    s_mov_b32 s25, s37
    s_mov_b32 s26, 2097152
    s_mov_b32 s27, 0x00020000
wop_67:
    s_lshl_b32 m0, s61, 10
    s_lshr_b32 s3, s61, 1
    s_xor_b32 s3, s3, s61
    s_and_b32 s3, s3, 1
    s_mul_i32 s3, s3, 3
    s_xor_b32 s3, s3, s61
    s_lshl_b32 s3, s3, 14
    buffer_load_dwordx4 v17, s[24:27], s3 offen lds
    s_add_u32 s61, s61, 3
    s_waitcnt vmcnt(7)
    s_cmp_lt_u32 s61, s63
    s_cbranch_scc1 wop_67
    s_barrier
wop_68:
    s_lshl_b32 m0, s61, 10
    s_lshr_b32 s3, s61, 1
    s_xor_b32 s3, s3, s61
    s_and_b32 s3, s3, 1
    s_mul_i32 s3, s3, 3
    s_xor_b32 s3, s3, s61
    s_lshl_b32 s3, s3, 14
    buffer_load_dwordx4 v17, s[24:27], s3 offen lds
    s_add_u32 s61, s61, 3
    s_waitcnt vmcnt(7)
    s_cmp_lt_u32 s61, 128
    s_cbranch_scc1 wop_68
    s_mov_b32 s61, s51
wop_69:
    s_lshl_b32 m0, s61, 10
    s_lshr_b32 s3, s61, 1
    s_xor_b32 s3, s3, s61
    s_and_b32 s3, s3, 1
    s_mul_i32 s3, s3, 3
    s_xor_b32 s3, s3, s61
    s_lshl_b32 s3, s3, 14
    buffer_load_dwordx4 v17, s[24:27], s3 offen lds
    s_add_u32 s61, s61, 3
    s_waitcnt vmcnt(7)
    s_cmp_lt_u32 s61, 48
    s_cbranch_scc1 wop_69
    s_branch l_wo
l_st_again:
    buffer_load_dwordx4 v[32:35], v5, s[12:15], s52 offen offset:0 sc1
    buffer_load_dwordx4 v[36:39], v5, s[12:15], s52 offen offset:1024 sc1
    buffer_load_dwordx4 v[40:43], v5, s[12:15], s52 offen offset:2048 sc1
    buffer_load_dwordx4 v[44:47], v5, s[12:15], s52 offen offset:3072 sc1
    buffer_load_dwordx4 v[48:51], v6, s[12:15], s53 offen sc1
    s_waitcnt vmcnt(0)
    s_branch l_st_chk
.p2align 6
h_wo:
l_wo:
    s_mul_i32 s98, s9, 786432
    s_add_u32 s98, s98, 65798144
    s_lshl_b32 s99, s11, 10
    s_add_u32 s98, s98, s99
    s_add_u32 s96, s4, s98
    s_addc_u32 s97, s5, 0
    s_mov_b32 s98, s10
    s_mov_b32 s99, s10
    s_sub_u32 s59, s8, 4
    s_lshl_b32 s60, s59, 7
    s_add_u32 s96, s96, s60
    s_addc_u32 s97, s97, 0
    s_lshl_b32 s60, s9, 2
    s_add_u32 s60, s60, 159504
    v_mov_b32 v10, s60
    s_lshl_b32 s60, 1, s59
    v_mov_b32 v11, s60
    v_lshlrev_b32 v13, 4, v11
    s_mov_b64 exec, 1
    s_waitcnt vmcnt(0)
    ds_or_b32 v10, v13
    s_mov_b32 s3, 0x100000
poll_70:
    s_load_dwordx8 s[88:95], s[96:97], 0 glc
    s_sub_u32 s3, s3, 1
    s_cbranch_scc1 poll_70_ok
    s_waitcnt lgkmcnt(0)
    s_xor_b64 s[100:101], s[88:89], s[98:99]
    s_xor_b64 s[88:89], s[90:91], s[98:99]
    s_or_b64 s[100:101], s[100:101], s[88:89]
    s_xor_b64 s[88:89], s[92:93], s[98:99]
    s_or_b64 s[100:101], s[100:101], s[88:89]
    s_xor_b64 s[88:89], s[94:95], s[98:99]
    s_or_b64 s[100:101], s[100:101], s[88:89]
    s_cbranch_scc1 poll_70
poll_70_ok:
    s_waitcnt lgkmcnt(0)
    ds_or_b32 v10, v11
    s_mov_b64 exec, -1
    s_setprio 0
    s_waitcnt lgkmcnt(0)
    s_cmp_eq_u32 s8, 4
    s_cbranch_scc1 l_wo_end
    s_cmp_lg_u32 s9, 0
    s_cbranch_scc1 l_wo_end
    s_lshl_b32 s53, s8, 7
    s_lshl_b32 s52, s11, 10
    s_add_u32 s53, s53, s52
    s_add_u32 s53, s53, 64487168
    s_add_u32 s96, s4, s53
    s_addc_u32 s97, s5, 0
    s_mov_b32 s98, s10
    s_mov_b32 s99, s10
    s_mov_b32 s3, 0x100000
poll_71:
    s_load_dwordx16 s[80:95], s[96:97], 0 glc
    s_sub_u32 s3, s3, 1
    s_cbranch_scc1 poll_71_ok
    s_waitcnt lgkmcnt(0)
    s_xor_b64 s[100:101], s[80:81], s[98:99]
    s_xor_b64 s[80:81], s[82:83], s[98:99]
    s_or_b64 s[100:101], s[100:101], s[80:81]
    s_xor_b64 s[80:81], s[84:85], s[98:99]
    s_or_b64 s[100:101], s[100:101], s[80:81]
    s_xor_b64 s[80:81], s[86:87], s[98:99]
    s_or_b64 s[100:101], s[100:101], s[80:81]
    s_xor_b64 s[80:81], s[88:89], s[98:99]
    s_or_b64 s[100:101], s[100:101], s[80:81]
    s_xor_b64 s[80:81], s[90:91], s[98:99]
    s_or_b64 s[100:101], s[100:101], s[80:81]
    s_xor_b64 s[80:81], s[92:93], s[98:99]
    s_or_b64 s[100:101], s[100:101], s[80:81]
    s_xor_b64 s[80:81], s[94:95], s[98:99]
    s_or_b64 s[100:101], s[100:101], s[80:81]
    s_cbranch_scc1 poll_71
poll_71_ok:
    s_waitcnt lgkmcnt(0)
l_wo_end:
    s_add_u32 s9, s9, 1
    s_cmp_lg_u32 s9, 4
    s_cbranch_scc1 l_wo_next
    s_branch k_exit
l_wo_next:
    s_cmp_lg_u32 s8, 4
    s_cbranch_scc1 l_qkv
    s_cmp_eq_u32 s9, 2
    s_cbranch_scc1 h_qkvA
    s_branch h_qkvB
.p2align 6
s_attn:
    s_sub_u32 s48, s8, 4
    s_lshl_b32 s3, s7, 7
    v_lshrrev_b32 v20, 3, v1
    v_lshlrev_b32 v21, 11, v20
    v_and_b32 v22, 2, v20
    v_lshrrev_b32 v23, 2, v20
    v_or_b32 v22, v22, v23
    v_bfe_u32 v23, v1, 1, 2
    v_xor_b32 v22, v22, v23
    v_lshl_add_u32 v21, v22, 5, v21
    v_and_b32 v22, 1, v1
    v_lshl_add_u32 v21, v22, 4, v21
    v_add_u32 v7, s3, v21
    s_mov_b32 s24, s42
    s_mov_b32 s25, s43
    s_mov_b32 s26, 2097152
    s_mov_b32 s27, 0x00020000
    s_lshr_b32 s49, s9, 1
    s_lshl_b32 s49, s49, 23
    s_lshl_b32 s52, s7, 19
    s_add_u32 s49, s49, s52
    s_and_b32 s52, s6, 1
    s_lshl_b32 s52, s52, 18
    s_add_u32 s49, s49, s52
    s_add_u32 s49, s49, 33554432
    s_lshr_b32 s61, s6, 1
    s_mul_i32 s54, s9, 786432
    s_add_u32 s54, s54, 66322432
    s_lshl_b32 s55, s11, 10
    s_add_u32 s54, s54, s55
    s_add_u32 s52, s4, s54
    s_addc_u32 s53, s5, 0
    s_mov_b32 s54, s10
    s_mov_b32 s55, s10
    s_lshl_b32 s51, s48, 11
    s_add_u32 s49, s49, s51
    s_add_u32 s51, s51, 81920
    s_mov_b32 s60, s48
    s_setprio 3
    s_barrier
    s_lshl_b32 s58, 1, s61
    s_mov_b32 s57, 0
    s_add_u32 s62, s61, 1
    s_and_b32 s62, s62, 7
    s_lshl_b32 s50, s62, 15
    s_add_u32 s50, s50, s49
    s_lshr_b32 s63, s62, 1
    s_lshl_b32 s63, s63, 7
    s_and_b32 s62, s62, 1
    s_lshl_b32 s62, s62, 4
    s_add_u32 s62, s62, s63
    s_mov_b32 s58, 0x100000
need_72:
    s_load_dwordx4 s[64:67], s[52:53], s62 glc
    s_sub_u32 s58, s58, 1
    s_cbranch_scc1 need_72_ok
    s_waitcnt lgkmcnt(0)
need_72_t:
    s_cmp_ge_u32 s48, 2
    s_cselect_b32 s63, s65, s64
    s_cmp_lg_u32 s63, s10
    s_cbranch_scc1 need_72
need_72_ok:
    s_waitcnt lgkmcnt(0)
    s_add_u32 m0, s51, 32768
    s_nop 0
    buffer_load_dwordx4 v5, s[12:15], s50 offen offset:0 sc1 lds
    buffer_load_dwordx4 v5, s[12:15], s50 offen offset:1024 sc1 lds
    s_add_u32 s50, s50, 8192
    s_add_u32 m0, s51, 40960
    s_nop 0
    buffer_load_dwordx4 v5, s[12:15], s50 offen offset:0 sc1 lds
    buffer_load_dwordx4 v5, s[12:15], s50 offen offset:1024 sc1 lds
    s_add_u32 s50, s50, 8192
    s_branch need_73_t
need_73:
    s_load_dwordx4 s[64:67], s[52:53], s62 glc
    s_sub_u32 s58, s58, 1
    s_cbranch_scc1 need_73_ok
    s_waitcnt lgkmcnt(0)
need_73_t:
    s_cmp_ge_u32 s48, 2
    s_cselect_b32 s63, s67, s66
    s_cmp_lg_u32 s63, s10
    s_cbranch_scc1 need_73
need_73_ok:
    s_waitcnt lgkmcnt(0)
    s_add_u32 m0, s51, 49152
    s_nop 0
    buffer_load_dwordx4 v5, s[12:15], s50 offen offset:0 sc1 lds
    buffer_load_dwordx4 v5, s[12:15], s50 offen offset:1024 sc1 lds
    s_add_u32 s50, s50, 8192
    s_add_u32 m0, s51, 57344
    s_nop 0
    buffer_load_dwordx4 v5, s[12:15], s50 offen offset:0 sc1 lds
    buffer_load_dwordx4 v5, s[12:15], s50 offen offset:1024 sc1 lds
    s_add_u32 s50, s50, 8192
    s_waitcnt vmcnt(4)
    s_barrier
    s_add_u32 s62, s61, 2
    s_and_b32 s62, s62, 7
    s_lshl_b32 s50, s62, 15
    s_add_u32 s50, s50, s49
    s_lshr_b32 s63, s62, 1
    s_lshl_b32 s63, s63, 7
    s_and_b32 s62, s62, 1
    s_lshl_b32 s62, s62, 4
    s_add_u32 s62, s62, s63
    s_mov_b32 s58, 0x100000
need_74:
    s_load_dwordx4 s[64:67], s[52:53], s62 glc
    s_sub_u32 s58, s58, 1
    s_cbranch_scc1 need_74_ok
    s_waitcnt lgkmcnt(0)
need_74_t:
    s_cmp_ge_u32 s48, 2
    s_cselect_b32 s63, s65, s64
    s_cmp_lg_u32 s63, s10
    s_cbranch_scc1 need_74
need_74_ok:
    s_waitcnt lgkmcnt(0)
    s_add_u32 m0, s51, 0
    s_nop 0
    buffer_load_dwordx4 v5, s[12:15], s50 offen offset:0 sc1 lds
    buffer_load_dwordx4 v5, s[12:15], s50 offen offset:1024 sc1 lds
    s_add_u32 s50, s50, 8192
    s_add_u32 m0, s51, 8192
    s_nop 0
    buffer_load_dwordx4 v5, s[12:15], s50 offen offset:0 sc1 lds
    buffer_load_dwordx4 v5, s[12:15], s50 offen offset:1024 sc1 lds
    s_add_u32 s50, s50, 8192
    s_waitcnt vmcnt(4)
    s_barrier
    s_branch need_75_t
need_75:
    s_load_dwordx4 s[64:67], s[52:53], s62 glc
    s_sub_u32 s58, s58, 1
    s_cbranch_scc1 need_75_ok
    s_waitcnt lgkmcnt(0)
need_75_t:
    s_cmp_ge_u32 s48, 2
    s_cselect_b32 s63, s67, s66
    s_cmp_lg_u32 s63, s10
    s_cbranch_scc1 need_75
need_75_ok:
    s_waitcnt lgkmcnt(0)
    s_add_u32 m0, s51, 16384
    s_nop 0
    buffer_load_dwordx4 v5, s[12:15], s50 offen offset:0 sc1 lds
    buffer_load_dwordx4 v5, s[12:15], s50 offen offset:1024 sc1 lds
    s_add_u32 s50, s50, 8192
    s_add_u32 m0, s51, 24576
    s_nop 0
    buffer_load_dwordx4 v5, s[12:15], s50 offen offset:0 sc1 lds
    buffer_load_dwordx4 v5, s[12:15], s50 offen offset:1024 sc1 lds
    s_add_u32 s50, s50, 8192
    s_waitcnt vmcnt(4)
    s_barrier
    s_add_u32 s62, s61, 3
    s_and_b32 s62, s62, 7
    s_lshl_b32 s50, s62, 15
    s_add_u32 s50, s50, s49
    s_lshr_b32 s63, s62, 1
    s_lshl_b32 s63, s63, 7
    s_and_b32 s62, s62, 1
    s_lshl_b32 s62, s62, 4
    s_add_u32 s62, s62, s63
    s_mov_b32 s58, 0x100000
need_76:
    s_load_dwordx4 s[64:67], s[52:53], s62 glc
    s_sub_u32 s58, s58, 1
    s_cbranch_scc1 need_76_ok
    s_waitcnt lgkmcnt(0)
need_76_t:
    s_cmp_ge_u32 s48, 2
    s_cselect_b32 s63, s65, s64
    s_cmp_lg_u32 s63, s10
    s_cbranch_scc1 need_76
need_76_ok:
    s_waitcnt lgkmcnt(0)
    s_add_u32 m0, s51, 32768
    s_nop 0
    buffer_load_dwordx4 v5, s[12:15], s50 offen offset:0 sc1 lds
    buffer_load_dwordx4 v5, s[12:15], s50 offen offset:1024 sc1 lds
    s_add_u32 s50, s50, 8192
    s_add_u32 m0, s51, 40960
    s_nop 0
    buffer_load_dwordx4 v5, s[12:15], s50 offen offset:0 sc1 lds
    buffer_load_dwordx4 v5, s[12:15], s50 offen offset:1024 sc1 lds
    s_add_u32 s50, s50, 8192
    s_lshl_b32 m0, s60, 10
    s_lshl_b32 s3, s60, 14
    buffer_load_dwordx4 v7, s[24:27], s3 offen lds
    s_add_u32 s60, s60, 4
    s_lshl_b32 m0, s60, 10
    s_lshl_b32 s3, s60, 14
    buffer_load_dwordx4 v7, s[24:27], s3 offen lds
    s_add_u32 s60, s60, 4
    s_waitcnt vmcnt(6)
    s_barrier
    s_branch need_77_t
need_77:
    s_load_dwordx4 s[64:67], s[52:53], s62 glc
    s_sub_u32 s58, s58, 1
    s_cbranch_scc1 need_77_ok
    s_waitcnt lgkmcnt(0)
need_77_t:
    s_cmp_ge_u32 s48, 2
    s_cselect_b32 s63, s67, s66
    s_cmp_lg_u32 s63, s10
    s_cbranch_scc1 need_77
need_77_ok:
    s_waitcnt lgkmcnt(0)
    s_add_u32 m0, s51, 49152
    s_nop 0
    buffer_load_dwordx4 v5, s[12:15], s50 offen offset:0 sc1 lds
    buffer_load_dwordx4 v5, s[12:15], s50 offen offset:1024 sc1 lds
    s_add_u32 s50, s50, 8192
    s_add_u32 m0, s51, 57344
    s_nop 0
    buffer_load_dwordx4 v5, s[12:15], s50 offen offset:0 sc1 lds
    buffer_load_dwordx4 v5, s[12:15], s50 offen offset:1024 sc1 lds
    s_add_u32 s50, s50, 8192
    s_lshl_b32 m0, s60, 10
    s_lshl_b32 s3, s60, 14
    buffer_load_dwordx4 v7, s[24:27], s3 offen lds
    s_add_u32 s60, s60, 4
    s_lshl_b32 m0, s60, 10
    s_lshl_b32 s3, s60, 14
    buffer_load_dwordx4 v7, s[24:27], s3 offen lds
    s_add_u32 s60, s60, 4
    s_waitcnt vmcnt(8)
    s_barrier
    s_add_u32 s62, s61, 4
    s_and_b32 s62, s62, 7
    s_lshl_b32 s50, s62, 15
    s_add_u32 s50, s50, s49
    s_lshr_b32 s63, s62, 1
    s_lshl_b32 s63, s63, 7
    s_and_b32 s62, s62, 1
    s_lshl_b32 s62, s62, 4
    s_add_u32 s62, s62, s63
    s_mov_b32 s58, 0x100000
need_78:
    s_load_dwordx4 s[64:67], s[52:53], s62 glc
    s_sub_u32 s58, s58, 1
    s_cbranch_scc1 need_78_ok
    s_waitcnt lgkmcnt(0)
need_78_t:
    s_cmp_ge_u32 s48, 2
    s_cselect_b32 s63, s65, s64
    s_cmp_lg_u32 s63, s10
    s_cbranch_scc1 need_78
need_78_ok:
    s_waitcnt lgkmcnt(0)
    s_add_u32 m0, s51, 0
    s_nop 0
    buffer_load_dwordx4 v5, s[12:15], s50 offen offset:0 sc1 lds
    buffer_load_dwordx4 v5, s[12:15], s50 offen offset:1024 sc1 lds
    s_add_u32 s50, s50, 8192
    s_add_u32 m0, s51, 8192
    s_nop 0
    buffer_load_dwordx4 v5, s[12:15], s50 offen offset:0 sc1 lds
    buffer_load_dwordx4 v5, s[12:15], s50 offen offset:1024 sc1 lds
    s_add_u32 s50, s50, 8192
    s_lshl_b32 m0, s60, 10
    s_lshl_b32 s3, s60, 14
    buffer_load_dwordx4 v7, s[24:27], s3 offen lds
    s_add_u32 s60, s60, 4
    s_lshl_b32 m0, s60, 10
    s_lshl_b32 s3, s60, 14
    buffer_load_dwordx4 v7, s[24:27], s3 offen lds
    s_add_u32 s60, s60, 4
    s_waitcnt vmcnt(8)
    s_barrier
    s_branch need_79_t
need_79:
    s_load_dwordx4 s[64:67], s[52:53], s62 glc
    s_sub_u32 s58, s58, 1
    s_cbranch_scc1 need_79_ok
    s_waitcnt lgkmcnt(0)
need_79_t:
    s_cmp_ge_u32 s48, 2
    s_cselect_b32 s63, s67, s66
    s_cmp_lg_u32 s63, s10
    s_cbranch_scc1 need_79
need_79_ok:
    s_waitcnt lgkmcnt(0)
    s_add_u32 m0, s51, 16384
    s_nop 0
    buffer_load_dwordx4 v5, s[12:15], s50 offen offset:0 sc1 lds
    buffer_load_dwordx4 v5, s[12:15], s50 offen offset:1024 sc1 lds
    s_add_u32 s50, s50, 8192
    s_add_u32 m0, s51, 24576
    s_nop 0
    buffer_load_dwordx4 v5, s[12:15], s50 offen offset:0 sc1 lds
    buffer_load_dwordx4 v5, s[12:15], s50 offen offset:1024 sc1 lds
    s_add_u32 s50, s50, 8192
    s_lshl_b32 m0, s60, 10
    s_lshl_b32 s3, s60, 14
    buffer_load_dwordx4 v7, s[24:27], s3 offen lds
    s_add_u32 s60, s60, 4
    s_lshl_b32 m0, s60, 10
    s_lshl_b32 s3, s60, 14
    buffer_load_dwordx4 v7, s[24:27], s3 offen lds
    s_add_u32 s60, s60, 4
    s_waitcnt vmcnt(8)
    s_barrier
    s_add_u32 s62, s61, 5
    s_and_b32 s62, s62, 7
    s_lshl_b32 s50, s62, 15
    s_add_u32 s50, s50, s49
    s_lshr_b32 s63, s62, 1
    s_lshl_b32 s63, s63, 7
    s_and_b32 s62, s62, 1
    s_lshl_b32 s62, s62, 4
    s_add_u32 s62, s62, s63
    s_mov_b32 s58, 0x100000
need_80:
    s_load_dwordx4 s[64:67], s[52:53], s62 glc
    s_sub_u32 s58, s58, 1
    s_cbranch_scc1 need_80_ok
    s_waitcnt lgkmcnt(0)
need_80_t:
    s_cmp_ge_u32 s48, 2
    s_cselect_b32 s63, s65, s64
    s_cmp_lg_u32 s63, s10
    s_cbranch_scc1 need_80
need_80_ok:
    s_waitcnt lgkmcnt(0)
    s_add_u32 m0, s51, 32768
    s_nop 0
    buffer_load_dwordx4 v5, s[12:15], s50 offen offset:0 sc1 lds
    buffer_load_dwordx4 v5, s[12:15], s50 offen offset:1024 sc1 lds
    s_add_u32 s50, s50, 8192
    s_add_u32 m0, s51, 40960
    s_nop 0
    buffer_load_dwordx4 v5, s[12:15], s50 offen offset:0 sc1 lds
    buffer_load_dwordx4 v5, s[12:15], s50 offen offset:1024 sc1 lds
    s_add_u32 s50, s50, 8192
    s_lshl_b32 m0, s60, 10
    s_lshl_b32 s3, s60, 14
    buffer_load_dwordx4 v7, s[24:27], s3 offen lds
    s_add_u32 s60, s60, 4
    s_lshl_b32 m0, s60, 10
    s_lshl_b32 s3, s60, 14
    buffer_load_dwordx4 v7, s[24:27], s3 offen lds
    s_add_u32 s60, s60, 4
    s_waitcnt vmcnt(8)
    s_barrier
    s_branch need_81_t
need_81:
    s_load_dwordx4 s[64:67], s[52:53], s62 glc
    s_sub_u32 s58, s58, 1
    s_cbranch_scc1 need_81_ok
    s_waitcnt lgkmcnt(0)
need_81_t:
    s_cmp_ge_u32 s48, 2
    s_cselect_b32 s63, s67, s66
    s_cmp_lg_u32 s63, s10
    s_cbranch_scc1 need_81
need_81_ok:
    s_waitcnt lgkmcnt(0)
    s_add_u32 m0, s51, 49152
    s_nop 0
    buffer_load_dwordx4 v5, s[12:15], s50 offen offset:0 sc1 lds
    buffer_load_dwordx4 v5, s[12:15], s50 offen offset:1024 sc1 lds
    s_add_u32 s50, s50, 8192
    s_add_u32 m0, s51, 57344
    s_nop 0
    buffer_load_dwordx4 v5, s[12:15], s50 offen offset:0 sc1 lds
    buffer_load_dwordx4 v5, s[12:15], s50 offen offset:1024 sc1 lds
    s_add_u32 s50, s50, 8192
    s_lshl_b32 m0, s60, 10
    s_lshl_b32 s3, s60, 14
    buffer_load_dwordx4 v7, s[24:27], s3 offen lds
    s_add_u32 s60, s60, 4
    s_lshl_b32 m0, s60, 10
    s_lshl_b32 s3, s60, 14
    buffer_load_dwordx4 v7, s[24:27], s3 offen lds
    s_add_u32 s60, s60, 4
    s_waitcnt vmcnt(8)
    s_barrier
    s_add_u32 s62, s61, 6
    s_and_b32 s62, s62, 7
    s_lshl_b32 s50, s62, 15
    s_add_u32 s50, s50, s49
    s_lshr_b32 s63, s62, 1
    s_lshl_b32 s63, s63, 7
    s_and_b32 s62, s62, 1
    s_lshl_b32 s62, s62, 4
    s_add_u32 s62, s62, s63
    s_mov_b32 s58, 0x100000
need_82:
    s_load_dwordx4 s[64:67], s[52:53], s62 glc
    s_sub_u32 s58, s58, 1
    s_cbranch_scc1 need_82_ok
    s_waitcnt lgkmcnt(0)
need_82_t:
    s_cmp_ge_u32 s48, 2
    s_cselect_b32 s63, s65, s64
    s_cmp_lg_u32 s63, s10
    s_cbranch_scc1 need_82
need_82_ok:
    s_waitcnt lgkmcnt(0)
    s_add_u32 m0, s51, 0
    s_nop 0
    buffer_load_dwordx4 v5, s[12:15], s50 offen offset:0 sc1 lds
    buffer_load_dwordx4 v5, s[12:15], s50 offen offset:1024 sc1 lds
    s_add_u32 s50, s50, 8192
    s_add_u32 m0, s51, 8192
    s_nop 0
    buffer_load_dwordx4 v5, s[12:15], s50 offen offset:0 sc1 lds
    buffer_load_dwordx4 v5, s[12:15], s50 offen offset:1024 sc1 lds
    s_add_u32 s50, s50, 8192
    s_lshl_b32 m0, s60, 10
    s_lshl_b32 s3, s60, 14
    buffer_load_dwordx4 v7, s[24:27], s3 offen lds
    s_add_u32 s60, s60, 4
    s_lshl_b32 m0, s60, 10
    s_lshl_b32 s3, s60, 14
    buffer_load_dwordx4 v7, s[24:27], s3 offen lds
    s_add_u32 s60, s60, 4
    s_waitcnt vmcnt(8)
    s_barrier
    s_branch need_83_t
need_83:
    s_load_dwordx4 s[64:67], s[52:53], s62 glc
    s_sub_u32 s58, s58, 1
    s_cbranch_scc1 need_83_ok
    s_waitcnt lgkmcnt(0)
need_83_t:
    s_cmp_ge_u32 s48, 2
    s_cselect_b32 s63, s67, s66
    s_cmp_lg_u32 s63, s10
    s_cbranch_scc1 need_83
need_83_ok:
    s_waitcnt lgkmcnt(0)
    s_add_u32 m0, s51, 16384
    s_nop 0
    buffer_load_dwordx4 v5, s[12:15], s50 offen offset:0 sc1 lds
    buffer_load_dwordx4 v5, s[12:15], s50 offen offset:1024 sc1 lds
    s_add_u32 s50, s50, 8192
    s_add_u32 m0, s51, 24576
    s_nop 0
    buffer_load_dwordx4 v5, s[12:15], s50 offen offset:0 sc1 lds
    buffer_load_dwordx4 v5, s[12:15], s50 offen offset:1024 sc1 lds
    s_add_u32 s50, s50, 8192
    s_lshl_b32 m0, s60, 10
    s_lshl_b32 s3, s60, 14
    buffer_load_dwordx4 v7, s[24:27], s3 offen lds
    s_add_u32 s60, s60, 4
    s_lshl_b32 m0, s60, 10
    s_lshl_b32 s3, s60, 14
    buffer_load_dwordx4 v7, s[24:27], s3 offen lds
    s_add_u32 s60, s60, 4
    s_waitcnt vmcnt(8)
    s_barrier
    s_add_u32 s62, s61, 7
    s_and_b32 s62, s62, 7
    s_lshl_b32 s50, s62, 15
    s_add_u32 s50, s50, s49
    s_lshr_b32 s63, s62, 1
    s_lshl_b32 s63, s63, 7
    s_and_b32 s62, s62, 1
    s_lshl_b32 s62, s62, 4
    s_add_u32 s62, s62, s63
    s_mov_b32 s58, 0x100000
need_84:
    s_load_dwordx4 s[64:67], s[52:53], s62 glc
    s_sub_u32 s58, s58, 1
    s_cbranch_scc1 need_84_ok
    s_waitcnt lgkmcnt(0)
need_84_t:
    s_cmp_ge_u32 s48, 2
    s_cselect_b32 s63, s65, s64
    s_cmp_lg_u32 s63, s10
    s_cbranch_scc1 need_84
need_84_ok:
    s_waitcnt lgkmcnt(0)
    s_add_u32 m0, s51, 32768
    s_nop 0
    buffer_load_dwordx4 v5, s[12:15], s50 offen offset:0 sc1 lds
    buffer_load_dwordx4 v5, s[12:15], s50 offen offset:1024 sc1 lds
    s_add_u32 s50, s50, 8192
    s_add_u32 m0, s51, 40960
    s_nop 0
    buffer_load_dwordx4 v5, s[12:15], s50 offen offset:0 sc1 lds
    buffer_load_dwordx4 v5, s[12:15], s50 offen offset:1024 sc1 lds
    s_add_u32 s50, s50, 8192
    s_lshl_b32 m0, s60, 10
    s_lshl_b32 s3, s60, 14
    buffer_load_dwordx4 v7, s[24:27], s3 offen lds
    s_add_u32 s60, s60, 4
    s_lshl_b32 m0, s60, 10
    s_lshl_b32 s3, s60, 14
    buffer_load_dwordx4 v7, s[24:27], s3 offen lds
    s_add_u32 s60, s60, 4
    s_waitcnt vmcnt(8)
    s_barrier
    s_branch need_85_t
need_85:
    s_load_dwordx4 s[64:67], s[52:53], s62 glc
    s_sub_u32 s58, s58, 1
    s_cbranch_scc1 need_85_ok
    s_waitcnt lgkmcnt(0)
need_85_t:
    s_cmp_ge_u32 s48, 2
    s_cselect_b32 s63, s67, s66
    s_cmp_lg_u32 s63, s10
    s_cbranch_scc1 need_85
need_85_ok:
    s_waitcnt lgkmcnt(0)
    s_add_u32 m0, s51, 49152
    s_nop 0
    buffer_load_dwordx4 v5, s[12:15], s50 offen offset:0 sc1 lds
    buffer_load_dwordx4 v5, s[12:15], s50 offen offset:1024 sc1 lds
    s_add_u32 s50, s50, 8192
    s_add_u32 m0, s51, 57344
    s_nop 0
    buffer_load_dwordx4 v5, s[12:15], s50 offen offset:0 sc1 lds
    buffer_load_dwordx4 v5, s[12:15], s50 offen offset:1024 sc1 lds
    s_add_u32 s50, s50, 8192
    s_lshl_b32 m0, s60, 10
    s_lshl_b32 s3, s60, 14
    buffer_load_dwordx4 v7, s[24:27], s3 offen lds
    s_add_u32 s60, s60, 4
    s_lshl_b32 m0, s60, 10
    s_lshl_b32 s3, s60, 14
    buffer_load_dwordx4 v7, s[24:27], s3 offen lds
    s_add_u32 s60, s60, 4
    s_waitcnt vmcnt(8)
    s_barrier
    s_lshl_b32 m0, s60, 10
    s_lshl_b32 s3, s60, 14
    buffer_load_dwordx4 v7, s[24:27], s3 offen lds
    s_add_u32 s60, s60, 4
    s_lshl_b32 m0, s60, 10
    s_lshl_b32 s3, s60, 14
    buffer_load_dwordx4 v7, s[24:27], s3 offen lds
    s_add_u32 s60, s60, 4
    s_lshl_b32 m0, s60, 10
    s_lshl_b32 s3, s60, 14
    buffer_load_dwordx4 v7, s[24:27], s3 offen lds
    s_add_u32 s60, s60, 4
    s_lshl_b32 m0, s60, 10
    s_lshl_b32 s3, s60, 14
    buffer_load_dwordx4 v7, s[24:27], s3 offen lds
    s_add_u32 s60, s60, 4
    s_waitcnt vmcnt(6)
    s_barrier
    s_lshl_b32 m0, s60, 10
    s_lshl_b32 s3, s60, 14
    buffer_load_dwordx4 v7, s[24:27], s3 offen lds
    s_add_u32 s60, s60, 4
    s_lshl_b32 m0, s60, 10
    s_lshl_b32 s3, s60, 14
    buffer_load_dwordx4 v7, s[24:27], s3 offen lds
    s_add_u32 s60, s60, 4
    s_lshl_b32 m0, s60, 10
    s_lshl_b32 s3, s60, 14
    buffer_load_dwordx4 v7, s[24:27], s3 offen lds
    s_add_u32 s60, s60, 4
    s_lshl_b32 m0, s60, 10
    s_lshl_b32 s3, s60, 14
    buffer_load_dwordx4 v7, s[24:27], s3 offen lds
    s_add_u32 s60, s60, 4
    s_barrier
    s_lshl_b32 m0, s60, 10
    s_lshl_b32 s3, s60, 14
    buffer_load_dwordx4 v7, s[24:27], s3 offen lds
    s_add_u32 s60, s60, 4
    s_lshl_b32 m0, s60, 10
    s_lshl_b32 s3, s60, 14
    buffer_load_dwordx4 v7, s[24:27], s3 offen lds
    s_add_u32 s60, s60, 4
    s_lshl_b32 m0, s60, 10
    s_lshl_b32 s3, s60, 14
    buffer_load_dwordx4 v7, s[24:27], s3 offen lds
    s_add_u32 s60, s60, 4
    s_lshl_b32 m0, s60, 10
    s_lshl_b32 s3, s60, 14
    buffer_load_dwordx4 v7, s[24:27], s3 offen lds
    s_add_u32 s60, s60, 4
    s_cmp_eq_u32 s8, 4
    s_cbranch_scc1 h_wo
    s_branch l_wo
.p2align 6
c_attn_slow:
    s_waitcnt lgkmcnt(0)
    s_lshr_b32 s56, s9, 1
    s_lshl_b32 s56, s56, 23
    s_lshl_b32 s55, s7, 19
    s_add_u32 s56, s56, s55
    s_and_b32 s55, s6, 1
    s_lshl_b32 s55, s55, 18
    s_add_u32 s56, s56, s55
    s_add_u32 s56, s56, 33554432
    v_mov_b32 v28, 0xff800000
    v_mov_b32 v30, 0xff800000
    s_mov_b32 s57, 0
c_attn_slow1:
    s_lshr_b32 s55, s57, 2
    s_lshl_b32 s55, s55, 14
    s_and_b32 s58, s57, 3
    s_lshl_b32 s58, s58, 11
    s_add_u32 s55, s55, s58
    s_add_u32 s55, s55, s56
    buffer_load_dwordx4 v[128:131], v5, s[12:15], s55 offen offset:0 sc1
    buffer_load_dwordx4 v[132:135], v5, s[12:15], s55 offen offset:1024 sc1
    s_waitcnt vmcnt(0)
    v_mfma_f32_32x32x16_bf16 v[64:79], v[128:131], v[8:11], 0
    v_mfma_f32_32x32x16_bf16 v[80:95], v[128:131], v[16:19], 0
    v_mfma_f32_32x32x16_bf16 v[64:79], v[132:135], v[12:15], v[64:79]
    v_mfma_f32_32x32x16_bf16 v[80:95], v[132:135], v[20:23], v[80:95]
    s_nop 10
    v_max3_f32 v28, v28, v64, v65
    v_max3_f32 v28, v28, v66, v67
    v_max3_f32 v28, v28, v68, v69
    v_max3_f32 v28, v28, v70, v71
    v_max3_f32 v28, v28, v72, v73
    v_max3_f32 v28, v28, v74, v75
    v_max3_f32 v28, v28, v76, v77
    v_max3_f32 v28, v28, v78, v79
    v_max3_f32 v30, v30, v80, v81
    v_max3_f32 v30, v30, v82, v83
    v_max3_f32 v30, v30, v84, v85
    v_max3_f32 v30, v30, v86, v87
    v_max3_f32 v30, v30, v88, v89
    v_max3_f32 v30, v30, v90, v91
    v_max3_f32 v30, v30, v92, v93
    v_max3_f32 v30, v30, v94, v95
    s_add_u32 s57, s57, 1
    s_cmp_lt_u32 s57, 64
    s_cbranch_scc1 c_attn_slow1
    v_mov_b32 v29, v28
    s_nop 1
    v_permlane32_swap_b32 v28, v29
    v_max_f32 v28, v28, v29
    v_sub_f32 v96, 0, v28
    v_sub_f32 v97, 0, v28
    v_sub_f32 v98, 0, v28
    v_sub_f32 v99, 0, v28
    v_sub_f32 v100, 0, v28
    v_sub_f32 v101, 0, v28
    v_sub_f32 v102, 0, v28
    v_sub_f32 v103, 0, v28
    v_sub_f32 v104, 0, v28
    v_sub_f32 v105, 0, v28
    v_sub_f32 v106, 0, v28
    v_sub_f32 v107, 0, v28
    v_sub_f32 v108, 0, v28
    v_sub_f32 v109, 0, v28
    v_sub_f32 v110, 0, v28
    v_sub_f32 v111, 0, v28
    v_mov_b32 v160, 0
    v_mov_b32 v161, 0
    v_mov_b32 v162, 0
    v_mov_b32 v163, 0
    v_mov_b32 v164, 0
    v_mov_b32 v165, 0
    v_mov_b32 v166, 0
    v_mov_b32 v167, 0
    v_mov_b32 v168, 0
    v_mov_b32 v169, 0
    v_mov_b32 v170, 0
    v_mov_b32 v171, 0
    v_mov_b32 v172, 0
    v_mov_b32 v173, 0
    v_mov_b32 v174, 0
    v_mov_b32 v175, 0
    v_mov_b32 v192, 0
    v_mov_b32 v193, 0
    v_mov_b32 v194, 0
    v_mov_b32 v195, 0
    v_mov_b32 v31, v30
    s_nop 1
    v_permlane32_swap_b32 v30, v31
    v_max_f32 v30, v30, v31
    v_sub_f32 v112, 0, v30
    v_sub_f32 v113, 0, v30
    v_sub_f32 v114, 0, v30
    v_sub_f32 v115, 0, v30
    v_sub_f32 v116, 0, v30
    v_sub_f32 v117, 0, v30
    v_sub_f32 v118, 0, v30
    v_sub_f32 v119, 0, v30
    v_sub_f32 v120, 0, v30
    v_sub_f32 v121, 0, v30
    v_sub_f32 v122, 0, v30
    v_sub_f32 v123, 0, v30
    v_sub_f32 v124, 0, v30
    v_sub_f32 v125, 0, v30
    v_sub_f32 v126, 0, v30
    v_sub_f32 v127, 0, v30
    v_mov_b32 v176, 0
    v_mov_b32 v177, 0
    v_mov_b32 v178, 0
    v_mov_b32 v179, 0
    v_mov_b32 v180, 0
    v_mov_b32 v181, 0
    v_mov_b32 v182, 0
    v_mov_b32 v183, 0
    v_mov_b32 v184, 0
    v_mov_b32 v185, 0
    v_mov_b32 v186, 0
    v_mov_b32 v187, 0
    v_mov_b32 v188, 0
    v_mov_b32 v189, 0
    v_mov_b32 v190, 0
    v_mov_b32 v191, 0
    v_mov_b32 v196, 0
    v_mov_b32 v197, 0
    v_mov_b32 v198, 0
    v_mov_b32 v199, 0
    s_mov_b32 s57, 0
c_attn_slow2:
    s_lshr_b32 s55, s57, 2
    s_lshl_b32 s55, s55, 14
    s_and_b32 s58, s57, 3
    s_lshl_b32 s58, s58, 11
    s_add_u32 s55, s55, s58
    s_add_u32 s55, s55, s56
    buffer_load_dwordx4 v[128:131], v5, s[12:15], s55 offen offset:0 sc1
    buffer_load_dwordx4 v[132:135], v5, s[12:15], s55 offen offset:1024 sc1
    s_add_u32 s55, s55, 8192
    buffer_load_dwordx4 v[144:147], v5, s[12:15], s55 offen offset:0 sc1
    buffer_load_dwordx4 v[148:151], v5, s[12:15], s55 offen offset:1024 sc1
    s_waitcnt vmcnt(0)
    v_mfma_f32_32x32x16_bf16 v[64:79], v[128:131], v[8:11], v[96:111]
    v_mfma_f32_32x32x16_bf16 v[80:95], v[128:131], v[16:19], v[112:127]
    v_mfma_f32_32x32x16_bf16 v[64:79], v[132:135], v[12:15], v[64:79]
    v_mfma_f32_32x32x16_bf16 v[80:95], v[132:135], v[20:23], v[80:95]
    s_nop 10
    v_exp_f32 v64, v64
    v_exp_f32 v65, v65
    v_exp_f32 v66, v66
    v_exp_f32 v67, v67
    v_exp_f32 v68, v68
    v_exp_f32 v69, v69
    v_exp_f32 v70, v70
    v_exp_f32 v71, v71
    v_exp_f32 v72, v72
    v_exp_f32 v73, v73
    v_exp_f32 v74, v74
    v_exp_f32 v75, v75
    v_exp_f32 v76, v76
    v_exp_f32 v77, v77
    v_exp_f32 v78, v78
    v_exp_f32 v79, v79
    v_exp_f32 v80, v80
    v_exp_f32 v81, v81
    v_exp_f32 v82, v82
    v_exp_f32 v83, v83
    v_exp_f32 v84, v84
    v_exp_f32 v85, v85
    v_exp_f32 v86, v86
    v_exp_f32 v87, v87
    v_exp_f32 v88, v88
    v_exp_f32 v89, v89
    v_exp_f32 v90, v90
    v_exp_f32 v91, v91
    v_exp_f32 v92, v92
    v_exp_f32 v93, v93
    v_exp_f32 v94, v94
    v_exp_f32 v95, v95
    v_smfmac_f32_32x32x32_bf16 v[160:175], v[144:147], v[64:71], v204
    v_smfmac_f32_16x16x64_bf16 v[192:195], v[200:203], v[64:71], v204
    v_smfmac_f32_32x32x32_bf16 v[160:175], v[148:151], v[72:79], v204
    v_smfmac_f32_16x16x64_bf16 v[192:195], v[200:203], v[72:79], v204
    v_smfmac_f32_32x32x32_bf16 v[176:191], v[144:147], v[80:87], v204
    v_smfmac_f32_16x16x64_bf16 v[196:199], v[200:203], v[80:87], v204
    v_smfmac_f32_32x32x32_bf16 v[176:191], v[148:151], v[88:95], v204
    v_smfmac_f32_16x16x64_bf16 v[196:199], v[200:203], v[88:95], v204
    s_add_u32 s57, s57, 1
    s_cmp_lt_u32 s57, 64
    s_nop 15
    s_cbranch_scc1 c_attn_slow2
    s_branch c_attn_fin
    s_endpgm
k_end:
.section .rodata,"a"
.p2align 6
.amdhsa_kernel interleave_layers__sliding_local_dilated__softmax_full_mha__prompt_kernel
  .amdhsa_next_free_vgpr 256
  .amdhsa_next_free_sgpr 102
  .amdhsa_accum_offset 224
  .amdhsa_group_segment_fixed_size 0
  .amdhsa_kernarg_size 72
  .amdhsa_user_sgpr_count 2
  .amdhsa_user_sgpr_kernarg_segment_ptr 1
  .amdhsa_system_sgpr_workgroup_id_x 1
.end_amdhsa_kernel
```

```asm
; @launch grid=(256,1,1) block=(512,1,1) lds=159744
.amdgcn_target "amdgcn-amd-amdhsa--gfx950"
.text
.globl interleave_layers__sliding_local_dilated__softmax_full_mha__prompt_kernel
.type interleave_layers__sliding_local_dilated__softmax_full_mha__prompt_kernel,@function
.p2align 8
interleave_layers__sliding_local_dilated__softmax_full_mha__prompt_kernel:
    s_cmp_ge_u32 s2, 256
    s_cbranch_scc1 k_exit2
    s_load_dwordx16 s[32:47], s[0:1], 0
    s_load_dwordx2 s[4:5], s[0:1], 64
    v_lshrrev_b32 v2, 6, v0
    v_and_b32 v1, 63, v0
    v_mov_b32 v12, 0
    v_mov_b32 v14, 0
    v_mov_b32 v15, 0
    v_mov_b32 v16, 0
    v_readfirstlane_b32 s8, v2
    s_and_b32 s3, s2, 2
    s_lshl_b32 s3, s3, 2
    s_bfe_u32 s6, s2, 0x30003
    s_add_u32 s6, s3, s6
    s_and_b32 s3, s2, 1
    s_lshl_b32 s3, s3, 3
    s_lshr_b32 s7, s2, 6
    s_add_u32 s7, s3, s7
    s_and_b32 s3, s2, 4
    s_add_u32 s7, s3, s7
    s_lshl_b32 s11, s6, 4
    s_add_u32 s11, s11, s7
    s_mov_b32 s9, -1
    s_mov_b32 s96, 0
    s_mov_b32 s10, 0
    s_cmp_lt_u32 s8, 4
    s_cbranch_scc1 c_prep
    s_cmp_eq_u32 s8, 4
    s_cbranch_scc1 h_first
k_heads:
l_first:
    s_sub_u32 s51, s8, 5
    s_mul_i32 s61, s51, 0
    s_add_u32 s61, s61, s2
    s_and_b32 s61, s61, 255
    s_lshl_b32 s3, s51, 8
    s_add_u32 s61, s61, s3
    s_and_b32 s62, s61, 15
    s_lshr_b32 s63, s61, 4
    v_lshrrev_b32 v20, 3, v1
    v_mul_u32_u24 v12, 6144, v20
    v_and_b32 v21, 7, v1
    v_lshl_add_u32 v12, v21, 4, v12
    s_mul_i32 s52, s62, 393216
    s_lshl_b32 s56, s63, 7
    s_add_u32 s52, s52, s56
    s_waitcnt lgkmcnt(0)
    s_mov_b32 s12, s4
    s_mov_b32 s13, s5
    s_mov_b32 s14, 71303168
    s_mov_b32 s15, 0x00020000
    s_mov_b32 s20, s34
    s_mov_b32 s21, s35
    s_mov_b32 s22, 6291456
    s_mov_b32 s23, 0x00020000
    s_add_u32 s53, s52, 0
    buffer_load_dwordx4 v[160:163], v12, s[20:23], s53 offen nt
    s_add_u32 s53, s52, 49152
    buffer_load_dwordx4 v[164:167], v12, s[20:23], s53 offen nt
    s_add_u32 s53, s52, 98304
    buffer_load_dwordx4 v[168:171], v12, s[20:23], s53 offen nt
    s_add_u32 s53, s52, 147456
    buffer_load_dwordx4 v[172:175], v12, s[20:23], s53 offen nt
    s_add_u32 s53, s52, 196608
    buffer_load_dwordx4 v[176:179], v12, s[20:23], s53 offen nt
    s_add_u32 s53, s52, 245760
    buffer_load_dwordx4 v[180:183], v12, s[20:23], s53 offen nt
    s_add_u32 s53, s52, 294912
    buffer_load_dwordx4 v[184:187], v12, s[20:23], s53 offen nt
    s_add_u32 s53, s52, 344064
    buffer_load_dwordx4 v[188:191], v12, s[20:23], s53 offen nt
    s_barrier
    s_branch l_first_tail
c_prep:
    s_lshl_b32 s48, s6, 2
    s_add_u32 s48, s48, s8
    v_lshrrev_b32 v16, 3, v1
    v_and_b32 v17, 7, v1
    v_lshlrev_b32 v18, 11, v16
    v_lshl_add_u32 v18, v17, 4, v18
    s_lshl_b32 s55, s48, 16
    s_lshl_b32 s56, s7, 7
    s_add_u32 s3, s55, s56
    s_waitcnt lgkmcnt(0)
    s_mov_b32 s12, s4
    s_mov_b32 s13, s5
    s_mov_b32 s14, 71303168
    s_mov_b32 s15, 0x00020000
    s_mov_b32 s28, s32
    s_mov_b32 s29, s33
    s_mov_b32 s30, 4194304
    s_mov_b32 s31, 0x00020000
    buffer_load_dwordx4 v[32:35], v18, s[28:31], s3 offen nt
    s_add_u32 s3, s3, 16384
    buffer_load_dwordx4 v[36:39], v18, s[28:31], s3 offen nt
    s_add_u32 s3, s3, 16384
    buffer_load_dwordx4 v[40:43], v18, s[28:31], s3 offen nt
    s_add_u32 s3, s3, 16384
    buffer_load_dwordx4 v[44:47], v18, s[28:31], s3 offen nt
    s_add_u32 s3, s3, 16384
    s_barrier
    s_branch c_prep_tail
h_first:
    s_memrealtime s[50:51]
    s_getpc_b64 s[52:53]
pc_10:
    s_sub_u32 s52, s52, pc_10-interleave_layers__sliding_local_dilated__softmax_full_mha__prompt_kernel
    s_subb_u32 s53, s53, 0
    s_lshr_b32 s3, s2, 3
    s_lshl_b32 s3, s3, 11
    v_and_b32 v18, 15, v0
    v_lshl_add_u32 v18, v18, 7, s3
    v_min_u32 v18, k_end-interleave_layers__sliding_local_dilated__softmax_full_mha__prompt_kernel-4, v18
    v_mov_b32 v19, s53
    v_add_co_u32 v18, vcc, s52, v18
    s_nop 1
    v_addc_co_u32 v19, vcc, 0, v19, vcc
    s_mov_b64 exec, 0xffff
    global_load_dword v18, v[18:19], off
    s_mov_b64 exec, -1
    s_waitcnt lgkmcnt(0)
    s_mov_b32 s12, s4
    s_mov_b32 s13, s5
    s_mov_b32 s14, 71303168
    s_mov_b32 s15, 0x00020000
    s_cmp_lg_u32 s2, 0
    s_cbranch_scc1 h_first_nonon
    s_mov_b32 s16, s46
    s_mov_b32 s17, s47
    s_mov_b32 s18, 256
    s_mov_b32 s19, 0x00020000
    v_lshlrev_b32 v14, 6, v1
    s_or_b32 s50, s50, 1
    v_mov_b32 v13, s50
    buffer_store_dword v13, v14, s[16:19], 0 offen sc1
h_first_nonon:
    v_mov_b32 v8, 0
    v_mov_b32 v9, 0
    v_mov_b32 v10, 159488
    ds_write_b64 v10, v[8:9]
    ds_write_b64 v10, v[8:9] offset:8
    ds_write_b64 v10, v[8:9] offset:16
    ds_write_b64 v10, v[8:9] offset:24
    s_waitcnt lgkmcnt(0)
    s_barrier
    s_branch h_first_tail
k_exit:
k_exit2:
    s_endpgm
.p2align 6
c_qkvA:
    v_and_b32 v1, 63, v0
    v_lshrrev_b32 v2, 6, v0
    v_lshlrev_b32 v5, 4, v1
    v_lshrrev_b32 v3, 5, v1
    v_and_b32 v4, 15, v0
    v_bfe_u32 v7, v1, 4, 1
    v_lshl_add_u32 v6, v7, 5, v4
    v_lshlrev_b32 v6, 4, v6
    v_lshl_add_u32 v6, v3, 10, v6
    s_lshr_b32 s48, s6, 1
    s_lshl_b32 s48, s48, 2
    s_add_u32 s48, s48, s8
    s_lshl_b32 s55, s48, 17
    s_lshl_b32 s56, s9, 22
    s_add_u32 s55, s55, s56
    s_add_u32 s16, s4, s55
    s_addc_u32 s17, s5, 0
    s_mov_b32 s18, 65536
    s_mov_b32 s19, 0x00020000
    s_add_u32 s56, s55, 65536
    s_add_u32 s20, s4, s56
    s_addc_u32 s21, s5, 0
    s_mov_b32 s22, 65536
    s_mov_b32 s23, 0x00020000
    s_lshl_b32 s49, s7, 12
    s_add_u32 s49, s49, s55
    s_and_b32 s56, s6, 1
    s_lshl_b32 s56, s56, 11
    s_add_u32 s49, s49, s56
    s_add_u32 s49, s49, 16777216
    s_movk_i32 s54, 4096
    v_lshrrev_b32 v16, 2, v4
    v_lshl_add_u32 v18, v7, 2, v16
    v_lshl_add_u32 v18, v3, 4, v18
    v_lshlrev_b32 v18, 6, v18
    v_and_b32 v17, 3, v4
    v_lshl_add_u32 v18, v17, 3, v18
    v_lshl_add_u32 v26, v7, 5, v18
    v_xor_b32 v27, 32, v26
    v_mov_b32 v24, v26
    v_mov_b32 v25, v27
    v_and_b32 v18, 0x30, v1
    v_add_u32 v10, 155648, v18
    v_lshlrev_b32 v11, 2, v4
    v_add_u32 v11, 155648, v11
    v_lshl_add_u32 v8, v2, 8, v11
    v_lshl_add_u32 v9, v2, 8, v10
    s_lshr_b32 s3, s8, 1
    s_and_b32 s55, s8, 1
    s_lshl_b32 s56, s55, 5
    v_xor_b32 v29, s56, v26
    s_lshl_b32 s56, s3, 13
    s_add_u32 s56, s56, 8192
    v_add_u32 v29, s56, v29
    v_mov_b32 v28, v29
    v_add_u32 v30, 147456, v5
    v_lshl_add_u32 v14, v2, 6, v10
    v_lshl_add_u32 v12, v2, 11, v5
    v_add_u32 v12, 131072, v12
    v_lshlrev_b32 v16, 8, v16
    v_lshl_add_u32 v16, v18, 2, v16
    v_lshl_add_u32 v16, v17, 1, v16
    v_add_u32 v16, 1024, v16
    v_cmp_gt_u32 vcc, 2, v2
    s_nop 1
    v_cndmask_b32 v13, v16, v5, vcc
    s_lshl_b32 s56, s55, 3
    s_add_u32 s56, s56, 131072
    v_add_u32 v13, s56, v13
    v_lshrrev_b32 v18, 2, v18
    v_sub_u32 v18, v4, v18
    v_mov_b32 v19, 0xf149f2ca
    v_add_u32 v16, 0x0, v18
    v_and_b32 v16, 0xfffffff1, v16
    v_cmp_eq_u32 vcc, 0, v16
    s_nop 1
    v_cndmask_b32 v196, v19, 0, vcc
    v_add_u32 v16, 0xffffffff, v18
    v_and_b32 v16, 0xfffffff1, v16
    v_cmp_eq_u32 vcc, 0, v16
    s_nop 1
    v_cndmask_b32 v197, v19, 0, vcc
    v_add_u32 v16, 0xfffffffe, v18
    v_and_b32 v16, 0xfffffff1, v16
    v_cmp_eq_u32 vcc, 0, v16
    s_nop 1
    v_cndmask_b32 v198, v19, 0, vcc
    v_add_u32 v16, 0xfffffffd, v18
    v_and_b32 v16, 0xfffffff1, v16
    v_cmp_eq_u32 vcc, 0, v16
    s_nop 1
    v_cndmask_b32 v199, v19, 0, vcc
    v_add_u32 v16, 0x10, v18
    v_and_b32 v16, 0xfffffff1, v16
    v_cmp_eq_u32 vcc, 0, v16
    s_nop 1
    v_cndmask_b32 v200, v19, 0, vcc
    v_add_u32 v16, 0xf, v18
    v_and_b32 v16, 0xfffffff1, v16
    v_cmp_eq_u32 vcc, 0, v16
    s_nop 1
    v_cndmask_b32 v201, v19, 0, vcc
    v_add_u32 v16, 0xe, v18
    v_and_b32 v16, 0xfffffff1, v16
    v_cmp_eq_u32 vcc, 0, v16
    s_nop 1
    v_cndmask_b32 v202, v19, 0, vcc
    v_add_u32 v16, 0xd, v18
    v_and_b32 v16, 0xfffffff1, v16
    v_cmp_eq_u32 vcc, 0, v16
    s_nop 1
    v_cndmask_b32 v203, v19, 0, vcc
    s_cmp_eq_u32 s48, 0
    s_cselect_b64 vcc, -1, 0
    v_cndmask_b32 v204, v200, v19, vcc
    v_cndmask_b32 v205, v201, v19, vcc
    v_cndmask_b32 v206, v202, v19, vcc
    v_cndmask_b32 v207, v203, v19, vcc
    v_mov_b32 v208, 0x3f803f80
    v_mov_b32 v209, 0x3f803f80
    v_mov_b32 v210, 0x3f803f80
    v_mov_b32 v211, 0x3f803f80
    v_mov_b32 v184, 0
    v_mov_b32 v185, 0
    v_mov_b32 v186, 0
    v_mov_b32 v187, 0
    v_mov_b32 v188, 0
    v_mov_b32 v189, 0
    v_mov_b32 v190, 0
    v_mov_b32 v191, 0
    v_mov_b32 v192, 0
    v_mov_b32 v193, 0
    v_mov_b32 v194, 0
    v_mov_b32 v195, 0
    v_mov_b32 v32, 0
    v_mov_b32 v33, 0
    v_mov_b32 v34, 0
    v_mov_b32 v35, 0
    v_mov_b32 v36, 0
    v_mov_b32 v37, 0
    v_mov_b32 v38, 0
    v_mov_b32 v39, 0
    v_mov_b32 v40, 0
    v_mov_b32 v41, 0
    v_mov_b32 v42, 0
    v_mov_b32 v43, 0
    v_mov_b32 v44, 0
    v_mov_b32 v45, 0
    v_mov_b32 v46, 0
    v_mov_b32 v47, 0
    v_mov_b32 v48, 0
    v_mov_b32 v49, 0
    v_mov_b32 v50, 0
    v_mov_b32 v51, 0
    v_mov_b32 v52, 0
    v_mov_b32 v53, 0
    v_mov_b32 v54, 0
    v_mov_b32 v55, 0
    v_mov_b32 v56, 0
    v_mov_b32 v57, 0
    v_mov_b32 v58, 0
    v_mov_b32 v59, 0
    v_mov_b32 v60, 0
    v_mov_b32 v61, 0
    v_mov_b32 v62, 0
    v_mov_b32 v63, 0
    v_mov_b32 v64, 0
    v_mov_b32 v65, 0
    v_mov_b32 v66, 0
    v_mov_b32 v67, 0
    v_mov_b32 v68, 0
    v_mov_b32 v69, 0
    v_mov_b32 v70, 0
    v_mov_b32 v71, 0
    v_mov_b32 v72, 0
    v_mov_b32 v73, 0
    v_mov_b32 v74, 0
    v_mov_b32 v75, 0
    v_mov_b32 v76, 0
    v_mov_b32 v77, 0
    v_mov_b32 v78, 0
    v_mov_b32 v79, 0
    v_mov_b32 v80, 0
    v_mov_b32 v81, 0
    v_mov_b32 v82, 0
    v_mov_b32 v83, 0
    v_mov_b32 v84, 0
    v_mov_b32 v85, 0
    v_mov_b32 v86, 0
    v_mov_b32 v87, 0
    v_mov_b32 v88, 0
    v_mov_b32 v89, 0
    v_mov_b32 v90, 0
    v_mov_b32 v91, 0
    v_mov_b32 v92, 0
    v_mov_b32 v93, 0
    v_mov_b32 v94, 0
    v_mov_b32 v95, 0
    v_mov_b32 v96, 0
    v_mov_b32 v97, 0
    v_mov_b32 v98, 0
    v_mov_b32 v99, 0
    v_mov_b32 v100, 0
    v_mov_b32 v101, 0
    v_mov_b32 v102, 0
    v_mov_b32 v103, 0
    v_mov_b32 v104, 0
    v_mov_b32 v105, 0
    v_mov_b32 v106, 0
    v_mov_b32 v107, 0
    v_mov_b32 v108, 0
    v_mov_b32 v109, 0
    v_mov_b32 v110, 0
    v_mov_b32 v111, 0
    v_mov_b32 v112, 0
    v_mov_b32 v113, 0
    v_mov_b32 v114, 0
    v_mov_b32 v115, 0
    v_mov_b32 v116, 0
    v_mov_b32 v117, 0
    v_mov_b32 v118, 0
    v_mov_b32 v119, 0
    v_mov_b32 v120, 0
    v_mov_b32 v121, 0
    v_mov_b32 v122, 0
    v_mov_b32 v123, 0
    v_mov_b32 v124, 0
    v_mov_b32 v125, 0
    v_mov_b32 v126, 0
    v_mov_b32 v127, 0
    s_mov_b32 s50, 8192
    s_mov_b32 s58, 6144
    s_mov_b32 s51, 12288
    s_mov_b32 s59, 10240
    s_mov_b32 s52, 0
    s_mul_i32 s60, s9, 786432
    s_add_u32 s60, s60, 65273856
    s_lshl_b32 s61, s11, 10
    s_add_u32 s60, s60, s61
    s_and_b32 s61, s8, 2
    s_lshl_b32 s61, s61, 7
    s_add_u32 s60, s60, s61
    s_add_u32 s61, s60, 128
    s_mov_b32 s98, s10
    s_mov_b32 s99, s10
    s_mov_b32 s3, 0x100000
cp_1:
    s_load_dwordx8 s[64:71], s[4:5], s60 glc
    s_load_dwordx8 s[72:79], s[4:5], s61 glc
    s_sub_u32 s3, s3, 1
    s_cbranch_scc1 cp_1_ok
    s_waitcnt lgkmcnt(0)
    s_xor_b64 s[100:101], s[64:65], s[98:99]
    s_xor_b64 s[64:65], s[66:67], s[98:99]
    s_or_b64 s[100:101], s[100:101], s[64:65]
    s_xor_b64 s[64:65], s[68:69], s[98:99]
    s_or_b64 s[100:101], s[100:101], s[64:65]
    s_xor_b64 s[64:65], s[70:71], s[98:99]
    s_or_b64 s[100:101], s[100:101], s[64:65]
    s_xor_b64 s[64:65], s[72:73], s[98:99]
    s_or_b64 s[100:101], s[100:101], s[64:65]
    s_xor_b64 s[64:65], s[74:75], s[98:99]
    s_or_b64 s[100:101], s[100:101], s[64:65]
    s_xor_b64 s[64:65], s[76:77], s[98:99]
    s_or_b64 s[100:101], s[100:101], s[64:65]
    s_xor_b64 s[64:65], s[78:79], s[98:99]
    s_or_b64 s[100:101], s[100:101], s[64:65]
    s_cbranch_scc1 cp_1
cp_1_ok:
    s_waitcnt lgkmcnt(0)
    buffer_load_dwordx4 v[152:155], v6, s[16:19], 0 offen offset:0 sc1
    buffer_load_dwordx4 v[156:159], v6, s[16:19], 0 offen offset:256 sc1
    buffer_load_dwordx4 v[160:163], v6, s[20:23], 0 offen offset:0 sc1
    buffer_load_dwordx4 v[164:167], v6, s[20:23], 0 offen offset:256 sc1
    buffer_load_dwordx4 v[168:171], v6, s[16:19], 0 offen offset:2048 sc1
    buffer_load_dwordx4 v[172:175], v6, s[16:19], 0 offen offset:2304 sc1
    buffer_load_dwordx4 v[176:179], v6, s[20:23], 0 offen offset:2048 sc1
    buffer_load_dwordx4 v[180:183], v6, s[20:23], 0 offen offset:2304 sc1
    s_barrier
    ds_read_b64_tr_b16 v[128:129], v24 offset:0
    ds_read_b64_tr_b16 v[130:131], v24 offset:512
    ds_read_b64_tr_b16 v[132:133], v25 offset:0
    ds_read_b64_tr_b16 v[134:135], v25 offset:512
    ds_read_b64_tr_b16 v[136:137], v24 offset:8192
    ds_read_b64_tr_b16 v[138:139], v24 offset:8704
    ds_read_b64_tr_b16 v[140:141], v25 offset:8192
    ds_read_b64_tr_b16 v[142:143], v25 offset:8704
    ds_read_b64_tr_b16 v[144:145], v24 offset:16384
    ds_read_b64_tr_b16 v[146:147], v24 offset:16896
    buffer_load_dwordx4 a[0:3], v6, s[16:19], s54 offen offset:0 sc1
    buffer_load_dwordx4 a[4:7], v6, s[16:19], s54 offen offset:256 sc1
    buffer_load_dwordx4 a[8:11], v6, s[20:23], s54 offen offset:0 sc1
    buffer_load_dwordx4 a[12:15], v6, s[20:23], s54 offen offset:256 sc1
    buffer_load_dwordx4 a[16:19], v6, s[16:19], s54 offen offset:2048 sc1
    buffer_load_dwordx4 a[20:23], v6, s[16:19], s54 offen offset:2304 sc1
    s_mov_b32 s54, 7
.p2align 3
c_qkvA_loop:
    s_waitcnt vmcnt(12) lgkmcnt(8)
    v_mfma_f32_16x16x32_bf16 v[184:187], v[188:191], v[192:195], v[184:187]
    v_mfma_f32_16x16x32_bf16 v[32:35], v[128:131], v[152:155], v[32:35]
    ds_read_b64_tr_b16 v[148:149], v25 offset:16384
    buffer_load_dwordx4 a[24:27], v6, s[20:23], s58 offen offset:0 sc1
    v_mfma_f32_16x16x32_bf16 v[36:39], v[128:131], v[156:159], v[36:39]
    ds_read_b64_tr_b16 v[150:151], v25 offset:16896
    s_waitcnt lgkmcnt(8)
    v_mfma_f32_16x16x32_bf16 v[52:55], v[132:135], v[156:159], v[52:55]
    v_mfma_f32_16x16x32_bf16 v[48:51], v[132:135], v[152:155], v[48:51]
    ds_read_b64_tr_b16 v[188:189], v28 offset:0
    s_waitcnt lgkmcnt(7)
    v_mfma_f32_16x16x32_bf16 v[64:67], v[136:139], v[152:155], v[64:67]
    v_mfma_f32_16x16x32_bf16 v[68:71], v[136:139], v[156:159], v[68:71]
    ds_read_b64_tr_b16 v[190:191], v28 offset:512
    s_waitcnt lgkmcnt(6)
    v_mfma_f32_16x16x32_bf16 v[84:87], v[140:143], v[156:159], v[84:87]
    buffer_load_dwordx4 a[28:31], v6, s[20:23], s58 offen offset:256 sc1
    v_mfma_f32_16x16x32_bf16 v[80:83], v[140:143], v[152:155], v[80:83]
    ds_read_b128 v[192:195], v30 offset:0
    s_waitcnt lgkmcnt(5)
    v_mfma_f32_16x16x32_bf16 v[96:99], v[152:155], v[144:147], v[96:99]
    v_mfma_f32_16x16x32_bf16 v[100:103], v[156:159], v[144:147], v[100:103]
    s_waitcnt lgkmcnt(3)
    v_mfma_f32_16x16x32_bf16 v[116:119], v[156:159], v[148:151], v[116:119]
    v_mfma_f32_16x16x32_bf16 v[112:115], v[152:155], v[148:151], v[112:115]
    s_waitcnt vmcnt(12)
    v_mfma_f32_16x16x32_bf16 v[40:43], v[128:131], v[160:163], v[40:43]
    buffer_load_dwordx4 v[152:155], v6, s[16:19], s50 offen offset:0 sc1
    v_mfma_f32_16x16x32_bf16 v[44:47], v[128:131], v[164:167], v[44:47]
    v_mfma_f32_16x16x32_bf16 v[60:63], v[132:135], v[164:167], v[60:63]
    ds_read_b64_tr_b16 v[128:129], v24 offset:2048
    v_mfma_f32_16x16x32_bf16 v[56:59], v[132:135], v[160:163], v[56:59]
    ds_read_b64_tr_b16 v[130:131], v24 offset:2560
    v_mfma_f32_16x16x32_bf16 v[72:75], v[136:139], v[160:163], v[72:75]
    ds_read_b64_tr_b16 v[132:133], v25 offset:2048
    v_mfma_f32_16x16x32_bf16 v[76:79], v[136:139], v[164:167], v[76:79]
    ds_read_b64_tr_b16 v[134:135], v25 offset:2560
    v_mfma_f32_16x16x32_bf16 v[92:95], v[140:143], v[164:167], v[92:95]
    ds_read_b64_tr_b16 v[136:137], v24 offset:10240
    buffer_load_dwordx4 v[156:159], v6, s[16:19], s50 offen offset:256 sc1
    v_mfma_f32_16x16x32_bf16 v[88:91], v[140:143], v[160:163], v[88:91]
    ds_read_b64_tr_b16 v[138:139], v24 offset:10752
    v_mfma_f32_16x16x32_bf16 v[104:107], v[160:163], v[144:147], v[104:107]
    ds_read_b64_tr_b16 v[140:141], v25 offset:10240
    v_mfma_f32_16x16x32_bf16 v[108:111], v[164:167], v[144:147], v[108:111]
    ds_read_b64_tr_b16 v[142:143], v25 offset:10752
    v_mfma_f32_16x16x32_bf16 v[124:127], v[164:167], v[148:151], v[124:127]
    ds_read_b64_tr_b16 v[144:145], v24 offset:18432
    v_mfma_f32_16x16x32_bf16 v[120:123], v[160:163], v[148:151], v[120:123]
    ds_read_b64_tr_b16 v[146:147], v24 offset:18944
    s_waitcnt vmcnt(12) lgkmcnt(8)
    v_mfma_f32_16x16x32_bf16 v[184:187], v[188:191], v[192:195], v[184:187]
    v_mfma_f32_16x16x32_bf16 v[32:35], v[128:131], v[168:171], v[32:35]
    ds_read_b64_tr_b16 v[148:149], v25 offset:18432
    buffer_load_dwordx4 v[160:163], v6, s[20:23], s58 offen offset:2048 sc1
    v_mfma_f32_16x16x32_bf16 v[36:39], v[128:131], v[172:175], v[36:39]
    ds_read_b64_tr_b16 v[150:151], v25 offset:18944
    s_waitcnt lgkmcnt(8)
    v_mfma_f32_16x16x32_bf16 v[52:55], v[132:135], v[172:175], v[52:55]
    v_mfma_f32_16x16x32_bf16 v[48:51], v[132:135], v[168:171], v[48:51]
    ds_read_b64_tr_b16 v[188:189], v28 offset:2048
    s_waitcnt lgkmcnt(7)
    v_mfma_f32_16x16x32_bf16 v[64:67], v[136:139], v[168:171], v[64:67]
    v_mfma_f32_16x16x32_bf16 v[68:71], v[136:139], v[172:175], v[68:71]
    ds_read_b64_tr_b16 v[190:191], v28 offset:2560
    s_waitcnt lgkmcnt(6)
    v_mfma_f32_16x16x32_bf16 v[84:87], v[140:143], v[172:175], v[84:87]
    buffer_load_dwordx4 v[164:167], v6, s[20:23], s58 offen offset:2304 sc1
    v_mfma_f32_16x16x32_bf16 v[80:83], v[140:143], v[168:171], v[80:83]
    ds_read_b128 v[192:195], v30 offset:1024
    s_waitcnt lgkmcnt(5)
    v_mfma_f32_16x16x32_bf16 v[96:99], v[168:171], v[144:147], v[96:99]
    v_mfma_f32_16x16x32_bf16 v[100:103], v[172:175], v[144:147], v[100:103]
    s_waitcnt lgkmcnt(3)
    v_mfma_f32_16x16x32_bf16 v[116:119], v[172:175], v[148:151], v[116:119]
    v_mfma_f32_16x16x32_bf16 v[112:115], v[168:171], v[148:151], v[112:115]
    s_waitcnt vmcnt(12)
    v_mfma_f32_16x16x32_bf16 v[40:43], v[128:131], v[176:179], v[40:43]
    buffer_load_dwordx4 v[168:171], v6, s[16:19], s50 offen offset:2048 sc1
    v_mfma_f32_16x16x32_bf16 v[44:47], v[128:131], v[180:183], v[44:47]
    v_mfma_f32_16x16x32_bf16 v[60:63], v[132:135], v[180:183], v[60:63]
    ds_read_b64_tr_b16 v[128:129], v24 offset:4096
    v_mfma_f32_16x16x32_bf16 v[56:59], v[132:135], v[176:179], v[56:59]
    ds_read_b64_tr_b16 v[130:131], v24 offset:4608
    v_mfma_f32_16x16x32_bf16 v[72:75], v[136:139], v[176:179], v[72:75]
    ds_read_b64_tr_b16 v[132:133], v25 offset:4096
    v_mfma_f32_16x16x32_bf16 v[76:79], v[136:139], v[180:183], v[76:79]
    ds_read_b64_tr_b16 v[134:135], v25 offset:4608
    v_mfma_f32_16x16x32_bf16 v[92:95], v[140:143], v[180:183], v[92:95]
    ds_read_b64_tr_b16 v[136:137], v24 offset:12288
    buffer_load_dwordx4 v[172:175], v6, s[16:19], s50 offen offset:2304 sc1
    v_mfma_f32_16x16x32_bf16 v[88:91], v[140:143], v[176:179], v[88:91]
    ds_read_b64_tr_b16 v[138:139], v24 offset:12800
    v_mfma_f32_16x16x32_bf16 v[104:107], v[176:179], v[144:147], v[104:107]
    ds_read_b64_tr_b16 v[140:141], v25 offset:12288
    v_mfma_f32_16x16x32_bf16 v[108:111], v[180:183], v[144:147], v[108:111]
    ds_read_b64_tr_b16 v[142:143], v25 offset:12800
    v_mfma_f32_16x16x32_bf16 v[124:127], v[180:183], v[148:151], v[124:127]
    ds_read_b64_tr_b16 v[144:145], v24 offset:20480
    v_mfma_f32_16x16x32_bf16 v[120:123], v[176:179], v[148:151], v[120:123]
    ds_read_b64_tr_b16 v[146:147], v24 offset:20992
    s_waitcnt vmcnt(12) lgkmcnt(8)
    v_mfma_f32_16x16x32_bf16 v[184:187], v[188:191], v[192:195], v[184:187]
    v_mfma_f32_16x16x32_bf16 v[32:35], v[128:131], a[0:3], v[32:35]
    ds_read_b64_tr_b16 v[148:149], v25 offset:20480
    buffer_load_dwordx4 v[176:179], v6, s[20:23], s59 offen offset:0 sc1
    v_mfma_f32_16x16x32_bf16 v[36:39], v[128:131], a[4:7], v[36:39]
    ds_read_b64_tr_b16 v[150:151], v25 offset:20992
    s_waitcnt lgkmcnt(8)
    v_mfma_f32_16x16x32_bf16 v[52:55], v[132:135], a[4:7], v[52:55]
    s_add_u32 s58, s58, 8192
    v_mfma_f32_16x16x32_bf16 v[48:51], v[132:135], a[0:3], v[48:51]
    ds_read_b64_tr_b16 v[188:189], v28 offset:4096
    s_waitcnt lgkmcnt(7)
    v_mfma_f32_16x16x32_bf16 v[64:67], v[136:139], a[0:3], v[64:67]
    s_add_u32 s50, s50, 8192
    v_mfma_f32_16x16x32_bf16 v[68:71], v[136:139], a[4:7], v[68:71]
    ds_read_b64_tr_b16 v[190:191], v28 offset:4608
    s_waitcnt lgkmcnt(6)
    v_mfma_f32_16x16x32_bf16 v[84:87], v[140:143], a[4:7], v[84:87]
    buffer_load_dwordx4 v[180:183], v6, s[20:23], s59 offen offset:256 sc1
    v_mfma_f32_16x16x32_bf16 v[80:83], v[140:143], a[0:3], v[80:83]
    ds_read_b128 v[192:195], v30 offset:2048
    s_waitcnt lgkmcnt(5)
    v_mfma_f32_16x16x32_bf16 v[96:99], a[0:3], v[144:147], v[96:99]
    s_add_u32 s52, s52, 24576
    v_mfma_f32_16x16x32_bf16 v[100:103], a[4:7], v[144:147], v[100:103]
    s_cmp_eq_u32 s52, 147456
    s_waitcnt lgkmcnt(3)
    v_mfma_f32_16x16x32_bf16 v[116:119], a[4:7], v[148:151], v[116:119]
    s_cselect_b32 s52, 0, s52
    v_mfma_f32_16x16x32_bf16 v[112:115], a[0:3], v[148:151], v[112:115]
    s_waitcnt vmcnt(12)
    v_mfma_f32_16x16x32_bf16 v[40:43], v[128:131], a[8:11], v[40:43]
    buffer_load_dwordx4 a[0:3], v6, s[16:19], s51 offen offset:0 sc1
    v_mfma_f32_16x16x32_bf16 v[44:47], v[128:131], a[12:15], v[44:47]
    s_sub_u32 s54, s54, 1
    v_mfma_f32_16x16x32_bf16 v[60:63], v[132:135], a[12:15], v[60:63]
    ds_read_b64_tr_b16 v[128:129], v24 offset:6144
    v_mfma_f32_16x16x32_bf16 v[56:59], v[132:135], a[8:11], v[56:59]
    ds_read_b64_tr_b16 v[130:131], v24 offset:6656
    v_mfma_f32_16x16x32_bf16 v[72:75], v[136:139], a[8:11], v[72:75]
    ds_read_b64_tr_b16 v[132:133], v25 offset:6144
    v_mfma_f32_16x16x32_bf16 v[76:79], v[136:139], a[12:15], v[76:79]
    ds_read_b64_tr_b16 v[134:135], v25 offset:6656
    v_mfma_f32_16x16x32_bf16 v[92:95], v[140:143], a[12:15], v[92:95]
    ds_read_b64_tr_b16 v[136:137], v24 offset:14336
    buffer_load_dwordx4 a[4:7], v6, s[16:19], s51 offen offset:256 sc1
    v_mfma_f32_16x16x32_bf16 v[88:91], v[140:143], a[8:11], v[88:91]
    ds_read_b64_tr_b16 v[138:139], v24 offset:14848
    v_mfma_f32_16x16x32_bf16 v[104:107], a[8:11], v[144:147], v[104:107]
    ds_read_b64_tr_b16 v[140:141], v25 offset:14336
    v_mfma_f32_16x16x32_bf16 v[108:111], a[12:15], v[144:147], v[108:111]
    ds_read_b64_tr_b16 v[142:143], v25 offset:14848
    v_mfma_f32_16x16x32_bf16 v[124:127], a[12:15], v[148:151], v[124:127]
    ds_read_b64_tr_b16 v[144:145], v24 offset:22528
    v_mfma_f32_16x16x32_bf16 v[120:123], a[8:11], v[148:151], v[120:123]
    ds_read_b64_tr_b16 v[146:147], v24 offset:23040
    s_waitcnt vmcnt(12) lgkmcnt(8)
    v_mfma_f32_16x16x32_bf16 v[184:187], v[188:191], v[192:195], v[184:187]
    v_mfma_f32_16x16x32_bf16 v[32:35], v[128:131], a[16:19], v[32:35]
    ds_read_b64_tr_b16 v[148:149], v25 offset:22528
    buffer_load_dwordx4 a[8:11], v6, s[20:23], s59 offen offset:2048 sc1
    v_mfma_f32_16x16x32_bf16 v[36:39], v[128:131], a[20:23], v[36:39]
    ds_read_b64_tr_b16 v[150:151], v25 offset:23040
    s_waitcnt lgkmcnt(8)
    v_mfma_f32_16x16x32_bf16 v[52:55], v[132:135], a[20:23], v[52:55]
    v_add_u32 v24, s52, v26
    v_mfma_f32_16x16x32_bf16 v[48:51], v[132:135], a[16:19], v[48:51]
    ds_read_b64_tr_b16 v[188:189], v28 offset:6144
    s_waitcnt lgkmcnt(7)
    v_mfma_f32_16x16x32_bf16 v[64:67], v[136:139], a[16:19], v[64:67]
    v_add_u32 v25, s52, v27
    v_mfma_f32_16x16x32_bf16 v[68:71], v[136:139], a[20:23], v[68:71]
    ds_read_b64_tr_b16 v[190:191], v28 offset:6656
    s_waitcnt lgkmcnt(6)
    v_mfma_f32_16x16x32_bf16 v[84:87], v[140:143], a[20:23], v[84:87]
    buffer_load_dwordx4 a[12:15], v6, s[20:23], s59 offen offset:2304 sc1
    v_mfma_f32_16x16x32_bf16 v[80:83], v[140:143], a[16:19], v[80:83]
    ds_read_b128 v[192:195], v30 offset:3072
    s_waitcnt lgkmcnt(5)
    v_mfma_f32_16x16x32_bf16 v[96:99], a[16:19], v[144:147], v[96:99]
    s_add_u32 s59, s59, 8192
    v_mfma_f32_16x16x32_bf16 v[100:103], a[20:23], v[144:147], v[100:103]
    v_add_u32 v28, s52, v29
    s_waitcnt lgkmcnt(3)
    v_mfma_f32_16x16x32_bf16 v[116:119], a[20:23], v[148:151], v[116:119]
    s_waitcnt lgkmcnt(0)
    v_mfma_f32_16x16x32_bf16 v[112:115], a[16:19], v[148:151], v[112:115]
    s_barrier
    s_waitcnt vmcnt(12)
    v_mfma_f32_16x16x32_bf16 v[40:43], v[128:131], a[24:27], v[40:43]
    buffer_load_dwordx4 a[16:19], v6, s[16:19], s51 offen offset:2048 sc1
    v_mfma_f32_16x16x32_bf16 v[44:47], v[128:131], a[28:31], v[44:47]
    v_xor_b32 v30, 4096, v30
    v_mfma_f32_16x16x32_bf16 v[60:63], v[132:135], a[28:31], v[60:63]
    ds_read_b64_tr_b16 v[128:129], v24 offset:0
    v_mfma_f32_16x16x32_bf16 v[56:59], v[132:135], a[24:27], v[56:59]
    ds_read_b64_tr_b16 v[130:131], v24 offset:512
    v_mfma_f32_16x16x32_bf16 v[72:75], v[136:139], a[24:27], v[72:75]
    ds_read_b64_tr_b16 v[132:133], v25 offset:0
    v_mfma_f32_16x16x32_bf16 v[76:79], v[136:139], a[28:31], v[76:79]
    ds_read_b64_tr_b16 v[134:135], v25 offset:512
    v_mfma_f32_16x16x32_bf16 v[92:95], v[140:143], a[28:31], v[92:95]
    ds_read_b64_tr_b16 v[136:137], v24 offset:8192
    buffer_load_dwordx4 a[20:23], v6, s[16:19], s51 offen offset:2304 sc1
    v_mfma_f32_16x16x32_bf16 v[88:91], v[140:143], a[24:27], v[88:91]
    ds_read_b64_tr_b16 v[138:139], v24 offset:8704
    v_mfma_f32_16x16x32_bf16 v[104:107], a[24:27], v[144:147], v[104:107]
    ds_read_b64_tr_b16 v[140:141], v25 offset:8192
    s_add_u32 s51, s51, 8192
    v_mfma_f32_16x16x32_bf16 v[108:111], a[28:31], v[144:147], v[108:111]
    ds_read_b64_tr_b16 v[142:143], v25 offset:8704
    v_mfma_f32_16x16x32_bf16 v[124:127], a[28:31], v[148:151], v[124:127]
    ds_read_b64_tr_b16 v[144:145], v24 offset:16384
    s_cmp_lg_u32 s54, 0
    v_mfma_f32_16x16x32_bf16 v[120:123], a[24:27], v[148:151], v[120:123]
    ds_read_b64_tr_b16 v[146:147], v24 offset:16896
    s_cbranch_scc1 c_qkvA_loop
    s_waitcnt vmcnt(12) lgkmcnt(8)
    v_mfma_f32_16x16x32_bf16 v[184:187], v[188:191], v[192:195], v[184:187]
    v_mfma_f32_16x16x32_bf16 v[32:35], v[128:131], v[152:155], v[32:35]
    ds_read_b64_tr_b16 v[148:149], v25 offset:16384
    buffer_load_dwordx4 a[24:27], v6, s[20:23], s58 offen offset:0 sc1
    v_mfma_f32_16x16x32_bf16 v[36:39], v[128:131], v[156:159], v[36:39]
    ds_read_b64_tr_b16 v[150:151], v25 offset:16896
    s_waitcnt lgkmcnt(8)
    v_mfma_f32_16x16x32_bf16 v[52:55], v[132:135], v[156:159], v[52:55]
    ds_read_b32 v16, v8 offset:1280
    v_mfma_f32_16x16x32_bf16 v[48:51], v[132:135], v[152:155], v[48:51]
    ds_read_b64_tr_b16 v[188:189], v28 offset:0
    ds_read_b32 v18, v8 offset:1344
    s_waitcnt lgkmcnt(9)
    v_mfma_f32_16x16x32_bf16 v[64:67], v[136:139], v[152:155], v[64:67]
    ds_read_b32 v20, v8 offset:1408
    v_mfma_f32_16x16x32_bf16 v[68:71], v[136:139], v[156:159], v[68:71]
    ds_read_b64_tr_b16 v[190:191], v28 offset:512
    s_waitcnt lgkmcnt(9)
    v_mfma_f32_16x16x32_bf16 v[84:87], v[140:143], v[156:159], v[84:87]
    buffer_load_dwordx4 a[28:31], v6, s[20:23], s58 offen offset:256 sc1
    ds_read_b32 v22, v8 offset:1472
    v_mfma_f32_16x16x32_bf16 v[80:83], v[140:143], v[152:155], v[80:83]
    ds_read_b128 v[192:195], v30 offset:0
    ds_read_b128 v[212:215], v10 offset:128
    s_waitcnt lgkmcnt(10)
    v_mfma_f32_16x16x32_bf16 v[96:99], v[152:155], v[144:147], v[96:99]
    ds_read_b128 v[216:219], v10 offset:192
    v_mfma_f32_16x16x32_bf16 v[100:103], v[156:159], v[144:147], v[100:103]
    s_waitcnt lgkmcnt(9)
    v_mfma_f32_16x16x32_bf16 v[116:119], v[156:159], v[148:151], v[116:119]
    v_mfma_f32_16x16x32_bf16 v[112:115], v[152:155], v[148:151], v[112:115]
    s_waitcnt vmcnt(12)
    v_mfma_f32_16x16x32_bf16 v[40:43], v[128:131], v[160:163], v[40:43]
    s_waitcnt lgkmcnt(0)
    v_fma_f32 v64, -v16, v212, v64
    v_fma_f32 v65, -v16, v213, v65
    v_mfma_f32_16x16x32_bf16 v[44:47], v[128:131], v[164:167], v[44:47]
    v_fma_f32 v66, -v16, v214, v66
    v_mfma_f32_16x16x32_bf16 v[60:63], v[132:135], v[164:167], v[60:63]
    ds_read_b64_tr_b16 v[128:129], v24 offset:2048
    v_fma_f32 v67, -v16, v215, v67
    v_mfma_f32_16x16x32_bf16 v[56:59], v[132:135], v[160:163], v[56:59]
    ds_read_b64_tr_b16 v[130:131], v24 offset:2560
    v_fma_f32 v68, -v18, v212, v68
    v_fma_f32 v69, -v18, v213, v69
    v_mfma_f32_16x16x32_bf16 v[72:75], v[136:139], v[160:163], v[72:75]
    ds_read_b64_tr_b16 v[132:133], v25 offset:2048
    v_fma_f32 v70, -v18, v214, v70
    v_mfma_f32_16x16x32_bf16 v[76:79], v[136:139], v[164:167], v[76:79]
    ds_read_b64_tr_b16 v[134:135], v25 offset:2560
    v_fma_f32 v71, -v18, v215, v71
    v_mfma_f32_16x16x32_bf16 v[92:95], v[140:143], v[164:167], v[92:95]
    ds_read_b64_tr_b16 v[136:137], v24 offset:10240
    v_fma_f32 v80, -v16, v216, v80
    v_fma_f32 v81, -v16, v217, v81
    v_mfma_f32_16x16x32_bf16 v[88:91], v[140:143], v[160:163], v[88:91]
    ds_read_b64_tr_b16 v[138:139], v24 offset:10752
    v_fma_f32 v82, -v16, v218, v82
    v_mfma_f32_16x16x32_bf16 v[104:107], v[160:163], v[144:147], v[104:107]
    ds_read_b64_tr_b16 v[140:141], v25 offset:10240
    v_fma_f32 v83, -v16, v219, v83
    v_mfma_f32_16x16x32_bf16 v[108:111], v[164:167], v[144:147], v[108:111]
    ds_read_b64_tr_b16 v[142:143], v25 offset:10752
    v_fma_f32 v84, -v18, v216, v84
    v_fma_f32 v85, -v18, v217, v85
    v_mfma_f32_16x16x32_bf16 v[124:127], v[164:167], v[148:151], v[124:127]
    ds_read_b64_tr_b16 v[144:145], v24 offset:18432
    v_fma_f32 v86, -v18, v218, v86
    v_mfma_f32_16x16x32_bf16 v[120:123], v[160:163], v[148:151], v[120:123]
    ds_read_b64_tr_b16 v[146:147], v24 offset:18944
    v_fma_f32 v87, -v18, v219, v87
    s_waitcnt vmcnt(10) lgkmcnt(8)
    v_mfma_f32_16x16x32_bf16 v[184:187], v[188:191], v[192:195], v[184:187]
    v_mfma_f32_16x16x32_bf16 v[32:35], v[128:131], v[168:171], v[32:35]
    ds_read_b64_tr_b16 v[148:149], v25 offset:18432
    v_fma_f32 v72, -v20, v212, v72
    v_fma_f32 v73, -v20, v213, v73
    v_mfma_f32_16x16x32_bf16 v[36:39], v[128:131], v[172:175], v[36:39]
    ds_read_b64_tr_b16 v[150:151], v25 offset:18944
    v_fma_f32 v74, -v20, v214, v74
    s_waitcnt lgkmcnt(8)
    v_mfma_f32_16x16x32_bf16 v[52:55], v[132:135], v[172:175], v[52:55]
    v_fma_f32 v75, -v20, v215, v75
    ds_read_b128 v[152:155], v10 offset:0
    v_mfma_f32_16x16x32_bf16 v[48:51], v[132:135], v[168:171], v[48:51]
    ds_read_b64_tr_b16 v[188:189], v28 offset:2048
    v_fma_f32 v76, -v22, v212, v76
    v_fma_f32 v77, -v22, v213, v77
    ds_read_b128 v[156:159], v10 offset:64
    s_waitcnt lgkmcnt(9)
    v_mfma_f32_16x16x32_bf16 v[64:67], v[136:139], v[168:171], v[64:67]
    v_fma_f32 v78, -v22, v214, v78
    ds_read_b32 v17, v8 offset:2816
    v_mfma_f32_16x16x32_bf16 v[68:71], v[136:139], v[172:175], v[68:71]
    ds_read_b64_tr_b16 v[190:191], v28 offset:2560
    v_fma_f32 v79, -v22, v215, v79
    s_waitcnt lgkmcnt(9)
    v_mfma_f32_16x16x32_bf16 v[84:87], v[140:143], v[172:175], v[84:87]
    v_fma_f32 v88, -v20, v216, v88
    v_fma_f32 v89, -v20, v217, v89
    ds_read_b32 v19, v8 offset:2880
    v_mfma_f32_16x16x32_bf16 v[80:83], v[140:143], v[168:171], v[80:83]
    ds_read_b128 v[192:195], v30 offset:1024
    v_fma_f32 v90, -v20, v218, v90
    ds_read_b32 v21, v8 offset:2944
    s_waitcnt lgkmcnt(10)
    v_mfma_f32_16x16x32_bf16 v[96:99], v[168:171], v[144:147], v[96:99]
    v_fma_f32 v91, -v20, v219, v91
    ds_read_b32 v23, v8 offset:3008
    v_mfma_f32_16x16x32_bf16 v[100:103], v[172:175], v[144:147], v[100:103]
    v_fma_f32 v92, -v22, v216, v92
    v_fma_f32 v93, -v22, v217, v93
    s_waitcnt lgkmcnt(9)
    v_mfma_f32_16x16x32_bf16 v[116:119], v[172:175], v[148:151], v[116:119]
    v_fma_f32 v94, -v22, v218, v94
    v_mfma_f32_16x16x32_bf16 v[112:115], v[168:171], v[148:151], v[112:115]
    v_fma_f32 v95, -v22, v219, v95
    s_waitcnt vmcnt(8)
    v_mfma_f32_16x16x32_bf16 v[40:43], v[128:131], v[176:179], v[40:43]
    s_waitcnt lgkmcnt(0)
    v_fma_f32 v32, -v16, v152, v32
    v_fma_f32 v33, -v16, v153, v33
    v_mfma_f32_16x16x32_bf16 v[44:47], v[128:131], v[180:183], v[44:47]
    v_fma_f32 v34, -v16, v154, v34
    v_mfma_f32_16x16x32_bf16 v[60:63], v[132:135], v[180:183], v[60:63]
    ds_read_b64_tr_b16 v[128:129], v24 offset:4096
    v_fma_f32 v35, -v16, v155, v35
    v_fma_f32 v36, -v18, v152, v36
    v_mfma_f32_16x16x32_bf16 v[56:59], v[132:135], v[176:179], v[56:59]
    ds_read_b64_tr_b16 v[130:131], v24 offset:4608
    v_fma_f32 v37, -v18, v153, v37
    v_mfma_f32_16x16x32_bf16 v[72:75], v[136:139], v[176:179], v[72:75]
    ds_read_b64_tr_b16 v[132:133], v25 offset:4096
    v_fma_f32 v38, -v18, v154, v38
    v_fma_f32 v39, -v18, v155, v39
    v_mfma_f32_16x16x32_bf16 v[76:79], v[136:139], v[180:183], v[76:79]
    ds_read_b64_tr_b16 v[134:135], v25 offset:4608
    v_fma_f32 v48, -v16, v156, v48
    v_mfma_f32_16x16x32_bf16 v[92:95], v[140:143], v[180:183], v[92:95]
    ds_read_b64_tr_b16 v[136:137], v24 offset:12288
    v_fma_f32 v49, -v16, v157, v49
    v_fma_f32 v50, -v16, v158, v50
    v_mfma_f32_16x16x32_bf16 v[88:91], v[140:143], v[176:179], v[88:91]
    ds_read_b64_tr_b16 v[138:139], v24 offset:12800
    v_fma_f32 v51, -v16, v159, v51
    v_mfma_f32_16x16x32_bf16 v[104:107], v[176:179], v[144:147], v[104:107]
    ds_read_b64_tr_b16 v[140:141], v25 offset:12288
    v_fma_f32 v52, -v18, v156, v52
    v_fma_f32 v53, -v18, v157, v53
    v_mfma_f32_16x16x32_bf16 v[108:111], v[180:183], v[144:147], v[108:111]
    ds_read_b64_tr_b16 v[142:143], v25 offset:12800
    v_fma_f32 v54, -v18, v158, v54
    v_mfma_f32_16x16x32_bf16 v[124:127], v[180:183], v[148:151], v[124:127]
    ds_read_b64_tr_b16 v[144:145], v24 offset:20480
    v_fma_f32 v55, -v18, v159, v55
    v_mfma_f32_16x16x32_bf16 v[120:123], v[176:179], v[148:151], v[120:123]
    ds_read_b64_tr_b16 v[146:147], v24 offset:20992
    s_waitcnt vmcnt(6) lgkmcnt(8)
    v_mfma_f32_16x16x32_bf16 v[184:187], v[188:191], v[192:195], v[184:187]
    v_mfma_f32_16x16x32_bf16 v[32:35], v[128:131], a[0:3], v[32:35]
    ds_read_b64_tr_b16 v[148:149], v25 offset:20480
    v_fma_f32 v40, -v20, v152, v40
    v_fma_f32 v41, -v20, v153, v41
    v_mfma_f32_16x16x32_bf16 v[36:39], v[128:131], a[4:7], v[36:39]
    ds_read_b64_tr_b16 v[150:151], v25 offset:20992
    v_fma_f32 v42, -v20, v154, v42
    s_waitcnt lgkmcnt(8)
    v_mfma_f32_16x16x32_bf16 v[52:55], v[132:135], a[4:7], v[52:55]
    v_fma_f32 v43, -v20, v155, v43
    v_fma_f32 v44, -v22, v152, v44
    ds_read_b128 v[168:171], v9 offset:1280
    v_mfma_f32_16x16x32_bf16 v[48:51], v[132:135], a[0:3], v[48:51]
    ds_read_b64_tr_b16 v[188:189], v28 offset:4096
    v_fma_f32 v45, -v22, v153, v45
    ds_read_b128 v[172:175], v9 offset:1344
    s_waitcnt lgkmcnt(9)
    v_mfma_f32_16x16x32_bf16 v[64:67], v[136:139], a[0:3], v[64:67]
    v_fma_f32 v46, -v22, v154, v46
    v_fma_f32 v47, -v22, v155, v47
    v_mfma_f32_16x16x32_bf16 v[68:71], v[136:139], a[4:7], v[68:71]
    ds_read_b64_tr_b16 v[190:191], v28 offset:4608
    v_fma_f32 v56, -v20, v156, v56
    ds_read_b128 v[176:179], v9 offset:1408
    s_waitcnt lgkmcnt(9)
    v_mfma_f32_16x16x32_bf16 v[84:87], v[140:143], a[4:7], v[84:87]
    v_fma_f32 v57, -v20, v157, v57
    v_fma_f32 v58, -v20, v158, v58
    ds_read_b128 v[180:183], v9 offset:1472
    v_mfma_f32_16x16x32_bf16 v[80:83], v[140:143], a[0:3], v[80:83]
    ds_read_b128 v[192:195], v30 offset:2048
    v_fma_f32 v59, -v20, v159, v59
    s_waitcnt lgkmcnt(9)
    v_mfma_f32_16x16x32_bf16 v[96:99], a[0:3], v[144:147], v[96:99]
    v_fma_f32 v60, -v22, v156, v60
    v_fma_f32 v61, -v22, v157, v61
    ds_read2_b32 v[220:221], v11 offset0:64 offset1:80
    v_mfma_f32_16x16x32_bf16 v[100:103], a[4:7], v[144:147], v[100:103]
    v_fma_f32 v62, -v22, v158, v62
    s_waitcnt lgkmcnt(8)
    v_mfma_f32_16x16x32_bf16 v[116:119], a[4:7], v[148:151], v[116:119]
    v_fma_f32 v63, -v22, v159, v63
    v_mfma_f32_16x16x32_bf16 v[112:115], a[0:3], v[148:151], v[112:115]
    s_waitcnt vmcnt(4)
    v_mfma_f32_16x16x32_bf16 v[40:43], v[128:131], a[8:11], v[40:43]
    v_mfma_f32_16x16x32_bf16 v[44:47], v[128:131], a[12:15], v[44:47]
    s_waitcnt lgkmcnt(0)
    v_fma_f32 v96, -v168, v220, v96
    v_fma_f32 v97, -v169, v220, v97
    v_mfma_f32_16x16x32_bf16 v[60:63], v[132:135], a[12:15], v[60:63]
    ds_read_b64_tr_b16 v[128:129], v24 offset:6144
    v_fma_f32 v98, -v170, v220, v98
    v_mfma_f32_16x16x32_bf16 v[56:59], v[132:135], a[8:11], v[56:59]
    ds_read_b64_tr_b16 v[130:131], v24 offset:6656
    v_fma_f32 v99, -v171, v220, v99
    v_fma_f32 v100, -v172, v220, v100
    v_mfma_f32_16x16x32_bf16 v[72:75], v[136:139], a[8:11], v[72:75]
    ds_read_b64_tr_b16 v[132:133], v25 offset:6144
    v_fma_f32 v101, -v173, v220, v101
    v_mfma_f32_16x16x32_bf16 v[76:79], v[136:139], a[12:15], v[76:79]
    ds_read_b64_tr_b16 v[134:135], v25 offset:6656
    v_fma_f32 v102, -v174, v220, v102
    v_fma_f32 v103, -v175, v220, v103
    v_mfma_f32_16x16x32_bf16 v[92:95], v[140:143], a[12:15], v[92:95]
    ds_read_b64_tr_b16 v[136:137], v24 offset:14336
    v_fma_f32 v112, -v168, v221, v112
    v_mfma_f32_16x16x32_bf16 v[88:91], v[140:143], a[8:11], v[88:91]
    ds_read_b64_tr_b16 v[138:139], v24 offset:14848
    v_fma_f32 v113, -v169, v221, v113
    v_fma_f32 v114, -v170, v221, v114
    v_mfma_f32_16x16x32_bf16 v[104:107], a[8:11], v[144:147], v[104:107]
    ds_read_b64_tr_b16 v[140:141], v25 offset:14336
    v_fma_f32 v115, -v171, v221, v115
    v_mfma_f32_16x16x32_bf16 v[108:111], a[12:15], v[144:147], v[108:111]
    ds_read_b64_tr_b16 v[142:143], v25 offset:14848
    v_fma_f32 v116, -v172, v221, v116
    v_fma_f32 v117, -v173, v221, v117
    v_mfma_f32_16x16x32_bf16 v[124:127], a[12:15], v[148:151], v[124:127]
    ds_read_b64_tr_b16 v[144:145], v24 offset:22528
    v_fma_f32 v118, -v174, v221, v118
    v_mfma_f32_16x16x32_bf16 v[120:123], a[8:11], v[148:151], v[120:123]
    ds_read_b64_tr_b16 v[146:147], v24 offset:23040
    v_fma_f32 v119, -v175, v221, v119
    s_waitcnt vmcnt(2) lgkmcnt(8)
    v_mfma_f32_16x16x32_bf16 v[184:187], v[188:191], v[192:195], v[184:187]
    v_mfma_f32_16x16x32_bf16 v[32:35], v[128:131], a[16:19], v[32:35]
    ds_read_b64_tr_b16 v[148:149], v25 offset:22528
    v_mfma_f32_16x16x32_bf16 v[36:39], v[128:131], a[20:23], v[36:39]
    ds_read_b64_tr_b16 v[150:151], v25 offset:23040
    v_fma_f32 v104, -v176, v220, v104
    v_fma_f32 v105, -v177, v220, v105
    s_waitcnt lgkmcnt(8)
    v_mfma_f32_16x16x32_bf16 v[52:55], v[132:135], a[20:23], v[52:55]
    v_fma_f32 v106, -v178, v220, v106
    ds_read_b128 v[152:155], v9 offset:2816
    v_mfma_f32_16x16x32_bf16 v[48:51], v[132:135], a[16:19], v[48:51]
    ds_read_b64_tr_b16 v[188:189], v28 offset:6144
    v_fma_f32 v107, -v179, v220, v107
    v_fma_f32 v108, -v180, v220, v108
    ds_read_b128 v[156:159], v9 offset:2880
    s_waitcnt lgkmcnt(9)
    v_mfma_f32_16x16x32_bf16 v[64:67], v[136:139], a[16:19], v[64:67]
    v_fma_f32 v109, -v181, v220, v109
    ds_read_b128 v[160:163], v9 offset:2944
    v_mfma_f32_16x16x32_bf16 v[68:71], v[136:139], a[20:23], v[68:71]
    ds_read_b64_tr_b16 v[190:191], v28 offset:6656
    v_fma_f32 v110, -v182, v220, v110
    v_fma_f32 v111, -v183, v220, v111
    ds_read_b128 v[164:167], v9 offset:3008
    s_waitcnt lgkmcnt(10)
    v_mfma_f32_16x16x32_bf16 v[84:87], v[140:143], a[20:23], v[84:87]
    v_fma_f32 v120, -v176, v221, v120
    ds_read_b128 v[212:215], v14 offset:128
    v_mfma_f32_16x16x32_bf16 v[80:83], v[140:143], a[16:19], v[80:83]
    ds_read_b128 v[192:195], v30 offset:3072
    v_fma_f32 v121, -v177, v221, v121
    v_fma_f32 v122, -v178, v221, v122
    ds_read_b32 v222, v11 offset:1216
    s_waitcnt lgkmcnt(11)
    v_mfma_f32_16x16x32_bf16 v[96:99], a[16:19], v[144:147], v[96:99]
    v_fma_f32 v123, -v179, v221, v123
    ds_read_b32 v223, v11 offset:2752
    v_mfma_f32_16x16x32_bf16 v[100:103], a[20:23], v[144:147], v[100:103]
    v_fma_f32 v124, -v180, v221, v124
    v_fma_f32 v125, -v181, v221, v125
    s_waitcnt lgkmcnt(10)
    v_mfma_f32_16x16x32_bf16 v[116:119], a[20:23], v[148:151], v[116:119]
    v_fma_f32 v126, -v182, v221, v126
    s_waitcnt lgkmcnt(2)
    v_mfma_f32_16x16x32_bf16 v[112:115], a[16:19], v[148:151], v[112:115]
    v_fma_f32 v127, -v183, v221, v127
    s_barrier
    s_waitcnt vmcnt(0)
    v_mfma_f32_16x16x32_bf16 v[40:43], v[128:131], a[24:27], v[40:43]
    v_mul_f32 v64, v17, v64
    v_mul_f32 v65, v17, v65
    v_mfma_f32_16x16x32_bf16 v[44:47], v[128:131], a[28:31], v[44:47]
    v_mul_f32 v66, v17, v66
    v_mul_f32 v67, v17, v67
    v_mfma_f32_16x16x32_bf16 v[60:63], v[132:135], a[28:31], v[60:63]
    v_mul_f32 v80, v17, v80
    v_mul_f32 v81, v17, v81
    v_mfma_f32_16x16x32_bf16 v[56:59], v[132:135], a[24:27], v[56:59]
    v_mul_f32 v82, v17, v82
    v_mul_f32 v83, v17, v83
    v_mfma_f32_16x16x32_bf16 v[72:75], v[136:139], a[24:27], v[72:75]
    v_cvt_pk_bf16_f32 v64, v64, v65
    v_cvt_pk_bf16_f32 v65, v66, v67
    v_mfma_f32_16x16x32_bf16 v[76:79], v[136:139], a[28:31], v[76:79]
    v_cvt_pk_bf16_f32 v66, v80, v81
    v_cvt_pk_bf16_f32 v67, v82, v83
    v_mfma_f32_16x16x32_bf16 v[92:95], v[140:143], a[28:31], v[92:95]
    v_mul_f32 v68, v19, v68
    v_mul_f32 v69, v19, v69
    v_mfma_f32_16x16x32_bf16 v[88:91], v[140:143], a[24:27], v[88:91]
    v_mul_f32 v70, v19, v70
    v_mul_f32 v71, v19, v71
    v_mfma_f32_16x16x32_bf16 v[104:107], a[24:27], v[144:147], v[104:107]
    v_mul_f32 v84, v19, v84
    v_mul_f32 v85, v19, v85
    v_mfma_f32_16x16x32_bf16 v[108:111], a[28:31], v[144:147], v[108:111]
    v_mul_f32 v86, v19, v86
    v_mul_f32 v87, v19, v87
    v_mfma_f32_16x16x32_bf16 v[124:127], a[28:31], v[148:151], v[124:127]
    v_cvt_pk_bf16_f32 v68, v68, v69
    v_cvt_pk_bf16_f32 v69, v70, v71
    v_mfma_f32_16x16x32_bf16 v[120:123], a[24:27], v[148:151], v[120:123]
    v_cvt_pk_bf16_f32 v70, v84, v85
    v_cvt_pk_bf16_f32 v71, v86, v87
    v_mfma_f32_16x16x32_bf16 v[184:187], v[188:191], v[192:195], v[184:187]
    v_pk_mul_f32 v[72:73], v[20:21], v[72:73] op_sel:[1,0] op_sel_hi:[1,1]
    v_pk_mul_f32 v[74:75], v[20:21], v[74:75] op_sel:[1,0] op_sel_hi:[1,1]
    v_pk_mul_f32 v[88:89], v[20:21], v[88:89] op_sel:[1,0] op_sel_hi:[1,1]
    v_pk_mul_f32 v[90:91], v[20:21], v[90:91] op_sel:[1,0] op_sel_hi:[1,1]
    v_cvt_pk_bf16_f32 v72, v72, v73
    v_cvt_pk_bf16_f32 v73, v74, v75
    v_cvt_pk_bf16_f32 v74, v88, v89
    v_cvt_pk_bf16_f32 v75, v90, v91
    v_pk_mul_f32 v[76:77], v[22:23], v[76:77] op_sel:[1,0] op_sel_hi:[1,1]
    v_pk_mul_f32 v[78:79], v[22:23], v[78:79] op_sel:[1,0] op_sel_hi:[1,1]
    v_pk_mul_f32 v[92:93], v[22:23], v[92:93] op_sel:[1,0] op_sel_hi:[1,1]
    v_pk_mul_f32 v[94:95], v[22:23], v[94:95] op_sel:[1,0] op_sel_hi:[1,1]
    v_cvt_pk_bf16_f32 v76, v76, v77
    v_cvt_pk_bf16_f32 v77, v78, v79
    v_cvt_pk_bf16_f32 v78, v92, v93
    v_cvt_pk_bf16_f32 v79, v94, v95
    ds_write_b128 v12, v[76:79] offset:2048
    s_waitcnt lgkmcnt(1)
    v_pk_mul_f32 v[96:97], v[152:153], v[96:97]
    v_pk_mul_f32 v[98:99], v[154:155], v[98:99]
    v_pk_mul_f32 v[112:113], v[152:153], v[112:113]
    v_pk_mul_f32 v[114:115], v[154:155], v[114:115]
    v_cvt_pk_bf16_f32 v99, v98, v99
    v_cvt_pk_bf16_f32 v98, v96, v97
    v_cvt_pk_bf16_f32 v115, v114, v115
    v_cvt_pk_bf16_f32 v114, v112, v113
    v_pk_mul_f32 v[100:101], v[156:157], v[100:101]
    v_pk_mul_f32 v[102:103], v[158:159], v[102:103]
    v_pk_mul_f32 v[116:117], v[156:157], v[116:117]
    v_pk_mul_f32 v[118:119], v[158:159], v[118:119]
    v_cvt_pk_bf16_f32 v100, v100, v101
    v_cvt_pk_bf16_f32 v101, v102, v103
    v_cvt_pk_bf16_f32 v116, v116, v117
    v_cvt_pk_bf16_f32 v117, v118, v119
    v_pk_mul_f32 v[104:105], v[160:161], v[104:105]
    v_pk_mul_f32 v[106:107], v[162:163], v[106:107]
    v_pk_mul_f32 v[120:121], v[160:161], v[120:121]
    v_pk_mul_f32 v[122:123], v[162:163], v[122:123]
    v_cvt_pk_bf16_f32 v102, v104, v105
    v_cvt_pk_bf16_f32 v103, v106, v107
    v_cvt_pk_bf16_f32 v118, v120, v121
    v_cvt_pk_bf16_f32 v119, v122, v123
    v_pk_mul_f32 v[108:109], v[164:165], v[108:109]
    v_pk_mul_f32 v[110:111], v[166:167], v[110:111]
    v_pk_mul_f32 v[124:125], v[164:165], v[124:125]
    v_pk_mul_f32 v[126:127], v[166:167], v[126:127]
    v_cvt_pk_bf16_f32 v104, v108, v109
    v_cvt_pk_bf16_f32 v105, v110, v111
    v_cvt_pk_bf16_f32 v120, v124, v125
    v_cvt_pk_bf16_f32 v121, v126, v127
    ds_write_b64 v12, v[104:105] offset:3072
    ds_write_b64 v12, v[120:121] offset:3080
    v_pk_fma_f32 v[184:185], v[222:223], v[212:213], v[184:185] op_sel_hi:[0,1,1] neg_lo:[1,0,0] neg_hi:[1,0,0]
    v_pk_fma_f32 v[186:187], v[222:223], v[214:215], v[186:187] op_sel_hi:[0,1,1] neg_lo:[1,0,0] neg_hi:[1,0,0]
    v_pk_mul_f32 v[184:185], v[222:223], v[184:185] op_sel:[1,0] op_sel_hi:[1,1]
    v_pk_mul_f32 v[186:187], v[222:223], v[186:187] op_sel:[1,0] op_sel_hi:[1,1]
    v_cvt_pk_bf16_f32 v184, v184, v185
    v_cvt_pk_bf16_f32 v185, v186, v187
    s_cmp_ge_u32 s8, 2
    s_cbranch_scc1 c_qkvA_hv
    ds_write_b64 v13, v[184:185]
    s_branch c_qkvA_hd
c_qkvA_hv:
    ds_write_b16 v13, v184 offset:0
    ds_write_b16_d16_hi v13, v184 offset:16
    ds_write_b16 v13, v185 offset:32
    ds_write_b16_d16_hi v13, v185 offset:48
c_qkvA_hd:
    v_cvt_pk_bf16_f32 v44, v44, v45
    v_cvt_pk_bf16_f32 v45, v46, v47
    v_cvt_pk_bf16_f32 v46, v60, v61
    v_cvt_pk_bf16_f32 v47, v62, v63
    v_mul_f32 v23, 0x3e8293ee, v23
    v_cvt_pk_bf16_f32 v40, v40, v41
    v_mfma_f32_16x16x32_bf16 v[156:159], v[76:79], v[44:47], v[196:199]
    v_cvt_pk_bf16_f32 v41, v42, v43
    v_cvt_pk_bf16_f32 v42, v56, v57
    v_mfma_f32_16x16x32_bf16 v[152:155], v[72:75], v[44:47], v[200:203]
    v_cvt_pk_bf16_f32 v43, v58, v59
    v_mul_f32 v21, 0x3e8293ee, v21
    s_waitcnt lgkmcnt(0)
    s_barrier
    ds_read_b128 v[172:175], v12
    ds_read_b64 v[96:97], v12 offset:1024
    ds_read_b64 v[112:113], v12 offset:1032
    v_mfma_f32_16x16x32_bf16 v[148:151], v[72:75], v[40:43], v[196:199]
    v_cvt_pk_bf16_f32 v36, v36, v37
    v_cvt_pk_bf16_f32 v37, v38, v39
    v_mfma_f32_16x16x32_bf16 v[144:147], v[68:71], v[40:43], v[200:203]
    v_cvt_pk_bf16_f32 v38, v52, v53
    v_cvt_pk_bf16_f32 v39, v54, v55
    v_mul_f32 v19, 0x3e8293ee, v19
    v_cvt_pk_bf16_f32 v32, v32, v33
    v_mfma_f32_16x16x32_bf16 v[140:143], v[68:71], v[36:39], v[196:199]
    v_cvt_pk_bf16_f32 v33, v34, v35
    v_cvt_pk_bf16_f32 v34, v48, v49
    v_mfma_f32_16x16x32_bf16 v[136:139], v[64:67], v[36:39], v[200:203]
    v_cvt_pk_bf16_f32 v35, v50, v51
    v_mul_f32 v17, 0x3e8293ee, v17
    v_max3_f32 v179, v152, v153, v154
    s_waitcnt lgkmcnt(2)
    v_mfma_f32_16x16x32_bf16 v[132:135], v[64:67], v[32:35], v[196:199]
    v_max3_f32 v179, v179, v155, v156
    v_max3_f32 v179, v179, v157, v158
    v_mfma_f32_16x16x32_bf16 v[128:131], v[172:175], v[32:35], v[204:207]
    v_max_f32 v179, v179, v159
    v_mov_b32 v183, v179
    v_max3_f32 v178, v144, v145, v146
    v_max3_f32 v178, v178, v147, v148
    v_max3_f32 v178, v178, v149, v150
    v_max_f32 v178, v178, v151
    v_mov_b32 v182, v178
    v_max3_f32 v177, v136, v137, v138
    v_max3_f32 v177, v177, v139, v140
    v_max3_f32 v177, v177, v141, v142
    v_max_f32 v177, v177, v143
    v_mov_b32 v181, v177
    v_permlane32_swap_b32 v179, v183
    v_permlane32_swap_b32 v178, v182
    v_permlane32_swap_b32 v177, v181
    v_max3_f32 v176, v128, v129, v130
    v_max3_f32 v176, v176, v131, v132
    v_max3_f32 v176, v176, v133, v134
    v_max_f32 v176, v176, v135
    v_mov_b32 v180, v176
    v_max_f32 v179, v179, v183
    v_max_f32 v178, v178, v182
    v_max_f32 v177, v177, v181
    v_permlane32_swap_b32 v176, v180
    v_mov_b32 v183, v179
    v_mov_b32 v182, v178
    v_mov_b32 v181, v177
    v_max_f32 v176, v176, v180
    v_mov_b32 v180, v176
    v_permlane16_swap_b32 v179, v183
    v_permlane16_swap_b32 v178, v182
    v_permlane16_swap_b32 v177, v181
    v_permlane16_swap_b32 v176, v180
    v_max_f32 v179, v179, v183
    v_max_f32 v178, v178, v182
    v_max_f32 v177, v177, v181
    v_max_f32 v176, v176, v180
    v_mul_f32_e64 v22, -v179, v23
    v_mul_f32_e64 v20, -v178, v21
    v_mul_f32_e64 v18, -v177, v19
    v_mul_f32_e64 v16, -v176, v17
    s_waitcnt lgkmcnt(0)
    s_add_u32 s51, s49, 65536
    v_pk_fma_f32 v[152:153], v[152:153], v[22:23], v[22:23] op_sel:[0,1,0] op_sel_hi:[1,1,0]
    v_pk_fma_f32 v[154:155], v[154:155], v[22:23], v[22:23] op_sel:[0,1,0] op_sel_hi:[1,1,0]
    v_pk_fma_f32 v[156:157], v[156:157], v[22:23], v[22:23] op_sel:[0,1,0] op_sel_hi:[1,1,0]
    v_pk_fma_f32 v[158:159], v[158:159], v[22:23], v[22:23] op_sel:[0,1,0] op_sel_hi:[1,1,0]
    v_pk_fma_f32 v[144:145], v[144:145], v[20:21], v[20:21] op_sel:[0,1,0] op_sel_hi:[1,1,0]
    v_pk_fma_f32 v[146:147], v[146:147], v[20:21], v[20:21] op_sel:[0,1,0] op_sel_hi:[1,1,0]
    v_pk_fma_f32 v[148:149], v[148:149], v[20:21], v[20:21] op_sel:[0,1,0] op_sel_hi:[1,1,0]
    v_pk_fma_f32 v[150:151], v[150:151], v[20:21], v[20:21] op_sel:[0,1,0] op_sel_hi:[1,1,0]
    v_pk_fma_f32 v[136:137], v[136:137], v[18:19], v[18:19] op_sel:[0,1,0] op_sel_hi:[1,1,0]
    v_pk_fma_f32 v[138:139], v[138:139], v[18:19], v[18:19] op_sel:[0,1,0] op_sel_hi:[1,1,0]
    v_pk_fma_f32 v[140:141], v[140:141], v[18:19], v[18:19] op_sel:[0,1,0] op_sel_hi:[1,1,0]
    v_pk_fma_f32 v[142:143], v[142:143], v[18:19], v[18:19] op_sel:[0,1,0] op_sel_hi:[1,1,0]
    v_pk_fma_f32 v[128:129], v[128:129], v[16:17], v[16:17] op_sel:[0,1,0] op_sel_hi:[1,1,0]
    v_pk_fma_f32 v[130:131], v[130:131], v[16:17], v[16:17] op_sel:[0,1,0] op_sel_hi:[1,1,0]
    v_pk_fma_f32 v[132:133], v[132:133], v[16:17], v[16:17] op_sel:[0,1,0] op_sel_hi:[1,1,0]
    v_pk_fma_f32 v[134:135], v[134:135], v[16:17], v[16:17] op_sel:[0,1,0] op_sel_hi:[1,1,0]
    v_exp_f32 v152, v152
    v_exp_f32 v153, v153
    v_exp_f32 v154, v154
    v_exp_f32 v155, v155
    v_exp_f32 v156, v156
    v_exp_f32 v157, v157
    v_exp_f32 v158, v158
    v_exp_f32 v159, v159
    v_cvt_pk_bf16_f32 v172, v152, v153
    v_cvt_pk_bf16_f32 v173, v154, v155
    v_cvt_pk_bf16_f32 v174, v156, v157
    v_cvt_pk_bf16_f32 v175, v158, v159
    v_exp_f32 v144, v144
    v_exp_f32 v145, v145
    v_mfma_f32_16x16x32_bf16 v[92:95], v[208:211], v[172:175], 0
    v_exp_f32 v146, v146
    v_mfma_f32_16x16x32_bf16 v[60:63], v[102:105], v[172:175], 0
    v_exp_f32 v147, v147
    v_mfma_f32_16x16x32_bf16 v[76:79], v[118:121], v[172:175], 0
    v_exp_f32 v148, v148
    v_exp_f32 v149, v149
    v_exp_f32 v150, v150
    v_exp_f32 v151, v151
    v_rcp_f32 v92, v92
    v_cvt_pk_bf16_f32 v168, v144, v145
    v_cvt_pk_bf16_f32 v169, v146, v147
    v_cvt_pk_bf16_f32 v170, v148, v149
    v_cvt_pk_bf16_f32 v171, v150, v151
    v_pk_mul_f32 v[60:61], v[92:93], v[60:61] op_sel_hi:[0,1]
    v_pk_mul_f32 v[62:63], v[92:93], v[62:63] op_sel_hi:[0,1]
    v_pk_mul_f32 v[76:77], v[92:93], v[76:77] op_sel_hi:[0,1]
    v_pk_mul_f32 v[78:79], v[92:93], v[78:79] op_sel_hi:[0,1]
    v_cvt_pk_bf16_f32 v60, v60, v61
    v_cvt_pk_bf16_f32 v61, v62, v63
    v_cvt_pk_bf16_f32 v62, v76, v77
    v_cvt_pk_bf16_f32 v63, v78, v79
    buffer_store_dwordx4 v[60:63], v6, s[12:15], s51 offen offset:256 sc1
    v_exp_f32 v136, v136
    v_exp_f32 v137, v137
    v_mfma_f32_16x16x32_bf16 v[88:91], v[208:211], v[168:171], 0
    v_exp_f32 v138, v138
    v_mfma_f32_16x16x32_bf16 v[56:59], v[100:103], v[168:171], 0
    v_exp_f32 v139, v139
    v_mfma_f32_16x16x32_bf16 v[72:75], v[116:119], v[168:171], 0
    v_exp_f32 v140, v140
    v_exp_f32 v141, v141
    v_exp_f32 v142, v142
    v_exp_f32 v143, v143
    v_rcp_f32 v88, v88
    v_cvt_pk_bf16_f32 v164, v136, v137
    v_cvt_pk_bf16_f32 v165, v138, v139
    v_cvt_pk_bf16_f32 v166, v140, v141
    v_cvt_pk_bf16_f32 v167, v142, v143
    v_pk_mul_f32 v[56:57], v[88:89], v[56:57] op_sel_hi:[0,1]
    v_pk_mul_f32 v[58:59], v[88:89], v[58:59] op_sel_hi:[0,1]
    v_pk_mul_f32 v[72:73], v[88:89], v[72:73] op_sel_hi:[0,1]
    v_pk_mul_f32 v[74:75], v[88:89], v[74:75] op_sel_hi:[0,1]
    v_cvt_pk_bf16_f32 v56, v56, v57
    v_cvt_pk_bf16_f32 v57, v58, v59
    v_cvt_pk_bf16_f32 v58, v72, v73
    v_cvt_pk_bf16_f32 v59, v74, v75
    buffer_store_dwordx4 v[56:59], v6, s[12:15], s51 offen offset:0 sc1
    v_exp_f32 v128, v128
    v_exp_f32 v129, v129
    v_mfma_f32_16x16x32_bf16 v[84:87], v[208:211], v[164:167], 0
    v_exp_f32 v130, v130
    v_mfma_f32_16x16x32_bf16 v[52:55], v[98:101], v[164:167], 0
    v_exp_f32 v131, v131
    v_mfma_f32_16x16x32_bf16 v[68:71], v[114:117], v[164:167], 0
    v_exp_f32 v132, v132
    v_exp_f32 v133, v133
    v_exp_f32 v134, v134
    v_exp_f32 v135, v135
    v_rcp_f32 v84, v84
    v_cvt_pk_bf16_f32 v160, v128, v129
    v_cvt_pk_bf16_f32 v161, v130, v131
    v_cvt_pk_bf16_f32 v162, v132, v133
    v_cvt_pk_bf16_f32 v163, v134, v135
    v_pk_mul_f32 v[52:53], v[84:85], v[52:53] op_sel_hi:[0,1]
    v_pk_mul_f32 v[54:55], v[84:85], v[54:55] op_sel_hi:[0,1]
    v_mfma_f32_16x16x32_bf16 v[80:83], v[208:211], v[160:163], 0
    v_pk_mul_f32 v[68:69], v[84:85], v[68:69] op_sel_hi:[0,1]
    v_pk_mul_f32 v[70:71], v[84:85], v[70:71] op_sel_hi:[0,1]
    v_mfma_f32_16x16x32_bf16 v[48:51], v[96:99], v[160:163], 0
    v_cvt_pk_bf16_f32 v52, v52, v53
    v_cvt_pk_bf16_f32 v53, v54, v55
    v_mfma_f32_16x16x32_bf16 v[64:67], v[112:115], v[160:163], 0
    v_cvt_pk_bf16_f32 v54, v68, v69
    v_cvt_pk_bf16_f32 v55, v70, v71
    buffer_store_dwordx4 v[52:55], v6, s[12:15], s49 offen offset:256 sc1
    v_rcp_f32 v80, v80
    s_nop 0
    v_pk_mul_f32 v[48:49], v[80:81], v[48:49] op_sel_hi:[0,1]
    v_pk_mul_f32 v[50:51], v[80:81], v[50:51] op_sel_hi:[0,1]
    s_nop 0
    v_pk_mul_f32 v[64:65], v[80:81], v[64:65] op_sel_hi:[0,1]
    v_pk_mul_f32 v[66:67], v[80:81], v[66:67] op_sel_hi:[0,1]
    v_cvt_pk_bf16_f32 v48, v48, v49
    v_cvt_pk_bf16_f32 v49, v50, v51
    v_cvt_pk_bf16_f32 v50, v64, v65
    v_cvt_pk_bf16_f32 v51, v66, v67
    buffer_store_dwordx4 v[48:51], v6, s[12:15], s49 offen offset:0 sc1
    s_branch c_wo
.p2align 6
c_wo:
    v_and_b32 v1, 63, v0
    v_lshrrev_b32 v2, 6, v0
    v_lshlrev_b32 v5, 4, v1
    v_lshrrev_b32 v3, 5, v1
    s_lshl_b32 s48, s6, 2
    s_add_u32 s48, s48, s8
    s_lshl_b32 s55, s48, 16
    s_lshl_b32 s56, s9, 22
    s_add_u32 s55, s55, s56
    s_lshl_b32 s56, s7, 12
    s_add_u32 s58, s55, s56
    s_add_u32 s55, s55, 16777216
    s_add_u32 s16, s4, s55
    s_addc_u32 s17, s5, 0
    s_mov_b32 s18, 65536
    s_mov_b32 s19, 0x00020000
    s_lshl_b32 s60, s9, 2
    s_add_u32 s60, s60, 159504
    v_mov_b32 v28, s60
    s_mul_i32 s55, s9, 786432
    s_add_u32 s55, s55, 65798144
    v_and_b32 v24, 63, v0
    s_and_b32 s56, s11, 0xe0
    v_lshrrev_b32 v25, 5, v24
    v_add_u32 v24, s56, v24
    v_and_b32 v24, 255, v24
    v_lshlrev_b32 v24, 10, v24
    v_lshl_add_u32 v24, v25, 8, v24
    s_bfe_u32 s56, s11, 0x20003
    s_and_b32 s57, s11, 7
    s_lshl_b32 s56, s56, 7
    s_lshl_b32 s57, s57, 2
    s_add_u32 s55, s55, s56
    s_add_u32 s55, s55, s57
    v_mov_b32 v25, 159488
    v_mov_b32 v26, 1
    v_mov_b32 v27, s10
    v_and_b32 v4, 15, v0
    v_bfe_u32 v17, v1, 4, 1
    v_lshl_add_u32 v6, v17, 5, v4
    v_lshlrev_b32 v6, 4, v6
    v_lshl_add_u32 v6, v3, 10, v6
    v_lshrrev_b32 v16, 2, v4
    v_lshl_add_u32 v16, v17, 2, v16
    v_lshl_add_u32 v16, v3, 4, v16
    v_lshlrev_b32 v16, 7, v16
    v_and_b32 v18, 3, v4
    v_lshl_add_u32 v16, v18, 3, v16
    v_lshrrev_b32 v18, 3, v4
    v_lshl_add_u32 v18, v18, 1, v17
    v_lshl_add_u32 v12, v18, 5, v16
    ds_read_b32 v29, v28
    buffer_load_dwordx4 v[96:99], v6, s[12:15], s58 offen offset:0 sc1
    buffer_load_dwordx4 v[100:103], v6, s[12:15], s58 offen offset:256 sc1
    buffer_load_dwordx4 v[104:107], v6, s[12:15], s58 offen offset:2048 sc1
    buffer_load_dwordx4 v[108:111], v6, s[12:15], s58 offen offset:2304 sc1
    s_waitcnt lgkmcnt(0)
    v_readfirstlane_b32 s60, v29
    s_lshr_b32 s51, s60, 2
    s_and_b32 s51, s51, s60
    s_and_b32 s51, s51, 3
    s_cmp_eq_u32 s51, 0
    s_cbranch_scc1 c_wo_late
    s_and_b32 s52, s51, 1
    s_xor_b32 s52, s52, 1
    s_lshl_b32 s50, s52, 15
    buffer_load_dwordx4 v[112:115], v6, s[16:19], s50 offen offset:0 sc1
    buffer_load_dwordx4 v[116:119], v6, s[16:19], s50 offen offset:256 sc1
    buffer_load_dwordx4 v[120:123], v6, s[16:19], s50 offen offset:2048 sc1
    buffer_load_dwordx4 v[124:127], v6, s[16:19], s50 offen offset:2304 sc1
    s_add_u32 s50, s50, 4096
    buffer_load_dwordx4 v[128:131], v6, s[16:19], s50 offen offset:0 sc1
    s_mov_b64 exec, 1
    s_waitcnt vmcnt(9)
    ds_add_rtn_u32 v26, v25, v26
    s_waitcnt lgkmcnt(0)
    v_readfirstlane_b32 s56, v26
    s_and_b32 s56, s56, 3
    s_cmp_lg_u32 s56, 3
    s_cbranch_scc1 pub_2
    s_mov_b32 exec_lo, -1
    buffer_store_dword v27, v24, s[12:15], s55 offen sc1
pub_2:
    s_mov_b64 exec, -1
    s_branch c_wo_run
c_wo_late:
    s_mov_b64 exec, 1
    s_waitcnt vmcnt(4)
    ds_add_rtn_u32 v26, v25, v26
    s_waitcnt lgkmcnt(0)
    v_readfirstlane_b32 s56, v26
    s_and_b32 s56, s56, 3
    s_cmp_lg_u32 s56, 3
    s_cbranch_scc1 pub_3
    s_mov_b32 exec_lo, -1
    buffer_store_dword v27, v24, s[12:15], s55 offen sc1
pub_3:
    s_mov_b64 exec, -1
    s_branch wp_4_t
wp_4:
    ds_read_b32 v29, v28
    s_waitcnt lgkmcnt(0)
    v_readfirstlane_b32 s60, v29
    s_lshr_b32 s51, s60, 2
    s_and_b32 s51, s51, s60
    s_and_b32 s51, s51, 3
wp_4_t:
    s_cmp_lg_u32 s51, 0
    s_cbranch_scc0 wp_4
    s_and_b32 s52, s51, 1
    s_xor_b32 s52, s52, 1
    s_lshl_b32 s50, s52, 15
    buffer_load_dwordx4 v[112:115], v6, s[16:19], s50 offen offset:0 sc1
    buffer_load_dwordx4 v[116:119], v6, s[16:19], s50 offen offset:256 sc1
    buffer_load_dwordx4 v[120:123], v6, s[16:19], s50 offen offset:2048 sc1
    buffer_load_dwordx4 v[124:127], v6, s[16:19], s50 offen offset:2304 sc1
    s_add_u32 s50, s50, 4096
    buffer_load_dwordx4 v[128:131], v6, s[16:19], s50 offen offset:0 sc1
c_wo_run:
    buffer_load_dwordx4 v[132:135], v6, s[16:19], s50 offen offset:256 sc1
    buffer_load_dwordx4 v[136:139], v6, s[16:19], s50 offen offset:2048 sc1
    buffer_load_dwordx4 v[140:143], v6, s[16:19], s50 offen offset:2304 sc1
    s_add_u32 s50, s50, 4096
    s_lshl_b32 s3, s52, 16
    v_add_u32 v12, s3, v12
    v_xor_b32 v13, 32, v12
    v_xor_b32 v14, 64, v12
    v_xor_b32 v15, 96, v12
    s_cmp_eq_u32 s52, 0
    s_mov_b32 s3, 0x0c0c0c0c
    s_cselect_b32 s53, 0x01000c0c, s3
    s_cselect_b32 s54, 0x03020c0c, s3
    s_cselect_b32 s59, s3, 0x01000c0c
    s_cselect_b32 s97, s3, 0x03020c0c
    s_branch wp_5_t
wp_5:
    ds_read_b32 v29, v28
    s_waitcnt lgkmcnt(0)
    v_readfirstlane_b32 s60, v29
    s_lshr_b32 s51, s60, 2
    s_and_b32 s51, s51, s60
    s_and_b32 s51, s51, 3
wp_5_t:
    s_cmp_ge_u32 s60, 0xf0
    s_cbranch_scc0 wp_5
    ds_read_b64_tr_b16 v[64:65], v12 offset:0
    ds_read_b64_tr_b16 v[66:67], v12 offset:1024
    ds_read_b64_tr_b16 v[68:69], v13 offset:0
    ds_read_b64_tr_b16 v[70:71], v13 offset:1024
    ds_read_b64_tr_b16 v[72:73], v14 offset:0
    ds_read_b64_tr_b16 v[74:75], v14 offset:1024
    ds_read_b64_tr_b16 v[76:77], v15 offset:0
    ds_read_b64_tr_b16 v[78:79], v15 offset:1024
    ds_read_b64_tr_b16 v[80:81], v12 offset:4096
    ds_read_b64_tr_b16 v[82:83], v12 offset:5120
    ds_read_b64_tr_b16 v[84:85], v13 offset:4096
    ds_read_b64_tr_b16 v[86:87], v13 offset:5120
    ds_read_b64_tr_b16 v[88:89], v14 offset:4096
    ds_read_b64_tr_b16 v[90:91], v14 offset:5120
    s_waitcnt vmcnt(8)
    v_perm_b32 v32, v96, v96, s53
    v_perm_b32 v33, v96, v96, s54
    v_perm_b32 v34, v97, v97, s53
    v_perm_b32 v35, v97, v97, s54
    v_perm_b32 v36, v98, v98, s53
    v_perm_b32 v37, v98, v98, s54
    v_perm_b32 v38, v99, v99, s53
    v_perm_b32 v39, v99, v99, s54
    v_perm_b32 v40, v100, v100, s53
    v_perm_b32 v41, v100, v100, s54
    v_perm_b32 v42, v101, v101, s53
    v_perm_b32 v43, v101, v101, s54
    v_perm_b32 v44, v102, v102, s53
    v_perm_b32 v45, v102, v102, s54
    v_perm_b32 v46, v103, v103, s53
    v_perm_b32 v47, v103, v103, s54
    v_perm_b32 v48, v104, v104, s53
    v_perm_b32 v49, v104, v104, s54
    v_perm_b32 v50, v105, v105, s53
    v_perm_b32 v51, v105, v105, s54
    v_perm_b32 v52, v106, v106, s53
    v_perm_b32 v53, v106, v106, s54
    v_perm_b32 v54, v107, v107, s53
    v_perm_b32 v55, v107, v107, s54
    v_perm_b32 v56, v108, v108, s53
    v_perm_b32 v57, v108, v108, s54
    v_perm_b32 v58, v109, v109, s53
    v_perm_b32 v59, v109, v109, s54
    v_perm_b32 v60, v110, v110, s53
    v_perm_b32 v61, v110, v110, s54
    v_perm_b32 v62, v111, v111, s53
    v_perm_b32 v63, v111, v111, s54
    buffer_load_dwordx4 v[144:147], v6, s[16:19], s50 offen offset:0 sc1
    buffer_load_dwordx4 v[148:151], v6, s[16:19], s50 offen offset:256 sc1
    buffer_load_dwordx4 v[152:155], v6, s[16:19], s50 offen offset:2048 sc1
    buffer_load_dwordx4 v[156:159], v6, s[16:19], s50 offen offset:2304 sc1
    s_add_u32 s50, s50, 4096
    buffer_load_dwordx4 v[160:163], v6, s[16:19], s50 offen offset:0 sc1
    buffer_load_dwordx4 v[164:167], v6, s[16:19], s50 offen offset:256 sc1
    s_waitcnt vmcnt(12) lgkmcnt(10)
    v_mfma_f32_16x16x32_bf16 v[32:35], v[64:67], v[112:115], v[32:35]
    ds_read_b64_tr_b16 v[92:93], v15 offset:4096
    v_mfma_f32_16x16x32_bf16 v[40:43], v[64:67], v[116:119], v[40:43]
    ds_read_b64_tr_b16 v[94:95], v15 offset:5120
    v_perm_b32 v176, v96, v96, s59
    v_mfma_f32_16x16x32_bf16 v[44:47], v[68:71], v[116:119], v[44:47]
    ds_read_b64_tr_b16 v[64:65], v12 offset:8192
    buffer_load_dwordx4 v[168:171], v6, s[16:19], s50 offen offset:2048 sc1
    v_mfma_f32_16x16x32_bf16 v[36:39], v[68:71], v[112:115], v[36:39]
    ds_read_b64_tr_b16 v[66:67], v12 offset:9216
    v_perm_b32 v177, v96, v96, s97
    s_waitcnt lgkmcnt(10)
    v_mfma_f32_16x16x32_bf16 v[48:51], v[72:75], v[112:115], v[48:51]
    ds_read_b64_tr_b16 v[68:69], v13 offset:8192
    v_mfma_f32_16x16x32_bf16 v[56:59], v[72:75], v[116:119], v[56:59]
    ds_read_b64_tr_b16 v[70:71], v13 offset:9216
    v_perm_b32 v178, v97, v97, s59
    v_mfma_f32_16x16x32_bf16 v[60:63], v[76:79], v[116:119], v[60:63]
    ds_read_b64_tr_b16 v[72:73], v14 offset:8192
    buffer_load_dwordx4 v[172:175], v6, s[16:19], s50 offen offset:2304 sc1
    s_add_u32 s50, s50, 4096
    v_mfma_f32_16x16x32_bf16 v[52:55], v[76:79], v[112:115], v[52:55]
    ds_read_b64_tr_b16 v[74:75], v14 offset:9216
    s_waitcnt vmcnt(12) lgkmcnt(10)
    v_mfma_f32_16x16x32_bf16 v[32:35], v[80:83], v[120:123], v[32:35]
    ds_read_b64_tr_b16 v[76:77], v15 offset:8192
    v_mfma_f32_16x16x32_bf16 v[40:43], v[80:83], v[124:127], v[40:43]
    ds_read_b64_tr_b16 v[78:79], v15 offset:9216
    v_perm_b32 v179, v97, v97, s97
    v_mfma_f32_16x16x32_bf16 v[44:47], v[84:87], v[124:127], v[44:47]
    ds_read_b64_tr_b16 v[80:81], v12 offset:12288
    buffer_load_dwordx4 v[112:115], v6, s[16:19], s50 offen offset:0 sc1
    v_mfma_f32_16x16x32_bf16 v[36:39], v[84:87], v[120:123], v[36:39]
    ds_read_b64_tr_b16 v[82:83], v12 offset:13312
    v_perm_b32 v180, v98, v98, s59
    s_waitcnt lgkmcnt(10)
    v_mfma_f32_16x16x32_bf16 v[48:51], v[88:91], v[120:123], v[48:51]
    ds_read_b64_tr_b16 v[84:85], v13 offset:12288
    v_mfma_f32_16x16x32_bf16 v[56:59], v[88:91], v[124:127], v[56:59]
    ds_read_b64_tr_b16 v[86:87], v13 offset:13312
    v_perm_b32 v181, v98, v98, s97
    v_mfma_f32_16x16x32_bf16 v[60:63], v[92:95], v[124:127], v[60:63]
    ds_read_b64_tr_b16 v[88:89], v14 offset:12288
    buffer_load_dwordx4 v[116:119], v6, s[16:19], s50 offen offset:256 sc1
    v_mfma_f32_16x16x32_bf16 v[52:55], v[92:95], v[120:123], v[52:55]
    ds_read_b64_tr_b16 v[90:91], v14 offset:13312
    s_waitcnt vmcnt(12) lgkmcnt(10)
    v_mfma_f32_16x16x32_bf16 v[32:35], v[64:67], v[128:131], v[32:35]
    ds_read_b64_tr_b16 v[92:93], v15 offset:12288
    v_mfma_f32_16x16x32_bf16 v[40:43], v[64:67], v[132:135], v[40:43]
    ds_read_b64_tr_b16 v[94:95], v15 offset:13312
    v_perm_b32 v182, v99, v99, s59
    v_mfma_f32_16x16x32_bf16 v[44:47], v[68:71], v[132:135], v[44:47]
    ds_read_b64_tr_b16 v[64:65], v12 offset:16384
    buffer_load_dwordx4 v[120:123], v6, s[16:19], s50 offen offset:2048 sc1
    v_mfma_f32_16x16x32_bf16 v[36:39], v[68:71], v[128:131], v[36:39]
    ds_read_b64_tr_b16 v[66:67], v12 offset:17408
    v_perm_b32 v183, v99, v99, s97
    s_waitcnt lgkmcnt(10)
    v_mfma_f32_16x16x32_bf16 v[48:51], v[72:75], v[128:131], v[48:51]
    ds_read_b64_tr_b16 v[68:69], v13 offset:16384
    v_mfma_f32_16x16x32_bf16 v[56:59], v[72:75], v[132:135], v[56:59]
    ds_read_b64_tr_b16 v[70:71], v13 offset:17408
    v_perm_b32 v184, v100, v100, s59
    v_mfma_f32_16x16x32_bf16 v[60:63], v[76:79], v[132:135], v[60:63]
    ds_read_b64_tr_b16 v[72:73], v14 offset:16384
    buffer_load_dwordx4 v[124:127], v6, s[16:19], s50 offen offset:2304 sc1
    s_add_u32 s50, s50, 4096
    v_mfma_f32_16x16x32_bf16 v[52:55], v[76:79], v[128:131], v[52:55]
    ds_read_b64_tr_b16 v[74:75], v14 offset:17408
    s_waitcnt vmcnt(12) lgkmcnt(10)
    v_mfma_f32_16x16x32_bf16 v[32:35], v[80:83], v[136:139], v[32:35]
    ds_read_b64_tr_b16 v[76:77], v15 offset:16384
    v_mfma_f32_16x16x32_bf16 v[40:43], v[80:83], v[140:143], v[40:43]
    ds_read_b64_tr_b16 v[78:79], v15 offset:17408
    v_perm_b32 v185, v100, v100, s97
    v_mfma_f32_16x16x32_bf16 v[44:47], v[84:87], v[140:143], v[44:47]
    ds_read_b64_tr_b16 v[80:81], v12 offset:20480
    buffer_load_dwordx4 v[128:131], v6, s[16:19], s50 offen offset:0 sc1
    v_mfma_f32_16x16x32_bf16 v[36:39], v[84:87], v[136:139], v[36:39]
    ds_read_b64_tr_b16 v[82:83], v12 offset:21504
    v_perm_b32 v186, v101, v101, s59
    s_waitcnt lgkmcnt(10)
    v_mfma_f32_16x16x32_bf16 v[48:51], v[88:91], v[136:139], v[48:51]
    ds_read_b64_tr_b16 v[84:85], v13 offset:20480
    v_mfma_f32_16x16x32_bf16 v[56:59], v[88:91], v[140:143], v[56:59]
    ds_read_b64_tr_b16 v[86:87], v13 offset:21504
    v_perm_b32 v187, v101, v101, s97
    v_mfma_f32_16x16x32_bf16 v[60:63], v[92:95], v[140:143], v[60:63]
    ds_read_b64_tr_b16 v[88:89], v14 offset:20480
    buffer_load_dwordx4 v[132:135], v6, s[16:19], s50 offen offset:256 sc1
    v_mfma_f32_16x16x32_bf16 v[52:55], v[92:95], v[136:139], v[52:55]
    ds_read_b64_tr_b16 v[90:91], v14 offset:21504
    s_waitcnt vmcnt(12) lgkmcnt(10)
    v_mfma_f32_16x16x32_bf16 v[32:35], v[64:67], v[144:147], v[32:35]
    ds_read_b64_tr_b16 v[92:93], v15 offset:20480
    v_mfma_f32_16x16x32_bf16 v[40:43], v[64:67], v[148:151], v[40:43]
    ds_read_b64_tr_b16 v[94:95], v15 offset:21504
    v_perm_b32 v188, v102, v102, s59
    v_mfma_f32_16x16x32_bf16 v[44:47], v[68:71], v[148:151], v[44:47]
    ds_read_b64_tr_b16 v[64:65], v12 offset:24576
    buffer_load_dwordx4 v[136:139], v6, s[16:19], s50 offen offset:2048 sc1
    v_mfma_f32_16x16x32_bf16 v[36:39], v[68:71], v[144:147], v[36:39]
    ds_read_b64_tr_b16 v[66:67], v12 offset:25600
    v_perm_b32 v189, v102, v102, s97
    s_waitcnt lgkmcnt(10)
    v_mfma_f32_16x16x32_bf16 v[48:51], v[72:75], v[144:147], v[48:51]
    ds_read_b64_tr_b16 v[68:69], v13 offset:24576
    v_mfma_f32_16x16x32_bf16 v[56:59], v[72:75], v[148:151], v[56:59]
    ds_read_b64_tr_b16 v[70:71], v13 offset:25600
    v_perm_b32 v190, v103, v103, s59
    v_mfma_f32_16x16x32_bf16 v[60:63], v[76:79], v[148:151], v[60:63]
    ds_read_b64_tr_b16 v[72:73], v14 offset:24576
    buffer_load_dwordx4 v[140:143], v6, s[16:19], s50 offen offset:2304 sc1
    s_add_u32 s50, s50, 4096
    v_mfma_f32_16x16x32_bf16 v[52:55], v[76:79], v[144:147], v[52:55]
    ds_read_b64_tr_b16 v[74:75], v14 offset:25600
    s_waitcnt vmcnt(12) lgkmcnt(10)
    v_mfma_f32_16x16x32_bf16 v[32:35], v[80:83], v[152:155], v[32:35]
    ds_read_b64_tr_b16 v[76:77], v15 offset:24576
    v_mfma_f32_16x16x32_bf16 v[40:43], v[80:83], v[156:159], v[40:43]
    ds_read_b64_tr_b16 v[78:79], v15 offset:25600
    v_perm_b32 v191, v103, v103, s97
    v_mfma_f32_16x16x32_bf16 v[44:47], v[84:87], v[156:159], v[44:47]
    ds_read_b64_tr_b16 v[80:81], v12 offset:28672
    buffer_load_dwordx4 v[144:147], v6, s[16:19], s50 offen offset:0 sc1
    v_mfma_f32_16x16x32_bf16 v[36:39], v[84:87], v[152:155], v[36:39]
    ds_read_b64_tr_b16 v[82:83], v12 offset:29696
    v_perm_b32 v192, v104, v104, s59
    s_waitcnt lgkmcnt(10)
    v_mfma_f32_16x16x32_bf16 v[48:51], v[88:91], v[152:155], v[48:51]
    ds_read_b64_tr_b16 v[84:85], v13 offset:28672
    v_mfma_f32_16x16x32_bf16 v[56:59], v[88:91], v[156:159], v[56:59]
    ds_read_b64_tr_b16 v[86:87], v13 offset:29696
    v_perm_b32 v193, v104, v104, s97
    v_mfma_f32_16x16x32_bf16 v[60:63], v[92:95], v[156:159], v[60:63]
    ds_read_b64_tr_b16 v[88:89], v14 offset:28672
    buffer_load_dwordx4 v[148:151], v6, s[16:19], s50 offen offset:256 sc1
    v_mfma_f32_16x16x32_bf16 v[52:55], v[92:95], v[152:155], v[52:55]
    ds_read_b64_tr_b16 v[90:91], v14 offset:29696
    s_waitcnt vmcnt(12) lgkmcnt(10)
    v_mfma_f32_16x16x32_bf16 v[32:35], v[64:67], v[160:163], v[32:35]
    ds_read_b64_tr_b16 v[92:93], v15 offset:28672
    v_mfma_f32_16x16x32_bf16 v[40:43], v[64:67], v[164:167], v[40:43]
    ds_read_b64_tr_b16 v[94:95], v15 offset:29696
    v_perm_b32 v194, v105, v105, s59
    v_mfma_f32_16x16x32_bf16 v[44:47], v[68:71], v[164:167], v[44:47]
    ds_read_b64_tr_b16 v[64:65], v12 offset:32768
    buffer_load_dwordx4 v[152:155], v6, s[16:19], s50 offen offset:2048 sc1
    v_mfma_f32_16x16x32_bf16 v[36:39], v[68:71], v[160:163], v[36:39]
    ds_read_b64_tr_b16 v[66:67], v12 offset:33792
    v_perm_b32 v195, v105, v105, s97
    s_waitcnt lgkmcnt(10)
    v_mfma_f32_16x16x32_bf16 v[48:51], v[72:75], v[160:163], v[48:51]
    ds_read_b64_tr_b16 v[68:69], v13 offset:32768
    v_mfma_f32_16x16x32_bf16 v[56:59], v[72:75], v[164:167], v[56:59]
    ds_read_b64_tr_b16 v[70:71], v13 offset:33792
    v_perm_b32 v196, v106, v106, s59
    v_mfma_f32_16x16x32_bf16 v[60:63], v[76:79], v[164:167], v[60:63]
    ds_read_b64_tr_b16 v[72:73], v14 offset:32768
    buffer_load_dwordx4 v[156:159], v6, s[16:19], s50 offen offset:2304 sc1
    s_add_u32 s50, s50, 4096
    v_mfma_f32_16x16x32_bf16 v[52:55], v[76:79], v[160:163], v[52:55]
    ds_read_b64_tr_b16 v[74:75], v14 offset:33792
    s_waitcnt vmcnt(12) lgkmcnt(10)
    v_mfma_f32_16x16x32_bf16 v[32:35], v[80:83], v[168:171], v[32:35]
    ds_read_b64_tr_b16 v[76:77], v15 offset:32768
    v_mfma_f32_16x16x32_bf16 v[40:43], v[80:83], v[172:175], v[40:43]
    ds_read_b64_tr_b16 v[78:79], v15 offset:33792
    v_perm_b32 v197, v106, v106, s97
    v_mfma_f32_16x16x32_bf16 v[44:47], v[84:87], v[172:175], v[44:47]
    ds_read_b64_tr_b16 v[80:81], v12 offset:36864
    buffer_load_dwordx4 v[160:163], v6, s[16:19], s50 offen offset:0 sc1
    v_mfma_f32_16x16x32_bf16 v[36:39], v[84:87], v[168:171], v[36:39]
    ds_read_b64_tr_b16 v[82:83], v12 offset:37888
    v_perm_b32 v198, v107, v107, s59
    s_waitcnt lgkmcnt(10)
    v_mfma_f32_16x16x32_bf16 v[48:51], v[88:91], v[168:171], v[48:51]
    ds_read_b64_tr_b16 v[84:85], v13 offset:36864
    v_mfma_f32_16x16x32_bf16 v[56:59], v[88:91], v[172:175], v[56:59]
    ds_read_b64_tr_b16 v[86:87], v13 offset:37888
    v_perm_b32 v199, v107, v107, s97
    v_mfma_f32_16x16x32_bf16 v[60:63], v[92:95], v[172:175], v[60:63]
    ds_read_b64_tr_b16 v[88:89], v14 offset:36864
    buffer_load_dwordx4 v[164:167], v6, s[16:19], s50 offen offset:256 sc1
    v_mfma_f32_16x16x32_bf16 v[52:55], v[92:95], v[168:171], v[52:55]
    ds_read_b64_tr_b16 v[90:91], v14 offset:37888
    s_waitcnt vmcnt(12) lgkmcnt(10)
    v_mfma_f32_16x16x32_bf16 v[32:35], v[64:67], v[112:115], v[32:35]
    ds_read_b64_tr_b16 v[92:93], v15 offset:36864
    v_mfma_f32_16x16x32_bf16 v[40:43], v[64:67], v[116:119], v[40:43]
    ds_read_b64_tr_b16 v[94:95], v15 offset:37888
    v_perm_b32 v200, v108, v108, s59
    v_mfma_f32_16x16x32_bf16 v[44:47], v[68:71], v[116:119], v[44:47]
    ds_read_b64_tr_b16 v[64:65], v12 offset:40960
    buffer_load_dwordx4 v[168:171], v6, s[16:19], s50 offen offset:2048 sc1
    v_mfma_f32_16x16x32_bf16 v[36:39], v[68:71], v[112:115], v[36:39]
    ds_read_b64_tr_b16 v[66:67], v12 offset:41984
    v_perm_b32 v201, v108, v108, s97
    s_waitcnt lgkmcnt(10)
    v_mfma_f32_16x16x32_bf16 v[48:51], v[72:75], v[112:115], v[48:51]
    ds_read_b64_tr_b16 v[68:69], v13 offset:40960
    v_mfma_f32_16x16x32_bf16 v[56:59], v[72:75], v[116:119], v[56:59]
    ds_read_b64_tr_b16 v[70:71], v13 offset:41984
    v_perm_b32 v202, v109, v109, s59
    v_mfma_f32_16x16x32_bf16 v[60:63], v[76:79], v[116:119], v[60:63]
    ds_read_b64_tr_b16 v[72:73], v14 offset:40960
    buffer_load_dwordx4 v[172:175], v6, s[16:19], s50 offen offset:2304 sc1
    s_add_u32 s50, s50, 4096
    v_mfma_f32_16x16x32_bf16 v[52:55], v[76:79], v[112:115], v[52:55]
    ds_read_b64_tr_b16 v[74:75], v14 offset:41984
    s_waitcnt vmcnt(12) lgkmcnt(10)
    v_mfma_f32_16x16x32_bf16 v[32:35], v[80:83], v[120:123], v[32:35]
    ds_read_b64_tr_b16 v[76:77], v15 offset:40960
    v_mfma_f32_16x16x32_bf16 v[40:43], v[80:83], v[124:127], v[40:43]
    ds_read_b64_tr_b16 v[78:79], v15 offset:41984
    v_perm_b32 v203, v109, v109, s97
    v_mfma_f32_16x16x32_bf16 v[44:47], v[84:87], v[124:127], v[44:47]
    ds_read_b64_tr_b16 v[80:81], v12 offset:45056
    s_branch wp_6_t
wp_6:
    ds_read_b32 v29, v28
    s_waitcnt lgkmcnt(0)
    v_readfirstlane_b32 s60, v29
    s_lshr_b32 s51, s60, 2
    s_and_b32 s51, s51, s60
    s_and_b32 s51, s51, 3
wp_6_t:
    s_cmp_eq_u32 s51, 3
    s_cbranch_scc0 wp_6
    s_lshl_b32 s50, s52, 15
    s_xor_b32 s50, s50, 32768
    buffer_load_dwordx4 v[112:115], v6, s[16:19], s50 offen offset:0 sc1
    v_mfma_f32_16x16x32_bf16 v[36:39], v[84:87], v[120:123], v[36:39]
    ds_read_b64_tr_b16 v[82:83], v12 offset:46080
    v_perm_b32 v204, v110, v110, s59
    s_waitcnt lgkmcnt(10)
    v_mfma_f32_16x16x32_bf16 v[48:51], v[88:91], v[120:123], v[48:51]
    ds_read_b64_tr_b16 v[84:85], v13 offset:45056
    v_mfma_f32_16x16x32_bf16 v[56:59], v[88:91], v[124:127], v[56:59]
    ds_read_b64_tr_b16 v[86:87], v13 offset:46080
    v_perm_b32 v205, v110, v110, s97
    v_mfma_f32_16x16x32_bf16 v[60:63], v[92:95], v[124:127], v[60:63]
    ds_read_b64_tr_b16 v[88:89], v14 offset:45056
    buffer_load_dwordx4 v[116:119], v6, s[16:19], s50 offen offset:256 sc1
    v_mfma_f32_16x16x32_bf16 v[52:55], v[92:95], v[120:123], v[52:55]
    ds_read_b64_tr_b16 v[90:91], v14 offset:46080
    s_waitcnt vmcnt(12) lgkmcnt(10)
    v_mfma_f32_16x16x32_bf16 v[32:35], v[64:67], v[128:131], v[32:35]
    ds_read_b64_tr_b16 v[92:93], v15 offset:45056
    v_mfma_f32_16x16x32_bf16 v[40:43], v[64:67], v[132:135], v[40:43]
    ds_read_b64_tr_b16 v[94:95], v15 offset:46080
    v_perm_b32 v206, v111, v111, s59
    v_mfma_f32_16x16x32_bf16 v[44:47], v[68:71], v[132:135], v[44:47]
    ds_read_b64_tr_b16 v[64:65], v12 offset:49152
    buffer_load_dwordx4 v[120:123], v6, s[16:19], s50 offen offset:2048 sc1
    v_mfma_f32_16x16x32_bf16 v[36:39], v[68:71], v[128:131], v[36:39]
    ds_read_b64_tr_b16 v[66:67], v12 offset:50176
    v_perm_b32 v207, v111, v111, s97
    s_waitcnt lgkmcnt(10)
    v_mfma_f32_16x16x32_bf16 v[48:51], v[72:75], v[128:131], v[48:51]
    ds_read_b64_tr_b16 v[68:69], v13 offset:49152
    v_mfma_f32_16x16x32_bf16 v[56:59], v[72:75], v[132:135], v[56:59]
    ds_read_b64_tr_b16 v[70:71], v13 offset:50176
    v_mul_u32_u24 v8, 144, v4
    v_mfma_f32_16x16x32_bf16 v[60:63], v[76:79], v[132:135], v[60:63]
    ds_read_b64_tr_b16 v[72:73], v14 offset:49152
    buffer_load_dwordx4 v[124:127], v6, s[16:19], s50 offen offset:2304 sc1
    s_add_u32 s50, s50, 4096
    v_mfma_f32_16x16x32_bf16 v[52:55], v[76:79], v[128:131], v[52:55]
    ds_read_b64_tr_b16 v[74:75], v14 offset:50176
    s_waitcnt vmcnt(12) lgkmcnt(10)
    v_mfma_f32_16x16x32_bf16 v[32:35], v[80:83], v[136:139], v[32:35]
    ds_read_b64_tr_b16 v[76:77], v15 offset:49152
    v_mfma_f32_16x16x32_bf16 v[40:43], v[80:83], v[140:143], v[40:43]
    ds_read_b64_tr_b16 v[78:79], v15 offset:50176
    v_lshrrev_b32 v11, 4, v1
    v_mfma_f32_16x16x32_bf16 v[44:47], v[84:87], v[140:143], v[44:47]
    ds_read_b64_tr_b16 v[80:81], v12 offset:53248
    buffer_load_dwordx4 v[128:131], v6, s[16:19], s50 offen offset:0 sc1
    v_mfma_f32_16x16x32_bf16 v[36:39], v[84:87], v[136:139], v[36:39]
    ds_read_b64_tr_b16 v[82:83], v12 offset:54272
    v_lshl_add_u32 v8, v11, 3, v8
    s_waitcnt lgkmcnt(10)
    v_mfma_f32_16x16x32_bf16 v[48:51], v[88:91], v[136:139], v[48:51]
    ds_read_b64_tr_b16 v[84:85], v13 offset:53248
    v_mfma_f32_16x16x32_bf16 v[56:59], v[88:91], v[140:143], v[56:59]
    ds_read_b64_tr_b16 v[86:87], v13 offset:54272
    v_mul_u32_u24 v7, 4608, v2
    v_mfma_f32_16x16x32_bf16 v[60:63], v[92:95], v[140:143], v[60:63]
    ds_read_b64_tr_b16 v[88:89], v14 offset:53248
    buffer_load_dwordx4 v[132:135], v6, s[16:19], s50 offen offset:256 sc1
    v_mfma_f32_16x16x32_bf16 v[52:55], v[92:95], v[136:139], v[52:55]
    ds_read_b64_tr_b16 v[90:91], v14 offset:54272
    s_waitcnt vmcnt(12) lgkmcnt(10)
    v_mfma_f32_16x16x32_bf16 v[32:35], v[64:67], v[144:147], v[32:35]
    ds_read_b64_tr_b16 v[92:93], v15 offset:53248
    v_mfma_f32_16x16x32_bf16 v[40:43], v[64:67], v[148:151], v[40:43]
    ds_read_b64_tr_b16 v[94:95], v15 offset:54272
    v_add_u32 v7, 131072, v7
    v_mfma_f32_16x16x32_bf16 v[44:47], v[68:71], v[148:151], v[44:47]
    ds_read_b64_tr_b16 v[64:65], v12 offset:57344
    buffer_load_dwordx4 v[136:139], v6, s[16:19], s50 offen offset:2048 sc1
    v_mfma_f32_16x16x32_bf16 v[36:39], v[68:71], v[144:147], v[36:39]
    ds_read_b64_tr_b16 v[66:67], v12 offset:58368
    v_add_u32 v8, v8, v7
    s_waitcnt lgkmcnt(10)
    v_mfma_f32_16x16x32_bf16 v[48:51], v[72:75], v[144:147], v[48:51]
    ds_read_b64_tr_b16 v[68:69], v13 offset:57344
    v_mfma_f32_16x16x32_bf16 v[56:59], v[72:75], v[148:151], v[56:59]
    ds_read_b64_tr_b16 v[70:71], v13 offset:58368
    v_lshrrev_b32 v10, 3, v1
    v_mfma_f32_16x16x32_bf16 v[60:63], v[76:79], v[148:151], v[60:63]
    ds_read_b64_tr_b16 v[72:73], v14 offset:57344
    buffer_load_dwordx4 v[140:143], v6, s[16:19], s50 offen offset:2304 sc1
    s_add_u32 s50, s50, 4096
    v_mfma_f32_16x16x32_bf16 v[52:55], v[76:79], v[144:147], v[52:55]
    ds_read_b64_tr_b16 v[74:75], v14 offset:58368
    s_waitcnt vmcnt(12) lgkmcnt(10)
    v_mfma_f32_16x16x32_bf16 v[32:35], v[80:83], v[152:155], v[32:35]
    ds_read_b64_tr_b16 v[76:77], v15 offset:57344
    v_mfma_f32_16x16x32_bf16 v[40:43], v[80:83], v[156:159], v[40:43]
    ds_read_b64_tr_b16 v[78:79], v15 offset:58368
    v_and_b32 v11, 7, v1
    v_mfma_f32_16x16x32_bf16 v[44:47], v[84:87], v[156:159], v[44:47]
    ds_read_b64_tr_b16 v[80:81], v12 offset:61440
    buffer_load_dwordx4 v[144:147], v6, s[16:19], s50 offen offset:0 sc1
    v_mfma_f32_16x16x32_bf16 v[36:39], v[84:87], v[152:155], v[36:39]
    ds_read_b64_tr_b16 v[82:83], v12 offset:62464
    v_mul_u32_u24 v9, 144, v10
    s_waitcnt lgkmcnt(10)
    v_mfma_f32_16x16x32_bf16 v[48:51], v[88:91], v[152:155], v[48:51]
    ds_read_b64_tr_b16 v[84:85], v13 offset:61440
    v_mfma_f32_16x16x32_bf16 v[56:59], v[88:91], v[156:159], v[56:59]
    ds_read_b64_tr_b16 v[86:87], v13 offset:62464
    v_lshl_add_u32 v9, v11, 4, v9
    v_mfma_f32_16x16x32_bf16 v[60:63], v[92:95], v[156:159], v[60:63]
    ds_read_b64_tr_b16 v[88:89], v14 offset:61440
    buffer_load_dwordx4 v[148:151], v6, s[16:19], s50 offen offset:256 sc1
    v_mfma_f32_16x16x32_bf16 v[52:55], v[92:95], v[152:155], v[52:55]
    ds_read_b64_tr_b16 v[90:91], v14 offset:62464
    s_waitcnt vmcnt(12) lgkmcnt(10)
    v_mfma_f32_16x16x32_bf16 v[32:35], v[64:67], v[160:163], v[32:35]
    ds_read_b64_tr_b16 v[92:93], v15 offset:61440
    v_mfma_f32_16x16x32_bf16 v[40:43], v[64:67], v[164:167], v[40:43]
    ds_read_b64_tr_b16 v[94:95], v15 offset:62464
    v_add_u32 v9, v9, v7
    v_mfma_f32_16x16x32_bf16 v[44:47], v[68:71], v[164:167], v[44:47]
    v_xor_b32 v12, 0x10000, v12
    ds_read_b64_tr_b16 v[64:65], v12 offset:0
    buffer_load_dwordx4 v[152:155], v6, s[16:19], s50 offen offset:2048 sc1
    v_mfma_f32_16x16x32_bf16 v[36:39], v[68:71], v[160:163], v[36:39]
    ds_read_b64_tr_b16 v[66:67], v12 offset:1024
    v_lshlrev_b32 v10, 11, v10
    s_waitcnt lgkmcnt(10)
    v_mfma_f32_16x16x32_bf16 v[48:51], v[72:75], v[160:163], v[48:51]
    v_xor_b32 v13, 0x10000, v13
    ds_read_b64_tr_b16 v[68:69], v13 offset:0
    v_mfma_f32_16x16x32_bf16 v[56:59], v[72:75], v[164:167], v[56:59]
    ds_read_b64_tr_b16 v[70:71], v13 offset:1024
    v_lshl_add_u32 v10, v11, 4, v10
    v_mfma_f32_16x16x32_bf16 v[60:63], v[76:79], v[164:167], v[60:63]
    v_xor_b32 v14, 0x10000, v14
    ds_read_b64_tr_b16 v[72:73], v14 offset:0
    buffer_load_dwordx4 v[156:159], v6, s[16:19], s50 offen offset:2304 sc1
    s_add_u32 s50, s50, 4096
    v_mfma_f32_16x16x32_bf16 v[52:55], v[76:79], v[160:163], v[52:55]
    ds_read_b64_tr_b16 v[74:75], v14 offset:1024
    s_waitcnt vmcnt(12) lgkmcnt(10)
    v_mfma_f32_16x16x32_bf16 v[32:35], v[80:83], v[168:171], v[32:35]
    v_xor_b32 v15, 0x10000, v15
    ds_read_b64_tr_b16 v[76:77], v15 offset:0
    v_mfma_f32_16x16x32_bf16 v[40:43], v[80:83], v[172:175], v[40:43]
    ds_read_b64_tr_b16 v[78:79], v15 offset:1024
    v_mfma_f32_16x16x32_bf16 v[44:47], v[84:87], v[172:175], v[44:47]
    ds_read_b64_tr_b16 v[80:81], v12 offset:4096
    buffer_load_dwordx4 v[160:163], v6, s[16:19], s50 offen offset:0 sc1
    v_mfma_f32_16x16x32_bf16 v[36:39], v[84:87], v[168:171], v[36:39]
    ds_read_b64_tr_b16 v[82:83], v12 offset:5120
    s_waitcnt lgkmcnt(10)
    v_mfma_f32_16x16x32_bf16 v[48:51], v[88:91], v[168:171], v[48:51]
    ds_read_b64_tr_b16 v[84:85], v13 offset:4096
    v_mfma_f32_16x16x32_bf16 v[56:59], v[88:91], v[172:175], v[56:59]
    ds_read_b64_tr_b16 v[86:87], v13 offset:5120
    v_mfma_f32_16x16x32_bf16 v[60:63], v[92:95], v[172:175], v[60:63]
    ds_read_b64_tr_b16 v[88:89], v14 offset:4096
    buffer_load_dwordx4 v[164:167], v6, s[16:19], s50 offen offset:256 sc1
    v_mfma_f32_16x16x32_bf16 v[52:55], v[92:95], v[168:171], v[52:55]
    ds_read_b64_tr_b16 v[90:91], v14 offset:5120
    s_waitcnt vmcnt(12) lgkmcnt(10)
    v_mfma_f32_16x16x32_bf16 v[176:179], v[64:67], v[112:115], v[176:179]
    ds_read_b64_tr_b16 v[92:93], v15 offset:4096
    v_mfma_f32_16x16x32_bf16 v[184:187], v[64:67], v[116:119], v[184:187]
    ds_read_b64_tr_b16 v[94:95], v15 offset:5120
    v_mfma_f32_16x16x32_bf16 v[188:191], v[68:71], v[116:119], v[188:191]
    ds_read_b64_tr_b16 v[64:65], v12 offset:8192
    buffer_load_dwordx4 v[168:171], v6, s[16:19], s50 offen offset:2048 sc1
    v_mfma_f32_16x16x32_bf16 v[180:183], v[68:71], v[112:115], v[180:183]
    ds_read_b64_tr_b16 v[66:67], v12 offset:9216
    s_waitcnt lgkmcnt(10)
    v_mfma_f32_16x16x32_bf16 v[192:195], v[72:75], v[112:115], v[192:195]
    ds_read_b64_tr_b16 v[68:69], v13 offset:8192
    v_mfma_f32_16x16x32_bf16 v[200:203], v[72:75], v[116:119], v[200:203]
    ds_read_b64_tr_b16 v[70:71], v13 offset:9216
    v_mfma_f32_16x16x32_bf16 v[204:207], v[76:79], v[116:119], v[204:207]
    ds_read_b64_tr_b16 v[72:73], v14 offset:8192
    buffer_load_dwordx4 v[172:175], v6, s[16:19], s50 offen offset:2304 sc1
    s_add_u32 s50, s50, 4096
    v_mfma_f32_16x16x32_bf16 v[196:199], v[76:79], v[112:115], v[196:199]
    ds_read_b64_tr_b16 v[74:75], v14 offset:9216
    s_waitcnt vmcnt(12) lgkmcnt(10)
    v_mfma_f32_16x16x32_bf16 v[176:179], v[80:83], v[120:123], v[176:179]
    ds_read_b64_tr_b16 v[76:77], v15 offset:8192
    v_mfma_f32_16x16x32_bf16 v[184:187], v[80:83], v[124:127], v[184:187]
    ds_read_b64_tr_b16 v[78:79], v15 offset:9216
    v_mfma_f32_16x16x32_bf16 v[188:191], v[84:87], v[124:127], v[188:191]
    ds_read_b64_tr_b16 v[80:81], v12 offset:12288
    buffer_load_dwordx4 v[112:115], v6, s[16:19], s50 offen offset:0 sc1
    v_mfma_f32_16x16x32_bf16 v[180:183], v[84:87], v[120:123], v[180:183]
    ds_read_b64_tr_b16 v[82:83], v12 offset:13312
    s_waitcnt lgkmcnt(10)
    v_mfma_f32_16x16x32_bf16 v[192:195], v[88:91], v[120:123], v[192:195]
    ds_read_b64_tr_b16 v[84:85], v13 offset:12288
    v_mfma_f32_16x16x32_bf16 v[200:203], v[88:91], v[124:127], v[200:203]
    ds_read_b64_tr_b16 v[86:87], v13 offset:13312
    v_mfma_f32_16x16x32_bf16 v[204:207], v[92:95], v[124:127], v[204:207]
    ds_read_b64_tr_b16 v[88:89], v14 offset:12288
    buffer_load_dwordx4 v[116:119], v6, s[16:19], s50 offen offset:256 sc1
    v_mfma_f32_16x16x32_bf16 v[196:199], v[92:95], v[120:123], v[196:199]
    ds_read_b64_tr_b16 v[90:91], v14 offset:13312
    s_waitcnt vmcnt(12) lgkmcnt(10)
    v_mfma_f32_16x16x32_bf16 v[176:179], v[64:67], v[128:131], v[176:179]
    ds_read_b64_tr_b16 v[92:93], v15 offset:12288
    v_mfma_f32_16x16x32_bf16 v[184:187], v[64:67], v[132:135], v[184:187]
    ds_read_b64_tr_b16 v[94:95], v15 offset:13312
    v_mfma_f32_16x16x32_bf16 v[188:191], v[68:71], v[132:135], v[188:191]
    ds_read_b64_tr_b16 v[64:65], v12 offset:16384
    buffer_load_dwordx4 v[120:123], v6, s[16:19], s50 offen offset:2048 sc1
    v_mfma_f32_16x16x32_bf16 v[180:183], v[68:71], v[128:131], v[180:183]
    ds_read_b64_tr_b16 v[66:67], v12 offset:17408
    s_waitcnt lgkmcnt(10)
    v_mfma_f32_16x16x32_bf16 v[192:195], v[72:75], v[128:131], v[192:195]
    ds_read_b64_tr_b16 v[68:69], v13 offset:16384
    v_mfma_f32_16x16x32_bf16 v[200:203], v[72:75], v[132:135], v[200:203]
    ds_read_b64_tr_b16 v[70:71], v13 offset:17408
    v_mfma_f32_16x16x32_bf16 v[204:207], v[76:79], v[132:135], v[204:207]
    ds_read_b64_tr_b16 v[72:73], v14 offset:16384
    buffer_load_dwordx4 v[124:127], v6, s[16:19], s50 offen offset:2304 sc1
    s_add_u32 s50, s50, 4096
    v_mfma_f32_16x16x32_bf16 v[196:199], v[76:79], v[128:131], v[196:199]
    ds_read_b64_tr_b16 v[74:75], v14 offset:17408
    s_waitcnt vmcnt(12) lgkmcnt(10)
    v_mfma_f32_16x16x32_bf16 v[176:179], v[80:83], v[136:139], v[176:179]
    ds_read_b64_tr_b16 v[76:77], v15 offset:16384
    v_mfma_f32_16x16x32_bf16 v[184:187], v[80:83], v[140:143], v[184:187]
    ds_read_b64_tr_b16 v[78:79], v15 offset:17408
    v_mfma_f32_16x16x32_bf16 v[188:191], v[84:87], v[140:143], v[188:191]
    ds_read_b64_tr_b16 v[80:81], v12 offset:20480
    buffer_load_dwordx4 v[128:131], v6, s[16:19], s50 offen offset:0 sc1
    v_mfma_f32_16x16x32_bf16 v[180:183], v[84:87], v[136:139], v[180:183]
    ds_read_b64_tr_b16 v[82:83], v12 offset:21504
    s_waitcnt lgkmcnt(10)
    v_mfma_f32_16x16x32_bf16 v[192:195], v[88:91], v[136:139], v[192:195]
    ds_read_b64_tr_b16 v[84:85], v13 offset:20480
    v_mfma_f32_16x16x32_bf16 v[200:203], v[88:91], v[140:143], v[200:203]
    ds_read_b64_tr_b16 v[86:87], v13 offset:21504
    v_mfma_f32_16x16x32_bf16 v[204:207], v[92:95], v[140:143], v[204:207]
    ds_read_b64_tr_b16 v[88:89], v14 offset:20480
    buffer_load_dwordx4 v[132:135], v6, s[16:19], s50 offen offset:256 sc1
    v_mfma_f32_16x16x32_bf16 v[196:199], v[92:95], v[136:139], v[196:199]
    ds_read_b64_tr_b16 v[90:91], v14 offset:21504
    s_waitcnt vmcnt(12) lgkmcnt(10)
    v_mfma_f32_16x16x32_bf16 v[176:179], v[64:67], v[144:147], v[176:179]
    ds_read_b64_tr_b16 v[92:93], v15 offset:20480
    v_mfma_f32_16x16x32_bf16 v[184:187], v[64:67], v[148:151], v[184:187]
    ds_read_b64_tr_b16 v[94:95], v15 offset:21504
    v_mfma_f32_16x16x32_bf16 v[188:191], v[68:71], v[148:151], v[188:191]
    ds_read_b64_tr_b16 v[64:65], v12 offset:24576
    buffer_load_dwordx4 v[136:139], v6, s[16:19], s50 offen offset:2048 sc1
    v_mfma_f32_16x16x32_bf16 v[180:183], v[68:71], v[144:147], v[180:183]
    ds_read_b64_tr_b16 v[66:67], v12 offset:25600
    s_waitcnt lgkmcnt(10)
    v_mfma_f32_16x16x32_bf16 v[192:195], v[72:75], v[144:147], v[192:195]
    ds_read_b64_tr_b16 v[68:69], v13 offset:24576
    v_mfma_f32_16x16x32_bf16 v[200:203], v[72:75], v[148:151], v[200:203]
    ds_read_b64_tr_b16 v[70:71], v13 offset:25600
    v_mfma_f32_16x16x32_bf16 v[204:207], v[76:79], v[148:151], v[204:207]
    ds_read_b64_tr_b16 v[72:73], v14 offset:24576
    buffer_load_dwordx4 v[140:143], v6, s[16:19], s50 offen offset:2304 sc1
    s_add_u32 s50, s50, 4096
    v_mfma_f32_16x16x32_bf16 v[196:199], v[76:79], v[144:147], v[196:199]
    ds_read_b64_tr_b16 v[74:75], v14 offset:25600
    s_waitcnt vmcnt(12) lgkmcnt(10)
    v_mfma_f32_16x16x32_bf16 v[176:179], v[80:83], v[152:155], v[176:179]
    ds_read_b64_tr_b16 v[76:77], v15 offset:24576
    v_mfma_f32_16x16x32_bf16 v[184:187], v[80:83], v[156:159], v[184:187]
    ds_read_b64_tr_b16 v[78:79], v15 offset:25600
    v_mfma_f32_16x16x32_bf16 v[188:191], v[84:87], v[156:159], v[188:191]
    ds_read_b64_tr_b16 v[80:81], v12 offset:28672
    buffer_load_dwordx4 v[144:147], v6, s[16:19], s50 offen offset:0 sc1
    v_mfma_f32_16x16x32_bf16 v[180:183], v[84:87], v[152:155], v[180:183]
    ds_read_b64_tr_b16 v[82:83], v12 offset:29696
    s_waitcnt lgkmcnt(10)
    v_mfma_f32_16x16x32_bf16 v[192:195], v[88:91], v[152:155], v[192:195]
    ds_read_b64_tr_b16 v[84:85], v13 offset:28672
    v_mfma_f32_16x16x32_bf16 v[200:203], v[88:91], v[156:159], v[200:203]
    ds_read_b64_tr_b16 v[86:87], v13 offset:29696
    v_mfma_f32_16x16x32_bf16 v[204:207], v[92:95], v[156:159], v[204:207]
    ds_read_b64_tr_b16 v[88:89], v14 offset:28672
    buffer_load_dwordx4 v[148:151], v6, s[16:19], s50 offen offset:256 sc1
    v_mfma_f32_16x16x32_bf16 v[196:199], v[92:95], v[152:155], v[196:199]
    ds_read_b64_tr_b16 v[90:91], v14 offset:29696
    s_waitcnt vmcnt(12) lgkmcnt(10)
    v_mfma_f32_16x16x32_bf16 v[176:179], v[64:67], v[160:163], v[176:179]
    ds_read_b64_tr_b16 v[92:93], v15 offset:28672
    v_mfma_f32_16x16x32_bf16 v[184:187], v[64:67], v[164:167], v[184:187]
    ds_read_b64_tr_b16 v[94:95], v15 offset:29696
    v_mfma_f32_16x16x32_bf16 v[188:191], v[68:71], v[164:167], v[188:191]
    ds_read_b64_tr_b16 v[64:65], v12 offset:32768
    buffer_load_dwordx4 v[152:155], v6, s[16:19], s50 offen offset:2048 sc1
    v_mfma_f32_16x16x32_bf16 v[180:183], v[68:71], v[160:163], v[180:183]
    ds_read_b64_tr_b16 v[66:67], v12 offset:33792
    s_waitcnt lgkmcnt(10)
    v_mfma_f32_16x16x32_bf16 v[192:195], v[72:75], v[160:163], v[192:195]
    ds_read_b64_tr_b16 v[68:69], v13 offset:32768
    v_mfma_f32_16x16x32_bf16 v[200:203], v[72:75], v[164:167], v[200:203]
    ds_read_b64_tr_b16 v[70:71], v13 offset:33792
    v_mfma_f32_16x16x32_bf16 v[204:207], v[76:79], v[164:167], v[204:207]
    ds_read_b64_tr_b16 v[72:73], v14 offset:32768
    buffer_load_dwordx4 v[156:159], v6, s[16:19], s50 offen offset:2304 sc1
    s_add_u32 s50, s50, 4096
    v_mfma_f32_16x16x32_bf16 v[196:199], v[76:79], v[160:163], v[196:199]
    ds_read_b64_tr_b16 v[74:75], v14 offset:33792
    s_waitcnt vmcnt(12) lgkmcnt(10)
    v_mfma_f32_16x16x32_bf16 v[176:179], v[80:83], v[168:171], v[176:179]
    ds_read_b64_tr_b16 v[76:77], v15 offset:32768
    v_mfma_f32_16x16x32_bf16 v[184:187], v[80:83], v[172:175], v[184:187]
    ds_read_b64_tr_b16 v[78:79], v15 offset:33792
    v_mfma_f32_16x16x32_bf16 v[188:191], v[84:87], v[172:175], v[188:191]
    ds_read_b64_tr_b16 v[80:81], v12 offset:36864
    buffer_load_dwordx4 v[160:163], v6, s[16:19], s50 offen offset:0 sc1
    v_mfma_f32_16x16x32_bf16 v[180:183], v[84:87], v[168:171], v[180:183]
    ds_read_b64_tr_b16 v[82:83], v12 offset:37888
    s_waitcnt lgkmcnt(10)
    v_mfma_f32_16x16x32_bf16 v[192:195], v[88:91], v[168:171], v[192:195]
    ds_read_b64_tr_b16 v[84:85], v13 offset:36864
    v_mfma_f32_16x16x32_bf16 v[200:203], v[88:91], v[172:175], v[200:203]
    ds_read_b64_tr_b16 v[86:87], v13 offset:37888
    v_mfma_f32_16x16x32_bf16 v[204:207], v[92:95], v[172:175], v[204:207]
    ds_read_b64_tr_b16 v[88:89], v14 offset:36864
    buffer_load_dwordx4 v[164:167], v6, s[16:19], s50 offen offset:256 sc1
    v_mfma_f32_16x16x32_bf16 v[196:199], v[92:95], v[168:171], v[196:199]
    ds_read_b64_tr_b16 v[90:91], v14 offset:37888
    s_waitcnt vmcnt(12) lgkmcnt(10)
    v_mfma_f32_16x16x32_bf16 v[176:179], v[64:67], v[112:115], v[176:179]
    ds_read_b64_tr_b16 v[92:93], v15 offset:36864
    v_mfma_f32_16x16x32_bf16 v[184:187], v[64:67], v[116:119], v[184:187]
    ds_read_b64_tr_b16 v[94:95], v15 offset:37888
    v_mfma_f32_16x16x32_bf16 v[188:191], v[68:71], v[116:119], v[188:191]
    ds_read_b64_tr_b16 v[64:65], v12 offset:40960
    buffer_load_dwordx4 v[168:171], v6, s[16:19], s50 offen offset:2048 sc1
    v_mfma_f32_16x16x32_bf16 v[180:183], v[68:71], v[112:115], v[180:183]
    ds_read_b64_tr_b16 v[66:67], v12 offset:41984
    s_waitcnt lgkmcnt(10)
    v_mfma_f32_16x16x32_bf16 v[192:195], v[72:75], v[112:115], v[192:195]
    ds_read_b64_tr_b16 v[68:69], v13 offset:40960
    v_mfma_f32_16x16x32_bf16 v[200:203], v[72:75], v[116:119], v[200:203]
    ds_read_b64_tr_b16 v[70:71], v13 offset:41984
    v_mfma_f32_16x16x32_bf16 v[204:207], v[76:79], v[116:119], v[204:207]
    ds_read_b64_tr_b16 v[72:73], v14 offset:40960
    buffer_load_dwordx4 v[172:175], v6, s[16:19], s50 offen offset:2304 sc1
    s_add_u32 s50, s50, 4096
    v_mfma_f32_16x16x32_bf16 v[196:199], v[76:79], v[112:115], v[196:199]
    ds_read_b64_tr_b16 v[74:75], v14 offset:41984
    s_waitcnt vmcnt(12) lgkmcnt(10)
    v_mfma_f32_16x16x32_bf16 v[176:179], v[80:83], v[120:123], v[176:179]
    ds_read_b64_tr_b16 v[76:77], v15 offset:40960
    v_mfma_f32_16x16x32_bf16 v[184:187], v[80:83], v[124:127], v[184:187]
    ds_read_b64_tr_b16 v[78:79], v15 offset:41984
    v_mfma_f32_16x16x32_bf16 v[188:191], v[84:87], v[124:127], v[188:191]
    ds_read_b64_tr_b16 v[80:81], v12 offset:45056
    v_mfma_f32_16x16x32_bf16 v[180:183], v[84:87], v[120:123], v[180:183]
    ds_read_b64_tr_b16 v[82:83], v12 offset:46080
    s_waitcnt lgkmcnt(10)
    v_mfma_f32_16x16x32_bf16 v[192:195], v[88:91], v[120:123], v[192:195]
    ds_read_b64_tr_b16 v[84:85], v13 offset:45056
    v_mfma_f32_16x16x32_bf16 v[200:203], v[88:91], v[124:127], v[200:203]
    ds_read_b64_tr_b16 v[86:87], v13 offset:46080
    v_mfma_f32_16x16x32_bf16 v[204:207], v[92:95], v[124:127], v[204:207]
    ds_read_b64_tr_b16 v[88:89], v14 offset:45056
    v_mfma_f32_16x16x32_bf16 v[196:199], v[92:95], v[120:123], v[196:199]
    ds_read_b64_tr_b16 v[90:91], v14 offset:46080
    s_waitcnt vmcnt(10) lgkmcnt(10)
    v_mfma_f32_16x16x32_bf16 v[176:179], v[64:67], v[128:131], v[176:179]
    ds_read_b64_tr_b16 v[92:93], v15 offset:45056
    v_mfma_f32_16x16x32_bf16 v[184:187], v[64:67], v[132:135], v[184:187]
    ds_read_b64_tr_b16 v[94:95], v15 offset:46080
    v_mfma_f32_16x16x32_bf16 v[188:191], v[68:71], v[132:135], v[188:191]
    ds_read_b64_tr_b16 v[64:65], v12 offset:49152
    v_mfma_f32_16x16x32_bf16 v[180:183], v[68:71], v[128:131], v[180:183]
    ds_read_b64_tr_b16 v[66:67], v12 offset:50176
    s_waitcnt lgkmcnt(10)
    v_mfma_f32_16x16x32_bf16 v[192:195], v[72:75], v[128:131], v[192:195]
    ds_read_b64_tr_b16 v[68:69], v13 offset:49152
    v_mfma_f32_16x16x32_bf16 v[200:203], v[72:75], v[132:135], v[200:203]
    ds_read_b64_tr_b16 v[70:71], v13 offset:50176
    v_mfma_f32_16x16x32_bf16 v[204:207], v[76:79], v[132:135], v[204:207]
    ds_read_b64_tr_b16 v[72:73], v14 offset:49152
    v_mfma_f32_16x16x32_bf16 v[196:199], v[76:79], v[128:131], v[196:199]
    ds_read_b64_tr_b16 v[74:75], v14 offset:50176
    s_waitcnt vmcnt(8) lgkmcnt(10)
    v_mfma_f32_16x16x32_bf16 v[176:179], v[80:83], v[136:139], v[176:179]
    ds_read_b64_tr_b16 v[76:77], v15 offset:49152
    v_mfma_f32_16x16x32_bf16 v[184:187], v[80:83], v[140:143], v[184:187]
    ds_read_b64_tr_b16 v[78:79], v15 offset:50176
    v_mfma_f32_16x16x32_bf16 v[188:191], v[84:87], v[140:143], v[188:191]
    ds_read_b64_tr_b16 v[80:81], v12 offset:53248
    v_mfma_f32_16x16x32_bf16 v[180:183], v[84:87], v[136:139], v[180:183]
    ds_read_b64_tr_b16 v[82:83], v12 offset:54272
    s_waitcnt lgkmcnt(10)
    v_mfma_f32_16x16x32_bf16 v[192:195], v[88:91], v[136:139], v[192:195]
    ds_read_b64_tr_b16 v[84:85], v13 offset:53248
    v_mfma_f32_16x16x32_bf16 v[200:203], v[88:91], v[140:143], v[200:203]
    ds_read_b64_tr_b16 v[86:87], v13 offset:54272
    v_mfma_f32_16x16x32_bf16 v[204:207], v[92:95], v[140:143], v[204:207]
    ds_read_b64_tr_b16 v[88:89], v14 offset:53248
    v_mfma_f32_16x16x32_bf16 v[196:199], v[92:95], v[136:139], v[196:199]
    ds_read_b64_tr_b16 v[90:91], v14 offset:54272
    s_waitcnt vmcnt(6) lgkmcnt(10)
    v_mfma_f32_16x16x32_bf16 v[176:179], v[64:67], v[144:147], v[176:179]
    ds_read_b64_tr_b16 v[92:93], v15 offset:53248
    v_mfma_f32_16x16x32_bf16 v[184:187], v[64:67], v[148:151], v[184:187]
    ds_read_b64_tr_b16 v[94:95], v15 offset:54272
    v_mfma_f32_16x16x32_bf16 v[188:191], v[68:71], v[148:151], v[188:191]
    ds_read_b64_tr_b16 v[64:65], v12 offset:57344
    v_mfma_f32_16x16x32_bf16 v[180:183], v[68:71], v[144:147], v[180:183]
    ds_read_b64_tr_b16 v[66:67], v12 offset:58368
    s_waitcnt lgkmcnt(10)
    v_mfma_f32_16x16x32_bf16 v[192:195], v[72:75], v[144:147], v[192:195]
    ds_read_b64_tr_b16 v[68:69], v13 offset:57344
    v_mfma_f32_16x16x32_bf16 v[200:203], v[72:75], v[148:151], v[200:203]
    ds_read_b64_tr_b16 v[70:71], v13 offset:58368
    v_mfma_f32_16x16x32_bf16 v[204:207], v[76:79], v[148:151], v[204:207]
    ds_read_b64_tr_b16 v[72:73], v14 offset:57344
    v_mfma_f32_16x16x32_bf16 v[196:199], v[76:79], v[144:147], v[196:199]
    ds_read_b64_tr_b16 v[74:75], v14 offset:58368
    s_waitcnt vmcnt(4) lgkmcnt(10)
    v_mfma_f32_16x16x32_bf16 v[176:179], v[80:83], v[152:155], v[176:179]
    ds_read_b64_tr_b16 v[76:77], v15 offset:57344
    v_mfma_f32_16x16x32_bf16 v[184:187], v[80:83], v[156:159], v[184:187]
    ds_read_b64_tr_b16 v[78:79], v15 offset:58368
    v_mfma_f32_16x16x32_bf16 v[188:191], v[84:87], v[156:159], v[188:191]
    ds_read_b64_tr_b16 v[80:81], v12 offset:61440
    v_mfma_f32_16x16x32_bf16 v[180:183], v[84:87], v[152:155], v[180:183]
    ds_read_b64_tr_b16 v[82:83], v12 offset:62464
    s_waitcnt lgkmcnt(10)
    v_mfma_f32_16x16x32_bf16 v[192:195], v[88:91], v[152:155], v[192:195]
    ds_read_b64_tr_b16 v[84:85], v13 offset:61440
    v_mfma_f32_16x16x32_bf16 v[200:203], v[88:91], v[156:159], v[200:203]
    ds_read_b64_tr_b16 v[86:87], v13 offset:62464
    v_mfma_f32_16x16x32_bf16 v[204:207], v[92:95], v[156:159], v[204:207]
    ds_read_b64_tr_b16 v[88:89], v14 offset:61440
    v_mfma_f32_16x16x32_bf16 v[196:199], v[92:95], v[152:155], v[196:199]
    ds_read_b64_tr_b16 v[90:91], v14 offset:62464
    s_waitcnt vmcnt(2) lgkmcnt(10)
    v_mfma_f32_16x16x32_bf16 v[176:179], v[64:67], v[160:163], v[176:179]
    ds_read_b64_tr_b16 v[92:93], v15 offset:61440
    v_mfma_f32_16x16x32_bf16 v[184:187], v[64:67], v[164:167], v[184:187]
    ds_read_b64_tr_b16 v[94:95], v15 offset:62464
    v_mfma_f32_16x16x32_bf16 v[188:191], v[68:71], v[164:167], v[188:191]
    v_mfma_f32_16x16x32_bf16 v[180:183], v[68:71], v[160:163], v[180:183]
    s_waitcnt lgkmcnt(8)
    v_mfma_f32_16x16x32_bf16 v[192:195], v[72:75], v[160:163], v[192:195]
    v_mfma_f32_16x16x32_bf16 v[200:203], v[72:75], v[164:167], v[200:203]
    v_mfma_f32_16x16x32_bf16 v[204:207], v[76:79], v[164:167], v[204:207]
    v_mfma_f32_16x16x32_bf16 v[196:199], v[76:79], v[160:163], v[196:199]
    s_waitcnt vmcnt(0) lgkmcnt(4)
    v_mfma_f32_16x16x32_bf16 v[176:179], v[80:83], v[168:171], v[176:179]
    v_mfma_f32_16x16x32_bf16 v[184:187], v[80:83], v[172:175], v[184:187]
    v_mfma_f32_16x16x32_bf16 v[188:191], v[84:87], v[172:175], v[188:191]
    v_mfma_f32_16x16x32_bf16 v[180:183], v[84:87], v[168:171], v[180:183]
    s_waitcnt lgkmcnt(0)
    v_mfma_f32_16x16x32_bf16 v[192:195], v[88:91], v[168:171], v[192:195]
    v_mfma_f32_16x16x32_bf16 v[200:203], v[88:91], v[172:175], v[200:203]
    v_mfma_f32_16x16x32_bf16 v[204:207], v[92:95], v[172:175], v[204:207]
    v_mfma_f32_16x16x32_bf16 v[196:199], v[92:95], v[168:171], v[196:199]
    s_cmp_eq_u32 s9, 3
    s_cbranch_scc1 c_wo_fin
    s_add_u32 s58, s58, 4194304
    v_pk_add_f32 v[32:33], v[32:33], v[176:177]
    v_pk_add_f32 v[34:35], v[34:35], v[178:179]
    v_pk_add_f32 v[36:37], v[36:37], v[180:181]
    v_pk_add_f32 v[38:39], v[38:39], v[182:183]
    v_cvt_pk_bf16_f32 v96, v32, v33
    v_cvt_pk_bf16_f32 v97, v34, v35
    v_cvt_pk_bf16_f32 v98, v36, v37
    v_cvt_pk_bf16_f32 v99, v38, v39
    buffer_store_dwordx4 v[96:99], v6, s[12:15], s58 offen offset:0 sc1
    v_pk_add_f32 v[40:41], v[40:41], v[184:185]
    v_pk_add_f32 v[42:43], v[42:43], v[186:187]
    v_pk_add_f32 v[44:45], v[44:45], v[188:189]
    v_pk_add_f32 v[46:47], v[46:47], v[190:191]
    v_cvt_pk_bf16_f32 v100, v40, v41
    v_cvt_pk_bf16_f32 v101, v42, v43
    v_cvt_pk_bf16_f32 v102, v44, v45
    v_cvt_pk_bf16_f32 v103, v46, v47
    buffer_store_dwordx4 v[100:103], v6, s[12:15], s58 offen offset:256 sc1
    v_pk_add_f32 v[48:49], v[48:49], v[192:193]
    v_pk_add_f32 v[50:51], v[50:51], v[194:195]
    v_pk_add_f32 v[52:53], v[52:53], v[196:197]
    v_pk_add_f32 v[54:55], v[54:55], v[198:199]
    v_cvt_pk_bf16_f32 v104, v48, v49
    v_cvt_pk_bf16_f32 v105, v50, v51
    v_cvt_pk_bf16_f32 v106, v52, v53
    v_cvt_pk_bf16_f32 v107, v54, v55
    buffer_store_dwordx4 v[104:107], v6, s[12:15], s58 offen offset:2048 sc1
    v_pk_add_f32 v[56:57], v[56:57], v[200:201]
    v_pk_add_f32 v[58:59], v[58:59], v[202:203]
    v_pk_add_f32 v[60:61], v[60:61], v[204:205]
    v_pk_add_f32 v[62:63], v[62:63], v[206:207]
    v_cvt_pk_bf16_f32 v108, v56, v57
    v_cvt_pk_bf16_f32 v109, v58, v59
    v_cvt_pk_bf16_f32 v110, v60, v61
    v_cvt_pk_bf16_f32 v111, v62, v63
    buffer_store_dwordx4 v[108:111], v6, s[12:15], s58 offen offset:2304 sc1
    s_barrier
c_wo_stat:
    s_mov_b32 s55, 0x3f803f80
    v_dot2_f32_bf16 v18, v96, s55, 0
    v_dot2_f32_bf16 v19, v96, v96, 0
    v_dot2_f32_bf16 v20, v100, s55, 0
    v_dot2_f32_bf16 v21, v100, v100, 0
    v_dot2_f32_bf16 v18, v97, s55, v18
    v_dot2_f32_bf16 v19, v97, v97, v19
    v_dot2_f32_bf16 v20, v101, s55, v20
    v_dot2_f32_bf16 v21, v101, v101, v21
    v_dot2_f32_bf16 v18, v98, s55, v18
    v_dot2_f32_bf16 v19, v98, v98, v19
    v_dot2_f32_bf16 v20, v102, s55, v20
    v_dot2_f32_bf16 v21, v102, v102, v21
    v_dot2_f32_bf16 v18, v99, s55, v18
    v_dot2_f32_bf16 v19, v99, v99, v19
    v_dot2_f32_bf16 v20, v103, s55, v20
    v_dot2_f32_bf16 v21, v103, v103, v21
    v_dot2_f32_bf16 v18, v104, s55, v18
    v_dot2_f32_bf16 v19, v104, v104, v19
    v_dot2_f32_bf16 v20, v108, s55, v20
    v_dot2_f32_bf16 v21, v108, v108, v21
    v_dot2_f32_bf16 v18, v105, s55, v18
    v_dot2_f32_bf16 v19, v105, v105, v19
    v_dot2_f32_bf16 v20, v109, s55, v20
    v_dot2_f32_bf16 v21, v109, v109, v21
    v_dot2_f32_bf16 v18, v106, s55, v18
    v_dot2_f32_bf16 v19, v106, v106, v19
    v_dot2_f32_bf16 v20, v110, s55, v20
    v_dot2_f32_bf16 v21, v110, v110, v21
    v_dot2_f32_bf16 v18, v107, s55, v18
    v_dot2_f32_bf16 v19, v107, v107, v19
    v_dot2_f32_bf16 v20, v111, s55, v20
    v_dot2_f32_bf16 v21, v111, v111, v21
    v_lshlrev_b32 v16, 3, v1
    s_lshl_b32 s3, s48, 12
    s_lshl_b32 s55, s7, 8
    s_add_u32 s3, s3, s55
    v_permlane16_swap_b32 v18, v20
    v_permlane16_swap_b32 v19, v21
    s_lshl_b32 s55, s9, 18
    v_pk_add_f32 v[18:19], v[18:19], v[20:21]
    s_add_u32 s3, s3, s55
    s_add_u32 s3, s3, 63176704
    v_permlane32_swap_b32 v18, v20
    v_permlane32_swap_b32 v19, v21
    v_pk_add_f32 v[18:19], v[18:19], v[20:21]
    s_mov_b32 exec_hi, 0
    buffer_store_dwordx2 v[18:19], v16, s[12:15], s3 offen sc1
    s_mov_b64 exec, -1
    s_cmp_lg_u32 s9, -1
    s_cbranch_scc1 c_wo_pub
    v_mov_b32 v24, 159492
non_7:
    ds_read_b32 v25, v24
    s_waitcnt lgkmcnt(0)
    v_readfirstlane_b32 s10, v25
    s_cmp_eq_u32 s10, 0
    s_cbranch_scc1 non_7
c_wo_pub:
    s_mul_i32 s55, s9, 786432
    s_add_u32 s55, s55, 66060288
    v_and_b32 v24, 63, v0
    s_and_b32 s56, s11, 0xe0
    v_lshrrev_b32 v25, 5, v24
    v_add_u32 v24, s56, v24
    v_and_b32 v24, 255, v24
    v_lshlrev_b32 v24, 10, v24
    v_lshl_add_u32 v24, v25, 8, v24
    s_bfe_u32 s56, s11, 0x20003
    s_and_b32 s57, s11, 7
    s_lshl_b32 s56, s56, 7
    s_lshl_b32 s57, s57, 2
    s_add_u32 s55, s55, s56
    s_add_u32 s55, s55, s57
    s_and_b32 s57, s6, s9
    s_bfe_i32 s57, s57, 0x10000
    v_mov_b32 v25, 159488
    v_mov_b32 v26, 1
    v_mov_b32 v27, s10
    s_mov_b64 exec, 1
    s_waitcnt vmcnt(0)
    ds_add_rtn_u32 v26, v25, v26
    s_waitcnt lgkmcnt(0)
    v_readfirstlane_b32 s56, v26
    s_and_b32 s56, s56, 3
    s_cmp_lg_u32 s56, 3
    s_cbranch_scc1 pub_8
    s_mov_b32 exec_lo, -1
    s_mov_b32 exec_hi, s57
    buffer_store_dword v27, v24, s[12:15], s55 offen sc1
pub_8:
    s_mov_b64 exec, -1
    s_cmp_eq_u32 s9, -1
    s_cbranch_scc1 c_wo_pub3
    s_barrier
c_wo_pub3:
    s_add_u32 s9, s9, 1
    s_bitcmp1_b32 s9, 0
    s_cbranch_scc1 c_qkvB
    s_branch c_qkvA
c_wo_fin:
    s_mov_b32 s28, s44
    s_mov_b32 s29, s45
    s_mov_b32 s30, 4194304
    s_mov_b32 s31, 0x00020000
    s_lshl_b32 s3, s48, 16
    s_lshl_b32 s55, s7, 7
    s_add_u32 s3, s3, s55
    v_pk_add_f32 v[32:33], v[32:33], v[176:177]
    v_pk_add_f32 v[34:35], v[34:35], v[178:179]
    v_pk_add_f32 v[36:37], v[36:37], v[180:181]
    v_pk_add_f32 v[38:39], v[38:39], v[182:183]
    v_cvt_pk_bf16_f32 v96, v32, v33
    v_cvt_pk_bf16_f32 v97, v34, v35
    v_cvt_pk_bf16_f32 v98, v36, v37
    v_cvt_pk_bf16_f32 v99, v38, v39
    ds_write_b64 v8, v[96:97] offset:0
    ds_write_b64 v8, v[98:99] offset:32
    v_pk_add_f32 v[40:41], v[40:41], v[184:185]
    v_pk_add_f32 v[42:43], v[42:43], v[186:187]
    v_pk_add_f32 v[44:45], v[44:45], v[188:189]
    v_pk_add_f32 v[46:47], v[46:47], v[190:191]
    v_cvt_pk_bf16_f32 v100, v40, v41
    v_cvt_pk_bf16_f32 v101, v42, v43
    v_cvt_pk_bf16_f32 v102, v44, v45
    v_cvt_pk_bf16_f32 v103, v46, v47
    ds_write_b64 v8, v[100:101] offset:2304
    ds_write_b64 v8, v[102:103] offset:2336
    v_pk_add_f32 v[48:49], v[48:49], v[192:193]
    v_pk_add_f32 v[50:51], v[50:51], v[194:195]
    v_pk_add_f32 v[52:53], v[52:53], v[196:197]
    v_pk_add_f32 v[54:55], v[54:55], v[198:199]
    v_cvt_pk_bf16_f32 v104, v48, v49
    v_cvt_pk_bf16_f32 v105, v50, v51
    v_cvt_pk_bf16_f32 v106, v52, v53
    v_cvt_pk_bf16_f32 v107, v54, v55
    ds_write_b64 v8, v[104:105] offset:64
    ds_write_b64 v8, v[106:107] offset:96
    v_pk_add_f32 v[56:57], v[56:57], v[200:201]
    v_pk_add_f32 v[58:59], v[58:59], v[202:203]
    v_pk_add_f32 v[60:61], v[60:61], v[204:205]
    v_pk_add_f32 v[62:63], v[62:63], v[206:207]
    v_cvt_pk_bf16_f32 v108, v56, v57
    v_cvt_pk_bf16_f32 v109, v58, v59
    v_cvt_pk_bf16_f32 v110, v60, v61
    v_cvt_pk_bf16_f32 v111, v62, v63
    ds_write_b64 v8, v[108:109] offset:2368
    ds_write_b64 v8, v[110:111] offset:2400
    s_waitcnt lgkmcnt(0)
    ds_read_b128 v[32:35], v9 offset:0
    ds_read_b128 v[36:39], v9 offset:1152
    ds_read_b128 v[40:43], v9 offset:2304
    ds_read_b128 v[44:47], v9 offset:3456
    s_waitcnt lgkmcnt(3)
    buffer_store_dwordx4 v[32:35], v10, s[28:31], s3 offen sc1
    s_add_u32 s3, s3, 16384
    s_waitcnt lgkmcnt(2)
    buffer_store_dwordx4 v[36:39], v10, s[28:31], s3 offen sc1
    s_add_u32 s3, s3, 16384
    s_waitcnt lgkmcnt(1)
    buffer_store_dwordx4 v[40:43], v10, s[28:31], s3 offen sc1
    s_add_u32 s3, s3, 16384
    s_waitcnt lgkmcnt(0)
    buffer_store_dwordx4 v[44:47], v10, s[28:31], s3 offen sc1
    s_add_u32 s3, s3, 16384
    s_branch k_exit
c_prep_tail:
    s_lshl_b32 s56, s7, 12
    s_add_u32 s58, s55, s56
    s_lshl_b32 s3, s8, 12
    s_add_u32 s3, s3, 131072
    v_lshrrev_b32 v18, 2, v17
    v_and_b32 v19, 1, v17
    v_lshl_add_u32 v18, v18, 1, v19
    v_lshlrev_b32 v18, 10, v18
    v_lshl_add_u32 v18, v16, 4, v18
    v_bfe_u32 v17, v17, 1, 1
    v_lshl_add_u32 v18, v17, 3, v18
    v_add_u32 v18, s3, v18
    v_and_b32 v16, 15, v1
    v_bfe_u32 v17, v1, 4, 1
    v_lshl_add_u32 v6, v17, 5, v16
    v_lshlrev_b32 v6, 4, v6
    v_lshrrev_b32 v17, 5, v1
    v_lshl_add_u32 v6, v17, 10, v6
    v_add_u32 v19, s3, v6
    s_waitcnt vmcnt(3)
    ds_write_b64 v18, v[32:33] offset:0
    ds_write_b64 v18, v[34:35] offset:512
    s_waitcnt vmcnt(2)
    ds_write_b64 v18, v[36:37] offset:128
    ds_write_b64 v18, v[38:39] offset:640
    s_waitcnt vmcnt(1)
    ds_write_b64 v18, v[40:41] offset:256
    ds_write_b64 v18, v[42:43] offset:768
    s_waitcnt vmcnt(0)
    ds_write_b64 v18, v[44:45] offset:384
    ds_write_b64 v18, v[46:47] offset:896
    s_waitcnt lgkmcnt(0)
    ds_read_b128 v[96:99], v19 offset:0
    ds_read_b128 v[100:103], v19 offset:256
    ds_read_b128 v[104:107], v19 offset:2048
    ds_read_b128 v[108:111], v19 offset:2304
    s_waitcnt lgkmcnt(3)
    buffer_store_dwordx4 v[96:99], v6, s[12:15], s58 offen offset:0 sc1
    s_waitcnt lgkmcnt(2)
    buffer_store_dwordx4 v[100:103], v6, s[12:15], s58 offen offset:256 sc1
    s_waitcnt lgkmcnt(1)
    buffer_store_dwordx4 v[104:107], v6, s[12:15], s58 offen offset:2048 sc1
    s_waitcnt lgkmcnt(0)
    buffer_store_dwordx4 v[108:111], v6, s[12:15], s58 offen offset:2304 sc1
    s_branch c_wo_stat
.p2align 6
c_qkvB:
    v_and_b32 v1, 63, v0
    v_lshrrev_b32 v2, 6, v0
    v_lshlrev_b32 v5, 4, v1
    v_lshrrev_b32 v3, 5, v1
    v_and_b32 v4, 15, v0
    v_bfe_u32 v7, v1, 4, 1
    v_lshl_add_u32 v6, v7, 5, v4
    v_lshlrev_b32 v6, 4, v6
    v_lshl_add_u32 v6, v3, 10, v6
    s_lshr_b32 s48, s6, 1
    s_lshl_b32 s48, s48, 2
    s_add_u32 s48, s48, s8
    s_lshl_b32 s55, s48, 17
    s_lshl_b32 s56, s9, 22
    s_add_u32 s55, s55, s56
    s_add_u32 s16, s4, s55
    s_addc_u32 s17, s5, 0
    s_mov_b32 s18, 65536
    s_mov_b32 s19, 0x00020000
    s_add_u32 s56, s55, 65536
    s_add_u32 s20, s4, s56
    s_addc_u32 s21, s5, 0
    s_mov_b32 s22, 65536
    s_mov_b32 s23, 0x00020000
    s_lshl_b32 s49, s7, 12
    s_add_u32 s49, s49, s55
    s_and_b32 s56, s6, 1
    s_lshl_b32 s56, s56, 11
    s_add_u32 s49, s49, s56
    s_add_u32 s49, s49, 16777216
    s_movk_i32 s54, 4096
    v_lshrrev_b32 v16, 2, v4
    v_lshl_add_u32 v18, v7, 2, v16
    v_lshl_add_u32 v18, v3, 4, v18
    v_lshlrev_b32 v18, 6, v18
    v_and_b32 v17, 3, v4
    v_lshl_add_u32 v18, v17, 3, v18
    v_lshl_add_u32 v26, v7, 5, v18
    v_xor_b32 v27, 32, v26
    v_mov_b32 v24, v26
    v_mov_b32 v25, v27
    v_and_b32 v18, 0x30, v1
    v_add_u32 v10, 155648, v18
    v_lshlrev_b32 v11, 2, v4
    v_add_u32 v11, 155648, v11
    v_lshl_add_u32 v8, v2, 8, v11
    v_lshl_add_u32 v9, v2, 8, v10
    s_lshr_b32 s3, s8, 1
    s_and_b32 s55, s8, 1
    s_lshl_b32 s3, s3, 14
    s_lshl_b32 s55, s55, 12
    s_add_u32 s3, s3, s55
    s_add_u32 s3, s3, 81920
    v_lshl_add_u32 v12, v3, 5, v4
    v_lshlrev_b32 v12, 4, v12
    v_lshl_add_u32 v12, v7, 10, v12
    v_add_u32 v12, s3, v12
    v_add_u32 v13, s3, v5
    s_lshr_b32 s84, s9, 1
    s_lshl_b32 s84, s84, 23
    s_lshl_b32 s3, s7, 19
    s_add_u32 s84, s84, s3
    s_and_b32 s3, s6, 1
    s_lshl_b32 s3, s3, 18
    s_add_u32 s84, s84, s3
    s_add_u32 s84, s84, 33554432
    s_lshr_b32 s86, s6, 1
    s_lshl_b32 s3, s86, 15
    s_add_u32 s84, s84, s3
    s_sub_u32 s84, s84, 81920
    s_add_u32 s85, s84, 8192
    s_mul_i32 s53, s9, 786432
    s_add_u32 s53, s53, 66322432
    s_and_b32 s3, s11, 31
    s_lshl_b32 s3, s3, 10
    s_add_u32 s53, s53, s3
    s_lshr_b32 s3, s86, 1
    s_lshl_b32 s3, s3, 7
    s_add_u32 s53, s53, s3
    s_and_b32 s3, s86, 1
    s_lshl_b32 s3, s3, 2
    s_add_u32 s3, s3, s8
    s_lshl_b32 s3, s3, 2
    s_add_u32 s53, s53, s3
    v_lshlrev_b32 v28, 15, v1
    v_mov_b32 v29, s10
    v_mov_b32 v32, 0
    v_mov_b32 v33, 0
    v_mov_b32 v34, 0
    v_mov_b32 v35, 0
    v_mov_b32 v36, 0
    v_mov_b32 v37, 0
    v_mov_b32 v38, 0
    v_mov_b32 v39, 0
    v_mov_b32 v40, 0
    v_mov_b32 v41, 0
    v_mov_b32 v42, 0
    v_mov_b32 v43, 0
    v_mov_b32 v44, 0
    v_mov_b32 v45, 0
    v_mov_b32 v46, 0
    v_mov_b32 v47, 0
    v_mov_b32 v48, 0
    v_mov_b32 v49, 0
    v_mov_b32 v50, 0
    v_mov_b32 v51, 0
    v_mov_b32 v52, 0
    v_mov_b32 v53, 0
    v_mov_b32 v54, 0
    v_mov_b32 v55, 0
    v_mov_b32 v56, 0
    v_mov_b32 v57, 0
    v_mov_b32 v58, 0
    v_mov_b32 v59, 0
    v_mov_b32 v60, 0
    v_mov_b32 v61, 0
    v_mov_b32 v62, 0
    v_mov_b32 v63, 0
    v_mov_b32 v64, 0
    v_mov_b32 v65, 0
    v_mov_b32 v66, 0
    v_mov_b32 v67, 0
    v_mov_b32 v68, 0
    v_mov_b32 v69, 0
    v_mov_b32 v70, 0
    v_mov_b32 v71, 0
    v_mov_b32 v72, 0
    v_mov_b32 v73, 0
    v_mov_b32 v74, 0
    v_mov_b32 v75, 0
    v_mov_b32 v76, 0
    v_mov_b32 v77, 0
    v_mov_b32 v78, 0
    v_mov_b32 v79, 0
    v_mov_b32 v80, 0
    v_mov_b32 v81, 0
    v_mov_b32 v82, 0
    v_mov_b32 v83, 0
    v_mov_b32 v84, 0
    v_mov_b32 v85, 0
    v_mov_b32 v86, 0
    v_mov_b32 v87, 0
    v_mov_b32 v88, 0
    v_mov_b32 v89, 0
    v_mov_b32 v90, 0
    v_mov_b32 v91, 0
    v_mov_b32 v92, 0
    v_mov_b32 v93, 0
    v_mov_b32 v94, 0
    v_mov_b32 v95, 0
    v_mov_b32 v96, 0
    v_mov_b32 v97, 0
    v_mov_b32 v98, 0
    v_mov_b32 v99, 0
    v_mov_b32 v100, 0
    v_mov_b32 v101, 0
    v_mov_b32 v102, 0
    v_mov_b32 v103, 0
    v_mov_b32 v104, 0
    v_mov_b32 v105, 0
    v_mov_b32 v106, 0
    v_mov_b32 v107, 0
    v_mov_b32 v108, 0
    v_mov_b32 v109, 0
    v_mov_b32 v110, 0
    v_mov_b32 v111, 0
    v_mov_b32 v112, 0
    v_mov_b32 v113, 0
    v_mov_b32 v114, 0
    v_mov_b32 v115, 0
    v_mov_b32 v116, 0
    v_mov_b32 v117, 0
    v_mov_b32 v118, 0
    v_mov_b32 v119, 0
    v_mov_b32 v120, 0
    v_mov_b32 v121, 0
    v_mov_b32 v122, 0
    v_mov_b32 v123, 0
    v_mov_b32 v124, 0
    v_mov_b32 v125, 0
    v_mov_b32 v126, 0
    v_mov_b32 v127, 0
    s_mov_b32 s50, 8192
    s_mov_b32 s58, 6144
    s_mov_b32 s51, 12288
    s_mov_b32 s59, 10240
    s_mov_b32 s52, 0
    s_mul_i32 s60, s9, 786432
    s_add_u32 s60, s60, 65273856
    s_lshl_b32 s61, s11, 10
    s_add_u32 s60, s60, s61
    s_and_b32 s61, s8, 2
    s_lshl_b32 s61, s61, 7
    s_add_u32 s60, s60, s61
    s_add_u32 s61, s60, 128
    s_mov_b32 s98, s10
    s_mov_b32 s99, s10
    s_mov_b32 s3, 0x100000
cp_9:
    s_load_dwordx8 s[64:71], s[4:5], s60 glc
    s_load_dwordx8 s[72:79], s[4:5], s61 glc
    s_sub_u32 s3, s3, 1
    s_cbranch_scc1 cp_9_ok
    s_waitcnt lgkmcnt(0)
    s_xor_b64 s[100:101], s[64:65], s[98:99]
    s_xor_b64 s[64:65], s[66:67], s[98:99]
    s_or_b64 s[100:101], s[100:101], s[64:65]
    s_xor_b64 s[64:65], s[68:69], s[98:99]
    s_or_b64 s[100:101], s[100:101], s[64:65]
    s_xor_b64 s[64:65], s[70:71], s[98:99]
    s_or_b64 s[100:101], s[100:101], s[64:65]
    s_xor_b64 s[64:65], s[72:73], s[98:99]
    s_or_b64 s[100:101], s[100:101], s[64:65]
    s_xor_b64 s[64:65], s[74:75], s[98:99]
    s_or_b64 s[100:101], s[100:101], s[64:65]
    s_xor_b64 s[64:65], s[76:77], s[98:99]
    s_or_b64 s[100:101], s[100:101], s[64:65]
    s_xor_b64 s[64:65], s[78:79], s[98:99]
    s_or_b64 s[100:101], s[100:101], s[64:65]
    s_cbranch_scc1 cp_9
cp_9_ok:
    s_waitcnt lgkmcnt(0)
    buffer_load_dwordx4 v[152:155], v6, s[16:19], 0 offen offset:0 sc1
    buffer_load_dwordx4 v[156:159], v6, s[16:19], 0 offen offset:256 sc1
    buffer_load_dwordx4 v[160:163], v6, s[20:23], 0 offen offset:0 sc1
    buffer_load_dwordx4 v[164:167], v6, s[20:23], 0 offen offset:256 sc1
    buffer_load_dwordx4 v[168:171], v6, s[16:19], 0 offen offset:2048 sc1
    buffer_load_dwordx4 v[172:175], v6, s[16:19], 0 offen offset:2304 sc1
    buffer_load_dwordx4 v[176:179], v6, s[20:23], 0 offen offset:2048 sc1
    buffer_load_dwordx4 v[180:183], v6, s[20:23], 0 offen offset:2304 sc1
    s_barrier
    ds_read_b64_tr_b16 v[128:129], v24 offset:0
    ds_read_b64_tr_b16 v[130:131], v24 offset:512
    ds_read_b64_tr_b16 v[132:133], v25 offset:0
    ds_read_b64_tr_b16 v[134:135], v25 offset:512
    ds_read_b64_tr_b16 v[136:137], v24 offset:8192
    ds_read_b64_tr_b16 v[138:139], v24 offset:8704
    ds_read_b64_tr_b16 v[140:141], v25 offset:8192
    ds_read_b64_tr_b16 v[142:143], v25 offset:8704
    ds_read_b64_tr_b16 v[144:145], v24 offset:16384
    ds_read_b64_tr_b16 v[146:147], v24 offset:16896
    buffer_load_dwordx4 a[0:3], v6, s[16:19], s54 offen offset:0 sc1
    buffer_load_dwordx4 a[4:7], v6, s[16:19], s54 offen offset:256 sc1
    buffer_load_dwordx4 a[8:11], v6, s[20:23], s54 offen offset:0 sc1
    buffer_load_dwordx4 a[12:15], v6, s[20:23], s54 offen offset:256 sc1
    buffer_load_dwordx4 a[16:19], v6, s[16:19], s54 offen offset:2048 sc1
    buffer_load_dwordx4 a[20:23], v6, s[16:19], s54 offen offset:2304 sc1
    s_mov_b32 s54, 7
.p2align 3
c_qkvB_loop:
    s_waitcnt vmcnt(12) lgkmcnt(8)
    v_mfma_f32_16x16x32_bf16 v[32:35], v[128:131], v[152:155], v[32:35]
    ds_read_b64_tr_b16 v[148:149], v25 offset:16384
    buffer_load_dwordx4 a[24:27], v6, s[20:23], s58 offen offset:0 sc1
    v_mfma_f32_16x16x32_bf16 v[36:39], v[128:131], v[156:159], v[36:39]
    ds_read_b64_tr_b16 v[150:151], v25 offset:16896
    s_waitcnt lgkmcnt(8)
    v_mfma_f32_16x16x32_bf16 v[52:55], v[132:135], v[156:159], v[52:55]
    v_mfma_f32_16x16x32_bf16 v[48:51], v[132:135], v[152:155], v[48:51]
    s_waitcnt lgkmcnt(6)
    v_mfma_f32_16x16x32_bf16 v[64:67], v[136:139], v[152:155], v[64:67]
    v_mfma_f32_16x16x32_bf16 v[68:71], v[136:139], v[156:159], v[68:71]
    s_waitcnt lgkmcnt(4)
    v_mfma_f32_16x16x32_bf16 v[84:87], v[140:143], v[156:159], v[84:87]
    buffer_load_dwordx4 a[28:31], v6, s[20:23], s58 offen offset:256 sc1
    v_mfma_f32_16x16x32_bf16 v[80:83], v[140:143], v[152:155], v[80:83]
    s_waitcnt lgkmcnt(2)
    v_mfma_f32_16x16x32_bf16 v[96:99], v[152:155], v[144:147], v[96:99]
    v_mfma_f32_16x16x32_bf16 v[100:103], v[156:159], v[144:147], v[100:103]
    s_waitcnt lgkmcnt(0)
    v_mfma_f32_16x16x32_bf16 v[116:119], v[156:159], v[148:151], v[116:119]
    v_mfma_f32_16x16x32_bf16 v[112:115], v[152:155], v[148:151], v[112:115]
    s_waitcnt vmcnt(12)
    v_mfma_f32_16x16x32_bf16 v[40:43], v[128:131], v[160:163], v[40:43]
    buffer_load_dwordx4 v[152:155], v6, s[16:19], s50 offen offset:0 sc1
    v_mfma_f32_16x16x32_bf16 v[44:47], v[128:131], v[164:167], v[44:47]
    v_mfma_f32_16x16x32_bf16 v[60:63], v[132:135], v[164:167], v[60:63]
    ds_read_b64_tr_b16 v[128:129], v24 offset:2048
    v_mfma_f32_16x16x32_bf16 v[56:59], v[132:135], v[160:163], v[56:59]
    ds_read_b64_tr_b16 v[130:131], v24 offset:2560
    v_mfma_f32_16x16x32_bf16 v[72:75], v[136:139], v[160:163], v[72:75]
    ds_read_b64_tr_b16 v[132:133], v25 offset:2048
    v_mfma_f32_16x16x32_bf16 v[76:79], v[136:139], v[164:167], v[76:79]
    ds_read_b64_tr_b16 v[134:135], v25 offset:2560
    v_mfma_f32_16x16x32_bf16 v[92:95], v[140:143], v[164:167], v[92:95]
    ds_read_b64_tr_b16 v[136:137], v24 offset:10240
    buffer_load_dwordx4 v[156:159], v6, s[16:19], s50 offen offset:256 sc1
    v_mfma_f32_16x16x32_bf16 v[88:91], v[140:143], v[160:163], v[88:91]
    ds_read_b64_tr_b16 v[138:139], v24 offset:10752
    v_mfma_f32_16x16x32_bf16 v[104:107], v[160:163], v[144:147], v[104:107]
    ds_read_b64_tr_b16 v[140:141], v25 offset:10240
    v_mfma_f32_16x16x32_bf16 v[108:111], v[164:167], v[144:147], v[108:111]
    ds_read_b64_tr_b16 v[142:143], v25 offset:10752
    v_mfma_f32_16x16x32_bf16 v[124:127], v[164:167], v[148:151], v[124:127]
    ds_read_b64_tr_b16 v[144:145], v24 offset:18432
    v_mfma_f32_16x16x32_bf16 v[120:123], v[160:163], v[148:151], v[120:123]
    ds_read_b64_tr_b16 v[146:147], v24 offset:18944
    s_waitcnt vmcnt(12) lgkmcnt(8)
    v_mfma_f32_16x16x32_bf16 v[32:35], v[128:131], v[168:171], v[32:35]
    ds_read_b64_tr_b16 v[148:149], v25 offset:18432
    buffer_load_dwordx4 v[160:163], v6, s[20:23], s58 offen offset:2048 sc1
    v_mfma_f32_16x16x32_bf16 v[36:39], v[128:131], v[172:175], v[36:39]
    ds_read_b64_tr_b16 v[150:151], v25 offset:18944
    s_waitcnt lgkmcnt(8)
    v_mfma_f32_16x16x32_bf16 v[52:55], v[132:135], v[172:175], v[52:55]
    v_mfma_f32_16x16x32_bf16 v[48:51], v[132:135], v[168:171], v[48:51]
    s_waitcnt lgkmcnt(6)
    v_mfma_f32_16x16x32_bf16 v[64:67], v[136:139], v[168:171], v[64:67]
    v_mfma_f32_16x16x32_bf16 v[68:71], v[136:139], v[172:175], v[68:71]
    s_waitcnt lgkmcnt(4)
    v_mfma_f32_16x16x32_bf16 v[84:87], v[140:143], v[172:175], v[84:87]
    buffer_load_dwordx4 v[164:167], v6, s[20:23], s58 offen offset:2304 sc1
    v_mfma_f32_16x16x32_bf16 v[80:83], v[140:143], v[168:171], v[80:83]
    s_waitcnt lgkmcnt(2)
    v_mfma_f32_16x16x32_bf16 v[96:99], v[168:171], v[144:147], v[96:99]
    v_mfma_f32_16x16x32_bf16 v[100:103], v[172:175], v[144:147], v[100:103]
    s_waitcnt lgkmcnt(0)
    v_mfma_f32_16x16x32_bf16 v[116:119], v[172:175], v[148:151], v[116:119]
    v_mfma_f32_16x16x32_bf16 v[112:115], v[168:171], v[148:151], v[112:115]
    s_waitcnt vmcnt(12)
    v_mfma_f32_16x16x32_bf16 v[40:43], v[128:131], v[176:179], v[40:43]
    buffer_load_dwordx4 v[168:171], v6, s[16:19], s50 offen offset:2048 sc1
    v_mfma_f32_16x16x32_bf16 v[44:47], v[128:131], v[180:183], v[44:47]
    v_mfma_f32_16x16x32_bf16 v[60:63], v[132:135], v[180:183], v[60:63]
    ds_read_b64_tr_b16 v[128:129], v24 offset:4096
    v_mfma_f32_16x16x32_bf16 v[56:59], v[132:135], v[176:179], v[56:59]
    ds_read_b64_tr_b16 v[130:131], v24 offset:4608
    v_mfma_f32_16x16x32_bf16 v[72:75], v[136:139], v[176:179], v[72:75]
    ds_read_b64_tr_b16 v[132:133], v25 offset:4096
    v_mfma_f32_16x16x32_bf16 v[76:79], v[136:139], v[180:183], v[76:79]
    ds_read_b64_tr_b16 v[134:135], v25 offset:4608
    v_mfma_f32_16x16x32_bf16 v[92:95], v[140:143], v[180:183], v[92:95]
    ds_read_b64_tr_b16 v[136:137], v24 offset:12288
    buffer_load_dwordx4 v[172:175], v6, s[16:19], s50 offen offset:2304 sc1
    v_mfma_f32_16x16x32_bf16 v[88:91], v[140:143], v[176:179], v[88:91]
    ds_read_b64_tr_b16 v[138:139], v24 offset:12800
    v_mfma_f32_16x16x32_bf16 v[104:107], v[176:179], v[144:147], v[104:107]
    ds_read_b64_tr_b16 v[140:141], v25 offset:12288
    v_mfma_f32_16x16x32_bf16 v[108:111], v[180:183], v[144:147], v[108:111]
    ds_read_b64_tr_b16 v[142:143], v25 offset:12800
    v_mfma_f32_16x16x32_bf16 v[124:127], v[180:183], v[148:151], v[124:127]
    ds_read_b64_tr_b16 v[144:145], v24 offset:20480
    v_mfma_f32_16x16x32_bf16 v[120:123], v[176:179], v[148:151], v[120:123]
    ds_read_b64_tr_b16 v[146:147], v24 offset:20992
    s_waitcnt vmcnt(12) lgkmcnt(8)
    v_mfma_f32_16x16x32_bf16 v[32:35], v[128:131], a[0:3], v[32:35]
    ds_read_b64_tr_b16 v[148:149], v25 offset:20480
    buffer_load_dwordx4 v[176:179], v6, s[20:23], s59 offen offset:0 sc1
    v_mfma_f32_16x16x32_bf16 v[36:39], v[128:131], a[4:7], v[36:39]
    ds_read_b64_tr_b16 v[150:151], v25 offset:20992
    s_waitcnt lgkmcnt(8)
    v_mfma_f32_16x16x32_bf16 v[52:55], v[132:135], a[4:7], v[52:55]
    s_add_u32 s58, s58, 8192
    v_mfma_f32_16x16x32_bf16 v[48:51], v[132:135], a[0:3], v[48:51]
    s_waitcnt lgkmcnt(6)
    v_mfma_f32_16x16x32_bf16 v[64:67], v[136:139], a[0:3], v[64:67]
    s_add_u32 s50, s50, 8192
    v_mfma_f32_16x16x32_bf16 v[68:71], v[136:139], a[4:7], v[68:71]
    s_waitcnt lgkmcnt(4)
    v_mfma_f32_16x16x32_bf16 v[84:87], v[140:143], a[4:7], v[84:87]
    buffer_load_dwordx4 v[180:183], v6, s[20:23], s59 offen offset:256 sc1
    v_mfma_f32_16x16x32_bf16 v[80:83], v[140:143], a[0:3], v[80:83]
    s_waitcnt lgkmcnt(2)
    v_mfma_f32_16x16x32_bf16 v[96:99], a[0:3], v[144:147], v[96:99]
    s_add_u32 s52, s52, 24576
    v_mfma_f32_16x16x32_bf16 v[100:103], a[4:7], v[144:147], v[100:103]
    s_cmp_eq_u32 s52, 147456
    s_waitcnt lgkmcnt(0)
    v_mfma_f32_16x16x32_bf16 v[116:119], a[4:7], v[148:151], v[116:119]
    s_cselect_b32 s52, 0, s52
    v_mfma_f32_16x16x32_bf16 v[112:115], a[0:3], v[148:151], v[112:115]
    s_waitcnt vmcnt(12)
    v_mfma_f32_16x16x32_bf16 v[40:43], v[128:131], a[8:11], v[40:43]
    buffer_load_dwordx4 a[0:3], v6, s[16:19], s51 offen offset:0 sc1
    v_mfma_f32_16x16x32_bf16 v[44:47], v[128:131], a[12:15], v[44:47]
    s_sub_u32 s54, s54, 1
    v_mfma_f32_16x16x32_bf16 v[60:63], v[132:135], a[12:15], v[60:63]
    ds_read_b64_tr_b16 v[128:129], v24 offset:6144
    v_mfma_f32_16x16x32_bf16 v[56:59], v[132:135], a[8:11], v[56:59]
    ds_read_b64_tr_b16 v[130:131], v24 offset:6656
    v_mfma_f32_16x16x32_bf16 v[72:75], v[136:139], a[8:11], v[72:75]
    ds_read_b64_tr_b16 v[132:133], v25 offset:6144
    v_mfma_f32_16x16x32_bf16 v[76:79], v[136:139], a[12:15], v[76:79]
    ds_read_b64_tr_b16 v[134:135], v25 offset:6656
    v_mfma_f32_16x16x32_bf16 v[92:95], v[140:143], a[12:15], v[92:95]
    ds_read_b64_tr_b16 v[136:137], v24 offset:14336
    buffer_load_dwordx4 a[4:7], v6, s[16:19], s51 offen offset:256 sc1
    v_mfma_f32_16x16x32_bf16 v[88:91], v[140:143], a[8:11], v[88:91]
    ds_read_b64_tr_b16 v[138:139], v24 offset:14848
    v_mfma_f32_16x16x32_bf16 v[104:107], a[8:11], v[144:147], v[104:107]
    ds_read_b64_tr_b16 v[140:141], v25 offset:14336
    v_mfma_f32_16x16x32_bf16 v[108:111], a[12:15], v[144:147], v[108:111]
    ds_read_b64_tr_b16 v[142:143], v25 offset:14848
    v_mfma_f32_16x16x32_bf16 v[124:127], a[12:15], v[148:151], v[124:127]
    ds_read_b64_tr_b16 v[144:145], v24 offset:22528
    v_mfma_f32_16x16x32_bf16 v[120:123], a[8:11], v[148:151], v[120:123]
    ds_read_b64_tr_b16 v[146:147], v24 offset:23040
    s_waitcnt vmcnt(12) lgkmcnt(8)
    v_mfma_f32_16x16x32_bf16 v[32:35], v[128:131], a[16:19], v[32:35]
    ds_read_b64_tr_b16 v[148:149], v25 offset:22528
    buffer_load_dwordx4 a[8:11], v6, s[20:23], s59 offen offset:2048 sc1
    v_mfma_f32_16x16x32_bf16 v[36:39], v[128:131], a[20:23], v[36:39]
    ds_read_b64_tr_b16 v[150:151], v25 offset:23040
    s_waitcnt lgkmcnt(8)
    v_mfma_f32_16x16x32_bf16 v[52:55], v[132:135], a[20:23], v[52:55]
    v_add_u32 v24, s52, v26
    v_mfma_f32_16x16x32_bf16 v[48:51], v[132:135], a[16:19], v[48:51]
    s_waitcnt lgkmcnt(6)
    v_mfma_f32_16x16x32_bf16 v[64:67], v[136:139], a[16:19], v[64:67]
    v_add_u32 v25, s52, v27
    v_mfma_f32_16x16x32_bf16 v[68:71], v[136:139], a[20:23], v[68:71]
    s_waitcnt lgkmcnt(4)
    v_mfma_f32_16x16x32_bf16 v[84:87], v[140:143], a[20:23], v[84:87]
    buffer_load_dwordx4 a[12:15], v6, s[20:23], s59 offen offset:2304 sc1
    v_mfma_f32_16x16x32_bf16 v[80:83], v[140:143], a[16:19], v[80:83]
    s_waitcnt lgkmcnt(2)
    v_mfma_f32_16x16x32_bf16 v[96:99], a[16:19], v[144:147], v[96:99]
    s_add_u32 s59, s59, 8192
    v_mfma_f32_16x16x32_bf16 v[100:103], a[20:23], v[144:147], v[100:103]
    s_waitcnt lgkmcnt(0)
    v_mfma_f32_16x16x32_bf16 v[116:119], a[20:23], v[148:151], v[116:119]
    v_mfma_f32_16x16x32_bf16 v[112:115], a[16:19], v[148:151], v[112:115]
    s_barrier
    s_waitcnt vmcnt(12)
    v_mfma_f32_16x16x32_bf16 v[40:43], v[128:131], a[24:27], v[40:43]
    buffer_load_dwordx4 a[16:19], v6, s[16:19], s51 offen offset:2048 sc1
    v_mfma_f32_16x16x32_bf16 v[44:47], v[128:131], a[28:31], v[44:47]
    v_mfma_f32_16x16x32_bf16 v[60:63], v[132:135], a[28:31], v[60:63]
    ds_read_b64_tr_b16 v[128:129], v24 offset:0
    v_mfma_f32_16x16x32_bf16 v[56:59], v[132:135], a[24:27], v[56:59]
    ds_read_b64_tr_b16 v[130:131], v24 offset:512
    v_mfma_f32_16x16x32_bf16 v[72:75], v[136:139], a[24:27], v[72:75]
    ds_read_b64_tr_b16 v[132:133], v25 offset:0
    v_mfma_f32_16x16x32_bf16 v[76:79], v[136:139], a[28:31], v[76:79]
    ds_read_b64_tr_b16 v[134:135], v25 offset:512
    v_mfma_f32_16x16x32_bf16 v[92:95], v[140:143], a[28:31], v[92:95]
    ds_read_b64_tr_b16 v[136:137], v24 offset:8192
    buffer_load_dwordx4 a[20:23], v6, s[16:19], s51 offen offset:2304 sc1
    v_mfma_f32_16x16x32_bf16 v[88:91], v[140:143], a[24:27], v[88:91]
    ds_read_b64_tr_b16 v[138:139], v24 offset:8704
    v_mfma_f32_16x16x32_bf16 v[104:107], a[24:27], v[144:147], v[104:107]
    ds_read_b64_tr_b16 v[140:141], v25 offset:8192
    s_add_u32 s51, s51, 8192
    v_mfma_f32_16x16x32_bf16 v[108:111], a[28:31], v[144:147], v[108:111]
    ds_read_b64_tr_b16 v[142:143], v25 offset:8704
    v_mfma_f32_16x16x32_bf16 v[124:127], a[28:31], v[148:151], v[124:127]
    ds_read_b64_tr_b16 v[144:145], v24 offset:16384
    s_cmp_lg_u32 s54, 0
    v_mfma_f32_16x16x32_bf16 v[120:123], a[24:27], v[148:151], v[120:123]
    ds_read_b64_tr_b16 v[146:147], v24 offset:16896
    s_cbranch_scc1 c_qkvB_loop
    s_waitcnt vmcnt(12) lgkmcnt(8)
    v_mfma_f32_16x16x32_bf16 v[32:35], v[128:131], v[152:155], v[32:35]
    ds_read_b64_tr_b16 v[148:149], v25 offset:16384
    buffer_load_dwordx4 a[24:27], v6, s[20:23], s58 offen offset:0 sc1
    v_mfma_f32_16x16x32_bf16 v[36:39], v[128:131], v[156:159], v[36:39]
    ds_read_b64_tr_b16 v[150:151], v25 offset:16896
    s_waitcnt lgkmcnt(8)
    v_mfma_f32_16x16x32_bf16 v[52:55], v[132:135], v[156:159], v[52:55]
    ds_read_b32 v184, v8 offset:1280
    v_mfma_f32_16x16x32_bf16 v[48:51], v[132:135], v[152:155], v[48:51]
    ds_read_b32 v186, v8 offset:1344
    s_waitcnt lgkmcnt(8)
    v_mfma_f32_16x16x32_bf16 v[64:67], v[136:139], v[152:155], v[64:67]
    ds_read_b32 v188, v8 offset:1408
    v_mfma_f32_16x16x32_bf16 v[68:71], v[136:139], v[156:159], v[68:71]
    s_waitcnt lgkmcnt(7)
    v_mfma_f32_16x16x32_bf16 v[84:87], v[140:143], v[156:159], v[84:87]
    buffer_load_dwordx4 a[28:31], v6, s[20:23], s58 offen offset:256 sc1
    ds_read_b32 v190, v8 offset:1472
    v_mfma_f32_16x16x32_bf16 v[80:83], v[140:143], v[152:155], v[80:83]
    ds_read_b128 v[212:215], v10 offset:512
    s_waitcnt lgkmcnt(7)
    v_mfma_f32_16x16x32_bf16 v[96:99], v[152:155], v[144:147], v[96:99]
    ds_read_b128 v[216:219], v10 offset:576
    v_mfma_f32_16x16x32_bf16 v[100:103], v[156:159], v[144:147], v[100:103]
    s_waitcnt lgkmcnt(6)
    v_mfma_f32_16x16x32_bf16 v[116:119], v[156:159], v[148:151], v[116:119]
    v_mfma_f32_16x16x32_bf16 v[112:115], v[152:155], v[148:151], v[112:115]
    s_waitcnt vmcnt(12)
    v_mfma_f32_16x16x32_bf16 v[40:43], v[128:131], v[160:163], v[40:43]
    s_waitcnt lgkmcnt(0)
    v_fma_f32 v64, -v184, v212, v64
    v_fma_f32 v65, -v184, v213, v65
    v_mfma_f32_16x16x32_bf16 v[44:47], v[128:131], v[164:167], v[44:47]
    v_fma_f32 v66, -v184, v214, v66
    v_mfma_f32_16x16x32_bf16 v[60:63], v[132:135], v[164:167], v[60:63]
    ds_read_b64_tr_b16 v[128:129], v24 offset:2048
    v_fma_f32 v67, -v184, v215, v67
    v_mfma_f32_16x16x32_bf16 v[56:59], v[132:135], v[160:163], v[56:59]
    ds_read_b64_tr_b16 v[130:131], v24 offset:2560
    v_fma_f32 v68, -v186, v212, v68
    v_fma_f32 v69, -v186, v213, v69
    v_mfma_f32_16x16x32_bf16 v[72:75], v[136:139], v[160:163], v[72:75]
    ds_read_b64_tr_b16 v[132:133], v25 offset:2048
    v_fma_f32 v70, -v186, v214, v70
    v_mfma_f32_16x16x32_bf16 v[76:79], v[136:139], v[164:167], v[76:79]
    ds_read_b64_tr_b16 v[134:135], v25 offset:2560
    v_fma_f32 v71, -v186, v215, v71
    v_mfma_f32_16x16x32_bf16 v[92:95], v[140:143], v[164:167], v[92:95]
    ds_read_b64_tr_b16 v[136:137], v24 offset:10240
    v_fma_f32 v80, -v184, v216, v80
    v_fma_f32 v81, -v184, v217, v81
    v_mfma_f32_16x16x32_bf16 v[88:91], v[140:143], v[160:163], v[88:91]
    ds_read_b64_tr_b16 v[138:139], v24 offset:10752
    v_fma_f32 v82, -v184, v218, v82
    v_mfma_f32_16x16x32_bf16 v[104:107], v[160:163], v[144:147], v[104:107]
    ds_read_b64_tr_b16 v[140:141], v25 offset:10240
    v_fma_f32 v83, -v184, v219, v83
    v_mfma_f32_16x16x32_bf16 v[108:111], v[164:167], v[144:147], v[108:111]
    ds_read_b64_tr_b16 v[142:143], v25 offset:10752
    v_fma_f32 v84, -v186, v216, v84
    v_fma_f32 v85, -v186, v217, v85
    v_mfma_f32_16x16x32_bf16 v[124:127], v[164:167], v[148:151], v[124:127]
    ds_read_b64_tr_b16 v[144:145], v24 offset:18432
    v_fma_f32 v86, -v186, v218, v86
    v_mfma_f32_16x16x32_bf16 v[120:123], v[160:163], v[148:151], v[120:123]
    ds_read_b64_tr_b16 v[146:147], v24 offset:18944
    v_fma_f32 v87, -v186, v219, v87
    s_waitcnt vmcnt(10) lgkmcnt(8)
    v_mfma_f32_16x16x32_bf16 v[32:35], v[128:131], v[168:171], v[32:35]
    ds_read_b64_tr_b16 v[148:149], v25 offset:18432
    v_fma_f32 v72, -v188, v212, v72
    v_fma_f32 v73, -v188, v213, v73
    v_mfma_f32_16x16x32_bf16 v[36:39], v[128:131], v[172:175], v[36:39]
    ds_read_b64_tr_b16 v[150:151], v25 offset:18944
    v_fma_f32 v74, -v188, v214, v74
    s_waitcnt lgkmcnt(8)
    v_mfma_f32_16x16x32_bf16 v[52:55], v[132:135], v[172:175], v[52:55]
    v_fma_f32 v75, -v188, v215, v75
    ds_read_b128 v[152:155], v10 offset:384
    v_mfma_f32_16x16x32_bf16 v[48:51], v[132:135], v[168:171], v[48:51]
    v_fma_f32 v76, -v190, v212, v76
    v_fma_f32 v77, -v190, v213, v77
    ds_read_b128 v[156:159], v10 offset:448
    s_waitcnt lgkmcnt(8)
    v_mfma_f32_16x16x32_bf16 v[64:67], v[136:139], v[168:171], v[64:67]
    v_fma_f32 v78, -v190, v214, v78
    ds_read_b32 v185, v8 offset:2816
    v_mfma_f32_16x16x32_bf16 v[68:71], v[136:139], v[172:175], v[68:71]
    v_fma_f32 v79, -v190, v215, v79
    s_waitcnt lgkmcnt(7)
    v_mfma_f32_16x16x32_bf16 v[84:87], v[140:143], v[172:175], v[84:87]
    v_fma_f32 v88, -v188, v216, v88
    v_fma_f32 v89, -v188, v217, v89
    ds_read_b32 v187, v8 offset:2880
    v_mfma_f32_16x16x32_bf16 v[80:83], v[140:143], v[168:171], v[80:83]
    v_fma_f32 v90, -v188, v218, v90
    ds_read_b32 v189, v8 offset:2944
    s_waitcnt lgkmcnt(7)
    v_mfma_f32_16x16x32_bf16 v[96:99], v[168:171], v[144:147], v[96:99]
    v_fma_f32 v91, -v188, v219, v91
    ds_read_b32 v191, v8 offset:3008
    v_mfma_f32_16x16x32_bf16 v[100:103], v[172:175], v[144:147], v[100:103]
    v_fma_f32 v92, -v190, v216, v92
    v_fma_f32 v93, -v190, v217, v93
    s_waitcnt lgkmcnt(6)
    v_mfma_f32_16x16x32_bf16 v[116:119], v[172:175], v[148:151], v[116:119]
    v_fma_f32 v94, -v190, v218, v94
    v_mfma_f32_16x16x32_bf16 v[112:115], v[168:171], v[148:151], v[112:115]
    v_fma_f32 v95, -v190, v219, v95
    s_waitcnt vmcnt(8)
    v_mfma_f32_16x16x32_bf16 v[40:43], v[128:131], v[176:179], v[40:43]
    s_waitcnt lgkmcnt(0)
    v_fma_f32 v32, -v184, v152, v32
    v_fma_f32 v33, -v184, v153, v33
    v_mfma_f32_16x16x32_bf16 v[44:47], v[128:131], v[180:183], v[44:47]
    v_fma_f32 v34, -v184, v154, v34
    v_mfma_f32_16x16x32_bf16 v[60:63], v[132:135], v[180:183], v[60:63]
    ds_read_b64_tr_b16 v[128:129], v24 offset:4096
    v_fma_f32 v35, -v184, v155, v35
    v_fma_f32 v36, -v186, v152, v36
    v_mfma_f32_16x16x32_bf16 v[56:59], v[132:135], v[176:179], v[56:59]
    ds_read_b64_tr_b16 v[130:131], v24 offset:4608
    v_fma_f32 v37, -v186, v153, v37
    v_mfma_f32_16x16x32_bf16 v[72:75], v[136:139], v[176:179], v[72:75]
    ds_read_b64_tr_b16 v[132:133], v25 offset:4096
    v_fma_f32 v38, -v186, v154, v38
    v_fma_f32 v39, -v186, v155, v39
    v_mfma_f32_16x16x32_bf16 v[76:79], v[136:139], v[180:183], v[76:79]
    ds_read_b64_tr_b16 v[134:135], v25 offset:4608
    v_fma_f32 v48, -v184, v156, v48
    v_mfma_f32_16x16x32_bf16 v[92:95], v[140:143], v[180:183], v[92:95]
    ds_read_b64_tr_b16 v[136:137], v24 offset:12288
    v_fma_f32 v49, -v184, v157, v49
    v_fma_f32 v50, -v184, v158, v50
    v_mfma_f32_16x16x32_bf16 v[88:91], v[140:143], v[176:179], v[88:91]
    ds_read_b64_tr_b16 v[138:139], v24 offset:12800
    v_fma_f32 v51, -v184, v159, v51
    v_mfma_f32_16x16x32_bf16 v[104:107], v[176:179], v[144:147], v[104:107]
    ds_read_b64_tr_b16 v[140:141], v25 offset:12288
    v_fma_f32 v52, -v186, v156, v52
    v_fma_f32 v53, -v186, v157, v53
    v_mfma_f32_16x16x32_bf16 v[108:111], v[180:183], v[144:147], v[108:111]
    ds_read_b64_tr_b16 v[142:143], v25 offset:12800
    v_fma_f32 v54, -v186, v158, v54
    v_mfma_f32_16x16x32_bf16 v[124:127], v[180:183], v[148:151], v[124:127]
    ds_read_b64_tr_b16 v[144:145], v24 offset:20480
    v_fma_f32 v55, -v186, v159, v55
    v_mfma_f32_16x16x32_bf16 v[120:123], v[176:179], v[148:151], v[120:123]
    ds_read_b64_tr_b16 v[146:147], v24 offset:20992
    s_waitcnt vmcnt(6) lgkmcnt(8)
    v_mfma_f32_16x16x32_bf16 v[32:35], v[128:131], a[0:3], v[32:35]
    ds_read_b64_tr_b16 v[148:149], v25 offset:20480
    v_fma_f32 v40, -v188, v152, v40
    v_fma_f32 v41, -v188, v153, v41
    v_mfma_f32_16x16x32_bf16 v[36:39], v[128:131], a[4:7], v[36:39]
    ds_read_b64_tr_b16 v[150:151], v25 offset:20992
    v_fma_f32 v42, -v188, v154, v42
    s_waitcnt lgkmcnt(8)
    v_mfma_f32_16x16x32_bf16 v[52:55], v[132:135], a[4:7], v[52:55]
    v_fma_f32 v43, -v188, v155, v43
    v_fma_f32 v44, -v190, v152, v44
    ds_read_b128 v[168:171], v9 offset:1280
    v_mfma_f32_16x16x32_bf16 v[48:51], v[132:135], a[0:3], v[48:51]
    v_fma_f32 v45, -v190, v153, v45
    ds_read_b128 v[172:175], v9 offset:1344
    s_waitcnt lgkmcnt(8)
    v_mfma_f32_16x16x32_bf16 v[64:67], v[136:139], a[0:3], v[64:67]
    v_fma_f32 v46, -v190, v154, v46
    v_fma_f32 v47, -v190, v155, v47
    v_mfma_f32_16x16x32_bf16 v[68:71], v[136:139], a[4:7], v[68:71]
    v_fma_f32 v56, -v188, v156, v56
    ds_read_b128 v[176:179], v9 offset:1408
    s_waitcnt lgkmcnt(7)
    v_mfma_f32_16x16x32_bf16 v[84:87], v[140:143], a[4:7], v[84:87]
    v_fma_f32 v57, -v188, v157, v57
    v_fma_f32 v58, -v188, v158, v58
    ds_read_b128 v[180:183], v9 offset:1472
    v_mfma_f32_16x16x32_bf16 v[80:83], v[140:143], a[0:3], v[80:83]
    v_fma_f32 v59, -v188, v159, v59
    s_waitcnt lgkmcnt(6)
    v_mfma_f32_16x16x32_bf16 v[96:99], a[0:3], v[144:147], v[96:99]
    v_fma_f32 v60, -v190, v156, v60
    v_fma_f32 v61, -v190, v157, v61
    ds_read2_b32 v[220:221], v11 offset0:160 offset1:176
    v_mfma_f32_16x16x32_bf16 v[100:103], a[4:7], v[144:147], v[100:103]
    v_fma_f32 v62, -v190, v158, v62
    s_waitcnt lgkmcnt(5)
    v_mfma_f32_16x16x32_bf16 v[116:119], a[4:7], v[148:151], v[116:119]
    v_fma_f32 v63, -v190, v159, v63
    v_mfma_f32_16x16x32_bf16 v[112:115], a[0:3], v[148:151], v[112:115]
    s_waitcnt vmcnt(4)
    v_mfma_f32_16x16x32_bf16 v[40:43], v[128:131], a[8:11], v[40:43]
    v_mfma_f32_16x16x32_bf16 v[44:47], v[128:131], a[12:15], v[44:47]
    s_waitcnt lgkmcnt(0)
    v_fma_f32 v96, -v168, v220, v96
    v_fma_f32 v97, -v169, v220, v97
    v_mfma_f32_16x16x32_bf16 v[60:63], v[132:135], a[12:15], v[60:63]
    ds_read_b64_tr_b16 v[128:129], v24 offset:6144
    v_fma_f32 v98, -v170, v220, v98
    v_mfma_f32_16x16x32_bf16 v[56:59], v[132:135], a[8:11], v[56:59]
    ds_read_b64_tr_b16 v[130:131], v24 offset:6656
    v_fma_f32 v99, -v171, v220, v99
    v_fma_f32 v100, -v172, v220, v100
    v_mfma_f32_16x16x32_bf16 v[72:75], v[136:139], a[8:11], v[72:75]
    ds_read_b64_tr_b16 v[132:133], v25 offset:6144
    v_fma_f32 v101, -v173, v220, v101
    v_mfma_f32_16x16x32_bf16 v[76:79], v[136:139], a[12:15], v[76:79]
    ds_read_b64_tr_b16 v[134:135], v25 offset:6656
    v_fma_f32 v102, -v174, v220, v102
    v_fma_f32 v103, -v175, v220, v103
    v_mfma_f32_16x16x32_bf16 v[92:95], v[140:143], a[12:15], v[92:95]
    ds_read_b64_tr_b16 v[136:137], v24 offset:14336
    v_fma_f32 v112, -v168, v221, v112
    v_mfma_f32_16x16x32_bf16 v[88:91], v[140:143], a[8:11], v[88:91]
    ds_read_b64_tr_b16 v[138:139], v24 offset:14848
    v_fma_f32 v113, -v169, v221, v113
    v_fma_f32 v114, -v170, v221, v114
    v_mfma_f32_16x16x32_bf16 v[104:107], a[8:11], v[144:147], v[104:107]
    ds_read_b64_tr_b16 v[140:141], v25 offset:14336
    v_fma_f32 v115, -v171, v221, v115
    v_mfma_f32_16x16x32_bf16 v[108:111], a[12:15], v[144:147], v[108:111]
    ds_read_b64_tr_b16 v[142:143], v25 offset:14848
    v_fma_f32 v116, -v172, v221, v116
    v_fma_f32 v117, -v173, v221, v117
    v_mfma_f32_16x16x32_bf16 v[124:127], a[12:15], v[148:151], v[124:127]
    ds_read_b64_tr_b16 v[144:145], v24 offset:22528
    v_fma_f32 v118, -v174, v221, v118
    v_mfma_f32_16x16x32_bf16 v[120:123], a[8:11], v[148:151], v[120:123]
    ds_read_b64_tr_b16 v[146:147], v24 offset:23040
    v_fma_f32 v119, -v175, v221, v119
    s_waitcnt vmcnt(2) lgkmcnt(8)
    v_mfma_f32_16x16x32_bf16 v[32:35], v[128:131], a[16:19], v[32:35]
    ds_read_b64_tr_b16 v[148:149], v25 offset:22528
    v_mfma_f32_16x16x32_bf16 v[36:39], v[128:131], a[20:23], v[36:39]
    ds_read_b64_tr_b16 v[150:151], v25 offset:23040
    v_fma_f32 v104, -v176, v220, v104
    v_fma_f32 v105, -v177, v220, v105
    s_waitcnt lgkmcnt(8)
    v_mfma_f32_16x16x32_bf16 v[52:55], v[132:135], a[20:23], v[52:55]
    v_fma_f32 v106, -v178, v220, v106
    ds_read_b128 v[152:155], v9 offset:2816
    v_mfma_f32_16x16x32_bf16 v[48:51], v[132:135], a[16:19], v[48:51]
    v_fma_f32 v107, -v179, v220, v107
    v_fma_f32 v108, -v180, v220, v108
    s_waitcnt lgkmcnt(7)
    v_mfma_f32_16x16x32_bf16 v[64:67], v[136:139], a[16:19], v[64:67]
    v_fma_f32 v109, -v181, v220, v109
    ds_read_b128 v[156:159], v9 offset:2880
    v_mfma_f32_16x16x32_bf16 v[68:71], v[136:139], a[20:23], v[68:71]
    v_fma_f32 v110, -v182, v220, v110
    v_fma_f32 v111, -v183, v220, v111
    s_waitcnt lgkmcnt(6)
    v_mfma_f32_16x16x32_bf16 v[84:87], v[140:143], a[20:23], v[84:87]
    v_fma_f32 v120, -v176, v221, v120
    ds_read_b128 v[160:163], v9 offset:2944
    v_mfma_f32_16x16x32_bf16 v[80:83], v[140:143], a[16:19], v[80:83]
    v_fma_f32 v121, -v177, v221, v121
    v_fma_f32 v122, -v178, v221, v122
    s_waitcnt lgkmcnt(5)
    v_mfma_f32_16x16x32_bf16 v[96:99], a[16:19], v[144:147], v[96:99]
    v_fma_f32 v123, -v179, v221, v123
    ds_read_b128 v[164:167], v9 offset:3008
    v_mfma_f32_16x16x32_bf16 v[100:103], a[20:23], v[144:147], v[100:103]
    v_fma_f32 v124, -v180, v221, v124
    v_fma_f32 v125, -v181, v221, v125
    s_waitcnt lgkmcnt(4)
    v_mfma_f32_16x16x32_bf16 v[116:119], a[20:23], v[148:151], v[116:119]
    v_fma_f32 v126, -v182, v221, v126
    v_mfma_f32_16x16x32_bf16 v[112:115], a[16:19], v[148:151], v[112:115]
    v_fma_f32 v127, -v183, v221, v127
    s_barrier
    s_waitcnt vmcnt(0)
    v_mfma_f32_16x16x32_bf16 v[40:43], v[128:131], a[24:27], v[40:43]
    v_mul_f32 v64, v185, v64
    v_mul_f32 v65, v185, v65
    v_mfma_f32_16x16x32_bf16 v[44:47], v[128:131], a[28:31], v[44:47]
    v_mul_f32 v66, v185, v66
    v_mul_f32 v67, v185, v67
    v_mfma_f32_16x16x32_bf16 v[60:63], v[132:135], a[28:31], v[60:63]
    v_mul_f32 v80, v185, v80
    v_mul_f32 v81, v185, v81
    v_mfma_f32_16x16x32_bf16 v[56:59], v[132:135], a[24:27], v[56:59]
    v_mul_f32 v82, v185, v82
    v_mul_f32 v83, v185, v83
    v_mfma_f32_16x16x32_bf16 v[72:75], v[136:139], a[24:27], v[72:75]
    v_cvt_pk_bf16_f32 v64, v64, v65
    v_cvt_pk_bf16_f32 v65, v66, v67
    v_mfma_f32_16x16x32_bf16 v[76:79], v[136:139], a[28:31], v[76:79]
    v_cvt_pk_bf16_f32 v66, v80, v81
    v_cvt_pk_bf16_f32 v67, v82, v83
    v_mfma_f32_16x16x32_bf16 v[92:95], v[140:143], a[28:31], v[92:95]
    v_mul_f32 v68, v187, v68
    v_mul_f32 v69, v187, v69
    v_mfma_f32_16x16x32_bf16 v[88:91], v[140:143], a[24:27], v[88:91]
    v_mul_f32 v70, v187, v70
    v_mul_f32 v71, v187, v71
    v_mfma_f32_16x16x32_bf16 v[104:107], a[24:27], v[144:147], v[104:107]
    v_mul_f32 v84, v187, v84
    v_mul_f32 v85, v187, v85
    v_mfma_f32_16x16x32_bf16 v[108:111], a[28:31], v[144:147], v[108:111]
    v_mul_f32 v86, v187, v86
    v_mul_f32 v87, v187, v87
    v_mfma_f32_16x16x32_bf16 v[124:127], a[28:31], v[148:151], v[124:127]
    v_cvt_pk_bf16_f32 v68, v68, v69
    v_cvt_pk_bf16_f32 v69, v70, v71
    v_mfma_f32_16x16x32_bf16 v[120:123], a[24:27], v[148:151], v[120:123]
    v_cvt_pk_bf16_f32 v70, v84, v85
    v_cvt_pk_bf16_f32 v71, v86, v87
    buffer_store_dwordx4 v[64:67], v12, s[12:15], s84 offen offset:0 sc1
    ds_write_b128 v12, v[64:67] offset:0
    buffer_store_dwordx4 v[68:71], v12, s[12:15], s84 offen offset:256 sc1
    ds_write_b128 v12, v[68:71] offset:256
    v_pk_mul_f32 v[72:73], v[188:189], v[72:73] op_sel:[1,0] op_sel_hi:[1,1]
    v_pk_mul_f32 v[74:75], v[188:189], v[74:75] op_sel:[1,0] op_sel_hi:[1,1]
    v_pk_mul_f32 v[88:89], v[188:189], v[88:89] op_sel:[1,0] op_sel_hi:[1,1]
    v_pk_mul_f32 v[90:91], v[188:189], v[90:91] op_sel:[1,0] op_sel_hi:[1,1]
    v_cvt_pk_bf16_f32 v72, v72, v73
    v_cvt_pk_bf16_f32 v73, v74, v75
    v_cvt_pk_bf16_f32 v74, v88, v89
    v_cvt_pk_bf16_f32 v75, v90, v91
    buffer_store_dwordx4 v[72:75], v12, s[12:15], s84 offen offset:2048 sc1
    ds_write_b128 v12, v[72:75] offset:2048
    v_pk_mul_f32 v[76:77], v[190:191], v[76:77] op_sel:[1,0] op_sel_hi:[1,1]
    v_pk_mul_f32 v[78:79], v[190:191], v[78:79] op_sel:[1,0] op_sel_hi:[1,1]
    v_pk_mul_f32 v[92:93], v[190:191], v[92:93] op_sel:[1,0] op_sel_hi:[1,1]
    v_pk_mul_f32 v[94:95], v[190:191], v[94:95] op_sel:[1,0] op_sel_hi:[1,1]
    v_cvt_pk_bf16_f32 v76, v76, v77
    v_cvt_pk_bf16_f32 v77, v78, v79
    v_cvt_pk_bf16_f32 v78, v92, v93
    v_cvt_pk_bf16_f32 v79, v94, v95
    buffer_store_dwordx4 v[76:79], v12, s[12:15], s84 offen offset:2304 sc1
    ds_write_b128 v12, v[76:79] offset:2304
    s_waitcnt lgkmcnt(4)
    v_pk_mul_f32 v[96:97], v[152:153], v[96:97]
    v_pk_mul_f32 v[98:99], v[154:155], v[98:99]
    v_pk_mul_f32 v[112:113], v[152:153], v[112:113]
    v_pk_mul_f32 v[114:115], v[154:155], v[114:115]
    v_cvt_pk_bf16_f32 v96, v96, v97
    v_cvt_pk_bf16_f32 v97, v98, v99
    v_cvt_pk_bf16_f32 v98, v112, v113
    v_cvt_pk_bf16_f32 v99, v114, v115
    v_mul_f32 v185, 0x3e8293ee, v185
    v_permlane16_swap_b32 v96, v98
    v_permlane16_swap_b32 v97, v99
    buffer_store_dwordx4 v[96:99], v13, s[12:15], s85 offen offset:0 sc1
    ds_write_b128 v13, v[96:99] offset:8192
    v_pk_mul_f32 v[100:101], v[156:157], v[100:101]
    v_pk_mul_f32 v[102:103], v[158:159], v[102:103]
    v_pk_mul_f32 v[116:117], v[156:157], v[116:117]
    v_pk_mul_f32 v[118:119], v[158:159], v[118:119]
    v_cvt_pk_bf16_f32 v100, v100, v101
    v_cvt_pk_bf16_f32 v101, v102, v103
    v_cvt_pk_bf16_f32 v102, v116, v117
    v_cvt_pk_bf16_f32 v103, v118, v119
    v_mul_f32 v187, 0x3e8293ee, v187
    v_permlane16_swap_b32 v100, v102
    v_permlane16_swap_b32 v101, v103
    buffer_store_dwordx4 v[100:103], v13, s[12:15], s85 offen offset:1024 sc1
    ds_write_b128 v13, v[100:103] offset:9216
    v_pk_mul_f32 v[104:105], v[160:161], v[104:105]
    v_pk_mul_f32 v[106:107], v[162:163], v[106:107]
    v_pk_mul_f32 v[120:121], v[160:161], v[120:121]
    v_pk_mul_f32 v[122:123], v[162:163], v[122:123]
    v_cvt_pk_bf16_f32 v104, v104, v105
    v_cvt_pk_bf16_f32 v105, v106, v107
    v_cvt_pk_bf16_f32 v106, v120, v121
    v_cvt_pk_bf16_f32 v107, v122, v123
    v_mul_f32 v189, 0x3e8293ee, v189
    v_permlane16_swap_b32 v104, v106
    v_permlane16_swap_b32 v105, v107
    buffer_store_dwordx4 v[104:107], v13, s[12:15], s85 offen offset:2048 sc1
    ds_write_b128 v13, v[104:107] offset:10240
    v_pk_mul_f32 v[108:109], v[164:165], v[108:109]
    v_pk_mul_f32 v[110:111], v[166:167], v[110:111]
    v_pk_mul_f32 v[124:125], v[164:165], v[124:125]
    v_pk_mul_f32 v[126:127], v[166:167], v[126:127]
    v_cvt_pk_bf16_f32 v108, v108, v109
    v_cvt_pk_bf16_f32 v109, v110, v111
    v_cvt_pk_bf16_f32 v110, v124, v125
    v_cvt_pk_bf16_f32 v111, v126, v127
    v_mul_f32 v191, 0x3e8293ee, v191
    v_permlane16_swap_b32 v108, v110
    v_permlane16_swap_b32 v109, v111
    buffer_store_dwordx4 v[108:111], v13, s[12:15], s85 offen offset:3072 sc1
    ds_write_b128 v13, v[108:111] offset:11264
    v_add_u32 v24, 81920, v5
    s_waitcnt lgkmcnt(0)
    s_barrier
    ds_read_b128 v[128:131], v24 offset:0
    ds_read_b128 v[132:135], v24 offset:1024
    ds_read_b128 v[136:139], v24 offset:2048
    ds_read_b128 v[140:143], v24 offset:3072
    v_pk_mul_f32 v[32:33], v[184:185], v[32:33] op_sel:[1,0] op_sel_hi:[1,1]
    v_pk_mul_f32 v[34:35], v[184:185], v[34:35] op_sel:[1,0] op_sel_hi:[1,1]
    v_pk_mul_f32 v[48:49], v[184:185], v[48:49] op_sel:[1,0] op_sel_hi:[1,1]
    v_pk_mul_f32 v[50:51], v[184:185], v[50:51] op_sel:[1,0] op_sel_hi:[1,1]
    v_cvt_pk_bf16_f32 v8, v32, v33
    v_cvt_pk_bf16_f32 v9, v34, v35
    v_cvt_pk_bf16_f32 v10, v48, v49
    v_cvt_pk_bf16_f32 v11, v50, v51
    v_pk_mul_f32 v[36:37], v[186:187], v[36:37] op_sel:[1,0] op_sel_hi:[1,1]
    v_pk_mul_f32 v[38:39], v[186:187], v[38:39] op_sel:[1,0] op_sel_hi:[1,1]
    v_pk_mul_f32 v[52:53], v[186:187], v[52:53] op_sel:[1,0] op_sel_hi:[1,1]
    v_pk_mul_f32 v[54:55], v[186:187], v[54:55] op_sel:[1,0] op_sel_hi:[1,1]
    v_cvt_pk_bf16_f32 v12, v36, v37
    v_cvt_pk_bf16_f32 v13, v38, v39
    v_cvt_pk_bf16_f32 v14, v52, v53
    v_cvt_pk_bf16_f32 v15, v54, v55
    v_pk_mul_f32 v[40:41], v[188:189], v[40:41] op_sel:[1,0] op_sel_hi:[1,1]
    v_pk_mul_f32 v[42:43], v[188:189], v[42:43] op_sel:[1,0] op_sel_hi:[1,1]
    v_pk_mul_f32 v[56:57], v[188:189], v[56:57] op_sel:[1,0] op_sel_hi:[1,1]
    v_pk_mul_f32 v[58:59], v[188:189], v[58:59] op_sel:[1,0] op_sel_hi:[1,1]
    v_cvt_pk_bf16_f32 v16, v40, v41
    v_cvt_pk_bf16_f32 v17, v42, v43
    v_cvt_pk_bf16_f32 v18, v56, v57
    v_cvt_pk_bf16_f32 v19, v58, v59
    v_pk_mul_f32 v[44:45], v[190:191], v[44:45] op_sel:[1,0] op_sel_hi:[1,1]
    v_pk_mul_f32 v[46:47], v[190:191], v[46:47] op_sel:[1,0] op_sel_hi:[1,1]
    v_pk_mul_f32 v[60:61], v[190:191], v[60:61] op_sel:[1,0] op_sel_hi:[1,1]
    v_pk_mul_f32 v[62:63], v[190:191], v[62:63] op_sel:[1,0] op_sel_hi:[1,1]
    v_cvt_pk_bf16_f32 v20, v44, v45
    v_cvt_pk_bf16_f32 v21, v46, v47
    v_cvt_pk_bf16_f32 v22, v60, v61
    v_cvt_pk_bf16_f32 v23, v62, v63
    v_permlane16_swap_b32 v8, v12
    v_permlane16_swap_b32 v9, v13
    v_permlane16_swap_b32 v10, v14
    v_permlane16_swap_b32 v11, v15
    v_permlane16_swap_b32 v16, v20
    v_permlane16_swap_b32 v17, v21
    v_permlane16_swap_b32 v18, v22
    v_permlane16_swap_b32 v19, v23
    s_waitcnt lgkmcnt(0)
    v_mfma_f32_32x32x16_bf16 v[64:79], v[128:131], v[8:11], 0
    v_mfma_f32_32x32x16_bf16 v[64:79], v[132:135], v[12:15], v[64:79]
    v_and_b32 v25, 7, v1
    v_mov_b32 v26, 0x3f803f80
    v_cmp_eq_u32 vcc, 0, v25
    s_nop 1
    v_cndmask_b32 v200, 0, v26, vcc
    v_cndmask_b32 v201, 0, v26, vcc
    v_cmp_eq_u32 vcc, 4, v25
    s_nop 1
    v_cndmask_b32 v202, 0, v26, vcc
    v_cndmask_b32 v203, 0, v26, vcc
    v_mov_b32 v204, 0xdddddddd
    v_mov_b32 v160, 0
    v_mov_b32 v161, 0
    v_mov_b32 v162, 0
    v_mov_b32 v163, 0
    v_mov_b32 v164, 0
    v_mov_b32 v165, 0
    v_mov_b32 v166, 0
    v_mov_b32 v167, 0
    v_mov_b32 v168, 0
    v_mov_b32 v169, 0
    v_mov_b32 v170, 0
    v_mov_b32 v171, 0
    v_mov_b32 v172, 0
    v_mov_b32 v173, 0
    v_mov_b32 v174, 0
    v_mov_b32 v175, 0
    v_mov_b32 v192, 0
    v_mov_b32 v193, 0
    v_mov_b32 v194, 0
    v_mov_b32 v195, 0
    v_mov_b32 v176, 0
    v_mov_b32 v177, 0
    v_mov_b32 v178, 0
    v_mov_b32 v179, 0
    v_mov_b32 v180, 0
    v_mov_b32 v181, 0
    v_mov_b32 v182, 0
    v_mov_b32 v183, 0
    v_mov_b32 v184, 0
    v_mov_b32 v185, 0
    v_mov_b32 v186, 0
    v_mov_b32 v187, 0
    v_mov_b32 v188, 0
    v_mov_b32 v189, 0
    v_mov_b32 v190, 0
    v_mov_b32 v191, 0
    v_mov_b32 v196, 0
    v_mov_b32 v197, 0
    v_mov_b32 v198, 0
    v_mov_b32 v199, 0
    v_mov_b32 v112, 0
    v_mov_b32 v113, 0
    v_mov_b32 v114, 0
    v_mov_b32 v115, 0
    v_mov_b32 v116, 0
    v_mov_b32 v117, 0
    v_mov_b32 v118, 0
    v_mov_b32 v119, 0
    v_mov_b32 v120, 0
    v_mov_b32 v121, 0
    v_mov_b32 v122, 0
    v_mov_b32 v123, 0
    v_mov_b32 v124, 0
    v_mov_b32 v125, 0
    v_mov_b32 v126, 0
    v_mov_b32 v127, 0
    v_mov_b32 v152, 0
    v_mov_b32 v153, 0
    v_mov_b32 v154, 0
    v_mov_b32 v155, 0
    v_mov_b32 v156, 0
    v_mov_b32 v157, 0
    v_mov_b32 v158, 0
    v_mov_b32 v159, 0
    s_mov_b32 s54, 4
    s_mov_b64 exec, 0xff
    s_waitcnt vmcnt(0)
    buffer_store_dword v29, v28, s[12:15], s53 offen sc1
    s_mov_b64 exec, -1
.p2align 3
c_attn_loop:
    v_mfma_f32_32x32x16_bf16 v[80:95], v[128:131], v[16:19], 0
    v_exp_f32 v64, v64
    v_exp_f32 v65, v65
    v_exp_f32 v66, v66
    v_mfma_f32_32x32x16_bf16 v[80:95], v[132:135], v[20:23], v[80:95]
    v_exp_f32 v67, v67
    v_exp_f32 v68, v68
    v_exp_f32 v69, v69
    v_smfmac_f32_32x32x32_bf16 v[176:191], v[152:155], v[112:119], v204
    s_waitcnt lgkmcnt(0)
    v_exp_f32 v70, v70
    v_exp_f32 v71, v71
    v_exp_f32 v72, v72
    v_smfmac_f32_16x16x64_bf16 v[196:199], v[200:203], v[112:119], v204
    ds_read_b128 v[144:147], v24 offset:8192
    v_exp_f32 v73, v73
    v_exp_f32 v74, v74
    v_smfmac_f32_32x32x32_bf16 v[176:191], v[156:159], v[120:127], v204
    v_exp_f32 v75, v75
    v_exp_f32 v76, v76
    v_exp_f32 v77, v77
    v_smfmac_f32_16x16x64_bf16 v[196:199], v[200:203], v[120:127], v204
    ds_read_b128 v[148:151], v24 offset:9216
    v_exp_f32 v78, v78
    v_exp_f32 v79, v79
    v_mfma_f32_32x32x16_bf16 v[96:111], v[136:139], v[8:11], 0
    v_exp_f32 v80, v80
    v_exp_f32 v81, v81
    v_exp_f32 v82, v82
    v_mfma_f32_32x32x16_bf16 v[96:111], v[140:143], v[12:15], v[96:111]
    s_waitcnt lgkmcnt(1)
    v_exp_f32 v83, v83
    v_exp_f32 v84, v84
    v_exp_f32 v85, v85
    v_smfmac_f32_32x32x32_bf16 v[160:175], v[144:147], v[64:71], v204
    s_waitcnt lgkmcnt(0)
    v_exp_f32 v86, v86
    v_exp_f32 v87, v87
    v_exp_f32 v88, v88
    v_smfmac_f32_16x16x64_bf16 v[192:195], v[200:203], v[64:71], v204
    ds_read_b128 v[128:131], v24 offset:4096
    v_exp_f32 v89, v89
    v_exp_f32 v90, v90
    v_smfmac_f32_32x32x32_bf16 v[160:175], v[148:151], v[72:79], v204
    v_exp_f32 v91, v91
    v_exp_f32 v92, v92
    v_exp_f32 v93, v93
    v_smfmac_f32_16x16x64_bf16 v[192:195], v[200:203], v[72:79], v204
    ds_read_b128 v[132:135], v24 offset:5120
    v_exp_f32 v94, v94
    v_exp_f32 v95, v95
    v_mfma_f32_32x32x16_bf16 v[112:127], v[136:139], v[16:19], 0
    v_exp_f32 v96, v96
    v_exp_f32 v97, v97
    v_exp_f32 v98, v98
    v_mfma_f32_32x32x16_bf16 v[112:127], v[140:143], v[20:23], v[112:127]
    v_exp_f32 v99, v99
    v_exp_f32 v100, v100
    v_exp_f32 v101, v101
    v_smfmac_f32_32x32x32_bf16 v[176:191], v[144:147], v[80:87], v204
    s_waitcnt lgkmcnt(0)
    v_exp_f32 v102, v102
    v_exp_f32 v103, v103
    v_exp_f32 v104, v104
    v_smfmac_f32_16x16x64_bf16 v[196:199], v[200:203], v[80:87], v204
    ds_read_b128 v[152:155], v24 offset:10240
    v_exp_f32 v105, v105
    v_exp_f32 v106, v106
    v_smfmac_f32_32x32x32_bf16 v[176:191], v[148:151], v[88:95], v204
    v_exp_f32 v107, v107
    v_exp_f32 v108, v108
    v_exp_f32 v109, v109
    v_smfmac_f32_16x16x64_bf16 v[196:199], v[200:203], v[88:95], v204
    ds_read_b128 v[156:159], v24 offset:11264
    v_exp_f32 v110, v110
    v_exp_f32 v111, v111
    v_mfma_f32_32x32x16_bf16 v[64:79], v[128:131], v[8:11], 0
    v_exp_f32 v112, v112
    v_exp_f32 v113, v113
    v_exp_f32 v114, v114
    v_mfma_f32_32x32x16_bf16 v[64:79], v[132:135], v[12:15], v[64:79]
    s_waitcnt lgkmcnt(1)
    v_exp_f32 v115, v115
    v_exp_f32 v116, v116
    v_exp_f32 v117, v117
    v_smfmac_f32_32x32x32_bf16 v[160:175], v[152:155], v[96:103], v204
    s_waitcnt lgkmcnt(0)
    v_exp_f32 v118, v118
    v_exp_f32 v119, v119
    v_exp_f32 v120, v120
    v_smfmac_f32_16x16x64_bf16 v[192:195], v[200:203], v[96:103], v204
    ds_read_b128 v[136:139], v24 offset:6144
    v_exp_f32 v121, v121
    v_exp_f32 v122, v122
    v_smfmac_f32_32x32x32_bf16 v[160:175], v[156:159], v[104:111], v204
    v_exp_f32 v123, v123
    v_exp_f32 v124, v124
    v_exp_f32 v125, v125
    v_smfmac_f32_16x16x64_bf16 v[192:195], v[200:203], v[104:111], v204
    ds_read_b128 v[140:143], v24 offset:7168
    v_exp_f32 v126, v126
    v_exp_f32 v127, v127
    v_mfma_f32_32x32x16_bf16 v[80:95], v[128:131], v[16:19], 0
    s_cmp_eq_u32 s54, 4
    v_exp_f32 v64, v64
    v_exp_f32 v65, v65
    v_exp_f32 v66, v66
    v_mfma_f32_32x32x16_bf16 v[80:95], v[132:135], v[20:23], v[80:95]
    v_exp_f32 v67, v67
    v_exp_f32 v68, v68
    v_exp_f32 v69, v69
    v_smfmac_f32_32x32x32_bf16 v[176:191], v[152:155], v[112:119], v204
    s_waitcnt lgkmcnt(0)
    v_exp_f32 v70, v70
    v_exp_f32 v71, v71
    v_exp_f32 v72, v72
    v_smfmac_f32_16x16x64_bf16 v[196:199], v[200:203], v[112:119], v204
    ds_read_b128 v[144:147], v24 offset:12288
    v_exp_f32 v73, v73
    v_exp_f32 v74, v74
    v_smfmac_f32_32x32x32_bf16 v[176:191], v[156:159], v[120:127], v204
    v_exp_f32 v75, v75
    v_exp_f32 v76, v76
    v_exp_f32 v77, v77
    v_smfmac_f32_16x16x64_bf16 v[196:199], v[200:203], v[120:127], v204
    ds_read_b128 v[148:151], v24 offset:13312
    v_exp_f32 v78, v78
    v_exp_f32 v79, v79
    v_mfma_f32_32x32x16_bf16 v[96:111], v[136:139], v[8:11], 0
    s_cbranch_scc1 c_attn_nobar
    s_barrier
c_attn_nobar:
    v_exp_f32 v80, v80
    v_exp_f32 v81, v81
    v_exp_f32 v82, v82
    v_mfma_f32_32x32x16_bf16 v[96:111], v[140:143], v[12:15], v[96:111]
    s_waitcnt lgkmcnt(1)
    v_exp_f32 v83, v83
    v_exp_f32 v84, v84
    v_exp_f32 v85, v85
    v_smfmac_f32_32x32x32_bf16 v[160:175], v[144:147], v[64:71], v204
    s_waitcnt lgkmcnt(0)
    v_exp_f32 v86, v86
    v_exp_f32 v87, v87
    v_exp_f32 v88, v88
    v_smfmac_f32_16x16x64_bf16 v[192:195], v[200:203], v[64:71], v204
    ds_read_b128 v[128:131], v24 offset:16384
    v_exp_f32 v89, v89
    v_exp_f32 v90, v90
    v_smfmac_f32_32x32x32_bf16 v[160:175], v[148:151], v[72:79], v204
    v_exp_f32 v91, v91
    v_exp_f32 v92, v92
    v_exp_f32 v93, v93
    v_smfmac_f32_16x16x64_bf16 v[192:195], v[200:203], v[72:79], v204
    ds_read_b128 v[132:135], v24 offset:17408
    v_exp_f32 v94, v94
    v_exp_f32 v95, v95
    v_mfma_f32_32x32x16_bf16 v[112:127], v[136:139], v[16:19], 0
    v_exp_f32 v96, v96
    v_exp_f32 v97, v97
    v_exp_f32 v98, v98
    v_mfma_f32_32x32x16_bf16 v[112:127], v[140:143], v[20:23], v[112:127]
    v_exp_f32 v99, v99
    v_exp_f32 v100, v100
    v_exp_f32 v101, v101
    v_smfmac_f32_32x32x32_bf16 v[176:191], v[144:147], v[80:87], v204
    s_waitcnt lgkmcnt(0)
    v_exp_f32 v102, v102
    v_exp_f32 v103, v103
    v_exp_f32 v104, v104
    v_smfmac_f32_16x16x64_bf16 v[196:199], v[200:203], v[80:87], v204
    ds_read_b128 v[152:155], v24 offset:14336
    v_exp_f32 v105, v105
    v_exp_f32 v106, v106
    v_smfmac_f32_32x32x32_bf16 v[176:191], v[148:151], v[88:95], v204
    v_exp_f32 v107, v107
    v_exp_f32 v108, v108
    v_exp_f32 v109, v109
    v_smfmac_f32_16x16x64_bf16 v[196:199], v[200:203], v[88:95], v204
    ds_read_b128 v[156:159], v24 offset:15360
    v_exp_f32 v110, v110
    v_exp_f32 v111, v111
    v_mfma_f32_32x32x16_bf16 v[64:79], v[128:131], v[8:11], 0
    v_exp_f32 v112, v112
    v_exp_f32 v113, v113
    v_exp_f32 v114, v114
    v_mfma_f32_32x32x16_bf16 v[64:79], v[132:135], v[12:15], v[64:79]
    s_waitcnt lgkmcnt(1)
    v_exp_f32 v115, v115
    v_exp_f32 v116, v116
    v_exp_f32 v117, v117
    v_smfmac_f32_32x32x32_bf16 v[160:175], v[152:155], v[96:103], v204
    s_waitcnt lgkmcnt(0)
    v_exp_f32 v118, v118
    v_exp_f32 v119, v119
    v_exp_f32 v120, v120
    v_smfmac_f32_16x16x64_bf16 v[192:195], v[200:203], v[96:103], v204
    ds_read_b128 v[136:139], v24 offset:18432
    v_exp_f32 v121, v121
    v_exp_f32 v122, v122
    v_smfmac_f32_32x32x32_bf16 v[160:175], v[156:159], v[104:111], v204
    v_exp_f32 v123, v123
    v_exp_f32 v124, v124
    v_exp_f32 v125, v125
    v_smfmac_f32_16x16x64_bf16 v[192:195], v[200:203], v[104:111], v204
    ds_read_b128 v[140:143], v24 offset:19456
    v_exp_f32 v126, v126
    v_exp_f32 v127, v127
    v_mfma_f32_32x32x16_bf16 v[80:95], v[128:131], v[16:19], 0
    v_exp_f32 v64, v64
    v_exp_f32 v65, v65
    v_exp_f32 v66, v66
    v_mfma_f32_32x32x16_bf16 v[80:95], v[132:135], v[20:23], v[80:95]
    v_exp_f32 v67, v67
    v_exp_f32 v68, v68
    v_exp_f32 v69, v69
    v_smfmac_f32_32x32x32_bf16 v[176:191], v[152:155], v[112:119], v204
    s_waitcnt lgkmcnt(0)
    v_exp_f32 v70, v70
    v_exp_f32 v71, v71
    v_exp_f32 v72, v72
    v_smfmac_f32_16x16x64_bf16 v[196:199], v[200:203], v[112:119], v204
    ds_read_b128 v[144:147], v24 offset:24576
    v_exp_f32 v73, v73
    v_exp_f32 v74, v74
    v_smfmac_f32_32x32x32_bf16 v[176:191], v[156:159], v[120:127], v204
    v_exp_f32 v75, v75
    v_exp_f32 v76, v76
    v_exp_f32 v77, v77
    v_smfmac_f32_16x16x64_bf16 v[196:199], v[200:203], v[120:127], v204
    ds_read_b128 v[148:151], v24 offset:25600
    v_exp_f32 v78, v78
    v_exp_f32 v79, v79
    v_mfma_f32_32x32x16_bf16 v[96:111], v[136:139], v[8:11], 0
    v_exp_f32 v80, v80
    v_exp_f32 v81, v81
    v_exp_f32 v82, v82
    v_mfma_f32_32x32x16_bf16 v[96:111], v[140:143], v[12:15], v[96:111]
    s_waitcnt lgkmcnt(1)
    v_exp_f32 v83, v83
    v_exp_f32 v84, v84
    v_exp_f32 v85, v85
    v_smfmac_f32_32x32x32_bf16 v[160:175], v[144:147], v[64:71], v204
    s_waitcnt lgkmcnt(0)
    v_exp_f32 v86, v86
    v_exp_f32 v87, v87
    v_exp_f32 v88, v88
    v_smfmac_f32_16x16x64_bf16 v[192:195], v[200:203], v[64:71], v204
    ds_read_b128 v[128:131], v24 offset:20480
    v_exp_f32 v89, v89
    v_exp_f32 v90, v90
    v_smfmac_f32_32x32x32_bf16 v[160:175], v[148:151], v[72:79], v204
    v_exp_f32 v91, v91
    v_exp_f32 v92, v92
    v_exp_f32 v93, v93
    v_smfmac_f32_16x16x64_bf16 v[192:195], v[200:203], v[72:79], v204
    ds_read_b128 v[132:135], v24 offset:21504
    v_exp_f32 v94, v94
    v_exp_f32 v95, v95
    v_mfma_f32_32x32x16_bf16 v[112:127], v[136:139], v[16:19], 0
    v_exp_f32 v96, v96
    v_exp_f32 v97, v97
    v_exp_f32 v98, v98
    v_mfma_f32_32x32x16_bf16 v[112:127], v[140:143], v[20:23], v[112:127]
    v_exp_f32 v99, v99
    v_exp_f32 v100, v100
    v_exp_f32 v101, v101
    v_smfmac_f32_32x32x32_bf16 v[176:191], v[144:147], v[80:87], v204
    s_waitcnt lgkmcnt(0)
    v_exp_f32 v102, v102
    v_exp_f32 v103, v103
    v_exp_f32 v104, v104
    v_smfmac_f32_16x16x64_bf16 v[196:199], v[200:203], v[80:87], v204
    ds_read_b128 v[152:155], v24 offset:26624
    v_exp_f32 v105, v105
    v_exp_f32 v106, v106
    v_smfmac_f32_32x32x32_bf16 v[176:191], v[148:151], v[88:95], v204
    v_exp_f32 v107, v107
    v_exp_f32 v108, v108
    v_exp_f32 v109, v109
    v_smfmac_f32_16x16x64_bf16 v[196:199], v[200:203], v[88:95], v204
    ds_read_b128 v[156:159], v24 offset:27648
    v_exp_f32 v110, v110
    v_exp_f32 v111, v111
    v_mfma_f32_32x32x16_bf16 v[64:79], v[128:131], v[8:11], 0
    v_exp_f32 v112, v112
    v_exp_f32 v113, v113
    v_exp_f32 v114, v114
    v_mfma_f32_32x32x16_bf16 v[64:79], v[132:135], v[12:15], v[64:79]
    s_waitcnt lgkmcnt(1)
    v_exp_f32 v115, v115
    v_exp_f32 v116, v116
    v_exp_f32 v117, v117
    v_smfmac_f32_32x32x32_bf16 v[160:175], v[152:155], v[96:103], v204
    s_waitcnt lgkmcnt(0)
    v_exp_f32 v118, v118
    v_exp_f32 v119, v119
    v_exp_f32 v120, v120
    v_smfmac_f32_16x16x64_bf16 v[192:195], v[200:203], v[96:103], v204
    ds_read_b128 v[136:139], v24 offset:22528
    v_exp_f32 v121, v121
    v_exp_f32 v122, v122
    v_smfmac_f32_32x32x32_bf16 v[160:175], v[156:159], v[104:111], v204
    v_exp_f32 v123, v123
    v_exp_f32 v124, v124
    v_exp_f32 v125, v125
    v_smfmac_f32_16x16x64_bf16 v[192:195], v[200:203], v[104:111], v204
    ds_read_b128 v[140:143], v24 offset:23552
    v_exp_f32 v126, v126
    v_exp_f32 v127, v127
    v_mfma_f32_32x32x16_bf16 v[80:95], v[128:131], v[16:19], 0
    v_exp_f32 v64, v64
    v_exp_f32 v65, v65
    v_exp_f32 v66, v66
    v_mfma_f32_32x32x16_bf16 v[80:95], v[132:135], v[20:23], v[80:95]
    v_exp_f32 v67, v67
    v_exp_f32 v68, v68
    v_exp_f32 v69, v69
    v_smfmac_f32_32x32x32_bf16 v[176:191], v[152:155], v[112:119], v204
    s_waitcnt lgkmcnt(0)
    v_exp_f32 v70, v70
    v_exp_f32 v71, v71
    v_exp_f32 v72, v72
    v_smfmac_f32_16x16x64_bf16 v[196:199], v[200:203], v[112:119], v204
    ds_read_b128 v[144:147], v24 offset:28672
    v_exp_f32 v73, v73
    v_exp_f32 v74, v74
    v_smfmac_f32_32x32x32_bf16 v[176:191], v[156:159], v[120:127], v204
    v_exp_f32 v75, v75
    v_exp_f32 v76, v76
    v_exp_f32 v77, v77
    v_smfmac_f32_16x16x64_bf16 v[196:199], v[200:203], v[120:127], v204
    ds_read_b128 v[148:151], v24 offset:29696
    v_exp_f32 v78, v78
    v_exp_f32 v79, v79
    v_mfma_f32_32x32x16_bf16 v[96:111], v[136:139], v[8:11], 0
    s_barrier
    v_exp_f32 v80, v80
    v_exp_f32 v81, v81
    v_exp_f32 v82, v82
    v_mfma_f32_32x32x16_bf16 v[96:111], v[140:143], v[12:15], v[96:111]
    s_waitcnt lgkmcnt(1)
    v_exp_f32 v83, v83
    v_exp_f32 v84, v84
    v_exp_f32 v85, v85
    v_smfmac_f32_32x32x32_bf16 v[160:175], v[144:147], v[64:71], v204
    s_waitcnt lgkmcnt(0)
    v_exp_f32 v86, v86
    v_exp_f32 v87, v87
    v_exp_f32 v88, v88
    v_smfmac_f32_16x16x64_bf16 v[192:195], v[200:203], v[64:71], v204
    ds_read_b128 v[128:131], v24 offset:32768
    v_exp_f32 v89, v89
    v_exp_f32 v90, v90
    v_smfmac_f32_32x32x32_bf16 v[160:175], v[148:151], v[72:79], v204
    v_exp_f32 v91, v91
    v_exp_f32 v92, v92
    v_exp_f32 v93, v93
    v_smfmac_f32_16x16x64_bf16 v[192:195], v[200:203], v[72:79], v204
    ds_read_b128 v[132:135], v24 offset:33792
    v_exp_f32 v94, v94
    v_exp_f32 v95, v95
    v_mfma_f32_32x32x16_bf16 v[112:127], v[136:139], v[16:19], 0
    v_exp_f32 v96, v96
    v_exp_f32 v97, v97
    v_exp_f32 v98, v98
    v_mfma_f32_32x32x16_bf16 v[112:127], v[140:143], v[20:23], v[112:127]
    v_exp_f32 v99, v99
    v_exp_f32 v100, v100
    v_exp_f32 v101, v101
    v_smfmac_f32_32x32x32_bf16 v[176:191], v[144:147], v[80:87], v204
    s_waitcnt lgkmcnt(0)
    v_exp_f32 v102, v102
    v_exp_f32 v103, v103
    v_exp_f32 v104, v104
    v_smfmac_f32_16x16x64_bf16 v[196:199], v[200:203], v[80:87], v204
    ds_read_b128 v[152:155], v24 offset:30720
    v_exp_f32 v105, v105
    v_exp_f32 v106, v106
    v_smfmac_f32_32x32x32_bf16 v[176:191], v[148:151], v[88:95], v204
    v_exp_f32 v107, v107
    v_exp_f32 v108, v108
    v_exp_f32 v109, v109
    v_smfmac_f32_16x16x64_bf16 v[196:199], v[200:203], v[88:95], v204
    ds_read_b128 v[156:159], v24 offset:31744
    v_exp_f32 v110, v110
    v_exp_f32 v111, v111
    v_mfma_f32_32x32x16_bf16 v[64:79], v[128:131], v[8:11], 0
    v_exp_f32 v112, v112
    v_exp_f32 v113, v113
    v_exp_f32 v114, v114
    v_mfma_f32_32x32x16_bf16 v[64:79], v[132:135], v[12:15], v[64:79]
    s_waitcnt lgkmcnt(1)
    v_exp_f32 v115, v115
    v_exp_f32 v116, v116
    v_exp_f32 v117, v117
    v_smfmac_f32_32x32x32_bf16 v[160:175], v[152:155], v[96:103], v204
    s_waitcnt lgkmcnt(0)
    v_exp_f32 v118, v118
    v_exp_f32 v119, v119
    v_exp_f32 v120, v120
    v_smfmac_f32_16x16x64_bf16 v[192:195], v[200:203], v[96:103], v204
    ds_read_b128 v[136:139], v24 offset:34816
    v_exp_f32 v121, v121
    v_exp_f32 v122, v122
    v_smfmac_f32_32x32x32_bf16 v[160:175], v[156:159], v[104:111], v204
    v_exp_f32 v123, v123
    v_exp_f32 v124, v124
    v_exp_f32 v125, v125
    v_smfmac_f32_16x16x64_bf16 v[192:195], v[200:203], v[104:111], v204
    ds_read_b128 v[140:143], v24 offset:35840
    v_exp_f32 v126, v126
    v_exp_f32 v127, v127
    v_mfma_f32_32x32x16_bf16 v[80:95], v[128:131], v[16:19], 0
    v_exp_f32 v64, v64
    v_exp_f32 v65, v65
    v_exp_f32 v66, v66
    v_mfma_f32_32x32x16_bf16 v[80:95], v[132:135], v[20:23], v[80:95]
    v_exp_f32 v67, v67
    v_exp_f32 v68, v68
    v_exp_f32 v69, v69
    v_smfmac_f32_32x32x32_bf16 v[176:191], v[152:155], v[112:119], v204
    s_waitcnt lgkmcnt(0)
    v_exp_f32 v70, v70
    v_exp_f32 v71, v71
    v_exp_f32 v72, v72
    v_smfmac_f32_16x16x64_bf16 v[196:199], v[200:203], v[112:119], v204
    ds_read_b128 v[144:147], v24 offset:40960
    v_exp_f32 v73, v73
    v_exp_f32 v74, v74
    v_smfmac_f32_32x32x32_bf16 v[176:191], v[156:159], v[120:127], v204
    v_exp_f32 v75, v75
    v_exp_f32 v76, v76
    v_exp_f32 v77, v77
    v_smfmac_f32_16x16x64_bf16 v[196:199], v[200:203], v[120:127], v204
    ds_read_b128 v[148:151], v24 offset:41984
    v_exp_f32 v78, v78
    v_exp_f32 v79, v79
    v_mfma_f32_32x32x16_bf16 v[96:111], v[136:139], v[8:11], 0
    v_exp_f32 v80, v80
    v_exp_f32 v81, v81
    v_exp_f32 v82, v82
    v_mfma_f32_32x32x16_bf16 v[96:111], v[140:143], v[12:15], v[96:111]
    s_waitcnt lgkmcnt(1)
    v_exp_f32 v83, v83
    v_exp_f32 v84, v84
    v_exp_f32 v85, v85
    v_smfmac_f32_32x32x32_bf16 v[160:175], v[144:147], v[64:71], v204
    s_waitcnt lgkmcnt(0)
    v_exp_f32 v86, v86
    v_exp_f32 v87, v87
    v_exp_f32 v88, v88
    v_smfmac_f32_16x16x64_bf16 v[192:195], v[200:203], v[64:71], v204
    ds_read_b128 v[128:131], v24 offset:36864
    v_exp_f32 v89, v89
    v_exp_f32 v90, v90
    v_smfmac_f32_32x32x32_bf16 v[160:175], v[148:151], v[72:79], v204
    v_exp_f32 v91, v91
    v_exp_f32 v92, v92
    v_exp_f32 v93, v93
    v_smfmac_f32_16x16x64_bf16 v[192:195], v[200:203], v[72:79], v204
    ds_read_b128 v[132:135], v24 offset:37888
    v_exp_f32 v94, v94
    v_exp_f32 v95, v95
    v_mfma_f32_32x32x16_bf16 v[112:127], v[136:139], v[16:19], 0
    v_exp_f32 v96, v96
    v_exp_f32 v97, v97
    v_exp_f32 v98, v98
    v_mfma_f32_32x32x16_bf16 v[112:127], v[140:143], v[20:23], v[112:127]
    v_exp_f32 v99, v99
    v_exp_f32 v100, v100
    v_exp_f32 v101, v101
    v_smfmac_f32_32x32x32_bf16 v[176:191], v[144:147], v[80:87], v204
    s_waitcnt lgkmcnt(0)
    v_exp_f32 v102, v102
    v_exp_f32 v103, v103
    v_exp_f32 v104, v104
    v_smfmac_f32_16x16x64_bf16 v[196:199], v[200:203], v[80:87], v204
    ds_read_b128 v[152:155], v24 offset:43008
    v_exp_f32 v105, v105
    v_exp_f32 v106, v106
    v_smfmac_f32_32x32x32_bf16 v[176:191], v[148:151], v[88:95], v204
    v_exp_f32 v107, v107
    v_exp_f32 v108, v108
    v_exp_f32 v109, v109
    v_smfmac_f32_16x16x64_bf16 v[196:199], v[200:203], v[88:95], v204
    ds_read_b128 v[156:159], v24 offset:44032
    v_exp_f32 v110, v110
    v_exp_f32 v111, v111
    v_mfma_f32_32x32x16_bf16 v[64:79], v[128:131], v[8:11], 0
    v_exp_f32 v112, v112
    v_exp_f32 v113, v113
    v_exp_f32 v114, v114
    v_mfma_f32_32x32x16_bf16 v[64:79], v[132:135], v[12:15], v[64:79]
    s_waitcnt lgkmcnt(1)
    v_exp_f32 v115, v115
    v_exp_f32 v116, v116
    v_exp_f32 v117, v117
    v_smfmac_f32_32x32x32_bf16 v[160:175], v[152:155], v[96:103], v204
    s_waitcnt lgkmcnt(0)
    v_exp_f32 v118, v118
    v_exp_f32 v119, v119
    v_exp_f32 v120, v120
    v_smfmac_f32_16x16x64_bf16 v[192:195], v[200:203], v[96:103], v204
    ds_read_b128 v[136:139], v24 offset:38912
    v_exp_f32 v121, v121
    v_exp_f32 v122, v122
    v_smfmac_f32_32x32x32_bf16 v[160:175], v[156:159], v[104:111], v204
    v_exp_f32 v123, v123
    v_exp_f32 v124, v124
    v_exp_f32 v125, v125
    v_smfmac_f32_16x16x64_bf16 v[192:195], v[200:203], v[104:111], v204
    ds_read_b128 v[140:143], v24 offset:39936
    v_exp_f32 v126, v126
    v_exp_f32 v127, v127
    v_mfma_f32_32x32x16_bf16 v[80:95], v[128:131], v[16:19], 0
    v_exp_f32 v64, v64
    v_exp_f32 v65, v65
    v_exp_f32 v66, v66
    v_mfma_f32_32x32x16_bf16 v[80:95], v[132:135], v[20:23], v[80:95]
    v_exp_f32 v67, v67
    v_exp_f32 v68, v68
    v_exp_f32 v69, v69
    v_smfmac_f32_32x32x32_bf16 v[176:191], v[152:155], v[112:119], v204
    s_waitcnt lgkmcnt(0)
    v_exp_f32 v70, v70
    v_exp_f32 v71, v71
    v_exp_f32 v72, v72
    v_smfmac_f32_16x16x64_bf16 v[196:199], v[200:203], v[112:119], v204
    ds_read_b128 v[144:147], v24 offset:45056
    v_exp_f32 v73, v73
    v_exp_f32 v74, v74
    v_smfmac_f32_32x32x32_bf16 v[176:191], v[156:159], v[120:127], v204
    v_exp_f32 v75, v75
    v_exp_f32 v76, v76
    v_exp_f32 v77, v77
    v_smfmac_f32_16x16x64_bf16 v[196:199], v[200:203], v[120:127], v204
    ds_read_b128 v[148:151], v24 offset:46080
    v_exp_f32 v78, v78
    v_exp_f32 v79, v79
    v_mfma_f32_32x32x16_bf16 v[96:111], v[136:139], v[8:11], 0
    s_barrier
    v_exp_f32 v80, v80
    v_exp_f32 v81, v81
    v_exp_f32 v82, v82
    v_mfma_f32_32x32x16_bf16 v[96:111], v[140:143], v[12:15], v[96:111]
    s_waitcnt lgkmcnt(1)
    v_exp_f32 v83, v83
    v_exp_f32 v84, v84
    v_exp_f32 v85, v85
    v_smfmac_f32_32x32x32_bf16 v[160:175], v[144:147], v[64:71], v204
    s_waitcnt lgkmcnt(0)
    v_exp_f32 v86, v86
    v_exp_f32 v87, v87
    v_exp_f32 v88, v88
    v_smfmac_f32_16x16x64_bf16 v[192:195], v[200:203], v[64:71], v204
    ds_read_b128 v[128:131], v24 offset:49152
    v_exp_f32 v89, v89
    v_exp_f32 v90, v90
    v_smfmac_f32_32x32x32_bf16 v[160:175], v[148:151], v[72:79], v204
    v_exp_f32 v91, v91
    v_exp_f32 v92, v92
    v_exp_f32 v93, v93
    v_smfmac_f32_16x16x64_bf16 v[192:195], v[200:203], v[72:79], v204
    ds_read_b128 v[132:135], v24 offset:50176
    v_exp_f32 v94, v94
    v_exp_f32 v95, v95
    v_mfma_f32_32x32x16_bf16 v[112:127], v[136:139], v[16:19], 0
    v_exp_f32 v96, v96
    v_exp_f32 v97, v97
    v_exp_f32 v98, v98
    v_mfma_f32_32x32x16_bf16 v[112:127], v[140:143], v[20:23], v[112:127]
    v_exp_f32 v99, v99
    v_exp_f32 v100, v100
    v_exp_f32 v101, v101
    v_smfmac_f32_32x32x32_bf16 v[176:191], v[144:147], v[80:87], v204
    s_waitcnt lgkmcnt(0)
    v_exp_f32 v102, v102
    v_exp_f32 v103, v103
    v_exp_f32 v104, v104
    v_smfmac_f32_16x16x64_bf16 v[196:199], v[200:203], v[80:87], v204
    ds_read_b128 v[152:155], v24 offset:47104
    v_exp_f32 v105, v105
    v_exp_f32 v106, v106
    v_smfmac_f32_32x32x32_bf16 v[176:191], v[148:151], v[88:95], v204
    v_exp_f32 v107, v107
    v_exp_f32 v108, v108
    v_exp_f32 v109, v109
    v_smfmac_f32_16x16x64_bf16 v[196:199], v[200:203], v[88:95], v204
    ds_read_b128 v[156:159], v24 offset:48128
    v_exp_f32 v110, v110
    v_exp_f32 v111, v111
    v_mfma_f32_32x32x16_bf16 v[64:79], v[128:131], v[8:11], 0
    v_exp_f32 v112, v112
    v_exp_f32 v113, v113
    v_exp_f32 v114, v114
    v_mfma_f32_32x32x16_bf16 v[64:79], v[132:135], v[12:15], v[64:79]
    s_waitcnt lgkmcnt(1)
    v_exp_f32 v115, v115
    v_exp_f32 v116, v116
    v_exp_f32 v117, v117
    v_smfmac_f32_32x32x32_bf16 v[160:175], v[152:155], v[96:103], v204
    s_waitcnt lgkmcnt(0)
    v_exp_f32 v118, v118
    v_exp_f32 v119, v119
    v_exp_f32 v120, v120
    v_smfmac_f32_16x16x64_bf16 v[192:195], v[200:203], v[96:103], v204
    ds_read_b128 v[136:139], v24 offset:51200
    v_exp_f32 v121, v121
    v_exp_f32 v122, v122
    v_smfmac_f32_32x32x32_bf16 v[160:175], v[156:159], v[104:111], v204
    v_exp_f32 v123, v123
    v_exp_f32 v124, v124
    v_exp_f32 v125, v125
    v_smfmac_f32_16x16x64_bf16 v[192:195], v[200:203], v[104:111], v204
    ds_read_b128 v[140:143], v24 offset:52224
    v_exp_f32 v126, v126
    v_exp_f32 v127, v127
    v_mfma_f32_32x32x16_bf16 v[80:95], v[128:131], v[16:19], 0
    v_exp_f32 v64, v64
    v_exp_f32 v65, v65
    v_exp_f32 v66, v66
    v_mfma_f32_32x32x16_bf16 v[80:95], v[132:135], v[20:23], v[80:95]
    v_exp_f32 v67, v67
    v_exp_f32 v68, v68
    v_exp_f32 v69, v69
    v_smfmac_f32_32x32x32_bf16 v[176:191], v[152:155], v[112:119], v204
    s_waitcnt lgkmcnt(0)
    v_exp_f32 v70, v70
    v_exp_f32 v71, v71
    v_exp_f32 v72, v72
    v_smfmac_f32_16x16x64_bf16 v[196:199], v[200:203], v[112:119], v204
    ds_read_b128 v[144:147], v24 offset:57344
    v_exp_f32 v73, v73
    v_exp_f32 v74, v74
    v_smfmac_f32_32x32x32_bf16 v[176:191], v[156:159], v[120:127], v204
    v_exp_f32 v75, v75
    v_exp_f32 v76, v76
    v_exp_f32 v77, v77
    v_smfmac_f32_16x16x64_bf16 v[196:199], v[200:203], v[120:127], v204
    ds_read_b128 v[148:151], v24 offset:58368
    v_exp_f32 v78, v78
    v_exp_f32 v79, v79
    v_mfma_f32_32x32x16_bf16 v[96:111], v[136:139], v[8:11], 0
    v_exp_f32 v80, v80
    v_exp_f32 v81, v81
    v_exp_f32 v82, v82
    v_mfma_f32_32x32x16_bf16 v[96:111], v[140:143], v[12:15], v[96:111]
    s_waitcnt lgkmcnt(1)
    v_exp_f32 v83, v83
    v_exp_f32 v84, v84
    v_exp_f32 v85, v85
    v_smfmac_f32_32x32x32_bf16 v[160:175], v[144:147], v[64:71], v204
    s_waitcnt lgkmcnt(0)
    v_exp_f32 v86, v86
    v_exp_f32 v87, v87
    v_exp_f32 v88, v88
    v_smfmac_f32_16x16x64_bf16 v[192:195], v[200:203], v[64:71], v204
    ds_read_b128 v[128:131], v24 offset:53248
    v_exp_f32 v89, v89
    v_exp_f32 v90, v90
    v_smfmac_f32_32x32x32_bf16 v[160:175], v[148:151], v[72:79], v204
    v_exp_f32 v91, v91
    v_exp_f32 v92, v92
    v_exp_f32 v93, v93
    v_smfmac_f32_16x16x64_bf16 v[192:195], v[200:203], v[72:79], v204
    ds_read_b128 v[132:135], v24 offset:54272
    v_exp_f32 v94, v94
    v_exp_f32 v95, v95
    v_mfma_f32_32x32x16_bf16 v[112:127], v[136:139], v[16:19], 0
    v_exp_f32 v96, v96
    v_exp_f32 v97, v97
    v_exp_f32 v98, v98
    v_mfma_f32_32x32x16_bf16 v[112:127], v[140:143], v[20:23], v[112:127]
    v_exp_f32 v99, v99
    v_exp_f32 v100, v100
    v_exp_f32 v101, v101
    v_smfmac_f32_32x32x32_bf16 v[176:191], v[144:147], v[80:87], v204
    s_waitcnt lgkmcnt(0)
    v_exp_f32 v102, v102
    v_exp_f32 v103, v103
    v_exp_f32 v104, v104
    v_smfmac_f32_16x16x64_bf16 v[196:199], v[200:203], v[80:87], v204
    ds_read_b128 v[152:155], v24 offset:59392
    v_exp_f32 v105, v105
    v_exp_f32 v106, v106
    v_smfmac_f32_32x32x32_bf16 v[176:191], v[148:151], v[88:95], v204
    v_exp_f32 v107, v107
    v_exp_f32 v108, v108
    v_exp_f32 v109, v109
    v_smfmac_f32_16x16x64_bf16 v[196:199], v[200:203], v[88:95], v204
    ds_read_b128 v[156:159], v24 offset:60416
    v_exp_f32 v110, v110
    v_exp_f32 v111, v111
    v_mfma_f32_32x32x16_bf16 v[64:79], v[128:131], v[8:11], 0
    v_exp_f32 v112, v112
    v_exp_f32 v113, v113
    v_exp_f32 v114, v114
    v_mfma_f32_32x32x16_bf16 v[64:79], v[132:135], v[12:15], v[64:79]
    s_waitcnt lgkmcnt(1)
    v_exp_f32 v115, v115
    v_exp_f32 v116, v116
    v_exp_f32 v117, v117
    v_smfmac_f32_32x32x32_bf16 v[160:175], v[152:155], v[96:103], v204
    s_waitcnt lgkmcnt(0)
    v_exp_f32 v118, v118
    v_exp_f32 v119, v119
    v_exp_f32 v120, v120
    v_smfmac_f32_16x16x64_bf16 v[192:195], v[200:203], v[96:103], v204
    ds_read_b128 v[136:139], v24 offset:55296
    v_exp_f32 v121, v121
    v_exp_f32 v122, v122
    v_smfmac_f32_32x32x32_bf16 v[160:175], v[156:159], v[104:111], v204
    v_exp_f32 v123, v123
    v_exp_f32 v124, v124
    v_exp_f32 v125, v125
    v_smfmac_f32_16x16x64_bf16 v[192:195], v[200:203], v[104:111], v204
    ds_read_b128 v[140:143], v24 offset:56320
    v_exp_f32 v126, v126
    v_exp_f32 v127, v127
    v_mfma_f32_32x32x16_bf16 v[80:95], v[128:131], v[16:19], 0
    v_exp_f32 v64, v64
    v_exp_f32 v65, v65
    v_exp_f32 v66, v66
    v_mfma_f32_32x32x16_bf16 v[80:95], v[132:135], v[20:23], v[80:95]
    v_exp_f32 v67, v67
    v_exp_f32 v68, v68
    v_exp_f32 v69, v69
    v_smfmac_f32_32x32x32_bf16 v[176:191], v[152:155], v[112:119], v204
    s_waitcnt lgkmcnt(0)
    v_exp_f32 v70, v70
    v_exp_f32 v71, v71
    v_exp_f32 v72, v72
    v_smfmac_f32_16x16x64_bf16 v[196:199], v[200:203], v[112:119], v204
    ds_read_b128 v[144:147], v24 offset:61440
    v_exp_f32 v73, v73
    v_exp_f32 v74, v74
    v_smfmac_f32_32x32x32_bf16 v[176:191], v[156:159], v[120:127], v204
    v_exp_f32 v75, v75
    v_exp_f32 v76, v76
    v_exp_f32 v77, v77
    v_smfmac_f32_16x16x64_bf16 v[196:199], v[200:203], v[120:127], v204
    ds_read_b128 v[148:151], v24 offset:62464
    v_exp_f32 v78, v78
    v_exp_f32 v79, v79
    v_mfma_f32_32x32x16_bf16 v[96:111], v[136:139], v[8:11], 0
    s_barrier
    v_exp_f32 v80, v80
    v_exp_f32 v81, v81
    v_exp_f32 v82, v82
    v_mfma_f32_32x32x16_bf16 v[96:111], v[140:143], v[12:15], v[96:111]
    s_waitcnt lgkmcnt(1)
    v_exp_f32 v83, v83
    v_exp_f32 v84, v84
    v_exp_f32 v85, v85
    v_smfmac_f32_32x32x32_bf16 v[160:175], v[144:147], v[64:71], v204
    s_waitcnt lgkmcnt(0)
    v_exp_f32 v86, v86
    v_exp_f32 v87, v87
    v_exp_f32 v88, v88
    v_smfmac_f32_16x16x64_bf16 v[192:195], v[200:203], v[64:71], v204
    ds_read_b128 v[128:131], v24 offset:0
    v_exp_f32 v89, v89
    v_exp_f32 v90, v90
    v_smfmac_f32_32x32x32_bf16 v[160:175], v[148:151], v[72:79], v204
    v_exp_f32 v91, v91
    v_exp_f32 v92, v92
    v_exp_f32 v93, v93
    v_smfmac_f32_16x16x64_bf16 v[192:195], v[200:203], v[72:79], v204
    ds_read_b128 v[132:135], v24 offset:1024
    v_exp_f32 v94, v94
    v_exp_f32 v95, v95
    v_mfma_f32_32x32x16_bf16 v[112:127], v[136:139], v[16:19], 0
    v_exp_f32 v96, v96
    v_exp_f32 v97, v97
    v_exp_f32 v98, v98
    v_mfma_f32_32x32x16_bf16 v[112:127], v[140:143], v[20:23], v[112:127]
    v_exp_f32 v99, v99
    v_exp_f32 v100, v100
    v_exp_f32 v101, v101
    v_smfmac_f32_32x32x32_bf16 v[176:191], v[144:147], v[80:87], v204
    s_waitcnt lgkmcnt(0)
    v_exp_f32 v102, v102
    v_exp_f32 v103, v103
    v_exp_f32 v104, v104
    v_smfmac_f32_16x16x64_bf16 v[196:199], v[200:203], v[80:87], v204
    ds_read_b128 v[152:155], v24 offset:63488
    v_exp_f32 v105, v105
    v_exp_f32 v106, v106
    v_smfmac_f32_32x32x32_bf16 v[176:191], v[148:151], v[88:95], v204
    v_exp_f32 v107, v107
    v_exp_f32 v108, v108
    v_exp_f32 v109, v109
    v_smfmac_f32_16x16x64_bf16 v[196:199], v[200:203], v[88:95], v204
    ds_read_b128 v[156:159], v24 offset:64512
    v_exp_f32 v110, v110
    v_exp_f32 v111, v111
    v_mfma_f32_32x32x16_bf16 v[64:79], v[128:131], v[8:11], 0
    s_sub_u32 s54, s54, 1
    v_exp_f32 v112, v112
    v_exp_f32 v113, v113
    v_exp_f32 v114, v114
    v_mfma_f32_32x32x16_bf16 v[64:79], v[132:135], v[12:15], v[64:79]
    s_waitcnt lgkmcnt(1)
    v_exp_f32 v115, v115
    v_exp_f32 v116, v116
    v_exp_f32 v117, v117
    v_smfmac_f32_32x32x32_bf16 v[160:175], v[152:155], v[96:103], v204
    s_waitcnt lgkmcnt(0)
    v_exp_f32 v118, v118
    v_exp_f32 v119, v119
    v_exp_f32 v120, v120
    v_smfmac_f32_16x16x64_bf16 v[192:195], v[200:203], v[96:103], v204
    ds_read_b128 v[136:139], v24 offset:2048
    v_exp_f32 v121, v121
    v_exp_f32 v122, v122
    v_smfmac_f32_32x32x32_bf16 v[160:175], v[156:159], v[104:111], v204
    s_cmp_lg_u32 s54, 0
    v_exp_f32 v123, v123
    v_exp_f32 v124, v124
    v_exp_f32 v125, v125
    v_smfmac_f32_16x16x64_bf16 v[192:195], v[200:203], v[104:111], v204
    ds_read_b128 v[140:143], v24 offset:3072
    v_exp_f32 v126, v126
    v_exp_f32 v127, v127
    s_cbranch_scc1 c_attn_loop
    v_smfmac_f32_16x16x64_bf16 v[196:199], v[200:203], v[112:119], v204
    v_smfmac_f32_16x16x64_bf16 v[196:199], v[200:203], v[120:127], v204
    v_smfmac_f32_32x32x32_bf16 v[176:191], v[152:155], v[112:119], v204
    v_smfmac_f32_32x32x32_bf16 v[176:191], v[156:159], v[120:127], v204
    v_mov_b32 v25, 0x5f000000
    v_mov_b32 v26, 0x2b800000
    v_cmp_lt_f32 s[56:57], v192, v25
    v_cmp_gt_f32 vcc, v192, v26
    s_and_b64 s[56:57], s[56:57], vcc
    s_nop 0
    v_cmp_lt_f32 vcc, v196, v25
    s_and_b64 s[56:57], s[56:57], vcc
    v_cmp_gt_f32 vcc, v196, v26
    s_and_b64 s[56:57], s[56:57], vcc
    s_cmp_lg_u64 s[56:57], -1
    s_cbranch_scc1 c_attn_slow
c_attn_fin:
    s_lshl_b32 s3, s48, 17
    s_lshl_b32 s55, s7, 12
    s_add_u32 s3, s3, s55
    s_and_b32 s55, s6, 1
    s_lshl_b32 s55, s55, 11
    s_add_u32 s3, s3, s55
    s_lshl_b32 s55, s9, 22
    s_add_u32 s3, s3, s55
    s_add_u32 s3, s3, 16777216
    v_rcp_f32 v192, v192
    s_nop 0
    v_pk_mul_f32 v[160:161], v[192:193], v[160:161] op_sel_hi:[0,1]
    v_pk_mul_f32 v[162:163], v[192:193], v[162:163] op_sel_hi:[0,1]
    v_pk_mul_f32 v[164:165], v[192:193], v[164:165] op_sel_hi:[0,1]
    v_pk_mul_f32 v[166:167], v[192:193], v[166:167] op_sel_hi:[0,1]
    v_pk_mul_f32 v[168:169], v[192:193], v[168:169] op_sel_hi:[0,1]
    v_pk_mul_f32 v[170:171], v[192:193], v[170:171] op_sel_hi:[0,1]
    v_pk_mul_f32 v[172:173], v[192:193], v[172:173] op_sel_hi:[0,1]
    v_pk_mul_f32 v[174:175], v[192:193], v[174:175] op_sel_hi:[0,1]
    v_cvt_pk_bf16_f32 v160, v160, v161
    v_cvt_pk_bf16_f32 v161, v162, v163
    v_cvt_pk_bf16_f32 v162, v164, v165
    v_cvt_pk_bf16_f32 v163, v166, v167
    v_cvt_pk_bf16_f32 v164, v168, v169
    v_cvt_pk_bf16_f32 v165, v170, v171
    v_cvt_pk_bf16_f32 v166, v172, v173
    v_cvt_pk_bf16_f32 v167, v174, v175
    buffer_store_dwordx4 v[160:163], v5, s[12:15], s3 offen offset:0 sc1
    buffer_store_dwordx4 v[164:167], v5, s[12:15], s3 offen offset:1024 sc1
    s_add_u32 s3, s3, 65536
    v_rcp_f32 v196, v196
    s_nop 0
    v_pk_mul_f32 v[176:177], v[196:197], v[176:177] op_sel_hi:[0,1]
    v_pk_mul_f32 v[178:179], v[196:197], v[178:179] op_sel_hi:[0,1]
    v_pk_mul_f32 v[180:181], v[196:197], v[180:181] op_sel_hi:[0,1]
    v_pk_mul_f32 v[182:183], v[196:197], v[182:183] op_sel_hi:[0,1]
    v_pk_mul_f32 v[184:185], v[196:197], v[184:185] op_sel_hi:[0,1]
    v_pk_mul_f32 v[186:187], v[196:197], v[186:187] op_sel_hi:[0,1]
    v_pk_mul_f32 v[188:189], v[196:197], v[188:189] op_sel_hi:[0,1]
    v_pk_mul_f32 v[190:191], v[196:197], v[190:191] op_sel_hi:[0,1]
    v_cvt_pk_bf16_f32 v176, v176, v177
    v_cvt_pk_bf16_f32 v177, v178, v179
    v_cvt_pk_bf16_f32 v178, v180, v181
    v_cvt_pk_bf16_f32 v179, v182, v183
    v_cvt_pk_bf16_f32 v180, v184, v185
    v_cvt_pk_bf16_f32 v181, v186, v187
    v_cvt_pk_bf16_f32 v182, v188, v189
    v_cvt_pk_bf16_f32 v183, v190, v191
    buffer_store_dwordx4 v[176:179], v5, s[12:15], s3 offen offset:0 sc1
    buffer_store_dwordx4 v[180:183], v5, s[12:15], s3 offen offset:1024 sc1
    s_add_u32 s3, s3, 65536
    s_branch c_wo
.p2align 6
h_first_tail:
    s_waitcnt vmcnt(0)
    s_sub_u32 s50, s50, 8000
    s_load_dword s10, s[46:47], 0
    s_waitcnt lgkmcnt(0)
    s_sub_u32 s51, s10, s50
    s_and_b32 s3, s10, 1
    s_cselect_b32 s51, s51, -1
    s_cmp_ge_i32 s51, 0
    s_cbranch_scc1 h_first_non_ok
    s_load_dword s10, s[46:47], 128
    s_waitcnt lgkmcnt(0)
    s_sub_u32 s51, s10, s50
    s_and_b32 s3, s10, 1
    s_cselect_b32 s51, s51, -1
    s_cmp_ge_i32 s51, 0
    s_cbranch_scc1 h_first_non_ok
    s_load_dword s10, s[46:47], 64
    s_waitcnt lgkmcnt(0)
    s_sub_u32 s51, s10, s50
    s_and_b32 s3, s10, 1
    s_cselect_b32 s51, s51, -1
    s_cmp_ge_i32 s51, 0
    s_cbranch_scc1 h_first_non_ok
    s_load_dword s10, s[46:47], 192
    s_waitcnt lgkmcnt(0)
    s_sub_u32 s51, s10, s50
    s_and_b32 s3, s10, 1
    s_cselect_b32 s51, s51, -1
    s_cmp_ge_i32 s51, 0
    s_cbranch_scc1 h_first_non_ok
    s_mov_b32 s58, 0
    s_and_b32 s57, s2, 0xc0
h_first_non:
    s_load_dword s10, s[46:47], s57 glc
    s_waitcnt lgkmcnt(0)
    s_sub_u32 s51, s10, s50
    s_and_b32 s3, s10, 1
    s_cselect_b32 s51, s51, -1
    s_cmp_ge_i32 s51, 0
    s_cbranch_scc1 h_first_non_ok
    s_add_u32 s58, s58, 1
    s_cmp_gt_u32 s58, 100
    s_cselect_b32 s50, s10, s50
    s_cmp_lt_u32 s58, 0x100000
    s_cbranch_scc1 h_first_non
    s_mov_b32 s10, 1
h_first_non_ok:
    v_mov_b32 v12, s10
    ds_write_b32 v10, v12 offset:4
    v_lshlrev_b32 v13, 7, v1
    s_lshl_b32 s50, s2, 13
    s_mov_b32 s28, s36
    s_mov_b32 s29, s37
    s_mov_b32 s30, 2097152
    s_mov_b32 s31, 0x00020000
    buffer_load_dword v14, v13, s[28:31], s50 offen
    s_mov_b32 s9, 0
h_qkvA:
    s_mul_i32 s98, s9, 786432
    s_add_u32 s98, s98, 65273856
    s_lshl_b32 s99, s11, 10
    s_add_u32 s98, s98, s99
    s_add_u32 s96, s4, s98
    s_addc_u32 s97, s5, 0
    s_mov_b32 s98, s10
    s_mov_b32 s99, s10
    v_and_b32 v1, 63, v0
    v_lshlrev_b32 v5, 4, v1
    v_and_b32 v20, 15, v1
    v_lshrrev_b32 v11, 4, v1
    v_min_u32 v11, 2, v11
    v_lshlrev_b32 v21, 3, v20
    v_lshl_add_u32 v12, v11, 7, v21
    v_add_u32 v12, 155648, v12
    v_lshl_add_u32 v11, v11, 16, v21
    v_mov_b32 v10, 159496
    s_add_u32 s3, s9, 1
    v_mov_b32 v13, s3
    s_and_b32 s3, s6, 14
    s_lshl_b32 s3, s3, 2
    s_sub_u32 s3, s3, 1
    s_max_i32 s3, s3, 0
    s_lshl_b32 s3, s3, 16
    s_lshl_b32 s48, s9, 22
    s_add_u32 s3, s3, s48
    s_add_u32 s20, s4, s3
    s_addc_u32 s21, s5, 0
    s_mov_b32 s22, 65536
    s_mov_b32 s23, 0x00020000
    s_cmp_lt_u32 s6, 2
    s_cselect_b32 s22, 0, s22
    s_cselect_b32 s3, 0, 512
    s_add_u32 s96, s96, s3
    s_addc_u32 s97, s97, 0
    v_bfe_u32 v21, v1, 4, 1
    v_lshl_add_u32 v6, v21, 5, v20
    v_lshlrev_b32 v6, 4, v6
    v_lshrrev_b32 v21, 5, v1
    v_lshl_add_u32 v6, v21, 10, v6
    v_add_u32 v6, 256, v6
    v_mov_b32 v16, v5
    s_cmp_eq_u32 s9, 0
    s_cbranch_scc1 h_qkvA_noend
    s_barrier
    s_cmp_lt_u32 s9, 2
    s_cbranch_scc1 c4_11
    ds_write_b128 v16, v[64:67] offset:0
    ds_write_b128 v16, v[68:71] offset:1024
    ds_write_b128 v16, v[72:75] offset:2048
    ds_write_b128 v16, v[76:79] offset:3072
    ds_write_b128 v16, v[80:83] offset:4096
    ds_write_b128 v16, v[84:87] offset:5120
    ds_write_b128 v16, v[88:91] offset:6144
    ds_write_b128 v16, v[92:95] offset:7168
    ds_write_b128 v16, v[96:99] offset:8192
    ds_write_b128 v16, v[100:103] offset:9216
    ds_write_b128 v16, v[104:107] offset:10240
    ds_write_b128 v16, v[108:111] offset:11264
    ds_write_b128 v16, v[112:115] offset:12288
    ds_write_b128 v16, v[116:119] offset:13312
    ds_write_b128 v16, v[120:123] offset:14336
    ds_write_b128 v16, v[124:127] offset:15360
    ds_write_b128 v16, v[128:131] offset:16384
    ds_write_b128 v16, v[132:135] offset:17408
    ds_write_b128 v16, v[136:139] offset:18432
    ds_write_b128 v16, v[140:143] offset:19456
    ds_write_b128 v16, v[144:147] offset:20480
    ds_write_b128 v16, v[148:151] offset:21504
    ds_write_b128 v16, v[152:155] offset:22528
    ds_write_b128 v16, v[156:159] offset:23552
    s_waitcnt lgkmcnt(0)
c4_11:
    s_barrier
h_qkvA_noend:
    s_mov_b32 s3, 0x100000
poll_12:
    s_load_dwordx8 s[80:87], s[96:97], 0 glc
    s_load_dwordx8 s[88:95], s[96:97], 128 glc
    s_sub_u32 s3, s3, 1
    s_cbranch_scc1 poll_12_ok
    s_waitcnt lgkmcnt(0)
    s_xor_b64 s[100:101], s[80:81], s[98:99]
    s_xor_b64 s[80:81], s[82:83], s[98:99]
    s_or_b64 s[100:101], s[100:101], s[80:81]
    s_xor_b64 s[80:81], s[84:85], s[98:99]
    s_or_b64 s[100:101], s[100:101], s[80:81]
    s_xor_b64 s[80:81], s[86:87], s[98:99]
    s_or_b64 s[100:101], s[100:101], s[80:81]
    s_xor_b64 s[80:81], s[88:89], s[98:99]
    s_or_b64 s[100:101], s[100:101], s[80:81]
    s_xor_b64 s[80:81], s[90:91], s[98:99]
    s_or_b64 s[100:101], s[100:101], s[80:81]
    s_xor_b64 s[80:81], s[92:93], s[98:99]
    s_or_b64 s[100:101], s[100:101], s[80:81]
    s_xor_b64 s[80:81], s[94:95], s[98:99]
    s_or_b64 s[100:101], s[100:101], s[80:81]
    s_cbranch_scc1 poll_12
poll_12_ok:
    s_waitcnt lgkmcnt(0)
    ds_write_b32 v10, v13
    s_mov_b32 m0, 147456
    s_mov_b32 s48, 0
    buffer_load_dwordx4 v6, s[20:23], s48 offen sc1 lds
    s_mov_b32 m0, 148480
    s_mov_b32 s48, 2048
    buffer_load_dwordx4 v6, s[20:23], s48 offen sc1 lds
    s_mov_b32 m0, 149504
    s_mov_b32 s48, 4096
    buffer_load_dwordx4 v6, s[20:23], s48 offen sc1 lds
    s_mov_b32 m0, 150528
    s_mov_b32 s48, 6144
    buffer_load_dwordx4 v6, s[20:23], s48 offen sc1 lds
    s_mov_b32 m0, 151552
    s_mov_b32 s48, 8192
    buffer_load_dwordx4 v6, s[20:23], s48 offen sc1 lds
    s_mov_b32 m0, 152576
    s_mov_b32 s48, 10240
    buffer_load_dwordx4 v6, s[20:23], s48 offen sc1 lds
    s_mov_b32 m0, 153600
    s_mov_b32 s48, 12288
    buffer_load_dwordx4 v6, s[20:23], s48 offen sc1 lds
    s_mov_b32 m0, 154624
    s_mov_b32 s48, 14336
    buffer_load_dwordx4 v6, s[20:23], s48 offen sc1 lds
    s_lshl_b32 s56, s7, 12
    s_and_b32 s57, s6, 1
    s_lshl_b32 s57, s57, 7
    s_add_u32 s56, s56, s57
    s_add_u32 s56, s56, 63963136
    v_lshlrev_b32 v15, 7, v1
    s_lshr_b32 s59, s2, 3
    s_mul_i32 s59, s59, 3
    s_lshr_b32 s59, s59, 5
    s_lshl_b32 s3, s9, 4
    s_add_u32 s59, s59, s3
    s_waitcnt vmcnt(4)
    s_barrier
    s_cmp_ge_u32 s9, 2
    s_cbranch_scc1 c4_13
    ds_read_b128 v[64:67], v16 offset:0
    ds_read_b128 v[68:71], v16 offset:1024
    ds_read_b128 v[72:75], v16 offset:2048
    ds_read_b128 v[76:79], v16 offset:3072
    ds_read_b128 v[80:83], v16 offset:4096
    ds_read_b128 v[84:87], v16 offset:5120
    ds_read_b128 v[88:91], v16 offset:6144
    ds_read_b128 v[92:95], v16 offset:7168
    ds_read_b128 v[96:99], v16 offset:8192
    ds_read_b128 v[100:103], v16 offset:9216
    ds_read_b128 v[104:107], v16 offset:10240
    ds_read_b128 v[108:111], v16 offset:11264
    ds_read_b128 v[112:115], v16 offset:12288
    ds_read_b128 v[116:119], v16 offset:13312
    ds_read_b128 v[120:123], v16 offset:14336
    ds_read_b128 v[124:127], v16 offset:15360
    ds_read_b128 v[128:131], v16 offset:16384
    ds_read_b128 v[132:135], v16 offset:17408
    ds_read_b128 v[136:139], v16 offset:18432
    ds_read_b128 v[140:143], v16 offset:19456
    ds_read_b128 v[144:147], v16 offset:20480
    ds_read_b128 v[148:151], v16 offset:21504
    ds_read_b128 v[152:155], v16 offset:22528
    ds_read_b128 v[156:159], v16 offset:23552
    s_waitcnt lgkmcnt(0)
c4_13:
    s_waitcnt vmcnt(0)
    s_barrier
    s_mov_b32 m0, 147456
    s_mov_b32 s48, 16384
    buffer_load_dwordx4 v6, s[20:23], s48 offen sc1 lds
    s_mov_b32 m0, 148480
    s_mov_b32 s48, 18432
    buffer_load_dwordx4 v6, s[20:23], s48 offen sc1 lds
    s_mov_b32 m0, 149504
    s_mov_b32 s48, 20480
    buffer_load_dwordx4 v6, s[20:23], s48 offen sc1 lds
    s_mov_b32 m0, 150528
    s_mov_b32 s48, 22528
    buffer_load_dwordx4 v6, s[20:23], s48 offen sc1 lds
    s_waitcnt vmcnt(0)
    s_waitcnt vmcnt(0)
    s_barrier
    s_mov_b32 m0, 151552
    s_mov_b32 s48, 24576
    buffer_load_dwordx4 v6, s[20:23], s48 offen sc1 lds
    s_mov_b32 m0, 152576
    s_mov_b32 s48, 26624
    buffer_load_dwordx4 v6, s[20:23], s48 offen sc1 lds
    s_mov_b32 m0, 153600
    s_mov_b32 s48, 28672
    buffer_load_dwordx4 v6, s[20:23], s48 offen sc1 lds
    s_mov_b32 m0, 154624
    s_mov_b32 s48, 30720
    buffer_load_dwordx4 v6, s[20:23], s48 offen sc1 lds
    s_cmp_ge_u32 s9, 2
    s_cbranch_scc1 cs_15
    buffer_load_dwordx2 v[32:33], v11, s[12:15], s56 offen offset:0 sc1
    buffer_load_dwordx2 v[34:35], v11, s[12:15], s56 offen offset:256 sc1
    buffer_load_dwordx2 v[36:37], v11, s[12:15], s56 offen offset:512 sc1
    buffer_load_dwordx2 v[38:39], v11, s[12:15], s56 offen offset:768 sc1
    buffer_load_dwordx2 v[40:41], v11, s[12:15], s56 offen offset:1024 sc1
    buffer_load_dwordx2 v[42:43], v11, s[12:15], s56 offen offset:1280 sc1
    buffer_load_dwordx2 v[44:45], v11, s[12:15], s56 offen offset:1536 sc1
    buffer_load_dwordx2 v[46:47], v11, s[12:15], s56 offen offset:1792 sc1
    buffer_load_dwordx2 v[48:49], v11, s[12:15], s56 offen offset:2048 sc1
    buffer_load_dwordx2 v[50:51], v11, s[12:15], s56 offen offset:2304 sc1
    buffer_load_dwordx2 v[52:53], v11, s[12:15], s56 offen offset:2560 sc1
    buffer_load_dwordx2 v[54:55], v11, s[12:15], s56 offen offset:2816 sc1
cs_15:
    s_waitcnt vmcnt(0)
    s_waitcnt vmcnt(12)
    s_barrier
    s_mov_b32 m0, 147456
    s_mov_b32 s48, 32768
    buffer_load_dwordx4 v6, s[20:23], s48 offen sc1 lds
    s_mov_b32 m0, 148480
    s_mov_b32 s48, 34816
    buffer_load_dwordx4 v6, s[20:23], s48 offen sc1 lds
    s_mov_b32 m0, 149504
    s_mov_b32 s48, 36864
    buffer_load_dwordx4 v6, s[20:23], s48 offen sc1 lds
    s_mov_b32 m0, 150528
    s_mov_b32 s48, 38912
    buffer_load_dwordx4 v6, s[20:23], s48 offen sc1 lds
    s_cmp_ge_u32 s9, 2
    s_cbranch_scc1 cs_16
    buffer_load_dwordx2 v[56:57], v11, s[12:15], s56 offen offset:3072 sc1
    buffer_load_dwordx2 v[58:59], v11, s[12:15], s56 offen offset:3328 sc1
    buffer_load_dwordx2 v[60:61], v11, s[12:15], s56 offen offset:3584 sc1
    buffer_load_dwordx2 v[62:63], v11, s[12:15], s56 offen offset:3840 sc1
cs_16:
    s_waitcnt vmcnt(0)
    s_waitcnt vmcnt(4)
    s_barrier
    s_mov_b32 m0, 151552
    s_mov_b32 s48, 40960
    buffer_load_dwordx4 v6, s[20:23], s48 offen sc1 lds
    s_mov_b32 m0, 152576
    s_mov_b32 s48, 43008
    buffer_load_dwordx4 v6, s[20:23], s48 offen sc1 lds
    s_mov_b32 m0, 153600
    s_mov_b32 s48, 45056
    buffer_load_dwordx4 v6, s[20:23], s48 offen sc1 lds
    s_mov_b32 m0, 154624
    s_mov_b32 s48, 47104
    buffer_load_dwordx4 v6, s[20:23], s48 offen sc1 lds
    s_cmp_ge_u32 s9, 2
    s_cbranch_scc1 cs_17
    s_waitcnt vmcnt(4)
    v_add_f32 v32, v32, v48
    v_add_f32 v33, v33, v49
    v_add_f32 v34, v34, v50
    v_add_f32 v35, v35, v51
    v_add_f32 v36, v36, v52
    v_add_f32 v37, v37, v53
    v_add_f32 v38, v38, v54
    v_add_f32 v39, v39, v55
    v_add_f32 v40, v40, v56
    v_add_f32 v41, v41, v57
    v_add_f32 v42, v42, v58
    v_add_f32 v43, v43, v59
cs_17:
    s_waitcnt vmcnt(0)
    s_waitcnt vmcnt(0)
    s_barrier
    s_mov_b32 m0, 147456
    s_mov_b32 s48, 49152
    buffer_load_dwordx4 v6, s[20:23], s48 offen sc1 lds
    s_mov_b32 m0, 148480
    s_mov_b32 s48, 51200
    buffer_load_dwordx4 v6, s[20:23], s48 offen sc1 lds
    s_mov_b32 m0, 149504
    s_mov_b32 s48, 53248
    buffer_load_dwordx4 v6, s[20:23], s48 offen sc1 lds
    s_mov_b32 m0, 150528
    s_mov_b32 s48, 55296
    buffer_load_dwordx4 v6, s[20:23], s48 offen sc1 lds
    s_cmp_ge_u32 s9, 2
    s_cbranch_scc1 cs_18
    v_add_f32 v44, v44, v60
    v_add_f32 v45, v45, v61
    v_add_f32 v46, v46, v62
    v_add_f32 v47, v47, v63
    v_add_f32 v32, v32, v40
    v_add_f32 v33, v33, v41
    v_add_f32 v34, v34, v42
    v_add_f32 v35, v35, v43
    v_add_f32 v36, v36, v44
    v_add_f32 v37, v37, v45
    v_add_f32 v38, v38, v46
    v_add_f32 v39, v39, v47
cs_18:
    s_waitcnt vmcnt(0)
    s_waitcnt vmcnt(0)
    s_barrier
    s_mov_b32 m0, 151552
    s_mov_b32 s48, 57344
    buffer_load_dwordx4 v6, s[20:23], s48 offen sc1 lds
    s_mov_b32 m0, 152576
    s_mov_b32 s48, 59392
    buffer_load_dwordx4 v6, s[20:23], s48 offen sc1 lds
    s_mov_b32 m0, 153600
    s_mov_b32 s48, 61440
    buffer_load_dwordx4 v6, s[20:23], s48 offen sc1 lds
    s_mov_b32 m0, 154624
    s_mov_b32 s48, 63488
    buffer_load_dwordx4 v6, s[20:23], s48 offen sc1 lds
    s_cmp_ge_u32 s9, 2
    s_cbranch_scc1 cs_19
    v_add_f32 v32, v32, v36
    v_add_f32 v33, v33, v37
    v_add_f32 v34, v34, v38
    v_add_f32 v35, v35, v39
    v_add_f32 v32, v32, v34
    v_add_f32 v33, v33, v35
    ds_write_b64 v12, v[32:33]
    s_waitcnt lgkmcnt(0)
cs_19:
    s_waitcnt vmcnt(0)
    s_waitcnt vmcnt(0)
    s_barrier
    s_barrier
    s_barrier
    s_branch h_wo
h_qkvB:
    s_mul_i32 s98, s9, 786432
    s_add_u32 s98, s98, 65273856
    s_lshl_b32 s99, s11, 10
    s_add_u32 s98, s98, s99
    s_add_u32 s96, s4, s98
    s_addc_u32 s97, s5, 0
    s_mov_b32 s98, s10
    s_mov_b32 s99, s10
    v_and_b32 v1, 63, v0
    v_lshlrev_b32 v5, 4, v1
    v_and_b32 v20, 15, v1
    v_lshrrev_b32 v11, 4, v1
    v_min_u32 v11, 2, v11
    v_lshlrev_b32 v21, 3, v20
    v_lshl_add_u32 v12, v11, 7, v21
    v_add_u32 v12, 156032, v12
    v_lshl_add_u32 v11, v11, 16, v21
    v_mov_b32 v10, 159496
    s_add_u32 s3, s9, 1
    v_mov_b32 v13, s3
    v_mov_b32 v16, v5
    s_barrier
    s_cmp_lt_u32 s9, 2
    s_cbranch_scc1 c4_22
    ds_write_b128 v16, v[160:163] offset:0
    ds_write_b128 v16, v[164:167] offset:1024
    ds_write_b128 v16, v[168:171] offset:2048
    ds_write_b128 v16, v[172:175] offset:3072
    ds_write_b128 v16, v[176:179] offset:4096
    ds_write_b128 v16, v[180:183] offset:5120
    ds_write_b128 v16, v[184:187] offset:6144
    ds_write_b128 v16, v[188:191] offset:7168
    ds_write_b128 v16, v[192:195] offset:8192
    ds_write_b128 v16, v[196:199] offset:9216
    ds_write_b128 v16, v[200:203] offset:10240
    ds_write_b128 v16, v[204:207] offset:11264
    ds_write_b128 v16, v[208:211] offset:12288
    ds_write_b128 v16, v[212:215] offset:13312
    ds_write_b128 v16, v[216:219] offset:14336
    ds_write_b128 v16, v[220:223] offset:15360
    ds_write_b128 v16, a[0:3] offset:16384
    ds_write_b128 v16, a[4:7] offset:17408
    ds_write_b128 v16, a[8:11] offset:18432
    ds_write_b128 v16, a[12:15] offset:19456
    ds_write_b128 v16, a[16:19] offset:20480
    ds_write_b128 v16, a[20:23] offset:21504
    ds_write_b128 v16, a[24:27] offset:22528
    ds_write_b128 v16, a[28:31] offset:23552
    s_waitcnt lgkmcnt(0)
c4_22:
    s_barrier
    s_mov_b32 s3, 0x100000
poll_23:
    s_load_dwordx8 s[88:95], s[96:97], 0 glc
    s_sub_u32 s3, s3, 1
    s_cbranch_scc1 poll_23_ok
    s_waitcnt lgkmcnt(0)
    s_xor_b64 s[100:101], s[88:89], s[98:99]
    s_xor_b64 s[88:89], s[90:91], s[98:99]
    s_or_b64 s[100:101], s[100:101], s[88:89]
    s_xor_b64 s[88:89], s[92:93], s[98:99]
    s_or_b64 s[100:101], s[100:101], s[88:89]
    s_xor_b64 s[88:89], s[94:95], s[98:99]
    s_or_b64 s[100:101], s[100:101], s[88:89]
    s_cbranch_scc1 poll_23
poll_23_ok:
    s_waitcnt lgkmcnt(0)
    ds_write_b32 v10, v13
    s_lshl_b32 s56, s7, 12
    s_and_b32 s57, s6, 1
    s_lshl_b32 s57, s57, 7
    s_add_u32 s56, s56, s57
    s_add_u32 s56, s56, 64159744
    s_barrier
    s_cmp_ge_u32 s9, 2
    s_cbranch_scc1 c4_24
    ds_read_b128 v[160:163], v16 offset:0
    ds_read_b128 v[164:167], v16 offset:1024
    ds_read_b128 v[168:171], v16 offset:2048
    ds_read_b128 v[172:175], v16 offset:3072
    ds_read_b128 v[176:179], v16 offset:4096
    ds_read_b128 v[180:183], v16 offset:5120
    ds_read_b128 v[184:187], v16 offset:6144
    ds_read_b128 v[188:191], v16 offset:7168
    ds_read_b128 v[192:195], v16 offset:8192
    ds_read_b128 v[196:199], v16 offset:9216
    ds_read_b128 v[200:203], v16 offset:10240
    ds_read_b128 v[204:207], v16 offset:11264
    ds_read_b128 v[208:211], v16 offset:12288
    ds_read_b128 v[212:215], v16 offset:13312
    ds_read_b128 v[216:219], v16 offset:14336
    ds_read_b128 v[220:223], v16 offset:15360
    ds_read_b128 a[0:3], v16 offset:16384
    ds_read_b128 a[4:7], v16 offset:17408
    ds_read_b128 a[8:11], v16 offset:18432
    ds_read_b128 a[12:15], v16 offset:19456
    ds_read_b128 a[16:19], v16 offset:20480
    ds_read_b128 a[20:23], v16 offset:21504
    ds_read_b128 a[24:27], v16 offset:22528
    ds_read_b128 a[28:31], v16 offset:23552
    s_waitcnt lgkmcnt(0)
c4_24:
    s_barrier
    s_barrier
    s_cmp_ge_u32 s9, 2
    s_cbranch_scc1 cs_26
    buffer_load_dwordx2 v[32:33], v11, s[12:15], s56 offen offset:0 sc1
    buffer_load_dwordx2 v[34:35], v11, s[12:15], s56 offen offset:256 sc1
    buffer_load_dwordx2 v[36:37], v11, s[12:15], s56 offen offset:512 sc1
    buffer_load_dwordx2 v[38:39], v11, s[12:15], s56 offen offset:768 sc1
    buffer_load_dwordx2 v[40:41], v11, s[12:15], s56 offen offset:1024 sc1
    buffer_load_dwordx2 v[42:43], v11, s[12:15], s56 offen offset:1280 sc1
    buffer_load_dwordx2 v[44:45], v11, s[12:15], s56 offen offset:1536 sc1
    buffer_load_dwordx2 v[46:47], v11, s[12:15], s56 offen offset:1792 sc1
    buffer_load_dwordx2 v[48:49], v11, s[12:15], s56 offen offset:2048 sc1
    buffer_load_dwordx2 v[50:51], v11, s[12:15], s56 offen offset:2304 sc1
    buffer_load_dwordx2 v[52:53], v11, s[12:15], s56 offen offset:2560 sc1
    buffer_load_dwordx2 v[54:55], v11, s[12:15], s56 offen offset:2816 sc1
cs_26:
    s_barrier
    s_cmp_ge_u32 s9, 2
    s_cbranch_scc1 cs_27
    buffer_load_dwordx2 v[56:57], v11, s[12:15], s56 offen offset:3072 sc1
    buffer_load_dwordx2 v[58:59], v11, s[12:15], s56 offen offset:3328 sc1
    buffer_load_dwordx2 v[60:61], v11, s[12:15], s56 offen offset:3584 sc1
    buffer_load_dwordx2 v[62:63], v11, s[12:15], s56 offen offset:3840 sc1
cs_27:
    s_barrier
    s_cmp_ge_u32 s9, 2
    s_cbranch_scc1 cs_28
    s_waitcnt vmcnt(0)
    v_add_f32 v32, v32, v48
    v_add_f32 v33, v33, v49
    v_add_f32 v34, v34, v50
    v_add_f32 v35, v35, v51
    v_add_f32 v36, v36, v52
    v_add_f32 v37, v37, v53
    v_add_f32 v38, v38, v54
    v_add_f32 v39, v39, v55
    v_add_f32 v40, v40, v56
    v_add_f32 v41, v41, v57
    v_add_f32 v42, v42, v58
    v_add_f32 v43, v43, v59
cs_28:
    s_barrier
    s_cmp_ge_u32 s9, 2
    s_cbranch_scc1 cs_29
    v_add_f32 v44, v44, v60
    v_add_f32 v45, v45, v61
    v_add_f32 v46, v46, v62
    v_add_f32 v47, v47, v63
    v_add_f32 v32, v32, v40
    v_add_f32 v33, v33, v41
    v_add_f32 v34, v34, v42
    v_add_f32 v35, v35, v43
    v_add_f32 v36, v36, v44
    v_add_f32 v37, v37, v45
    v_add_f32 v38, v38, v46
    v_add_f32 v39, v39, v47
cs_29:
    s_barrier
    s_cmp_ge_u32 s9, 2
    s_cbranch_scc1 cs_30
    v_add_f32 v32, v32, v36
    v_add_f32 v33, v33, v37
    v_add_f32 v34, v34, v38
    v_add_f32 v35, v35, v39
    v_add_f32 v32, v32, v34
    v_add_f32 v33, v33, v35
    ds_write_b64 v12, v[32:33]
    s_waitcnt lgkmcnt(0)
cs_30:
    s_barrier
    s_barrier
    s_branch s_attn
.p2align 6
l_first_tail:
    s_mov_b32 s28, s40
    s_mov_b32 s29, s41
    s_mov_b32 s30, 6291456
    s_mov_b32 s31, 0x00020000
    v_lshlrev_b32 v14, 6, v20
    v_lshrrev_b32 v22, 5, v1
    v_bfe_u32 v23, v1, 1, 1
    v_xor_b32 v22, v22, v23
    v_lshl_add_u32 v14, v22, 5, v14
    v_and_b32 v22, 1, v1
    v_lshl_add_u32 v14, v22, 4, v14
    v_bfe_u32 v23, v1, 2, 1
    v_mul_u32_u24 v23, 196608, v23
    v_add_u32 v14, v14, v23
    v_lshlrev_b32 v22, 4, v22
    v_mov_b32 v23, 0x3f80
    v_lshlrev_b32 v23, v22, v23
    v_bfe_u32 v22, v1, 1, 3
    v_cmp_eq_u32 vcc, 0, v22
    s_nop 1
    v_cndmask_b32 v24, 0, v23, vcc
    v_cmp_eq_u32 vcc, 1, v22
    s_nop 1
    v_cndmask_b32 v25, 0, v23, vcc
    v_cmp_eq_u32 vcc, 2, v22
    s_nop 1
    v_cndmask_b32 v26, 0, v23, vcc
    v_cmp_eq_u32 vcc, 3, v22
    s_nop 1
    v_cndmask_b32 v27, 0, v23, vcc
    v_lshlrev_b32 v15, 5, v21
    v_and_b32 v22, 16, v1
    v_add_u32 v15, v15, v22
    v_lshlrev_b32 v16, 14, v1
    s_mov_b32 s9, 0
    s_lshr_b32 s55, s63, 4
    s_and_b32 s56, s63, 15
    s_lshl_b32 s57, s56, 4
    s_lshr_b32 s58, s62, 1
    s_add_u32 s57, s57, s58
    s_mul_i32 s57, s57, 3
    s_add_u32 s57, s57, s55
    s_lshl_b32 s57, s57, 13
    s_and_b32 s58, s62, 1
    s_lshl_b32 s58, s58, 12
    s_add_u32 s57, s57, s58
    s_add_u32 s57, s57, 50331648
    s_lshl_b32 s54, s61, 8
    s_add_u32 s54, s54, 63963136
    s_lshl_b32 s56, s56, 10
    s_lshl_b32 s55, s55, 7
    s_add_u32 s55, s55, s56
    s_lshl_b32 s56, s62, 2
    s_add_u32 s55, s55, s56
    s_add_u32 s55, s55, 64487424
    s_waitcnt vmcnt(7)
    buffer_store_dwordx4 v[160:163], v14, s[12:15], s57 offen offset:0 sc1
    v_mfma_f32_16x16x32_bf16 v[28:31], v[24:27], v[160:163], 0
    s_waitcnt vmcnt(7)
    buffer_store_dwordx4 v[164:167], v14, s[12:15], s57 offen offset:1024 sc1
    v_mfma_f32_16x16x32_bf16 v[28:31], v[24:27], v[164:167], v[28:31]
    s_waitcnt vmcnt(7)
    buffer_store_dwordx4 v[168:171], v14, s[12:15], s57 offen offset:512 sc1
    v_mfma_f32_16x16x32_bf16 v[28:31], v[24:27], v[168:171], v[28:31]
    s_waitcnt vmcnt(7)
    buffer_store_dwordx4 v[172:175], v14, s[12:15], s57 offen offset:1536 sc1
    v_mfma_f32_16x16x32_bf16 v[28:31], v[24:27], v[172:175], v[28:31]
    s_waitcnt vmcnt(7)
    buffer_store_dwordx4 v[176:179], v14, s[12:15], s57 offen offset:2048 sc1
    v_mfma_f32_16x16x32_bf16 v[28:31], v[24:27], v[176:179], v[28:31]
    s_waitcnt vmcnt(7)
    buffer_store_dwordx4 v[180:183], v14, s[12:15], s57 offen offset:3072 sc1
    v_mfma_f32_16x16x32_bf16 v[28:31], v[24:27], v[180:183], v[28:31]
    s_waitcnt vmcnt(7)
    buffer_store_dwordx4 v[184:187], v14, s[12:15], s57 offen offset:2560 sc1
    v_mfma_f32_16x16x32_bf16 v[28:31], v[24:27], v[184:187], v[28:31]
    s_waitcnt vmcnt(7)
    buffer_store_dwordx4 v[188:191], v14, s[12:15], s57 offen offset:3584 sc1
    v_mfma_f32_16x16x32_bf16 v[28:31], v[24:27], v[188:191], v[28:31]
    s_nop 7
    v_add_f32_dpp v28, v28, v28 row_ror:8 row_mask:0xf bank_mask:0xf
    v_add_f32_dpp v29, v29, v29 row_ror:8 row_mask:0xf bank_mask:0xf
    v_add_f32_dpp v30, v30, v30 row_ror:8 row_mask:0xf bank_mask:0xf
    v_add_f32_dpp v31, v31, v31 row_ror:8 row_mask:0xf bank_mask:0xf
    s_mov_b64 exec, 0x00ff00ff
    buffer_store_dwordx4 v[28:31], v15, s[12:15], s54 offen sc1
    s_mov_b64 exec, -1
    s_add_u32 s57, s57, 6291456
    s_add_u32 s54, s54, 196608
    v_mov_b32 v8, 159492
non_33:
    ds_read_b32 v9, v8
    s_waitcnt lgkmcnt(0)
    v_readfirstlane_b32 s10, v9
    s_cmp_eq_u32 s10, 0
    s_cbranch_scc1 non_33
    s_mov_b64 exec, 0xffff
    s_waitcnt vmcnt(0)
    buffer_store_dword v9, v16, s[12:15], s55 offen offset:0 sc1
    s_mov_b64 exec, -1
    s_add_u32 s53, s52, 0
    buffer_load_dwordx4 v[192:195], v12, s[28:31], s53 offen nt
    s_add_u32 s53, s52, 49152
    buffer_load_dwordx4 v[196:199], v12, s[28:31], s53 offen nt
    s_add_u32 s53, s52, 98304
    buffer_load_dwordx4 v[200:203], v12, s[28:31], s53 offen nt
    s_add_u32 s53, s52, 147456
    buffer_load_dwordx4 v[204:207], v12, s[28:31], s53 offen nt
    s_add_u32 s53, s52, 196608
    buffer_load_dwordx4 v[208:211], v12, s[28:31], s53 offen nt
    s_add_u32 s53, s52, 245760
    buffer_load_dwordx4 v[212:215], v12, s[28:31], s53 offen nt
    s_add_u32 s53, s52, 294912
    buffer_load_dwordx4 v[216:219], v12, s[28:31], s53 offen nt
    s_add_u32 s53, s52, 344064
    buffer_load_dwordx4 v[220:223], v12, s[28:31], s53 offen nt
    s_mov_b32 s58, s52
    s_lshr_b32 s60, s2, 3
    s_mul_i32 s60, s60, 3
    s_lshr_b32 s60, s60, 5
    s_add_u32 s60, s60, 1
    s_branch l_qkv2
l_qkv:
    s_mov_b32 s60, 0
l_qkv2:
    v_and_b32 v1, 63, v0
    v_lshlrev_b32 v5, 4, v1
    s_sub_u32 s51, s8, 5
    s_lshl_b32 s48, s51, 13
    s_and_b32 s53, s9, 1
    s_lshl_b32 s52, s53, 4
    s_add_u32 s49, s7, s52
    s_lshl_b32 s49, s49, 1
    s_and_b32 s52, s6, 1
    s_add_u32 s49, s49, s52
    s_mul_i32 s49, s49, 196608
    s_add_u32 s49, s49, s48
    s_add_u32 s49, s49, 50331648
    v_mov_b32 v13, 159496
    s_mov_b32 s50, 0
    v_lshrrev_b32 v10, 2, v1
    v_and_b32 v11, 3, v1
    v_lshlrev_b32 v10, 8, v10
    v_lshl_add_u32 v10, v11, 4, v10
    v_lshlrev_b32 v7, 5, v11
    v_lshlrev_b32 v11, 2, v1
    v_add_u32 v11, 155648, v11
    s_lshr_b32 s59, s11, 2
    s_lshl_b32 s59, s59, 12
    s_and_b32 s3, s11, 3
    s_lshl_b32 s3, s3, 6
    s_add_u32 s59, s59, s3
    s_lshl_b32 s3, s9, 18
    s_add_u32 s59, s59, s3
    s_add_u32 s59, s59, 62914560
    s_lshl_b32 s56, s9, 15
    s_add_u32 s56, s56, 64749568
    v_mov_b32 v41, s10
    v_mov_b32 v43, s10
    v_mov_b32 v45, s10
    v_mov_b32 v47, s10
    v_and_b32 v6, 0xff, v5
    s_lshl_b32 s3, s7, 7
    v_lshrrev_b32 v20, 3, v1
    v_lshlrev_b32 v21, 11, v20
    v_and_b32 v22, 2, v20
    v_lshrrev_b32 v23, 2, v20
    v_or_b32 v22, v22, v23
    v_bfe_u32 v23, v1, 1, 2
    v_xor_b32 v22, v22, v23
    v_lshl_add_u32 v21, v22, 5, v21
    v_and_b32 v22, 1, v1
    v_lshl_add_u32 v21, v22, 4, v21
    v_add_u32 v17, s3, v21
    s_lshl_b32 s3, s51, 13
    s_add_u32 s3, s3, 24576
    v_add_u32 v3, s3, v5
    s_cmp_lg_u32 s9, 0
    s_cbranch_scc1 l_qkv_tiled
    s_lshl_b32 s53, s8, 7
    s_lshl_b32 s52, s11, 10
    s_add_u32 s53, s53, s52
    s_add_u32 s53, s53, 64486784
    s_add_u32 s96, s4, s53
    s_addc_u32 s97, s5, 0
    s_mov_b32 s98, s10
    s_mov_b32 s99, s10
    s_mov_b32 s3, 0x100000
poll_34:
    s_load_dwordx16 s[80:95], s[96:97], 0 glc
    s_sub_u32 s3, s3, 1
    s_cbranch_scc1 poll_34_ok
    s_waitcnt lgkmcnt(0)
    s_xor_b64 s[100:101], s[80:81], s[98:99]
    s_xor_b64 s[80:81], s[82:83], s[98:99]
    s_or_b64 s[100:101], s[100:101], s[80:81]
    s_xor_b64 s[80:81], s[84:85], s[98:99]
    s_or_b64 s[100:101], s[100:101], s[80:81]
    s_xor_b64 s[80:81], s[86:87], s[98:99]
    s_or_b64 s[100:101], s[100:101], s[80:81]
    s_xor_b64 s[80:81], s[88:89], s[98:99]
    s_or_b64 s[100:101], s[100:101], s[80:81]
    s_xor_b64 s[80:81], s[90:91], s[98:99]
    s_or_b64 s[100:101], s[100:101], s[80:81]
    s_xor_b64 s[80:81], s[92:93], s[98:99]
    s_or_b64 s[100:101], s[100:101], s[80:81]
    s_xor_b64 s[80:81], s[94:95], s[98:99]
    s_or_b64 s[100:101], s[100:101], s[80:81]
    s_cbranch_scc1 poll_34
poll_34_ok:
    s_waitcnt lgkmcnt(0)
    s_branch l_qkv_fill
l_qkv_tiled:
    s_barrier
    s_cmp_lt_u32 s9, 2
    s_cbranch_scc1 l_qkv_nocache
    s_bitcmp1_b32 s9, 0
    s_cbranch_scc1 l_qkv_c_b
    ds_write_b128 v3, v[64:67] offset:0
    ds_write_b128 v3, v[68:71] offset:1024
    ds_write_b128 v3, v[72:75] offset:2048
    ds_write_b128 v3, v[76:79] offset:3072
    ds_write_b128 v3, v[80:83] offset:4096
    ds_write_b128 v3, v[84:87] offset:5120
    ds_write_b128 v3, v[88:91] offset:6144
    ds_write_b128 v3, v[92:95] offset:7168
    ds_write_b128 v3, v[96:99] offset:24576
    ds_write_b128 v3, v[100:103] offset:25600
    ds_write_b128 v3, v[104:107] offset:26624
    ds_write_b128 v3, v[108:111] offset:27648
    ds_write_b128 v3, v[112:115] offset:28672
    ds_write_b128 v3, v[116:119] offset:29696
    ds_write_b128 v3, v[120:123] offset:30720
    ds_write_b128 v3, v[124:127] offset:31744
    ds_write_b128 v3, v[128:131] offset:49152
    ds_write_b128 v3, v[132:135] offset:50176
    ds_write_b128 v3, v[136:139] offset:51200
    ds_write_b128 v3, v[140:143] offset:52224
    ds_write_b128 v3, v[144:147] offset:53248
    ds_write_b128 v3, v[148:151] offset:54272
    ds_write_b128 v3, v[152:155] offset:55296
    ds_write_b128 v3, v[156:159] offset:56320
    s_branch l_qkv_c_w
l_qkv_c_b:
    ds_write_b128 v3, v[160:163] offset:0
    ds_write_b128 v3, v[164:167] offset:1024
    ds_write_b128 v3, v[168:171] offset:2048
    ds_write_b128 v3, v[172:175] offset:3072
    ds_write_b128 v3, v[176:179] offset:4096
    ds_write_b128 v3, v[180:183] offset:5120
    ds_write_b128 v3, v[184:187] offset:6144
    ds_write_b128 v3, v[188:191] offset:7168
    ds_write_b128 v3, v[192:195] offset:24576
    ds_write_b128 v3, v[196:199] offset:25600
    ds_write_b128 v3, v[200:203] offset:26624
    ds_write_b128 v3, v[204:207] offset:27648
    ds_write_b128 v3, v[208:211] offset:28672
    ds_write_b128 v3, v[212:215] offset:29696
    ds_write_b128 v3, v[216:219] offset:30720
    ds_write_b128 v3, v[220:223] offset:31744
    ds_write_b128 v3, a[0:3] offset:49152
    ds_write_b128 v3, a[4:7] offset:50176
    ds_write_b128 v3, a[8:11] offset:51200
    ds_write_b128 v3, a[12:15] offset:52224
    ds_write_b128 v3, a[16:19] offset:53248
    ds_write_b128 v3, a[20:23] offset:54272
    ds_write_b128 v3, a[24:27] offset:55296
    ds_write_b128 v3, a[28:31] offset:56320
l_qkv_c_w:
    s_waitcnt lgkmcnt(0)
    s_mov_b32 s50, 8
    s_add_u32 s49, s49, 98304
    s_add_u32 s48, s48, 98304
    s_barrier
    s_mov_b32 m0, s48
    s_add_u32 s50, s50, 1
    buffer_load_dwordx4 v5, s[12:15], s49 offen offset:0 sc1 lds
    buffer_load_dwordx4 v5, s[12:15], s49 offen offset:1024 sc1 lds
    buffer_load_dwordx4 v5, s[12:15], s49 offen offset:2048 sc1 lds
    buffer_load_dwordx4 v5, s[12:15], s49 offen offset:3072 sc1 lds
    s_add_u32 s49, s49, 4096
    s_bitcmp1_b32 s50, 0
    s_cselect_b32 s3, 0, 16384
    s_add_u32 s48, s48, s3
    s_add_u32 s49, s49, s3
    s_cmp_eq_u32 s50, 12
    s_cselect_b32 s3, 4294819840, 0
    s_add_u32 s48, s48, 4096
    s_add_u32 s48, s48, s3
    s_mov_b32 m0, s48
    s_add_u32 s50, s50, 1
    buffer_load_dwordx4 v5, s[12:15], s49 offen offset:0 sc1 lds
    buffer_load_dwordx4 v5, s[12:15], s49 offen offset:1024 sc1 lds
    buffer_load_dwordx4 v5, s[12:15], s49 offen offset:2048 sc1 lds
    buffer_load_dwordx4 v5, s[12:15], s49 offen offset:3072 sc1 lds
    s_add_u32 s49, s49, 4096
    s_bitcmp1_b32 s50, 0
    s_cselect_b32 s3, 0, 16384
    s_add_u32 s48, s48, s3
    s_add_u32 s49, s49, s3
    s_cmp_eq_u32 s50, 12
    s_cselect_b32 s3, 4294819840, 0
    s_add_u32 s48, s48, 4096
    s_add_u32 s48, s48, s3
    s_mov_b32 m0, s48
    s_add_u32 s50, s50, 1
    buffer_load_dwordx4 v5, s[12:15], s49 offen offset:0 sc1 lds
    buffer_load_dwordx4 v5, s[12:15], s49 offen offset:1024 sc1 lds
    buffer_load_dwordx4 v5, s[12:15], s49 offen offset:2048 sc1 lds
    buffer_load_dwordx4 v5, s[12:15], s49 offen offset:3072 sc1 lds
    s_add_u32 s49, s49, 4096
    s_bitcmp1_b32 s50, 0
    s_cselect_b32 s3, 0, 16384
    s_add_u32 s48, s48, s3
    s_add_u32 s49, s49, s3
    s_cmp_eq_u32 s50, 12
    s_cselect_b32 s3, 4294819840, 0
    s_add_u32 s48, s48, 4096
    s_add_u32 s48, s48, s3
    s_mov_b32 m0, s48
    s_add_u32 s50, s50, 1
    buffer_load_dwordx4 v5, s[12:15], s49 offen offset:0 sc1 lds
    buffer_load_dwordx4 v5, s[12:15], s49 offen offset:1024 sc1 lds
    buffer_load_dwordx4 v5, s[12:15], s49 offen offset:2048 sc1 lds
    buffer_load_dwordx4 v5, s[12:15], s49 offen offset:3072 sc1 lds
    s_add_u32 s49, s49, 4096
    s_bitcmp1_b32 s50, 0
    s_cselect_b32 s3, 0, 16384
    s_add_u32 s48, s48, s3
    s_add_u32 s49, s49, s3
    s_cmp_eq_u32 s50, 12
    s_cselect_b32 s3, 4294819840, 0
    s_add_u32 s48, s48, 4096
    s_add_u32 s48, s48, s3
    s_barrier
    s_branch l_qkv_gone
l_qkv_nocache:
    s_barrier
l_qkv_fill:
    s_mov_b32 m0, s48
    s_add_u32 s50, s50, 1
    buffer_load_dwordx4 v5, s[12:15], s49 offen offset:0 sc1 lds
    buffer_load_dwordx4 v5, s[12:15], s49 offen offset:1024 sc1 lds
    buffer_load_dwordx4 v5, s[12:15], s49 offen offset:2048 sc1 lds
    buffer_load_dwordx4 v5, s[12:15], s49 offen offset:3072 sc1 lds
    s_add_u32 s49, s49, 4096
    s_bitcmp1_b32 s50, 0
    s_cselect_b32 s3, 0, 16384
    s_add_u32 s48, s48, s3
    s_add_u32 s49, s49, s3
    s_cmp_eq_u32 s50, 12
    s_cselect_b32 s3, 4294819840, 0
    s_add_u32 s48, s48, 4096
    s_add_u32 s48, s48, s3
l_qkv_fill1:
    s_mov_b32 m0, s48
    s_add_u32 s50, s50, 1
    buffer_load_dwordx4 v5, s[12:15], s49 offen offset:0 sc1 lds
    buffer_load_dwordx4 v5, s[12:15], s49 offen offset:1024 sc1 lds
    buffer_load_dwordx4 v5, s[12:15], s49 offen offset:2048 sc1 lds
    buffer_load_dwordx4 v5, s[12:15], s49 offen offset:3072 sc1 lds
    s_add_u32 s49, s49, 4096
    s_bitcmp1_b32 s50, 0
    s_cselect_b32 s3, 0, 16384
    s_add_u32 s48, s48, s3
    s_add_u32 s49, s49, s3
    s_cmp_eq_u32 s50, 12
    s_cselect_b32 s3, 4294819840, 0
    s_add_u32 s48, s48, 4096
    s_add_u32 s48, s48, s3
l_qkv_fill2:
    s_add_u32 s52, s9, 1
    s_mov_b32 m0, s48
    s_add_u32 s50, s50, 1
    buffer_load_dwordx4 v5, s[12:15], s49 offen offset:0 sc1 lds
    s_waitcnt vmcnt(10)
    buffer_load_dwordx4 v5, s[12:15], s49 offen offset:1024 sc1 lds
    s_waitcnt vmcnt(10)
    buffer_load_dwordx4 v5, s[12:15], s49 offen offset:2048 sc1 lds
    s_waitcnt vmcnt(10)
    buffer_load_dwordx4 v5, s[12:15], s49 offen offset:3072 sc1 lds
    s_waitcnt vmcnt(10)
    s_add_u32 s49, s49, 4096
    s_bitcmp1_b32 s50, 0
    s_cselect_b32 s3, 0, 16384
    s_add_u32 s48, s48, s3
    s_add_u32 s49, s49, s3
    s_cmp_eq_u32 s50, 12
    s_cselect_b32 s3, 4294819840, 0
    s_add_u32 s48, s48, 4096
    s_add_u32 s48, s48, s3
l_qkv_pre:
    s_mov_b32 m0, s48
    s_add_u32 s50, s50, 1
    buffer_load_dwordx4 v5, s[12:15], s49 offen offset:0 sc1 lds
    s_waitcnt vmcnt(10)
    buffer_load_dwordx4 v5, s[12:15], s49 offen offset:1024 sc1 lds
    s_waitcnt vmcnt(10)
    buffer_load_dwordx4 v5, s[12:15], s49 offen offset:2048 sc1 lds
    s_waitcnt vmcnt(10)
    buffer_load_dwordx4 v5, s[12:15], s49 offen offset:3072 sc1 lds
    s_waitcnt vmcnt(10)
    s_add_u32 s49, s49, 4096
    s_bitcmp1_b32 s50, 0
    s_cselect_b32 s3, 0, 16384
    s_add_u32 s48, s48, s3
    s_add_u32 s49, s49, s3
    s_cmp_eq_u32 s50, 12
    s_cselect_b32 s3, 4294819840, 0
    s_add_u32 s48, s48, 4096
    s_add_u32 s48, s48, s3
    ds_read_b32 v8, v13
    s_cmp_ge_u32 s50, 12
    s_cbranch_scc1 l_qkv_go
    s_waitcnt lgkmcnt(0)
    v_readfirstlane_b32 s3, v8
    s_cmp_lg_u32 s3, s52
    s_cbranch_scc1 l_qkv_pre
    s_cmp_ge_u32 s50, 5
    s_cbranch_scc1 l_qkv_go
    s_waitcnt vmcnt(8)
l_qkv_go:
    s_waitcnt lgkmcnt(0)
    s_barrier
l_qkv_gone:
    s_bitcmp0_b32 s50, 0
    s_cbranch_scc1 l_qkv_even
    s_mov_b32 m0, s48
    s_add_u32 s50, s50, 1
    buffer_load_dwordx4 v5, s[12:15], s49 offen offset:0 sc1 lds
    buffer_load_dwordx4 v5, s[12:15], s49 offen offset:1024 sc1 lds
    buffer_load_dwordx4 v5, s[12:15], s49 offen offset:2048 sc1 lds
    buffer_load_dwordx4 v5, s[12:15], s49 offen offset:3072 sc1 lds
    s_add_u32 s49, s49, 4096
    s_bitcmp1_b32 s50, 0
    s_cselect_b32 s3, 0, 16384
    s_add_u32 s48, s48, s3
    s_add_u32 s49, s49, s3
    s_cmp_eq_u32 s50, 12
    s_cselect_b32 s3, 4294819840, 0
    s_add_u32 s48, s48, 4096
    s_add_u32 s48, s48, s3
l_qkv_even:
    s_cmp_gt_u32 s50, 11
    s_cbranch_scc1 stg_35
    s_mov_b32 m0, s48
    s_add_u32 s50, s50, 1
    buffer_load_dwordx4 v5, s[12:15], s49 offen offset:0 sc1 lds
    buffer_load_dwordx4 v5, s[12:15], s49 offen offset:1024 sc1 lds
    buffer_load_dwordx4 v5, s[12:15], s49 offen offset:2048 sc1 lds
    buffer_load_dwordx4 v5, s[12:15], s49 offen offset:3072 sc1 lds
    s_add_u32 s49, s49, 4096
    s_bitcmp1_b32 s50, 0
    s_cselect_b32 s3, 0, 16384
    s_add_u32 s48, s48, s3
    s_add_u32 s49, s49, s3
    s_cmp_eq_u32 s50, 12
    s_cselect_b32 s3, 4294819840, 0
    s_add_u32 s48, s48, 4096
    s_add_u32 s48, s48, s3
    s_cmp_ge_u32 s9, 2
    s_cbranch_scc1 stg_35
stg_35:
    s_cmp_lg_u32 s51, 0
    s_cbranch_scc1 role_36
    buffer_load_dwordx4 v[32:35], v10, s[12:15], s59 offen sc1
role_36:
    s_lshr_b32 s3, s9, 1
    s_andn2_b32 s3, s50, s3
    s_bitcmp0_b32 s3, 0
    s_cbranch_scc1 str_37
    s_waitcnt vmcnt(1)
    s_mov_b32 m0, s48
    s_add_u32 s50, s50, 1
    buffer_load_dwordx4 v5, s[12:15], s49 offen offset:0 sc1 lds
    buffer_load_dwordx4 v5, s[12:15], s49 offen offset:1024 sc1 lds
    buffer_load_dwordx4 v5, s[12:15], s49 offen offset:2048 sc1 lds
    buffer_load_dwordx4 v5, s[12:15], s49 offen offset:3072 sc1 lds
    s_add_u32 s49, s49, 4096
    s_bitcmp1_b32 s50, 0
    s_cselect_b32 s3, 0, 16384
    s_add_u32 s48, s48, s3
    s_add_u32 s49, s49, s3
    s_cmp_eq_u32 s50, 12
    s_cselect_b32 s3, 4294819840, 0
    s_add_u32 s48, s48, 4096
    s_add_u32 s48, s48, s3
str_37:
    s_waitcnt vmcnt(8)
    s_barrier
    s_waitcnt vmcnt(0)
l_qkv_b0:
    s_cmp_gt_u32 s50, 13
    s_cbranch_scc1 stg_38
    s_mov_b32 m0, s48
    s_add_u32 s50, s50, 1
    buffer_load_dwordx4 v5, s[12:15], s49 offen offset:0 sc1 lds
    buffer_load_dwordx4 v5, s[12:15], s49 offen offset:1024 sc1 lds
    buffer_load_dwordx4 v5, s[12:15], s49 offen offset:2048 sc1 lds
    buffer_load_dwordx4 v5, s[12:15], s49 offen offset:3072 sc1 lds
    s_add_u32 s49, s49, 4096
    s_bitcmp1_b32 s50, 0
    s_cselect_b32 s3, 0, 16384
    s_add_u32 s48, s48, s3
    s_add_u32 s49, s49, s3
    s_cmp_eq_u32 s50, 12
    s_cselect_b32 s3, 4294819840, 0
    s_add_u32 s48, s48, 4096
    s_add_u32 s48, s48, s3
    s_cmp_ge_u32 s9, 2
    s_cbranch_scc1 stg_38
stg_38:
    s_cmp_eq_u32 s60, 0
    s_cbranch_scc1 ub_39
    buffer_store_dwordx4 v[192:195], v14, s[12:15], s57 offen offset:0 sc1
    v_mfma_f32_16x16x32_bf16 v[28:31], v[24:27], v[192:195], 0
    buffer_store_dwordx4 v[196:199], v14, s[12:15], s57 offen offset:1024 sc1
    v_mfma_f32_16x16x32_bf16 v[28:31], v[24:27], v[196:199], v[28:31]
ub_39:
    s_cmp_ge_u32 s9, 2
    s_cbranch_scc1 wc_40
    s_bitcmp1_b32 s9, 0
    s_cbranch_scc1 wc_40_b
    ds_read_b128 v[64:67], v3 offset:0
    ds_read_b128 v[68:71], v3 offset:1024
    ds_read_b128 v[72:75], v3 offset:2048
    ds_read_b128 v[76:79], v3 offset:3072
    ds_read_b128 v[80:83], v3 offset:4096
    ds_read_b128 v[84:87], v3 offset:5120
    ds_read_b128 v[88:91], v3 offset:6144
    ds_read_b128 v[92:95], v3 offset:7168
    s_branch wc_40_w
wc_40_b:
    ds_read_b128 v[160:163], v3 offset:0
    ds_read_b128 v[164:167], v3 offset:1024
    ds_read_b128 v[168:171], v3 offset:2048
    ds_read_b128 v[172:175], v3 offset:3072
    ds_read_b128 v[176:179], v3 offset:4096
    ds_read_b128 v[180:183], v3 offset:5120
    ds_read_b128 v[184:187], v3 offset:6144
    ds_read_b128 v[188:191], v3 offset:7168
wc_40_w:
    s_waitcnt lgkmcnt(0)
wc_40:
    s_cmp_lg_u32 s51, 0
    s_cbranch_scc1 role_41
    v_add_f32_dpp v32, v32, v32 row_ror:4 row_mask:0xf bank_mask:0xf
    v_add_f32_dpp v33, v33, v33 row_ror:4 row_mask:0xf bank_mask:0xf
    v_add_f32_dpp v34, v34, v34 row_ror:4 row_mask:0xf bank_mask:0xf
    v_add_f32_dpp v35, v35, v35 row_ror:4 row_mask:0xf bank_mask:0xf
    v_add_f32_dpp v32, v32, v32 row_ror:8 row_mask:0xf bank_mask:0xf
    v_add_f32_dpp v33, v33, v33 row_ror:8 row_mask:0xf bank_mask:0xf
    v_add_f32_dpp v34, v34, v34 row_ror:8 row_mask:0xf bank_mask:0xf
    v_add_f32_dpp v35, v35, v35 row_ror:8 row_mask:0xf bank_mask:0xf
    v_mov_b32 v36, v32
    v_mov_b32 v37, v33
    v_mov_b32 v38, v34
    v_mov_b32 v39, v35
    v_permlane16_swap_b32 v32, v36
    v_permlane16_swap_b32 v33, v37
    v_permlane16_swap_b32 v34, v38
    v_permlane16_swap_b32 v35, v39
    v_add_f32 v32, v32, v36
    v_add_f32 v33, v33, v37
    v_add_f32 v34, v34, v38
    v_add_f32 v35, v35, v39
    v_mov_b32 v36, v32
    v_mov_b32 v37, v33
    v_mov_b32 v38, v34
    v_mov_b32 v39, v35
    v_permlane32_swap_b32 v32, v36
    v_permlane32_swap_b32 v33, v37
    v_permlane32_swap_b32 v34, v38
    v_permlane32_swap_b32 v35, v39
    v_add_f32 v40, v32, v36
    v_add_f32 v42, v33, v37
    v_add_f32 v44, v34, v38
    v_add_f32 v46, v35, v39
role_41:
    s_lshr_b32 s3, s9, 1
    s_andn2_b32 s3, s50, s3
    s_bitcmp0_b32 s3, 0
    s_cbranch_scc1 str_42
    s_waitcnt vmcnt(1)
    s_mov_b32 m0, s48
    s_add_u32 s50, s50, 1
    buffer_load_dwordx4 v5, s[12:15], s49 offen offset:0 sc1 lds
    buffer_load_dwordx4 v5, s[12:15], s49 offen offset:1024 sc1 lds
    buffer_load_dwordx4 v5, s[12:15], s49 offen offset:2048 sc1 lds
    buffer_load_dwordx4 v5, s[12:15], s49 offen offset:3072 sc1 lds
    s_add_u32 s49, s49, 4096
    s_bitcmp1_b32 s50, 0
    s_cselect_b32 s3, 0, 16384
    s_add_u32 s48, s48, s3
    s_add_u32 s49, s49, s3
    s_cmp_eq_u32 s50, 12
    s_cselect_b32 s3, 4294819840, 0
    s_add_u32 s48, s48, 4096
    s_add_u32 s48, s48, s3
str_42:
    s_waitcnt vmcnt(8)
    s_barrier
    s_cmp_gt_u32 s50, 15
    s_cbranch_scc1 stg_43
    s_mov_b32 m0, s48
    s_add_u32 s50, s50, 1
    buffer_load_dwordx4 v5, s[12:15], s49 offen offset:0 sc1 lds
    buffer_load_dwordx4 v5, s[12:15], s49 offen offset:1024 sc1 lds
    buffer_load_dwordx4 v5, s[12:15], s49 offen offset:2048 sc1 lds
    buffer_load_dwordx4 v5, s[12:15], s49 offen offset:3072 sc1 lds
    s_add_u32 s49, s49, 4096
    s_bitcmp1_b32 s50, 0
    s_cselect_b32 s3, 0, 16384
    s_add_u32 s48, s48, s3
    s_add_u32 s49, s49, s3
    s_cmp_eq_u32 s50, 12
    s_cselect_b32 s3, 4294819840, 0
    s_add_u32 s48, s48, 4096
    s_add_u32 s48, s48, s3
    s_cmp_ge_u32 s9, 2
    s_cbranch_scc1 stg_43
stg_43:
    s_cmp_eq_u32 s60, 0
    s_cbranch_scc1 ub_44
    buffer_store_dwordx4 v[200:203], v14, s[12:15], s57 offen offset:512 sc1
    v_mfma_f32_16x16x32_bf16 v[28:31], v[24:27], v[200:203], v[28:31]
    buffer_store_dwordx4 v[204:207], v14, s[12:15], s57 offen offset:1536 sc1
    v_mfma_f32_16x16x32_bf16 v[28:31], v[24:27], v[204:207], v[28:31]
ub_44:
    s_cmp_lg_u32 s51, 0
    s_cbranch_scc1 role_45
    v_mul_f32 v40, 0x3a800000, v40
    v_mul_f32 v44, 0x3a800000, v44
    v_mul_f32 v42, 0x3a800000, v42
    v_mul_f32 v46, 0x3a800000, v46
    v_fma_f32 v42, -v40, v40, v42
    v_fma_f32 v46, -v44, v44, v46
    v_max_f32 v42, 0, v42
    v_max_f32 v46, 0, v46
    v_add_f32 v42, 0x3727c5ac, v42
    v_add_f32 v46, 0x3727c5ac, v46
    v_rsq_f32 v42, v42
    v_rsq_f32 v46, v46
    s_lshl_b32 s3, s11, 7
    s_add_u32 s3, s3, s56
    s_mov_b64 exec, 0xf
    buffer_store_dwordx4 v[40:43], v7, s[12:15], s3 offen offset:0 sc1
    buffer_store_dwordx4 v[44:47], v7, s[12:15], s3 offen offset:16 sc1
    s_mov_b64 exec, -1
role_45:
    s_lshr_b32 s3, s9, 1
    s_andn2_b32 s3, s50, s3
    s_bitcmp0_b32 s3, 0
    s_cbranch_scc1 str_46
    s_waitcnt vmcnt(1)
    s_mov_b32 m0, s48
    s_add_u32 s50, s50, 1
    buffer_load_dwordx4 v5, s[12:15], s49 offen offset:0 sc1 lds
    buffer_load_dwordx4 v5, s[12:15], s49 offen offset:1024 sc1 lds
    buffer_load_dwordx4 v5, s[12:15], s49 offen offset:2048 sc1 lds
    buffer_load_dwordx4 v5, s[12:15], s49 offen offset:3072 sc1 lds
    s_add_u32 s49, s49, 4096
    s_bitcmp1_b32 s50, 0
    s_cselect_b32 s3, 0, 16384
    s_add_u32 s48, s48, s3
    s_add_u32 s49, s49, s3
    s_cmp_eq_u32 s50, 12
    s_cselect_b32 s3, 4294819840, 0
    s_add_u32 s48, s48, 4096
    s_add_u32 s48, s48, s3
str_46:
    s_waitcnt vmcnt(8)
    s_barrier
    s_cmp_gt_u32 s50, 15
    s_cbranch_scc1 stg_47
    s_mov_b32 m0, s48
    s_add_u32 s50, s50, 1
    buffer_load_dwordx4 v5, s[12:15], s49 offen offset:0 sc1 lds
    buffer_load_dwordx4 v5, s[12:15], s49 offen offset:1024 sc1 lds
    buffer_load_dwordx4 v5, s[12:15], s49 offen offset:2048 sc1 lds
    buffer_load_dwordx4 v5, s[12:15], s49 offen offset:3072 sc1 lds
    s_add_u32 s49, s49, 4096
    s_bitcmp1_b32 s50, 0
    s_cselect_b32 s3, 0, 16384
    s_add_u32 s48, s48, s3
    s_add_u32 s49, s49, s3
    s_cmp_eq_u32 s50, 12
    s_cselect_b32 s3, 4294819840, 0
    s_add_u32 s48, s48, 4096
    s_add_u32 s48, s48, s3
    s_cmp_ge_u32 s9, 2
    s_cbranch_scc1 stg_47
stg_47:
    s_cmp_eq_u32 s60, 0
    s_cbranch_scc1 ub_48
    buffer_store_dwordx4 v[208:211], v14, s[12:15], s57 offen offset:2048 sc1
    v_mfma_f32_16x16x32_bf16 v[28:31], v[24:27], v[208:211], v[28:31]
    buffer_store_dwordx4 v[212:215], v14, s[12:15], s57 offen offset:3072 sc1
    v_mfma_f32_16x16x32_bf16 v[28:31], v[24:27], v[212:215], v[28:31]
ub_48:
    s_cmp_ge_u32 s9, 2
    s_cbranch_scc1 wc_49
    s_bitcmp1_b32 s9, 0
    s_cbranch_scc1 wc_49_b
    ds_read_b128 v[96:99], v3 offset:24576
    ds_read_b128 v[100:103], v3 offset:25600
    ds_read_b128 v[104:107], v3 offset:26624
    ds_read_b128 v[108:111], v3 offset:27648
    ds_read_b128 v[112:115], v3 offset:28672
    ds_read_b128 v[116:119], v3 offset:29696
    ds_read_b128 v[120:123], v3 offset:30720
    ds_read_b128 v[124:127], v3 offset:31744
    s_branch wc_49_w
wc_49_b:
    ds_read_b128 v[192:195], v3 offset:24576
    ds_read_b128 v[196:199], v3 offset:25600
    ds_read_b128 v[200:203], v3 offset:26624
    ds_read_b128 v[204:207], v3 offset:27648
    ds_read_b128 v[208:211], v3 offset:28672
    ds_read_b128 v[212:215], v3 offset:29696
    ds_read_b128 v[216:219], v3 offset:30720
    ds_read_b128 v[220:223], v3 offset:31744
wc_49_w:
    s_waitcnt lgkmcnt(0)
wc_49:
    s_lshr_b32 s3, s9, 1
    s_andn2_b32 s3, s50, s3
    s_bitcmp0_b32 s3, 0
    s_cbranch_scc1 str_50
    s_waitcnt vmcnt(1)
    s_mov_b32 m0, s48
    s_add_u32 s50, s50, 1
    buffer_load_dwordx4 v5, s[12:15], s49 offen offset:0 sc1 lds
    buffer_load_dwordx4 v5, s[12:15], s49 offen offset:1024 sc1 lds
    buffer_load_dwordx4 v5, s[12:15], s49 offen offset:2048 sc1 lds
    buffer_load_dwordx4 v5, s[12:15], s49 offen offset:3072 sc1 lds
    s_add_u32 s49, s49, 4096
    s_bitcmp1_b32 s50, 0
    s_cselect_b32 s3, 0, 16384
    s_add_u32 s48, s48, s3
    s_add_u32 s49, s49, s3
    s_cmp_eq_u32 s50, 12
    s_cselect_b32 s3, 4294819840, 0
    s_add_u32 s48, s48, 4096
    s_add_u32 s48, s48, s3
str_50:
    s_waitcnt vmcnt(8)
    s_barrier
    s_cmp_gt_u32 s50, 15
    s_cbranch_scc1 stg_51
    s_mov_b32 m0, s48
    s_add_u32 s50, s50, 1
    buffer_load_dwordx4 v5, s[12:15], s49 offen offset:0 sc1 lds
    buffer_load_dwordx4 v5, s[12:15], s49 offen offset:1024 sc1 lds
    buffer_load_dwordx4 v5, s[12:15], s49 offen offset:2048 sc1 lds
    buffer_load_dwordx4 v5, s[12:15], s49 offen offset:3072 sc1 lds
    s_add_u32 s49, s49, 4096
    s_bitcmp1_b32 s50, 0
    s_cselect_b32 s3, 0, 16384
    s_add_u32 s48, s48, s3
    s_add_u32 s49, s49, s3
    s_cmp_eq_u32 s50, 12
    s_cselect_b32 s3, 4294819840, 0
    s_add_u32 s48, s48, 4096
    s_add_u32 s48, s48, s3
    s_cmp_ge_u32 s9, 2
    s_cbranch_scc1 stg_51
stg_51:
    s_cmp_eq_u32 s60, 0
    s_cbranch_scc1 ub_52
    buffer_store_dwordx4 v[216:219], v14, s[12:15], s57 offen offset:2560 sc1
    v_mfma_f32_16x16x32_bf16 v[28:31], v[24:27], v[216:219], v[28:31]
    buffer_store_dwordx4 v[220:223], v14, s[12:15], s57 offen offset:3584 sc1
    v_mfma_f32_16x16x32_bf16 v[28:31], v[24:27], v[220:223], v[28:31]
ub_52:
    s_cmp_ge_u32 s9, 2
    s_cbranch_scc1 wc_53
    s_bitcmp1_b32 s9, 0
    s_cbranch_scc1 wc_53_b
    ds_read_b128 v[128:131], v3 offset:49152
    ds_read_b128 v[132:135], v3 offset:50176
    ds_read_b128 v[136:139], v3 offset:51200
    ds_read_b128 v[140:143], v3 offset:52224
    ds_read_b128 v[144:147], v3 offset:53248
    ds_read_b128 v[148:151], v3 offset:54272
    ds_read_b128 v[152:155], v3 offset:55296
    ds_read_b128 v[156:159], v3 offset:56320
    s_branch wc_53_w
wc_53_b:
    ds_read_b128 a[0:3], v3 offset:49152
    ds_read_b128 a[4:7], v3 offset:50176
    ds_read_b128 a[8:11], v3 offset:51200
    ds_read_b128 a[12:15], v3 offset:52224
    ds_read_b128 a[16:19], v3 offset:53248
    ds_read_b128 a[20:23], v3 offset:54272
    ds_read_b128 a[24:27], v3 offset:55296
    ds_read_b128 a[28:31], v3 offset:56320
wc_53_w:
    s_waitcnt lgkmcnt(0)
wc_53:
    s_cmp_lg_u32 s51, 1
    s_cbranch_scc1 role_54
    s_and_b32 s52, s11, 0xe0
    s_lshl_b32 s52, s52, 7
    s_add_u32 s52, s52, s56
    s_lshr_b32 s3, s6, 1
    s_min_u32 s3, s3, 1
    s_andn2_b32 s3, s3, s9
    s_lshl_b32 s3, s3, 8
    s_sub_u32 s53, s52, s3
    buffer_load_dwordx4 v[32:35], v5, s[12:15], s52 offen offset:0 sc1
    buffer_load_dwordx4 v[36:39], v5, s[12:15], s52 offen offset:1024 sc1
    buffer_load_dwordx4 v[40:43], v5, s[12:15], s52 offen offset:2048 sc1
    buffer_load_dwordx4 v[44:47], v5, s[12:15], s52 offen offset:3072 sc1
    buffer_load_dwordx4 v[48:51], v6, s[12:15], s53 offen sc1
role_54:
    s_lshr_b32 s3, s9, 1
    s_andn2_b32 s3, s50, s3
    s_bitcmp0_b32 s3, 0
    s_cbranch_scc1 str_55
    s_waitcnt vmcnt(1)
    s_mov_b32 m0, s48
    s_add_u32 s50, s50, 1
    buffer_load_dwordx4 v5, s[12:15], s49 offen offset:0 sc1 lds
    buffer_load_dwordx4 v5, s[12:15], s49 offen offset:1024 sc1 lds
    buffer_load_dwordx4 v5, s[12:15], s49 offen offset:2048 sc1 lds
    buffer_load_dwordx4 v5, s[12:15], s49 offen offset:3072 sc1 lds
    s_add_u32 s49, s49, 4096
    s_bitcmp1_b32 s50, 0
    s_cselect_b32 s3, 0, 16384
    s_add_u32 s48, s48, s3
    s_add_u32 s49, s49, s3
    s_cmp_eq_u32 s50, 12
    s_cselect_b32 s3, 4294819840, 0
    s_add_u32 s48, s48, 4096
    s_add_u32 s48, s48, s3
str_55:
    s_waitcnt vmcnt(8)
    s_barrier
    s_waitcnt vmcnt(0)
    s_cmp_gt_u32 s50, 15
    s_cbranch_scc1 stg_56
    s_mov_b32 m0, s48
    s_add_u32 s50, s50, 1
    buffer_load_dwordx4 v5, s[12:15], s49 offen offset:0 sc1 lds
    buffer_load_dwordx4 v5, s[12:15], s49 offen offset:1024 sc1 lds
    buffer_load_dwordx4 v5, s[12:15], s49 offen offset:2048 sc1 lds
    buffer_load_dwordx4 v5, s[12:15], s49 offen offset:3072 sc1 lds
    s_add_u32 s49, s49, 4096
    s_bitcmp1_b32 s50, 0
    s_cselect_b32 s3, 0, 16384
    s_add_u32 s48, s48, s3
    s_add_u32 s49, s49, s3
    s_cmp_eq_u32 s50, 12
    s_cselect_b32 s3, 4294819840, 0
    s_add_u32 s48, s48, 4096
    s_add_u32 s48, s48, s3
    s_cmp_ge_u32 s9, 2
    s_cbranch_scc1 stg_56
stg_56:
    s_cmp_eq_u32 s60, 0
    s_cbranch_scc1 ub_57
    v_add_f32_dpp v28, v28, v28 row_ror:8 row_mask:0xf bank_mask:0xf
    v_add_f32_dpp v29, v29, v29 row_ror:8 row_mask:0xf bank_mask:0xf
    v_add_f32_dpp v30, v30, v30 row_ror:8 row_mask:0xf bank_mask:0xf
    v_add_f32_dpp v31, v31, v31 row_ror:8 row_mask:0xf bank_mask:0xf
    s_mov_b64 exec, 0x00ff00ff
    buffer_store_dwordx4 v[28:31], v15, s[12:15], s54 offen sc1
    s_mov_b64 exec, -1
ub_57:
    s_cmp_lg_u32 s51, 1
    s_cbranch_scc1 role_58
    s_mov_b32 s3, 0x100000
l_st_chk:
    v_cmp_ne_u32 s[64:65], s10, v33
    v_cmp_ne_u32 vcc, s10, v35
    s_or_b64 s[64:65], s[64:65], vcc
    v_cmp_ne_u32 vcc, s10, v37
    s_or_b64 s[64:65], s[64:65], vcc
    v_cmp_ne_u32 vcc, s10, v39
    s_or_b64 s[64:65], s[64:65], vcc
    v_cmp_ne_u32 vcc, s10, v41
    s_or_b64 s[64:65], s[64:65], vcc
    v_cmp_ne_u32 vcc, s10, v43
    s_or_b64 s[64:65], s[64:65], vcc
    v_cmp_ne_u32 vcc, s10, v45
    s_or_b64 s[64:65], s[64:65], vcc
    v_cmp_ne_u32 vcc, s10, v47
    s_or_b64 s[64:65], s[64:65], vcc
    v_cmp_ne_u32 vcc, s10, v49
    s_or_b64 s[64:65], s[64:65], vcc
    v_cmp_ne_u32 vcc, s10, v51
    s_or_b64 s[64:65], s[64:65], vcc
    s_cbranch_scc0 l_st_ok
    s_sub_u32 s3, s3, 1
    s_cbranch_scc0 l_st_again
l_st_ok:
    ds_write_b32 v11, v32 offset:1280
    ds_write_b32 v11, v34 offset:2816
    ds_write_b32 v11, v36 offset:1536
    ds_write_b32 v11, v38 offset:3072
    ds_write_b32 v11, v40 offset:1792
    ds_write_b32 v11, v42 offset:3328
    ds_write_b32 v11, v44 offset:2048
    ds_write_b32 v11, v46 offset:3584
    s_mov_b64 exec, 0xffff
    ds_write_b32 v11, v48 offset:1216
    ds_write_b32 v11, v50 offset:2752
    s_mov_b64 exec, -1
    s_waitcnt lgkmcnt(0)
role_58:
    s_lshr_b32 s3, s9, 1
    s_andn2_b32 s3, s50, s3
    s_bitcmp0_b32 s3, 0
    s_cbranch_scc1 str_59
    s_waitcnt vmcnt(1)
    s_mov_b32 m0, s48
    s_add_u32 s50, s50, 1
    buffer_load_dwordx4 v5, s[12:15], s49 offen offset:0 sc1 lds
    buffer_load_dwordx4 v5, s[12:15], s49 offen offset:1024 sc1 lds
    buffer_load_dwordx4 v5, s[12:15], s49 offen offset:2048 sc1 lds
    buffer_load_dwordx4 v5, s[12:15], s49 offen offset:3072 sc1 lds
    s_add_u32 s49, s49, 4096
    s_bitcmp1_b32 s50, 0
    s_cselect_b32 s3, 0, 16384
    s_add_u32 s48, s48, s3
    s_add_u32 s49, s49, s3
    s_cmp_eq_u32 s50, 12
    s_cselect_b32 s3, 4294819840, 0
    s_add_u32 s48, s48, 4096
    s_add_u32 s48, s48, s3
str_59:
    s_add_u32 s61, s51, 48
    s_bitcmp1_b32 s9, 0
    s_cbranch_scc1 wo_60
    s_mov_b32 s24, s36
    s_mov_b32 s25, s37
    s_mov_b32 s26, 2097152
    s_mov_b32 s27, 0x00020000
    s_and_b32 s3, s7, 7
    s_cmp_eq_u32 s3, 3
    s_cbranch_scc0 wo_60
    s_cmp_eq_u32 s9, 0
    s_cbranch_scc1 wo_60
wop_61:
    s_lshl_b32 m0, s61, 10
    s_lshr_b32 s3, s61, 1
    s_xor_b32 s3, s3, s61
    s_and_b32 s3, s3, 1
    s_mul_i32 s3, s3, 3
    s_xor_b32 s3, s3, s61
    s_lshl_b32 s3, s3, 14
    buffer_load_dwordx4 v17, s[24:27], s3 offen lds
    s_add_u32 s61, s61, 3
    s_waitcnt vmcnt(4)
    s_cmp_lt_u32 s61, 66
    s_cbranch_scc1 wop_61
wo_60:
    s_waitcnt vmcnt(8)
    s_barrier
    s_cmp_eq_u32 s60, 0
    s_cbranch_scc1 ub_62
    s_waitcnt vmcnt(0)
    s_mov_b64 exec, 0xffff
    buffer_store_dword v9, v16, s[12:15], s55 offen offset:384 sc1
    s_mov_b64 exec, -1
ub_62:
    s_bitcmp1_b32 s9, 0
    s_cbranch_scc1 wo_63
    s_mov_b32 s24, s36
    s_mov_b32 s25, s37
    s_mov_b32 s26, 2097152
    s_mov_b32 s27, 0x00020000
    s_and_b32 s3, s7, 7
    s_cmp_eq_u32 s3, 3
    s_cbranch_scc0 wo_63
    s_cmp_eq_u32 s9, 0
    s_cbranch_scc1 wo_63
wop_64:
    s_lshl_b32 m0, s61, 10
    s_lshr_b32 s3, s61, 1
    s_xor_b32 s3, s3, s61
    s_and_b32 s3, s3, 1
    s_mul_i32 s3, s3, 3
    s_xor_b32 s3, s3, s61
    s_lshl_b32 s3, s3, 14
    buffer_load_dwordx4 v17, s[24:27], s3 offen lds
    s_add_u32 s61, s61, 3
    s_waitcnt vmcnt(4)
    s_cmp_lt_u32 s61, 84
    s_cbranch_scc1 wop_64
wo_63:
    s_waitcnt vmcnt(0)
    s_barrier
    s_bitcmp1_b32 s9, 0
    s_cbranch_scc1 wo_65
    s_mov_b32 s24, s36
    s_mov_b32 s25, s37
    s_mov_b32 s26, 2097152
    s_mov_b32 s27, 0x00020000
    s_and_b32 s3, s7, 7
    s_cmp_eq_u32 s3, 3
    s_cselect_b32 s62, 27, 48
    s_cselect_b32 s63, 12, 24
    s_add_u32 s62, s62, s61
    s_sub_u32 s62, s62, s51
    s_add_u32 s63, s63, s62
wop_66:
    s_lshl_b32 m0, s61, 10
    s_lshr_b32 s3, s61, 1
    s_xor_b32 s3, s3, s61
    s_and_b32 s3, s3, 1
    s_mul_i32 s3, s3, 3
    s_xor_b32 s3, s3, s61
    s_lshl_b32 s3, s3, 14
    buffer_load_dwordx4 v17, s[24:27], s3 offen lds
    s_add_u32 s61, s61, 3
    s_waitcnt vmcnt(7)
    s_cmp_lt_u32 s61, s62
    s_cbranch_scc1 wop_66
wo_65:
    s_barrier
    s_bitcmp1_b32 s9, 0
    s_cbranch_scc1 s_attn
    s_mov_b32 s24, s36
    s_mov_b32 s25, s37
    s_mov_b32 s26, 2097152
    s_mov_b32 s27, 0x00020000
wop_67:
    s_lshl_b32 m0, s61, 10
    s_lshr_b32 s3, s61, 1
    s_xor_b32 s3, s3, s61
    s_and_b32 s3, s3, 1
    s_mul_i32 s3, s3, 3
    s_xor_b32 s3, s3, s61
    s_lshl_b32 s3, s3, 14
    buffer_load_dwordx4 v17, s[24:27], s3 offen lds
    s_add_u32 s61, s61, 3
    s_waitcnt vmcnt(7)
    s_cmp_lt_u32 s61, s63
    s_cbranch_scc1 wop_67
    s_barrier
wop_68:
    s_lshl_b32 m0, s61, 10
    s_lshr_b32 s3, s61, 1
    s_xor_b32 s3, s3, s61
    s_and_b32 s3, s3, 1
    s_mul_i32 s3, s3, 3
    s_xor_b32 s3, s3, s61
    s_lshl_b32 s3, s3, 14
    buffer_load_dwordx4 v17, s[24:27], s3 offen lds
    s_add_u32 s61, s61, 3
    s_waitcnt vmcnt(7)
    s_cmp_lt_u32 s61, 128
    s_cbranch_scc1 wop_68
    s_mov_b32 s61, s51
wop_69:
    s_lshl_b32 m0, s61, 10
    s_lshr_b32 s3, s61, 1
    s_xor_b32 s3, s3, s61
    s_and_b32 s3, s3, 1
    s_mul_i32 s3, s3, 3
    s_xor_b32 s3, s3, s61
    s_lshl_b32 s3, s3, 14
    buffer_load_dwordx4 v17, s[24:27], s3 offen lds
    s_add_u32 s61, s61, 3
    s_waitcnt vmcnt(7)
    s_cmp_lt_u32 s61, 48
    s_cbranch_scc1 wop_69
    s_branch l_wo
l_st_again:
    buffer_load_dwordx4 v[32:35], v5, s[12:15], s52 offen offset:0 sc1
    buffer_load_dwordx4 v[36:39], v5, s[12:15], s52 offen offset:1024 sc1
    buffer_load_dwordx4 v[40:43], v5, s[12:15], s52 offen offset:2048 sc1
    buffer_load_dwordx4 v[44:47], v5, s[12:15], s52 offen offset:3072 sc1
    buffer_load_dwordx4 v[48:51], v6, s[12:15], s53 offen sc1
    s_waitcnt vmcnt(0)
    s_branch l_st_chk
.p2align 6
h_wo:
l_wo:
    s_mul_i32 s98, s9, 786432
    s_add_u32 s98, s98, 65798144
    s_lshl_b32 s99, s11, 10
    s_add_u32 s98, s98, s99
    s_add_u32 s96, s4, s98
    s_addc_u32 s97, s5, 0
    s_mov_b32 s98, s10
    s_mov_b32 s99, s10
    s_sub_u32 s59, s8, 4
    s_lshl_b32 s60, s59, 7
    s_add_u32 s96, s96, s60
    s_addc_u32 s97, s97, 0
    s_lshl_b32 s60, s9, 2
    s_add_u32 s60, s60, 159504
    v_mov_b32 v10, s60
    s_lshl_b32 s60, 1, s59
    v_mov_b32 v11, s60
    v_lshlrev_b32 v13, 4, v11
    s_mov_b64 exec, 1
    s_waitcnt vmcnt(0)
    ds_or_b32 v10, v13
    s_mov_b32 s3, 0x100000
poll_70:
    s_load_dwordx8 s[88:95], s[96:97], 0 glc
    s_sub_u32 s3, s3, 1
    s_cbranch_scc1 poll_70_ok
    s_waitcnt lgkmcnt(0)
    s_xor_b64 s[100:101], s[88:89], s[98:99]
    s_xor_b64 s[88:89], s[90:91], s[98:99]
    s_or_b64 s[100:101], s[100:101], s[88:89]
    s_xor_b64 s[88:89], s[92:93], s[98:99]
    s_or_b64 s[100:101], s[100:101], s[88:89]
    s_xor_b64 s[88:89], s[94:95], s[98:99]
    s_or_b64 s[100:101], s[100:101], s[88:89]
    s_cbranch_scc1 poll_70
poll_70_ok:
    s_waitcnt lgkmcnt(0)
    ds_or_b32 v10, v11
    s_mov_b64 exec, -1
    s_setprio 0
    s_waitcnt lgkmcnt(0)
    s_cmp_eq_u32 s8, 4
    s_cbranch_scc1 l_wo_end
    s_cmp_lg_u32 s9, 0
    s_cbranch_scc1 l_wo_end
    s_lshl_b32 s53, s8, 7
    s_lshl_b32 s52, s11, 10
    s_add_u32 s53, s53, s52
    s_add_u32 s53, s53, 64487168
    s_add_u32 s96, s4, s53
    s_addc_u32 s97, s5, 0
    s_mov_b32 s98, s10
    s_mov_b32 s99, s10
    s_mov_b32 s3, 0x100000
poll_71:
    s_load_dwordx16 s[80:95], s[96:97], 0 glc
    s_sub_u32 s3, s3, 1
    s_cbranch_scc1 poll_71_ok
    s_waitcnt lgkmcnt(0)
    s_xor_b64 s[100:101], s[80:81], s[98:99]
    s_xor_b64 s[80:81], s[82:83], s[98:99]
    s_or_b64 s[100:101], s[100:101], s[80:81]
    s_xor_b64 s[80:81], s[84:85], s[98:99]
    s_or_b64 s[100:101], s[100:101], s[80:81]
    s_xor_b64 s[80:81], s[86:87], s[98:99]
    s_or_b64 s[100:101], s[100:101], s[80:81]
    s_xor_b64 s[80:81], s[88:89], s[98:99]
    s_or_b64 s[100:101], s[100:101], s[80:81]
    s_xor_b64 s[80:81], s[90:91], s[98:99]
    s_or_b64 s[100:101], s[100:101], s[80:81]
    s_xor_b64 s[80:81], s[92:93], s[98:99]
    s_or_b64 s[100:101], s[100:101], s[80:81]
    s_xor_b64 s[80:81], s[94:95], s[98:99]
    s_or_b64 s[100:101], s[100:101], s[80:81]
    s_cbranch_scc1 poll_71
poll_71_ok:
    s_waitcnt lgkmcnt(0)
l_wo_end:
    s_add_u32 s9, s9, 1
    s_cmp_lg_u32 s9, 4
    s_cbranch_scc1 l_wo_next
    s_branch k_exit
l_wo_next:
    s_cmp_lg_u32 s8, 4
    s_cbranch_scc1 l_qkv
    s_cmp_eq_u32 s9, 2
    s_cbranch_scc1 h_qkvA
    s_branch h_qkvB
.p2align 6
s_attn:
    s_sub_u32 s48, s8, 4
    s_lshl_b32 s3, s7, 7
    v_lshrrev_b32 v20, 3, v1
    v_lshlrev_b32 v21, 11, v20
    v_and_b32 v22, 2, v20
    v_lshrrev_b32 v23, 2, v20
    v_or_b32 v22, v22, v23
    v_bfe_u32 v23, v1, 1, 2
    v_xor_b32 v22, v22, v23
    v_lshl_add_u32 v21, v22, 5, v21
    v_and_b32 v22, 1, v1
    v_lshl_add_u32 v21, v22, 4, v21
    v_add_u32 v7, s3, v21
    s_mov_b32 s24, s42
    s_mov_b32 s25, s43
    s_mov_b32 s26, 2097152
    s_mov_b32 s27, 0x00020000
    s_lshr_b32 s49, s9, 1
    s_lshl_b32 s49, s49, 23
    s_lshl_b32 s52, s7, 19
    s_add_u32 s49, s49, s52
    s_and_b32 s52, s6, 1
    s_lshl_b32 s52, s52, 18
    s_add_u32 s49, s49, s52
    s_add_u32 s49, s49, 33554432
    s_lshr_b32 s61, s6, 1
    s_mul_i32 s54, s9, 786432
    s_add_u32 s54, s54, 66322432
    s_lshl_b32 s55, s11, 10
    s_add_u32 s54, s54, s55
    s_add_u32 s52, s4, s54
    s_addc_u32 s53, s5, 0
    s_mov_b32 s54, s10
    s_mov_b32 s55, s10
    s_lshl_b32 s51, s48, 11
    s_add_u32 s49, s49, s51
    s_add_u32 s51, s51, 81920
    s_mov_b32 s60, s48
    s_setprio 3
    s_barrier
    s_lshl_b32 s58, 1, s61
    s_mov_b32 s57, 0
    s_add_u32 s62, s61, 1
    s_and_b32 s62, s62, 7
    s_lshl_b32 s50, s62, 15
    s_add_u32 s50, s50, s49
    s_lshr_b32 s63, s62, 1
    s_lshl_b32 s63, s63, 7
    s_and_b32 s62, s62, 1
    s_lshl_b32 s62, s62, 4
    s_add_u32 s62, s62, s63
    s_mov_b32 s58, 0x100000
need_72:
    s_load_dwordx4 s[64:67], s[52:53], s62 glc
    s_sub_u32 s58, s58, 1
    s_cbranch_scc1 need_72_ok
    s_waitcnt lgkmcnt(0)
need_72_t:
    s_cmp_ge_u32 s48, 2
    s_cselect_b32 s63, s65, s64
    s_cmp_lg_u32 s63, s10
    s_cbranch_scc1 need_72
need_72_ok:
    s_waitcnt lgkmcnt(0)
    s_add_u32 m0, s51, 32768
    s_nop 0
    buffer_load_dwordx4 v5, s[12:15], s50 offen offset:0 sc1 lds
    buffer_load_dwordx4 v5, s[12:15], s50 offen offset:1024 sc1 lds
    s_add_u32 s50, s50, 8192
    s_add_u32 m0, s51, 40960
    s_nop 0
    buffer_load_dwordx4 v5, s[12:15], s50 offen offset:0 sc1 lds
    buffer_load_dwordx4 v5, s[12:15], s50 offen offset:1024 sc1 lds
    s_add_u32 s50, s50, 8192
    s_branch need_73_t
need_73:
    s_load_dwordx4 s[64:67], s[52:53], s62 glc
    s_sub_u32 s58, s58, 1
    s_cbranch_scc1 need_73_ok
    s_waitcnt lgkmcnt(0)
need_73_t:
    s_cmp_ge_u32 s48, 2
    s_cselect_b32 s63, s67, s66
    s_cmp_lg_u32 s63, s10
    s_cbranch_scc1 need_73
need_73_ok:
    s_waitcnt lgkmcnt(0)
    s_add_u32 m0, s51, 49152
    s_nop 0
    buffer_load_dwordx4 v5, s[12:15], s50 offen offset:0 sc1 lds
    buffer_load_dwordx4 v5, s[12:15], s50 offen offset:1024 sc1 lds
    s_add_u32 s50, s50, 8192
    s_add_u32 m0, s51, 57344
    s_nop 0
    buffer_load_dwordx4 v5, s[12:15], s50 offen offset:0 sc1 lds
    buffer_load_dwordx4 v5, s[12:15], s50 offen offset:1024 sc1 lds
    s_add_u32 s50, s50, 8192
    s_waitcnt vmcnt(4)
    s_barrier
    s_add_u32 s62, s61, 2
    s_and_b32 s62, s62, 7
    s_lshl_b32 s50, s62, 15
    s_add_u32 s50, s50, s49
    s_lshr_b32 s63, s62, 1
    s_lshl_b32 s63, s63, 7
    s_and_b32 s62, s62, 1
    s_lshl_b32 s62, s62, 4
    s_add_u32 s62, s62, s63
    s_mov_b32 s58, 0x100000
need_74:
    s_load_dwordx4 s[64:67], s[52:53], s62 glc
    s_sub_u32 s58, s58, 1
    s_cbranch_scc1 need_74_ok
    s_waitcnt lgkmcnt(0)
need_74_t:
    s_cmp_ge_u32 s48, 2
    s_cselect_b32 s63, s65, s64
    s_cmp_lg_u32 s63, s10
    s_cbranch_scc1 need_74
need_74_ok:
    s_waitcnt lgkmcnt(0)
    s_add_u32 m0, s51, 0
    s_nop 0
    buffer_load_dwordx4 v5, s[12:15], s50 offen offset:0 sc1 lds
    buffer_load_dwordx4 v5, s[12:15], s50 offen offset:1024 sc1 lds
    s_add_u32 s50, s50, 8192
    s_add_u32 m0, s51, 8192
    s_nop 0
    buffer_load_dwordx4 v5, s[12:15], s50 offen offset:0 sc1 lds
    buffer_load_dwordx4 v5, s[12:15], s50 offen offset:1024 sc1 lds
    s_add_u32 s50, s50, 8192
    s_waitcnt vmcnt(4)
    s_barrier
    s_branch need_75_t
need_75:
    s_load_dwordx4 s[64:67], s[52:53], s62 glc
    s_sub_u32 s58, s58, 1
    s_cbranch_scc1 need_75_ok
    s_waitcnt lgkmcnt(0)
need_75_t:
    s_cmp_ge_u32 s48, 2
    s_cselect_b32 s63, s67, s66
    s_cmp_lg_u32 s63, s10
    s_cbranch_scc1 need_75
need_75_ok:
    s_waitcnt lgkmcnt(0)
    s_add_u32 m0, s51, 16384
    s_nop 0
    buffer_load_dwordx4 v5, s[12:15], s50 offen offset:0 sc1 lds
    buffer_load_dwordx4 v5, s[12:15], s50 offen offset:1024 sc1 lds
    s_add_u32 s50, s50, 8192
    s_add_u32 m0, s51, 24576
    s_nop 0
    buffer_load_dwordx4 v5, s[12:15], s50 offen offset:0 sc1 lds
    buffer_load_dwordx4 v5, s[12:15], s50 offen offset:1024 sc1 lds
    s_add_u32 s50, s50, 8192
    s_waitcnt vmcnt(4)
    s_barrier
    s_add_u32 s62, s61, 3
    s_and_b32 s62, s62, 7
    s_lshl_b32 s50, s62, 15
    s_add_u32 s50, s50, s49
    s_lshr_b32 s63, s62, 1
    s_lshl_b32 s63, s63, 7
    s_and_b32 s62, s62, 1
    s_lshl_b32 s62, s62, 4
    s_add_u32 s62, s62, s63
    s_mov_b32 s58, 0x100000
need_76:
    s_load_dwordx4 s[64:67], s[52:53], s62 glc
    s_sub_u32 s58, s58, 1
    s_cbranch_scc1 need_76_ok
    s_waitcnt lgkmcnt(0)
need_76_t:
    s_cmp_ge_u32 s48, 2
    s_cselect_b32 s63, s65, s64
    s_cmp_lg_u32 s63, s10
    s_cbranch_scc1 need_76
need_76_ok:
    s_waitcnt lgkmcnt(0)
    s_add_u32 m0, s51, 32768
    s_nop 0
    buffer_load_dwordx4 v5, s[12:15], s50 offen offset:0 sc1 lds
    buffer_load_dwordx4 v5, s[12:15], s50 offen offset:1024 sc1 lds
    s_add_u32 s50, s50, 8192
    s_add_u32 m0, s51, 40960
    s_nop 0
    buffer_load_dwordx4 v5, s[12:15], s50 offen offset:0 sc1 lds
    buffer_load_dwordx4 v5, s[12:15], s50 offen offset:1024 sc1 lds
    s_add_u32 s50, s50, 8192
    s_lshl_b32 m0, s60, 10
    s_lshl_b32 s3, s60, 14
    buffer_load_dwordx4 v7, s[24:27], s3 offen lds
    s_add_u32 s60, s60, 4
    s_lshl_b32 m0, s60, 10
    s_lshl_b32 s3, s60, 14
    buffer_load_dwordx4 v7, s[24:27], s3 offen lds
    s_add_u32 s60, s60, 4
    s_waitcnt vmcnt(6)
    s_barrier
    s_branch need_77_t
need_77:
    s_load_dwordx4 s[64:67], s[52:53], s62 glc
    s_sub_u32 s58, s58, 1
    s_cbranch_scc1 need_77_ok
    s_waitcnt lgkmcnt(0)
need_77_t:
    s_cmp_ge_u32 s48, 2
    s_cselect_b32 s63, s67, s66
    s_cmp_lg_u32 s63, s10
    s_cbranch_scc1 need_77
need_77_ok:
    s_waitcnt lgkmcnt(0)
    s_add_u32 m0, s51, 49152
    s_nop 0
    buffer_load_dwordx4 v5, s[12:15], s50 offen offset:0 sc1 lds
    buffer_load_dwordx4 v5, s[12:15], s50 offen offset:1024 sc1 lds
    s_add_u32 s50, s50, 8192
    s_add_u32 m0, s51, 57344
    s_nop 0
    buffer_load_dwordx4 v5, s[12:15], s50 offen offset:0 sc1 lds
    buffer_load_dwordx4 v5, s[12:15], s50 offen offset:1024 sc1 lds
    s_add_u32 s50, s50, 8192
    s_lshl_b32 m0, s60, 10
    s_lshl_b32 s3, s60, 14
    buffer_load_dwordx4 v7, s[24:27], s3 offen lds
    s_add_u32 s60, s60, 4
    s_lshl_b32 m0, s60, 10
    s_lshl_b32 s3, s60, 14
    buffer_load_dwordx4 v7, s[24:27], s3 offen lds
    s_add_u32 s60, s60, 4
    s_waitcnt vmcnt(8)
    s_barrier
    s_add_u32 s62, s61, 4
    s_and_b32 s62, s62, 7
    s_lshl_b32 s50, s62, 15
    s_add_u32 s50, s50, s49
    s_lshr_b32 s63, s62, 1
    s_lshl_b32 s63, s63, 7
    s_and_b32 s62, s62, 1
    s_lshl_b32 s62, s62, 4
    s_add_u32 s62, s62, s63
    s_mov_b32 s58, 0x100000
need_78:
    s_load_dwordx4 s[64:67], s[52:53], s62 glc
    s_sub_u32 s58, s58, 1
    s_cbranch_scc1 need_78_ok
    s_waitcnt lgkmcnt(0)
need_78_t:
    s_cmp_ge_u32 s48, 2
    s_cselect_b32 s63, s65, s64
    s_cmp_lg_u32 s63, s10
    s_cbranch_scc1 need_78
need_78_ok:
    s_waitcnt lgkmcnt(0)
    s_add_u32 m0, s51, 0
    s_nop 0
    buffer_load_dwordx4 v5, s[12:15], s50 offen offset:0 sc1 lds
    buffer_load_dwordx4 v5, s[12:15], s50 offen offset:1024 sc1 lds
    s_add_u32 s50, s50, 8192
    s_add_u32 m0, s51, 8192
    s_nop 0
    buffer_load_dwordx4 v5, s[12:15], s50 offen offset:0 sc1 lds
    buffer_load_dwordx4 v5, s[12:15], s50 offen offset:1024 sc1 lds
    s_add_u32 s50, s50, 8192
    s_lshl_b32 m0, s60, 10
    s_lshl_b32 s3, s60, 14
    buffer_load_dwordx4 v7, s[24:27], s3 offen lds
    s_add_u32 s60, s60, 4
    s_lshl_b32 m0, s60, 10
    s_lshl_b32 s3, s60, 14
    buffer_load_dwordx4 v7, s[24:27], s3 offen lds
    s_add_u32 s60, s60, 4
    s_waitcnt vmcnt(8)
    s_barrier
    s_branch need_79_t
need_79:
    s_load_dwordx4 s[64:67], s[52:53], s62 glc
    s_sub_u32 s58, s58, 1
    s_cbranch_scc1 need_79_ok
    s_waitcnt lgkmcnt(0)
need_79_t:
    s_cmp_ge_u32 s48, 2
    s_cselect_b32 s63, s67, s66
    s_cmp_lg_u32 s63, s10
    s_cbranch_scc1 need_79
need_79_ok:
    s_waitcnt lgkmcnt(0)
    s_add_u32 m0, s51, 16384
    s_nop 0
    buffer_load_dwordx4 v5, s[12:15], s50 offen offset:0 sc1 lds
    buffer_load_dwordx4 v5, s[12:15], s50 offen offset:1024 sc1 lds
    s_add_u32 s50, s50, 8192
    s_add_u32 m0, s51, 24576
    s_nop 0
    buffer_load_dwordx4 v5, s[12:15], s50 offen offset:0 sc1 lds
    buffer_load_dwordx4 v5, s[12:15], s50 offen offset:1024 sc1 lds
    s_add_u32 s50, s50, 8192
    s_lshl_b32 m0, s60, 10
    s_lshl_b32 s3, s60, 14
    buffer_load_dwordx4 v7, s[24:27], s3 offen lds
    s_add_u32 s60, s60, 4
    s_lshl_b32 m0, s60, 10
    s_lshl_b32 s3, s60, 14
    buffer_load_dwordx4 v7, s[24:27], s3 offen lds
    s_add_u32 s60, s60, 4
    s_waitcnt vmcnt(8)
    s_barrier
    s_add_u32 s62, s61, 5
    s_and_b32 s62, s62, 7
    s_lshl_b32 s50, s62, 15
    s_add_u32 s50, s50, s49
    s_lshr_b32 s63, s62, 1
    s_lshl_b32 s63, s63, 7
    s_and_b32 s62, s62, 1
    s_lshl_b32 s62, s62, 4
    s_add_u32 s62, s62, s63
    s_mov_b32 s58, 0x100000
need_80:
    s_load_dwordx4 s[64:67], s[52:53], s62 glc
    s_sub_u32 s58, s58, 1
    s_cbranch_scc1 need_80_ok
    s_waitcnt lgkmcnt(0)
need_80_t:
    s_cmp_ge_u32 s48, 2
    s_cselect_b32 s63, s65, s64
    s_cmp_lg_u32 s63, s10
    s_cbranch_scc1 need_80
need_80_ok:
    s_waitcnt lgkmcnt(0)
    s_add_u32 m0, s51, 32768
    s_nop 0
    buffer_load_dwordx4 v5, s[12:15], s50 offen offset:0 sc1 lds
    buffer_load_dwordx4 v5, s[12:15], s50 offen offset:1024 sc1 lds
    s_add_u32 s50, s50, 8192
    s_add_u32 m0, s51, 40960
    s_nop 0
    buffer_load_dwordx4 v5, s[12:15], s50 offen offset:0 sc1 lds
    buffer_load_dwordx4 v5, s[12:15], s50 offen offset:1024 sc1 lds
    s_add_u32 s50, s50, 8192
    s_lshl_b32 m0, s60, 10
    s_lshl_b32 s3, s60, 14
    buffer_load_dwordx4 v7, s[24:27], s3 offen lds
    s_add_u32 s60, s60, 4
    s_lshl_b32 m0, s60, 10
    s_lshl_b32 s3, s60, 14
    buffer_load_dwordx4 v7, s[24:27], s3 offen lds
    s_add_u32 s60, s60, 4
    s_waitcnt vmcnt(8)
    s_barrier
    s_branch need_81_t
need_81:
    s_load_dwordx4 s[64:67], s[52:53], s62 glc
    s_sub_u32 s58, s58, 1
    s_cbranch_scc1 need_81_ok
    s_waitcnt lgkmcnt(0)
need_81_t:
    s_cmp_ge_u32 s48, 2
    s_cselect_b32 s63, s67, s66
    s_cmp_lg_u32 s63, s10
    s_cbranch_scc1 need_81
need_81_ok:
    s_waitcnt lgkmcnt(0)
    s_add_u32 m0, s51, 49152
    s_nop 0
    buffer_load_dwordx4 v5, s[12:15], s50 offen offset:0 sc1 lds
    buffer_load_dwordx4 v5, s[12:15], s50 offen offset:1024 sc1 lds
    s_add_u32 s50, s50, 8192
    s_add_u32 m0, s51, 57344
    s_nop 0
    buffer_load_dwordx4 v5, s[12:15], s50 offen offset:0 sc1 lds
    buffer_load_dwordx4 v5, s[12:15], s50 offen offset:1024 sc1 lds
    s_add_u32 s50, s50, 8192
    s_lshl_b32 m0, s60, 10
    s_lshl_b32 s3, s60, 14
    buffer_load_dwordx4 v7, s[24:27], s3 offen lds
    s_add_u32 s60, s60, 4
    s_lshl_b32 m0, s60, 10
    s_lshl_b32 s3, s60, 14
    buffer_load_dwordx4 v7, s[24:27], s3 offen lds
    s_add_u32 s60, s60, 4
    s_waitcnt vmcnt(8)
    s_barrier
    s_add_u32 s62, s61, 6
    s_and_b32 s62, s62, 7
    s_lshl_b32 s50, s62, 15
    s_add_u32 s50, s50, s49
    s_lshr_b32 s63, s62, 1
    s_lshl_b32 s63, s63, 7
    s_and_b32 s62, s62, 1
    s_lshl_b32 s62, s62, 4
    s_add_u32 s62, s62, s63
    s_mov_b32 s58, 0x100000
need_82:
    s_load_dwordx4 s[64:67], s[52:53], s62 glc
    s_sub_u32 s58, s58, 1
    s_cbranch_scc1 need_82_ok
    s_waitcnt lgkmcnt(0)
need_82_t:
    s_cmp_ge_u32 s48, 2
    s_cselect_b32 s63, s65, s64
    s_cmp_lg_u32 s63, s10
    s_cbranch_scc1 need_82
need_82_ok:
    s_waitcnt lgkmcnt(0)
    s_add_u32 m0, s51, 0
    s_nop 0
    buffer_load_dwordx4 v5, s[12:15], s50 offen offset:0 sc1 lds
    buffer_load_dwordx4 v5, s[12:15], s50 offen offset:1024 sc1 lds
    s_add_u32 s50, s50, 8192
    s_add_u32 m0, s51, 8192
    s_nop 0
    buffer_load_dwordx4 v5, s[12:15], s50 offen offset:0 sc1 lds
    buffer_load_dwordx4 v5, s[12:15], s50 offen offset:1024 sc1 lds
    s_add_u32 s50, s50, 8192
    s_lshl_b32 m0, s60, 10
    s_lshl_b32 s3, s60, 14
    buffer_load_dwordx4 v7, s[24:27], s3 offen lds
    s_add_u32 s60, s60, 4
    s_lshl_b32 m0, s60, 10
    s_lshl_b32 s3, s60, 14
    buffer_load_dwordx4 v7, s[24:27], s3 offen lds
    s_add_u32 s60, s60, 4
    s_waitcnt vmcnt(8)
    s_barrier
    s_branch need_83_t
need_83:
    s_load_dwordx4 s[64:67], s[52:53], s62 glc
    s_sub_u32 s58, s58, 1
    s_cbranch_scc1 need_83_ok
    s_waitcnt lgkmcnt(0)
need_83_t:
    s_cmp_ge_u32 s48, 2
    s_cselect_b32 s63, s67, s66
    s_cmp_lg_u32 s63, s10
    s_cbranch_scc1 need_83
need_83_ok:
    s_waitcnt lgkmcnt(0)
    s_add_u32 m0, s51, 16384
    s_nop 0
    buffer_load_dwordx4 v5, s[12:15], s50 offen offset:0 sc1 lds
    buffer_load_dwordx4 v5, s[12:15], s50 offen offset:1024 sc1 lds
    s_add_u32 s50, s50, 8192
    s_add_u32 m0, s51, 24576
    s_nop 0
    buffer_load_dwordx4 v5, s[12:15], s50 offen offset:0 sc1 lds
    buffer_load_dwordx4 v5, s[12:15], s50 offen offset:1024 sc1 lds
    s_add_u32 s50, s50, 8192
    s_lshl_b32 m0, s60, 10
    s_lshl_b32 s3, s60, 14
    buffer_load_dwordx4 v7, s[24:27], s3 offen lds
    s_add_u32 s60, s60, 4
    s_lshl_b32 m0, s60, 10
    s_lshl_b32 s3, s60, 14
    buffer_load_dwordx4 v7, s[24:27], s3 offen lds
    s_add_u32 s60, s60, 4
    s_waitcnt vmcnt(8)
    s_barrier
    s_add_u32 s62, s61, 7
    s_and_b32 s62, s62, 7
    s_lshl_b32 s50, s62, 15
    s_add_u32 s50, s50, s49
    s_lshr_b32 s63, s62, 1
    s_lshl_b32 s63, s63, 7
    s_and_b32 s62, s62, 1
    s_lshl_b32 s62, s62, 4
    s_add_u32 s62, s62, s63
    s_mov_b32 s58, 0x100000
need_84:
    s_load_dwordx4 s[64:67], s[52:53], s62 glc
    s_sub_u32 s58, s58, 1
    s_cbranch_scc1 need_84_ok
    s_waitcnt lgkmcnt(0)
need_84_t:
    s_cmp_ge_u32 s48, 2
    s_cselect_b32 s63, s65, s64
    s_cmp_lg_u32 s63, s10
    s_cbranch_scc1 need_84
need_84_ok:
    s_waitcnt lgkmcnt(0)
    s_add_u32 m0, s51, 32768
    s_nop 0
    buffer_load_dwordx4 v5, s[12:15], s50 offen offset:0 sc1 lds
    buffer_load_dwordx4 v5, s[12:15], s50 offen offset:1024 sc1 lds
    s_add_u32 s50, s50, 8192
    s_add_u32 m0, s51, 40960
    s_nop 0
    buffer_load_dwordx4 v5, s[12:15], s50 offen offset:0 sc1 lds
    buffer_load_dwordx4 v5, s[12:15], s50 offen offset:1024 sc1 lds
    s_add_u32 s50, s50, 8192
    s_lshl_b32 m0, s60, 10
    s_lshl_b32 s3, s60, 14
    buffer_load_dwordx4 v7, s[24:27], s3 offen lds
    s_add_u32 s60, s60, 4
    s_lshl_b32 m0, s60, 10
    s_lshl_b32 s3, s60, 14
    buffer_load_dwordx4 v7, s[24:27], s3 offen lds
    s_add_u32 s60, s60, 4
    s_waitcnt vmcnt(8)
    s_barrier
    s_branch need_85_t
need_85:
    s_load_dwordx4 s[64:67], s[52:53], s62 glc
    s_sub_u32 s58, s58, 1
    s_cbranch_scc1 need_85_ok
    s_waitcnt lgkmcnt(0)
need_85_t:
    s_cmp_ge_u32 s48, 2
    s_cselect_b32 s63, s67, s66
    s_cmp_lg_u32 s63, s10
    s_cbranch_scc1 need_85
need_85_ok:
    s_waitcnt lgkmcnt(0)
    s_add_u32 m0, s51, 49152
    s_nop 0
    buffer_load_dwordx4 v5, s[12:15], s50 offen offset:0 sc1 lds
    buffer_load_dwordx4 v5, s[12:15], s50 offen offset:1024 sc1 lds
    s_add_u32 s50, s50, 8192
    s_add_u32 m0, s51, 57344
    s_nop 0
    buffer_load_dwordx4 v5, s[12:15], s50 offen offset:0 sc1 lds
    buffer_load_dwordx4 v5, s[12:15], s50 offen offset:1024 sc1 lds
    s_add_u32 s50, s50, 8192
    s_lshl_b32 m0, s60, 10
    s_lshl_b32 s3, s60, 14
    buffer_load_dwordx4 v7, s[24:27], s3 offen lds
    s_add_u32 s60, s60, 4
    s_lshl_b32 m0, s60, 10
    s_lshl_b32 s3, s60, 14
    buffer_load_dwordx4 v7, s[24:27], s3 offen lds
    s_add_u32 s60, s60, 4
    s_waitcnt vmcnt(8)
    s_barrier
    s_lshl_b32 m0, s60, 10
    s_lshl_b32 s3, s60, 14
    buffer_load_dwordx4 v7, s[24:27], s3 offen lds
    s_add_u32 s60, s60, 4
    s_lshl_b32 m0, s60, 10
    s_lshl_b32 s3, s60, 14
    buffer_load_dwordx4 v7, s[24:27], s3 offen lds
    s_add_u32 s60, s60, 4
    s_lshl_b32 m0, s60, 10
    s_lshl_b32 s3, s60, 14
    buffer_load_dwordx4 v7, s[24:27], s3 offen lds
    s_add_u32 s60, s60, 4
    s_lshl_b32 m0, s60, 10
    s_lshl_b32 s3, s60, 14
    buffer_load_dwordx4 v7, s[24:27], s3 offen lds
    s_add_u32 s60, s60, 4
    s_waitcnt vmcnt(6)
    s_barrier
    s_lshl_b32 m0, s60, 10
    s_lshl_b32 s3, s60, 14
    buffer_load_dwordx4 v7, s[24:27], s3 offen lds
    s_add_u32 s60, s60, 4
    s_lshl_b32 m0, s60, 10
    s_lshl_b32 s3, s60, 14
    buffer_load_dwordx4 v7, s[24:27], s3 offen lds
    s_add_u32 s60, s60, 4
    s_lshl_b32 m0, s60, 10
    s_lshl_b32 s3, s60, 14
    buffer_load_dwordx4 v7, s[24:27], s3 offen lds
    s_add_u32 s60, s60, 4
    s_lshl_b32 m0, s60, 10
    s_lshl_b32 s3, s60, 14
    buffer_load_dwordx4 v7, s[24:27], s3 offen lds
    s_add_u32 s60, s60, 4
    s_barrier
    s_lshl_b32 m0, s60, 10
    s_lshl_b32 s3, s60, 14
    buffer_load_dwordx4 v7, s[24:27], s3 offen lds
    s_add_u32 s60, s60, 4
    s_lshl_b32 m0, s60, 10
    s_lshl_b32 s3, s60, 14
    buffer_load_dwordx4 v7, s[24:27], s3 offen lds
    s_add_u32 s60, s60, 4
    s_lshl_b32 m0, s60, 10
    s_lshl_b32 s3, s60, 14
    buffer_load_dwordx4 v7, s[24:27], s3 offen lds
    s_add_u32 s60, s60, 4
    s_lshl_b32 m0, s60, 10
    s_lshl_b32 s3, s60, 14
    buffer_load_dwordx4 v7, s[24:27], s3 offen lds
    s_add_u32 s60, s60, 4
    s_cmp_eq_u32 s8, 4
    s_cbranch_scc1 h_wo
    s_branch l_wo
.p2align 6
c_attn_slow:
    s_waitcnt lgkmcnt(0)
    s_lshr_b32 s56, s9, 1
    s_lshl_b32 s56, s56, 23
    s_lshl_b32 s55, s7, 19
    s_add_u32 s56, s56, s55
    s_and_b32 s55, s6, 1
    s_lshl_b32 s55, s55, 18
    s_add_u32 s56, s56, s55
    s_add_u32 s56, s56, 33554432
    v_mov_b32 v28, 0xff800000
    v_mov_b32 v30, 0xff800000
    s_mov_b32 s57, 0
c_attn_slow1:
    s_lshr_b32 s55, s57, 2
    s_lshl_b32 s55, s55, 14
    s_and_b32 s58, s57, 3
    s_lshl_b32 s58, s58, 11
    s_add_u32 s55, s55, s58
    s_add_u32 s55, s55, s56
    buffer_load_dwordx4 v[128:131], v5, s[12:15], s55 offen offset:0 sc1
    buffer_load_dwordx4 v[132:135], v5, s[12:15], s55 offen offset:1024 sc1
    s_waitcnt vmcnt(0)
    v_mfma_f32_32x32x16_bf16 v[64:79], v[128:131], v[8:11], 0
    v_mfma_f32_32x32x16_bf16 v[80:95], v[128:131], v[16:19], 0
    v_mfma_f32_32x32x16_bf16 v[64:79], v[132:135], v[12:15], v[64:79]
    v_mfma_f32_32x32x16_bf16 v[80:95], v[132:135], v[20:23], v[80:95]
    s_nop 10
    v_max3_f32 v28, v28, v64, v65
    v_max3_f32 v28, v28, v66, v67
    v_max3_f32 v28, v28, v68, v69
    v_max3_f32 v28, v28, v70, v71
    v_max3_f32 v28, v28, v72, v73
    v_max3_f32 v28, v28, v74, v75
    v_max3_f32 v28, v28, v76, v77
    v_max3_f32 v28, v28, v78, v79
    v_max3_f32 v30, v30, v80, v81
    v_max3_f32 v30, v30, v82, v83
    v_max3_f32 v30, v30, v84, v85
    v_max3_f32 v30, v30, v86, v87
    v_max3_f32 v30, v30, v88, v89
    v_max3_f32 v30, v30, v90, v91
    v_max3_f32 v30, v30, v92, v93
    v_max3_f32 v30, v30, v94, v95
    s_add_u32 s57, s57, 1
    s_cmp_lt_u32 s57, 64
    s_cbranch_scc1 c_attn_slow1
    v_mov_b32 v29, v28
    s_nop 1
    v_permlane32_swap_b32 v28, v29
    v_max_f32 v28, v28, v29
    v_sub_f32 v96, 0, v28
    v_sub_f32 v97, 0, v28
    v_sub_f32 v98, 0, v28
    v_sub_f32 v99, 0, v28
    v_sub_f32 v100, 0, v28
    v_sub_f32 v101, 0, v28
    v_sub_f32 v102, 0, v28
    v_sub_f32 v103, 0, v28
    v_sub_f32 v104, 0, v28
    v_sub_f32 v105, 0, v28
    v_sub_f32 v106, 0, v28
    v_sub_f32 v107, 0, v28
    v_sub_f32 v108, 0, v28
    v_sub_f32 v109, 0, v28
    v_sub_f32 v110, 0, v28
    v_sub_f32 v111, 0, v28
    v_mov_b32 v160, 0
    v_mov_b32 v161, 0
    v_mov_b32 v162, 0
    v_mov_b32 v163, 0
    v_mov_b32 v164, 0
    v_mov_b32 v165, 0
    v_mov_b32 v166, 0
    v_mov_b32 v167, 0
    v_mov_b32 v168, 0
    v_mov_b32 v169, 0
    v_mov_b32 v170, 0
    v_mov_b32 v171, 0
    v_mov_b32 v172, 0
    v_mov_b32 v173, 0
    v_mov_b32 v174, 0
    v_mov_b32 v175, 0
    v_mov_b32 v192, 0
    v_mov_b32 v193, 0
    v_mov_b32 v194, 0
    v_mov_b32 v195, 0
    v_mov_b32 v31, v30
    s_nop 1
    v_permlane32_swap_b32 v30, v31
    v_max_f32 v30, v30, v31
    v_sub_f32 v112, 0, v30
    v_sub_f32 v113, 0, v30
    v_sub_f32 v114, 0, v30
    v_sub_f32 v115, 0, v30
    v_sub_f32 v116, 0, v30
    v_sub_f32 v117, 0, v30
    v_sub_f32 v118, 0, v30
    v_sub_f32 v119, 0, v30
    v_sub_f32 v120, 0, v30
    v_sub_f32 v121, 0, v30
    v_sub_f32 v122, 0, v30
    v_sub_f32 v123, 0, v30
    v_sub_f32 v124, 0, v30
    v_sub_f32 v125, 0, v30
    v_sub_f32 v126, 0, v30
    v_sub_f32 v127, 0, v30
    v_mov_b32 v176, 0
    v_mov_b32 v177, 0
    v_mov_b32 v178, 0
    v_mov_b32 v179, 0
    v_mov_b32 v180, 0
    v_mov_b32 v181, 0
    v_mov_b32 v182, 0
    v_mov_b32 v183, 0
    v_mov_b32 v184, 0
    v_mov_b32 v185, 0
    v_mov_b32 v186, 0
    v_mov_b32 v187, 0
    v_mov_b32 v188, 0
    v_mov_b32 v189, 0
    v_mov_b32 v190, 0
    v_mov_b32 v191, 0
    v_mov_b32 v196, 0
    v_mov_b32 v197, 0
    v_mov_b32 v198, 0
    v_mov_b32 v199, 0
    s_mov_b32 s57, 0
c_attn_slow2:
    s_lshr_b32 s55, s57, 2
    s_lshl_b32 s55, s55, 14
    s_and_b32 s58, s57, 3
    s_lshl_b32 s58, s58, 11
    s_add_u32 s55, s55, s58
    s_add_u32 s55, s55, s56
    buffer_load_dwordx4 v[128:131], v5, s[12:15], s55 offen offset:0 sc1
    buffer_load_dwordx4 v[132:135], v5, s[12:15], s55 offen offset:1024 sc1
    s_add_u32 s55, s55, 8192
    buffer_load_dwordx4 v[144:147], v5, s[12:15], s55 offen offset:0 sc1
    buffer_load_dwordx4 v[148:151], v5, s[12:15], s55 offen offset:1024 sc1
    s_waitcnt vmcnt(0)
    v_mfma_f32_32x32x16_bf16 v[64:79], v[128:131], v[8:11], v[96:111]
    v_mfma_f32_32x32x16_bf16 v[80:95], v[128:131], v[16:19], v[112:127]
    v_mfma_f32_32x32x16_bf16 v[64:79], v[132:135], v[12:15], v[64:79]
    v_mfma_f32_32x32x16_bf16 v[80:95], v[132:135], v[20:23], v[80:95]
    s_nop 10
    v_exp_f32 v64, v64
    v_exp_f32 v65, v65
    v_exp_f32 v66, v66
    v_exp_f32 v67, v67
    v_exp_f32 v68, v68
    v_exp_f32 v69, v69
    v_exp_f32 v70, v70
    v_exp_f32 v71, v71
    v_exp_f32 v72, v72
    v_exp_f32 v73, v73
    v_exp_f32 v74, v74
    v_exp_f32 v75, v75
    v_exp_f32 v76, v76
    v_exp_f32 v77, v77
    v_exp_f32 v78, v78
    v_exp_f32 v79, v79
    v_exp_f32 v80, v80
    v_exp_f32 v81, v81
    v_exp_f32 v82, v82
    v_exp_f32 v83, v83
    v_exp_f32 v84, v84
    v_exp_f32 v85, v85
    v_exp_f32 v86, v86
    v_exp_f32 v87, v87
    v_exp_f32 v88, v88
    v_exp_f32 v89, v89
    v_exp_f32 v90, v90
    v_exp_f32 v91, v91
    v_exp_f32 v92, v92
    v_exp_f32 v93, v93
    v_exp_f32 v94, v94
    v_exp_f32 v95, v95
    v_smfmac_f32_32x32x32_bf16 v[160:175], v[144:147], v[64:71], v204
    v_smfmac_f32_16x16x64_bf16 v[192:195], v[200:203], v[64:71], v204
    v_smfmac_f32_32x32x32_bf16 v[160:175], v[148:151], v[72:79], v204
    v_smfmac_f32_16x16x64_bf16 v[192:195], v[200:203], v[72:79], v204
    v_smfmac_f32_32x32x32_bf16 v[176:191], v[144:147], v[80:87], v204
    v_smfmac_f32_16x16x64_bf16 v[196:199], v[200:203], v[80:87], v204
    v_smfmac_f32_32x32x32_bf16 v[176:191], v[148:151], v[88:95], v204
    v_smfmac_f32_16x16x64_bf16 v[196:199], v[200:203], v[88:95], v204
    s_add_u32 s57, s57, 1
    s_cmp_lt_u32 s57, 64
    s_nop 15
    s_cbranch_scc1 c_attn_slow2
    s_branch c_attn_fin
    s_endpgm
k_end:
.section .rodata,"a"
.p2align 6
.amdhsa_kernel interleave_layers__sliding_local_dilated__softmax_full_mha__prompt_kernel
  .amdhsa_next_free_vgpr 256
  .amdhsa_next_free_sgpr 102
  .amdhsa_accum_offset 224
  .amdhsa_group_segment_fixed_size 0
  .amdhsa_kernarg_size 72
  .amdhsa_user_sgpr_count 2
  .amdhsa_user_sgpr_kernarg_segment_ptr 1
  .amdhsa_system_sgpr_workgroup_id_x 1
.end_amdhsa_kernel
```

```asm
; @launch grid=(256,1,1) block=(512,1,1) lds=159744
.amdgcn_target "amdgcn-amd-amdhsa--gfx950"
.text
.globl interleave_layers__sliding_local_dilated__softmax_full_mha__prompt_kernel
.type interleave_layers__sliding_local_dilated__softmax_full_mha__prompt_kernel,@function
.p2align 8
interleave_layers__sliding_local_dilated__softmax_full_mha__prompt_kernel:
    s_cmp_ge_u32 s2, 256
    s_cbranch_scc1 k_exit2
    s_load_dwordx16 s[32:47], s[0:1], 0
    s_load_dwordx2 s[4:5], s[0:1], 64
    v_lshrrev_b32 v2, 6, v0
    v_and_b32 v1, 63, v0
    v_mov_b32 v12, 0
    v_mov_b32 v14, 0
    v_mov_b32 v15, 0
    v_mov_b32 v16, 0
    v_readfirstlane_b32 s8, v2
    s_and_b32 s3, s2, 2
    s_lshl_b32 s3, s3, 2
    s_bfe_u32 s6, s2, 0x30003
    s_add_u32 s6, s3, s6
    s_and_b32 s3, s2, 1
    s_lshl_b32 s3, s3, 3
    s_lshr_b32 s7, s2, 6
    s_add_u32 s7, s3, s7
    s_and_b32 s3, s2, 4
    s_add_u32 s7, s3, s7
    s_lshl_b32 s11, s6, 4
    s_add_u32 s11, s11, s7
    s_mov_b32 s9, -1
    s_mov_b32 s96, 0
    s_mov_b32 s10, 0
    s_cmp_lt_u32 s8, 4
    s_cbranch_scc1 c_prep
    s_cmp_eq_u32 s8, 4
    s_cbranch_scc1 h_first
k_heads:
l_first:
    s_sub_u32 s51, s8, 5
    s_mul_i32 s61, s51, 0
    s_add_u32 s61, s61, s2
    s_and_b32 s61, s61, 255
    s_lshl_b32 s3, s51, 8
    s_add_u32 s61, s61, s3
    s_and_b32 s62, s61, 15
    s_lshr_b32 s63, s61, 4
    v_lshrrev_b32 v20, 3, v1
    v_mul_u32_u24 v12, 6144, v20
    v_and_b32 v21, 7, v1
    v_lshl_add_u32 v12, v21, 4, v12
    s_mul_i32 s52, s62, 393216
    s_lshl_b32 s56, s63, 7
    s_add_u32 s52, s52, s56
    s_waitcnt lgkmcnt(0)
    s_mov_b32 s12, s4
    s_mov_b32 s13, s5
    s_mov_b32 s14, 71303168
    s_mov_b32 s15, 0x00020000
    s_mov_b32 s20, s34
    s_mov_b32 s21, s35
    s_mov_b32 s22, 6291456
    s_mov_b32 s23, 0x00020000
    s_add_u32 s53, s52, 0
    buffer_load_dwordx4 v[160:163], v12, s[20:23], s53 offen nt
    s_add_u32 s53, s52, 49152
    buffer_load_dwordx4 v[164:167], v12, s[20:23], s53 offen nt
    s_add_u32 s53, s52, 98304
    buffer_load_dwordx4 v[168:171], v12, s[20:23], s53 offen nt
    s_add_u32 s53, s52, 147456
    buffer_load_dwordx4 v[172:175], v12, s[20:23], s53 offen nt
    s_add_u32 s53, s52, 196608
    buffer_load_dwordx4 v[176:179], v12, s[20:23], s53 offen nt
    s_add_u32 s53, s52, 245760
    buffer_load_dwordx4 v[180:183], v12, s[20:23], s53 offen nt
    s_add_u32 s53, s52, 294912
    buffer_load_dwordx4 v[184:187], v12, s[20:23], s53 offen nt
    s_add_u32 s53, s52, 344064
    buffer_load_dwordx4 v[188:191], v12, s[20:23], s53 offen nt
    s_barrier
    s_branch l_first_tail
c_prep:
    s_lshl_b32 s48, s6, 2
    s_add_u32 s48, s48, s8
    v_lshrrev_b32 v16, 3, v1
    v_and_b32 v17, 7, v1
    v_lshlrev_b32 v18, 11, v16
    v_lshl_add_u32 v18, v17, 4, v18
    s_lshl_b32 s55, s48, 16
    s_lshl_b32 s56, s7, 7
    s_add_u32 s3, s55, s56
    s_waitcnt lgkmcnt(0)
    s_mov_b32 s12, s4
    s_mov_b32 s13, s5
    s_mov_b32 s14, 71303168
    s_mov_b32 s15, 0x00020000
    s_mov_b32 s28, s32
    s_mov_b32 s29, s33
    s_mov_b32 s30, 4194304
    s_mov_b32 s31, 0x00020000
    buffer_load_dwordx4 v[32:35], v18, s[28:31], s3 offen nt
    s_add_u32 s3, s3, 16384
    buffer_load_dwordx4 v[36:39], v18, s[28:31], s3 offen nt
    s_add_u32 s3, s3, 16384
    buffer_load_dwordx4 v[40:43], v18, s[28:31], s3 offen nt
    s_add_u32 s3, s3, 16384
    buffer_load_dwordx4 v[44:47], v18, s[28:31], s3 offen nt
    s_add_u32 s3, s3, 16384
    s_barrier
    s_branch c_prep_tail
h_first:
    s_memrealtime s[50:51]
    s_getpc_b64 s[52:53]
pc_10:
    s_sub_u32 s52, s52, pc_10-interleave_layers__sliding_local_dilated__softmax_full_mha__prompt_kernel
    s_subb_u32 s53, s53, 0
    s_lshr_b32 s3, s2, 3
    s_lshl_b32 s3, s3, 11
    v_and_b32 v18, 15, v0
    v_lshl_add_u32 v18, v18, 7, s3
    v_min_u32 v18, k_end-interleave_layers__sliding_local_dilated__softmax_full_mha__prompt_kernel-4, v18
    v_mov_b32 v19, s53
    v_add_co_u32 v18, vcc, s52, v18
    s_nop 1
    v_addc_co_u32 v19, vcc, 0, v19, vcc
    s_mov_b64 exec, 0xffff
    global_load_dword v18, v[18:19], off
    s_mov_b64 exec, -1
    s_waitcnt lgkmcnt(0)
    s_mov_b32 s12, s4
    s_mov_b32 s13, s5
    s_mov_b32 s14, 71303168
    s_mov_b32 s15, 0x00020000
    s_cmp_lg_u32 s2, 0
    s_cbranch_scc1 h_first_nonon
    s_mov_b32 s16, s46
    s_mov_b32 s17, s47
    s_mov_b32 s18, 256
    s_mov_b32 s19, 0x00020000
    v_lshlrev_b32 v14, 6, v1
    s_or_b32 s50, s50, 1
    v_mov_b32 v13, s50
    buffer_store_dword v13, v14, s[16:19], 0 offen sc1
h_first_nonon:
    v_mov_b32 v8, 0
    v_mov_b32 v9, 0
    v_mov_b32 v10, 159488
    ds_write_b64 v10, v[8:9]
    ds_write_b64 v10, v[8:9] offset:8
    ds_write_b64 v10, v[8:9] offset:16
    ds_write_b64 v10, v[8:9] offset:24
    s_waitcnt lgkmcnt(0)
    s_barrier
    s_branch h_first_tail
k_exit:
k_exit2:
    s_endpgm
.p2align 6
c_qkvA:
    v_and_b32 v1, 63, v0
    v_lshrrev_b32 v2, 6, v0
    v_lshlrev_b32 v5, 4, v1
    v_lshrrev_b32 v3, 5, v1
    v_and_b32 v4, 15, v0
    v_bfe_u32 v7, v1, 4, 1
    v_lshl_add_u32 v6, v7, 5, v4
    v_lshlrev_b32 v6, 4, v6
    v_lshl_add_u32 v6, v3, 10, v6
    s_lshr_b32 s48, s6, 1
    s_lshl_b32 s48, s48, 2
    s_add_u32 s48, s48, s8
    s_lshl_b32 s55, s48, 17
    s_lshl_b32 s56, s9, 22
    s_add_u32 s55, s55, s56
    s_add_u32 s16, s4, s55
    s_addc_u32 s17, s5, 0
    s_mov_b32 s18, 65536
    s_mov_b32 s19, 0x00020000
    s_add_u32 s56, s55, 65536
    s_add_u32 s20, s4, s56
    s_addc_u32 s21, s5, 0
    s_mov_b32 s22, 65536
    s_mov_b32 s23, 0x00020000
    s_lshl_b32 s49, s7, 12
    s_add_u32 s49, s49, s55
    s_and_b32 s56, s6, 1
    s_lshl_b32 s56, s56, 11
    s_add_u32 s49, s49, s56
    s_add_u32 s49, s49, 16777216
    s_movk_i32 s54, 4096
    v_lshrrev_b32 v16, 2, v4
    v_lshl_add_u32 v18, v7, 2, v16
    v_lshl_add_u32 v18, v3, 4, v18
    v_lshlrev_b32 v18, 6, v18
    v_and_b32 v17, 3, v4
    v_lshl_add_u32 v18, v17, 3, v18
    v_lshl_add_u32 v26, v7, 5, v18
    v_xor_b32 v27, 32, v26
    v_mov_b32 v24, v26
    v_mov_b32 v25, v27
    v_and_b32 v18, 0x30, v1
    v_add_u32 v10, 155648, v18
    v_lshlrev_b32 v11, 2, v4
    v_add_u32 v11, 155648, v11
    v_lshl_add_u32 v8, v2, 8, v11
    v_lshl_add_u32 v9, v2, 8, v10
    s_lshr_b32 s3, s8, 1
    s_and_b32 s55, s8, 1
    s_lshl_b32 s56, s55, 5
    v_xor_b32 v29, s56, v26
    s_lshl_b32 s56, s3, 13
    s_add_u32 s56, s56, 8192
    v_add_u32 v29, s56, v29
    v_mov_b32 v28, v29
    v_add_u32 v30, 147456, v5
    v_lshl_add_u32 v14, v2, 6, v10
    v_lshl_add_u32 v12, v2, 11, v5
    v_add_u32 v12, 131072, v12
    v_lshlrev_b32 v16, 8, v16
    v_lshl_add_u32 v16, v18, 2, v16
    v_lshl_add_u32 v16, v17, 1, v16
    v_add_u32 v16, 1024, v16
    v_cmp_gt_u32 vcc, 2, v2
    s_nop 1
    v_cndmask_b32 v13, v16, v5, vcc
    s_lshl_b32 s56, s55, 3
    s_add_u32 s56, s56, 131072
    v_add_u32 v13, s56, v13
    v_lshrrev_b32 v18, 2, v18
    v_sub_u32 v18, v4, v18
    v_mov_b32 v19, 0xf149f2ca
    v_add_u32 v16, 0x0, v18
    v_and_b32 v16, 0xfffffff1, v16
    v_cmp_eq_u32 vcc, 0, v16
    s_nop 1
    v_cndmask_b32 v196, v19, 0, vcc
    v_add_u32 v16, 0xffffffff, v18
    v_and_b32 v16, 0xfffffff1, v16
    v_cmp_eq_u32 vcc, 0, v16
    s_nop 1
    v_cndmask_b32 v197, v19, 0, vcc
    v_add_u32 v16, 0xfffffffe, v18
    v_and_b32 v16, 0xfffffff1, v16
    v_cmp_eq_u32 vcc, 0, v16
    s_nop 1
    v_cndmask_b32 v198, v19, 0, vcc
    v_add_u32 v16, 0xfffffffd, v18
    v_and_b32 v16, 0xfffffff1, v16
    v_cmp_eq_u32 vcc, 0, v16
    s_nop 1
    v_cndmask_b32 v199, v19, 0, vcc
    v_add_u32 v16, 0x10, v18
    v_and_b32 v16, 0xfffffff1, v16
    v_cmp_eq_u32 vcc, 0, v16
    s_nop 1
    v_cndmask_b32 v200, v19, 0, vcc
    v_add_u32 v16, 0xf, v18
    v_and_b32 v16, 0xfffffff1, v16
    v_cmp_eq_u32 vcc, 0, v16
    s_nop 1
    v_cndmask_b32 v201, v19, 0, vcc
    v_add_u32 v16, 0xe, v18
    v_and_b32 v16, 0xfffffff1, v16
    v_cmp_eq_u32 vcc, 0, v16
    s_nop 1
    v_cndmask_b32 v202, v19, 0, vcc
    v_add_u32 v16, 0xd, v18
    v_and_b32 v16, 0xfffffff1, v16
    v_cmp_eq_u32 vcc, 0, v16
    s_nop 1
    v_cndmask_b32 v203, v19, 0, vcc
    s_cmp_eq_u32 s48, 0
    s_cselect_b64 vcc, -1, 0
    v_cndmask_b32 v204, v200, v19, vcc
    v_cndmask_b32 v205, v201, v19, vcc
    v_cndmask_b32 v206, v202, v19, vcc
    v_cndmask_b32 v207, v203, v19, vcc
    v_mov_b32 v208, 0x3f803f80
    v_mov_b32 v209, 0x3f803f80
    v_mov_b32 v210, 0x3f803f80
    v_mov_b32 v211, 0x3f803f80
    v_mov_b32 v184, 0
    v_mov_b32 v185, 0
    v_mov_b32 v186, 0
    v_mov_b32 v187, 0
    v_mov_b32 v188, 0
    v_mov_b32 v189, 0
    v_mov_b32 v190, 0
    v_mov_b32 v191, 0
    v_mov_b32 v192, 0
    v_mov_b32 v193, 0
    v_mov_b32 v194, 0
    v_mov_b32 v195, 0
    v_mov_b32 v32, 0
    v_mov_b32 v33, 0
    v_mov_b32 v34, 0
    v_mov_b32 v35, 0
    v_mov_b32 v36, 0
    v_mov_b32 v37, 0
    v_mov_b32 v38, 0
    v_mov_b32 v39, 0
    v_mov_b32 v40, 0
    v_mov_b32 v41, 0
    v_mov_b32 v42, 0
    v_mov_b32 v43, 0
    v_mov_b32 v44, 0
    v_mov_b32 v45, 0
    v_mov_b32 v46, 0
    v_mov_b32 v47, 0
    v_mov_b32 v48, 0
    v_mov_b32 v49, 0
    v_mov_b32 v50, 0
    v_mov_b32 v51, 0
    v_mov_b32 v52, 0
    v_mov_b32 v53, 0
    v_mov_b32 v54, 0
    v_mov_b32 v55, 0
    v_mov_b32 v56, 0
    v_mov_b32 v57, 0
    v_mov_b32 v58, 0
    v_mov_b32 v59, 0
    v_mov_b32 v60, 0
    v_mov_b32 v61, 0
    v_mov_b32 v62, 0
    v_mov_b32 v63, 0
    v_mov_b32 v64, 0
    v_mov_b32 v65, 0
    v_mov_b32 v66, 0
    v_mov_b32 v67, 0
    v_mov_b32 v68, 0
    v_mov_b32 v69, 0
    v_mov_b32 v70, 0
    v_mov_b32 v71, 0
    v_mov_b32 v72, 0
    v_mov_b32 v73, 0
    v_mov_b32 v74, 0
    v_mov_b32 v75, 0
    v_mov_b32 v76, 0
    v_mov_b32 v77, 0
    v_mov_b32 v78, 0
    v_mov_b32 v79, 0
    v_mov_b32 v80, 0
    v_mov_b32 v81, 0
    v_mov_b32 v82, 0
    v_mov_b32 v83, 0
    v_mov_b32 v84, 0
    v_mov_b32 v85, 0
    v_mov_b32 v86, 0
    v_mov_b32 v87, 0
    v_mov_b32 v88, 0
    v_mov_b32 v89, 0
    v_mov_b32 v90, 0
    v_mov_b32 v91, 0
    v_mov_b32 v92, 0
    v_mov_b32 v93, 0
    v_mov_b32 v94, 0
    v_mov_b32 v95, 0
    v_mov_b32 v96, 0
    v_mov_b32 v97, 0
    v_mov_b32 v98, 0
    v_mov_b32 v99, 0
    v_mov_b32 v100, 0
    v_mov_b32 v101, 0
    v_mov_b32 v102, 0
    v_mov_b32 v103, 0
    v_mov_b32 v104, 0
    v_mov_b32 v105, 0
    v_mov_b32 v106, 0
    v_mov_b32 v107, 0
    v_mov_b32 v108, 0
    v_mov_b32 v109, 0
    v_mov_b32 v110, 0
    v_mov_b32 v111, 0
    v_mov_b32 v112, 0
    v_mov_b32 v113, 0
    v_mov_b32 v114, 0
    v_mov_b32 v115, 0
    v_mov_b32 v116, 0
    v_mov_b32 v117, 0
    v_mov_b32 v118, 0
    v_mov_b32 v119, 0
    v_mov_b32 v120, 0
    v_mov_b32 v121, 0
    v_mov_b32 v122, 0
    v_mov_b32 v123, 0
    v_mov_b32 v124, 0
    v_mov_b32 v125, 0
    v_mov_b32 v126, 0
    v_mov_b32 v127, 0
    s_mov_b32 s50, 8192
    s_mov_b32 s58, 6144
    s_mov_b32 s51, 12288
    s_mov_b32 s59, 10240
    s_mov_b32 s52, 0
    s_mul_i32 s60, s9, 786432
    s_add_u32 s60, s60, 65273856
    s_lshl_b32 s61, s11, 10
    s_add_u32 s60, s60, s61
    s_and_b32 s61, s8, 2
    s_lshl_b32 s61, s61, 7
    s_add_u32 s60, s60, s61
    s_add_u32 s61, s60, 128
    s_mov_b32 s98, s10
    s_mov_b32 s99, s10
    s_mov_b32 s3, 0x100000
cp_1:
    s_load_dwordx8 s[64:71], s[4:5], s60 glc
    s_load_dwordx8 s[72:79], s[4:5], s61 glc
    s_sub_u32 s3, s3, 1
    s_cbranch_scc1 cp_1_ok
    s_waitcnt lgkmcnt(0)
    s_xor_b64 s[100:101], s[64:65], s[98:99]
    s_xor_b64 s[64:65], s[66:67], s[98:99]
    s_or_b64 s[100:101], s[100:101], s[64:65]
    s_xor_b64 s[64:65], s[68:69], s[98:99]
    s_or_b64 s[100:101], s[100:101], s[64:65]
    s_xor_b64 s[64:65], s[70:71], s[98:99]
    s_or_b64 s[100:101], s[100:101], s[64:65]
    s_xor_b64 s[64:65], s[72:73], s[98:99]
    s_or_b64 s[100:101], s[100:101], s[64:65]
    s_xor_b64 s[64:65], s[74:75], s[98:99]
    s_or_b64 s[100:101], s[100:101], s[64:65]
    s_xor_b64 s[64:65], s[76:77], s[98:99]
    s_or_b64 s[100:101], s[100:101], s[64:65]
    s_xor_b64 s[64:65], s[78:79], s[98:99]
    s_or_b64 s[100:101], s[100:101], s[64:65]
    s_cbranch_scc1 cp_1
cp_1_ok:
    s_waitcnt lgkmcnt(0)
    buffer_load_dwordx4 v[152:155], v6, s[16:19], 0 offen offset:0 sc1
    buffer_load_dwordx4 v[156:159], v6, s[16:19], 0 offen offset:256 sc1
    buffer_load_dwordx4 v[160:163], v6, s[20:23], 0 offen offset:0 sc1
    buffer_load_dwordx4 v[164:167], v6, s[20:23], 0 offen offset:256 sc1
    buffer_load_dwordx4 v[168:171], v6, s[16:19], 0 offen offset:2048 sc1
    buffer_load_dwordx4 v[172:175], v6, s[16:19], 0 offen offset:2304 sc1
    buffer_load_dwordx4 v[176:179], v6, s[20:23], 0 offen offset:2048 sc1
    buffer_load_dwordx4 v[180:183], v6, s[20:23], 0 offen offset:2304 sc1
    s_barrier
    ds_read_b64_tr_b16 v[128:129], v24 offset:0
    ds_read_b64_tr_b16 v[130:131], v24 offset:512
    ds_read_b64_tr_b16 v[132:133], v25 offset:0
    ds_read_b64_tr_b16 v[134:135], v25 offset:512
    ds_read_b64_tr_b16 v[136:137], v24 offset:8192
    ds_read_b64_tr_b16 v[138:139], v24 offset:8704
    ds_read_b64_tr_b16 v[140:141], v25 offset:8192
    ds_read_b64_tr_b16 v[142:143], v25 offset:8704
    ds_read_b64_tr_b16 v[144:145], v24 offset:16384
    ds_read_b64_tr_b16 v[146:147], v24 offset:16896
    buffer_load_dwordx4 a[0:3], v6, s[16:19], s54 offen offset:0 sc1
    buffer_load_dwordx4 a[4:7], v6, s[16:19], s54 offen offset:256 sc1
    buffer_load_dwordx4 a[8:11], v6, s[20:23], s54 offen offset:0 sc1
    buffer_load_dwordx4 a[12:15], v6, s[20:23], s54 offen offset:256 sc1
    buffer_load_dwordx4 a[16:19], v6, s[16:19], s54 offen offset:2048 sc1
    buffer_load_dwordx4 a[20:23], v6, s[16:19], s54 offen offset:2304 sc1
    s_mov_b32 s54, 7
.p2align 3
c_qkvA_loop:
    s_waitcnt vmcnt(12) lgkmcnt(6)
    v_mfma_f32_16x16x32_bf16 v[184:187], v[188:191], v[192:195], v[184:187]
    v_mfma_f32_16x16x32_bf16 v[32:35], v[128:131], v[152:155], v[32:35]
    ds_read_b64_tr_b16 v[148:149], v25 offset:16384
    v_mfma_f32_16x16x32_bf16 v[36:39], v[128:131], v[156:159], v[36:39]
    ds_read_b64_tr_b16 v[150:151], v25 offset:16896
    v_mfma_f32_16x16x32_bf16 v[52:55], v[132:135], v[156:159], v[52:55]
    buffer_load_dwordx4 a[24:27], v6, s[20:23], s58 offen offset:0 sc1
    v_mfma_f32_16x16x32_bf16 v[48:51], v[132:135], v[152:155], v[48:51]
    ds_read_b64_tr_b16 v[188:189], v28 offset:0
    s_waitcnt lgkmcnt(5)
    v_mfma_f32_16x16x32_bf16 v[64:67], v[136:139], v[152:155], v[64:67]
    v_mfma_f32_16x16x32_bf16 v[68:71], v[136:139], v[156:159], v[68:71]
    ds_read_b64_tr_b16 v[190:191], v28 offset:512
    v_mfma_f32_16x16x32_bf16 v[84:87], v[140:143], v[156:159], v[84:87]
    buffer_load_dwordx4 a[28:31], v6, s[20:23], s58 offen offset:256 sc1
    v_mfma_f32_16x16x32_bf16 v[80:83], v[140:143], v[152:155], v[80:83]
    ds_read_b128 v[192:195], v30 offset:0
    s_waitcnt lgkmcnt(3)
    v_mfma_f32_16x16x32_bf16 v[96:99], v[152:155], v[144:147], v[96:99]
    v_mfma_f32_16x16x32_bf16 v[100:103], v[156:159], v[144:147], v[100:103]
    v_mfma_f32_16x16x32_bf16 v[116:119], v[156:159], v[148:151], v[116:119]
    v_mfma_f32_16x16x32_bf16 v[112:115], v[152:155], v[148:151], v[112:115]
    s_waitcnt vmcnt(12)
    v_mfma_f32_16x16x32_bf16 v[40:43], v[128:131], v[160:163], v[40:43]
    buffer_load_dwordx4 v[152:155], v6, s[16:19], s50 offen offset:0 sc1
    v_mfma_f32_16x16x32_bf16 v[44:47], v[128:131], v[164:167], v[44:47]
    v_mfma_f32_16x16x32_bf16 v[60:63], v[132:135], v[164:167], v[60:63]
    ds_read_b64_tr_b16 v[128:129], v24 offset:2048
    v_mfma_f32_16x16x32_bf16 v[56:59], v[132:135], v[160:163], v[56:59]
    ds_read_b64_tr_b16 v[130:131], v24 offset:2560
    v_mfma_f32_16x16x32_bf16 v[72:75], v[136:139], v[160:163], v[72:75]
    ds_read_b64_tr_b16 v[132:133], v25 offset:2048
    v_mfma_f32_16x16x32_bf16 v[76:79], v[136:139], v[164:167], v[76:79]
    ds_read_b64_tr_b16 v[134:135], v25 offset:2560
    v_mfma_f32_16x16x32_bf16 v[92:95], v[140:143], v[164:167], v[92:95]
    ds_read_b64_tr_b16 v[136:137], v24 offset:10240
    buffer_load_dwordx4 v[156:159], v6, s[16:19], s50 offen offset:256 sc1
    v_mfma_f32_16x16x32_bf16 v[88:91], v[140:143], v[160:163], v[88:91]
    ds_read_b64_tr_b16 v[138:139], v24 offset:10752
    v_mfma_f32_16x16x32_bf16 v[104:107], v[160:163], v[144:147], v[104:107]
    ds_read_b64_tr_b16 v[140:141], v25 offset:10240
    v_mfma_f32_16x16x32_bf16 v[108:111], v[164:167], v[144:147], v[108:111]
    ds_read_b64_tr_b16 v[142:143], v25 offset:10752
    v_mfma_f32_16x16x32_bf16 v[124:127], v[164:167], v[148:151], v[124:127]
    ds_read_b64_tr_b16 v[144:145], v24 offset:18432
    v_mfma_f32_16x16x32_bf16 v[120:123], v[160:163], v[148:151], v[120:123]
    ds_read_b64_tr_b16 v[146:147], v24 offset:18944
    s_waitcnt vmcnt(12) lgkmcnt(6)
    v_mfma_f32_16x16x32_bf16 v[184:187], v[188:191], v[192:195], v[184:187]
    v_mfma_f32_16x16x32_bf16 v[32:35], v[128:131], v[168:171], v[32:35]
    ds_read_b64_tr_b16 v[148:149], v25 offset:18432
    v_mfma_f32_16x16x32_bf16 v[36:39], v[128:131], v[172:175], v[36:39]
    ds_read_b64_tr_b16 v[150:151], v25 offset:18944
    v_mfma_f32_16x16x32_bf16 v[52:55], v[132:135], v[172:175], v[52:55]
    buffer_load_dwordx4 v[160:163], v6, s[20:23], s58 offen offset:2048 sc1
    v_mfma_f32_16x16x32_bf16 v[48:51], v[132:135], v[168:171], v[48:51]
    ds_read_b64_tr_b16 v[188:189], v28 offset:2048
    s_waitcnt lgkmcnt(5)
    v_mfma_f32_16x16x32_bf16 v[64:67], v[136:139], v[168:171], v[64:67]
    v_mfma_f32_16x16x32_bf16 v[68:71], v[136:139], v[172:175], v[68:71]
    ds_read_b64_tr_b16 v[190:191], v28 offset:2560
    v_mfma_f32_16x16x32_bf16 v[84:87], v[140:143], v[172:175], v[84:87]
    buffer_load_dwordx4 v[164:167], v6, s[20:23], s58 offen offset:2304 sc1
    v_mfma_f32_16x16x32_bf16 v[80:83], v[140:143], v[168:171], v[80:83]
    ds_read_b128 v[192:195], v30 offset:1024
    s_waitcnt lgkmcnt(3)
    v_mfma_f32_16x16x32_bf16 v[96:99], v[168:171], v[144:147], v[96:99]
    v_mfma_f32_16x16x32_bf16 v[100:103], v[172:175], v[144:147], v[100:103]
    v_mfma_f32_16x16x32_bf16 v[116:119], v[172:175], v[148:151], v[116:119]
    v_mfma_f32_16x16x32_bf16 v[112:115], v[168:171], v[148:151], v[112:115]
    s_waitcnt vmcnt(12)
    v_mfma_f32_16x16x32_bf16 v[40:43], v[128:131], v[176:179], v[40:43]
    buffer_load_dwordx4 v[168:171], v6, s[16:19], s50 offen offset:2048 sc1
    v_mfma_f32_16x16x32_bf16 v[44:47], v[128:131], v[180:183], v[44:47]
    v_mfma_f32_16x16x32_bf16 v[60:63], v[132:135], v[180:183], v[60:63]
    ds_read_b64_tr_b16 v[128:129], v24 offset:4096
    v_mfma_f32_16x16x32_bf16 v[56:59], v[132:135], v[176:179], v[56:59]
    ds_read_b64_tr_b16 v[130:131], v24 offset:4608
    v_mfma_f32_16x16x32_bf16 v[72:75], v[136:139], v[176:179], v[72:75]
    ds_read_b64_tr_b16 v[132:133], v25 offset:4096
    v_mfma_f32_16x16x32_bf16 v[76:79], v[136:139], v[180:183], v[76:79]
    ds_read_b64_tr_b16 v[134:135], v25 offset:4608
    v_mfma_f32_16x16x32_bf16 v[92:95], v[140:143], v[180:183], v[92:95]
    ds_read_b64_tr_b16 v[136:137], v24 offset:12288
    buffer_load_dwordx4 v[172:175], v6, s[16:19], s50 offen offset:2304 sc1
    v_mfma_f32_16x16x32_bf16 v[88:91], v[140:143], v[176:179], v[88:91]
    ds_read_b64_tr_b16 v[138:139], v24 offset:12800
    v_mfma_f32_16x16x32_bf16 v[104:107], v[176:179], v[144:147], v[104:107]
    ds_read_b64_tr_b16 v[140:141], v25 offset:12288
    v_mfma_f32_16x16x32_bf16 v[108:111], v[180:183], v[144:147], v[108:111]
    ds_read_b64_tr_b16 v[142:143], v25 offset:12800
    v_mfma_f32_16x16x32_bf16 v[124:127], v[180:183], v[148:151], v[124:127]
    ds_read_b64_tr_b16 v[144:145], v24 offset:20480
    v_mfma_f32_16x16x32_bf16 v[120:123], v[176:179], v[148:151], v[120:123]
    ds_read_b64_tr_b16 v[146:147], v24 offset:20992
    s_waitcnt vmcnt(12) lgkmcnt(6)
    v_mfma_f32_16x16x32_bf16 v[184:187], v[188:191], v[192:195], v[184:187]
    v_mfma_f32_16x16x32_bf16 v[32:35], v[128:131], a[0:3], v[32:35]
    ds_read_b64_tr_b16 v[148:149], v25 offset:20480
    v_mfma_f32_16x16x32_bf16 v[36:39], v[128:131], a[4:7], v[36:39]
    ds_read_b64_tr_b16 v[150:151], v25 offset:20992
    v_mfma_f32_16x16x32_bf16 v[52:55], v[132:135], a[4:7], v[52:55]
    buffer_load_dwordx4 v[176:179], v6, s[20:23], s59 offen offset:0 sc1
    v_mfma_f32_16x16x32_bf16 v[48:51], v[132:135], a[0:3], v[48:51]
    ds_read_b64_tr_b16 v[188:189], v28 offset:4096
    s_waitcnt lgkmcnt(5)
    v_mfma_f32_16x16x32_bf16 v[64:67], v[136:139], a[0:3], v[64:67]
    s_add_u32 s50, s50, 8192
    v_mfma_f32_16x16x32_bf16 v[68:71], v[136:139], a[4:7], v[68:71]
    ds_read_b64_tr_b16 v[190:191], v28 offset:4608
    v_mfma_f32_16x16x32_bf16 v[84:87], v[140:143], a[4:7], v[84:87]
    buffer_load_dwordx4 v[180:183], v6, s[20:23], s59 offen offset:256 sc1
    v_mfma_f32_16x16x32_bf16 v[80:83], v[140:143], a[0:3], v[80:83]
    ds_read_b128 v[192:195], v30 offset:2048
    s_waitcnt lgkmcnt(3)
    v_mfma_f32_16x16x32_bf16 v[96:99], a[0:3], v[144:147], v[96:99]
    s_add_u32 s52, s52, 24576
    v_mfma_f32_16x16x32_bf16 v[100:103], a[4:7], v[144:147], v[100:103]
    s_cmp_eq_u32 s52, 147456
    v_mfma_f32_16x16x32_bf16 v[116:119], a[4:7], v[148:151], v[116:119]
    s_cselect_b32 s52, 0, s52
    v_mfma_f32_16x16x32_bf16 v[112:115], a[0:3], v[148:151], v[112:115]
    s_add_u32 s58, s58, 8192
    s_waitcnt vmcnt(12)
    v_mfma_f32_16x16x32_bf16 v[40:43], v[128:131], a[8:11], v[40:43]
    buffer_load_dwordx4 a[0:3], v6, s[16:19], s51 offen offset:0 sc1
    v_mfma_f32_16x16x32_bf16 v[44:47], v[128:131], a[12:15], v[44:47]
    s_sub_u32 s54, s54, 1
    v_mfma_f32_16x16x32_bf16 v[60:63], v[132:135], a[12:15], v[60:63]
    ds_read_b64_tr_b16 v[128:129], v24 offset:6144
    v_mfma_f32_16x16x32_bf16 v[56:59], v[132:135], a[8:11], v[56:59]
    ds_read_b64_tr_b16 v[130:131], v24 offset:6656
    v_mfma_f32_16x16x32_bf16 v[72:75], v[136:139], a[8:11], v[72:75]
    ds_read_b64_tr_b16 v[132:133], v25 offset:6144
    v_mfma_f32_16x16x32_bf16 v[76:79], v[136:139], a[12:15], v[76:79]
    ds_read_b64_tr_b16 v[134:135], v25 offset:6656
    v_mfma_f32_16x16x32_bf16 v[92:95], v[140:143], a[12:15], v[92:95]
    ds_read_b64_tr_b16 v[136:137], v24 offset:14336
    buffer_load_dwordx4 a[4:7], v6, s[16:19], s51 offen offset:256 sc1
    v_mfma_f32_16x16x32_bf16 v[88:91], v[140:143], a[8:11], v[88:91]
    ds_read_b64_tr_b16 v[138:139], v24 offset:14848
    v_mfma_f32_16x16x32_bf16 v[104:107], a[8:11], v[144:147], v[104:107]
    ds_read_b64_tr_b16 v[140:141], v25 offset:14336
    v_mfma_f32_16x16x32_bf16 v[108:111], a[12:15], v[144:147], v[108:111]
    ds_read_b64_tr_b16 v[142:143], v25 offset:14848
    v_mfma_f32_16x16x32_bf16 v[124:127], a[12:15], v[148:151], v[124:127]
    ds_read_b64_tr_b16 v[144:145], v24 offset:22528
    v_mfma_f32_16x16x32_bf16 v[120:123], a[8:11], v[148:151], v[120:123]
    ds_read_b64_tr_b16 v[146:147], v24 offset:23040
    s_waitcnt vmcnt(12) lgkmcnt(6)
    v_mfma_f32_16x16x32_bf16 v[184:187], v[188:191], v[192:195], v[184:187]
    v_mfma_f32_16x16x32_bf16 v[32:35], v[128:131], a[16:19], v[32:35]
    ds_read_b64_tr_b16 v[148:149], v25 offset:22528
    v_mfma_f32_16x16x32_bf16 v[36:39], v[128:131], a[20:23], v[36:39]
    ds_read_b64_tr_b16 v[150:151], v25 offset:23040
    v_mfma_f32_16x16x32_bf16 v[52:55], v[132:135], a[20:23], v[52:55]
    buffer_load_dwordx4 a[8:11], v6, s[20:23], s59 offen offset:2048 sc1
    v_mfma_f32_16x16x32_bf16 v[48:51], v[132:135], a[16:19], v[48:51]
    ds_read_b64_tr_b16 v[188:189], v28 offset:6144
    s_waitcnt lgkmcnt(5)
    v_mfma_f32_16x16x32_bf16 v[64:67], v[136:139], a[16:19], v[64:67]
    v_add_u32 v25, s52, v27
    v_mfma_f32_16x16x32_bf16 v[68:71], v[136:139], a[20:23], v[68:71]
    ds_read_b64_tr_b16 v[190:191], v28 offset:6656
    v_mfma_f32_16x16x32_bf16 v[84:87], v[140:143], a[20:23], v[84:87]
    buffer_load_dwordx4 a[12:15], v6, s[20:23], s59 offen offset:2304 sc1
    v_mfma_f32_16x16x32_bf16 v[80:83], v[140:143], a[16:19], v[80:83]
    ds_read_b128 v[192:195], v30 offset:3072
    s_waitcnt lgkmcnt(3)
    v_mfma_f32_16x16x32_bf16 v[96:99], a[16:19], v[144:147], v[96:99]
    v_add_u32 v24, s52, v26
    v_mfma_f32_16x16x32_bf16 v[100:103], a[20:23], v[144:147], v[100:103]
    v_add_u32 v28, s52, v29
    v_mfma_f32_16x16x32_bf16 v[116:119], a[20:23], v[148:151], v[116:119]
    s_add_u32 s59, s59, 8192
    s_waitcnt lgkmcnt(0)
    v_mfma_f32_16x16x32_bf16 v[112:115], a[16:19], v[148:151], v[112:115]
    s_barrier
    s_waitcnt vmcnt(12)
    v_mfma_f32_16x16x32_bf16 v[40:43], v[128:131], a[24:27], v[40:43]
    buffer_load_dwordx4 a[16:19], v6, s[16:19], s51 offen offset:2048 sc1
    v_mfma_f32_16x16x32_bf16 v[44:47], v[128:131], a[28:31], v[44:47]
    v_xor_b32 v30, 4096, v30
    v_mfma_f32_16x16x32_bf16 v[60:63], v[132:135], a[28:31], v[60:63]
    ds_read_b64_tr_b16 v[128:129], v24 offset:0
    v_mfma_f32_16x16x32_bf16 v[56:59], v[132:135], a[24:27], v[56:59]
    ds_read_b64_tr_b16 v[130:131], v24 offset:512
    v_mfma_f32_16x16x32_bf16 v[72:75], v[136:139], a[24:27], v[72:75]
    ds_read_b64_tr_b16 v[132:133], v25 offset:0
    v_mfma_f32_16x16x32_bf16 v[76:79], v[136:139], a[28:31], v[76:79]
    ds_read_b64_tr_b16 v[134:135], v25 offset:512
    v_mfma_f32_16x16x32_bf16 v[92:95], v[140:143], a[28:31], v[92:95]
    ds_read_b64_tr_b16 v[136:137], v24 offset:8192
    buffer_load_dwordx4 a[20:23], v6, s[16:19], s51 offen offset:2304 sc1
    v_mfma_f32_16x16x32_bf16 v[88:91], v[140:143], a[24:27], v[88:91]
    ds_read_b64_tr_b16 v[138:139], v24 offset:8704
    v_mfma_f32_16x16x32_bf16 v[104:107], a[24:27], v[144:147], v[104:107]
    ds_read_b64_tr_b16 v[140:141], v25 offset:8192
    s_add_u32 s51, s51, 8192
    v_mfma_f32_16x16x32_bf16 v[108:111], a[28:31], v[144:147], v[108:111]
    ds_read_b64_tr_b16 v[142:143], v25 offset:8704
    v_mfma_f32_16x16x32_bf16 v[124:127], a[28:31], v[148:151], v[124:127]
    ds_read_b64_tr_b16 v[144:145], v24 offset:16384
    s_cmp_lg_u32 s54, 0
    v_mfma_f32_16x16x32_bf16 v[120:123], a[24:27], v[148:151], v[120:123]
    ds_read_b64_tr_b16 v[146:147], v24 offset:16896
    s_cbranch_scc1 c_qkvA_loop
    s_waitcnt vmcnt(12) lgkmcnt(6)
    v_mfma_f32_16x16x32_bf16 v[184:187], v[188:191], v[192:195], v[184:187]
    v_mfma_f32_16x16x32_bf16 v[32:35], v[128:131], v[152:155], v[32:35]
    ds_read_b64_tr_b16 v[148:149], v25 offset:16384
    v_mfma_f32_16x16x32_bf16 v[36:39], v[128:131], v[156:159], v[36:39]
    ds_read_b64_tr_b16 v[150:151], v25 offset:16896
    v_mfma_f32_16x16x32_bf16 v[52:55], v[132:135], v[156:159], v[52:55]
    buffer_load_dwordx4 a[24:27], v6, s[20:23], s58 offen offset:0 sc1
    ds_read_b32 v16, v8 offset:1280
    v_mfma_f32_16x16x32_bf16 v[48:51], v[132:135], v[152:155], v[48:51]
    ds_read_b64_tr_b16 v[188:189], v28 offset:0
    ds_read_b32 v18, v8 offset:1344
    s_waitcnt lgkmcnt(7)
    v_mfma_f32_16x16x32_bf16 v[64:67], v[136:139], v[152:155], v[64:67]
    ds_read_b32 v20, v8 offset:1408
    v_mfma_f32_16x16x32_bf16 v[68:71], v[136:139], v[156:159], v[68:71]
    ds_read_b64_tr_b16 v[190:191], v28 offset:512
    v_mfma_f32_16x16x32_bf16 v[84:87], v[140:143], v[156:159], v[84:87]
    buffer_load_dwordx4 a[28:31], v6, s[20:23], s58 offen offset:256 sc1
    ds_read_b32 v22, v8 offset:1472
    v_mfma_f32_16x16x32_bf16 v[80:83], v[140:143], v[152:155], v[80:83]
    ds_read_b128 v[192:195], v30 offset:0
    ds_read_b128 v[212:215], v10 offset:128
    s_waitcnt lgkmcnt(8)
    v_mfma_f32_16x16x32_bf16 v[96:99], v[152:155], v[144:147], v[96:99]
    ds_read_b128 v[216:219], v10 offset:192
    v_mfma_f32_16x16x32_bf16 v[100:103], v[156:159], v[144:147], v[100:103]
    v_mfma_f32_16x16x32_bf16 v[116:119], v[156:159], v[148:151], v[116:119]
    v_mfma_f32_16x16x32_bf16 v[112:115], v[152:155], v[148:151], v[112:115]
    s_waitcnt vmcnt(12)
    v_mfma_f32_16x16x32_bf16 v[40:43], v[128:131], v[160:163], v[40:43]
    s_waitcnt lgkmcnt(0)
    v_fma_f32 v64, -v16, v212, v64
    v_fma_f32 v65, -v16, v213, v65
    v_mfma_f32_16x16x32_bf16 v[44:47], v[128:131], v[164:167], v[44:47]
    v_fma_f32 v66, -v16, v214, v66
    v_mfma_f32_16x16x32_bf16 v[60:63], v[132:135], v[164:167], v[60:63]
    ds_read_b64_tr_b16 v[128:129], v24 offset:2048
    v_fma_f32 v67, -v16, v215, v67
    v_mfma_f32_16x16x32_bf16 v[56:59], v[132:135], v[160:163], v[56:59]
    ds_read_b64_tr_b16 v[130:131], v24 offset:2560
    v_fma_f32 v68, -v18, v212, v68
    v_fma_f32 v69, -v18, v213, v69
    v_mfma_f32_16x16x32_bf16 v[72:75], v[136:139], v[160:163], v[72:75]
    ds_read_b64_tr_b16 v[132:133], v25 offset:2048
    v_fma_f32 v70, -v18, v214, v70
    v_mfma_f32_16x16x32_bf16 v[76:79], v[136:139], v[164:167], v[76:79]
    ds_read_b64_tr_b16 v[134:135], v25 offset:2560
    v_fma_f32 v71, -v18, v215, v71
    v_mfma_f32_16x16x32_bf16 v[92:95], v[140:143], v[164:167], v[92:95]
    ds_read_b64_tr_b16 v[136:137], v24 offset:10240
    v_fma_f32 v80, -v16, v216, v80
    v_fma_f32 v81, -v16, v217, v81
    v_mfma_f32_16x16x32_bf16 v[88:91], v[140:143], v[160:163], v[88:91]
    ds_read_b64_tr_b16 v[138:139], v24 offset:10752
    v_fma_f32 v82, -v16, v218, v82
    v_mfma_f32_16x16x32_bf16 v[104:107], v[160:163], v[144:147], v[104:107]
    ds_read_b64_tr_b16 v[140:141], v25 offset:10240
    v_fma_f32 v83, -v16, v219, v83
    v_mfma_f32_16x16x32_bf16 v[108:111], v[164:167], v[144:147], v[108:111]
    ds_read_b64_tr_b16 v[142:143], v25 offset:10752
    v_fma_f32 v84, -v18, v216, v84
    v_fma_f32 v85, -v18, v217, v85
    v_mfma_f32_16x16x32_bf16 v[124:127], v[164:167], v[148:151], v[124:127]
    ds_read_b64_tr_b16 v[144:145], v24 offset:18432
    v_fma_f32 v86, -v18, v218, v86
    v_mfma_f32_16x16x32_bf16 v[120:123], v[160:163], v[148:151], v[120:123]
    ds_read_b64_tr_b16 v[146:147], v24 offset:18944
    v_fma_f32 v87, -v18, v219, v87
    s_waitcnt vmcnt(10) lgkmcnt(6)
    v_mfma_f32_16x16x32_bf16 v[184:187], v[188:191], v[192:195], v[184:187]
    v_mfma_f32_16x16x32_bf16 v[32:35], v[128:131], v[168:171], v[32:35]
    ds_read_b64_tr_b16 v[148:149], v25 offset:18432
    v_fma_f32 v72, -v20, v212, v72
    v_fma_f32 v73, -v20, v213, v73
    v_mfma_f32_16x16x32_bf16 v[36:39], v[128:131], v[172:175], v[36:39]
    ds_read_b64_tr_b16 v[150:151], v25 offset:18944
    v_fma_f32 v74, -v20, v214, v74
    v_mfma_f32_16x16x32_bf16 v[52:55], v[132:135], v[172:175], v[52:55]
    v_fma_f32 v75, -v20, v215, v75
    ds_read_b128 v[152:155], v10 offset:0
    v_mfma_f32_16x16x32_bf16 v[48:51], v[132:135], v[168:171], v[48:51]
    ds_read_b64_tr_b16 v[188:189], v28 offset:2048
    v_fma_f32 v76, -v22, v212, v76
    v_fma_f32 v77, -v22, v213, v77
    ds_read_b128 v[156:159], v10 offset:64
    s_waitcnt lgkmcnt(7)
    v_mfma_f32_16x16x32_bf16 v[64:67], v[136:139], v[168:171], v[64:67]
    v_fma_f32 v78, -v22, v214, v78
    ds_read_b32 v17, v8 offset:2816
    v_mfma_f32_16x16x32_bf16 v[68:71], v[136:139], v[172:175], v[68:71]
    ds_read_b64_tr_b16 v[190:191], v28 offset:2560
    v_fma_f32 v79, -v22, v215, v79
    v_mfma_f32_16x16x32_bf16 v[84:87], v[140:143], v[172:175], v[84:87]
    v_fma_f32 v88, -v20, v216, v88
    v_fma_f32 v89, -v20, v217, v89
    ds_read_b32 v19, v8 offset:2880
    v_mfma_f32_16x16x32_bf16 v[80:83], v[140:143], v[168:171], v[80:83]
    ds_read_b128 v[192:195], v30 offset:1024
    v_fma_f32 v90, -v20, v218, v90
    ds_read_b32 v21, v8 offset:2944
    s_waitcnt lgkmcnt(8)
    v_mfma_f32_16x16x32_bf16 v[96:99], v[168:171], v[144:147], v[96:99]
    v_fma_f32 v91, -v20, v219, v91
    ds_read_b32 v23, v8 offset:3008
    v_mfma_f32_16x16x32_bf16 v[100:103], v[172:175], v[144:147], v[100:103]
    v_fma_f32 v92, -v22, v216, v92
    v_fma_f32 v93, -v22, v217, v93
    v_mfma_f32_16x16x32_bf16 v[116:119], v[172:175], v[148:151], v[116:119]
    v_fma_f32 v94, -v22, v218, v94
    v_mfma_f32_16x16x32_bf16 v[112:115], v[168:171], v[148:151], v[112:115]
    v_fma_f32 v95, -v22, v219, v95
    s_waitcnt vmcnt(8)
    v_mfma_f32_16x16x32_bf16 v[40:43], v[128:131], v[176:179], v[40:43]
    s_waitcnt lgkmcnt(0)
    v_fma_f32 v32, -v16, v152, v32
    v_fma_f32 v33, -v16, v153, v33
    v_mfma_f32_16x16x32_bf16 v[44:47], v[128:131], v[180:183], v[44:47]
    v_fma_f32 v34, -v16, v154, v34
    v_mfma_f32_16x16x32_bf16 v[60:63], v[132:135], v[180:183], v[60:63]
    ds_read_b64_tr_b16 v[128:129], v24 offset:4096
    v_fma_f32 v35, -v16, v155, v35
    v_fma_f32 v36, -v18, v152, v36
    v_mfma_f32_16x16x32_bf16 v[56:59], v[132:135], v[176:179], v[56:59]
    ds_read_b64_tr_b16 v[130:131], v24 offset:4608
    v_fma_f32 v37, -v18, v153, v37
    v_mfma_f32_16x16x32_bf16 v[72:75], v[136:139], v[176:179], v[72:75]
    ds_read_b64_tr_b16 v[132:133], v25 offset:4096
    v_fma_f32 v38, -v18, v154, v38
    v_fma_f32 v39, -v18, v155, v39
    v_mfma_f32_16x16x32_bf16 v[76:79], v[136:139], v[180:183], v[76:79]
    ds_read_b64_tr_b16 v[134:135], v25 offset:4608
    v_fma_f32 v48, -v16, v156, v48
    v_mfma_f32_16x16x32_bf16 v[92:95], v[140:143], v[180:183], v[92:95]
    ds_read_b64_tr_b16 v[136:137], v24 offset:12288
    v_fma_f32 v49, -v16, v157, v49
    v_fma_f32 v50, -v16, v158, v50
    v_mfma_f32_16x16x32_bf16 v[88:91], v[140:143], v[176:179], v[88:91]
    ds_read_b64_tr_b16 v[138:139], v24 offset:12800
    v_fma_f32 v51, -v16, v159, v51
    v_mfma_f32_16x16x32_bf16 v[104:107], v[176:179], v[144:147], v[104:107]
    ds_read_b64_tr_b16 v[140:141], v25 offset:12288
    v_fma_f32 v52, -v18, v156, v52
    v_fma_f32 v53, -v18, v157, v53
    v_mfma_f32_16x16x32_bf16 v[108:111], v[180:183], v[144:147], v[108:111]
    ds_read_b64_tr_b16 v[142:143], v25 offset:12800
    v_fma_f32 v54, -v18, v158, v54
    v_mfma_f32_16x16x32_bf16 v[124:127], v[180:183], v[148:151], v[124:127]
    ds_read_b64_tr_b16 v[144:145], v24 offset:20480
    v_fma_f32 v55, -v18, v159, v55
    v_mfma_f32_16x16x32_bf16 v[120:123], v[176:179], v[148:151], v[120:123]
    ds_read_b64_tr_b16 v[146:147], v24 offset:20992
    s_waitcnt vmcnt(6) lgkmcnt(6)
    v_mfma_f32_16x16x32_bf16 v[184:187], v[188:191], v[192:195], v[184:187]
    v_mfma_f32_16x16x32_bf16 v[32:35], v[128:131], a[0:3], v[32:35]
    ds_read_b64_tr_b16 v[148:149], v25 offset:20480
    v_fma_f32 v40, -v20, v152, v40
    v_fma_f32 v41, -v20, v153, v41
    v_mfma_f32_16x16x32_bf16 v[36:39], v[128:131], a[4:7], v[36:39]
    ds_read_b64_tr_b16 v[150:151], v25 offset:20992
    v_fma_f32 v42, -v20, v154, v42
    v_mfma_f32_16x16x32_bf16 v[52:55], v[132:135], a[4:7], v[52:55]
    v_fma_f32 v43, -v20, v155, v43
    v_fma_f32 v44, -v22, v152, v44
    ds_read_b128 v[168:171], v9 offset:1280
    v_mfma_f32_16x16x32_bf16 v[48:51], v[132:135], a[0:3], v[48:51]
    ds_read_b64_tr_b16 v[188:189], v28 offset:4096
    v_fma_f32 v45, -v22, v153, v45
    ds_read_b128 v[172:175], v9 offset:1344
    s_waitcnt lgkmcnt(7)
    v_mfma_f32_16x16x32_bf16 v[64:67], v[136:139], a[0:3], v[64:67]
    v_fma_f32 v46, -v22, v154, v46
    v_fma_f32 v47, -v22, v155, v47
    v_mfma_f32_16x16x32_bf16 v[68:71], v[136:139], a[4:7], v[68:71]
    ds_read_b64_tr_b16 v[190:191], v28 offset:4608
    v_fma_f32 v56, -v20, v156, v56
    ds_read_b128 v[176:179], v9 offset:1408
    v_mfma_f32_16x16x32_bf16 v[84:87], v[140:143], a[4:7], v[84:87]
    v_fma_f32 v57, -v20, v157, v57
    v_fma_f32 v58, -v20, v158, v58
    ds_read_b128 v[180:183], v9 offset:1472
    v_mfma_f32_16x16x32_bf16 v[80:83], v[140:143], a[0:3], v[80:83]
    ds_read_b128 v[192:195], v30 offset:2048
    v_fma_f32 v59, -v20, v159, v59
    s_waitcnt lgkmcnt(7)
    v_mfma_f32_16x16x32_bf16 v[96:99], a[0:3], v[144:147], v[96:99]
    v_fma_f32 v60, -v22, v156, v60
    v_fma_f32 v61, -v22, v157, v61
    ds_read2_b32 v[220:221], v11 offset0:64 offset1:80
    v_mfma_f32_16x16x32_bf16 v[100:103], a[4:7], v[144:147], v[100:103]
    v_fma_f32 v62, -v22, v158, v62
    v_mfma_f32_16x16x32_bf16 v[116:119], a[4:7], v[148:151], v[116:119]
    v_fma_f32 v63, -v22, v159, v63
    v_mfma_f32_16x16x32_bf16 v[112:115], a[0:3], v[148:151], v[112:115]
    s_waitcnt vmcnt(4)
    v_mfma_f32_16x16x32_bf16 v[40:43], v[128:131], a[8:11], v[40:43]
    v_mfma_f32_16x16x32_bf16 v[44:47], v[128:131], a[12:15], v[44:47]
    s_waitcnt lgkmcnt(0)
    v_fma_f32 v96, -v168, v220, v96
    v_fma_f32 v97, -v169, v220, v97
    v_mfma_f32_16x16x32_bf16 v[60:63], v[132:135], a[12:15], v[60:63]
    ds_read_b64_tr_b16 v[128:129], v24 offset:6144
    v_fma_f32 v98, -v170, v220, v98
    v_mfma_f32_16x16x32_bf16 v[56:59], v[132:135], a[8:11], v[56:59]
    ds_read_b64_tr_b16 v[130:131], v24 offset:6656
    v_fma_f32 v99, -v171, v220, v99
    v_fma_f32 v100, -v172, v220, v100
    v_mfma_f32_16x16x32_bf16 v[72:75], v[136:139], a[8:11], v[72:75]
    ds_read_b64_tr_b16 v[132:133], v25 offset:6144
    v_fma_f32 v101, -v173, v220, v101
    v_mfma_f32_16x16x32_bf16 v[76:79], v[136:139], a[12:15], v[76:79]
    ds_read_b64_tr_b16 v[134:135], v25 offset:6656
    v_fma_f32 v102, -v174, v220, v102
    v_fma_f32 v103, -v175, v220, v103
    v_mfma_f32_16x16x32_bf16 v[92:95], v[140:143], a[12:15], v[92:95]
    ds_read_b64_tr_b16 v[136:137], v24 offset:14336
    v_fma_f32 v112, -v168, v221, v112
    v_mfma_f32_16x16x32_bf16 v[88:91], v[140:143], a[8:11], v[88:91]
    ds_read_b64_tr_b16 v[138:139], v24 offset:14848
    v_fma_f32 v113, -v169, v221, v113
    v_fma_f32 v114, -v170, v221, v114
    v_mfma_f32_16x16x32_bf16 v[104:107], a[8:11], v[144:147], v[104:107]
    ds_read_b64_tr_b16 v[140:141], v25 offset:14336
    v_fma_f32 v115, -v171, v221, v115
    v_mfma_f32_16x16x32_bf16 v[108:111], a[12:15], v[144:147], v[108:111]
    ds_read_b64_tr_b16 v[142:143], v25 offset:14848
    v_fma_f32 v116, -v172, v221, v116
    v_fma_f32 v117, -v173, v221, v117
    v_mfma_f32_16x16x32_bf16 v[124:127], a[12:15], v[148:151], v[124:127]
    ds_read_b64_tr_b16 v[144:145], v24 offset:22528
    v_fma_f32 v118, -v174, v221, v118
    v_mfma_f32_16x16x32_bf16 v[120:123], a[8:11], v[148:151], v[120:123]
    ds_read_b64_tr_b16 v[146:147], v24 offset:23040
    v_fma_f32 v119, -v175, v221, v119
    s_waitcnt vmcnt(2) lgkmcnt(6)
    v_mfma_f32_16x16x32_bf16 v[184:187], v[188:191], v[192:195], v[184:187]
    v_mfma_f32_16x16x32_bf16 v[32:35], v[128:131], a[16:19], v[32:35]
    ds_read_b64_tr_b16 v[148:149], v25 offset:22528
    v_mfma_f32_16x16x32_bf16 v[36:39], v[128:131], a[20:23], v[36:39]
    ds_read_b64_tr_b16 v[150:151], v25 offset:23040
    v_fma_f32 v104, -v176, v220, v104
    v_fma_f32 v105, -v177, v220, v105
    v_mfma_f32_16x16x32_bf16 v[52:55], v[132:135], a[20:23], v[52:55]
    v_fma_f32 v106, -v178, v220, v106
    ds_read_b128 v[152:155], v9 offset:2816
    v_mfma_f32_16x16x32_bf16 v[48:51], v[132:135], a[16:19], v[48:51]
    ds_read_b64_tr_b16 v[188:189], v28 offset:6144
    v_fma_f32 v107, -v179, v220, v107
    v_fma_f32 v108, -v180, v220, v108
    ds_read_b128 v[156:159], v9 offset:2880
    s_waitcnt lgkmcnt(7)
    v_mfma_f32_16x16x32_bf16 v[64:67], v[136:139], a[16:19], v[64:67]
    v_fma_f32 v109, -v181, v220, v109
    ds_read_b128 v[160:163], v9 offset:2944
    v_mfma_f32_16x16x32_bf16 v[68:71], v[136:139], a[20:23], v[68:71]
    ds_read_b64_tr_b16 v[190:191], v28 offset:6656
    v_fma_f32 v110, -v182, v220, v110
    v_fma_f32 v111, -v183, v220, v111
    ds_read_b128 v[164:167], v9 offset:3008
    v_mfma_f32_16x16x32_bf16 v[84:87], v[140:143], a[20:23], v[84:87]
    v_fma_f32 v120, -v176, v221, v120
    ds_read_b128 v[212:215], v14 offset:128
    v_mfma_f32_16x16x32_bf16 v[80:83], v[140:143], a[16:19], v[80:83]
    ds_read_b128 v[192:195], v30 offset:3072
    v_fma_f32 v121, -v177, v221, v121
    v_fma_f32 v122, -v178, v221, v122
    ds_read_b32 v222, v11 offset:1216
    s_waitcnt lgkmcnt(9)
    v_mfma_f32_16x16x32_bf16 v[96:99], a[16:19], v[144:147], v[96:99]
    v_fma_f32 v123, -v179, v221, v123
    ds_read_b32 v223, v11 offset:2752
    v_mfma_f32_16x16x32_bf16 v[100:103], a[20:23], v[144:147], v[100:103]
    v_fma_f32 v124, -v180, v221, v124
    v_fma_f32 v125, -v181, v221, v125
    v_mfma_f32_16x16x32_bf16 v[116:119], a[20:23], v[148:151], v[116:119]
    v_fma_f32 v126, -v182, v221, v126
    s_waitcnt lgkmcnt(2)
    v_mfma_f32_16x16x32_bf16 v[112:115], a[16:19], v[148:151], v[112:115]
    v_fma_f32 v127, -v183, v221, v127
    s_barrier
    s_waitcnt vmcnt(0)
    v_mfma_f32_16x16x32_bf16 v[40:43], v[128:131], a[24:27], v[40:43]
    v_mul_f32 v64, v17, v64
    v_mul_f32 v65, v17, v65
    v_mfma_f32_16x16x32_bf16 v[44:47], v[128:131], a[28:31], v[44:47]
    v_mul_f32 v66, v17, v66
    v_mul_f32 v67, v17, v67
    v_mfma_f32_16x16x32_bf16 v[60:63], v[132:135], a[28:31], v[60:63]
    v_mul_f32 v80, v17, v80
    v_mul_f32 v81, v17, v81
    v_mfma_f32_16x16x32_bf16 v[56:59], v[132:135], a[24:27], v[56:59]
    v_mul_f32 v82, v17, v82
    v_mul_f32 v83, v17, v83
    v_mfma_f32_16x16x32_bf16 v[72:75], v[136:139], a[24:27], v[72:75]
    v_cvt_pk_bf16_f32 v64, v64, v65
    v_cvt_pk_bf16_f32 v65, v66, v67
    v_mfma_f32_16x16x32_bf16 v[76:79], v[136:139], a[28:31], v[76:79]
    v_cvt_pk_bf16_f32 v66, v80, v81
    v_cvt_pk_bf16_f32 v67, v82, v83
    v_mfma_f32_16x16x32_bf16 v[92:95], v[140:143], a[28:31], v[92:95]
    v_mul_f32 v68, v19, v68
    v_mul_f32 v69, v19, v69
    v_mfma_f32_16x16x32_bf16 v[88:91], v[140:143], a[24:27], v[88:91]
    v_mul_f32 v70, v19, v70
    v_mul_f32 v71, v19, v71
    v_mfma_f32_16x16x32_bf16 v[104:107], a[24:27], v[144:147], v[104:107]
    v_mul_f32 v84, v19, v84
    v_mul_f32 v85, v19, v85
    v_mfma_f32_16x16x32_bf16 v[108:111], a[28:31], v[144:147], v[108:111]
    v_mul_f32 v86, v19, v86
    v_mul_f32 v87, v19, v87
    v_mfma_f32_16x16x32_bf16 v[124:127], a[28:31], v[148:151], v[124:127]
    v_cvt_pk_bf16_f32 v68, v68, v69
    v_cvt_pk_bf16_f32 v69, v70, v71
    v_mfma_f32_16x16x32_bf16 v[120:123], a[24:27], v[148:151], v[120:123]
    v_cvt_pk_bf16_f32 v70, v84, v85
    v_cvt_pk_bf16_f32 v71, v86, v87
    v_mfma_f32_16x16x32_bf16 v[184:187], v[188:191], v[192:195], v[184:187]
    v_pk_mul_f32 v[72:73], v[20:21], v[72:73] op_sel:[1,0] op_sel_hi:[1,1]
    v_pk_mul_f32 v[74:75], v[20:21], v[74:75] op_sel:[1,0] op_sel_hi:[1,1]
    v_pk_mul_f32 v[88:89], v[20:21], v[88:89] op_sel:[1,0] op_sel_hi:[1,1]
    v_pk_mul_f32 v[90:91], v[20:21], v[90:91] op_sel:[1,0] op_sel_hi:[1,1]
    v_cvt_pk_bf16_f32 v72, v72, v73
    v_cvt_pk_bf16_f32 v73, v74, v75
    v_cvt_pk_bf16_f32 v74, v88, v89
    v_cvt_pk_bf16_f32 v75, v90, v91
    v_pk_mul_f32 v[76:77], v[22:23], v[76:77] op_sel:[1,0] op_sel_hi:[1,1]
    v_pk_mul_f32 v[78:79], v[22:23], v[78:79] op_sel:[1,0] op_sel_hi:[1,1]
    v_pk_mul_f32 v[92:93], v[22:23], v[92:93] op_sel:[1,0] op_sel_hi:[1,1]
    v_pk_mul_f32 v[94:95], v[22:23], v[94:95] op_sel:[1,0] op_sel_hi:[1,1]
    v_cvt_pk_bf16_f32 v76, v76, v77
    v_cvt_pk_bf16_f32 v77, v78, v79
    v_cvt_pk_bf16_f32 v78, v92, v93
    v_cvt_pk_bf16_f32 v79, v94, v95
    ds_write_b128 v12, v[76:79] offset:2048
    s_waitcnt lgkmcnt(1)
    v_pk_mul_f32 v[96:97], v[152:153], v[96:97]
    v_pk_mul_f32 v[98:99], v[154:155], v[98:99]
    v_pk_mul_f32 v[112:113], v[152:153], v[112:113]
    v_pk_mul_f32 v[114:115], v[154:155], v[114:115]
    v_cvt_pk_bf16_f32 v99, v98, v99
    v_cvt_pk_bf16_f32 v98, v96, v97
    v_cvt_pk_bf16_f32 v115, v114, v115
    v_cvt_pk_bf16_f32 v114, v112, v113
    v_pk_mul_f32 v[100:101], v[156:157], v[100:101]
    v_pk_mul_f32 v[102:103], v[158:159], v[102:103]
    v_pk_mul_f32 v[116:117], v[156:157], v[116:117]
    v_pk_mul_f32 v[118:119], v[158:159], v[118:119]
    v_cvt_pk_bf16_f32 v100, v100, v101
    v_cvt_pk_bf16_f32 v101, v102, v103
    v_cvt_pk_bf16_f32 v116, v116, v117
    v_cvt_pk_bf16_f32 v117, v118, v119
    v_pk_mul_f32 v[104:105], v[160:161], v[104:105]
    v_pk_mul_f32 v[106:107], v[162:163], v[106:107]
    v_pk_mul_f32 v[120:121], v[160:161], v[120:121]
    v_pk_mul_f32 v[122:123], v[162:163], v[122:123]
    v_cvt_pk_bf16_f32 v102, v104, v105
    v_cvt_pk_bf16_f32 v103, v106, v107
    v_cvt_pk_bf16_f32 v118, v120, v121
    v_cvt_pk_bf16_f32 v119, v122, v123
    v_pk_mul_f32 v[108:109], v[164:165], v[108:109]
    v_pk_mul_f32 v[110:111], v[166:167], v[110:111]
    v_pk_mul_f32 v[124:125], v[164:165], v[124:125]
    v_pk_mul_f32 v[126:127], v[166:167], v[126:127]
    v_cvt_pk_bf16_f32 v104, v108, v109
    v_cvt_pk_bf16_f32 v105, v110, v111
    v_cvt_pk_bf16_f32 v120, v124, v125
    v_cvt_pk_bf16_f32 v121, v126, v127
    ds_write_b64 v12, v[104:105] offset:3072
    ds_write_b64 v12, v[120:121] offset:3080
    v_pk_fma_f32 v[184:185], v[222:223], v[212:213], v[184:185] op_sel_hi:[0,1,1] neg_lo:[1,0,0] neg_hi:[1,0,0]
    v_pk_fma_f32 v[186:187], v[222:223], v[214:215], v[186:187] op_sel_hi:[0,1,1] neg_lo:[1,0,0] neg_hi:[1,0,0]
    v_pk_mul_f32 v[184:185], v[222:223], v[184:185] op_sel:[1,0] op_sel_hi:[1,1]
    v_pk_mul_f32 v[186:187], v[222:223], v[186:187] op_sel:[1,0] op_sel_hi:[1,1]
    v_cvt_pk_bf16_f32 v184, v184, v185
    v_cvt_pk_bf16_f32 v185, v186, v187
    s_cmp_ge_u32 s8, 2
    s_cbranch_scc1 c_qkvA_hv
    ds_write_b64 v13, v[184:185]
    s_branch c_qkvA_hd
c_qkvA_hv:
    ds_write_b16 v13, v184 offset:0
    ds_write_b16_d16_hi v13, v184 offset:16
    ds_write_b16 v13, v185 offset:32
    ds_write_b16_d16_hi v13, v185 offset:48
c_qkvA_hd:
    v_cvt_pk_bf16_f32 v44, v44, v45
    v_cvt_pk_bf16_f32 v45, v46, v47
    v_cvt_pk_bf16_f32 v46, v60, v61
    v_cvt_pk_bf16_f32 v47, v62, v63
    v_mul_f32 v23, 0x3e8293ee, v23
    v_cvt_pk_bf16_f32 v40, v40, v41
    v_mfma_f32_16x16x32_bf16 v[156:159], v[76:79], v[44:47], v[196:199]
    v_cvt_pk_bf16_f32 v41, v42, v43
    v_cvt_pk_bf16_f32 v42, v56, v57
    v_mfma_f32_16x16x32_bf16 v[152:155], v[72:75], v[44:47], v[200:203]
    v_cvt_pk_bf16_f32 v43, v58, v59
    v_mul_f32 v21, 0x3e8293ee, v21
    s_waitcnt lgkmcnt(0)
    s_barrier
    ds_read_b128 v[172:175], v12
    ds_read_b64 v[96:97], v12 offset:1024
    ds_read_b64 v[112:113], v12 offset:1032
    v_mfma_f32_16x16x32_bf16 v[148:151], v[72:75], v[40:43], v[196:199]
    v_cvt_pk_bf16_f32 v36, v36, v37
    v_cvt_pk_bf16_f32 v37, v38, v39
    v_mfma_f32_16x16x32_bf16 v[144:147], v[68:71], v[40:43], v[200:203]
    v_cvt_pk_bf16_f32 v38, v52, v53
    v_cvt_pk_bf16_f32 v39, v54, v55
    v_mul_f32 v19, 0x3e8293ee, v19
    v_cvt_pk_bf16_f32 v32, v32, v33
    v_mfma_f32_16x16x32_bf16 v[140:143], v[68:71], v[36:39], v[196:199]
    v_cvt_pk_bf16_f32 v33, v34, v35
    v_cvt_pk_bf16_f32 v34, v48, v49
    v_mfma_f32_16x16x32_bf16 v[136:139], v[64:67], v[36:39], v[200:203]
    v_cvt_pk_bf16_f32 v35, v50, v51
    v_mul_f32 v17, 0x3e8293ee, v17
    v_max3_f32 v179, v152, v153, v154
    s_waitcnt lgkmcnt(2)
    v_mfma_f32_16x16x32_bf16 v[132:135], v[64:67], v[32:35], v[196:199]
    v_max3_f32 v179, v179, v155, v156
    v_max3_f32 v179, v179, v157, v158
    v_mfma_f32_16x16x32_bf16 v[128:131], v[172:175], v[32:35], v[204:207]
    v_max_f32 v179, v179, v159
    v_mov_b32 v183, v179
    v_max3_f32 v178, v144, v145, v146
    v_max3_f32 v178, v178, v147, v148
    v_max3_f32 v178, v178, v149, v150
    v_max_f32 v178, v178, v151
    v_mov_b32 v182, v178
    v_max3_f32 v177, v136, v137, v138
    v_max3_f32 v177, v177, v139, v140
    v_max3_f32 v177, v177, v141, v142
    v_max_f32 v177, v177, v143
    v_mov_b32 v181, v177
    v_permlane32_swap_b32 v179, v183
    v_permlane32_swap_b32 v178, v182
    v_permlane32_swap_b32 v177, v181
    v_max3_f32 v176, v128, v129, v130
    v_max3_f32 v176, v176, v131, v132
    v_max3_f32 v176, v176, v133, v134
    v_max_f32 v176, v176, v135
    v_mov_b32 v180, v176
    v_max_f32 v179, v179, v183
    v_max_f32 v178, v178, v182
    v_max_f32 v177, v177, v181
    v_permlane32_swap_b32 v176, v180
    v_mov_b32 v183, v179
    v_mov_b32 v182, v178
    v_mov_b32 v181, v177
    v_max_f32 v176, v176, v180
    v_mov_b32 v180, v176
    v_permlane16_swap_b32 v179, v183
    v_permlane16_swap_b32 v178, v182
    v_permlane16_swap_b32 v177, v181
    v_permlane16_swap_b32 v176, v180
    v_max_f32 v179, v179, v183
    v_max_f32 v178, v178, v182
    v_max_f32 v177, v177, v181
    v_max_f32 v176, v176, v180
    v_mul_f32_e64 v22, -v179, v23
    v_mul_f32_e64 v20, -v178, v21
    v_mul_f32_e64 v18, -v177, v19
    v_mul_f32_e64 v16, -v176, v17
    s_waitcnt lgkmcnt(0)
    s_add_u32 s51, s49, 65536
    v_pk_fma_f32 v[152:153], v[152:153], v[22:23], v[22:23] op_sel:[0,1,0] op_sel_hi:[1,1,0]
    v_pk_fma_f32 v[154:155], v[154:155], v[22:23], v[22:23] op_sel:[0,1,0] op_sel_hi:[1,1,0]
    v_pk_fma_f32 v[156:157], v[156:157], v[22:23], v[22:23] op_sel:[0,1,0] op_sel_hi:[1,1,0]
    v_pk_fma_f32 v[158:159], v[158:159], v[22:23], v[22:23] op_sel:[0,1,0] op_sel_hi:[1,1,0]
    v_pk_fma_f32 v[144:145], v[144:145], v[20:21], v[20:21] op_sel:[0,1,0] op_sel_hi:[1,1,0]
    v_pk_fma_f32 v[146:147], v[146:147], v[20:21], v[20:21] op_sel:[0,1,0] op_sel_hi:[1,1,0]
    v_pk_fma_f32 v[148:149], v[148:149], v[20:21], v[20:21] op_sel:[0,1,0] op_sel_hi:[1,1,0]
    v_pk_fma_f32 v[150:151], v[150:151], v[20:21], v[20:21] op_sel:[0,1,0] op_sel_hi:[1,1,0]
    v_pk_fma_f32 v[136:137], v[136:137], v[18:19], v[18:19] op_sel:[0,1,0] op_sel_hi:[1,1,0]
    v_pk_fma_f32 v[138:139], v[138:139], v[18:19], v[18:19] op_sel:[0,1,0] op_sel_hi:[1,1,0]
    v_pk_fma_f32 v[140:141], v[140:141], v[18:19], v[18:19] op_sel:[0,1,0] op_sel_hi:[1,1,0]
    v_pk_fma_f32 v[142:143], v[142:143], v[18:19], v[18:19] op_sel:[0,1,0] op_sel_hi:[1,1,0]
    v_pk_fma_f32 v[128:129], v[128:129], v[16:17], v[16:17] op_sel:[0,1,0] op_sel_hi:[1,1,0]
    v_pk_fma_f32 v[130:131], v[130:131], v[16:17], v[16:17] op_sel:[0,1,0] op_sel_hi:[1,1,0]
    v_pk_fma_f32 v[132:133], v[132:133], v[16:17], v[16:17] op_sel:[0,1,0] op_sel_hi:[1,1,0]
    v_pk_fma_f32 v[134:135], v[134:135], v[16:17], v[16:17] op_sel:[0,1,0] op_sel_hi:[1,1,0]
    v_exp_f32 v152, v152
    v_exp_f32 v153, v153
    v_exp_f32 v154, v154
    v_exp_f32 v155, v155
    v_exp_f32 v156, v156
    v_exp_f32 v157, v157
    v_exp_f32 v158, v158
    v_exp_f32 v159, v159
    v_cvt_pk_bf16_f32 v172, v152, v153
    v_cvt_pk_bf16_f32 v173, v154, v155
    v_cvt_pk_bf16_f32 v174, v156, v157
    v_cvt_pk_bf16_f32 v175, v158, v159
    v_exp_f32 v144, v144
    v_exp_f32 v145, v145
    v_mfma_f32_16x16x32_bf16 v[92:95], v[208:211], v[172:175], 0
    v_exp_f32 v146, v146
    v_mfma_f32_16x16x32_bf16 v[60:63], v[102:105], v[172:175], 0
    v_exp_f32 v147, v147
    v_mfma_f32_16x16x32_bf16 v[76:79], v[118:121], v[172:175], 0
    v_exp_f32 v148, v148
    v_exp_f32 v149, v149
    v_exp_f32 v150, v150
    v_exp_f32 v151, v151
    v_rcp_f32 v92, v92
    v_cvt_pk_bf16_f32 v168, v144, v145
    v_cvt_pk_bf16_f32 v169, v146, v147
    v_cvt_pk_bf16_f32 v170, v148, v149
    v_cvt_pk_bf16_f32 v171, v150, v151
    v_pk_mul_f32 v[60:61], v[92:93], v[60:61] op_sel_hi:[0,1]
    v_pk_mul_f32 v[62:63], v[92:93], v[62:63] op_sel_hi:[0,1]
    v_pk_mul_f32 v[76:77], v[92:93], v[76:77] op_sel_hi:[0,1]
    v_pk_mul_f32 v[78:79], v[92:93], v[78:79] op_sel_hi:[0,1]
    v_cvt_pk_bf16_f32 v60, v60, v61
    v_cvt_pk_bf16_f32 v61, v62, v63
    v_cvt_pk_bf16_f32 v62, v76, v77
    v_cvt_pk_bf16_f32 v63, v78, v79
    buffer_store_dwordx4 v[60:63], v6, s[12:15], s51 offen offset:256 sc1
    v_exp_f32 v136, v136
    v_exp_f32 v137, v137
    v_mfma_f32_16x16x32_bf16 v[88:91], v[208:211], v[168:171], 0
    v_exp_f32 v138, v138
    v_mfma_f32_16x16x32_bf16 v[56:59], v[100:103], v[168:171], 0
    v_exp_f32 v139, v139
    v_mfma_f32_16x16x32_bf16 v[72:75], v[116:119], v[168:171], 0
    v_exp_f32 v140, v140
    v_exp_f32 v141, v141
    v_exp_f32 v142, v142
    v_exp_f32 v143, v143
    v_rcp_f32 v88, v88
    v_cvt_pk_bf16_f32 v164, v136, v137
    v_cvt_pk_bf16_f32 v165, v138, v139
    v_cvt_pk_bf16_f32 v166, v140, v141
    v_cvt_pk_bf16_f32 v167, v142, v143
    v_pk_mul_f32 v[56:57], v[88:89], v[56:57] op_sel_hi:[0,1]
    v_pk_mul_f32 v[58:59], v[88:89], v[58:59] op_sel_hi:[0,1]
    v_pk_mul_f32 v[72:73], v[88:89], v[72:73] op_sel_hi:[0,1]
    v_pk_mul_f32 v[74:75], v[88:89], v[74:75] op_sel_hi:[0,1]
    v_cvt_pk_bf16_f32 v56, v56, v57
    v_cvt_pk_bf16_f32 v57, v58, v59
    v_cvt_pk_bf16_f32 v58, v72, v73
    v_cvt_pk_bf16_f32 v59, v74, v75
    buffer_store_dwordx4 v[56:59], v6, s[12:15], s51 offen offset:0 sc1
    v_exp_f32 v128, v128
    v_exp_f32 v129, v129
    v_mfma_f32_16x16x32_bf16 v[84:87], v[208:211], v[164:167], 0
    v_exp_f32 v130, v130
    v_mfma_f32_16x16x32_bf16 v[52:55], v[98:101], v[164:167], 0
    v_exp_f32 v131, v131
    v_mfma_f32_16x16x32_bf16 v[68:71], v[114:117], v[164:167], 0
    v_exp_f32 v132, v132
    v_exp_f32 v133, v133
    v_exp_f32 v134, v134
    v_exp_f32 v135, v135
    v_rcp_f32 v84, v84
    v_cvt_pk_bf16_f32 v160, v128, v129
    v_cvt_pk_bf16_f32 v161, v130, v131
    v_cvt_pk_bf16_f32 v162, v132, v133
    v_cvt_pk_bf16_f32 v163, v134, v135
    v_pk_mul_f32 v[52:53], v[84:85], v[52:53] op_sel_hi:[0,1]
    v_pk_mul_f32 v[54:55], v[84:85], v[54:55] op_sel_hi:[0,1]
    v_mfma_f32_16x16x32_bf16 v[80:83], v[208:211], v[160:163], 0
    v_pk_mul_f32 v[68:69], v[84:85], v[68:69] op_sel_hi:[0,1]
    v_pk_mul_f32 v[70:71], v[84:85], v[70:71] op_sel_hi:[0,1]
    v_mfma_f32_16x16x32_bf16 v[48:51], v[96:99], v[160:163], 0
    v_cvt_pk_bf16_f32 v52, v52, v53
    v_cvt_pk_bf16_f32 v53, v54, v55
    v_mfma_f32_16x16x32_bf16 v[64:67], v[112:115], v[160:163], 0
    v_cvt_pk_bf16_f32 v54, v68, v69
    v_cvt_pk_bf16_f32 v55, v70, v71
    buffer_store_dwordx4 v[52:55], v6, s[12:15], s49 offen offset:256 sc1
    v_rcp_f32 v80, v80
    s_nop 0
    v_pk_mul_f32 v[48:49], v[80:81], v[48:49] op_sel_hi:[0,1]
    v_pk_mul_f32 v[50:51], v[80:81], v[50:51] op_sel_hi:[0,1]
    s_nop 0
    v_pk_mul_f32 v[64:65], v[80:81], v[64:65] op_sel_hi:[0,1]
    v_pk_mul_f32 v[66:67], v[80:81], v[66:67] op_sel_hi:[0,1]
    v_cvt_pk_bf16_f32 v48, v48, v49
    v_cvt_pk_bf16_f32 v49, v50, v51
    v_cvt_pk_bf16_f32 v50, v64, v65
    v_cvt_pk_bf16_f32 v51, v66, v67
    buffer_store_dwordx4 v[48:51], v6, s[12:15], s49 offen offset:0 sc1
    s_branch c_wo
.p2align 6
c_wo:
    v_and_b32 v1, 63, v0
    v_lshrrev_b32 v2, 6, v0
    v_lshlrev_b32 v5, 4, v1
    v_lshrrev_b32 v3, 5, v1
    s_lshl_b32 s48, s6, 2
    s_add_u32 s48, s48, s8
    s_lshl_b32 s55, s48, 16
    s_lshl_b32 s56, s9, 22
    s_add_u32 s55, s55, s56
    s_lshl_b32 s56, s7, 12
    s_add_u32 s58, s55, s56
    s_add_u32 s55, s55, 16777216
    s_add_u32 s16, s4, s55
    s_addc_u32 s17, s5, 0
    s_mov_b32 s18, 65536
    s_mov_b32 s19, 0x00020000
    s_lshl_b32 s60, s9, 2
    s_add_u32 s60, s60, 159504
    v_mov_b32 v28, s60
    s_mul_i32 s55, s9, 786432
    s_add_u32 s55, s55, 65798144
    v_and_b32 v24, 63, v0
    s_and_b32 s56, s11, 0xe0
    v_lshrrev_b32 v25, 5, v24
    v_add_u32 v24, s56, v24
    v_and_b32 v24, 255, v24
    v_lshlrev_b32 v24, 10, v24
    v_lshl_add_u32 v24, v25, 8, v24
    s_bfe_u32 s56, s11, 0x20003
    s_and_b32 s57, s11, 7
    s_lshl_b32 s56, s56, 7
    s_lshl_b32 s57, s57, 2
    s_add_u32 s55, s55, s56
    s_add_u32 s55, s55, s57
    v_mov_b32 v25, 159488
    v_mov_b32 v26, 1
    v_mov_b32 v27, s10
    v_and_b32 v4, 15, v0
    v_bfe_u32 v17, v1, 4, 1
    v_lshl_add_u32 v6, v17, 5, v4
    v_lshlrev_b32 v6, 4, v6
    v_lshl_add_u32 v6, v3, 10, v6
    v_lshrrev_b32 v16, 2, v4
    v_lshl_add_u32 v16, v17, 2, v16
    v_lshl_add_u32 v16, v3, 4, v16
    v_lshlrev_b32 v16, 7, v16
    v_and_b32 v18, 3, v4
    v_lshl_add_u32 v16, v18, 3, v16
    v_lshrrev_b32 v18, 3, v4
    v_lshl_add_u32 v18, v18, 1, v17
    v_lshl_add_u32 v12, v18, 5, v16
    ds_read_b32 v29, v28
    buffer_load_dwordx4 v[96:99], v6, s[12:15], s58 offen offset:0 sc1
    buffer_load_dwordx4 v[100:103], v6, s[12:15], s58 offen offset:256 sc1
    buffer_load_dwordx4 v[104:107], v6, s[12:15], s58 offen offset:2048 sc1
    buffer_load_dwordx4 v[108:111], v6, s[12:15], s58 offen offset:2304 sc1
    s_waitcnt lgkmcnt(0)
    v_readfirstlane_b32 s60, v29
    s_lshr_b32 s51, s60, 2
    s_and_b32 s51, s51, s60
    s_and_b32 s51, s51, 3
    s_cmp_eq_u32 s51, 0
    s_cbranch_scc1 c_wo_late
    s_and_b32 s52, s51, 1
    s_xor_b32 s52, s52, 1
    s_lshl_b32 s50, s52, 15
    buffer_load_dwordx4 v[112:115], v6, s[16:19], s50 offen offset:0 sc1
    buffer_load_dwordx4 v[116:119], v6, s[16:19], s50 offen offset:256 sc1
    buffer_load_dwordx4 v[120:123], v6, s[16:19], s50 offen offset:2048 sc1
    buffer_load_dwordx4 v[124:127], v6, s[16:19], s50 offen offset:2304 sc1
    s_add_u32 s50, s50, 4096
    buffer_load_dwordx4 v[128:131], v6, s[16:19], s50 offen offset:0 sc1
    s_mov_b64 exec, 1
    s_waitcnt vmcnt(9)
    ds_add_rtn_u32 v26, v25, v26
    s_waitcnt lgkmcnt(0)
    v_readfirstlane_b32 s56, v26
    s_and_b32 s56, s56, 3
    s_cmp_lg_u32 s56, 3
    s_cbranch_scc1 pub_2
    s_mov_b32 exec_lo, -1
    buffer_store_dword v27, v24, s[12:15], s55 offen sc1
pub_2:
    s_mov_b64 exec, -1
    s_branch c_wo_run
c_wo_late:
    s_mov_b64 exec, 1
    s_waitcnt vmcnt(4)
    ds_add_rtn_u32 v26, v25, v26
    s_waitcnt lgkmcnt(0)
    v_readfirstlane_b32 s56, v26
    s_and_b32 s56, s56, 3
    s_cmp_lg_u32 s56, 3
    s_cbranch_scc1 pub_3
    s_mov_b32 exec_lo, -1
    buffer_store_dword v27, v24, s[12:15], s55 offen sc1
pub_3:
    s_mov_b64 exec, -1
    s_branch wp_4_t
wp_4:
    ds_read_b32 v29, v28
    s_waitcnt lgkmcnt(0)
    v_readfirstlane_b32 s60, v29
    s_lshr_b32 s51, s60, 2
    s_and_b32 s51, s51, s60
    s_and_b32 s51, s51, 3
wp_4_t:
    s_cmp_lg_u32 s51, 0
    s_cbranch_scc0 wp_4
    s_and_b32 s52, s51, 1
    s_xor_b32 s52, s52, 1
    s_lshl_b32 s50, s52, 15
    buffer_load_dwordx4 v[112:115], v6, s[16:19], s50 offen offset:0 sc1
    buffer_load_dwordx4 v[116:119], v6, s[16:19], s50 offen offset:256 sc1
    buffer_load_dwordx4 v[120:123], v6, s[16:19], s50 offen offset:2048 sc1
    buffer_load_dwordx4 v[124:127], v6, s[16:19], s50 offen offset:2304 sc1
    s_add_u32 s50, s50, 4096
    buffer_load_dwordx4 v[128:131], v6, s[16:19], s50 offen offset:0 sc1
c_wo_run:
    buffer_load_dwordx4 v[132:135], v6, s[16:19], s50 offen offset:256 sc1
    buffer_load_dwordx4 v[136:139], v6, s[16:19], s50 offen offset:2048 sc1
    buffer_load_dwordx4 v[140:143], v6, s[16:19], s50 offen offset:2304 sc1
    s_add_u32 s50, s50, 4096
    s_lshl_b32 s3, s52, 16
    v_add_u32 v12, s3, v12
    v_xor_b32 v13, 32, v12
    v_xor_b32 v14, 64, v12
    v_xor_b32 v15, 96, v12
    s_cmp_eq_u32 s52, 0
    s_mov_b32 s3, 0x0c0c0c0c
    s_cselect_b32 s53, 0x01000c0c, s3
    s_cselect_b32 s54, 0x03020c0c, s3
    s_cselect_b32 s59, s3, 0x01000c0c
    s_cselect_b32 s97, s3, 0x03020c0c
    s_branch wp_5_t
wp_5:
    ds_read_b32 v29, v28
    s_waitcnt lgkmcnt(0)
    v_readfirstlane_b32 s60, v29
    s_lshr_b32 s51, s60, 2
    s_and_b32 s51, s51, s60
    s_and_b32 s51, s51, 3
wp_5_t:
    s_cmp_ge_u32 s60, 0xf0
    s_cbranch_scc0 wp_5
    ds_read_b64_tr_b16 v[64:65], v12 offset:0
    ds_read_b64_tr_b16 v[66:67], v12 offset:1024
    ds_read_b64_tr_b16 v[68:69], v13 offset:0
    ds_read_b64_tr_b16 v[70:71], v13 offset:1024
    ds_read_b64_tr_b16 v[72:73], v14 offset:0
    ds_read_b64_tr_b16 v[74:75], v14 offset:1024
    ds_read_b64_tr_b16 v[76:77], v15 offset:0
    ds_read_b64_tr_b16 v[78:79], v15 offset:1024
    ds_read_b64_tr_b16 v[80:81], v12 offset:4096
    ds_read_b64_tr_b16 v[82:83], v12 offset:5120
    ds_read_b64_tr_b16 v[84:85], v13 offset:4096
    ds_read_b64_tr_b16 v[86:87], v13 offset:5120
    ds_read_b64_tr_b16 v[88:89], v14 offset:4096
    ds_read_b64_tr_b16 v[90:91], v14 offset:5120
    s_waitcnt vmcnt(8)
    v_perm_b32 v32, v96, v96, s53
    v_perm_b32 v33, v96, v96, s54
    v_perm_b32 v34, v97, v97, s53
    v_perm_b32 v35, v97, v97, s54
    v_perm_b32 v36, v98, v98, s53
    v_perm_b32 v37, v98, v98, s54
    v_perm_b32 v38, v99, v99, s53
    v_perm_b32 v39, v99, v99, s54
    v_perm_b32 v40, v100, v100, s53
    v_perm_b32 v41, v100, v100, s54
    v_perm_b32 v42, v101, v101, s53
    v_perm_b32 v43, v101, v101, s54
    v_perm_b32 v44, v102, v102, s53
    v_perm_b32 v45, v102, v102, s54
    v_perm_b32 v46, v103, v103, s53
    v_perm_b32 v47, v103, v103, s54
    v_perm_b32 v48, v104, v104, s53
    v_perm_b32 v49, v104, v104, s54
    v_perm_b32 v50, v105, v105, s53
    v_perm_b32 v51, v105, v105, s54
    v_perm_b32 v52, v106, v106, s53
    v_perm_b32 v53, v106, v106, s54
    v_perm_b32 v54, v107, v107, s53
    v_perm_b32 v55, v107, v107, s54
    v_perm_b32 v56, v108, v108, s53
    v_perm_b32 v57, v108, v108, s54
    v_perm_b32 v58, v109, v109, s53
    v_perm_b32 v59, v109, v109, s54
    v_perm_b32 v60, v110, v110, s53
    v_perm_b32 v61, v110, v110, s54
    v_perm_b32 v62, v111, v111, s53
    v_perm_b32 v63, v111, v111, s54
    buffer_load_dwordx4 v[144:147], v6, s[16:19], s50 offen offset:0 sc1
    buffer_load_dwordx4 v[148:151], v6, s[16:19], s50 offen offset:256 sc1
    buffer_load_dwordx4 v[152:155], v6, s[16:19], s50 offen offset:2048 sc1
    buffer_load_dwordx4 v[156:159], v6, s[16:19], s50 offen offset:2304 sc1
    s_add_u32 s50, s50, 4096
    buffer_load_dwordx4 v[160:163], v6, s[16:19], s50 offen offset:0 sc1
    buffer_load_dwordx4 v[164:167], v6, s[16:19], s50 offen offset:256 sc1
    s_waitcnt vmcnt(12) lgkmcnt(10)
    v_mfma_f32_16x16x32_bf16 v[32:35], v[64:67], v[112:115], v[32:35]
    ds_read_b64_tr_b16 v[92:93], v15 offset:4096
    v_mfma_f32_16x16x32_bf16 v[40:43], v[64:67], v[116:119], v[40:43]
    ds_read_b64_tr_b16 v[94:95], v15 offset:5120
    v_perm_b32 v176, v96, v96, s59
    v_mfma_f32_16x16x32_bf16 v[44:47], v[68:71], v[116:119], v[44:47]
    ds_read_b64_tr_b16 v[64:65], v12 offset:8192
    buffer_load_dwordx4 v[168:171], v6, s[16:19], s50 offen offset:2048 sc1
    v_mfma_f32_16x16x32_bf16 v[36:39], v[68:71], v[112:115], v[36:39]
    ds_read_b64_tr_b16 v[66:67], v12 offset:9216
    v_perm_b32 v177, v96, v96, s97
    s_waitcnt lgkmcnt(10)
    v_mfma_f32_16x16x32_bf16 v[48:51], v[72:75], v[112:115], v[48:51]
    ds_read_b64_tr_b16 v[68:69], v13 offset:8192
    v_mfma_f32_16x16x32_bf16 v[56:59], v[72:75], v[116:119], v[56:59]
    ds_read_b64_tr_b16 v[70:71], v13 offset:9216
    v_perm_b32 v178, v97, v97, s59
    v_mfma_f32_16x16x32_bf16 v[60:63], v[76:79], v[116:119], v[60:63]
    ds_read_b64_tr_b16 v[72:73], v14 offset:8192
    buffer_load_dwordx4 v[172:175], v6, s[16:19], s50 offen offset:2304 sc1
    s_add_u32 s50, s50, 4096
    v_mfma_f32_16x16x32_bf16 v[52:55], v[76:79], v[112:115], v[52:55]
    ds_read_b64_tr_b16 v[74:75], v14 offset:9216
    s_waitcnt vmcnt(12) lgkmcnt(10)
    v_mfma_f32_16x16x32_bf16 v[32:35], v[80:83], v[120:123], v[32:35]
    ds_read_b64_tr_b16 v[76:77], v15 offset:8192
    v_mfma_f32_16x16x32_bf16 v[40:43], v[80:83], v[124:127], v[40:43]
    ds_read_b64_tr_b16 v[78:79], v15 offset:9216
    v_perm_b32 v179, v97, v97, s97
    v_mfma_f32_16x16x32_bf16 v[44:47], v[84:87], v[124:127], v[44:47]
    ds_read_b64_tr_b16 v[80:81], v12 offset:12288
    buffer_load_dwordx4 v[112:115], v6, s[16:19], s50 offen offset:0 sc1
    v_mfma_f32_16x16x32_bf16 v[36:39], v[84:87], v[120:123], v[36:39]
    ds_read_b64_tr_b16 v[82:83], v12 offset:13312
    v_perm_b32 v180, v98, v98, s59
    s_waitcnt lgkmcnt(10)
    v_mfma_f32_16x16x32_bf16 v[48:51], v[88:91], v[120:123], v[48:51]
    ds_read_b64_tr_b16 v[84:85], v13 offset:12288
    v_mfma_f32_16x16x32_bf16 v[56:59], v[88:91], v[124:127], v[56:59]
    ds_read_b64_tr_b16 v[86:87], v13 offset:13312
    v_perm_b32 v181, v98, v98, s97
    v_mfma_f32_16x16x32_bf16 v[60:63], v[92:95], v[124:127], v[60:63]
    ds_read_b64_tr_b16 v[88:89], v14 offset:12288
    buffer_load_dwordx4 v[116:119], v6, s[16:19], s50 offen offset:256 sc1
    v_mfma_f32_16x16x32_bf16 v[52:55], v[92:95], v[120:123], v[52:55]
    ds_read_b64_tr_b16 v[90:91], v14 offset:13312
    s_waitcnt vmcnt(12) lgkmcnt(10)
    v_mfma_f32_16x16x32_bf16 v[32:35], v[64:67], v[128:131], v[32:35]
    ds_read_b64_tr_b16 v[92:93], v15 offset:12288
    v_mfma_f32_16x16x32_bf16 v[40:43], v[64:67], v[132:135], v[40:43]
    ds_read_b64_tr_b16 v[94:95], v15 offset:13312
    v_perm_b32 v182, v99, v99, s59
    v_mfma_f32_16x16x32_bf16 v[44:47], v[68:71], v[132:135], v[44:47]
    ds_read_b64_tr_b16 v[64:65], v12 offset:16384
    buffer_load_dwordx4 v[120:123], v6, s[16:19], s50 offen offset:2048 sc1
    v_mfma_f32_16x16x32_bf16 v[36:39], v[68:71], v[128:131], v[36:39]
    ds_read_b64_tr_b16 v[66:67], v12 offset:17408
    v_perm_b32 v183, v99, v99, s97
    s_waitcnt lgkmcnt(10)
    v_mfma_f32_16x16x32_bf16 v[48:51], v[72:75], v[128:131], v[48:51]
    ds_read_b64_tr_b16 v[68:69], v13 offset:16384
    v_mfma_f32_16x16x32_bf16 v[56:59], v[72:75], v[132:135], v[56:59]
    ds_read_b64_tr_b16 v[70:71], v13 offset:17408
    v_perm_b32 v184, v100, v100, s59
    v_mfma_f32_16x16x32_bf16 v[60:63], v[76:79], v[132:135], v[60:63]
    ds_read_b64_tr_b16 v[72:73], v14 offset:16384
    buffer_load_dwordx4 v[124:127], v6, s[16:19], s50 offen offset:2304 sc1
    s_add_u32 s50, s50, 4096
    v_mfma_f32_16x16x32_bf16 v[52:55], v[76:79], v[128:131], v[52:55]
    ds_read_b64_tr_b16 v[74:75], v14 offset:17408
    s_waitcnt vmcnt(12) lgkmcnt(10)
    v_mfma_f32_16x16x32_bf16 v[32:35], v[80:83], v[136:139], v[32:35]
    ds_read_b64_tr_b16 v[76:77], v15 offset:16384
    v_mfma_f32_16x16x32_bf16 v[40:43], v[80:83], v[140:143], v[40:43]
    ds_read_b64_tr_b16 v[78:79], v15 offset:17408
    v_perm_b32 v185, v100, v100, s97
    v_mfma_f32_16x16x32_bf16 v[44:47], v[84:87], v[140:143], v[44:47]
    ds_read_b64_tr_b16 v[80:81], v12 offset:20480
    buffer_load_dwordx4 v[128:131], v6, s[16:19], s50 offen offset:0 sc1
    v_mfma_f32_16x16x32_bf16 v[36:39], v[84:87], v[136:139], v[36:39]
    ds_read_b64_tr_b16 v[82:83], v12 offset:21504
    v_perm_b32 v186, v101, v101, s59
    s_waitcnt lgkmcnt(10)
    v_mfma_f32_16x16x32_bf16 v[48:51], v[88:91], v[136:139], v[48:51]
    ds_read_b64_tr_b16 v[84:85], v13 offset:20480
    v_mfma_f32_16x16x32_bf16 v[56:59], v[88:91], v[140:143], v[56:59]
    ds_read_b64_tr_b16 v[86:87], v13 offset:21504
    v_perm_b32 v187, v101, v101, s97
    v_mfma_f32_16x16x32_bf16 v[60:63], v[92:95], v[140:143], v[60:63]
    ds_read_b64_tr_b16 v[88:89], v14 offset:20480
    buffer_load_dwordx4 v[132:135], v6, s[16:19], s50 offen offset:256 sc1
    v_mfma_f32_16x16x32_bf16 v[52:55], v[92:95], v[136:139], v[52:55]
    ds_read_b64_tr_b16 v[90:91], v14 offset:21504
    s_waitcnt vmcnt(12) lgkmcnt(10)
    v_mfma_f32_16x16x32_bf16 v[32:35], v[64:67], v[144:147], v[32:35]
    ds_read_b64_tr_b16 v[92:93], v15 offset:20480
    v_mfma_f32_16x16x32_bf16 v[40:43], v[64:67], v[148:151], v[40:43]
    ds_read_b64_tr_b16 v[94:95], v15 offset:21504
    v_perm_b32 v188, v102, v102, s59
    v_mfma_f32_16x16x32_bf16 v[44:47], v[68:71], v[148:151], v[44:47]
    ds_read_b64_tr_b16 v[64:65], v12 offset:24576
    buffer_load_dwordx4 v[136:139], v6, s[16:19], s50 offen offset:2048 sc1
    v_mfma_f32_16x16x32_bf16 v[36:39], v[68:71], v[144:147], v[36:39]
    ds_read_b64_tr_b16 v[66:67], v12 offset:25600
    v_perm_b32 v189, v102, v102, s97
    s_waitcnt lgkmcnt(10)
    v_mfma_f32_16x16x32_bf16 v[48:51], v[72:75], v[144:147], v[48:51]
    ds_read_b64_tr_b16 v[68:69], v13 offset:24576
    v_mfma_f32_16x16x32_bf16 v[56:59], v[72:75], v[148:151], v[56:59]
    ds_read_b64_tr_b16 v[70:71], v13 offset:25600
    v_perm_b32 v190, v103, v103, s59
    v_mfma_f32_16x16x32_bf16 v[60:63], v[76:79], v[148:151], v[60:63]
    ds_read_b64_tr_b16 v[72:73], v14 offset:24576
    buffer_load_dwordx4 v[140:143], v6, s[16:19], s50 offen offset:2304 sc1
    s_add_u32 s50, s50, 4096
    v_mfma_f32_16x16x32_bf16 v[52:55], v[76:79], v[144:147], v[52:55]
    ds_read_b64_tr_b16 v[74:75], v14 offset:25600
    s_waitcnt vmcnt(12) lgkmcnt(10)
    v_mfma_f32_16x16x32_bf16 v[32:35], v[80:83], v[152:155], v[32:35]
    ds_read_b64_tr_b16 v[76:77], v15 offset:24576
    v_mfma_f32_16x16x32_bf16 v[40:43], v[80:83], v[156:159], v[40:43]
    ds_read_b64_tr_b16 v[78:79], v15 offset:25600
    v_perm_b32 v191, v103, v103, s97
    v_mfma_f32_16x16x32_bf16 v[44:47], v[84:87], v[156:159], v[44:47]
    ds_read_b64_tr_b16 v[80:81], v12 offset:28672
    buffer_load_dwordx4 v[144:147], v6, s[16:19], s50 offen offset:0 sc1
    v_mfma_f32_16x16x32_bf16 v[36:39], v[84:87], v[152:155], v[36:39]
    ds_read_b64_tr_b16 v[82:83], v12 offset:29696
    v_perm_b32 v192, v104, v104, s59
    s_waitcnt lgkmcnt(10)
    v_mfma_f32_16x16x32_bf16 v[48:51], v[88:91], v[152:155], v[48:51]
    ds_read_b64_tr_b16 v[84:85], v13 offset:28672
    v_mfma_f32_16x16x32_bf16 v[56:59], v[88:91], v[156:159], v[56:59]
    ds_read_b64_tr_b16 v[86:87], v13 offset:29696
    v_perm_b32 v193, v104, v104, s97
    v_mfma_f32_16x16x32_bf16 v[60:63], v[92:95], v[156:159], v[60:63]
    ds_read_b64_tr_b16 v[88:89], v14 offset:28672
    buffer_load_dwordx4 v[148:151], v6, s[16:19], s50 offen offset:256 sc1
    v_mfma_f32_16x16x32_bf16 v[52:55], v[92:95], v[152:155], v[52:55]
    ds_read_b64_tr_b16 v[90:91], v14 offset:29696
    s_waitcnt vmcnt(12) lgkmcnt(10)
    v_mfma_f32_16x16x32_bf16 v[32:35], v[64:67], v[160:163], v[32:35]
    ds_read_b64_tr_b16 v[92:93], v15 offset:28672
    v_mfma_f32_16x16x32_bf16 v[40:43], v[64:67], v[164:167], v[40:43]
    ds_read_b64_tr_b16 v[94:95], v15 offset:29696
    v_perm_b32 v194, v105, v105, s59
    v_mfma_f32_16x16x32_bf16 v[44:47], v[68:71], v[164:167], v[44:47]
    ds_read_b64_tr_b16 v[64:65], v12 offset:32768
    buffer_load_dwordx4 v[152:155], v6, s[16:19], s50 offen offset:2048 sc1
    v_mfma_f32_16x16x32_bf16 v[36:39], v[68:71], v[160:163], v[36:39]
    ds_read_b64_tr_b16 v[66:67], v12 offset:33792
    v_perm_b32 v195, v105, v105, s97
    s_waitcnt lgkmcnt(10)
    v_mfma_f32_16x16x32_bf16 v[48:51], v[72:75], v[160:163], v[48:51]
    ds_read_b64_tr_b16 v[68:69], v13 offset:32768
    v_mfma_f32_16x16x32_bf16 v[56:59], v[72:75], v[164:167], v[56:59]
    ds_read_b64_tr_b16 v[70:71], v13 offset:33792
    v_perm_b32 v196, v106, v106, s59
    v_mfma_f32_16x16x32_bf16 v[60:63], v[76:79], v[164:167], v[60:63]
    ds_read_b64_tr_b16 v[72:73], v14 offset:32768
    buffer_load_dwordx4 v[156:159], v6, s[16:19], s50 offen offset:2304 sc1
    s_add_u32 s50, s50, 4096
    v_mfma_f32_16x16x32_bf16 v[52:55], v[76:79], v[160:163], v[52:55]
    ds_read_b64_tr_b16 v[74:75], v14 offset:33792
    s_waitcnt vmcnt(12) lgkmcnt(10)
    v_mfma_f32_16x16x32_bf16 v[32:35], v[80:83], v[168:171], v[32:35]
    ds_read_b64_tr_b16 v[76:77], v15 offset:32768
    v_mfma_f32_16x16x32_bf16 v[40:43], v[80:83], v[172:175], v[40:43]
    ds_read_b64_tr_b16 v[78:79], v15 offset:33792
    v_perm_b32 v197, v106, v106, s97
    v_mfma_f32_16x16x32_bf16 v[44:47], v[84:87], v[172:175], v[44:47]
    ds_read_b64_tr_b16 v[80:81], v12 offset:36864
    buffer_load_dwordx4 v[160:163], v6, s[16:19], s50 offen offset:0 sc1
    v_mfma_f32_16x16x32_bf16 v[36:39], v[84:87], v[168:171], v[36:39]
    ds_read_b64_tr_b16 v[82:83], v12 offset:37888
    v_perm_b32 v198, v107, v107, s59
    s_waitcnt lgkmcnt(10)
    v_mfma_f32_16x16x32_bf16 v[48:51], v[88:91], v[168:171], v[48:51]
    ds_read_b64_tr_b16 v[84:85], v13 offset:36864
    v_mfma_f32_16x16x32_bf16 v[56:59], v[88:91], v[172:175], v[56:59]
    ds_read_b64_tr_b16 v[86:87], v13 offset:37888
    v_perm_b32 v199, v107, v107, s97
    v_mfma_f32_16x16x32_bf16 v[60:63], v[92:95], v[172:175], v[60:63]
    ds_read_b64_tr_b16 v[88:89], v14 offset:36864
    buffer_load_dwordx4 v[164:167], v6, s[16:19], s50 offen offset:256 sc1
    v_mfma_f32_16x16x32_bf16 v[52:55], v[92:95], v[168:171], v[52:55]
    ds_read_b64_tr_b16 v[90:91], v14 offset:37888
    s_waitcnt vmcnt(12) lgkmcnt(10)
    v_mfma_f32_16x16x32_bf16 v[32:35], v[64:67], v[112:115], v[32:35]
    ds_read_b64_tr_b16 v[92:93], v15 offset:36864
    v_mfma_f32_16x16x32_bf16 v[40:43], v[64:67], v[116:119], v[40:43]
    ds_read_b64_tr_b16 v[94:95], v15 offset:37888
    v_perm_b32 v200, v108, v108, s59
    v_mfma_f32_16x16x32_bf16 v[44:47], v[68:71], v[116:119], v[44:47]
    ds_read_b64_tr_b16 v[64:65], v12 offset:40960
    buffer_load_dwordx4 v[168:171], v6, s[16:19], s50 offen offset:2048 sc1
    v_mfma_f32_16x16x32_bf16 v[36:39], v[68:71], v[112:115], v[36:39]
    ds_read_b64_tr_b16 v[66:67], v12 offset:41984
    v_perm_b32 v201, v108, v108, s97
    s_waitcnt lgkmcnt(10)
    v_mfma_f32_16x16x32_bf16 v[48:51], v[72:75], v[112:115], v[48:51]
    ds_read_b64_tr_b16 v[68:69], v13 offset:40960
    v_mfma_f32_16x16x32_bf16 v[56:59], v[72:75], v[116:119], v[56:59]
    ds_read_b64_tr_b16 v[70:71], v13 offset:41984
    v_perm_b32 v202, v109, v109, s59
    v_mfma_f32_16x16x32_bf16 v[60:63], v[76:79], v[116:119], v[60:63]
    ds_read_b64_tr_b16 v[72:73], v14 offset:40960
    buffer_load_dwordx4 v[172:175], v6, s[16:19], s50 offen offset:2304 sc1
    s_add_u32 s50, s50, 4096
    v_mfma_f32_16x16x32_bf16 v[52:55], v[76:79], v[112:115], v[52:55]
    ds_read_b64_tr_b16 v[74:75], v14 offset:41984
    s_waitcnt vmcnt(12) lgkmcnt(10)
    v_mfma_f32_16x16x32_bf16 v[32:35], v[80:83], v[120:123], v[32:35]
    ds_read_b64_tr_b16 v[76:77], v15 offset:40960
    v_mfma_f32_16x16x32_bf16 v[40:43], v[80:83], v[124:127], v[40:43]
    ds_read_b64_tr_b16 v[78:79], v15 offset:41984
    v_perm_b32 v203, v109, v109, s97
    v_mfma_f32_16x16x32_bf16 v[44:47], v[84:87], v[124:127], v[44:47]
    ds_read_b64_tr_b16 v[80:81], v12 offset:45056
    s_branch wp_6_t
wp_6:
    ds_read_b32 v29, v28
    s_waitcnt lgkmcnt(0)
    v_readfirstlane_b32 s60, v29
    s_lshr_b32 s51, s60, 2
    s_and_b32 s51, s51, s60
    s_and_b32 s51, s51, 3
wp_6_t:
    s_cmp_eq_u32 s51, 3
    s_cbranch_scc0 wp_6
    s_lshl_b32 s50, s52, 15
    s_xor_b32 s50, s50, 32768
    buffer_load_dwordx4 v[112:115], v6, s[16:19], s50 offen offset:0 sc1
    v_mfma_f32_16x16x32_bf16 v[36:39], v[84:87], v[120:123], v[36:39]
    ds_read_b64_tr_b16 v[82:83], v12 offset:46080
    v_perm_b32 v204, v110, v110, s59
    s_waitcnt lgkmcnt(10)
    v_mfma_f32_16x16x32_bf16 v[48:51], v[88:91], v[120:123], v[48:51]
    ds_read_b64_tr_b16 v[84:85], v13 offset:45056
    v_mfma_f32_16x16x32_bf16 v[56:59], v[88:91], v[124:127], v[56:59]
    ds_read_b64_tr_b16 v[86:87], v13 offset:46080
    v_perm_b32 v205, v110, v110, s97
    v_mfma_f32_16x16x32_bf16 v[60:63], v[92:95], v[124:127], v[60:63]
    ds_read_b64_tr_b16 v[88:89], v14 offset:45056
    buffer_load_dwordx4 v[116:119], v6, s[16:19], s50 offen offset:256 sc1
    v_mfma_f32_16x16x32_bf16 v[52:55], v[92:95], v[120:123], v[52:55]
    ds_read_b64_tr_b16 v[90:91], v14 offset:46080
    s_waitcnt vmcnt(12) lgkmcnt(10)
    v_mfma_f32_16x16x32_bf16 v[32:35], v[64:67], v[128:131], v[32:35]
    ds_read_b64_tr_b16 v[92:93], v15 offset:45056
    v_mfma_f32_16x16x32_bf16 v[40:43], v[64:67], v[132:135], v[40:43]
    ds_read_b64_tr_b16 v[94:95], v15 offset:46080
    v_perm_b32 v206, v111, v111, s59
    v_mfma_f32_16x16x32_bf16 v[44:47], v[68:71], v[132:135], v[44:47]
    ds_read_b64_tr_b16 v[64:65], v12 offset:49152
    buffer_load_dwordx4 v[120:123], v6, s[16:19], s50 offen offset:2048 sc1
    v_mfma_f32_16x16x32_bf16 v[36:39], v[68:71], v[128:131], v[36:39]
    ds_read_b64_tr_b16 v[66:67], v12 offset:50176
    v_perm_b32 v207, v111, v111, s97
    s_waitcnt lgkmcnt(10)
    v_mfma_f32_16x16x32_bf16 v[48:51], v[72:75], v[128:131], v[48:51]
    ds_read_b64_tr_b16 v[68:69], v13 offset:49152
    v_mfma_f32_16x16x32_bf16 v[56:59], v[72:75], v[132:135], v[56:59]
    ds_read_b64_tr_b16 v[70:71], v13 offset:50176
    v_mul_u32_u24 v8, 144, v4
    v_mfma_f32_16x16x32_bf16 v[60:63], v[76:79], v[132:135], v[60:63]
    ds_read_b64_tr_b16 v[72:73], v14 offset:49152
    buffer_load_dwordx4 v[124:127], v6, s[16:19], s50 offen offset:2304 sc1
    s_add_u32 s50, s50, 4096
    v_mfma_f32_16x16x32_bf16 v[52:55], v[76:79], v[128:131], v[52:55]
    ds_read_b64_tr_b16 v[74:75], v14 offset:50176
    s_waitcnt vmcnt(12) lgkmcnt(10)
    v_mfma_f32_16x16x32_bf16 v[32:35], v[80:83], v[136:139], v[32:35]
    ds_read_b64_tr_b16 v[76:77], v15 offset:49152
    v_mfma_f32_16x16x32_bf16 v[40:43], v[80:83], v[140:143], v[40:43]
    ds_read_b64_tr_b16 v[78:79], v15 offset:50176
    v_lshrrev_b32 v11, 4, v1
    v_mfma_f32_16x16x32_bf16 v[44:47], v[84:87], v[140:143], v[44:47]
    ds_read_b64_tr_b16 v[80:81], v12 offset:53248
    buffer_load_dwordx4 v[128:131], v6, s[16:19], s50 offen offset:0 sc1
    v_mfma_f32_16x16x32_bf16 v[36:39], v[84:87], v[136:139], v[36:39]
    ds_read_b64_tr_b16 v[82:83], v12 offset:54272
    v_lshl_add_u32 v8, v11, 3, v8
    s_waitcnt lgkmcnt(10)
    v_mfma_f32_16x16x32_bf16 v[48:51], v[88:91], v[136:139], v[48:51]
    ds_read_b64_tr_b16 v[84:85], v13 offset:53248
    v_mfma_f32_16x16x32_bf16 v[56:59], v[88:91], v[140:143], v[56:59]
    ds_read_b64_tr_b16 v[86:87], v13 offset:54272
    v_mul_u32_u24 v7, 4608, v2
    v_mfma_f32_16x16x32_bf16 v[60:63], v[92:95], v[140:143], v[60:63]
    ds_read_b64_tr_b16 v[88:89], v14 offset:53248
    buffer_load_dwordx4 v[132:135], v6, s[16:19], s50 offen offset:256 sc1
    v_mfma_f32_16x16x32_bf16 v[52:55], v[92:95], v[136:139], v[52:55]
    ds_read_b64_tr_b16 v[90:91], v14 offset:54272
    s_waitcnt vmcnt(12) lgkmcnt(10)
    v_mfma_f32_16x16x32_bf16 v[32:35], v[64:67], v[144:147], v[32:35]
    ds_read_b64_tr_b16 v[92:93], v15 offset:53248
    v_mfma_f32_16x16x32_bf16 v[40:43], v[64:67], v[148:151], v[40:43]
    ds_read_b64_tr_b16 v[94:95], v15 offset:54272
    v_add_u32 v7, 131072, v7
    v_mfma_f32_16x16x32_bf16 v[44:47], v[68:71], v[148:151], v[44:47]
    ds_read_b64_tr_b16 v[64:65], v12 offset:57344
    buffer_load_dwordx4 v[136:139], v6, s[16:19], s50 offen offset:2048 sc1
    v_mfma_f32_16x16x32_bf16 v[36:39], v[68:71], v[144:147], v[36:39]
    ds_read_b64_tr_b16 v[66:67], v12 offset:58368
    v_add_u32 v8, v8, v7
    s_waitcnt lgkmcnt(10)
    v_mfma_f32_16x16x32_bf16 v[48:51], v[72:75], v[144:147], v[48:51]
    ds_read_b64_tr_b16 v[68:69], v13 offset:57344
    v_mfma_f32_16x16x32_bf16 v[56:59], v[72:75], v[148:151], v[56:59]
    ds_read_b64_tr_b16 v[70:71], v13 offset:58368
    v_lshrrev_b32 v10, 3, v1
    v_mfma_f32_16x16x32_bf16 v[60:63], v[76:79], v[148:151], v[60:63]
    ds_read_b64_tr_b16 v[72:73], v14 offset:57344
    buffer_load_dwordx4 v[140:143], v6, s[16:19], s50 offen offset:2304 sc1
    s_add_u32 s50, s50, 4096
    v_mfma_f32_16x16x32_bf16 v[52:55], v[76:79], v[144:147], v[52:55]
    ds_read_b64_tr_b16 v[74:75], v14 offset:58368
    s_waitcnt vmcnt(12) lgkmcnt(10)
    v_mfma_f32_16x16x32_bf16 v[32:35], v[80:83], v[152:155], v[32:35]
    ds_read_b64_tr_b16 v[76:77], v15 offset:57344
    v_mfma_f32_16x16x32_bf16 v[40:43], v[80:83], v[156:159], v[40:43]
    ds_read_b64_tr_b16 v[78:79], v15 offset:58368
    v_and_b32 v11, 7, v1
    v_mfma_f32_16x16x32_bf16 v[44:47], v[84:87], v[156:159], v[44:47]
    ds_read_b64_tr_b16 v[80:81], v12 offset:61440
    buffer_load_dwordx4 v[144:147], v6, s[16:19], s50 offen offset:0 sc1
    v_mfma_f32_16x16x32_bf16 v[36:39], v[84:87], v[152:155], v[36:39]
    ds_read_b64_tr_b16 v[82:83], v12 offset:62464
    v_mul_u32_u24 v9, 144, v10
    s_waitcnt lgkmcnt(10)
    v_mfma_f32_16x16x32_bf16 v[48:51], v[88:91], v[152:155], v[48:51]
    ds_read_b64_tr_b16 v[84:85], v13 offset:61440
    v_mfma_f32_16x16x32_bf16 v[56:59], v[88:91], v[156:159], v[56:59]
    ds_read_b64_tr_b16 v[86:87], v13 offset:62464
    v_lshl_add_u32 v9, v11, 4, v9
    v_mfma_f32_16x16x32_bf16 v[60:63], v[92:95], v[156:159], v[60:63]
    ds_read_b64_tr_b16 v[88:89], v14 offset:61440
    buffer_load_dwordx4 v[148:151], v6, s[16:19], s50 offen offset:256 sc1
    v_mfma_f32_16x16x32_bf16 v[52:55], v[92:95], v[152:155], v[52:55]
    ds_read_b64_tr_b16 v[90:91], v14 offset:62464
    s_waitcnt vmcnt(12) lgkmcnt(10)
    v_mfma_f32_16x16x32_bf16 v[32:35], v[64:67], v[160:163], v[32:35]
    ds_read_b64_tr_b16 v[92:93], v15 offset:61440
    v_mfma_f32_16x16x32_bf16 v[40:43], v[64:67], v[164:167], v[40:43]
    ds_read_b64_tr_b16 v[94:95], v15 offset:62464
    v_add_u32 v9, v9, v7
    v_mfma_f32_16x16x32_bf16 v[44:47], v[68:71], v[164:167], v[44:47]
    v_xor_b32 v12, 0x10000, v12
    ds_read_b64_tr_b16 v[64:65], v12 offset:0
    buffer_load_dwordx4 v[152:155], v6, s[16:19], s50 offen offset:2048 sc1
    v_mfma_f32_16x16x32_bf16 v[36:39], v[68:71], v[160:163], v[36:39]
    ds_read_b64_tr_b16 v[66:67], v12 offset:1024
    v_lshlrev_b32 v10, 11, v10
    s_waitcnt lgkmcnt(10)
    v_mfma_f32_16x16x32_bf16 v[48:51], v[72:75], v[160:163], v[48:51]
    v_xor_b32 v13, 0x10000, v13
    ds_read_b64_tr_b16 v[68:69], v13 offset:0
    v_mfma_f32_16x16x32_bf16 v[56:59], v[72:75], v[164:167], v[56:59]
    ds_read_b64_tr_b16 v[70:71], v13 offset:1024
    v_lshl_add_u32 v10, v11, 4, v10
    v_mfma_f32_16x16x32_bf16 v[60:63], v[76:79], v[164:167], v[60:63]
    v_xor_b32 v14, 0x10000, v14
    ds_read_b64_tr_b16 v[72:73], v14 offset:0
    buffer_load_dwordx4 v[156:159], v6, s[16:19], s50 offen offset:2304 sc1
    s_add_u32 s50, s50, 4096
    v_mfma_f32_16x16x32_bf16 v[52:55], v[76:79], v[160:163], v[52:55]
    ds_read_b64_tr_b16 v[74:75], v14 offset:1024
    s_waitcnt vmcnt(12) lgkmcnt(10)
    v_mfma_f32_16x16x32_bf16 v[32:35], v[80:83], v[168:171], v[32:35]
    v_xor_b32 v15, 0x10000, v15
    ds_read_b64_tr_b16 v[76:77], v15 offset:0
    v_mfma_f32_16x16x32_bf16 v[40:43], v[80:83], v[172:175], v[40:43]
    ds_read_b64_tr_b16 v[78:79], v15 offset:1024
    v_mfma_f32_16x16x32_bf16 v[44:47], v[84:87], v[172:175], v[44:47]
    ds_read_b64_tr_b16 v[80:81], v12 offset:4096
    buffer_load_dwordx4 v[160:163], v6, s[16:19], s50 offen offset:0 sc1
    v_mfma_f32_16x16x32_bf16 v[36:39], v[84:87], v[168:171], v[36:39]
    ds_read_b64_tr_b16 v[82:83], v12 offset:5120
    s_waitcnt lgkmcnt(10)
    v_mfma_f32_16x16x32_bf16 v[48:51], v[88:91], v[168:171], v[48:51]
    ds_read_b64_tr_b16 v[84:85], v13 offset:4096
    v_mfma_f32_16x16x32_bf16 v[56:59], v[88:91], v[172:175], v[56:59]
    ds_read_b64_tr_b16 v[86:87], v13 offset:5120
    v_mfma_f32_16x16x32_bf16 v[60:63], v[92:95], v[172:175], v[60:63]
    ds_read_b64_tr_b16 v[88:89], v14 offset:4096
    buffer_load_dwordx4 v[164:167], v6, s[16:19], s50 offen offset:256 sc1
    v_mfma_f32_16x16x32_bf16 v[52:55], v[92:95], v[168:171], v[52:55]
    ds_read_b64_tr_b16 v[90:91], v14 offset:5120
    s_waitcnt vmcnt(12) lgkmcnt(10)
    v_mfma_f32_16x16x32_bf16 v[176:179], v[64:67], v[112:115], v[176:179]
    ds_read_b64_tr_b16 v[92:93], v15 offset:4096
    v_mfma_f32_16x16x32_bf16 v[184:187], v[64:67], v[116:119], v[184:187]
    ds_read_b64_tr_b16 v[94:95], v15 offset:5120
    v_mfma_f32_16x16x32_bf16 v[188:191], v[68:71], v[116:119], v[188:191]
    ds_read_b64_tr_b16 v[64:65], v12 offset:8192
    buffer_load_dwordx4 v[168:171], v6, s[16:19], s50 offen offset:2048 sc1
    v_mfma_f32_16x16x32_bf16 v[180:183], v[68:71], v[112:115], v[180:183]
    ds_read_b64_tr_b16 v[66:67], v12 offset:9216
    s_waitcnt lgkmcnt(10)
    v_mfma_f32_16x16x32_bf16 v[192:195], v[72:75], v[112:115], v[192:195]
    ds_read_b64_tr_b16 v[68:69], v13 offset:8192
    v_mfma_f32_16x16x32_bf16 v[200:203], v[72:75], v[116:119], v[200:203]
    ds_read_b64_tr_b16 v[70:71], v13 offset:9216
    v_mfma_f32_16x16x32_bf16 v[204:207], v[76:79], v[116:119], v[204:207]
    ds_read_b64_tr_b16 v[72:73], v14 offset:8192
    buffer_load_dwordx4 v[172:175], v6, s[16:19], s50 offen offset:2304 sc1
    s_add_u32 s50, s50, 4096
    v_mfma_f32_16x16x32_bf16 v[196:199], v[76:79], v[112:115], v[196:199]
    ds_read_b64_tr_b16 v[74:75], v14 offset:9216
    s_waitcnt vmcnt(12) lgkmcnt(10)
    v_mfma_f32_16x16x32_bf16 v[176:179], v[80:83], v[120:123], v[176:179]
    ds_read_b64_tr_b16 v[76:77], v15 offset:8192
    v_mfma_f32_16x16x32_bf16 v[184:187], v[80:83], v[124:127], v[184:187]
    ds_read_b64_tr_b16 v[78:79], v15 offset:9216
    v_mfma_f32_16x16x32_bf16 v[188:191], v[84:87], v[124:127], v[188:191]
    ds_read_b64_tr_b16 v[80:81], v12 offset:12288
    buffer_load_dwordx4 v[112:115], v6, s[16:19], s50 offen offset:0 sc1
    v_mfma_f32_16x16x32_bf16 v[180:183], v[84:87], v[120:123], v[180:183]
    ds_read_b64_tr_b16 v[82:83], v12 offset:13312
    s_waitcnt lgkmcnt(10)
    v_mfma_f32_16x16x32_bf16 v[192:195], v[88:91], v[120:123], v[192:195]
    ds_read_b64_tr_b16 v[84:85], v13 offset:12288
    v_mfma_f32_16x16x32_bf16 v[200:203], v[88:91], v[124:127], v[200:203]
    ds_read_b64_tr_b16 v[86:87], v13 offset:13312
    v_mfma_f32_16x16x32_bf16 v[204:207], v[92:95], v[124:127], v[204:207]
    ds_read_b64_tr_b16 v[88:89], v14 offset:12288
    buffer_load_dwordx4 v[116:119], v6, s[16:19], s50 offen offset:256 sc1
    v_mfma_f32_16x16x32_bf16 v[196:199], v[92:95], v[120:123], v[196:199]
    ds_read_b64_tr_b16 v[90:91], v14 offset:13312
    s_waitcnt vmcnt(12) lgkmcnt(10)
    v_mfma_f32_16x16x32_bf16 v[176:179], v[64:67], v[128:131], v[176:179]
    ds_read_b64_tr_b16 v[92:93], v15 offset:12288
    v_mfma_f32_16x16x32_bf16 v[184:187], v[64:67], v[132:135], v[184:187]
    ds_read_b64_tr_b16 v[94:95], v15 offset:13312
    v_mfma_f32_16x16x32_bf16 v[188:191], v[68:71], v[132:135], v[188:191]
    ds_read_b64_tr_b16 v[64:65], v12 offset:16384
    buffer_load_dwordx4 v[120:123], v6, s[16:19], s50 offen offset:2048 sc1
    v_mfma_f32_16x16x32_bf16 v[180:183], v[68:71], v[128:131], v[180:183]
    ds_read_b64_tr_b16 v[66:67], v12 offset:17408
    s_waitcnt lgkmcnt(10)
    v_mfma_f32_16x16x32_bf16 v[192:195], v[72:75], v[128:131], v[192:195]
    ds_read_b64_tr_b16 v[68:69], v13 offset:16384
    v_mfma_f32_16x16x32_bf16 v[200:203], v[72:75], v[132:135], v[200:203]
    ds_read_b64_tr_b16 v[70:71], v13 offset:17408
    v_mfma_f32_16x16x32_bf16 v[204:207], v[76:79], v[132:135], v[204:207]
    ds_read_b64_tr_b16 v[72:73], v14 offset:16384
    buffer_load_dwordx4 v[124:127], v6, s[16:19], s50 offen offset:2304 sc1
    s_add_u32 s50, s50, 4096
    v_mfma_f32_16x16x32_bf16 v[196:199], v[76:79], v[128:131], v[196:199]
    ds_read_b64_tr_b16 v[74:75], v14 offset:17408
    s_waitcnt vmcnt(12) lgkmcnt(10)
    v_mfma_f32_16x16x32_bf16 v[176:179], v[80:83], v[136:139], v[176:179]
    ds_read_b64_tr_b16 v[76:77], v15 offset:16384
    v_mfma_f32_16x16x32_bf16 v[184:187], v[80:83], v[140:143], v[184:187]
    ds_read_b64_tr_b16 v[78:79], v15 offset:17408
    v_mfma_f32_16x16x32_bf16 v[188:191], v[84:87], v[140:143], v[188:191]
    ds_read_b64_tr_b16 v[80:81], v12 offset:20480
    buffer_load_dwordx4 v[128:131], v6, s[16:19], s50 offen offset:0 sc1
    v_mfma_f32_16x16x32_bf16 v[180:183], v[84:87], v[136:139], v[180:183]
    ds_read_b64_tr_b16 v[82:83], v12 offset:21504
    s_waitcnt lgkmcnt(10)
    v_mfma_f32_16x16x32_bf16 v[192:195], v[88:91], v[136:139], v[192:195]
    ds_read_b64_tr_b16 v[84:85], v13 offset:20480
    v_mfma_f32_16x16x32_bf16 v[200:203], v[88:91], v[140:143], v[200:203]
    ds_read_b64_tr_b16 v[86:87], v13 offset:21504
    v_mfma_f32_16x16x32_bf16 v[204:207], v[92:95], v[140:143], v[204:207]
    ds_read_b64_tr_b16 v[88:89], v14 offset:20480
    buffer_load_dwordx4 v[132:135], v6, s[16:19], s50 offen offset:256 sc1
    v_mfma_f32_16x16x32_bf16 v[196:199], v[92:95], v[136:139], v[196:199]
    ds_read_b64_tr_b16 v[90:91], v14 offset:21504
    s_waitcnt vmcnt(12) lgkmcnt(10)
    v_mfma_f32_16x16x32_bf16 v[176:179], v[64:67], v[144:147], v[176:179]
    ds_read_b64_tr_b16 v[92:93], v15 offset:20480
    v_mfma_f32_16x16x32_bf16 v[184:187], v[64:67], v[148:151], v[184:187]
    ds_read_b64_tr_b16 v[94:95], v15 offset:21504
    v_mfma_f32_16x16x32_bf16 v[188:191], v[68:71], v[148:151], v[188:191]
    ds_read_b64_tr_b16 v[64:65], v12 offset:24576
    buffer_load_dwordx4 v[136:139], v6, s[16:19], s50 offen offset:2048 sc1
    v_mfma_f32_16x16x32_bf16 v[180:183], v[68:71], v[144:147], v[180:183]
    ds_read_b64_tr_b16 v[66:67], v12 offset:25600
    s_waitcnt lgkmcnt(10)
    v_mfma_f32_16x16x32_bf16 v[192:195], v[72:75], v[144:147], v[192:195]
    ds_read_b64_tr_b16 v[68:69], v13 offset:24576
    v_mfma_f32_16x16x32_bf16 v[200:203], v[72:75], v[148:151], v[200:203]
    ds_read_b64_tr_b16 v[70:71], v13 offset:25600
    v_mfma_f32_16x16x32_bf16 v[204:207], v[76:79], v[148:151], v[204:207]
    ds_read_b64_tr_b16 v[72:73], v14 offset:24576
    buffer_load_dwordx4 v[140:143], v6, s[16:19], s50 offen offset:2304 sc1
    s_add_u32 s50, s50, 4096
    v_mfma_f32_16x16x32_bf16 v[196:199], v[76:79], v[144:147], v[196:199]
    ds_read_b64_tr_b16 v[74:75], v14 offset:25600
    s_waitcnt vmcnt(12) lgkmcnt(10)
    v_mfma_f32_16x16x32_bf16 v[176:179], v[80:83], v[152:155], v[176:179]
    ds_read_b64_tr_b16 v[76:77], v15 offset:24576
    v_mfma_f32_16x16x32_bf16 v[184:187], v[80:83], v[156:159], v[184:187]
    ds_read_b64_tr_b16 v[78:79], v15 offset:25600
    v_mfma_f32_16x16x32_bf16 v[188:191], v[84:87], v[156:159], v[188:191]
    ds_read_b64_tr_b16 v[80:81], v12 offset:28672
    buffer_load_dwordx4 v[144:147], v6, s[16:19], s50 offen offset:0 sc1
    v_mfma_f32_16x16x32_bf16 v[180:183], v[84:87], v[152:155], v[180:183]
    ds_read_b64_tr_b16 v[82:83], v12 offset:29696
    s_waitcnt lgkmcnt(10)
    v_mfma_f32_16x16x32_bf16 v[192:195], v[88:91], v[152:155], v[192:195]
    ds_read_b64_tr_b16 v[84:85], v13 offset:28672
    v_mfma_f32_16x16x32_bf16 v[200:203], v[88:91], v[156:159], v[200:203]
    ds_read_b64_tr_b16 v[86:87], v13 offset:29696
    v_mfma_f32_16x16x32_bf16 v[204:207], v[92:95], v[156:159], v[204:207]
    ds_read_b64_tr_b16 v[88:89], v14 offset:28672
    buffer_load_dwordx4 v[148:151], v6, s[16:19], s50 offen offset:256 sc1
    v_mfma_f32_16x16x32_bf16 v[196:199], v[92:95], v[152:155], v[196:199]
    ds_read_b64_tr_b16 v[90:91], v14 offset:29696
    s_waitcnt vmcnt(12) lgkmcnt(10)
    v_mfma_f32_16x16x32_bf16 v[176:179], v[64:67], v[160:163], v[176:179]
    ds_read_b64_tr_b16 v[92:93], v15 offset:28672
    v_mfma_f32_16x16x32_bf16 v[184:187], v[64:67], v[164:167], v[184:187]
    ds_read_b64_tr_b16 v[94:95], v15 offset:29696
    v_mfma_f32_16x16x32_bf16 v[188:191], v[68:71], v[164:167], v[188:191]
    ds_read_b64_tr_b16 v[64:65], v12 offset:32768
    buffer_load_dwordx4 v[152:155], v6, s[16:19], s50 offen offset:2048 sc1
    v_mfma_f32_16x16x32_bf16 v[180:183], v[68:71], v[160:163], v[180:183]
    ds_read_b64_tr_b16 v[66:67], v12 offset:33792
    s_waitcnt lgkmcnt(10)
    v_mfma_f32_16x16x32_bf16 v[192:195], v[72:75], v[160:163], v[192:195]
    ds_read_b64_tr_b16 v[68:69], v13 offset:32768
    v_mfma_f32_16x16x32_bf16 v[200:203], v[72:75], v[164:167], v[200:203]
    ds_read_b64_tr_b16 v[70:71], v13 offset:33792
    v_mfma_f32_16x16x32_bf16 v[204:207], v[76:79], v[164:167], v[204:207]
    ds_read_b64_tr_b16 v[72:73], v14 offset:32768
    buffer_load_dwordx4 v[156:159], v6, s[16:19], s50 offen offset:2304 sc1
    s_add_u32 s50, s50, 4096
    v_mfma_f32_16x16x32_bf16 v[196:199], v[76:79], v[160:163], v[196:199]
    ds_read_b64_tr_b16 v[74:75], v14 offset:33792
    s_waitcnt vmcnt(12) lgkmcnt(10)
    v_mfma_f32_16x16x32_bf16 v[176:179], v[80:83], v[168:171], v[176:179]
    ds_read_b64_tr_b16 v[76:77], v15 offset:32768
    v_mfma_f32_16x16x32_bf16 v[184:187], v[80:83], v[172:175], v[184:187]
    ds_read_b64_tr_b16 v[78:79], v15 offset:33792
    v_mfma_f32_16x16x32_bf16 v[188:191], v[84:87], v[172:175], v[188:191]
    ds_read_b64_tr_b16 v[80:81], v12 offset:36864
    buffer_load_dwordx4 v[160:163], v6, s[16:19], s50 offen offset:0 sc1
    v_mfma_f32_16x16x32_bf16 v[180:183], v[84:87], v[168:171], v[180:183]
    ds_read_b64_tr_b16 v[82:83], v12 offset:37888
    s_waitcnt lgkmcnt(10)
    v_mfma_f32_16x16x32_bf16 v[192:195], v[88:91], v[168:171], v[192:195]
    ds_read_b64_tr_b16 v[84:85], v13 offset:36864
    v_mfma_f32_16x16x32_bf16 v[200:203], v[88:91], v[172:175], v[200:203]
    ds_read_b64_tr_b16 v[86:87], v13 offset:37888
    v_mfma_f32_16x16x32_bf16 v[204:207], v[92:95], v[172:175], v[204:207]
    ds_read_b64_tr_b16 v[88:89], v14 offset:36864
    buffer_load_dwordx4 v[164:167], v6, s[16:19], s50 offen offset:256 sc1
    v_mfma_f32_16x16x32_bf16 v[196:199], v[92:95], v[168:171], v[196:199]
    ds_read_b64_tr_b16 v[90:91], v14 offset:37888
    s_waitcnt vmcnt(12) lgkmcnt(10)
    v_mfma_f32_16x16x32_bf16 v[176:179], v[64:67], v[112:115], v[176:179]
    ds_read_b64_tr_b16 v[92:93], v15 offset:36864
    v_mfma_f32_16x16x32_bf16 v[184:187], v[64:67], v[116:119], v[184:187]
    ds_read_b64_tr_b16 v[94:95], v15 offset:37888
    v_mfma_f32_16x16x32_bf16 v[188:191], v[68:71], v[116:119], v[188:191]
    ds_read_b64_tr_b16 v[64:65], v12 offset:40960
    buffer_load_dwordx4 v[168:171], v6, s[16:19], s50 offen offset:2048 sc1
    v_mfma_f32_16x16x32_bf16 v[180:183], v[68:71], v[112:115], v[180:183]
    ds_read_b64_tr_b16 v[66:67], v12 offset:41984
    s_waitcnt lgkmcnt(10)
    v_mfma_f32_16x16x32_bf16 v[192:195], v[72:75], v[112:115], v[192:195]
    ds_read_b64_tr_b16 v[68:69], v13 offset:40960
    v_mfma_f32_16x16x32_bf16 v[200:203], v[72:75], v[116:119], v[200:203]
    ds_read_b64_tr_b16 v[70:71], v13 offset:41984
    v_mfma_f32_16x16x32_bf16 v[204:207], v[76:79], v[116:119], v[204:207]
    ds_read_b64_tr_b16 v[72:73], v14 offset:40960
    buffer_load_dwordx4 v[172:175], v6, s[16:19], s50 offen offset:2304 sc1
    s_add_u32 s50, s50, 4096
    v_mfma_f32_16x16x32_bf16 v[196:199], v[76:79], v[112:115], v[196:199]
    ds_read_b64_tr_b16 v[74:75], v14 offset:41984
    s_waitcnt vmcnt(12) lgkmcnt(10)
    v_mfma_f32_16x16x32_bf16 v[176:179], v[80:83], v[120:123], v[176:179]
    ds_read_b64_tr_b16 v[76:77], v15 offset:40960
    v_mfma_f32_16x16x32_bf16 v[184:187], v[80:83], v[124:127], v[184:187]
    ds_read_b64_tr_b16 v[78:79], v15 offset:41984
    v_mfma_f32_16x16x32_bf16 v[188:191], v[84:87], v[124:127], v[188:191]
    ds_read_b64_tr_b16 v[80:81], v12 offset:45056
    v_mfma_f32_16x16x32_bf16 v[180:183], v[84:87], v[120:123], v[180:183]
    ds_read_b64_tr_b16 v[82:83], v12 offset:46080
    s_waitcnt lgkmcnt(10)
    v_mfma_f32_16x16x32_bf16 v[192:195], v[88:91], v[120:123], v[192:195]
    ds_read_b64_tr_b16 v[84:85], v13 offset:45056
    v_mfma_f32_16x16x32_bf16 v[200:203], v[88:91], v[124:127], v[200:203]
    ds_read_b64_tr_b16 v[86:87], v13 offset:46080
    v_mfma_f32_16x16x32_bf16 v[204:207], v[92:95], v[124:127], v[204:207]
    ds_read_b64_tr_b16 v[88:89], v14 offset:45056
    v_mfma_f32_16x16x32_bf16 v[196:199], v[92:95], v[120:123], v[196:199]
    ds_read_b64_tr_b16 v[90:91], v14 offset:46080
    s_waitcnt vmcnt(10) lgkmcnt(10)
    v_mfma_f32_16x16x32_bf16 v[176:179], v[64:67], v[128:131], v[176:179]
    ds_read_b64_tr_b16 v[92:93], v15 offset:45056
    v_mfma_f32_16x16x32_bf16 v[184:187], v[64:67], v[132:135], v[184:187]
    ds_read_b64_tr_b16 v[94:95], v15 offset:46080
    v_mfma_f32_16x16x32_bf16 v[188:191], v[68:71], v[132:135], v[188:191]
    ds_read_b64_tr_b16 v[64:65], v12 offset:49152
    v_mfma_f32_16x16x32_bf16 v[180:183], v[68:71], v[128:131], v[180:183]
    ds_read_b64_tr_b16 v[66:67], v12 offset:50176
    s_waitcnt lgkmcnt(10)
    v_mfma_f32_16x16x32_bf16 v[192:195], v[72:75], v[128:131], v[192:195]
    ds_read_b64_tr_b16 v[68:69], v13 offset:49152
    v_mfma_f32_16x16x32_bf16 v[200:203], v[72:75], v[132:135], v[200:203]
    ds_read_b64_tr_b16 v[70:71], v13 offset:50176
    v_mfma_f32_16x16x32_bf16 v[204:207], v[76:79], v[132:135], v[204:207]
    ds_read_b64_tr_b16 v[72:73], v14 offset:49152
    v_mfma_f32_16x16x32_bf16 v[196:199], v[76:79], v[128:131], v[196:199]
    ds_read_b64_tr_b16 v[74:75], v14 offset:50176
    s_waitcnt vmcnt(8) lgkmcnt(10)
    v_mfma_f32_16x16x32_bf16 v[176:179], v[80:83], v[136:139], v[176:179]
    ds_read_b64_tr_b16 v[76:77], v15 offset:49152
    v_mfma_f32_16x16x32_bf16 v[184:187], v[80:83], v[140:143], v[184:187]
    ds_read_b64_tr_b16 v[78:79], v15 offset:50176
    v_mfma_f32_16x16x32_bf16 v[188:191], v[84:87], v[140:143], v[188:191]
    ds_read_b64_tr_b16 v[80:81], v12 offset:53248
    v_mfma_f32_16x16x32_bf16 v[180:183], v[84:87], v[136:139], v[180:183]
    ds_read_b64_tr_b16 v[82:83], v12 offset:54272
    s_waitcnt lgkmcnt(10)
    v_mfma_f32_16x16x32_bf16 v[192:195], v[88:91], v[136:139], v[192:195]
    ds_read_b64_tr_b16 v[84:85], v13 offset:53248
    v_mfma_f32_16x16x32_bf16 v[200:203], v[88:91], v[140:143], v[200:203]
    ds_read_b64_tr_b16 v[86:87], v13 offset:54272
    v_mfma_f32_16x16x32_bf16 v[204:207], v[92:95], v[140:143], v[204:207]
    ds_read_b64_tr_b16 v[88:89], v14 offset:53248
    v_mfma_f32_16x16x32_bf16 v[196:199], v[92:95], v[136:139], v[196:199]
    ds_read_b64_tr_b16 v[90:91], v14 offset:54272
    s_waitcnt vmcnt(6) lgkmcnt(10)
    v_mfma_f32_16x16x32_bf16 v[176:179], v[64:67], v[144:147], v[176:179]
    ds_read_b64_tr_b16 v[92:93], v15 offset:53248
    v_mfma_f32_16x16x32_bf16 v[184:187], v[64:67], v[148:151], v[184:187]
    ds_read_b64_tr_b16 v[94:95], v15 offset:54272
    v_mfma_f32_16x16x32_bf16 v[188:191], v[68:71], v[148:151], v[188:191]
    ds_read_b64_tr_b16 v[64:65], v12 offset:57344
    v_mfma_f32_16x16x32_bf16 v[180:183], v[68:71], v[144:147], v[180:183]
    ds_read_b64_tr_b16 v[66:67], v12 offset:58368
    s_waitcnt lgkmcnt(10)
    v_mfma_f32_16x16x32_bf16 v[192:195], v[72:75], v[144:147], v[192:195]
    ds_read_b64_tr_b16 v[68:69], v13 offset:57344
    v_mfma_f32_16x16x32_bf16 v[200:203], v[72:75], v[148:151], v[200:203]
    ds_read_b64_tr_b16 v[70:71], v13 offset:58368
    v_mfma_f32_16x16x32_bf16 v[204:207], v[76:79], v[148:151], v[204:207]
    ds_read_b64_tr_b16 v[72:73], v14 offset:57344
    v_mfma_f32_16x16x32_bf16 v[196:199], v[76:79], v[144:147], v[196:199]
    ds_read_b64_tr_b16 v[74:75], v14 offset:58368
    s_waitcnt vmcnt(4) lgkmcnt(10)
    v_mfma_f32_16x16x32_bf16 v[176:179], v[80:83], v[152:155], v[176:179]
    ds_read_b64_tr_b16 v[76:77], v15 offset:57344
    v_mfma_f32_16x16x32_bf16 v[184:187], v[80:83], v[156:159], v[184:187]
    ds_read_b64_tr_b16 v[78:79], v15 offset:58368
    v_mfma_f32_16x16x32_bf16 v[188:191], v[84:87], v[156:159], v[188:191]
    ds_read_b64_tr_b16 v[80:81], v12 offset:61440
    v_mfma_f32_16x16x32_bf16 v[180:183], v[84:87], v[152:155], v[180:183]
    ds_read_b64_tr_b16 v[82:83], v12 offset:62464
    s_waitcnt lgkmcnt(10)
    v_mfma_f32_16x16x32_bf16 v[192:195], v[88:91], v[152:155], v[192:195]
    ds_read_b64_tr_b16 v[84:85], v13 offset:61440
    v_mfma_f32_16x16x32_bf16 v[200:203], v[88:91], v[156:159], v[200:203]
    ds_read_b64_tr_b16 v[86:87], v13 offset:62464
    v_mfma_f32_16x16x32_bf16 v[204:207], v[92:95], v[156:159], v[204:207]
    ds_read_b64_tr_b16 v[88:89], v14 offset:61440
    v_mfma_f32_16x16x32_bf16 v[196:199], v[92:95], v[152:155], v[196:199]
    ds_read_b64_tr_b16 v[90:91], v14 offset:62464
    s_waitcnt vmcnt(2) lgkmcnt(10)
    v_mfma_f32_16x16x32_bf16 v[176:179], v[64:67], v[160:163], v[176:179]
    ds_read_b64_tr_b16 v[92:93], v15 offset:61440
    v_mfma_f32_16x16x32_bf16 v[184:187], v[64:67], v[164:167], v[184:187]
    ds_read_b64_tr_b16 v[94:95], v15 offset:62464
    v_mfma_f32_16x16x32_bf16 v[188:191], v[68:71], v[164:167], v[188:191]
    v_mfma_f32_16x16x32_bf16 v[180:183], v[68:71], v[160:163], v[180:183]
    s_waitcnt lgkmcnt(8)
    v_mfma_f32_16x16x32_bf16 v[192:195], v[72:75], v[160:163], v[192:195]
    v_mfma_f32_16x16x32_bf16 v[200:203], v[72:75], v[164:167], v[200:203]
    v_mfma_f32_16x16x32_bf16 v[204:207], v[76:79], v[164:167], v[204:207]
    v_mfma_f32_16x16x32_bf16 v[196:199], v[76:79], v[160:163], v[196:199]
    s_waitcnt vmcnt(0) lgkmcnt(4)
    v_mfma_f32_16x16x32_bf16 v[176:179], v[80:83], v[168:171], v[176:179]
    v_mfma_f32_16x16x32_bf16 v[184:187], v[80:83], v[172:175], v[184:187]
    v_mfma_f32_16x16x32_bf16 v[188:191], v[84:87], v[172:175], v[188:191]
    v_mfma_f32_16x16x32_bf16 v[180:183], v[84:87], v[168:171], v[180:183]
    s_waitcnt lgkmcnt(0)
    v_mfma_f32_16x16x32_bf16 v[192:195], v[88:91], v[168:171], v[192:195]
    v_mfma_f32_16x16x32_bf16 v[200:203], v[88:91], v[172:175], v[200:203]
    v_mfma_f32_16x16x32_bf16 v[204:207], v[92:95], v[172:175], v[204:207]
    v_mfma_f32_16x16x32_bf16 v[196:199], v[92:95], v[168:171], v[196:199]
    s_cmp_eq_u32 s9, 3
    s_cbranch_scc1 c_wo_fin
    s_add_u32 s58, s58, 4194304
    v_pk_add_f32 v[32:33], v[32:33], v[176:177]
    v_pk_add_f32 v[34:35], v[34:35], v[178:179]
    v_pk_add_f32 v[36:37], v[36:37], v[180:181]
    v_pk_add_f32 v[38:39], v[38:39], v[182:183]
    v_cvt_pk_bf16_f32 v96, v32, v33
    v_cvt_pk_bf16_f32 v97, v34, v35
    v_cvt_pk_bf16_f32 v98, v36, v37
    v_cvt_pk_bf16_f32 v99, v38, v39
    buffer_store_dwordx4 v[96:99], v6, s[12:15], s58 offen offset:0 sc1
    v_pk_add_f32 v[40:41], v[40:41], v[184:185]
    v_pk_add_f32 v[42:43], v[42:43], v[186:187]
    v_pk_add_f32 v[44:45], v[44:45], v[188:189]
    v_pk_add_f32 v[46:47], v[46:47], v[190:191]
    v_cvt_pk_bf16_f32 v100, v40, v41
    v_cvt_pk_bf16_f32 v101, v42, v43
    v_cvt_pk_bf16_f32 v102, v44, v45
    v_cvt_pk_bf16_f32 v103, v46, v47
    buffer_store_dwordx4 v[100:103], v6, s[12:15], s58 offen offset:256 sc1
    v_pk_add_f32 v[48:49], v[48:49], v[192:193]
    v_pk_add_f32 v[50:51], v[50:51], v[194:195]
    v_pk_add_f32 v[52:53], v[52:53], v[196:197]
    v_pk_add_f32 v[54:55], v[54:55], v[198:199]
    v_cvt_pk_bf16_f32 v104, v48, v49
    v_cvt_pk_bf16_f32 v105, v50, v51
    v_cvt_pk_bf16_f32 v106, v52, v53
    v_cvt_pk_bf16_f32 v107, v54, v55
    buffer_store_dwordx4 v[104:107], v6, s[12:15], s58 offen offset:2048 sc1
    v_pk_add_f32 v[56:57], v[56:57], v[200:201]
    v_pk_add_f32 v[58:59], v[58:59], v[202:203]
    v_pk_add_f32 v[60:61], v[60:61], v[204:205]
    v_pk_add_f32 v[62:63], v[62:63], v[206:207]
    v_cvt_pk_bf16_f32 v108, v56, v57
    v_cvt_pk_bf16_f32 v109, v58, v59
    v_cvt_pk_bf16_f32 v110, v60, v61
    v_cvt_pk_bf16_f32 v111, v62, v63
    buffer_store_dwordx4 v[108:111], v6, s[12:15], s58 offen offset:2304 sc1
    s_barrier
c_wo_stat:
    s_mov_b32 s55, 0x3f803f80
    v_dot2_f32_bf16 v18, v96, s55, 0
    v_dot2_f32_bf16 v19, v96, v96, 0
    v_dot2_f32_bf16 v20, v100, s55, 0
    v_dot2_f32_bf16 v21, v100, v100, 0
    v_dot2_f32_bf16 v18, v97, s55, v18
    v_dot2_f32_bf16 v19, v97, v97, v19
    v_dot2_f32_bf16 v20, v101, s55, v20
    v_dot2_f32_bf16 v21, v101, v101, v21
    v_dot2_f32_bf16 v18, v98, s55, v18
    v_dot2_f32_bf16 v19, v98, v98, v19
    v_dot2_f32_bf16 v20, v102, s55, v20
    v_dot2_f32_bf16 v21, v102, v102, v21
    v_dot2_f32_bf16 v18, v99, s55, v18
    v_dot2_f32_bf16 v19, v99, v99, v19
    v_dot2_f32_bf16 v20, v103, s55, v20
    v_dot2_f32_bf16 v21, v103, v103, v21
    v_dot2_f32_bf16 v18, v104, s55, v18
    v_dot2_f32_bf16 v19, v104, v104, v19
    v_dot2_f32_bf16 v20, v108, s55, v20
    v_dot2_f32_bf16 v21, v108, v108, v21
    v_dot2_f32_bf16 v18, v105, s55, v18
    v_dot2_f32_bf16 v19, v105, v105, v19
    v_dot2_f32_bf16 v20, v109, s55, v20
    v_dot2_f32_bf16 v21, v109, v109, v21
    v_dot2_f32_bf16 v18, v106, s55, v18
    v_dot2_f32_bf16 v19, v106, v106, v19
    v_dot2_f32_bf16 v20, v110, s55, v20
    v_dot2_f32_bf16 v21, v110, v110, v21
    v_dot2_f32_bf16 v18, v107, s55, v18
    v_dot2_f32_bf16 v19, v107, v107, v19
    v_dot2_f32_bf16 v20, v111, s55, v20
    v_dot2_f32_bf16 v21, v111, v111, v21
    v_lshlrev_b32 v16, 3, v1
    s_lshl_b32 s3, s48, 12
    s_lshl_b32 s55, s7, 8
    s_add_u32 s3, s3, s55
    v_permlane16_swap_b32 v18, v20
    v_permlane16_swap_b32 v19, v21
    s_lshl_b32 s55, s9, 18
    v_pk_add_f32 v[18:19], v[18:19], v[20:21]
    s_add_u32 s3, s3, s55
    s_add_u32 s3, s3, 63176704
    v_permlane32_swap_b32 v18, v20
    v_permlane32_swap_b32 v19, v21
    v_pk_add_f32 v[18:19], v[18:19], v[20:21]
    s_mov_b32 exec_hi, 0
    buffer_store_dwordx2 v[18:19], v16, s[12:15], s3 offen sc1
    s_mov_b64 exec, -1
    s_cmp_lg_u32 s9, -1
    s_cbranch_scc1 c_wo_pub
    v_mov_b32 v24, 159492
non_7:
    ds_read_b32 v25, v24
    s_waitcnt lgkmcnt(0)
    v_readfirstlane_b32 s10, v25
    s_cmp_eq_u32 s10, 0
    s_cbranch_scc1 non_7
c_wo_pub:
    s_mul_i32 s55, s9, 786432
    s_add_u32 s55, s55, 66060288
    v_and_b32 v24, 63, v0
    s_and_b32 s56, s11, 0xe0
    v_lshrrev_b32 v25, 5, v24
    v_add_u32 v24, s56, v24
    v_and_b32 v24, 255, v24
    v_lshlrev_b32 v24, 10, v24
    v_lshl_add_u32 v24, v25, 8, v24
    s_bfe_u32 s56, s11, 0x20003
    s_and_b32 s57, s11, 7
    s_lshl_b32 s56, s56, 7
    s_lshl_b32 s57, s57, 2
    s_add_u32 s55, s55, s56
    s_add_u32 s55, s55, s57
    s_and_b32 s57, s6, s9
    s_bfe_i32 s57, s57, 0x10000
    v_mov_b32 v25, 159488
    v_mov_b32 v26, 1
    v_mov_b32 v27, s10
    s_mov_b64 exec, 1
    s_waitcnt vmcnt(0)
    ds_add_rtn_u32 v26, v25, v26
    s_waitcnt lgkmcnt(0)
    v_readfirstlane_b32 s56, v26
    s_and_b32 s56, s56, 3
    s_cmp_lg_u32 s56, 3
    s_cbranch_scc1 pub_8
    s_mov_b32 exec_lo, -1
    s_mov_b32 exec_hi, s57
    buffer_store_dword v27, v24, s[12:15], s55 offen sc1
pub_8:
    s_mov_b64 exec, -1
    s_cmp_eq_u32 s9, -1
    s_cbranch_scc1 c_wo_pub3
    s_barrier
c_wo_pub3:
    s_add_u32 s9, s9, 1
    s_bitcmp1_b32 s9, 0
    s_cbranch_scc1 c_qkvB
    s_branch c_qkvA
c_wo_fin:
    s_mov_b32 s28, s44
    s_mov_b32 s29, s45
    s_mov_b32 s30, 4194304
    s_mov_b32 s31, 0x00020000
    s_lshl_b32 s3, s48, 16
    s_lshl_b32 s55, s7, 7
    s_add_u32 s3, s3, s55
    v_pk_add_f32 v[32:33], v[32:33], v[176:177]
    v_pk_add_f32 v[34:35], v[34:35], v[178:179]
    v_pk_add_f32 v[36:37], v[36:37], v[180:181]
    v_pk_add_f32 v[38:39], v[38:39], v[182:183]
    v_cvt_pk_bf16_f32 v96, v32, v33
    v_cvt_pk_bf16_f32 v97, v34, v35
    v_cvt_pk_bf16_f32 v98, v36, v37
    v_cvt_pk_bf16_f32 v99, v38, v39
    ds_write_b64 v8, v[96:97] offset:0
    ds_write_b64 v8, v[98:99] offset:32
    v_pk_add_f32 v[40:41], v[40:41], v[184:185]
    v_pk_add_f32 v[42:43], v[42:43], v[186:187]
    v_pk_add_f32 v[44:45], v[44:45], v[188:189]
    v_pk_add_f32 v[46:47], v[46:47], v[190:191]
    v_cvt_pk_bf16_f32 v100, v40, v41
    v_cvt_pk_bf16_f32 v101, v42, v43
    v_cvt_pk_bf16_f32 v102, v44, v45
    v_cvt_pk_bf16_f32 v103, v46, v47
    ds_write_b64 v8, v[100:101] offset:2304
    ds_write_b64 v8, v[102:103] offset:2336
    v_pk_add_f32 v[48:49], v[48:49], v[192:193]
    v_pk_add_f32 v[50:51], v[50:51], v[194:195]
    v_pk_add_f32 v[52:53], v[52:53], v[196:197]
    v_pk_add_f32 v[54:55], v[54:55], v[198:199]
    v_cvt_pk_bf16_f32 v104, v48, v49
    v_cvt_pk_bf16_f32 v105, v50, v51
    v_cvt_pk_bf16_f32 v106, v52, v53
    v_cvt_pk_bf16_f32 v107, v54, v55
    ds_write_b64 v8, v[104:105] offset:64
    ds_write_b64 v8, v[106:107] offset:96
    v_pk_add_f32 v[56:57], v[56:57], v[200:201]
    v_pk_add_f32 v[58:59], v[58:59], v[202:203]
    v_pk_add_f32 v[60:61], v[60:61], v[204:205]
    v_pk_add_f32 v[62:63], v[62:63], v[206:207]
    v_cvt_pk_bf16_f32 v108, v56, v57
    v_cvt_pk_bf16_f32 v109, v58, v59
    v_cvt_pk_bf16_f32 v110, v60, v61
    v_cvt_pk_bf16_f32 v111, v62, v63
    ds_write_b64 v8, v[108:109] offset:2368
    ds_write_b64 v8, v[110:111] offset:2400
    s_waitcnt lgkmcnt(0)
    ds_read_b128 v[32:35], v9 offset:0
    ds_read_b128 v[36:39], v9 offset:1152
    ds_read_b128 v[40:43], v9 offset:2304
    ds_read_b128 v[44:47], v9 offset:3456
    s_waitcnt lgkmcnt(3)
    buffer_store_dwordx4 v[32:35], v10, s[28:31], s3 offen sc1
    s_add_u32 s3, s3, 16384
    s_waitcnt lgkmcnt(2)
    buffer_store_dwordx4 v[36:39], v10, s[28:31], s3 offen sc1
    s_add_u32 s3, s3, 16384
    s_waitcnt lgkmcnt(1)
    buffer_store_dwordx4 v[40:43], v10, s[28:31], s3 offen sc1
    s_add_u32 s3, s3, 16384
    s_waitcnt lgkmcnt(0)
    buffer_store_dwordx4 v[44:47], v10, s[28:31], s3 offen sc1
    s_add_u32 s3, s3, 16384
    s_branch k_exit
c_prep_tail:
    s_lshl_b32 s56, s7, 12
    s_add_u32 s58, s55, s56
    s_lshl_b32 s3, s8, 12
    s_add_u32 s3, s3, 131072
    v_lshrrev_b32 v18, 2, v17
    v_and_b32 v19, 1, v17
    v_lshl_add_u32 v18, v18, 1, v19
    v_lshlrev_b32 v18, 10, v18
    v_lshl_add_u32 v18, v16, 4, v18
    v_bfe_u32 v17, v17, 1, 1
    v_lshl_add_u32 v18, v17, 3, v18
    v_add_u32 v18, s3, v18
    v_and_b32 v16, 15, v1
    v_bfe_u32 v17, v1, 4, 1
    v_lshl_add_u32 v6, v17, 5, v16
    v_lshlrev_b32 v6, 4, v6
    v_lshrrev_b32 v17, 5, v1
    v_lshl_add_u32 v6, v17, 10, v6
    v_add_u32 v19, s3, v6
    s_waitcnt vmcnt(3)
    ds_write_b64 v18, v[32:33] offset:0
    ds_write_b64 v18, v[34:35] offset:512
    s_waitcnt vmcnt(2)
    ds_write_b64 v18, v[36:37] offset:128
    ds_write_b64 v18, v[38:39] offset:640
    s_waitcnt vmcnt(1)
    ds_write_b64 v18, v[40:41] offset:256
    ds_write_b64 v18, v[42:43] offset:768
    s_waitcnt vmcnt(0)
    ds_write_b64 v18, v[44:45] offset:384
    ds_write_b64 v18, v[46:47] offset:896
    s_waitcnt lgkmcnt(0)
    ds_read_b128 v[96:99], v19 offset:0
    ds_read_b128 v[100:103], v19 offset:256
    ds_read_b128 v[104:107], v19 offset:2048
    ds_read_b128 v[108:111], v19 offset:2304
    s_waitcnt lgkmcnt(3)
    buffer_store_dwordx4 v[96:99], v6, s[12:15], s58 offen offset:0 sc1
    s_waitcnt lgkmcnt(2)
    buffer_store_dwordx4 v[100:103], v6, s[12:15], s58 offen offset:256 sc1
    s_waitcnt lgkmcnt(1)
    buffer_store_dwordx4 v[104:107], v6, s[12:15], s58 offen offset:2048 sc1
    s_waitcnt lgkmcnt(0)
    buffer_store_dwordx4 v[108:111], v6, s[12:15], s58 offen offset:2304 sc1
    s_branch c_wo_stat
.p2align 6
c_qkvB:
    v_and_b32 v1, 63, v0
    v_lshrrev_b32 v2, 6, v0
    v_lshlrev_b32 v5, 4, v1
    v_lshrrev_b32 v3, 5, v1
    v_and_b32 v4, 15, v0
    v_bfe_u32 v7, v1, 4, 1
    v_lshl_add_u32 v6, v7, 5, v4
    v_lshlrev_b32 v6, 4, v6
    v_lshl_add_u32 v6, v3, 10, v6
    s_lshr_b32 s48, s6, 1
    s_lshl_b32 s48, s48, 2
    s_add_u32 s48, s48, s8
    s_lshl_b32 s55, s48, 17
    s_lshl_b32 s56, s9, 22
    s_add_u32 s55, s55, s56
    s_add_u32 s16, s4, s55
    s_addc_u32 s17, s5, 0
    s_mov_b32 s18, 65536
    s_mov_b32 s19, 0x00020000
    s_add_u32 s56, s55, 65536
    s_add_u32 s20, s4, s56
    s_addc_u32 s21, s5, 0
    s_mov_b32 s22, 65536
    s_mov_b32 s23, 0x00020000
    s_lshl_b32 s49, s7, 12
    s_add_u32 s49, s49, s55
    s_and_b32 s56, s6, 1
    s_lshl_b32 s56, s56, 11
    s_add_u32 s49, s49, s56
    s_add_u32 s49, s49, 16777216
    s_movk_i32 s54, 4096
    v_lshrrev_b32 v16, 2, v4
    v_lshl_add_u32 v18, v7, 2, v16
    v_lshl_add_u32 v18, v3, 4, v18
    v_lshlrev_b32 v18, 6, v18
    v_and_b32 v17, 3, v4
    v_lshl_add_u32 v18, v17, 3, v18
    v_lshl_add_u32 v26, v7, 5, v18
    v_xor_b32 v27, 32, v26
    v_mov_b32 v24, v26
    v_mov_b32 v25, v27
    v_and_b32 v18, 0x30, v1
    v_add_u32 v10, 155648, v18
    v_lshlrev_b32 v11, 2, v4
    v_add_u32 v11, 155648, v11
    v_lshl_add_u32 v8, v2, 8, v11
    v_lshl_add_u32 v9, v2, 8, v10
    s_lshr_b32 s3, s8, 1
    s_and_b32 s55, s8, 1
    s_lshl_b32 s3, s3, 14
    s_lshl_b32 s55, s55, 12
    s_add_u32 s3, s3, s55
    s_add_u32 s3, s3, 81920
    v_lshl_add_u32 v12, v3, 5, v4
    v_lshlrev_b32 v12, 4, v12
    v_lshl_add_u32 v12, v7, 10, v12
    v_add_u32 v12, s3, v12
    v_add_u32 v13, s3, v5
    s_lshr_b32 s84, s9, 1
    s_lshl_b32 s84, s84, 23
    s_lshl_b32 s3, s7, 19
    s_add_u32 s84, s84, s3
    s_and_b32 s3, s6, 1
    s_lshl_b32 s3, s3, 18
    s_add_u32 s84, s84, s3
    s_add_u32 s84, s84, 33554432
    s_lshr_b32 s86, s6, 1
    s_lshl_b32 s3, s86, 15
    s_add_u32 s84, s84, s3
    s_sub_u32 s84, s84, 81920
    s_add_u32 s85, s84, 8192
    s_mul_i32 s53, s9, 786432
    s_add_u32 s53, s53, 66322432
    s_and_b32 s3, s11, 31
    s_lshl_b32 s3, s3, 10
    s_add_u32 s53, s53, s3
    s_lshr_b32 s3, s86, 1
    s_lshl_b32 s3, s3, 7
    s_add_u32 s53, s53, s3
    s_and_b32 s3, s86, 1
    s_lshl_b32 s3, s3, 2
    s_add_u32 s3, s3, s8
    s_lshl_b32 s3, s3, 2
    s_add_u32 s53, s53, s3
    v_lshlrev_b32 v28, 15, v1
    v_mov_b32 v29, s10
    v_mov_b32 v32, 0
    v_mov_b32 v33, 0
    v_mov_b32 v34, 0
    v_mov_b32 v35, 0
    v_mov_b32 v36, 0
    v_mov_b32 v37, 0
    v_mov_b32 v38, 0
    v_mov_b32 v39, 0
    v_mov_b32 v40, 0
    v_mov_b32 v41, 0
    v_mov_b32 v42, 0
    v_mov_b32 v43, 0
    v_mov_b32 v44, 0
    v_mov_b32 v45, 0
    v_mov_b32 v46, 0
    v_mov_b32 v47, 0
    v_mov_b32 v48, 0
    v_mov_b32 v49, 0
    v_mov_b32 v50, 0
    v_mov_b32 v51, 0
    v_mov_b32 v52, 0
    v_mov_b32 v53, 0
    v_mov_b32 v54, 0
    v_mov_b32 v55, 0
    v_mov_b32 v56, 0
    v_mov_b32 v57, 0
    v_mov_b32 v58, 0
    v_mov_b32 v59, 0
    v_mov_b32 v60, 0
    v_mov_b32 v61, 0
    v_mov_b32 v62, 0
    v_mov_b32 v63, 0
    v_mov_b32 v64, 0
    v_mov_b32 v65, 0
    v_mov_b32 v66, 0
    v_mov_b32 v67, 0
    v_mov_b32 v68, 0
    v_mov_b32 v69, 0
    v_mov_b32 v70, 0
    v_mov_b32 v71, 0
    v_mov_b32 v72, 0
    v_mov_b32 v73, 0
    v_mov_b32 v74, 0
    v_mov_b32 v75, 0
    v_mov_b32 v76, 0
    v_mov_b32 v77, 0
    v_mov_b32 v78, 0
    v_mov_b32 v79, 0
    v_mov_b32 v80, 0
    v_mov_b32 v81, 0
    v_mov_b32 v82, 0
    v_mov_b32 v83, 0
    v_mov_b32 v84, 0
    v_mov_b32 v85, 0
    v_mov_b32 v86, 0
    v_mov_b32 v87, 0
    v_mov_b32 v88, 0
    v_mov_b32 v89, 0
    v_mov_b32 v90, 0
    v_mov_b32 v91, 0
    v_mov_b32 v92, 0
    v_mov_b32 v93, 0
    v_mov_b32 v94, 0
    v_mov_b32 v95, 0
    v_mov_b32 v96, 0
    v_mov_b32 v97, 0
    v_mov_b32 v98, 0
    v_mov_b32 v99, 0
    v_mov_b32 v100, 0
    v_mov_b32 v101, 0
    v_mov_b32 v102, 0
    v_mov_b32 v103, 0
    v_mov_b32 v104, 0
    v_mov_b32 v105, 0
    v_mov_b32 v106, 0
    v_mov_b32 v107, 0
    v_mov_b32 v108, 0
    v_mov_b32 v109, 0
    v_mov_b32 v110, 0
    v_mov_b32 v111, 0
    v_mov_b32 v112, 0
    v_mov_b32 v113, 0
    v_mov_b32 v114, 0
    v_mov_b32 v115, 0
    v_mov_b32 v116, 0
    v_mov_b32 v117, 0
    v_mov_b32 v118, 0
    v_mov_b32 v119, 0
    v_mov_b32 v120, 0
    v_mov_b32 v121, 0
    v_mov_b32 v122, 0
    v_mov_b32 v123, 0
    v_mov_b32 v124, 0
    v_mov_b32 v125, 0
    v_mov_b32 v126, 0
    v_mov_b32 v127, 0
    s_mov_b32 s50, 8192
    s_mov_b32 s58, 6144
    s_mov_b32 s51, 12288
    s_mov_b32 s59, 10240
    s_mov_b32 s52, 0
    s_mul_i32 s60, s9, 786432
    s_add_u32 s60, s60, 65273856
    s_lshl_b32 s61, s11, 10
    s_add_u32 s60, s60, s61
    s_and_b32 s61, s8, 2
    s_lshl_b32 s61, s61, 7
    s_add_u32 s60, s60, s61
    s_add_u32 s61, s60, 128
    s_mov_b32 s98, s10
    s_mov_b32 s99, s10
    s_mov_b32 s3, 0x100000
cp_9:
    s_load_dwordx8 s[64:71], s[4:5], s60 glc
    s_load_dwordx8 s[72:79], s[4:5], s61 glc
    s_sub_u32 s3, s3, 1
    s_cbranch_scc1 cp_9_ok
    s_waitcnt lgkmcnt(0)
    s_xor_b64 s[100:101], s[64:65], s[98:99]
    s_xor_b64 s[64:65], s[66:67], s[98:99]
    s_or_b64 s[100:101], s[100:101], s[64:65]
    s_xor_b64 s[64:65], s[68:69], s[98:99]
    s_or_b64 s[100:101], s[100:101], s[64:65]
    s_xor_b64 s[64:65], s[70:71], s[98:99]
    s_or_b64 s[100:101], s[100:101], s[64:65]
    s_xor_b64 s[64:65], s[72:73], s[98:99]
    s_or_b64 s[100:101], s[100:101], s[64:65]
    s_xor_b64 s[64:65], s[74:75], s[98:99]
    s_or_b64 s[100:101], s[100:101], s[64:65]
    s_xor_b64 s[64:65], s[76:77], s[98:99]
    s_or_b64 s[100:101], s[100:101], s[64:65]
    s_xor_b64 s[64:65], s[78:79], s[98:99]
    s_or_b64 s[100:101], s[100:101], s[64:65]
    s_cbranch_scc1 cp_9
cp_9_ok:
    s_waitcnt lgkmcnt(0)
    buffer_load_dwordx4 v[152:155], v6, s[16:19], 0 offen offset:0 sc1
    buffer_load_dwordx4 v[156:159], v6, s[16:19], 0 offen offset:256 sc1
    buffer_load_dwordx4 v[160:163], v6, s[20:23], 0 offen offset:0 sc1
    buffer_load_dwordx4 v[164:167], v6, s[20:23], 0 offen offset:256 sc1
    buffer_load_dwordx4 v[168:171], v6, s[16:19], 0 offen offset:2048 sc1
    buffer_load_dwordx4 v[172:175], v6, s[16:19], 0 offen offset:2304 sc1
    buffer_load_dwordx4 v[176:179], v6, s[20:23], 0 offen offset:2048 sc1
    buffer_load_dwordx4 v[180:183], v6, s[20:23], 0 offen offset:2304 sc1
    s_barrier
    ds_read_b64_tr_b16 v[128:129], v24 offset:0
    ds_read_b64_tr_b16 v[130:131], v24 offset:512
    ds_read_b64_tr_b16 v[132:133], v25 offset:0
    ds_read_b64_tr_b16 v[134:135], v25 offset:512
    ds_read_b64_tr_b16 v[136:137], v24 offset:8192
    ds_read_b64_tr_b16 v[138:139], v24 offset:8704
    ds_read_b64_tr_b16 v[140:141], v25 offset:8192
    ds_read_b64_tr_b16 v[142:143], v25 offset:8704
    ds_read_b64_tr_b16 v[144:145], v24 offset:16384
    ds_read_b64_tr_b16 v[146:147], v24 offset:16896
    buffer_load_dwordx4 a[0:3], v6, s[16:19], s54 offen offset:0 sc1
    buffer_load_dwordx4 a[4:7], v6, s[16:19], s54 offen offset:256 sc1
    buffer_load_dwordx4 a[8:11], v6, s[20:23], s54 offen offset:0 sc1
    buffer_load_dwordx4 a[12:15], v6, s[20:23], s54 offen offset:256 sc1
    buffer_load_dwordx4 a[16:19], v6, s[16:19], s54 offen offset:2048 sc1
    buffer_load_dwordx4 a[20:23], v6, s[16:19], s54 offen offset:2304 sc1
    s_mov_b32 s54, 7
.p2align 3
c_qkvB_loop:
    s_waitcnt vmcnt(12) lgkmcnt(6)
    v_mfma_f32_16x16x32_bf16 v[32:35], v[128:131], v[152:155], v[32:35]
    ds_read_b64_tr_b16 v[148:149], v25 offset:16384
    v_mfma_f32_16x16x32_bf16 v[36:39], v[128:131], v[156:159], v[36:39]
    ds_read_b64_tr_b16 v[150:151], v25 offset:16896
    v_mfma_f32_16x16x32_bf16 v[52:55], v[132:135], v[156:159], v[52:55]
    buffer_load_dwordx4 a[24:27], v6, s[20:23], s58 offen offset:0 sc1
    v_mfma_f32_16x16x32_bf16 v[48:51], v[132:135], v[152:155], v[48:51]
    s_waitcnt lgkmcnt(4)
    v_mfma_f32_16x16x32_bf16 v[64:67], v[136:139], v[152:155], v[64:67]
    v_mfma_f32_16x16x32_bf16 v[68:71], v[136:139], v[156:159], v[68:71]
    v_mfma_f32_16x16x32_bf16 v[84:87], v[140:143], v[156:159], v[84:87]
    buffer_load_dwordx4 a[28:31], v6, s[20:23], s58 offen offset:256 sc1
    v_mfma_f32_16x16x32_bf16 v[80:83], v[140:143], v[152:155], v[80:83]
    s_waitcnt lgkmcnt(0)
    v_mfma_f32_16x16x32_bf16 v[96:99], v[152:155], v[144:147], v[96:99]
    v_mfma_f32_16x16x32_bf16 v[100:103], v[156:159], v[144:147], v[100:103]
    v_mfma_f32_16x16x32_bf16 v[116:119], v[156:159], v[148:151], v[116:119]
    v_mfma_f32_16x16x32_bf16 v[112:115], v[152:155], v[148:151], v[112:115]
    s_waitcnt vmcnt(12)
    v_mfma_f32_16x16x32_bf16 v[40:43], v[128:131], v[160:163], v[40:43]
    buffer_load_dwordx4 v[152:155], v6, s[16:19], s50 offen offset:0 sc1
    v_mfma_f32_16x16x32_bf16 v[44:47], v[128:131], v[164:167], v[44:47]
    v_mfma_f32_16x16x32_bf16 v[60:63], v[132:135], v[164:167], v[60:63]
    ds_read_b64_tr_b16 v[128:129], v24 offset:2048
    v_mfma_f32_16x16x32_bf16 v[56:59], v[132:135], v[160:163], v[56:59]
    ds_read_b64_tr_b16 v[130:131], v24 offset:2560
    v_mfma_f32_16x16x32_bf16 v[72:75], v[136:139], v[160:163], v[72:75]
    ds_read_b64_tr_b16 v[132:133], v25 offset:2048
    v_mfma_f32_16x16x32_bf16 v[76:79], v[136:139], v[164:167], v[76:79]
    ds_read_b64_tr_b16 v[134:135], v25 offset:2560
    v_mfma_f32_16x16x32_bf16 v[92:95], v[140:143], v[164:167], v[92:95]
    ds_read_b64_tr_b16 v[136:137], v24 offset:10240
    buffer_load_dwordx4 v[156:159], v6, s[16:19], s50 offen offset:256 sc1
    v_mfma_f32_16x16x32_bf16 v[88:91], v[140:143], v[160:163], v[88:91]
    ds_read_b64_tr_b16 v[138:139], v24 offset:10752
    v_mfma_f32_16x16x32_bf16 v[104:107], v[160:163], v[144:147], v[104:107]
    ds_read_b64_tr_b16 v[140:141], v25 offset:10240
    v_mfma_f32_16x16x32_bf16 v[108:111], v[164:167], v[144:147], v[108:111]
    ds_read_b64_tr_b16 v[142:143], v25 offset:10752
    v_mfma_f32_16x16x32_bf16 v[124:127], v[164:167], v[148:151], v[124:127]
    ds_read_b64_tr_b16 v[144:145], v24 offset:18432
    v_mfma_f32_16x16x32_bf16 v[120:123], v[160:163], v[148:151], v[120:123]
    ds_read_b64_tr_b16 v[146:147], v24 offset:18944
    s_waitcnt vmcnt(12) lgkmcnt(6)
    v_mfma_f32_16x16x32_bf16 v[32:35], v[128:131], v[168:171], v[32:35]
    ds_read_b64_tr_b16 v[148:149], v25 offset:18432
    v_mfma_f32_16x16x32_bf16 v[36:39], v[128:131], v[172:175], v[36:39]
    ds_read_b64_tr_b16 v[150:151], v25 offset:18944
    v_mfma_f32_16x16x32_bf16 v[52:55], v[132:135], v[172:175], v[52:55]
    buffer_load_dwordx4 v[160:163], v6, s[20:23], s58 offen offset:2048 sc1
    v_mfma_f32_16x16x32_bf16 v[48:51], v[132:135], v[168:171], v[48:51]
    s_waitcnt lgkmcnt(4)
    v_mfma_f32_16x16x32_bf16 v[64:67], v[136:139], v[168:171], v[64:67]
    v_mfma_f32_16x16x32_bf16 v[68:71], v[136:139], v[172:175], v[68:71]
    v_mfma_f32_16x16x32_bf16 v[84:87], v[140:143], v[172:175], v[84:87]
    buffer_load_dwordx4 v[164:167], v6, s[20:23], s58 offen offset:2304 sc1
    v_mfma_f32_16x16x32_bf16 v[80:83], v[140:143], v[168:171], v[80:83]
    s_waitcnt lgkmcnt(0)
    v_mfma_f32_16x16x32_bf16 v[96:99], v[168:171], v[144:147], v[96:99]
    v_mfma_f32_16x16x32_bf16 v[100:103], v[172:175], v[144:147], v[100:103]
    v_mfma_f32_16x16x32_bf16 v[116:119], v[172:175], v[148:151], v[116:119]
    v_mfma_f32_16x16x32_bf16 v[112:115], v[168:171], v[148:151], v[112:115]
    s_waitcnt vmcnt(12)
    v_mfma_f32_16x16x32_bf16 v[40:43], v[128:131], v[176:179], v[40:43]
    buffer_load_dwordx4 v[168:171], v6, s[16:19], s50 offen offset:2048 sc1
    v_mfma_f32_16x16x32_bf16 v[44:47], v[128:131], v[180:183], v[44:47]
    v_mfma_f32_16x16x32_bf16 v[60:63], v[132:135], v[180:183], v[60:63]
    ds_read_b64_tr_b16 v[128:129], v24 offset:4096
    v_mfma_f32_16x16x32_bf16 v[56:59], v[132:135], v[176:179], v[56:59]
    ds_read_b64_tr_b16 v[130:131], v24 offset:4608
    v_mfma_f32_16x16x32_bf16 v[72:75], v[136:139], v[176:179], v[72:75]
    ds_read_b64_tr_b16 v[132:133], v25 offset:4096
    v_mfma_f32_16x16x32_bf16 v[76:79], v[136:139], v[180:183], v[76:79]
    ds_read_b64_tr_b16 v[134:135], v25 offset:4608
    v_mfma_f32_16x16x32_bf16 v[92:95], v[140:143], v[180:183], v[92:95]
    ds_read_b64_tr_b16 v[136:137], v24 offset:12288
    buffer_load_dwordx4 v[172:175], v6, s[16:19], s50 offen offset:2304 sc1
    v_mfma_f32_16x16x32_bf16 v[88:91], v[140:143], v[176:179], v[88:91]
    ds_read_b64_tr_b16 v[138:139], v24 offset:12800
    v_mfma_f32_16x16x32_bf16 v[104:107], v[176:179], v[144:147], v[104:107]
    ds_read_b64_tr_b16 v[140:141], v25 offset:12288
    v_mfma_f32_16x16x32_bf16 v[108:111], v[180:183], v[144:147], v[108:111]
    ds_read_b64_tr_b16 v[142:143], v25 offset:12800
    v_mfma_f32_16x16x32_bf16 v[124:127], v[180:183], v[148:151], v[124:127]
    ds_read_b64_tr_b16 v[144:145], v24 offset:20480
    v_mfma_f32_16x16x32_bf16 v[120:123], v[176:179], v[148:151], v[120:123]
    ds_read_b64_tr_b16 v[146:147], v24 offset:20992
    s_waitcnt vmcnt(12) lgkmcnt(6)
    v_mfma_f32_16x16x32_bf16 v[32:35], v[128:131], a[0:3], v[32:35]
    ds_read_b64_tr_b16 v[148:149], v25 offset:20480
    v_mfma_f32_16x16x32_bf16 v[36:39], v[128:131], a[4:7], v[36:39]
    ds_read_b64_tr_b16 v[150:151], v25 offset:20992
    v_mfma_f32_16x16x32_bf16 v[52:55], v[132:135], a[4:7], v[52:55]
    buffer_load_dwordx4 v[176:179], v6, s[20:23], s59 offen offset:0 sc1
    v_mfma_f32_16x16x32_bf16 v[48:51], v[132:135], a[0:3], v[48:51]
    s_waitcnt lgkmcnt(4)
    v_mfma_f32_16x16x32_bf16 v[64:67], v[136:139], a[0:3], v[64:67]
    s_add_u32 s50, s50, 8192
    v_mfma_f32_16x16x32_bf16 v[68:71], v[136:139], a[4:7], v[68:71]
    v_mfma_f32_16x16x32_bf16 v[84:87], v[140:143], a[4:7], v[84:87]
    buffer_load_dwordx4 v[180:183], v6, s[20:23], s59 offen offset:256 sc1
    v_mfma_f32_16x16x32_bf16 v[80:83], v[140:143], a[0:3], v[80:83]
    s_waitcnt lgkmcnt(0)
    v_mfma_f32_16x16x32_bf16 v[96:99], a[0:3], v[144:147], v[96:99]
    s_add_u32 s52, s52, 24576
    v_mfma_f32_16x16x32_bf16 v[100:103], a[4:7], v[144:147], v[100:103]
    s_cmp_eq_u32 s52, 147456
    v_mfma_f32_16x16x32_bf16 v[116:119], a[4:7], v[148:151], v[116:119]
    s_cselect_b32 s52, 0, s52
    v_mfma_f32_16x16x32_bf16 v[112:115], a[0:3], v[148:151], v[112:115]
    s_add_u32 s58, s58, 8192
    s_waitcnt vmcnt(12)
    v_mfma_f32_16x16x32_bf16 v[40:43], v[128:131], a[8:11], v[40:43]
    buffer_load_dwordx4 a[0:3], v6, s[16:19], s51 offen offset:0 sc1
    v_mfma_f32_16x16x32_bf16 v[44:47], v[128:131], a[12:15], v[44:47]
    s_sub_u32 s54, s54, 1
    v_mfma_f32_16x16x32_bf16 v[60:63], v[132:135], a[12:15], v[60:63]
    ds_read_b64_tr_b16 v[128:129], v24 offset:6144
    v_mfma_f32_16x16x32_bf16 v[56:59], v[132:135], a[8:11], v[56:59]
    ds_read_b64_tr_b16 v[130:131], v24 offset:6656
    v_mfma_f32_16x16x32_bf16 v[72:75], v[136:139], a[8:11], v[72:75]
    ds_read_b64_tr_b16 v[132:133], v25 offset:6144
    v_mfma_f32_16x16x32_bf16 v[76:79], v[136:139], a[12:15], v[76:79]
    ds_read_b64_tr_b16 v[134:135], v25 offset:6656
    v_mfma_f32_16x16x32_bf16 v[92:95], v[140:143], a[12:15], v[92:95]
    ds_read_b64_tr_b16 v[136:137], v24 offset:14336
    buffer_load_dwordx4 a[4:7], v6, s[16:19], s51 offen offset:256 sc1
    v_mfma_f32_16x16x32_bf16 v[88:91], v[140:143], a[8:11], v[88:91]
    ds_read_b64_tr_b16 v[138:139], v24 offset:14848
    v_mfma_f32_16x16x32_bf16 v[104:107], a[8:11], v[144:147], v[104:107]
    ds_read_b64_tr_b16 v[140:141], v25 offset:14336
    v_mfma_f32_16x16x32_bf16 v[108:111], a[12:15], v[144:147], v[108:111]
    ds_read_b64_tr_b16 v[142:143], v25 offset:14848
    v_mfma_f32_16x16x32_bf16 v[124:127], a[12:15], v[148:151], v[124:127]
    ds_read_b64_tr_b16 v[144:145], v24 offset:22528
    v_mfma_f32_16x16x32_bf16 v[120:123], a[8:11], v[148:151], v[120:123]
    ds_read_b64_tr_b16 v[146:147], v24 offset:23040
    s_waitcnt vmcnt(12) lgkmcnt(6)
    v_mfma_f32_16x16x32_bf16 v[32:35], v[128:131], a[16:19], v[32:35]
    ds_read_b64_tr_b16 v[148:149], v25 offset:22528
    v_mfma_f32_16x16x32_bf16 v[36:39], v[128:131], a[20:23], v[36:39]
    ds_read_b64_tr_b16 v[150:151], v25 offset:23040
    v_mfma_f32_16x16x32_bf16 v[52:55], v[132:135], a[20:23], v[52:55]
    buffer_load_dwordx4 a[8:11], v6, s[20:23], s59 offen offset:2048 sc1
    v_mfma_f32_16x16x32_bf16 v[48:51], v[132:135], a[16:19], v[48:51]
    s_waitcnt lgkmcnt(4)
    v_mfma_f32_16x16x32_bf16 v[64:67], v[136:139], a[16:19], v[64:67]
    v_add_u32 v25, s52, v27
    v_mfma_f32_16x16x32_bf16 v[68:71], v[136:139], a[20:23], v[68:71]
    v_mfma_f32_16x16x32_bf16 v[84:87], v[140:143], a[20:23], v[84:87]
    buffer_load_dwordx4 a[12:15], v6, s[20:23], s59 offen offset:2304 sc1
    v_mfma_f32_16x16x32_bf16 v[80:83], v[140:143], a[16:19], v[80:83]
    s_waitcnt lgkmcnt(0)
    v_mfma_f32_16x16x32_bf16 v[96:99], a[16:19], v[144:147], v[96:99]
    v_add_u32 v24, s52, v26
    v_mfma_f32_16x16x32_bf16 v[100:103], a[20:23], v[144:147], v[100:103]
    v_mfma_f32_16x16x32_bf16 v[116:119], a[20:23], v[148:151], v[116:119]
    s_add_u32 s59, s59, 8192
    v_mfma_f32_16x16x32_bf16 v[112:115], a[16:19], v[148:151], v[112:115]
    s_barrier
    s_waitcnt vmcnt(12)
    v_mfma_f32_16x16x32_bf16 v[40:43], v[128:131], a[24:27], v[40:43]
    buffer_load_dwordx4 a[16:19], v6, s[16:19], s51 offen offset:2048 sc1
    v_mfma_f32_16x16x32_bf16 v[44:47], v[128:131], a[28:31], v[44:47]
    v_mfma_f32_16x16x32_bf16 v[60:63], v[132:135], a[28:31], v[60:63]
    ds_read_b64_tr_b16 v[128:129], v24 offset:0
    v_mfma_f32_16x16x32_bf16 v[56:59], v[132:135], a[24:27], v[56:59]
    ds_read_b64_tr_b16 v[130:131], v24 offset:512
    v_mfma_f32_16x16x32_bf16 v[72:75], v[136:139], a[24:27], v[72:75]
    ds_read_b64_tr_b16 v[132:133], v25 offset:0
    v_mfma_f32_16x16x32_bf16 v[76:79], v[136:139], a[28:31], v[76:79]
    ds_read_b64_tr_b16 v[134:135], v25 offset:512
    v_mfma_f32_16x16x32_bf16 v[92:95], v[140:143], a[28:31], v[92:95]
    ds_read_b64_tr_b16 v[136:137], v24 offset:8192
    buffer_load_dwordx4 a[20:23], v6, s[16:19], s51 offen offset:2304 sc1
    v_mfma_f32_16x16x32_bf16 v[88:91], v[140:143], a[24:27], v[88:91]
    ds_read_b64_tr_b16 v[138:139], v24 offset:8704
    v_mfma_f32_16x16x32_bf16 v[104:107], a[24:27], v[144:147], v[104:107]
    ds_read_b64_tr_b16 v[140:141], v25 offset:8192
    s_add_u32 s51, s51, 8192
    v_mfma_f32_16x16x32_bf16 v[108:111], a[28:31], v[144:147], v[108:111]
    ds_read_b64_tr_b16 v[142:143], v25 offset:8704
    v_mfma_f32_16x16x32_bf16 v[124:127], a[28:31], v[148:151], v[124:127]
    ds_read_b64_tr_b16 v[144:145], v24 offset:16384
    s_cmp_lg_u32 s54, 0
    v_mfma_f32_16x16x32_bf16 v[120:123], a[24:27], v[148:151], v[120:123]
    ds_read_b64_tr_b16 v[146:147], v24 offset:16896
    s_cbranch_scc1 c_qkvB_loop
    s_waitcnt vmcnt(12) lgkmcnt(6)
    v_mfma_f32_16x16x32_bf16 v[32:35], v[128:131], v[152:155], v[32:35]
    ds_read_b64_tr_b16 v[148:149], v25 offset:16384
    v_mfma_f32_16x16x32_bf16 v[36:39], v[128:131], v[156:159], v[36:39]
    ds_read_b64_tr_b16 v[150:151], v25 offset:16896
    v_mfma_f32_16x16x32_bf16 v[52:55], v[132:135], v[156:159], v[52:55]
    buffer_load_dwordx4 a[24:27], v6, s[20:23], s58 offen offset:0 sc1
    ds_read_b32 v184, v8 offset:1280
    v_mfma_f32_16x16x32_bf16 v[48:51], v[132:135], v[152:155], v[48:51]
    ds_read_b32 v186, v8 offset:1344
    s_waitcnt lgkmcnt(6)
    v_mfma_f32_16x16x32_bf16 v[64:67], v[136:139], v[152:155], v[64:67]
    ds_read_b32 v188, v8 offset:1408
    v_mfma_f32_16x16x32_bf16 v[68:71], v[136:139], v[156:159], v[68:71]
    v_mfma_f32_16x16x32_bf16 v[84:87], v[140:143], v[156:159], v[84:87]
    buffer_load_dwordx4 a[28:31], v6, s[20:23], s58 offen offset:256 sc1
    ds_read_b32 v190, v8 offset:1472
    v_mfma_f32_16x16x32_bf16 v[80:83], v[140:143], v[152:155], v[80:83]
    ds_read_b128 v[212:215], v10 offset:512
    s_waitcnt lgkmcnt(5)
    v_mfma_f32_16x16x32_bf16 v[96:99], v[152:155], v[144:147], v[96:99]
    ds_read_b128 v[216:219], v10 offset:576
    v_mfma_f32_16x16x32_bf16 v[100:103], v[156:159], v[144:147], v[100:103]
    v_mfma_f32_16x16x32_bf16 v[116:119], v[156:159], v[148:151], v[116:119]
    v_mfma_f32_16x16x32_bf16 v[112:115], v[152:155], v[148:151], v[112:115]
    s_waitcnt vmcnt(12)
    v_mfma_f32_16x16x32_bf16 v[40:43], v[128:131], v[160:163], v[40:43]
    s_waitcnt lgkmcnt(0)
    v_fma_f32 v64, -v184, v212, v64
    v_fma_f32 v65, -v184, v213, v65
    v_mfma_f32_16x16x32_bf16 v[44:47], v[128:131], v[164:167], v[44:47]
    v_fma_f32 v66, -v184, v214, v66
    v_mfma_f32_16x16x32_bf16 v[60:63], v[132:135], v[164:167], v[60:63]
    ds_read_b64_tr_b16 v[128:129], v24 offset:2048
    v_fma_f32 v67, -v184, v215, v67
    v_mfma_f32_16x16x32_bf16 v[56:59], v[132:135], v[160:163], v[56:59]
    ds_read_b64_tr_b16 v[130:131], v24 offset:2560
    v_fma_f32 v68, -v186, v212, v68
    v_fma_f32 v69, -v186, v213, v69
    v_mfma_f32_16x16x32_bf16 v[72:75], v[136:139], v[160:163], v[72:75]
    ds_read_b64_tr_b16 v[132:133], v25 offset:2048
    v_fma_f32 v70, -v186, v214, v70
    v_mfma_f32_16x16x32_bf16 v[76:79], v[136:139], v[164:167], v[76:79]
    ds_read_b64_tr_b16 v[134:135], v25 offset:2560
    v_fma_f32 v71, -v186, v215, v71
    v_mfma_f32_16x16x32_bf16 v[92:95], v[140:143], v[164:167], v[92:95]
    ds_read_b64_tr_b16 v[136:137], v24 offset:10240
    v_fma_f32 v80, -v184, v216, v80
    v_fma_f32 v81, -v184, v217, v81
    v_mfma_f32_16x16x32_bf16 v[88:91], v[140:143], v[160:163], v[88:91]
    ds_read_b64_tr_b16 v[138:139], v24 offset:10752
    v_fma_f32 v82, -v184, v218, v82
    v_mfma_f32_16x16x32_bf16 v[104:107], v[160:163], v[144:147], v[104:107]
    ds_read_b64_tr_b16 v[140:141], v25 offset:10240
    v_fma_f32 v83, -v184, v219, v83
    v_mfma_f32_16x16x32_bf16 v[108:111], v[164:167], v[144:147], v[108:111]
    ds_read_b64_tr_b16 v[142:143], v25 offset:10752
    v_fma_f32 v84, -v186, v216, v84
    v_fma_f32 v85, -v186, v217, v85
    v_mfma_f32_16x16x32_bf16 v[124:127], v[164:167], v[148:151], v[124:127]
    ds_read_b64_tr_b16 v[144:145], v24 offset:18432
    v_fma_f32 v86, -v186, v218, v86
    v_mfma_f32_16x16x32_bf16 v[120:123], v[160:163], v[148:151], v[120:123]
    ds_read_b64_tr_b16 v[146:147], v24 offset:18944
    v_fma_f32 v87, -v186, v219, v87
    s_waitcnt vmcnt(10) lgkmcnt(6)
    v_mfma_f32_16x16x32_bf16 v[32:35], v[128:131], v[168:171], v[32:35]
    ds_read_b64_tr_b16 v[148:149], v25 offset:18432
    v_fma_f32 v72, -v188, v212, v72
    v_fma_f32 v73, -v188, v213, v73
    v_mfma_f32_16x16x32_bf16 v[36:39], v[128:131], v[172:175], v[36:39]
    ds_read_b64_tr_b16 v[150:151], v25 offset:18944
    v_fma_f32 v74, -v188, v214, v74
    v_mfma_f32_16x16x32_bf16 v[52:55], v[132:135], v[172:175], v[52:55]
    v_fma_f32 v75, -v188, v215, v75
    ds_read_b128 v[152:155], v10 offset:384
    v_mfma_f32_16x16x32_bf16 v[48:51], v[132:135], v[168:171], v[48:51]
    v_fma_f32 v76, -v190, v212, v76
    v_fma_f32 v77, -v190, v213, v77
    ds_read_b128 v[156:159], v10 offset:448
    s_waitcnt lgkmcnt(6)
    v_mfma_f32_16x16x32_bf16 v[64:67], v[136:139], v[168:171], v[64:67]
    v_fma_f32 v78, -v190, v214, v78
    ds_read_b32 v185, v8 offset:2816
    v_mfma_f32_16x16x32_bf16 v[68:71], v[136:139], v[172:175], v[68:71]
    v_fma_f32 v79, -v190, v215, v79
    v_mfma_f32_16x16x32_bf16 v[84:87], v[140:143], v[172:175], v[84:87]
    v_fma_f32 v88, -v188, v216, v88
    v_fma_f32 v89, -v188, v217, v89
    ds_read_b32 v187, v8 offset:2880
    v_mfma_f32_16x16x32_bf16 v[80:83], v[140:143], v[168:171], v[80:83]
    v_fma_f32 v90, -v188, v218, v90
    ds_read_b32 v189, v8 offset:2944
    s_waitcnt lgkmcnt(5)
    v_mfma_f32_16x16x32_bf16 v[96:99], v[168:171], v[144:147], v[96:99]
    v_fma_f32 v91, -v188, v219, v91
    ds_read_b32 v191, v8 offset:3008
    v_mfma_f32_16x16x32_bf16 v[100:103], v[172:175], v[144:147], v[100:103]
    v_fma_f32 v92, -v190, v216, v92
    v_fma_f32 v93, -v190, v217, v93
    v_mfma_f32_16x16x32_bf16 v[116:119], v[172:175], v[148:151], v[116:119]
    v_fma_f32 v94, -v190, v218, v94
    v_mfma_f32_16x16x32_bf16 v[112:115], v[168:171], v[148:151], v[112:115]
    v_fma_f32 v95, -v190, v219, v95
    s_waitcnt vmcnt(8)
    v_mfma_f32_16x16x32_bf16 v[40:43], v[128:131], v[176:179], v[40:43]
    s_waitcnt lgkmcnt(0)
    v_fma_f32 v32, -v184, v152, v32
    v_fma_f32 v33, -v184, v153, v33
    v_mfma_f32_16x16x32_bf16 v[44:47], v[128:131], v[180:183], v[44:47]
    v_fma_f32 v34, -v184, v154, v34
    v_mfma_f32_16x16x32_bf16 v[60:63], v[132:135], v[180:183], v[60:63]
    ds_read_b64_tr_b16 v[128:129], v24 offset:4096
    v_fma_f32 v35, -v184, v155, v35
    v_fma_f32 v36, -v186, v152, v36
    v_mfma_f32_16x16x32_bf16 v[56:59], v[132:135], v[176:179], v[56:59]
    ds_read_b64_tr_b16 v[130:131], v24 offset:4608
    v_fma_f32 v37, -v186, v153, v37
    v_mfma_f32_16x16x32_bf16 v[72:75], v[136:139], v[176:179], v[72:75]
    ds_read_b64_tr_b16 v[132:133], v25 offset:4096
    v_fma_f32 v38, -v186, v154, v38
    v_fma_f32 v39, -v186, v155, v39
    v_mfma_f32_16x16x32_bf16 v[76:79], v[136:139], v[180:183], v[76:79]
    ds_read_b64_tr_b16 v[134:135], v25 offset:4608
    v_fma_f32 v48, -v184, v156, v48
    v_mfma_f32_16x16x32_bf16 v[92:95], v[140:143], v[180:183], v[92:95]
    ds_read_b64_tr_b16 v[136:137], v24 offset:12288
    v_fma_f32 v49, -v184, v157, v49
    v_fma_f32 v50, -v184, v158, v50
    v_mfma_f32_16x16x32_bf16 v[88:91], v[140:143], v[176:179], v[88:91]
    ds_read_b64_tr_b16 v[138:139], v24 offset:12800
    v_fma_f32 v51, -v184, v159, v51
    v_mfma_f32_16x16x32_bf16 v[104:107], v[176:179], v[144:147], v[104:107]
    ds_read_b64_tr_b16 v[140:141], v25 offset:12288
    v_fma_f32 v52, -v186, v156, v52
    v_fma_f32 v53, -v186, v157, v53
    v_mfma_f32_16x16x32_bf16 v[108:111], v[180:183], v[144:147], v[108:111]
    ds_read_b64_tr_b16 v[142:143], v25 offset:12800
    v_fma_f32 v54, -v186, v158, v54
    v_mfma_f32_16x16x32_bf16 v[124:127], v[180:183], v[148:151], v[124:127]
    ds_read_b64_tr_b16 v[144:145], v24 offset:20480
    v_fma_f32 v55, -v186, v159, v55
    v_mfma_f32_16x16x32_bf16 v[120:123], v[176:179], v[148:151], v[120:123]
    ds_read_b64_tr_b16 v[146:147], v24 offset:20992
    s_waitcnt vmcnt(6) lgkmcnt(6)
    v_mfma_f32_16x16x32_bf16 v[32:35], v[128:131], a[0:3], v[32:35]
    ds_read_b64_tr_b16 v[148:149], v25 offset:20480
    v_fma_f32 v40, -v188, v152, v40
    v_fma_f32 v41, -v188, v153, v41
    v_mfma_f32_16x16x32_bf16 v[36:39], v[128:131], a[4:7], v[36:39]
    ds_read_b64_tr_b16 v[150:151], v25 offset:20992
    v_fma_f32 v42, -v188, v154, v42
    v_mfma_f32_16x16x32_bf16 v[52:55], v[132:135], a[4:7], v[52:55]
    v_fma_f32 v43, -v188, v155, v43
    v_fma_f32 v44, -v190, v152, v44
    ds_read_b128 v[168:171], v9 offset:1280
    v_mfma_f32_16x16x32_bf16 v[48:51], v[132:135], a[0:3], v[48:51]
    v_fma_f32 v45, -v190, v153, v45
    ds_read_b128 v[172:175], v9 offset:1344
    s_waitcnt lgkmcnt(6)
    v_mfma_f32_16x16x32_bf16 v[64:67], v[136:139], a[0:3], v[64:67]
    v_fma_f32 v46, -v190, v154, v46
    v_fma_f32 v47, -v190, v155, v47
    v_mfma_f32_16x16x32_bf16 v[68:71], v[136:139], a[4:7], v[68:71]
    v_fma_f32 v56, -v188, v156, v56
    ds_read_b128 v[176:179], v9 offset:1408
    v_mfma_f32_16x16x32_bf16 v[84:87], v[140:143], a[4:7], v[84:87]
    v_fma_f32 v57, -v188, v157, v57
    v_fma_f32 v58, -v188, v158, v58
    ds_read_b128 v[180:183], v9 offset:1472
    v_mfma_f32_16x16x32_bf16 v[80:83], v[140:143], a[0:3], v[80:83]
    v_fma_f32 v59, -v188, v159, v59
    s_waitcnt lgkmcnt(4)
    v_mfma_f32_16x16x32_bf16 v[96:99], a[0:3], v[144:147], v[96:99]
    v_fma_f32 v60, -v190, v156, v60
    v_fma_f32 v61, -v190, v157, v61
    ds_read2_b32 v[220:221], v11 offset0:160 offset1:176
    v_mfma_f32_16x16x32_bf16 v[100:103], a[4:7], v[144:147], v[100:103]
    v_fma_f32 v62, -v190, v158, v62
    v_mfma_f32_16x16x32_bf16 v[116:119], a[4:7], v[148:151], v[116:119]
    v_fma_f32 v63, -v190, v159, v63
    v_mfma_f32_16x16x32_bf16 v[112:115], a[0:3], v[148:151], v[112:115]
    s_waitcnt vmcnt(4)
    v_mfma_f32_16x16x32_bf16 v[40:43], v[128:131], a[8:11], v[40:43]
    v_mfma_f32_16x16x32_bf16 v[44:47], v[128:131], a[12:15], v[44:47]
    s_waitcnt lgkmcnt(0)
    v_fma_f32 v96, -v168, v220, v96
    v_fma_f32 v97, -v169, v220, v97
    v_mfma_f32_16x16x32_bf16 v[60:63], v[132:135], a[12:15], v[60:63]
    ds_read_b64_tr_b16 v[128:129], v24 offset:6144
    v_fma_f32 v98, -v170, v220, v98
    v_mfma_f32_16x16x32_bf16 v[56:59], v[132:135], a[8:11], v[56:59]
    ds_read_b64_tr_b16 v[130:131], v24 offset:6656
    v_fma_f32 v99, -v171, v220, v99
    v_fma_f32 v100, -v172, v220, v100
    v_mfma_f32_16x16x32_bf16 v[72:75], v[136:139], a[8:11], v[72:75]
    ds_read_b64_tr_b16 v[132:133], v25 offset:6144
    v_fma_f32 v101, -v173, v220, v101
    v_mfma_f32_16x16x32_bf16 v[76:79], v[136:139], a[12:15], v[76:79]
    ds_read_b64_tr_b16 v[134:135], v25 offset:6656
    v_fma_f32 v102, -v174, v220, v102
    v_fma_f32 v103, -v175, v220, v103
    v_mfma_f32_16x16x32_bf16 v[92:95], v[140:143], a[12:15], v[92:95]
    ds_read_b64_tr_b16 v[136:137], v24 offset:14336
    v_fma_f32 v112, -v168, v221, v112
    v_mfma_f32_16x16x32_bf16 v[88:91], v[140:143], a[8:11], v[88:91]
    ds_read_b64_tr_b16 v[138:139], v24 offset:14848
    v_fma_f32 v113, -v169, v221, v113
    v_fma_f32 v114, -v170, v221, v114
    v_mfma_f32_16x16x32_bf16 v[104:107], a[8:11], v[144:147], v[104:107]
    ds_read_b64_tr_b16 v[140:141], v25 offset:14336
    v_fma_f32 v115, -v171, v221, v115
    v_mfma_f32_16x16x32_bf16 v[108:111], a[12:15], v[144:147], v[108:111]
    ds_read_b64_tr_b16 v[142:143], v25 offset:14848
    v_fma_f32 v116, -v172, v221, v116
    v_fma_f32 v117, -v173, v221, v117
    v_mfma_f32_16x16x32_bf16 v[124:127], a[12:15], v[148:151], v[124:127]
    ds_read_b64_tr_b16 v[144:145], v24 offset:22528
    v_fma_f32 v118, -v174, v221, v118
    v_mfma_f32_16x16x32_bf16 v[120:123], a[8:11], v[148:151], v[120:123]
    ds_read_b64_tr_b16 v[146:147], v24 offset:23040
    v_fma_f32 v119, -v175, v221, v119
    s_waitcnt vmcnt(2) lgkmcnt(6)
    v_mfma_f32_16x16x32_bf16 v[32:35], v[128:131], a[16:19], v[32:35]
    ds_read_b64_tr_b16 v[148:149], v25 offset:22528
    v_mfma_f32_16x16x32_bf16 v[36:39], v[128:131], a[20:23], v[36:39]
    ds_read_b64_tr_b16 v[150:151], v25 offset:23040
    v_fma_f32 v104, -v176, v220, v104
    v_fma_f32 v105, -v177, v220, v105
    v_mfma_f32_16x16x32_bf16 v[52:55], v[132:135], a[20:23], v[52:55]
    v_fma_f32 v106, -v178, v220, v106
    ds_read_b128 v[152:155], v9 offset:2816
    v_mfma_f32_16x16x32_bf16 v[48:51], v[132:135], a[16:19], v[48:51]
    v_fma_f32 v107, -v179, v220, v107
    v_fma_f32 v108, -v180, v220, v108
    s_waitcnt lgkmcnt(5)
    v_mfma_f32_16x16x32_bf16 v[64:67], v[136:139], a[16:19], v[64:67]
    v_fma_f32 v109, -v181, v220, v109
    ds_read_b128 v[156:159], v9 offset:2880
    v_mfma_f32_16x16x32_bf16 v[68:71], v[136:139], a[20:23], v[68:71]
    v_fma_f32 v110, -v182, v220, v110
    v_fma_f32 v111, -v183, v220, v111
    v_mfma_f32_16x16x32_bf16 v[84:87], v[140:143], a[20:23], v[84:87]
    v_fma_f32 v120, -v176, v221, v120
    ds_read_b128 v[160:163], v9 offset:2944
    v_mfma_f32_16x16x32_bf16 v[80:83], v[140:143], a[16:19], v[80:83]
    v_fma_f32 v121, -v177, v221, v121
    v_fma_f32 v122, -v178, v221, v122
    s_waitcnt lgkmcnt(3)
    v_mfma_f32_16x16x32_bf16 v[96:99], a[16:19], v[144:147], v[96:99]
    v_fma_f32 v123, -v179, v221, v123
    ds_read_b128 v[164:167], v9 offset:3008
    v_mfma_f32_16x16x32_bf16 v[100:103], a[20:23], v[144:147], v[100:103]
    v_fma_f32 v124, -v180, v221, v124
    v_fma_f32 v125, -v181, v221, v125
    v_mfma_f32_16x16x32_bf16 v[116:119], a[20:23], v[148:151], v[116:119]
    v_fma_f32 v126, -v182, v221, v126
    v_mfma_f32_16x16x32_bf16 v[112:115], a[16:19], v[148:151], v[112:115]
    v_fma_f32 v127, -v183, v221, v127
    s_barrier
    s_waitcnt vmcnt(0)
    v_mfma_f32_16x16x32_bf16 v[40:43], v[128:131], a[24:27], v[40:43]
    v_mul_f32 v64, v185, v64
    v_mul_f32 v65, v185, v65
    v_mfma_f32_16x16x32_bf16 v[44:47], v[128:131], a[28:31], v[44:47]
    v_mul_f32 v66, v185, v66
    v_mul_f32 v67, v185, v67
    v_mfma_f32_16x16x32_bf16 v[60:63], v[132:135], a[28:31], v[60:63]
    v_mul_f32 v80, v185, v80
    v_mul_f32 v81, v185, v81
    v_mfma_f32_16x16x32_bf16 v[56:59], v[132:135], a[24:27], v[56:59]
    v_mul_f32 v82, v185, v82
    v_mul_f32 v83, v185, v83
    v_mfma_f32_16x16x32_bf16 v[72:75], v[136:139], a[24:27], v[72:75]
    v_cvt_pk_bf16_f32 v64, v64, v65
    v_cvt_pk_bf16_f32 v65, v66, v67
    v_mfma_f32_16x16x32_bf16 v[76:79], v[136:139], a[28:31], v[76:79]
    v_cvt_pk_bf16_f32 v66, v80, v81
    v_cvt_pk_bf16_f32 v67, v82, v83
    v_mfma_f32_16x16x32_bf16 v[92:95], v[140:143], a[28:31], v[92:95]
    v_mul_f32 v68, v187, v68
    v_mul_f32 v69, v187, v69
    v_mfma_f32_16x16x32_bf16 v[88:91], v[140:143], a[24:27], v[88:91]
    v_mul_f32 v70, v187, v70
    v_mul_f32 v71, v187, v71
    v_mfma_f32_16x16x32_bf16 v[104:107], a[24:27], v[144:147], v[104:107]
    v_mul_f32 v84, v187, v84
    v_mul_f32 v85, v187, v85
    v_mfma_f32_16x16x32_bf16 v[108:111], a[28:31], v[144:147], v[108:111]
    v_mul_f32 v86, v187, v86
    v_mul_f32 v87, v187, v87
    v_mfma_f32_16x16x32_bf16 v[124:127], a[28:31], v[148:151], v[124:127]
    v_cvt_pk_bf16_f32 v68, v68, v69
    v_cvt_pk_bf16_f32 v69, v70, v71
    v_mfma_f32_16x16x32_bf16 v[120:123], a[24:27], v[148:151], v[120:123]
    v_cvt_pk_bf16_f32 v70, v84, v85
    v_cvt_pk_bf16_f32 v71, v86, v87
    buffer_store_dwordx4 v[64:67], v12, s[12:15], s84 offen offset:0 sc1
    ds_write_b128 v12, v[64:67] offset:0
    buffer_store_dwordx4 v[68:71], v12, s[12:15], s84 offen offset:256 sc1
    ds_write_b128 v12, v[68:71] offset:256
    v_pk_mul_f32 v[72:73], v[188:189], v[72:73] op_sel:[1,0] op_sel_hi:[1,1]
    v_pk_mul_f32 v[74:75], v[188:189], v[74:75] op_sel:[1,0] op_sel_hi:[1,1]
    v_pk_mul_f32 v[88:89], v[188:189], v[88:89] op_sel:[1,0] op_sel_hi:[1,1]
    v_pk_mul_f32 v[90:91], v[188:189], v[90:91] op_sel:[1,0] op_sel_hi:[1,1]
    v_cvt_pk_bf16_f32 v72, v72, v73
    v_cvt_pk_bf16_f32 v73, v74, v75
    v_cvt_pk_bf16_f32 v74, v88, v89
    v_cvt_pk_bf16_f32 v75, v90, v91
    buffer_store_dwordx4 v[72:75], v12, s[12:15], s84 offen offset:2048 sc1
    ds_write_b128 v12, v[72:75] offset:2048
    v_pk_mul_f32 v[76:77], v[190:191], v[76:77] op_sel:[1,0] op_sel_hi:[1,1]
    v_pk_mul_f32 v[78:79], v[190:191], v[78:79] op_sel:[1,0] op_sel_hi:[1,1]
    v_pk_mul_f32 v[92:93], v[190:191], v[92:93] op_sel:[1,0] op_sel_hi:[1,1]
    v_pk_mul_f32 v[94:95], v[190:191], v[94:95] op_sel:[1,0] op_sel_hi:[1,1]
    v_cvt_pk_bf16_f32 v76, v76, v77
    v_cvt_pk_bf16_f32 v77, v78, v79
    v_cvt_pk_bf16_f32 v78, v92, v93
    v_cvt_pk_bf16_f32 v79, v94, v95
    buffer_store_dwordx4 v[76:79], v12, s[12:15], s84 offen offset:2304 sc1
    ds_write_b128 v12, v[76:79] offset:2304
    s_waitcnt lgkmcnt(4)
    v_pk_mul_f32 v[96:97], v[152:153], v[96:97]
    v_pk_mul_f32 v[98:99], v[154:155], v[98:99]
    v_pk_mul_f32 v[112:113], v[152:153], v[112:113]
    v_pk_mul_f32 v[114:115], v[154:155], v[114:115]
    v_cvt_pk_bf16_f32 v96, v96, v97
    v_cvt_pk_bf16_f32 v97, v98, v99
    v_cvt_pk_bf16_f32 v98, v112, v113
    v_cvt_pk_bf16_f32 v99, v114, v115
    v_mul_f32 v185, 0x3e8293ee, v185
    v_permlane16_swap_b32 v96, v98
    v_permlane16_swap_b32 v97, v99
    buffer_store_dwordx4 v[96:99], v13, s[12:15], s85 offen offset:0 sc1
    ds_write_b128 v13, v[96:99] offset:8192
    v_pk_mul_f32 v[100:101], v[156:157], v[100:101]
    v_pk_mul_f32 v[102:103], v[158:159], v[102:103]
    v_pk_mul_f32 v[116:117], v[156:157], v[116:117]
    v_pk_mul_f32 v[118:119], v[158:159], v[118:119]
    v_cvt_pk_bf16_f32 v100, v100, v101
    v_cvt_pk_bf16_f32 v101, v102, v103
    v_cvt_pk_bf16_f32 v102, v116, v117
    v_cvt_pk_bf16_f32 v103, v118, v119
    v_mul_f32 v187, 0x3e8293ee, v187
    v_permlane16_swap_b32 v100, v102
    v_permlane16_swap_b32 v101, v103
    buffer_store_dwordx4 v[100:103], v13, s[12:15], s85 offen offset:1024 sc1
    ds_write_b128 v13, v[100:103] offset:9216
    v_pk_mul_f32 v[104:105], v[160:161], v[104:105]
    v_pk_mul_f32 v[106:107], v[162:163], v[106:107]
    v_pk_mul_f32 v[120:121], v[160:161], v[120:121]
    v_pk_mul_f32 v[122:123], v[162:163], v[122:123]
    v_cvt_pk_bf16_f32 v104, v104, v105
    v_cvt_pk_bf16_f32 v105, v106, v107
    v_cvt_pk_bf16_f32 v106, v120, v121
    v_cvt_pk_bf16_f32 v107, v122, v123
    v_mul_f32 v189, 0x3e8293ee, v189
    v_permlane16_swap_b32 v104, v106
    v_permlane16_swap_b32 v105, v107
    buffer_store_dwordx4 v[104:107], v13, s[12:15], s85 offen offset:2048 sc1
    ds_write_b128 v13, v[104:107] offset:10240
    v_pk_mul_f32 v[108:109], v[164:165], v[108:109]
    v_pk_mul_f32 v[110:111], v[166:167], v[110:111]
    v_pk_mul_f32 v[124:125], v[164:165], v[124:125]
    v_pk_mul_f32 v[126:127], v[166:167], v[126:127]
    v_cvt_pk_bf16_f32 v108, v108, v109
    v_cvt_pk_bf16_f32 v109, v110, v111
    v_cvt_pk_bf16_f32 v110, v124, v125
    v_cvt_pk_bf16_f32 v111, v126, v127
    v_mul_f32 v191, 0x3e8293ee, v191
    v_permlane16_swap_b32 v108, v110
    v_permlane16_swap_b32 v109, v111
    buffer_store_dwordx4 v[108:111], v13, s[12:15], s85 offen offset:3072 sc1
    ds_write_b128 v13, v[108:111] offset:11264
    v_add_u32 v24, 81920, v5
    s_waitcnt lgkmcnt(0)
    s_barrier
    ds_read_b128 v[128:131], v24 offset:0
    ds_read_b128 v[132:135], v24 offset:1024
    ds_read_b128 v[136:139], v24 offset:2048
    ds_read_b128 v[140:143], v24 offset:3072
    v_pk_mul_f32 v[32:33], v[184:185], v[32:33] op_sel:[1,0] op_sel_hi:[1,1]
    v_pk_mul_f32 v[34:35], v[184:185], v[34:35] op_sel:[1,0] op_sel_hi:[1,1]
    v_pk_mul_f32 v[48:49], v[184:185], v[48:49] op_sel:[1,0] op_sel_hi:[1,1]
    v_pk_mul_f32 v[50:51], v[184:185], v[50:51] op_sel:[1,0] op_sel_hi:[1,1]
    v_cvt_pk_bf16_f32 v8, v32, v33
    v_cvt_pk_bf16_f32 v9, v34, v35
    v_cvt_pk_bf16_f32 v10, v48, v49
    v_cvt_pk_bf16_f32 v11, v50, v51
    v_pk_mul_f32 v[36:37], v[186:187], v[36:37] op_sel:[1,0] op_sel_hi:[1,1]
    v_pk_mul_f32 v[38:39], v[186:187], v[38:39] op_sel:[1,0] op_sel_hi:[1,1]
    v_pk_mul_f32 v[52:53], v[186:187], v[52:53] op_sel:[1,0] op_sel_hi:[1,1]
    v_pk_mul_f32 v[54:55], v[186:187], v[54:55] op_sel:[1,0] op_sel_hi:[1,1]
    v_cvt_pk_bf16_f32 v12, v36, v37
    v_cvt_pk_bf16_f32 v13, v38, v39
    v_cvt_pk_bf16_f32 v14, v52, v53
    v_cvt_pk_bf16_f32 v15, v54, v55
    v_pk_mul_f32 v[40:41], v[188:189], v[40:41] op_sel:[1,0] op_sel_hi:[1,1]
    v_pk_mul_f32 v[42:43], v[188:189], v[42:43] op_sel:[1,0] op_sel_hi:[1,1]
    v_pk_mul_f32 v[56:57], v[188:189], v[56:57] op_sel:[1,0] op_sel_hi:[1,1]
    v_pk_mul_f32 v[58:59], v[188:189], v[58:59] op_sel:[1,0] op_sel_hi:[1,1]
    v_cvt_pk_bf16_f32 v16, v40, v41
    v_cvt_pk_bf16_f32 v17, v42, v43
    v_cvt_pk_bf16_f32 v18, v56, v57
    v_cvt_pk_bf16_f32 v19, v58, v59
    v_pk_mul_f32 v[44:45], v[190:191], v[44:45] op_sel:[1,0] op_sel_hi:[1,1]
    v_pk_mul_f32 v[46:47], v[190:191], v[46:47] op_sel:[1,0] op_sel_hi:[1,1]
    v_pk_mul_f32 v[60:61], v[190:191], v[60:61] op_sel:[1,0] op_sel_hi:[1,1]
    v_pk_mul_f32 v[62:63], v[190:191], v[62:63] op_sel:[1,0] op_sel_hi:[1,1]
    v_cvt_pk_bf16_f32 v20, v44, v45
    v_cvt_pk_bf16_f32 v21, v46, v47
    v_cvt_pk_bf16_f32 v22, v60, v61
    v_cvt_pk_bf16_f32 v23, v62, v63
    v_permlane16_swap_b32 v8, v12
    v_permlane16_swap_b32 v9, v13
    v_permlane16_swap_b32 v10, v14
    v_permlane16_swap_b32 v11, v15
    v_permlane16_swap_b32 v16, v20
    v_permlane16_swap_b32 v17, v21
    v_permlane16_swap_b32 v18, v22
    v_permlane16_swap_b32 v19, v23
    s_waitcnt lgkmcnt(0)
    v_mfma_f32_32x32x16_bf16 v[64:79], v[128:131], v[8:11], 0
    v_mfma_f32_32x32x16_bf16 v[64:79], v[132:135], v[12:15], v[64:79]
    v_and_b32 v25, 7, v1
    v_mov_b32 v26, 0x3f803f80
    v_cmp_eq_u32 vcc, 0, v25
    s_nop 1
    v_cndmask_b32 v200, 0, v26, vcc
    v_cndmask_b32 v201, 0, v26, vcc
    v_cmp_eq_u32 vcc, 4, v25
    s_nop 1
    v_cndmask_b32 v202, 0, v26, vcc
    v_cndmask_b32 v203, 0, v26, vcc
    v_mov_b32 v204, 0xdddddddd
    v_mov_b32 v160, 0
    v_mov_b32 v161, 0
    v_mov_b32 v162, 0
    v_mov_b32 v163, 0
    v_mov_b32 v164, 0
    v_mov_b32 v165, 0
    v_mov_b32 v166, 0
    v_mov_b32 v167, 0
    v_mov_b32 v168, 0
    v_mov_b32 v169, 0
    v_mov_b32 v170, 0
    v_mov_b32 v171, 0
    v_mov_b32 v172, 0
    v_mov_b32 v173, 0
    v_mov_b32 v174, 0
    v_mov_b32 v175, 0
    v_mov_b32 v192, 0
    v_mov_b32 v193, 0
    v_mov_b32 v194, 0
    v_mov_b32 v195, 0
    v_mov_b32 v176, 0
    v_mov_b32 v177, 0
    v_mov_b32 v178, 0
    v_mov_b32 v179, 0
    v_mov_b32 v180, 0
    v_mov_b32 v181, 0
    v_mov_b32 v182, 0
    v_mov_b32 v183, 0
    v_mov_b32 v184, 0
    v_mov_b32 v185, 0
    v_mov_b32 v186, 0
    v_mov_b32 v187, 0
    v_mov_b32 v188, 0
    v_mov_b32 v189, 0
    v_mov_b32 v190, 0
    v_mov_b32 v191, 0
    v_mov_b32 v196, 0
    v_mov_b32 v197, 0
    v_mov_b32 v198, 0
    v_mov_b32 v199, 0
    v_mov_b32 v112, 0
    v_mov_b32 v113, 0
    v_mov_b32 v114, 0
    v_mov_b32 v115, 0
    v_mov_b32 v116, 0
    v_mov_b32 v117, 0
    v_mov_b32 v118, 0
    v_mov_b32 v119, 0
    v_mov_b32 v120, 0
    v_mov_b32 v121, 0
    v_mov_b32 v122, 0
    v_mov_b32 v123, 0
    v_mov_b32 v124, 0
    v_mov_b32 v125, 0
    v_mov_b32 v126, 0
    v_mov_b32 v127, 0
    v_mov_b32 v152, 0
    v_mov_b32 v153, 0
    v_mov_b32 v154, 0
    v_mov_b32 v155, 0
    v_mov_b32 v156, 0
    v_mov_b32 v157, 0
    v_mov_b32 v158, 0
    v_mov_b32 v159, 0
    s_mov_b32 s54, 4
.p2align 3
c_attn_loop:
    v_mfma_f32_32x32x16_bf16 v[80:95], v[128:131], v[16:19], 0
    v_exp_f32 v64, v64
    v_exp_f32 v65, v65
    v_exp_f32 v66, v66
    v_mfma_f32_32x32x16_bf16 v[80:95], v[132:135], v[20:23], v[80:95]
    v_exp_f32 v67, v67
    v_exp_f32 v68, v68
    v_exp_f32 v69, v69
    v_smfmac_f32_32x32x32_bf16 v[176:191], v[152:155], v[112:119], v204
    s_waitcnt lgkmcnt(0)
    v_exp_f32 v70, v70
    v_exp_f32 v71, v71
    v_exp_f32 v72, v72
    v_smfmac_f32_16x16x64_bf16 v[196:199], v[200:203], v[112:119], v204
    ds_read_b128 v[144:147], v24 offset:8192
    v_exp_f32 v73, v73
    v_exp_f32 v74, v74
    v_smfmac_f32_32x32x32_bf16 v[176:191], v[156:159], v[120:127], v204
    v_exp_f32 v75, v75
    v_exp_f32 v76, v76
    v_exp_f32 v77, v77
    v_smfmac_f32_16x16x64_bf16 v[196:199], v[200:203], v[120:127], v204
    ds_read_b128 v[148:151], v24 offset:9216
    v_exp_f32 v78, v78
    v_exp_f32 v79, v79
    v_mfma_f32_32x32x16_bf16 v[96:111], v[136:139], v[8:11], 0
    v_exp_f32 v80, v80
    v_exp_f32 v81, v81
    v_exp_f32 v82, v82
    v_mfma_f32_32x32x16_bf16 v[96:111], v[140:143], v[12:15], v[96:111]
    s_waitcnt lgkmcnt(1)
    v_exp_f32 v83, v83
    v_exp_f32 v84, v84
    v_exp_f32 v85, v85
    v_smfmac_f32_32x32x32_bf16 v[160:175], v[144:147], v[64:71], v204
    s_waitcnt lgkmcnt(0)
    v_exp_f32 v86, v86
    v_exp_f32 v87, v87
    v_exp_f32 v88, v88
    v_smfmac_f32_16x16x64_bf16 v[192:195], v[200:203], v[64:71], v204
    ds_read_b128 v[128:131], v24 offset:4096
    v_exp_f32 v89, v89
    v_exp_f32 v90, v90
    v_smfmac_f32_32x32x32_bf16 v[160:175], v[148:151], v[72:79], v204
    v_exp_f32 v91, v91
    v_exp_f32 v92, v92
    v_exp_f32 v93, v93
    v_smfmac_f32_16x16x64_bf16 v[192:195], v[200:203], v[72:79], v204
    ds_read_b128 v[132:135], v24 offset:5120
    v_exp_f32 v94, v94
    v_exp_f32 v95, v95
    v_mfma_f32_32x32x16_bf16 v[112:127], v[136:139], v[16:19], 0
    s_cmp_eq_u32 s54, 4
    v_exp_f32 v96, v96
    v_exp_f32 v97, v97
    v_exp_f32 v98, v98
    v_mfma_f32_32x32x16_bf16 v[112:127], v[140:143], v[20:23], v[112:127]
    v_exp_f32 v99, v99
    v_exp_f32 v100, v100
    v_exp_f32 v101, v101
    v_smfmac_f32_32x32x32_bf16 v[176:191], v[144:147], v[80:87], v204
    s_waitcnt lgkmcnt(0)
    v_exp_f32 v102, v102
    v_exp_f32 v103, v103
    v_exp_f32 v104, v104
    v_smfmac_f32_16x16x64_bf16 v[196:199], v[200:203], v[80:87], v204
    ds_read_b128 v[152:155], v24 offset:10240
    v_exp_f32 v105, v105
    v_exp_f32 v106, v106
    v_smfmac_f32_32x32x32_bf16 v[176:191], v[148:151], v[88:95], v204
    v_exp_f32 v107, v107
    v_exp_f32 v108, v108
    v_exp_f32 v109, v109
    v_smfmac_f32_16x16x64_bf16 v[196:199], v[200:203], v[88:95], v204
    ds_read_b128 v[156:159], v24 offset:11264
    v_exp_f32 v110, v110
    v_exp_f32 v111, v111
    v_mfma_f32_32x32x16_bf16 v[64:79], v[128:131], v[8:11], 0
    s_cbranch_scc0 c_attn_nofl
    s_mov_b64 exec, 0xff
    s_waitcnt vmcnt(0)
    buffer_store_dword v29, v28, s[12:15], s53 offen sc1
    s_mov_b64 exec, -1
c_attn_nofl:
    v_exp_f32 v112, v112
    v_exp_f32 v113, v113
    v_exp_f32 v114, v114
    v_mfma_f32_32x32x16_bf16 v[64:79], v[132:135], v[12:15], v[64:79]
    s_waitcnt lgkmcnt(1)
    v_exp_f32 v115, v115
    v_exp_f32 v116, v116
    v_exp_f32 v117, v117
    v_smfmac_f32_32x32x32_bf16 v[160:175], v[152:155], v[96:103], v204
    s_waitcnt lgkmcnt(0)
    v_exp_f32 v118, v118
    v_exp_f32 v119, v119
    v_exp_f32 v120, v120
    v_smfmac_f32_16x16x64_bf16 v[192:195], v[200:203], v[96:103], v204
    ds_read_b128 v[136:139], v24 offset:6144
    v_exp_f32 v121, v121
    v_exp_f32 v122, v122
    v_smfmac_f32_32x32x32_bf16 v[160:175], v[156:159], v[104:111], v204
    v_exp_f32 v123, v123
    v_exp_f32 v124, v124
    v_exp_f32 v125, v125
    v_smfmac_f32_16x16x64_bf16 v[192:195], v[200:203], v[104:111], v204
    ds_read_b128 v[140:143], v24 offset:7168
    v_exp_f32 v126, v126
    v_exp_f32 v127, v127
    v_mfma_f32_32x32x16_bf16 v[80:95], v[128:131], v[16:19], 0
    s_cmp_eq_u32 s54, 4
    v_exp_f32 v64, v64
    v_exp_f32 v65, v65
    v_exp_f32 v66, v66
    v_mfma_f32_32x32x16_bf16 v[80:95], v[132:135], v[20:23], v[80:95]
    v_exp_f32 v67, v67
    v_exp_f32 v68, v68
    v_exp_f32 v69, v69
    v_smfmac_f32_32x32x32_bf16 v[176:191], v[152:155], v[112:119], v204
    s_waitcnt lgkmcnt(0)
    v_exp_f32 v70, v70
    v_exp_f32 v71, v71
    v_exp_f32 v72, v72
    v_smfmac_f32_16x16x64_bf16 v[196:199], v[200:203], v[112:119], v204
    ds_read_b128 v[144:147], v24 offset:12288
    v_exp_f32 v73, v73
    v_exp_f32 v74, v74
    v_smfmac_f32_32x32x32_bf16 v[176:191], v[156:159], v[120:127], v204
    v_exp_f32 v75, v75
    v_exp_f32 v76, v76
    v_exp_f32 v77, v77
    v_smfmac_f32_16x16x64_bf16 v[196:199], v[200:203], v[120:127], v204
    ds_read_b128 v[148:151], v24 offset:13312
    v_exp_f32 v78, v78
    v_exp_f32 v79, v79
    v_mfma_f32_32x32x16_bf16 v[96:111], v[136:139], v[8:11], 0
    s_cbranch_scc1 c_attn_nobar
    s_barrier
c_attn_nobar:
    v_exp_f32 v80, v80
    v_exp_f32 v81, v81
    v_exp_f32 v82, v82
    v_mfma_f32_32x32x16_bf16 v[96:111], v[140:143], v[12:15], v[96:111]
    s_waitcnt lgkmcnt(1)
    v_exp_f32 v83, v83
    v_exp_f32 v84, v84
    v_exp_f32 v85, v85
    v_smfmac_f32_32x32x32_bf16 v[160:175], v[144:147], v[64:71], v204
    s_waitcnt lgkmcnt(0)
    v_exp_f32 v86, v86
    v_exp_f32 v87, v87
    v_exp_f32 v88, v88
    v_smfmac_f32_16x16x64_bf16 v[192:195], v[200:203], v[64:71], v204
    ds_read_b128 v[128:131], v24 offset:16384
    v_exp_f32 v89, v89
    v_exp_f32 v90, v90
    v_smfmac_f32_32x32x32_bf16 v[160:175], v[148:151], v[72:79], v204
    v_exp_f32 v91, v91
    v_exp_f32 v92, v92
    v_exp_f32 v93, v93
    v_smfmac_f32_16x16x64_bf16 v[192:195], v[200:203], v[72:79], v204
    ds_read_b128 v[132:135], v24 offset:17408
    v_exp_f32 v94, v94
    v_exp_f32 v95, v95
    v_mfma_f32_32x32x16_bf16 v[112:127], v[136:139], v[16:19], 0
    v_exp_f32 v96, v96
    v_exp_f32 v97, v97
    v_exp_f32 v98, v98
    v_mfma_f32_32x32x16_bf16 v[112:127], v[140:143], v[20:23], v[112:127]
    v_exp_f32 v99, v99
    v_exp_f32 v100, v100
    v_exp_f32 v101, v101
    v_smfmac_f32_32x32x32_bf16 v[176:191], v[144:147], v[80:87], v204
    s_waitcnt lgkmcnt(0)
    v_exp_f32 v102, v102
    v_exp_f32 v103, v103
    v_exp_f32 v104, v104
    v_smfmac_f32_16x16x64_bf16 v[196:199], v[200:203], v[80:87], v204
    ds_read_b128 v[152:155], v24 offset:14336
    v_exp_f32 v105, v105
    v_exp_f32 v106, v106
    v_smfmac_f32_32x32x32_bf16 v[176:191], v[148:151], v[88:95], v204
    v_exp_f32 v107, v107
    v_exp_f32 v108, v108
    v_exp_f32 v109, v109
    v_smfmac_f32_16x16x64_bf16 v[196:199], v[200:203], v[88:95], v204
    ds_read_b128 v[156:159], v24 offset:15360
    v_exp_f32 v110, v110
    v_exp_f32 v111, v111
    v_mfma_f32_32x32x16_bf16 v[64:79], v[128:131], v[8:11], 0
    v_exp_f32 v112, v112
    v_exp_f32 v113, v113
    v_exp_f32 v114, v114
    v_mfma_f32_32x32x16_bf16 v[64:79], v[132:135], v[12:15], v[64:79]
    s_waitcnt lgkmcnt(1)
    v_exp_f32 v115, v115
    v_exp_f32 v116, v116
    v_exp_f32 v117, v117
    v_smfmac_f32_32x32x32_bf16 v[160:175], v[152:155], v[96:103], v204
    s_waitcnt lgkmcnt(0)
    v_exp_f32 v118, v118
    v_exp_f32 v119, v119
    v_exp_f32 v120, v120
    v_smfmac_f32_16x16x64_bf16 v[192:195], v[200:203], v[96:103], v204
    ds_read_b128 v[136:139], v24 offset:18432
    v_exp_f32 v121, v121
    v_exp_f32 v122, v122
    v_smfmac_f32_32x32x32_bf16 v[160:175], v[156:159], v[104:111], v204
    v_exp_f32 v123, v123
    v_exp_f32 v124, v124
    v_exp_f32 v125, v125
    v_smfmac_f32_16x16x64_bf16 v[192:195], v[200:203], v[104:111], v204
    ds_read_b128 v[140:143], v24 offset:19456
    v_exp_f32 v126, v126
    v_exp_f32 v127, v127
    v_mfma_f32_32x32x16_bf16 v[80:95], v[128:131], v[16:19], 0
    v_exp_f32 v64, v64
    v_exp_f32 v65, v65
    v_exp_f32 v66, v66
    v_mfma_f32_32x32x16_bf16 v[80:95], v[132:135], v[20:23], v[80:95]
    v_exp_f32 v67, v67
    v_exp_f32 v68, v68
    v_exp_f32 v69, v69
    v_smfmac_f32_32x32x32_bf16 v[176:191], v[152:155], v[112:119], v204
    s_waitcnt lgkmcnt(0)
    v_exp_f32 v70, v70
    v_exp_f32 v71, v71
    v_exp_f32 v72, v72
    v_smfmac_f32_16x16x64_bf16 v[196:199], v[200:203], v[112:119], v204
    ds_read_b128 v[144:147], v24 offset:24576
    v_exp_f32 v73, v73
    v_exp_f32 v74, v74
    v_smfmac_f32_32x32x32_bf16 v[176:191], v[156:159], v[120:127], v204
    v_exp_f32 v75, v75
    v_exp_f32 v76, v76
    v_exp_f32 v77, v77
    v_smfmac_f32_16x16x64_bf16 v[196:199], v[200:203], v[120:127], v204
    ds_read_b128 v[148:151], v24 offset:25600
    v_exp_f32 v78, v78
    v_exp_f32 v79, v79
    v_mfma_f32_32x32x16_bf16 v[96:111], v[136:139], v[8:11], 0
    v_exp_f32 v80, v80
    v_exp_f32 v81, v81
    v_exp_f32 v82, v82
    v_mfma_f32_32x32x16_bf16 v[96:111], v[140:143], v[12:15], v[96:111]
    s_waitcnt lgkmcnt(1)
    v_exp_f32 v83, v83
    v_exp_f32 v84, v84
    v_exp_f32 v85, v85
    v_smfmac_f32_32x32x32_bf16 v[160:175], v[144:147], v[64:71], v204
    s_waitcnt lgkmcnt(0)
    v_exp_f32 v86, v86
    v_exp_f32 v87, v87
    v_exp_f32 v88, v88
    v_smfmac_f32_16x16x64_bf16 v[192:195], v[200:203], v[64:71], v204
    ds_read_b128 v[128:131], v24 offset:20480
    v_exp_f32 v89, v89
    v_exp_f32 v90, v90
    v_smfmac_f32_32x32x32_bf16 v[160:175], v[148:151], v[72:79], v204
    v_exp_f32 v91, v91
    v_exp_f32 v92, v92
    v_exp_f32 v93, v93
    v_smfmac_f32_16x16x64_bf16 v[192:195], v[200:203], v[72:79], v204
    ds_read_b128 v[132:135], v24 offset:21504
    v_exp_f32 v94, v94
    v_exp_f32 v95, v95
    v_mfma_f32_32x32x16_bf16 v[112:127], v[136:139], v[16:19], 0
    v_exp_f32 v96, v96
    v_exp_f32 v97, v97
    v_exp_f32 v98, v98
    v_mfma_f32_32x32x16_bf16 v[112:127], v[140:143], v[20:23], v[112:127]
    v_exp_f32 v99, v99
    v_exp_f32 v100, v100
    v_exp_f32 v101, v101
    v_smfmac_f32_32x32x32_bf16 v[176:191], v[144:147], v[80:87], v204
    s_waitcnt lgkmcnt(0)
    v_exp_f32 v102, v102
    v_exp_f32 v103, v103
    v_exp_f32 v104, v104
    v_smfmac_f32_16x16x64_bf16 v[196:199], v[200:203], v[80:87], v204
    ds_read_b128 v[152:155], v24 offset:26624
    v_exp_f32 v105, v105
    v_exp_f32 v106, v106
    v_smfmac_f32_32x32x32_bf16 v[176:191], v[148:151], v[88:95], v204
    v_exp_f32 v107, v107
    v_exp_f32 v108, v108
    v_exp_f32 v109, v109
    v_smfmac_f32_16x16x64_bf16 v[196:199], v[200:203], v[88:95], v204
    ds_read_b128 v[156:159], v24 offset:27648
    v_exp_f32 v110, v110
    v_exp_f32 v111, v111
    v_mfma_f32_32x32x16_bf16 v[64:79], v[128:131], v[8:11], 0
    v_exp_f32 v112, v112
    v_exp_f32 v113, v113
    v_exp_f32 v114, v114
    v_mfma_f32_32x32x16_bf16 v[64:79], v[132:135], v[12:15], v[64:79]
    s_waitcnt lgkmcnt(1)
    v_exp_f32 v115, v115
    v_exp_f32 v116, v116
    v_exp_f32 v117, v117
    v_smfmac_f32_32x32x32_bf16 v[160:175], v[152:155], v[96:103], v204
    s_waitcnt lgkmcnt(0)
    v_exp_f32 v118, v118
    v_exp_f32 v119, v119
    v_exp_f32 v120, v120
    v_smfmac_f32_16x16x64_bf16 v[192:195], v[200:203], v[96:103], v204
    ds_read_b128 v[136:139], v24 offset:22528
    v_exp_f32 v121, v121
    v_exp_f32 v122, v122
    v_smfmac_f32_32x32x32_bf16 v[160:175], v[156:159], v[104:111], v204
    v_exp_f32 v123, v123
    v_exp_f32 v124, v124
    v_exp_f32 v125, v125
    v_smfmac_f32_16x16x64_bf16 v[192:195], v[200:203], v[104:111], v204
    ds_read_b128 v[140:143], v24 offset:23552
    v_exp_f32 v126, v126
    v_exp_f32 v127, v127
    v_mfma_f32_32x32x16_bf16 v[80:95], v[128:131], v[16:19], 0
    v_exp_f32 v64, v64
    v_exp_f32 v65, v65
    v_exp_f32 v66, v66
    v_mfma_f32_32x32x16_bf16 v[80:95], v[132:135], v[20:23], v[80:95]
    v_exp_f32 v67, v67
    v_exp_f32 v68, v68
    v_exp_f32 v69, v69
    v_smfmac_f32_32x32x32_bf16 v[176:191], v[152:155], v[112:119], v204
    s_waitcnt lgkmcnt(0)
    v_exp_f32 v70, v70
    v_exp_f32 v71, v71
    v_exp_f32 v72, v72
    v_smfmac_f32_16x16x64_bf16 v[196:199], v[200:203], v[112:119], v204
    ds_read_b128 v[144:147], v24 offset:28672
    v_exp_f32 v73, v73
    v_exp_f32 v74, v74
    v_smfmac_f32_32x32x32_bf16 v[176:191], v[156:159], v[120:127], v204
    v_exp_f32 v75, v75
    v_exp_f32 v76, v76
    v_exp_f32 v77, v77
    v_smfmac_f32_16x16x64_bf16 v[196:199], v[200:203], v[120:127], v204
    ds_read_b128 v[148:151], v24 offset:29696
    v_exp_f32 v78, v78
    v_exp_f32 v79, v79
    v_mfma_f32_32x32x16_bf16 v[96:111], v[136:139], v[8:11], 0
    v_exp_f32 v80, v80
    v_exp_f32 v81, v81
    v_exp_f32 v82, v82
    v_mfma_f32_32x32x16_bf16 v[96:111], v[140:143], v[12:15], v[96:111]
    s_waitcnt lgkmcnt(1)
    v_exp_f32 v83, v83
    v_exp_f32 v84, v84
    v_exp_f32 v85, v85
    v_smfmac_f32_32x32x32_bf16 v[160:175], v[144:147], v[64:71], v204
    s_waitcnt lgkmcnt(0)
    s_barrier
    v_exp_f32 v86, v86
    v_exp_f32 v87, v87
    v_exp_f32 v88, v88
    v_smfmac_f32_16x16x64_bf16 v[192:195], v[200:203], v[64:71], v204
    ds_read_b128 v[128:131], v24 offset:32768
    v_exp_f32 v89, v89
    v_exp_f32 v90, v90
    v_smfmac_f32_32x32x32_bf16 v[160:175], v[148:151], v[72:79], v204
    v_exp_f32 v91, v91
    v_exp_f32 v92, v92
    v_exp_f32 v93, v93
    v_smfmac_f32_16x16x64_bf16 v[192:195], v[200:203], v[72:79], v204
    ds_read_b128 v[132:135], v24 offset:33792
    v_exp_f32 v94, v94
    v_exp_f32 v95, v95
    v_mfma_f32_32x32x16_bf16 v[112:127], v[136:139], v[16:19], 0
    v_exp_f32 v96, v96
    v_exp_f32 v97, v97
    v_exp_f32 v98, v98
    v_mfma_f32_32x32x16_bf16 v[112:127], v[140:143], v[20:23], v[112:127]
    v_exp_f32 v99, v99
    v_exp_f32 v100, v100
    v_exp_f32 v101, v101
    v_smfmac_f32_32x32x32_bf16 v[176:191], v[144:147], v[80:87], v204
    s_waitcnt lgkmcnt(0)
    v_exp_f32 v102, v102
    v_exp_f32 v103, v103
    v_exp_f32 v104, v104
    v_smfmac_f32_16x16x64_bf16 v[196:199], v[200:203], v[80:87], v204
    ds_read_b128 v[152:155], v24 offset:30720
    v_exp_f32 v105, v105
    v_exp_f32 v106, v106
    v_smfmac_f32_32x32x32_bf16 v[176:191], v[148:151], v[88:95], v204
    v_exp_f32 v107, v107
    v_exp_f32 v108, v108
    v_exp_f32 v109, v109
    v_smfmac_f32_16x16x64_bf16 v[196:199], v[200:203], v[88:95], v204
    ds_read_b128 v[156:159], v24 offset:31744
    v_exp_f32 v110, v110
    v_exp_f32 v111, v111
    v_mfma_f32_32x32x16_bf16 v[64:79], v[128:131], v[8:11], 0
    v_exp_f32 v112, v112
    v_exp_f32 v113, v113
    v_exp_f32 v114, v114
    v_mfma_f32_32x32x16_bf16 v[64:79], v[132:135], v[12:15], v[64:79]
    s_waitcnt lgkmcnt(1)
    v_exp_f32 v115, v115
    v_exp_f32 v116, v116
    v_exp_f32 v117, v117
    v_smfmac_f32_32x32x32_bf16 v[160:175], v[152:155], v[96:103], v204
    s_waitcnt lgkmcnt(0)
    v_exp_f32 v118, v118
    v_exp_f32 v119, v119
    v_exp_f32 v120, v120
    v_smfmac_f32_16x16x64_bf16 v[192:195], v[200:203], v[96:103], v204
    ds_read_b128 v[136:139], v24 offset:34816
    v_exp_f32 v121, v121
    v_exp_f32 v122, v122
    v_smfmac_f32_32x32x32_bf16 v[160:175], v[156:159], v[104:111], v204
    v_exp_f32 v123, v123
    v_exp_f32 v124, v124
    v_exp_f32 v125, v125
    v_smfmac_f32_16x16x64_bf16 v[192:195], v[200:203], v[104:111], v204
    ds_read_b128 v[140:143], v24 offset:35840
    v_exp_f32 v126, v126
    v_exp_f32 v127, v127
    v_mfma_f32_32x32x16_bf16 v[80:95], v[128:131], v[16:19], 0
    v_exp_f32 v64, v64
    v_exp_f32 v65, v65
    v_exp_f32 v66, v66
    v_mfma_f32_32x32x16_bf16 v[80:95], v[132:135], v[20:23], v[80:95]
    v_exp_f32 v67, v67
    v_exp_f32 v68, v68
    v_exp_f32 v69, v69
    v_smfmac_f32_32x32x32_bf16 v[176:191], v[152:155], v[112:119], v204
    s_waitcnt lgkmcnt(0)
    v_exp_f32 v70, v70
    v_exp_f32 v71, v71
    v_exp_f32 v72, v72
    v_smfmac_f32_16x16x64_bf16 v[196:199], v[200:203], v[112:119], v204
    ds_read_b128 v[144:147], v24 offset:40960
    v_exp_f32 v73, v73
    v_exp_f32 v74, v74
    v_smfmac_f32_32x32x32_bf16 v[176:191], v[156:159], v[120:127], v204
    v_exp_f32 v75, v75
    v_exp_f32 v76, v76
    v_exp_f32 v77, v77
    v_smfmac_f32_16x16x64_bf16 v[196:199], v[200:203], v[120:127], v204
    ds_read_b128 v[148:151], v24 offset:41984
    v_exp_f32 v78, v78
    v_exp_f32 v79, v79
    v_mfma_f32_32x32x16_bf16 v[96:111], v[136:139], v[8:11], 0
    v_exp_f32 v80, v80
    v_exp_f32 v81, v81
    v_exp_f32 v82, v82
    v_mfma_f32_32x32x16_bf16 v[96:111], v[140:143], v[12:15], v[96:111]
    s_waitcnt lgkmcnt(1)
    v_exp_f32 v83, v83
    v_exp_f32 v84, v84
    v_exp_f32 v85, v85
    v_smfmac_f32_32x32x32_bf16 v[160:175], v[144:147], v[64:71], v204
    s_waitcnt lgkmcnt(0)
    v_exp_f32 v86, v86
    v_exp_f32 v87, v87
    v_exp_f32 v88, v88
    v_smfmac_f32_16x16x64_bf16 v[192:195], v[200:203], v[64:71], v204
    ds_read_b128 v[128:131], v24 offset:36864
    v_exp_f32 v89, v89
    v_exp_f32 v90, v90
    v_smfmac_f32_32x32x32_bf16 v[160:175], v[148:151], v[72:79], v204
    v_exp_f32 v91, v91
    v_exp_f32 v92, v92
    v_exp_f32 v93, v93
    v_smfmac_f32_16x16x64_bf16 v[192:195], v[200:203], v[72:79], v204
    ds_read_b128 v[132:135], v24 offset:37888
    v_exp_f32 v94, v94
    v_exp_f32 v95, v95
    v_mfma_f32_32x32x16_bf16 v[112:127], v[136:139], v[16:19], 0
    v_exp_f32 v96, v96
    v_exp_f32 v97, v97
    v_exp_f32 v98, v98
    v_mfma_f32_32x32x16_bf16 v[112:127], v[140:143], v[20:23], v[112:127]
    v_exp_f32 v99, v99
    v_exp_f32 v100, v100
    v_exp_f32 v101, v101
    v_smfmac_f32_32x32x32_bf16 v[176:191], v[144:147], v[80:87], v204
    s_waitcnt lgkmcnt(0)
    v_exp_f32 v102, v102
    v_exp_f32 v103, v103
    v_exp_f32 v104, v104
    v_smfmac_f32_16x16x64_bf16 v[196:199], v[200:203], v[80:87], v204
    ds_read_b128 v[152:155], v24 offset:43008
    v_exp_f32 v105, v105
    v_exp_f32 v106, v106
    v_smfmac_f32_32x32x32_bf16 v[176:191], v[148:151], v[88:95], v204
    v_exp_f32 v107, v107
    v_exp_f32 v108, v108
    v_exp_f32 v109, v109
    v_smfmac_f32_16x16x64_bf16 v[196:199], v[200:203], v[88:95], v204
    ds_read_b128 v[156:159], v24 offset:44032
    v_exp_f32 v110, v110
    v_exp_f32 v111, v111
    v_mfma_f32_32x32x16_bf16 v[64:79], v[128:131], v[8:11], 0
    v_exp_f32 v112, v112
    v_exp_f32 v113, v113
    v_exp_f32 v114, v114
    v_mfma_f32_32x32x16_bf16 v[64:79], v[132:135], v[12:15], v[64:79]
    s_waitcnt lgkmcnt(1)
    v_exp_f32 v115, v115
    v_exp_f32 v116, v116
    v_exp_f32 v117, v117
    v_smfmac_f32_32x32x32_bf16 v[160:175], v[152:155], v[96:103], v204
    s_waitcnt lgkmcnt(0)
    v_exp_f32 v118, v118
    v_exp_f32 v119, v119
    v_exp_f32 v120, v120
    v_smfmac_f32_16x16x64_bf16 v[192:195], v[200:203], v[96:103], v204
    ds_read_b128 v[136:139], v24 offset:38912
    v_exp_f32 v121, v121
    v_exp_f32 v122, v122
    v_smfmac_f32_32x32x32_bf16 v[160:175], v[156:159], v[104:111], v204
    v_exp_f32 v123, v123
    v_exp_f32 v124, v124
    v_exp_f32 v125, v125
    v_smfmac_f32_16x16x64_bf16 v[192:195], v[200:203], v[104:111], v204
    ds_read_b128 v[140:143], v24 offset:39936
    v_exp_f32 v126, v126
    v_exp_f32 v127, v127
    v_mfma_f32_32x32x16_bf16 v[80:95], v[128:131], v[16:19], 0
    v_exp_f32 v64, v64
    v_exp_f32 v65, v65
    v_exp_f32 v66, v66
    v_mfma_f32_32x32x16_bf16 v[80:95], v[132:135], v[20:23], v[80:95]
    v_exp_f32 v67, v67
    v_exp_f32 v68, v68
    v_exp_f32 v69, v69
    v_smfmac_f32_32x32x32_bf16 v[176:191], v[152:155], v[112:119], v204
    s_waitcnt lgkmcnt(0)
    v_exp_f32 v70, v70
    v_exp_f32 v71, v71
    v_exp_f32 v72, v72
    v_smfmac_f32_16x16x64_bf16 v[196:199], v[200:203], v[112:119], v204
    ds_read_b128 v[144:147], v24 offset:45056
    v_exp_f32 v73, v73
    v_exp_f32 v74, v74
    v_smfmac_f32_32x32x32_bf16 v[176:191], v[156:159], v[120:127], v204
    v_exp_f32 v75, v75
    v_exp_f32 v76, v76
    v_exp_f32 v77, v77
    v_smfmac_f32_16x16x64_bf16 v[196:199], v[200:203], v[120:127], v204
    ds_read_b128 v[148:151], v24 offset:46080
    v_exp_f32 v78, v78
    v_exp_f32 v79, v79
    v_mfma_f32_32x32x16_bf16 v[96:111], v[136:139], v[8:11], 0
    v_exp_f32 v80, v80
    v_exp_f32 v81, v81
    v_exp_f32 v82, v82
    v_mfma_f32_32x32x16_bf16 v[96:111], v[140:143], v[12:15], v[96:111]
    s_waitcnt lgkmcnt(1)
    v_exp_f32 v83, v83
    v_exp_f32 v84, v84
    v_exp_f32 v85, v85
    v_smfmac_f32_32x32x32_bf16 v[160:175], v[144:147], v[64:71], v204
    s_waitcnt lgkmcnt(0)
    s_barrier
    v_exp_f32 v86, v86
    v_exp_f32 v87, v87
    v_exp_f32 v88, v88
    v_smfmac_f32_16x16x64_bf16 v[192:195], v[200:203], v[64:71], v204
    ds_read_b128 v[128:131], v24 offset:49152
    v_exp_f32 v89, v89
    v_exp_f32 v90, v90
    v_smfmac_f32_32x32x32_bf16 v[160:175], v[148:151], v[72:79], v204
    v_exp_f32 v91, v91
    v_exp_f32 v92, v92
    v_exp_f32 v93, v93
    v_smfmac_f32_16x16x64_bf16 v[192:195], v[200:203], v[72:79], v204
    ds_read_b128 v[132:135], v24 offset:50176
    v_exp_f32 v94, v94
    v_exp_f32 v95, v95
    v_mfma_f32_32x32x16_bf16 v[112:127], v[136:139], v[16:19], 0
    v_exp_f32 v96, v96
    v_exp_f32 v97, v97
    v_exp_f32 v98, v98
    v_mfma_f32_32x32x16_bf16 v[112:127], v[140:143], v[20:23], v[112:127]
    v_exp_f32 v99, v99
    v_exp_f32 v100, v100
    v_exp_f32 v101, v101
    v_smfmac_f32_32x32x32_bf16 v[176:191], v[144:147], v[80:87], v204
    s_waitcnt lgkmcnt(0)
    v_exp_f32 v102, v102
    v_exp_f32 v103, v103
    v_exp_f32 v104, v104
    v_smfmac_f32_16x16x64_bf16 v[196:199], v[200:203], v[80:87], v204
    ds_read_b128 v[152:155], v24 offset:47104
    v_exp_f32 v105, v105
    v_exp_f32 v106, v106
    v_smfmac_f32_32x32x32_bf16 v[176:191], v[148:151], v[88:95], v204
    v_exp_f32 v107, v107
    v_exp_f32 v108, v108
    v_exp_f32 v109, v109
    v_smfmac_f32_16x16x64_bf16 v[196:199], v[200:203], v[88:95], v204
    ds_read_b128 v[156:159], v24 offset:48128
    v_exp_f32 v110, v110
    v_exp_f32 v111, v111
    v_mfma_f32_32x32x16_bf16 v[64:79], v[128:131], v[8:11], 0
    v_exp_f32 v112, v112
    v_exp_f32 v113, v113
    v_exp_f32 v114, v114
    v_mfma_f32_32x32x16_bf16 v[64:79], v[132:135], v[12:15], v[64:79]
    s_waitcnt lgkmcnt(1)
    v_exp_f32 v115, v115
    v_exp_f32 v116, v116
    v_exp_f32 v117, v117
    v_smfmac_f32_32x32x32_bf16 v[160:175], v[152:155], v[96:103], v204
    s_waitcnt lgkmcnt(0)
    v_exp_f32 v118, v118
    v_exp_f32 v119, v119
    v_exp_f32 v120, v120
    v_smfmac_f32_16x16x64_bf16 v[192:195], v[200:203], v[96:103], v204
    ds_read_b128 v[136:139], v24 offset:51200
    v_exp_f32 v121, v121
    v_exp_f32 v122, v122
    v_smfmac_f32_32x32x32_bf16 v[160:175], v[156:159], v[104:111], v204
    v_exp_f32 v123, v123
    v_exp_f32 v124, v124
    v_exp_f32 v125, v125
    v_smfmac_f32_16x16x64_bf16 v[192:195], v[200:203], v[104:111], v204
    ds_read_b128 v[140:143], v24 offset:52224
    v_exp_f32 v126, v126
    v_exp_f32 v127, v127
    v_mfma_f32_32x32x16_bf16 v[80:95], v[128:131], v[16:19], 0
    v_exp_f32 v64, v64
    v_exp_f32 v65, v65
    v_exp_f32 v66, v66
    v_mfma_f32_32x32x16_bf16 v[80:95], v[132:135], v[20:23], v[80:95]
    v_exp_f32 v67, v67
    v_exp_f32 v68, v68
    v_exp_f32 v69, v69
    v_smfmac_f32_32x32x32_bf16 v[176:191], v[152:155], v[112:119], v204
    s_waitcnt lgkmcnt(0)
    v_exp_f32 v70, v70
    v_exp_f32 v71, v71
    v_exp_f32 v72, v72
    v_smfmac_f32_16x16x64_bf16 v[196:199], v[200:203], v[112:119], v204
    ds_read_b128 v[144:147], v24 offset:57344
    v_exp_f32 v73, v73
    v_exp_f32 v74, v74
    v_smfmac_f32_32x32x32_bf16 v[176:191], v[156:159], v[120:127], v204
    v_exp_f32 v75, v75
    v_exp_f32 v76, v76
    v_exp_f32 v77, v77
    v_smfmac_f32_16x16x64_bf16 v[196:199], v[200:203], v[120:127], v204
    ds_read_b128 v[148:151], v24 offset:58368
    v_exp_f32 v78, v78
    v_exp_f32 v79, v79
    v_mfma_f32_32x32x16_bf16 v[96:111], v[136:139], v[8:11], 0
    v_exp_f32 v80, v80
    v_exp_f32 v81, v81
    v_exp_f32 v82, v82
    v_mfma_f32_32x32x16_bf16 v[96:111], v[140:143], v[12:15], v[96:111]
    s_waitcnt lgkmcnt(1)
    v_exp_f32 v83, v83
    v_exp_f32 v84, v84
    v_exp_f32 v85, v85
    v_smfmac_f32_32x32x32_bf16 v[160:175], v[144:147], v[64:71], v204
    s_waitcnt lgkmcnt(0)
    v_exp_f32 v86, v86
    v_exp_f32 v87, v87
    v_exp_f32 v88, v88
    v_smfmac_f32_16x16x64_bf16 v[192:195], v[200:203], v[64:71], v204
    ds_read_b128 v[128:131], v24 offset:53248
    v_exp_f32 v89, v89
    v_exp_f32 v90, v90
    v_smfmac_f32_32x32x32_bf16 v[160:175], v[148:151], v[72:79], v204
    v_exp_f32 v91, v91
    v_exp_f32 v92, v92
    v_exp_f32 v93, v93
    v_smfmac_f32_16x16x64_bf16 v[192:195], v[200:203], v[72:79], v204
    ds_read_b128 v[132:135], v24 offset:54272
    v_exp_f32 v94, v94
    v_exp_f32 v95, v95
    v_mfma_f32_32x32x16_bf16 v[112:127], v[136:139], v[16:19], 0
    v_exp_f32 v96, v96
    v_exp_f32 v97, v97
    v_exp_f32 v98, v98
    v_mfma_f32_32x32x16_bf16 v[112:127], v[140:143], v[20:23], v[112:127]
    v_exp_f32 v99, v99
    v_exp_f32 v100, v100
    v_exp_f32 v101, v101
    v_smfmac_f32_32x32x32_bf16 v[176:191], v[144:147], v[80:87], v204
    s_waitcnt lgkmcnt(0)
    v_exp_f32 v102, v102
    v_exp_f32 v103, v103
    v_exp_f32 v104, v104
    v_smfmac_f32_16x16x64_bf16 v[196:199], v[200:203], v[80:87], v204
    ds_read_b128 v[152:155], v24 offset:59392
    v_exp_f32 v105, v105
    v_exp_f32 v106, v106
    v_smfmac_f32_32x32x32_bf16 v[176:191], v[148:151], v[88:95], v204
    v_exp_f32 v107, v107
    v_exp_f32 v108, v108
    v_exp_f32 v109, v109
    v_smfmac_f32_16x16x64_bf16 v[196:199], v[200:203], v[88:95], v204
    ds_read_b128 v[156:159], v24 offset:60416
    v_exp_f32 v110, v110
    v_exp_f32 v111, v111
    v_mfma_f32_32x32x16_bf16 v[64:79], v[128:131], v[8:11], 0
    v_exp_f32 v112, v112
    v_exp_f32 v113, v113
    v_exp_f32 v114, v114
    v_mfma_f32_32x32x16_bf16 v[64:79], v[132:135], v[12:15], v[64:79]
    s_waitcnt lgkmcnt(1)
    v_exp_f32 v115, v115
    v_exp_f32 v116, v116
    v_exp_f32 v117, v117
    v_smfmac_f32_32x32x32_bf16 v[160:175], v[152:155], v[96:103], v204
    s_waitcnt lgkmcnt(0)
    v_exp_f32 v118, v118
    v_exp_f32 v119, v119
    v_exp_f32 v120, v120
    v_smfmac_f32_16x16x64_bf16 v[192:195], v[200:203], v[96:103], v204
    ds_read_b128 v[136:139], v24 offset:55296
    v_exp_f32 v121, v121
    v_exp_f32 v122, v122
    v_smfmac_f32_32x32x32_bf16 v[160:175], v[156:159], v[104:111], v204
    v_exp_f32 v123, v123
    v_exp_f32 v124, v124
    v_exp_f32 v125, v125
    v_smfmac_f32_16x16x64_bf16 v[192:195], v[200:203], v[104:111], v204
    ds_read_b128 v[140:143], v24 offset:56320
    v_exp_f32 v126, v126
    v_exp_f32 v127, v127
    v_mfma_f32_32x32x16_bf16 v[80:95], v[128:131], v[16:19], 0
    v_exp_f32 v64, v64
    v_exp_f32 v65, v65
    v_exp_f32 v66, v66
    v_mfma_f32_32x32x16_bf16 v[80:95], v[132:135], v[20:23], v[80:95]
    v_exp_f32 v67, v67
    v_exp_f32 v68, v68
    v_exp_f32 v69, v69
    v_smfmac_f32_32x32x32_bf16 v[176:191], v[152:155], v[112:119], v204
    s_waitcnt lgkmcnt(0)
    v_exp_f32 v70, v70
    v_exp_f32 v71, v71
    v_exp_f32 v72, v72
    v_smfmac_f32_16x16x64_bf16 v[196:199], v[200:203], v[112:119], v204
    ds_read_b128 v[144:147], v24 offset:61440
    v_exp_f32 v73, v73
    v_exp_f32 v74, v74
    v_smfmac_f32_32x32x32_bf16 v[176:191], v[156:159], v[120:127], v204
    v_exp_f32 v75, v75
    v_exp_f32 v76, v76
    v_exp_f32 v77, v77
    v_smfmac_f32_16x16x64_bf16 v[196:199], v[200:203], v[120:127], v204
    ds_read_b128 v[148:151], v24 offset:62464
    v_exp_f32 v78, v78
    v_exp_f32 v79, v79
    v_mfma_f32_32x32x16_bf16 v[96:111], v[136:139], v[8:11], 0
    v_exp_f32 v80, v80
    v_exp_f32 v81, v81
    v_exp_f32 v82, v82
    v_mfma_f32_32x32x16_bf16 v[96:111], v[140:143], v[12:15], v[96:111]
    s_waitcnt lgkmcnt(1)
    v_exp_f32 v83, v83
    v_exp_f32 v84, v84
    v_exp_f32 v85, v85
    v_smfmac_f32_32x32x32_bf16 v[160:175], v[144:147], v[64:71], v204
    s_waitcnt lgkmcnt(0)
    s_barrier
    v_exp_f32 v86, v86
    v_exp_f32 v87, v87
    v_exp_f32 v88, v88
    v_smfmac_f32_16x16x64_bf16 v[192:195], v[200:203], v[64:71], v204
    ds_read_b128 v[128:131], v24 offset:0
    v_exp_f32 v89, v89
    v_exp_f32 v90, v90
    v_smfmac_f32_32x32x32_bf16 v[160:175], v[148:151], v[72:79], v204
    v_exp_f32 v91, v91
    v_exp_f32 v92, v92
    v_exp_f32 v93, v93
    v_smfmac_f32_16x16x64_bf16 v[192:195], v[200:203], v[72:79], v204
    ds_read_b128 v[132:135], v24 offset:1024
    v_exp_f32 v94, v94
    v_exp_f32 v95, v95
    v_mfma_f32_32x32x16_bf16 v[112:127], v[136:139], v[16:19], 0
    v_exp_f32 v96, v96
    v_exp_f32 v97, v97
    v_exp_f32 v98, v98
    v_mfma_f32_32x32x16_bf16 v[112:127], v[140:143], v[20:23], v[112:127]
    v_exp_f32 v99, v99
    v_exp_f32 v100, v100
    v_exp_f32 v101, v101
    v_smfmac_f32_32x32x32_bf16 v[176:191], v[144:147], v[80:87], v204
    s_waitcnt lgkmcnt(0)
    v_exp_f32 v102, v102
    v_exp_f32 v103, v103
    v_exp_f32 v104, v104
    v_smfmac_f32_16x16x64_bf16 v[196:199], v[200:203], v[80:87], v204
    ds_read_b128 v[152:155], v24 offset:63488
    v_exp_f32 v105, v105
    v_exp_f32 v106, v106
    v_smfmac_f32_32x32x32_bf16 v[176:191], v[148:151], v[88:95], v204
    v_exp_f32 v107, v107
    v_exp_f32 v108, v108
    v_exp_f32 v109, v109
    v_smfmac_f32_16x16x64_bf16 v[196:199], v[200:203], v[88:95], v204
    ds_read_b128 v[156:159], v24 offset:64512
    v_exp_f32 v110, v110
    v_exp_f32 v111, v111
    v_mfma_f32_32x32x16_bf16 v[64:79], v[128:131], v[8:11], 0
    s_sub_u32 s54, s54, 1
    v_exp_f32 v112, v112
    v_exp_f32 v113, v113
    v_exp_f32 v114, v114
    v_mfma_f32_32x32x16_bf16 v[64:79], v[132:135], v[12:15], v[64:79]
    s_waitcnt lgkmcnt(1)
    v_exp_f32 v115, v115
    v_exp_f32 v116, v116
    v_exp_f32 v117, v117
    v_smfmac_f32_32x32x32_bf16 v[160:175], v[152:155], v[96:103], v204
    s_waitcnt lgkmcnt(0)
    v_exp_f32 v118, v118
    v_exp_f32 v119, v119
    v_exp_f32 v120, v120
    v_smfmac_f32_16x16x64_bf16 v[192:195], v[200:203], v[96:103], v204
    ds_read_b128 v[136:139], v24 offset:2048
    v_exp_f32 v121, v121
    v_exp_f32 v122, v122
    v_smfmac_f32_32x32x32_bf16 v[160:175], v[156:159], v[104:111], v204
    s_cmp_lg_u32 s54, 0
    v_exp_f32 v123, v123
    v_exp_f32 v124, v124
    v_exp_f32 v125, v125
    v_smfmac_f32_16x16x64_bf16 v[192:195], v[200:203], v[104:111], v204
    ds_read_b128 v[140:143], v24 offset:3072
    v_exp_f32 v126, v126
    v_exp_f32 v127, v127
    s_cbranch_scc1 c_attn_loop
    v_smfmac_f32_16x16x64_bf16 v[196:199], v[200:203], v[112:119], v204
    v_smfmac_f32_16x16x64_bf16 v[196:199], v[200:203], v[120:127], v204
    v_smfmac_f32_32x32x32_bf16 v[176:191], v[152:155], v[112:119], v204
    v_smfmac_f32_32x32x32_bf16 v[176:191], v[156:159], v[120:127], v204
    v_mov_b32 v25, 0x5f000000
    v_mov_b32 v26, 0x2b800000
    v_cmp_lt_f32 s[56:57], v192, v25
    v_cmp_gt_f32 vcc, v192, v26
    s_and_b64 s[56:57], s[56:57], vcc
    s_nop 0
    v_cmp_lt_f32 vcc, v196, v25
    s_and_b64 s[56:57], s[56:57], vcc
    v_cmp_gt_f32 vcc, v196, v26
    s_and_b64 s[56:57], s[56:57], vcc
    s_cmp_lg_u64 s[56:57], -1
    s_cbranch_scc1 c_attn_slow
c_attn_fin:
    s_lshl_b32 s3, s48, 17
    s_lshl_b32 s55, s7, 12
    s_add_u32 s3, s3, s55
    s_and_b32 s55, s6, 1
    s_lshl_b32 s55, s55, 11
    s_add_u32 s3, s3, s55
    s_lshl_b32 s55, s9, 22
    s_add_u32 s3, s3, s55
    s_add_u32 s3, s3, 16777216
    v_rcp_f32 v192, v192
    s_nop 0
    v_pk_mul_f32 v[160:161], v[192:193], v[160:161] op_sel_hi:[0,1]
    v_pk_mul_f32 v[162:163], v[192:193], v[162:163] op_sel_hi:[0,1]
    v_pk_mul_f32 v[164:165], v[192:193], v[164:165] op_sel_hi:[0,1]
    v_pk_mul_f32 v[166:167], v[192:193], v[166:167] op_sel_hi:[0,1]
    v_pk_mul_f32 v[168:169], v[192:193], v[168:169] op_sel_hi:[0,1]
    v_pk_mul_f32 v[170:171], v[192:193], v[170:171] op_sel_hi:[0,1]
    v_pk_mul_f32 v[172:173], v[192:193], v[172:173] op_sel_hi:[0,1]
    v_pk_mul_f32 v[174:175], v[192:193], v[174:175] op_sel_hi:[0,1]
    v_cvt_pk_bf16_f32 v160, v160, v161
    v_cvt_pk_bf16_f32 v161, v162, v163
    v_cvt_pk_bf16_f32 v162, v164, v165
    v_cvt_pk_bf16_f32 v163, v166, v167
    v_cvt_pk_bf16_f32 v164, v168, v169
    v_cvt_pk_bf16_f32 v165, v170, v171
    v_cvt_pk_bf16_f32 v166, v172, v173
    v_cvt_pk_bf16_f32 v167, v174, v175
    buffer_store_dwordx4 v[160:163], v5, s[12:15], s3 offen offset:0 sc1
    buffer_store_dwordx4 v[164:167], v5, s[12:15], s3 offen offset:1024 sc1
    s_add_u32 s3, s3, 65536
    v_rcp_f32 v196, v196
    s_nop 0
    v_pk_mul_f32 v[176:177], v[196:197], v[176:177] op_sel_hi:[0,1]
    v_pk_mul_f32 v[178:179], v[196:197], v[178:179] op_sel_hi:[0,1]
    v_pk_mul_f32 v[180:181], v[196:197], v[180:181] op_sel_hi:[0,1]
    v_pk_mul_f32 v[182:183], v[196:197], v[182:183] op_sel_hi:[0,1]
    v_pk_mul_f32 v[184:185], v[196:197], v[184:185] op_sel_hi:[0,1]
    v_pk_mul_f32 v[186:187], v[196:197], v[186:187] op_sel_hi:[0,1]
    v_pk_mul_f32 v[188:189], v[196:197], v[188:189] op_sel_hi:[0,1]
    v_pk_mul_f32 v[190:191], v[196:197], v[190:191] op_sel_hi:[0,1]
    v_cvt_pk_bf16_f32 v176, v176, v177
    v_cvt_pk_bf16_f32 v177, v178, v179
    v_cvt_pk_bf16_f32 v178, v180, v181
    v_cvt_pk_bf16_f32 v179, v182, v183
    v_cvt_pk_bf16_f32 v180, v184, v185
    v_cvt_pk_bf16_f32 v181, v186, v187
    v_cvt_pk_bf16_f32 v182, v188, v189
    v_cvt_pk_bf16_f32 v183, v190, v191
    buffer_store_dwordx4 v[176:179], v5, s[12:15], s3 offen offset:0 sc1
    buffer_store_dwordx4 v[180:183], v5, s[12:15], s3 offen offset:1024 sc1
    s_add_u32 s3, s3, 65536
    s_branch c_wo
.p2align 6
h_first_tail:
    s_waitcnt vmcnt(0)
    s_sub_u32 s50, s50, 8000
    s_load_dword s10, s[46:47], 0
    s_waitcnt lgkmcnt(0)
    s_sub_u32 s51, s10, s50
    s_and_b32 s3, s10, 1
    s_cselect_b32 s51, s51, -1
    s_cmp_ge_i32 s51, 0
    s_cbranch_scc1 h_first_non_ok
    s_load_dword s10, s[46:47], 128
    s_waitcnt lgkmcnt(0)
    s_sub_u32 s51, s10, s50
    s_and_b32 s3, s10, 1
    s_cselect_b32 s51, s51, -1
    s_cmp_ge_i32 s51, 0
    s_cbranch_scc1 h_first_non_ok
    s_load_dword s10, s[46:47], 64
    s_waitcnt lgkmcnt(0)
    s_sub_u32 s51, s10, s50
    s_and_b32 s3, s10, 1
    s_cselect_b32 s51, s51, -1
    s_cmp_ge_i32 s51, 0
    s_cbranch_scc1 h_first_non_ok
    s_load_dword s10, s[46:47], 192
    s_waitcnt lgkmcnt(0)
    s_sub_u32 s51, s10, s50
    s_and_b32 s3, s10, 1
    s_cselect_b32 s51, s51, -1
    s_cmp_ge_i32 s51, 0
    s_cbranch_scc1 h_first_non_ok
    s_mov_b32 s58, 0
    s_and_b32 s57, s2, 0xc0
h_first_non:
    s_load_dword s10, s[46:47], s57 glc
    s_waitcnt lgkmcnt(0)
    s_sub_u32 s51, s10, s50
    s_and_b32 s3, s10, 1
    s_cselect_b32 s51, s51, -1
    s_cmp_ge_i32 s51, 0
    s_cbranch_scc1 h_first_non_ok
    s_add_u32 s58, s58, 1
    s_cmp_gt_u32 s58, 100
    s_cselect_b32 s50, s10, s50
    s_cmp_lt_u32 s58, 0x100000
    s_cbranch_scc1 h_first_non
    s_mov_b32 s10, 1
h_first_non_ok:
    v_mov_b32 v12, s10
    ds_write_b32 v10, v12 offset:4
    v_lshlrev_b32 v13, 7, v1
    s_lshl_b32 s50, s2, 13
    s_mov_b32 s28, s36
    s_mov_b32 s29, s37
    s_mov_b32 s30, 2097152
    s_mov_b32 s31, 0x00020000
    buffer_load_dword v14, v13, s[28:31], s50 offen
    s_mov_b32 s9, 0
h_qkvA:
    s_mul_i32 s98, s9, 786432
    s_add_u32 s98, s98, 65273856
    s_lshl_b32 s99, s11, 10
    s_add_u32 s98, s98, s99
    s_add_u32 s96, s4, s98
    s_addc_u32 s97, s5, 0
    s_mov_b32 s98, s10
    s_mov_b32 s99, s10
    v_and_b32 v1, 63, v0
    v_lshlrev_b32 v5, 4, v1
    v_and_b32 v20, 15, v1
    v_lshrrev_b32 v11, 4, v1
    v_min_u32 v11, 2, v11
    v_lshlrev_b32 v21, 3, v20
    v_lshl_add_u32 v12, v11, 7, v21
    v_add_u32 v12, 155648, v12
    v_lshl_add_u32 v11, v11, 16, v21
    v_mov_b32 v10, 159496
    s_add_u32 s3, s9, 1
    v_mov_b32 v13, s3
    s_and_b32 s3, s6, 14
    s_lshl_b32 s3, s3, 2
    s_sub_u32 s3, s3, 1
    s_max_i32 s3, s3, 0
    s_lshl_b32 s3, s3, 16
    s_lshl_b32 s48, s9, 22
    s_add_u32 s3, s3, s48
    s_add_u32 s20, s4, s3
    s_addc_u32 s21, s5, 0
    s_mov_b32 s22, 65536
    s_mov_b32 s23, 0x00020000
    s_cmp_lt_u32 s6, 2
    s_cselect_b32 s22, 0, s22
    s_cselect_b32 s3, 0, 512
    s_add_u32 s96, s96, s3
    s_addc_u32 s97, s97, 0
    v_bfe_u32 v21, v1, 4, 1
    v_lshl_add_u32 v6, v21, 5, v20
    v_lshlrev_b32 v6, 4, v6
    v_lshrrev_b32 v21, 5, v1
    v_lshl_add_u32 v6, v21, 10, v6
    v_add_u32 v6, 256, v6
    v_mov_b32 v16, v5
    s_cmp_eq_u32 s9, 0
    s_cbranch_scc1 h_qkvA_noend
    s_barrier
    s_cmp_lt_u32 s9, 2
    s_cbranch_scc1 c4_11
    ds_write_b128 v16, v[64:67] offset:0
    ds_write_b128 v16, v[68:71] offset:1024
    ds_write_b128 v16, v[72:75] offset:2048
    ds_write_b128 v16, v[76:79] offset:3072
    ds_write_b128 v16, v[80:83] offset:4096
    ds_write_b128 v16, v[84:87] offset:5120
    ds_write_b128 v16, v[88:91] offset:6144
    ds_write_b128 v16, v[92:95] offset:7168
    ds_write_b128 v16, v[96:99] offset:8192
    ds_write_b128 v16, v[100:103] offset:9216
    ds_write_b128 v16, v[104:107] offset:10240
    ds_write_b128 v16, v[108:111] offset:11264
    ds_write_b128 v16, v[112:115] offset:12288
    ds_write_b128 v16, v[116:119] offset:13312
    ds_write_b128 v16, v[120:123] offset:14336
    ds_write_b128 v16, v[124:127] offset:15360
    ds_write_b128 v16, v[128:131] offset:16384
    ds_write_b128 v16, v[132:135] offset:17408
    ds_write_b128 v16, v[136:139] offset:18432
    ds_write_b128 v16, v[140:143] offset:19456
    ds_write_b128 v16, v[144:147] offset:20480
    ds_write_b128 v16, v[148:151] offset:21504
    ds_write_b128 v16, v[152:155] offset:22528
    ds_write_b128 v16, v[156:159] offset:23552
    s_waitcnt lgkmcnt(0)
c4_11:
    s_barrier
h_qkvA_noend:
    s_mov_b32 s3, 0x100000
poll_12:
    s_load_dwordx8 s[80:87], s[96:97], 0 glc
    s_load_dwordx8 s[88:95], s[96:97], 128 glc
    s_sub_u32 s3, s3, 1
    s_cbranch_scc1 poll_12_ok
    s_waitcnt lgkmcnt(0)
    s_xor_b64 s[100:101], s[80:81], s[98:99]
    s_xor_b64 s[80:81], s[82:83], s[98:99]
    s_or_b64 s[100:101], s[100:101], s[80:81]
    s_xor_b64 s[80:81], s[84:85], s[98:99]
    s_or_b64 s[100:101], s[100:101], s[80:81]
    s_xor_b64 s[80:81], s[86:87], s[98:99]
    s_or_b64 s[100:101], s[100:101], s[80:81]
    s_xor_b64 s[80:81], s[88:89], s[98:99]
    s_or_b64 s[100:101], s[100:101], s[80:81]
    s_xor_b64 s[80:81], s[90:91], s[98:99]
    s_or_b64 s[100:101], s[100:101], s[80:81]
    s_xor_b64 s[80:81], s[92:93], s[98:99]
    s_or_b64 s[100:101], s[100:101], s[80:81]
    s_xor_b64 s[80:81], s[94:95], s[98:99]
    s_or_b64 s[100:101], s[100:101], s[80:81]
    s_cbranch_scc1 poll_12
poll_12_ok:
    s_waitcnt lgkmcnt(0)
    ds_write_b32 v10, v13
    s_mov_b32 m0, 147456
    s_mov_b32 s48, 0
    buffer_load_dwordx4 v6, s[20:23], s48 offen sc1 lds
    s_mov_b32 m0, 148480
    s_mov_b32 s48, 2048
    buffer_load_dwordx4 v6, s[20:23], s48 offen sc1 lds
    s_mov_b32 m0, 149504
    s_mov_b32 s48, 4096
    buffer_load_dwordx4 v6, s[20:23], s48 offen sc1 lds
    s_mov_b32 m0, 150528
    s_mov_b32 s48, 6144
    buffer_load_dwordx4 v6, s[20:23], s48 offen sc1 lds
    s_mov_b32 m0, 151552
    s_mov_b32 s48, 8192
    buffer_load_dwordx4 v6, s[20:23], s48 offen sc1 lds
    s_mov_b32 m0, 152576
    s_mov_b32 s48, 10240
    buffer_load_dwordx4 v6, s[20:23], s48 offen sc1 lds
    s_mov_b32 m0, 153600
    s_mov_b32 s48, 12288
    buffer_load_dwordx4 v6, s[20:23], s48 offen sc1 lds
    s_mov_b32 m0, 154624
    s_mov_b32 s48, 14336
    buffer_load_dwordx4 v6, s[20:23], s48 offen sc1 lds
    s_lshl_b32 s56, s7, 12
    s_and_b32 s57, s6, 1
    s_lshl_b32 s57, s57, 7
    s_add_u32 s56, s56, s57
    s_add_u32 s56, s56, 63963136
    v_lshlrev_b32 v15, 7, v1
    s_lshr_b32 s59, s2, 3
    s_mul_i32 s59, s59, 3
    s_lshr_b32 s59, s59, 5
    s_lshl_b32 s3, s9, 4
    s_add_u32 s59, s59, s3
    s_waitcnt vmcnt(4)
    s_barrier
    s_cmp_ge_u32 s9, 2
    s_cbranch_scc1 c4_13
    ds_read_b128 v[64:67], v16 offset:0
    ds_read_b128 v[68:71], v16 offset:1024
    ds_read_b128 v[72:75], v16 offset:2048
    ds_read_b128 v[76:79], v16 offset:3072
    ds_read_b128 v[80:83], v16 offset:4096
    ds_read_b128 v[84:87], v16 offset:5120
    ds_read_b128 v[88:91], v16 offset:6144
    ds_read_b128 v[92:95], v16 offset:7168
    ds_read_b128 v[96:99], v16 offset:8192
    ds_read_b128 v[100:103], v16 offset:9216
    ds_read_b128 v[104:107], v16 offset:10240
    ds_read_b128 v[108:111], v16 offset:11264
    ds_read_b128 v[112:115], v16 offset:12288
    ds_read_b128 v[116:119], v16 offset:13312
    ds_read_b128 v[120:123], v16 offset:14336
    ds_read_b128 v[124:127], v16 offset:15360
    ds_read_b128 v[128:131], v16 offset:16384
    ds_read_b128 v[132:135], v16 offset:17408
    ds_read_b128 v[136:139], v16 offset:18432
    ds_read_b128 v[140:143], v16 offset:19456
    ds_read_b128 v[144:147], v16 offset:20480
    ds_read_b128 v[148:151], v16 offset:21504
    ds_read_b128 v[152:155], v16 offset:22528
    ds_read_b128 v[156:159], v16 offset:23552
    s_waitcnt lgkmcnt(0)
c4_13:
    s_waitcnt vmcnt(0)
    s_barrier
    s_mov_b32 m0, 147456
    s_mov_b32 s48, 16384
    buffer_load_dwordx4 v6, s[20:23], s48 offen sc1 lds
    s_mov_b32 m0, 148480
    s_mov_b32 s48, 18432
    buffer_load_dwordx4 v6, s[20:23], s48 offen sc1 lds
    s_mov_b32 m0, 149504
    s_mov_b32 s48, 20480
    buffer_load_dwordx4 v6, s[20:23], s48 offen sc1 lds
    s_mov_b32 m0, 150528
    s_mov_b32 s48, 22528
    buffer_load_dwordx4 v6, s[20:23], s48 offen sc1 lds
    s_waitcnt vmcnt(0)
    s_waitcnt vmcnt(0)
    s_barrier
    s_mov_b32 m0, 151552
    s_mov_b32 s48, 24576
    buffer_load_dwordx4 v6, s[20:23], s48 offen sc1 lds
    s_mov_b32 m0, 152576
    s_mov_b32 s48, 26624
    buffer_load_dwordx4 v6, s[20:23], s48 offen sc1 lds
    s_mov_b32 m0, 153600
    s_mov_b32 s48, 28672
    buffer_load_dwordx4 v6, s[20:23], s48 offen sc1 lds
    s_mov_b32 m0, 154624
    s_mov_b32 s48, 30720
    buffer_load_dwordx4 v6, s[20:23], s48 offen sc1 lds
    s_cmp_ge_u32 s9, 2
    s_cbranch_scc1 cs_15
    buffer_load_dwordx2 v[32:33], v11, s[12:15], s56 offen offset:0 sc1
    buffer_load_dwordx2 v[34:35], v11, s[12:15], s56 offen offset:256 sc1
    buffer_load_dwordx2 v[36:37], v11, s[12:15], s56 offen offset:512 sc1
    buffer_load_dwordx2 v[38:39], v11, s[12:15], s56 offen offset:768 sc1
    buffer_load_dwordx2 v[40:41], v11, s[12:15], s56 offen offset:1024 sc1
    buffer_load_dwordx2 v[42:43], v11, s[12:15], s56 offen offset:1280 sc1
    buffer_load_dwordx2 v[44:45], v11, s[12:15], s56 offen offset:1536 sc1
    buffer_load_dwordx2 v[46:47], v11, s[12:15], s56 offen offset:1792 sc1
    buffer_load_dwordx2 v[48:49], v11, s[12:15], s56 offen offset:2048 sc1
    buffer_load_dwordx2 v[50:51], v11, s[12:15], s56 offen offset:2304 sc1
    buffer_load_dwordx2 v[52:53], v11, s[12:15], s56 offen offset:2560 sc1
    buffer_load_dwordx2 v[54:55], v11, s[12:15], s56 offen offset:2816 sc1
cs_15:
    s_waitcnt vmcnt(0)
    s_waitcnt vmcnt(12)
    s_barrier
    s_mov_b32 m0, 147456
    s_mov_b32 s48, 32768
    buffer_load_dwordx4 v6, s[20:23], s48 offen sc1 lds
    s_mov_b32 m0, 148480
    s_mov_b32 s48, 34816
    buffer_load_dwordx4 v6, s[20:23], s48 offen sc1 lds
    s_mov_b32 m0, 149504
    s_mov_b32 s48, 36864
    buffer_load_dwordx4 v6, s[20:23], s48 offen sc1 lds
    s_mov_b32 m0, 150528
    s_mov_b32 s48, 38912
    buffer_load_dwordx4 v6, s[20:23], s48 offen sc1 lds
    s_cmp_ge_u32 s9, 2
    s_cbranch_scc1 cs_16
    buffer_load_dwordx2 v[56:57], v11, s[12:15], s56 offen offset:3072 sc1
    buffer_load_dwordx2 v[58:59], v11, s[12:15], s56 offen offset:3328 sc1
    buffer_load_dwordx2 v[60:61], v11, s[12:15], s56 offen offset:3584 sc1
    buffer_load_dwordx2 v[62:63], v11, s[12:15], s56 offen offset:3840 sc1
cs_16:
    s_waitcnt vmcnt(0)
    s_waitcnt vmcnt(4)
    s_barrier
    s_mov_b32 m0, 151552
    s_mov_b32 s48, 40960
    buffer_load_dwordx4 v6, s[20:23], s48 offen sc1 lds
    s_mov_b32 m0, 152576
    s_mov_b32 s48, 43008
    buffer_load_dwordx4 v6, s[20:23], s48 offen sc1 lds
    s_mov_b32 m0, 153600
    s_mov_b32 s48, 45056
    buffer_load_dwordx4 v6, s[20:23], s48 offen sc1 lds
    s_mov_b32 m0, 154624
    s_mov_b32 s48, 47104
    buffer_load_dwordx4 v6, s[20:23], s48 offen sc1 lds
    s_cmp_ge_u32 s9, 2
    s_cbranch_scc1 cs_17
    s_waitcnt vmcnt(4)
    v_add_f32 v32, v32, v48
    v_add_f32 v33, v33, v49
    v_add_f32 v34, v34, v50
    v_add_f32 v35, v35, v51
    v_add_f32 v36, v36, v52
    v_add_f32 v37, v37, v53
    v_add_f32 v38, v38, v54
    v_add_f32 v39, v39, v55
    v_add_f32 v40, v40, v56
    v_add_f32 v41, v41, v57
    v_add_f32 v42, v42, v58
    v_add_f32 v43, v43, v59
cs_17:
    s_waitcnt vmcnt(0)
    s_waitcnt vmcnt(0)
    s_barrier
    s_mov_b32 m0, 147456
    s_mov_b32 s48, 49152
    buffer_load_dwordx4 v6, s[20:23], s48 offen sc1 lds
    s_mov_b32 m0, 148480
    s_mov_b32 s48, 51200
    buffer_load_dwordx4 v6, s[20:23], s48 offen sc1 lds
    s_mov_b32 m0, 149504
    s_mov_b32 s48, 53248
    buffer_load_dwordx4 v6, s[20:23], s48 offen sc1 lds
    s_mov_b32 m0, 150528
    s_mov_b32 s48, 55296
    buffer_load_dwordx4 v6, s[20:23], s48 offen sc1 lds
    s_cmp_ge_u32 s9, 2
    s_cbranch_scc1 cs_18
    v_add_f32 v44, v44, v60
    v_add_f32 v45, v45, v61
    v_add_f32 v46, v46, v62
    v_add_f32 v47, v47, v63
    v_add_f32 v32, v32, v40
    v_add_f32 v33, v33, v41
    v_add_f32 v34, v34, v42
    v_add_f32 v35, v35, v43
    v_add_f32 v36, v36, v44
    v_add_f32 v37, v37, v45
    v_add_f32 v38, v38, v46
    v_add_f32 v39, v39, v47
cs_18:
    s_waitcnt vmcnt(0)
    s_waitcnt vmcnt(0)
    s_barrier
    s_mov_b32 m0, 151552
    s_mov_b32 s48, 57344
    buffer_load_dwordx4 v6, s[20:23], s48 offen sc1 lds
    s_mov_b32 m0, 152576
    s_mov_b32 s48, 59392
    buffer_load_dwordx4 v6, s[20:23], s48 offen sc1 lds
    s_mov_b32 m0, 153600
    s_mov_b32 s48, 61440
    buffer_load_dwordx4 v6, s[20:23], s48 offen sc1 lds
    s_mov_b32 m0, 154624
    s_mov_b32 s48, 63488
    buffer_load_dwordx4 v6, s[20:23], s48 offen sc1 lds
    s_cmp_ge_u32 s9, 2
    s_cbranch_scc1 cs_19
    v_add_f32 v32, v32, v36
    v_add_f32 v33, v33, v37
    v_add_f32 v34, v34, v38
    v_add_f32 v35, v35, v39
    v_add_f32 v32, v32, v34
    v_add_f32 v33, v33, v35
    ds_write_b64 v12, v[32:33]
    s_waitcnt lgkmcnt(0)
cs_19:
    s_waitcnt vmcnt(0)
    s_waitcnt vmcnt(0)
    s_barrier
    s_barrier
    s_barrier
    s_branch h_wo
h_qkvB:
    s_mul_i32 s98, s9, 786432
    s_add_u32 s98, s98, 65273856
    s_lshl_b32 s99, s11, 10
    s_add_u32 s98, s98, s99
    s_add_u32 s96, s4, s98
    s_addc_u32 s97, s5, 0
    s_mov_b32 s98, s10
    s_mov_b32 s99, s10
    v_and_b32 v1, 63, v0
    v_lshlrev_b32 v5, 4, v1
    v_and_b32 v20, 15, v1
    v_lshrrev_b32 v11, 4, v1
    v_min_u32 v11, 2, v11
    v_lshlrev_b32 v21, 3, v20
    v_lshl_add_u32 v12, v11, 7, v21
    v_add_u32 v12, 156032, v12
    v_lshl_add_u32 v11, v11, 16, v21
    v_mov_b32 v10, 159496
    s_add_u32 s3, s9, 1
    v_mov_b32 v13, s3
    v_mov_b32 v16, v5
    s_barrier
    s_cmp_lt_u32 s9, 2
    s_cbranch_scc1 c4_22
    ds_write_b128 v16, v[160:163] offset:0
    ds_write_b128 v16, v[164:167] offset:1024
    ds_write_b128 v16, v[168:171] offset:2048
    ds_write_b128 v16, v[172:175] offset:3072
    ds_write_b128 v16, v[176:179] offset:4096
    ds_write_b128 v16, v[180:183] offset:5120
    ds_write_b128 v16, v[184:187] offset:6144
    ds_write_b128 v16, v[188:191] offset:7168
    ds_write_b128 v16, v[192:195] offset:8192
    ds_write_b128 v16, v[196:199] offset:9216
    ds_write_b128 v16, v[200:203] offset:10240
    ds_write_b128 v16, v[204:207] offset:11264
    ds_write_b128 v16, v[208:211] offset:12288
    ds_write_b128 v16, v[212:215] offset:13312
    ds_write_b128 v16, v[216:219] offset:14336
    ds_write_b128 v16, v[220:223] offset:15360
    ds_write_b128 v16, a[0:3] offset:16384
    ds_write_b128 v16, a[4:7] offset:17408
    ds_write_b128 v16, a[8:11] offset:18432
    ds_write_b128 v16, a[12:15] offset:19456
    ds_write_b128 v16, a[16:19] offset:20480
    ds_write_b128 v16, a[20:23] offset:21504
    ds_write_b128 v16, a[24:27] offset:22528
    ds_write_b128 v16, a[28:31] offset:23552
    s_waitcnt lgkmcnt(0)
c4_22:
    s_barrier
    s_mov_b32 s3, 0x100000
poll_23:
    s_load_dwordx8 s[88:95], s[96:97], 0 glc
    s_sub_u32 s3, s3, 1
    s_cbranch_scc1 poll_23_ok
    s_waitcnt lgkmcnt(0)
    s_xor_b64 s[100:101], s[88:89], s[98:99]
    s_xor_b64 s[88:89], s[90:91], s[98:99]
    s_or_b64 s[100:101], s[100:101], s[88:89]
    s_xor_b64 s[88:89], s[92:93], s[98:99]
    s_or_b64 s[100:101], s[100:101], s[88:89]
    s_xor_b64 s[88:89], s[94:95], s[98:99]
    s_or_b64 s[100:101], s[100:101], s[88:89]
    s_cbranch_scc1 poll_23
poll_23_ok:
    s_waitcnt lgkmcnt(0)
    ds_write_b32 v10, v13
    s_lshl_b32 s56, s7, 12
    s_and_b32 s57, s6, 1
    s_lshl_b32 s57, s57, 7
    s_add_u32 s56, s56, s57
    s_add_u32 s56, s56, 64159744
    s_barrier
    s_cmp_ge_u32 s9, 2
    s_cbranch_scc1 c4_24
    ds_read_b128 v[160:163], v16 offset:0
    ds_read_b128 v[164:167], v16 offset:1024
    ds_read_b128 v[168:171], v16 offset:2048
    ds_read_b128 v[172:175], v16 offset:3072
    ds_read_b128 v[176:179], v16 offset:4096
    ds_read_b128 v[180:183], v16 offset:5120
    ds_read_b128 v[184:187], v16 offset:6144
    ds_read_b128 v[188:191], v16 offset:7168
    ds_read_b128 v[192:195], v16 offset:8192
    ds_read_b128 v[196:199], v16 offset:9216
    ds_read_b128 v[200:203], v16 offset:10240
    ds_read_b128 v[204:207], v16 offset:11264
    ds_read_b128 v[208:211], v16 offset:12288
    ds_read_b128 v[212:215], v16 offset:13312
    ds_read_b128 v[216:219], v16 offset:14336
    ds_read_b128 v[220:223], v16 offset:15360
    ds_read_b128 a[0:3], v16 offset:16384
    ds_read_b128 a[4:7], v16 offset:17408
    ds_read_b128 a[8:11], v16 offset:18432
    ds_read_b128 a[12:15], v16 offset:19456
    ds_read_b128 a[16:19], v16 offset:20480
    ds_read_b128 a[20:23], v16 offset:21504
    ds_read_b128 a[24:27], v16 offset:22528
    ds_read_b128 a[28:31], v16 offset:23552
    s_waitcnt lgkmcnt(0)
c4_24:
    s_barrier
    s_barrier
    s_cmp_ge_u32 s9, 2
    s_cbranch_scc1 cs_26
    buffer_load_dwordx2 v[32:33], v11, s[12:15], s56 offen offset:0 sc1
    buffer_load_dwordx2 v[34:35], v11, s[12:15], s56 offen offset:256 sc1
    buffer_load_dwordx2 v[36:37], v11, s[12:15], s56 offen offset:512 sc1
    buffer_load_dwordx2 v[38:39], v11, s[12:15], s56 offen offset:768 sc1
    buffer_load_dwordx2 v[40:41], v11, s[12:15], s56 offen offset:1024 sc1
    buffer_load_dwordx2 v[42:43], v11, s[12:15], s56 offen offset:1280 sc1
    buffer_load_dwordx2 v[44:45], v11, s[12:15], s56 offen offset:1536 sc1
    buffer_load_dwordx2 v[46:47], v11, s[12:15], s56 offen offset:1792 sc1
    buffer_load_dwordx2 v[48:49], v11, s[12:15], s56 offen offset:2048 sc1
    buffer_load_dwordx2 v[50:51], v11, s[12:15], s56 offen offset:2304 sc1
    buffer_load_dwordx2 v[52:53], v11, s[12:15], s56 offen offset:2560 sc1
    buffer_load_dwordx2 v[54:55], v11, s[12:15], s56 offen offset:2816 sc1
cs_26:
    s_barrier
    s_cmp_ge_u32 s9, 2
    s_cbranch_scc1 cs_27
    buffer_load_dwordx2 v[56:57], v11, s[12:15], s56 offen offset:3072 sc1
    buffer_load_dwordx2 v[58:59], v11, s[12:15], s56 offen offset:3328 sc1
    buffer_load_dwordx2 v[60:61], v11, s[12:15], s56 offen offset:3584 sc1
    buffer_load_dwordx2 v[62:63], v11, s[12:15], s56 offen offset:3840 sc1
cs_27:
    s_barrier
    s_cmp_ge_u32 s9, 2
    s_cbranch_scc1 cs_28
    s_waitcnt vmcnt(0)
    v_add_f32 v32, v32, v48
    v_add_f32 v33, v33, v49
    v_add_f32 v34, v34, v50
    v_add_f32 v35, v35, v51
    v_add_f32 v36, v36, v52
    v_add_f32 v37, v37, v53
    v_add_f32 v38, v38, v54
    v_add_f32 v39, v39, v55
    v_add_f32 v40, v40, v56
    v_add_f32 v41, v41, v57
    v_add_f32 v42, v42, v58
    v_add_f32 v43, v43, v59
cs_28:
    s_barrier
    s_cmp_ge_u32 s9, 2
    s_cbranch_scc1 cs_29
    v_add_f32 v44, v44, v60
    v_add_f32 v45, v45, v61
    v_add_f32 v46, v46, v62
    v_add_f32 v47, v47, v63
    v_add_f32 v32, v32, v40
    v_add_f32 v33, v33, v41
    v_add_f32 v34, v34, v42
    v_add_f32 v35, v35, v43
    v_add_f32 v36, v36, v44
    v_add_f32 v37, v37, v45
    v_add_f32 v38, v38, v46
    v_add_f32 v39, v39, v47
cs_29:
    s_barrier
    s_cmp_ge_u32 s9, 2
    s_cbranch_scc1 cs_30
    v_add_f32 v32, v32, v36
    v_add_f32 v33, v33, v37
    v_add_f32 v34, v34, v38
    v_add_f32 v35, v35, v39
    v_add_f32 v32, v32, v34
    v_add_f32 v33, v33, v35
    ds_write_b64 v12, v[32:33]
    s_waitcnt lgkmcnt(0)
cs_30:
    s_barrier
    s_barrier
    s_branch s_attn
.p2align 6
l_first_tail:
    s_mov_b32 s28, s40
    s_mov_b32 s29, s41
    s_mov_b32 s30, 6291456
    s_mov_b32 s31, 0x00020000
    v_lshlrev_b32 v14, 6, v20
    v_lshrrev_b32 v22, 5, v1
    v_bfe_u32 v23, v1, 1, 1
    v_xor_b32 v22, v22, v23
    v_lshl_add_u32 v14, v22, 5, v14
    v_and_b32 v22, 1, v1
    v_lshl_add_u32 v14, v22, 4, v14
    v_bfe_u32 v23, v1, 2, 1
    v_mul_u32_u24 v23, 196608, v23
    v_add_u32 v14, v14, v23
    v_lshlrev_b32 v22, 4, v22
    v_mov_b32 v23, 0x3f80
    v_lshlrev_b32 v23, v22, v23
    v_bfe_u32 v22, v1, 1, 3
    v_cmp_eq_u32 vcc, 0, v22
    s_nop 1
    v_cndmask_b32 v24, 0, v23, vcc
    v_cmp_eq_u32 vcc, 1, v22
    s_nop 1
    v_cndmask_b32 v25, 0, v23, vcc
    v_cmp_eq_u32 vcc, 2, v22
    s_nop 1
    v_cndmask_b32 v26, 0, v23, vcc
    v_cmp_eq_u32 vcc, 3, v22
    s_nop 1
    v_cndmask_b32 v27, 0, v23, vcc
    v_lshlrev_b32 v15, 5, v21
    v_and_b32 v22, 16, v1
    v_add_u32 v15, v15, v22
    v_lshlrev_b32 v16, 14, v1
    s_mov_b32 s9, 0
    s_lshr_b32 s55, s63, 4
    s_and_b32 s56, s63, 15
    s_lshl_b32 s57, s56, 4
    s_lshr_b32 s58, s62, 1
    s_add_u32 s57, s57, s58
    s_mul_i32 s57, s57, 3
    s_add_u32 s57, s57, s55
    s_lshl_b32 s57, s57, 13
    s_and_b32 s58, s62, 1
    s_lshl_b32 s58, s58, 12
    s_add_u32 s57, s57, s58
    s_add_u32 s57, s57, 50331648
    s_lshl_b32 s54, s61, 8
    s_add_u32 s54, s54, 63963136
    s_lshl_b32 s56, s56, 10
    s_lshl_b32 s55, s55, 7
    s_add_u32 s55, s55, s56
    s_lshl_b32 s56, s62, 2
    s_add_u32 s55, s55, s56
    s_add_u32 s55, s55, 64487424
    s_waitcnt vmcnt(7)
    buffer_store_dwordx4 v[160:163], v14, s[12:15], s57 offen offset:0 sc1
    v_mfma_f32_16x16x32_bf16 v[28:31], v[24:27], v[160:163], 0
    s_waitcnt vmcnt(7)
    buffer_store_dwordx4 v[164:167], v14, s[12:15], s57 offen offset:1024 sc1
    v_mfma_f32_16x16x32_bf16 v[28:31], v[24:27], v[164:167], v[28:31]
    s_waitcnt vmcnt(7)
    buffer_store_dwordx4 v[168:171], v14, s[12:15], s57 offen offset:512 sc1
    v_mfma_f32_16x16x32_bf16 v[28:31], v[24:27], v[168:171], v[28:31]
    s_waitcnt vmcnt(7)
    buffer_store_dwordx4 v[172:175], v14, s[12:15], s57 offen offset:1536 sc1
    v_mfma_f32_16x16x32_bf16 v[28:31], v[24:27], v[172:175], v[28:31]
    s_waitcnt vmcnt(7)
    buffer_store_dwordx4 v[176:179], v14, s[12:15], s57 offen offset:2048 sc1
    v_mfma_f32_16x16x32_bf16 v[28:31], v[24:27], v[176:179], v[28:31]
    s_waitcnt vmcnt(7)
    buffer_store_dwordx4 v[180:183], v14, s[12:15], s57 offen offset:3072 sc1
    v_mfma_f32_16x16x32_bf16 v[28:31], v[24:27], v[180:183], v[28:31]
    s_waitcnt vmcnt(7)
    buffer_store_dwordx4 v[184:187], v14, s[12:15], s57 offen offset:2560 sc1
    v_mfma_f32_16x16x32_bf16 v[28:31], v[24:27], v[184:187], v[28:31]
    s_waitcnt vmcnt(7)
    buffer_store_dwordx4 v[188:191], v14, s[12:15], s57 offen offset:3584 sc1
    v_mfma_f32_16x16x32_bf16 v[28:31], v[24:27], v[188:191], v[28:31]
    s_nop 7
    v_add_f32_dpp v28, v28, v28 row_ror:8 row_mask:0xf bank_mask:0xf
    v_add_f32_dpp v29, v29, v29 row_ror:8 row_mask:0xf bank_mask:0xf
    v_add_f32_dpp v30, v30, v30 row_ror:8 row_mask:0xf bank_mask:0xf
    v_add_f32_dpp v31, v31, v31 row_ror:8 row_mask:0xf bank_mask:0xf
    s_mov_b64 exec, 0x00ff00ff
    buffer_store_dwordx4 v[28:31], v15, s[12:15], s54 offen sc1
    s_mov_b64 exec, -1
    s_add_u32 s57, s57, 6291456
    s_add_u32 s54, s54, 196608
    v_mov_b32 v8, 159492
non_33:
    ds_read_b32 v9, v8
    s_waitcnt lgkmcnt(0)
    v_readfirstlane_b32 s10, v9
    s_cmp_eq_u32 s10, 0
    s_cbranch_scc1 non_33
    s_mov_b64 exec, 0xffff
    s_waitcnt vmcnt(0)
    buffer_store_dword v9, v16, s[12:15], s55 offen offset:0 sc1
    s_mov_b64 exec, -1
    s_add_u32 s53, s52, 0
    buffer_load_dwordx4 v[192:195], v12, s[28:31], s53 offen nt
    s_add_u32 s53, s52, 49152
    buffer_load_dwordx4 v[196:199], v12, s[28:31], s53 offen nt
    s_add_u32 s53, s52, 98304
    buffer_load_dwordx4 v[200:203], v12, s[28:31], s53 offen nt
    s_add_u32 s53, s52, 147456
    buffer_load_dwordx4 v[204:207], v12, s[28:31], s53 offen nt
    s_add_u32 s53, s52, 196608
    buffer_load_dwordx4 v[208:211], v12, s[28:31], s53 offen nt
    s_add_u32 s53, s52, 245760
    buffer_load_dwordx4 v[212:215], v12, s[28:31], s53 offen nt
    s_add_u32 s53, s52, 294912
    buffer_load_dwordx4 v[216:219], v12, s[28:31], s53 offen nt
    s_add_u32 s53, s52, 344064
    buffer_load_dwordx4 v[220:223], v12, s[28:31], s53 offen nt
    s_mov_b32 s58, s52
    s_lshr_b32 s60, s2, 3
    s_mul_i32 s60, s60, 3
    s_lshr_b32 s60, s60, 5
    s_add_u32 s60, s60, 1
    s_branch l_qkv2
l_qkv:
    s_mov_b32 s60, 0
l_qkv2:
    v_and_b32 v1, 63, v0
    v_lshlrev_b32 v5, 4, v1
    s_sub_u32 s51, s8, 5
    s_lshl_b32 s48, s51, 13
    s_and_b32 s53, s9, 1
    s_lshl_b32 s52, s53, 4
    s_add_u32 s49, s7, s52
    s_lshl_b32 s49, s49, 1
    s_and_b32 s52, s6, 1
    s_add_u32 s49, s49, s52
    s_mul_i32 s49, s49, 196608
    s_add_u32 s49, s49, s48
    s_add_u32 s49, s49, 50331648
    v_mov_b32 v13, 159496
    s_mov_b32 s50, 0
    v_lshrrev_b32 v10, 2, v1
    v_and_b32 v11, 3, v1
    v_lshlrev_b32 v10, 8, v10
    v_lshl_add_u32 v10, v11, 4, v10
    v_lshlrev_b32 v7, 5, v11
    v_lshlrev_b32 v11, 2, v1
    v_add_u32 v11, 155648, v11
    s_lshr_b32 s59, s11, 2
    s_lshl_b32 s59, s59, 12
    s_and_b32 s3, s11, 3
    s_lshl_b32 s3, s3, 6
    s_add_u32 s59, s59, s3
    s_lshl_b32 s3, s9, 18
    s_add_u32 s59, s59, s3
    s_add_u32 s59, s59, 62914560
    s_lshl_b32 s56, s9, 15
    s_add_u32 s56, s56, 64749568
    v_mov_b32 v41, s10
    v_mov_b32 v43, s10
    v_mov_b32 v45, s10
    v_mov_b32 v47, s10
    v_and_b32 v6, 0xff, v5
    s_lshl_b32 s3, s7, 7
    v_lshrrev_b32 v20, 3, v1
    v_lshlrev_b32 v21, 11, v20
    v_and_b32 v22, 2, v20
    v_lshrrev_b32 v23, 2, v20
    v_or_b32 v22, v22, v23
    v_bfe_u32 v23, v1, 1, 2
    v_xor_b32 v22, v22, v23
    v_lshl_add_u32 v21, v22, 5, v21
    v_and_b32 v22, 1, v1
    v_lshl_add_u32 v21, v22, 4, v21
    v_add_u32 v17, s3, v21
    s_lshl_b32 s3, s51, 13
    s_add_u32 s3, s3, 24576
    v_add_u32 v3, s3, v5
    s_cmp_lg_u32 s9, 0
    s_cbranch_scc1 l_qkv_tiled
    s_lshl_b32 s53, s8, 7
    s_lshl_b32 s52, s11, 10
    s_add_u32 s53, s53, s52
    s_add_u32 s53, s53, 64486784
    s_add_u32 s96, s4, s53
    s_addc_u32 s97, s5, 0
    s_mov_b32 s98, s10
    s_mov_b32 s99, s10
    s_mov_b32 s3, 0x100000
poll_34:
    s_load_dwordx16 s[80:95], s[96:97], 0 glc
    s_sub_u32 s3, s3, 1
    s_cbranch_scc1 poll_34_ok
    s_waitcnt lgkmcnt(0)
    s_xor_b64 s[100:101], s[80:81], s[98:99]
    s_xor_b64 s[80:81], s[82:83], s[98:99]
    s_or_b64 s[100:101], s[100:101], s[80:81]
    s_xor_b64 s[80:81], s[84:85], s[98:99]
    s_or_b64 s[100:101], s[100:101], s[80:81]
    s_xor_b64 s[80:81], s[86:87], s[98:99]
    s_or_b64 s[100:101], s[100:101], s[80:81]
    s_xor_b64 s[80:81], s[88:89], s[98:99]
    s_or_b64 s[100:101], s[100:101], s[80:81]
    s_xor_b64 s[80:81], s[90:91], s[98:99]
    s_or_b64 s[100:101], s[100:101], s[80:81]
    s_xor_b64 s[80:81], s[92:93], s[98:99]
    s_or_b64 s[100:101], s[100:101], s[80:81]
    s_xor_b64 s[80:81], s[94:95], s[98:99]
    s_or_b64 s[100:101], s[100:101], s[80:81]
    s_cbranch_scc1 poll_34
poll_34_ok:
    s_waitcnt lgkmcnt(0)
    s_branch l_qkv_fill
l_qkv_tiled:
    s_barrier
    s_cmp_lt_u32 s9, 2
    s_cbranch_scc1 l_qkv_nocache
    s_bitcmp1_b32 s9, 0
    s_cbranch_scc1 l_qkv_c_b
    ds_write_b128 v3, v[64:67] offset:0
    ds_write_b128 v3, v[68:71] offset:1024
    ds_write_b128 v3, v[72:75] offset:2048
    ds_write_b128 v3, v[76:79] offset:3072
    ds_write_b128 v3, v[80:83] offset:4096
    ds_write_b128 v3, v[84:87] offset:5120
    ds_write_b128 v3, v[88:91] offset:6144
    ds_write_b128 v3, v[92:95] offset:7168
    ds_write_b128 v3, v[96:99] offset:24576
    ds_write_b128 v3, v[100:103] offset:25600
    ds_write_b128 v3, v[104:107] offset:26624
    ds_write_b128 v3, v[108:111] offset:27648
    ds_write_b128 v3, v[112:115] offset:28672
    ds_write_b128 v3, v[116:119] offset:29696
    ds_write_b128 v3, v[120:123] offset:30720
    ds_write_b128 v3, v[124:127] offset:31744
    ds_write_b128 v3, v[128:131] offset:49152
    ds_write_b128 v3, v[132:135] offset:50176
    ds_write_b128 v3, v[136:139] offset:51200
    ds_write_b128 v3, v[140:143] offset:52224
    ds_write_b128 v3, v[144:147] offset:53248
    ds_write_b128 v3, v[148:151] offset:54272
    ds_write_b128 v3, v[152:155] offset:55296
    ds_write_b128 v3, v[156:159] offset:56320
    s_branch l_qkv_c_w
l_qkv_c_b:
    ds_write_b128 v3, v[160:163] offset:0
    ds_write_b128 v3, v[164:167] offset:1024
    ds_write_b128 v3, v[168:171] offset:2048
    ds_write_b128 v3, v[172:175] offset:3072
    ds_write_b128 v3, v[176:179] offset:4096
    ds_write_b128 v3, v[180:183] offset:5120
    ds_write_b128 v3, v[184:187] offset:6144
    ds_write_b128 v3, v[188:191] offset:7168
    ds_write_b128 v3, v[192:195] offset:24576
    ds_write_b128 v3, v[196:199] offset:25600
    ds_write_b128 v3, v[200:203] offset:26624
    ds_write_b128 v3, v[204:207] offset:27648
    ds_write_b128 v3, v[208:211] offset:28672
    ds_write_b128 v3, v[212:215] offset:29696
    ds_write_b128 v3, v[216:219] offset:30720
    ds_write_b128 v3, v[220:223] offset:31744
    ds_write_b128 v3, a[0:3] offset:49152
    ds_write_b128 v3, a[4:7] offset:50176
    ds_write_b128 v3, a[8:11] offset:51200
    ds_write_b128 v3, a[12:15] offset:52224
    ds_write_b128 v3, a[16:19] offset:53248
    ds_write_b128 v3, a[20:23] offset:54272
    ds_write_b128 v3, a[24:27] offset:55296
    ds_write_b128 v3, a[28:31] offset:56320
l_qkv_c_w:
    s_waitcnt lgkmcnt(0)
    s_mov_b32 s50, 8
    s_add_u32 s49, s49, 98304
    s_add_u32 s48, s48, 98304
    s_barrier
    s_mov_b32 m0, s48
    s_add_u32 s50, s50, 1
    buffer_load_dwordx4 v5, s[12:15], s49 offen offset:0 sc1 lds
    buffer_load_dwordx4 v5, s[12:15], s49 offen offset:1024 sc1 lds
    buffer_load_dwordx4 v5, s[12:15], s49 offen offset:2048 sc1 lds
    buffer_load_dwordx4 v5, s[12:15], s49 offen offset:3072 sc1 lds
    s_add_u32 s49, s49, 4096
    s_bitcmp1_b32 s50, 0
    s_cselect_b32 s3, 0, 16384
    s_add_u32 s48, s48, s3
    s_add_u32 s49, s49, s3
    s_cmp_eq_u32 s50, 12
    s_cselect_b32 s3, 4294819840, 0
    s_add_u32 s48, s48, 4096
    s_add_u32 s48, s48, s3
    s_mov_b32 m0, s48
    s_add_u32 s50, s50, 1
    buffer_load_dwordx4 v5, s[12:15], s49 offen offset:0 sc1 lds
    buffer_load_dwordx4 v5, s[12:15], s49 offen offset:1024 sc1 lds
    buffer_load_dwordx4 v5, s[12:15], s49 offen offset:2048 sc1 lds
    buffer_load_dwordx4 v5, s[12:15], s49 offen offset:3072 sc1 lds
    s_add_u32 s49, s49, 4096
    s_bitcmp1_b32 s50, 0
    s_cselect_b32 s3, 0, 16384
    s_add_u32 s48, s48, s3
    s_add_u32 s49, s49, s3
    s_cmp_eq_u32 s50, 12
    s_cselect_b32 s3, 4294819840, 0
    s_add_u32 s48, s48, 4096
    s_add_u32 s48, s48, s3
    s_mov_b32 m0, s48
    s_add_u32 s50, s50, 1
    buffer_load_dwordx4 v5, s[12:15], s49 offen offset:0 sc1 lds
    buffer_load_dwordx4 v5, s[12:15], s49 offen offset:1024 sc1 lds
    buffer_load_dwordx4 v5, s[12:15], s49 offen offset:2048 sc1 lds
    buffer_load_dwordx4 v5, s[12:15], s49 offen offset:3072 sc1 lds
    s_add_u32 s49, s49, 4096
    s_bitcmp1_b32 s50, 0
    s_cselect_b32 s3, 0, 16384
    s_add_u32 s48, s48, s3
    s_add_u32 s49, s49, s3
    s_cmp_eq_u32 s50, 12
    s_cselect_b32 s3, 4294819840, 0
    s_add_u32 s48, s48, 4096
    s_add_u32 s48, s48, s3
    s_mov_b32 m0, s48
    s_add_u32 s50, s50, 1
    buffer_load_dwordx4 v5, s[12:15], s49 offen offset:0 sc1 lds
    buffer_load_dwordx4 v5, s[12:15], s49 offen offset:1024 sc1 lds
    buffer_load_dwordx4 v5, s[12:15], s49 offen offset:2048 sc1 lds
    buffer_load_dwordx4 v5, s[12:15], s49 offen offset:3072 sc1 lds
    s_add_u32 s49, s49, 4096
    s_bitcmp1_b32 s50, 0
    s_cselect_b32 s3, 0, 16384
    s_add_u32 s48, s48, s3
    s_add_u32 s49, s49, s3
    s_cmp_eq_u32 s50, 12
    s_cselect_b32 s3, 4294819840, 0
    s_add_u32 s48, s48, 4096
    s_add_u32 s48, s48, s3
    s_barrier
    s_branch l_qkv_gone
l_qkv_nocache:
    s_barrier
l_qkv_fill:
    s_mov_b32 m0, s48
    s_add_u32 s50, s50, 1
    buffer_load_dwordx4 v5, s[12:15], s49 offen offset:0 sc1 lds
    buffer_load_dwordx4 v5, s[12:15], s49 offen offset:1024 sc1 lds
    buffer_load_dwordx4 v5, s[12:15], s49 offen offset:2048 sc1 lds
    buffer_load_dwordx4 v5, s[12:15], s49 offen offset:3072 sc1 lds
    s_add_u32 s49, s49, 4096
    s_bitcmp1_b32 s50, 0
    s_cselect_b32 s3, 0, 16384
    s_add_u32 s48, s48, s3
    s_add_u32 s49, s49, s3
    s_cmp_eq_u32 s50, 12
    s_cselect_b32 s3, 4294819840, 0
    s_add_u32 s48, s48, 4096
    s_add_u32 s48, s48, s3
l_qkv_fill1:
    s_mov_b32 m0, s48
    s_add_u32 s50, s50, 1
    buffer_load_dwordx4 v5, s[12:15], s49 offen offset:0 sc1 lds
    buffer_load_dwordx4 v5, s[12:15], s49 offen offset:1024 sc1 lds
    buffer_load_dwordx4 v5, s[12:15], s49 offen offset:2048 sc1 lds
    buffer_load_dwordx4 v5, s[12:15], s49 offen offset:3072 sc1 lds
    s_add_u32 s49, s49, 4096
    s_bitcmp1_b32 s50, 0
    s_cselect_b32 s3, 0, 16384
    s_add_u32 s48, s48, s3
    s_add_u32 s49, s49, s3
    s_cmp_eq_u32 s50, 12
    s_cselect_b32 s3, 4294819840, 0
    s_add_u32 s48, s48, 4096
    s_add_u32 s48, s48, s3
l_qkv_fill2:
    s_add_u32 s52, s9, 1
    s_mov_b32 m0, s48
    s_add_u32 s50, s50, 1
    buffer_load_dwordx4 v5, s[12:15], s49 offen offset:0 sc1 lds
    s_waitcnt vmcnt(10)
    buffer_load_dwordx4 v5, s[12:15], s49 offen offset:1024 sc1 lds
    s_waitcnt vmcnt(10)
    buffer_load_dwordx4 v5, s[12:15], s49 offen offset:2048 sc1 lds
    s_waitcnt vmcnt(10)
    buffer_load_dwordx4 v5, s[12:15], s49 offen offset:3072 sc1 lds
    s_waitcnt vmcnt(10)
    s_add_u32 s49, s49, 4096
    s_bitcmp1_b32 s50, 0
    s_cselect_b32 s3, 0, 16384
    s_add_u32 s48, s48, s3
    s_add_u32 s49, s49, s3
    s_cmp_eq_u32 s50, 12
    s_cselect_b32 s3, 4294819840, 0
    s_add_u32 s48, s48, 4096
    s_add_u32 s48, s48, s3
l_qkv_pre:
    s_mov_b32 m0, s48
    s_add_u32 s50, s50, 1
    buffer_load_dwordx4 v5, s[12:15], s49 offen offset:0 sc1 lds
    s_waitcnt vmcnt(10)
    buffer_load_dwordx4 v5, s[12:15], s49 offen offset:1024 sc1 lds
    s_waitcnt vmcnt(10)
    buffer_load_dwordx4 v5, s[12:15], s49 offen offset:2048 sc1 lds
    s_waitcnt vmcnt(10)
    buffer_load_dwordx4 v5, s[12:15], s49 offen offset:3072 sc1 lds
    s_waitcnt vmcnt(10)
    s_add_u32 s49, s49, 4096
    s_bitcmp1_b32 s50, 0
    s_cselect_b32 s3, 0, 16384
    s_add_u32 s48, s48, s3
    s_add_u32 s49, s49, s3
    s_cmp_eq_u32 s50, 12
    s_cselect_b32 s3, 4294819840, 0
    s_add_u32 s48, s48, 4096
    s_add_u32 s48, s48, s3
    ds_read_b32 v8, v13
    s_cmp_ge_u32 s50, 12
    s_cbranch_scc1 l_qkv_go
    s_waitcnt lgkmcnt(0)
    v_readfirstlane_b32 s3, v8
    s_cmp_lg_u32 s3, s52
    s_cbranch_scc1 l_qkv_pre
    s_cmp_ge_u32 s50, 5
    s_cbranch_scc1 l_qkv_go
    s_waitcnt vmcnt(8)
l_qkv_go:
    s_waitcnt lgkmcnt(0)
    s_barrier
l_qkv_gone:
    s_bitcmp0_b32 s50, 0
    s_cbranch_scc1 l_qkv_even
    s_mov_b32 m0, s48
    s_add_u32 s50, s50, 1
    buffer_load_dwordx4 v5, s[12:15], s49 offen offset:0 sc1 lds
    buffer_load_dwordx4 v5, s[12:15], s49 offen offset:1024 sc1 lds
    buffer_load_dwordx4 v5, s[12:15], s49 offen offset:2048 sc1 lds
    buffer_load_dwordx4 v5, s[12:15], s49 offen offset:3072 sc1 lds
    s_add_u32 s49, s49, 4096
    s_bitcmp1_b32 s50, 0
    s_cselect_b32 s3, 0, 16384
    s_add_u32 s48, s48, s3
    s_add_u32 s49, s49, s3
    s_cmp_eq_u32 s50, 12
    s_cselect_b32 s3, 4294819840, 0
    s_add_u32 s48, s48, 4096
    s_add_u32 s48, s48, s3
l_qkv_even:
    s_cmp_gt_u32 s50, 11
    s_cbranch_scc1 stg_35
    s_mov_b32 m0, s48
    s_add_u32 s50, s50, 1
    buffer_load_dwordx4 v5, s[12:15], s49 offen offset:0 sc1 lds
    buffer_load_dwordx4 v5, s[12:15], s49 offen offset:1024 sc1 lds
    buffer_load_dwordx4 v5, s[12:15], s49 offen offset:2048 sc1 lds
    buffer_load_dwordx4 v5, s[12:15], s49 offen offset:3072 sc1 lds
    s_add_u32 s49, s49, 4096
    s_bitcmp1_b32 s50, 0
    s_cselect_b32 s3, 0, 16384
    s_add_u32 s48, s48, s3
    s_add_u32 s49, s49, s3
    s_cmp_eq_u32 s50, 12
    s_cselect_b32 s3, 4294819840, 0
    s_add_u32 s48, s48, 4096
    s_add_u32 s48, s48, s3
    s_cmp_ge_u32 s9, 2
    s_cbranch_scc1 stg_35
stg_35:
    s_cmp_lg_u32 s51, 0
    s_cbranch_scc1 role_36
    buffer_load_dwordx4 v[32:35], v10, s[12:15], s59 offen sc1
role_36:
    s_lshr_b32 s3, s9, 1
    s_andn2_b32 s3, s50, s3
    s_bitcmp0_b32 s3, 0
    s_cbranch_scc1 str_37
    s_waitcnt vmcnt(1)
    s_mov_b32 m0, s48
    s_add_u32 s50, s50, 1
    buffer_load_dwordx4 v5, s[12:15], s49 offen offset:0 sc1 lds
    buffer_load_dwordx4 v5, s[12:15], s49 offen offset:1024 sc1 lds
    buffer_load_dwordx4 v5, s[12:15], s49 offen offset:2048 sc1 lds
    buffer_load_dwordx4 v5, s[12:15], s49 offen offset:3072 sc1 lds
    s_add_u32 s49, s49, 4096
    s_bitcmp1_b32 s50, 0
    s_cselect_b32 s3, 0, 16384
    s_add_u32 s48, s48, s3
    s_add_u32 s49, s49, s3
    s_cmp_eq_u32 s50, 12
    s_cselect_b32 s3, 4294819840, 0
    s_add_u32 s48, s48, 4096
    s_add_u32 s48, s48, s3
str_37:
    s_waitcnt vmcnt(8)
    s_barrier
    s_waitcnt vmcnt(0)
l_qkv_b0:
    s_cmp_gt_u32 s50, 13
    s_cbranch_scc1 stg_38
    s_mov_b32 m0, s48
    s_add_u32 s50, s50, 1
    buffer_load_dwordx4 v5, s[12:15], s49 offen offset:0 sc1 lds
    buffer_load_dwordx4 v5, s[12:15], s49 offen offset:1024 sc1 lds
    buffer_load_dwordx4 v5, s[12:15], s49 offen offset:2048 sc1 lds
    buffer_load_dwordx4 v5, s[12:15], s49 offen offset:3072 sc1 lds
    s_add_u32 s49, s49, 4096
    s_bitcmp1_b32 s50, 0
    s_cselect_b32 s3, 0, 16384
    s_add_u32 s48, s48, s3
    s_add_u32 s49, s49, s3
    s_cmp_eq_u32 s50, 12
    s_cselect_b32 s3, 4294819840, 0
    s_add_u32 s48, s48, 4096
    s_add_u32 s48, s48, s3
    s_cmp_ge_u32 s9, 2
    s_cbranch_scc1 stg_38
stg_38:
    s_cmp_eq_u32 s60, 0
    s_cbranch_scc1 ub_39
    buffer_store_dwordx4 v[192:195], v14, s[12:15], s57 offen offset:0 sc1
    v_mfma_f32_16x16x32_bf16 v[28:31], v[24:27], v[192:195], 0
    buffer_store_dwordx4 v[196:199], v14, s[12:15], s57 offen offset:1024 sc1
    v_mfma_f32_16x16x32_bf16 v[28:31], v[24:27], v[196:199], v[28:31]
ub_39:
    s_cmp_ge_u32 s9, 2
    s_cbranch_scc1 wc_40
    s_bitcmp1_b32 s9, 0
    s_cbranch_scc1 wc_40_b
    ds_read_b128 v[64:67], v3 offset:0
    ds_read_b128 v[68:71], v3 offset:1024
    ds_read_b128 v[72:75], v3 offset:2048
    ds_read_b128 v[76:79], v3 offset:3072
    ds_read_b128 v[80:83], v3 offset:4096
    ds_read_b128 v[84:87], v3 offset:5120
    ds_read_b128 v[88:91], v3 offset:6144
    ds_read_b128 v[92:95], v3 offset:7168
    s_branch wc_40_w
wc_40_b:
    ds_read_b128 v[160:163], v3 offset:0
    ds_read_b128 v[164:167], v3 offset:1024
    ds_read_b128 v[168:171], v3 offset:2048
    ds_read_b128 v[172:175], v3 offset:3072
    ds_read_b128 v[176:179], v3 offset:4096
    ds_read_b128 v[180:183], v3 offset:5120
    ds_read_b128 v[184:187], v3 offset:6144
    ds_read_b128 v[188:191], v3 offset:7168
wc_40_w:
    s_waitcnt lgkmcnt(0)
wc_40:
    s_cmp_lg_u32 s51, 0
    s_cbranch_scc1 role_41
    v_add_f32_dpp v32, v32, v32 row_ror:4 row_mask:0xf bank_mask:0xf
    v_add_f32_dpp v33, v33, v33 row_ror:4 row_mask:0xf bank_mask:0xf
    v_add_f32_dpp v34, v34, v34 row_ror:4 row_mask:0xf bank_mask:0xf
    v_add_f32_dpp v35, v35, v35 row_ror:4 row_mask:0xf bank_mask:0xf
    v_add_f32_dpp v32, v32, v32 row_ror:8 row_mask:0xf bank_mask:0xf
    v_add_f32_dpp v33, v33, v33 row_ror:8 row_mask:0xf bank_mask:0xf
    v_add_f32_dpp v34, v34, v34 row_ror:8 row_mask:0xf bank_mask:0xf
    v_add_f32_dpp v35, v35, v35 row_ror:8 row_mask:0xf bank_mask:0xf
    v_mov_b32 v36, v32
    v_mov_b32 v37, v33
    v_mov_b32 v38, v34
    v_mov_b32 v39, v35
    v_permlane16_swap_b32 v32, v36
    v_permlane16_swap_b32 v33, v37
    v_permlane16_swap_b32 v34, v38
    v_permlane16_swap_b32 v35, v39
    v_add_f32 v32, v32, v36
    v_add_f32 v33, v33, v37
    v_add_f32 v34, v34, v38
    v_add_f32 v35, v35, v39
    v_mov_b32 v36, v32
    v_mov_b32 v37, v33
    v_mov_b32 v38, v34
    v_mov_b32 v39, v35
    v_permlane32_swap_b32 v32, v36
    v_permlane32_swap_b32 v33, v37
    v_permlane32_swap_b32 v34, v38
    v_permlane32_swap_b32 v35, v39
    v_add_f32 v40, v32, v36
    v_add_f32 v42, v33, v37
    v_add_f32 v44, v34, v38
    v_add_f32 v46, v35, v39
role_41:
    s_lshr_b32 s3, s9, 1
    s_andn2_b32 s3, s50, s3
    s_bitcmp0_b32 s3, 0
    s_cbranch_scc1 str_42
    s_waitcnt vmcnt(1)
    s_mov_b32 m0, s48
    s_add_u32 s50, s50, 1
    buffer_load_dwordx4 v5, s[12:15], s49 offen offset:0 sc1 lds
    buffer_load_dwordx4 v5, s[12:15], s49 offen offset:1024 sc1 lds
    buffer_load_dwordx4 v5, s[12:15], s49 offen offset:2048 sc1 lds
    buffer_load_dwordx4 v5, s[12:15], s49 offen offset:3072 sc1 lds
    s_add_u32 s49, s49, 4096
    s_bitcmp1_b32 s50, 0
    s_cselect_b32 s3, 0, 16384
    s_add_u32 s48, s48, s3
    s_add_u32 s49, s49, s3
    s_cmp_eq_u32 s50, 12
    s_cselect_b32 s3, 4294819840, 0
    s_add_u32 s48, s48, 4096
    s_add_u32 s48, s48, s3
str_42:
    s_waitcnt vmcnt(8)
    s_barrier
    s_cmp_gt_u32 s50, 15
    s_cbranch_scc1 stg_43
    s_mov_b32 m0, s48
    s_add_u32 s50, s50, 1
    buffer_load_dwordx4 v5, s[12:15], s49 offen offset:0 sc1 lds
    buffer_load_dwordx4 v5, s[12:15], s49 offen offset:1024 sc1 lds
    buffer_load_dwordx4 v5, s[12:15], s49 offen offset:2048 sc1 lds
    buffer_load_dwordx4 v5, s[12:15], s49 offen offset:3072 sc1 lds
    s_add_u32 s49, s49, 4096
    s_bitcmp1_b32 s50, 0
    s_cselect_b32 s3, 0, 16384
    s_add_u32 s48, s48, s3
    s_add_u32 s49, s49, s3
    s_cmp_eq_u32 s50, 12
    s_cselect_b32 s3, 4294819840, 0
    s_add_u32 s48, s48, 4096
    s_add_u32 s48, s48, s3
    s_cmp_ge_u32 s9, 2
    s_cbranch_scc1 stg_43
stg_43:
    s_cmp_eq_u32 s60, 0
    s_cbranch_scc1 ub_44
    buffer_store_dwordx4 v[200:203], v14, s[12:15], s57 offen offset:512 sc1
    v_mfma_f32_16x16x32_bf16 v[28:31], v[24:27], v[200:203], v[28:31]
    buffer_store_dwordx4 v[204:207], v14, s[12:15], s57 offen offset:1536 sc1
    v_mfma_f32_16x16x32_bf16 v[28:31], v[24:27], v[204:207], v[28:31]
ub_44:
    s_cmp_lg_u32 s51, 0
    s_cbranch_scc1 role_45
    v_mul_f32 v40, 0x3a800000, v40
    v_mul_f32 v44, 0x3a800000, v44
    v_mul_f32 v42, 0x3a800000, v42
    v_mul_f32 v46, 0x3a800000, v46
    v_fma_f32 v42, -v40, v40, v42
    v_fma_f32 v46, -v44, v44, v46
    v_max_f32 v42, 0, v42
    v_max_f32 v46, 0, v46
    v_add_f32 v42, 0x3727c5ac, v42
    v_add_f32 v46, 0x3727c5ac, v46
    v_rsq_f32 v42, v42
    v_rsq_f32 v46, v46
    s_lshl_b32 s3, s11, 7
    s_add_u32 s3, s3, s56
    s_mov_b64 exec, 0xf
    buffer_store_dwordx4 v[40:43], v7, s[12:15], s3 offen offset:0 sc1
    buffer_store_dwordx4 v[44:47], v7, s[12:15], s3 offen offset:16 sc1
    s_mov_b64 exec, -1
role_45:
    s_lshr_b32 s3, s9, 1
    s_andn2_b32 s3, s50, s3
    s_bitcmp0_b32 s3, 0
    s_cbranch_scc1 str_46
    s_waitcnt vmcnt(1)
    s_mov_b32 m0, s48
    s_add_u32 s50, s50, 1
    buffer_load_dwordx4 v5, s[12:15], s49 offen offset:0 sc1 lds
    buffer_load_dwordx4 v5, s[12:15], s49 offen offset:1024 sc1 lds
    buffer_load_dwordx4 v5, s[12:15], s49 offen offset:2048 sc1 lds
    buffer_load_dwordx4 v5, s[12:15], s49 offen offset:3072 sc1 lds
    s_add_u32 s49, s49, 4096
    s_bitcmp1_b32 s50, 0
    s_cselect_b32 s3, 0, 16384
    s_add_u32 s48, s48, s3
    s_add_u32 s49, s49, s3
    s_cmp_eq_u32 s50, 12
    s_cselect_b32 s3, 4294819840, 0
    s_add_u32 s48, s48, 4096
    s_add_u32 s48, s48, s3
str_46:
    s_waitcnt vmcnt(8)
    s_barrier
    s_cmp_gt_u32 s50, 15
    s_cbranch_scc1 stg_47
    s_mov_b32 m0, s48
    s_add_u32 s50, s50, 1
    buffer_load_dwordx4 v5, s[12:15], s49 offen offset:0 sc1 lds
    buffer_load_dwordx4 v5, s[12:15], s49 offen offset:1024 sc1 lds
    buffer_load_dwordx4 v5, s[12:15], s49 offen offset:2048 sc1 lds
    buffer_load_dwordx4 v5, s[12:15], s49 offen offset:3072 sc1 lds
    s_add_u32 s49, s49, 4096
    s_bitcmp1_b32 s50, 0
    s_cselect_b32 s3, 0, 16384
    s_add_u32 s48, s48, s3
    s_add_u32 s49, s49, s3
    s_cmp_eq_u32 s50, 12
    s_cselect_b32 s3, 4294819840, 0
    s_add_u32 s48, s48, 4096
    s_add_u32 s48, s48, s3
    s_cmp_ge_u32 s9, 2
    s_cbranch_scc1 stg_47
stg_47:
    s_cmp_eq_u32 s60, 0
    s_cbranch_scc1 ub_48
    buffer_store_dwordx4 v[208:211], v14, s[12:15], s57 offen offset:2048 sc1
    v_mfma_f32_16x16x32_bf16 v[28:31], v[24:27], v[208:211], v[28:31]
    buffer_store_dwordx4 v[212:215], v14, s[12:15], s57 offen offset:3072 sc1
    v_mfma_f32_16x16x32_bf16 v[28:31], v[24:27], v[212:215], v[28:31]
ub_48:
    s_cmp_ge_u32 s9, 2
    s_cbranch_scc1 wc_49
    s_bitcmp1_b32 s9, 0
    s_cbranch_scc1 wc_49_b
    ds_read_b128 v[96:99], v3 offset:24576
    ds_read_b128 v[100:103], v3 offset:25600
    ds_read_b128 v[104:107], v3 offset:26624
    ds_read_b128 v[108:111], v3 offset:27648
    ds_read_b128 v[112:115], v3 offset:28672
    ds_read_b128 v[116:119], v3 offset:29696
    ds_read_b128 v[120:123], v3 offset:30720
    ds_read_b128 v[124:127], v3 offset:31744
    s_branch wc_49_w
wc_49_b:
    ds_read_b128 v[192:195], v3 offset:24576
    ds_read_b128 v[196:199], v3 offset:25600
    ds_read_b128 v[200:203], v3 offset:26624
    ds_read_b128 v[204:207], v3 offset:27648
    ds_read_b128 v[208:211], v3 offset:28672
    ds_read_b128 v[212:215], v3 offset:29696
    ds_read_b128 v[216:219], v3 offset:30720
    ds_read_b128 v[220:223], v3 offset:31744
wc_49_w:
    s_waitcnt lgkmcnt(0)
wc_49:
    s_lshr_b32 s3, s9, 1
    s_andn2_b32 s3, s50, s3
    s_bitcmp0_b32 s3, 0
    s_cbranch_scc1 str_50
    s_waitcnt vmcnt(1)
    s_mov_b32 m0, s48
    s_add_u32 s50, s50, 1
    buffer_load_dwordx4 v5, s[12:15], s49 offen offset:0 sc1 lds
    buffer_load_dwordx4 v5, s[12:15], s49 offen offset:1024 sc1 lds
    buffer_load_dwordx4 v5, s[12:15], s49 offen offset:2048 sc1 lds
    buffer_load_dwordx4 v5, s[12:15], s49 offen offset:3072 sc1 lds
    s_add_u32 s49, s49, 4096
    s_bitcmp1_b32 s50, 0
    s_cselect_b32 s3, 0, 16384
    s_add_u32 s48, s48, s3
    s_add_u32 s49, s49, s3
    s_cmp_eq_u32 s50, 12
    s_cselect_b32 s3, 4294819840, 0
    s_add_u32 s48, s48, 4096
    s_add_u32 s48, s48, s3
str_50:
    s_waitcnt vmcnt(8)
    s_barrier
    s_cmp_gt_u32 s50, 15
    s_cbranch_scc1 stg_51
    s_mov_b32 m0, s48
    s_add_u32 s50, s50, 1
    buffer_load_dwordx4 v5, s[12:15], s49 offen offset:0 sc1 lds
    buffer_load_dwordx4 v5, s[12:15], s49 offen offset:1024 sc1 lds
    buffer_load_dwordx4 v5, s[12:15], s49 offen offset:2048 sc1 lds
    buffer_load_dwordx4 v5, s[12:15], s49 offen offset:3072 sc1 lds
    s_add_u32 s49, s49, 4096
    s_bitcmp1_b32 s50, 0
    s_cselect_b32 s3, 0, 16384
    s_add_u32 s48, s48, s3
    s_add_u32 s49, s49, s3
    s_cmp_eq_u32 s50, 12
    s_cselect_b32 s3, 4294819840, 0
    s_add_u32 s48, s48, 4096
    s_add_u32 s48, s48, s3
    s_cmp_ge_u32 s9, 2
    s_cbranch_scc1 stg_51
stg_51:
    s_cmp_eq_u32 s60, 0
    s_cbranch_scc1 ub_52
    buffer_store_dwordx4 v[216:219], v14, s[12:15], s57 offen offset:2560 sc1
    v_mfma_f32_16x16x32_bf16 v[28:31], v[24:27], v[216:219], v[28:31]
    buffer_store_dwordx4 v[220:223], v14, s[12:15], s57 offen offset:3584 sc1
    v_mfma_f32_16x16x32_bf16 v[28:31], v[24:27], v[220:223], v[28:31]
ub_52:
    s_cmp_ge_u32 s9, 2
    s_cbranch_scc1 wc_53
    s_bitcmp1_b32 s9, 0
    s_cbranch_scc1 wc_53_b
    ds_read_b128 v[128:131], v3 offset:49152
    ds_read_b128 v[132:135], v3 offset:50176
    ds_read_b128 v[136:139], v3 offset:51200
    ds_read_b128 v[140:143], v3 offset:52224
    ds_read_b128 v[144:147], v3 offset:53248
    ds_read_b128 v[148:151], v3 offset:54272
    ds_read_b128 v[152:155], v3 offset:55296
    ds_read_b128 v[156:159], v3 offset:56320
    s_branch wc_53_w
wc_53_b:
    ds_read_b128 a[0:3], v3 offset:49152
    ds_read_b128 a[4:7], v3 offset:50176
    ds_read_b128 a[8:11], v3 offset:51200
    ds_read_b128 a[12:15], v3 offset:52224
    ds_read_b128 a[16:19], v3 offset:53248
    ds_read_b128 a[20:23], v3 offset:54272
    ds_read_b128 a[24:27], v3 offset:55296
    ds_read_b128 a[28:31], v3 offset:56320
wc_53_w:
    s_waitcnt lgkmcnt(0)
wc_53:
    s_cmp_lg_u32 s51, 1
    s_cbranch_scc1 role_54
    s_and_b32 s52, s11, 0xe0
    s_lshl_b32 s52, s52, 7
    s_add_u32 s52, s52, s56
    s_lshr_b32 s3, s6, 1
    s_min_u32 s3, s3, 1
    s_andn2_b32 s3, s3, s9
    s_lshl_b32 s3, s3, 8
    s_sub_u32 s53, s52, s3
    buffer_load_dwordx4 v[32:35], v5, s[12:15], s52 offen offset:0 sc1
    buffer_load_dwordx4 v[36:39], v5, s[12:15], s52 offen offset:1024 sc1
    buffer_load_dwordx4 v[40:43], v5, s[12:15], s52 offen offset:2048 sc1
    buffer_load_dwordx4 v[44:47], v5, s[12:15], s52 offen offset:3072 sc1
    buffer_load_dwordx4 v[48:51], v6, s[12:15], s53 offen sc1
role_54:
    s_lshr_b32 s3, s9, 1
    s_andn2_b32 s3, s50, s3
    s_bitcmp0_b32 s3, 0
    s_cbranch_scc1 str_55
    s_waitcnt vmcnt(1)
    s_mov_b32 m0, s48
    s_add_u32 s50, s50, 1
    buffer_load_dwordx4 v5, s[12:15], s49 offen offset:0 sc1 lds
    buffer_load_dwordx4 v5, s[12:15], s49 offen offset:1024 sc1 lds
    buffer_load_dwordx4 v5, s[12:15], s49 offen offset:2048 sc1 lds
    buffer_load_dwordx4 v5, s[12:15], s49 offen offset:3072 sc1 lds
    s_add_u32 s49, s49, 4096
    s_bitcmp1_b32 s50, 0
    s_cselect_b32 s3, 0, 16384
    s_add_u32 s48, s48, s3
    s_add_u32 s49, s49, s3
    s_cmp_eq_u32 s50, 12
    s_cselect_b32 s3, 4294819840, 0
    s_add_u32 s48, s48, 4096
    s_add_u32 s48, s48, s3
str_55:
    s_waitcnt vmcnt(8)
    s_barrier
    s_waitcnt vmcnt(0)
    s_cmp_gt_u32 s50, 15
    s_cbranch_scc1 stg_56
    s_mov_b32 m0, s48
    s_add_u32 s50, s50, 1
    buffer_load_dwordx4 v5, s[12:15], s49 offen offset:0 sc1 lds
    buffer_load_dwordx4 v5, s[12:15], s49 offen offset:1024 sc1 lds
    buffer_load_dwordx4 v5, s[12:15], s49 offen offset:2048 sc1 lds
    buffer_load_dwordx4 v5, s[12:15], s49 offen offset:3072 sc1 lds
    s_add_u32 s49, s49, 4096
    s_bitcmp1_b32 s50, 0
    s_cselect_b32 s3, 0, 16384
    s_add_u32 s48, s48, s3
    s_add_u32 s49, s49, s3
    s_cmp_eq_u32 s50, 12
    s_cselect_b32 s3, 4294819840, 0
    s_add_u32 s48, s48, 4096
    s_add_u32 s48, s48, s3
    s_cmp_ge_u32 s9, 2
    s_cbranch_scc1 stg_56
stg_56:
    s_cmp_eq_u32 s60, 0
    s_cbranch_scc1 ub_57
    v_add_f32_dpp v28, v28, v28 row_ror:8 row_mask:0xf bank_mask:0xf
    v_add_f32_dpp v29, v29, v29 row_ror:8 row_mask:0xf bank_mask:0xf
    v_add_f32_dpp v30, v30, v30 row_ror:8 row_mask:0xf bank_mask:0xf
    v_add_f32_dpp v31, v31, v31 row_ror:8 row_mask:0xf bank_mask:0xf
    s_mov_b64 exec, 0x00ff00ff
    buffer_store_dwordx4 v[28:31], v15, s[12:15], s54 offen sc1
    s_mov_b64 exec, -1
ub_57:
    s_cmp_lg_u32 s51, 1
    s_cbranch_scc1 role_58
    s_mov_b32 s3, 0x100000
l_st_chk:
    v_cmp_ne_u32 s[64:65], s10, v33
    v_cmp_ne_u32 vcc, s10, v35
    s_or_b64 s[64:65], s[64:65], vcc
    v_cmp_ne_u32 vcc, s10, v37
    s_or_b64 s[64:65], s[64:65], vcc
    v_cmp_ne_u32 vcc, s10, v39
    s_or_b64 s[64:65], s[64:65], vcc
    v_cmp_ne_u32 vcc, s10, v41
    s_or_b64 s[64:65], s[64:65], vcc
    v_cmp_ne_u32 vcc, s10, v43
    s_or_b64 s[64:65], s[64:65], vcc
    v_cmp_ne_u32 vcc, s10, v45
    s_or_b64 s[64:65], s[64:65], vcc
    v_cmp_ne_u32 vcc, s10, v47
    s_or_b64 s[64:65], s[64:65], vcc
    v_cmp_ne_u32 vcc, s10, v49
    s_or_b64 s[64:65], s[64:65], vcc
    v_cmp_ne_u32 vcc, s10, v51
    s_or_b64 s[64:65], s[64:65], vcc
    s_cbranch_scc0 l_st_ok
    s_sub_u32 s3, s3, 1
    s_cbranch_scc0 l_st_again
l_st_ok:
    ds_write_b32 v11, v32 offset:1280
    ds_write_b32 v11, v34 offset:2816
    ds_write_b32 v11, v36 offset:1536
    ds_write_b32 v11, v38 offset:3072
    ds_write_b32 v11, v40 offset:1792
    ds_write_b32 v11, v42 offset:3328
    ds_write_b32 v11, v44 offset:2048
    ds_write_b32 v11, v46 offset:3584
    s_mov_b64 exec, 0xffff
    ds_write_b32 v11, v48 offset:1216
    ds_write_b32 v11, v50 offset:2752
    s_mov_b64 exec, -1
    s_waitcnt lgkmcnt(0)
role_58:
    s_lshr_b32 s3, s9, 1
    s_andn2_b32 s3, s50, s3
    s_bitcmp0_b32 s3, 0
    s_cbranch_scc1 str_59
    s_waitcnt vmcnt(1)
    s_mov_b32 m0, s48
    s_add_u32 s50, s50, 1
    buffer_load_dwordx4 v5, s[12:15], s49 offen offset:0 sc1 lds
    buffer_load_dwordx4 v5, s[12:15], s49 offen offset:1024 sc1 lds
    buffer_load_dwordx4 v5, s[12:15], s49 offen offset:2048 sc1 lds
    buffer_load_dwordx4 v5, s[12:15], s49 offen offset:3072 sc1 lds
    s_add_u32 s49, s49, 4096
    s_bitcmp1_b32 s50, 0
    s_cselect_b32 s3, 0, 16384
    s_add_u32 s48, s48, s3
    s_add_u32 s49, s49, s3
    s_cmp_eq_u32 s50, 12
    s_cselect_b32 s3, 4294819840, 0
    s_add_u32 s48, s48, 4096
    s_add_u32 s48, s48, s3
str_59:
    s_add_u32 s61, s51, 48
    s_bitcmp1_b32 s9, 0
    s_cbranch_scc1 wo_60
    s_mov_b32 s24, s36
    s_mov_b32 s25, s37
    s_mov_b32 s26, 2097152
    s_mov_b32 s27, 0x00020000
    s_and_b32 s3, s7, 7
    s_cmp_eq_u32 s3, 3
    s_cbranch_scc0 wo_60
    s_cmp_eq_u32 s9, 0
    s_cbranch_scc1 wo_60
wop_61:
    s_lshl_b32 m0, s61, 10
    s_lshr_b32 s3, s61, 1
    s_xor_b32 s3, s3, s61
    s_and_b32 s3, s3, 1
    s_mul_i32 s3, s3, 3
    s_xor_b32 s3, s3, s61
    s_lshl_b32 s3, s3, 14
    buffer_load_dwordx4 v17, s[24:27], s3 offen lds
    s_add_u32 s61, s61, 3
    s_waitcnt vmcnt(4)
    s_cmp_lt_u32 s61, 66
    s_cbranch_scc1 wop_61
wo_60:
    s_waitcnt vmcnt(8)
    s_barrier
    s_cmp_eq_u32 s60, 0
    s_cbranch_scc1 ub_62
    s_waitcnt vmcnt(0)
    s_mov_b64 exec, 0xffff
    buffer_store_dword v9, v16, s[12:15], s55 offen offset:384 sc1
    s_mov_b64 exec, -1
ub_62:
    s_bitcmp1_b32 s9, 0
    s_cbranch_scc1 wo_63
    s_mov_b32 s24, s36
    s_mov_b32 s25, s37
    s_mov_b32 s26, 2097152
    s_mov_b32 s27, 0x00020000
    s_and_b32 s3, s7, 7
    s_cmp_eq_u32 s3, 3
    s_cbranch_scc0 wo_63
    s_cmp_eq_u32 s9, 0
    s_cbranch_scc1 wo_63
wop_64:
    s_lshl_b32 m0, s61, 10
    s_lshr_b32 s3, s61, 1
    s_xor_b32 s3, s3, s61
    s_and_b32 s3, s3, 1
    s_mul_i32 s3, s3, 3
    s_xor_b32 s3, s3, s61
    s_lshl_b32 s3, s3, 14
    buffer_load_dwordx4 v17, s[24:27], s3 offen lds
    s_add_u32 s61, s61, 3
    s_waitcnt vmcnt(4)
    s_cmp_lt_u32 s61, 84
    s_cbranch_scc1 wop_64
wo_63:
    s_waitcnt vmcnt(0)
    s_barrier
    s_bitcmp1_b32 s9, 0
    s_cbranch_scc1 wo_65
    s_mov_b32 s24, s36
    s_mov_b32 s25, s37
    s_mov_b32 s26, 2097152
    s_mov_b32 s27, 0x00020000
    s_and_b32 s3, s7, 7
    s_cmp_eq_u32 s3, 3
    s_cselect_b32 s62, 27, 48
    s_cselect_b32 s63, 12, 24
    s_add_u32 s62, s62, s61
    s_sub_u32 s62, s62, s51
    s_add_u32 s63, s63, s62
wop_66:
    s_lshl_b32 m0, s61, 10
    s_lshr_b32 s3, s61, 1
    s_xor_b32 s3, s3, s61
    s_and_b32 s3, s3, 1
    s_mul_i32 s3, s3, 3
    s_xor_b32 s3, s3, s61
    s_lshl_b32 s3, s3, 14
    buffer_load_dwordx4 v17, s[24:27], s3 offen lds
    s_add_u32 s61, s61, 3
    s_waitcnt vmcnt(7)
    s_cmp_lt_u32 s61, s62
    s_cbranch_scc1 wop_66
wo_65:
    s_barrier
    s_bitcmp1_b32 s9, 0
    s_cbranch_scc1 s_attn
    s_mov_b32 s24, s36
    s_mov_b32 s25, s37
    s_mov_b32 s26, 2097152
    s_mov_b32 s27, 0x00020000
wop_67:
    s_lshl_b32 m0, s61, 10
    s_lshr_b32 s3, s61, 1
    s_xor_b32 s3, s3, s61
    s_and_b32 s3, s3, 1
    s_mul_i32 s3, s3, 3
    s_xor_b32 s3, s3, s61
    s_lshl_b32 s3, s3, 14
    buffer_load_dwordx4 v17, s[24:27], s3 offen lds
    s_add_u32 s61, s61, 3
    s_waitcnt vmcnt(7)
    s_cmp_lt_u32 s61, s63
    s_cbranch_scc1 wop_67
    s_barrier
wop_68:
    s_lshl_b32 m0, s61, 10
    s_lshr_b32 s3, s61, 1
    s_xor_b32 s3, s3, s61
    s_and_b32 s3, s3, 1
    s_mul_i32 s3, s3, 3
    s_xor_b32 s3, s3, s61
    s_lshl_b32 s3, s3, 14
    buffer_load_dwordx4 v17, s[24:27], s3 offen lds
    s_add_u32 s61, s61, 3
    s_waitcnt vmcnt(7)
    s_cmp_lt_u32 s61, 128
    s_cbranch_scc1 wop_68
    s_mov_b32 s61, s51
wop_69:
    s_lshl_b32 m0, s61, 10
    s_lshr_b32 s3, s61, 1
    s_xor_b32 s3, s3, s61
    s_and_b32 s3, s3, 1
    s_mul_i32 s3, s3, 3
    s_xor_b32 s3, s3, s61
    s_lshl_b32 s3, s3, 14
    buffer_load_dwordx4 v17, s[24:27], s3 offen lds
    s_add_u32 s61, s61, 3
    s_waitcnt vmcnt(7)
    s_cmp_lt_u32 s61, 48
    s_cbranch_scc1 wop_69
    s_branch l_wo
l_st_again:
    buffer_load_dwordx4 v[32:35], v5, s[12:15], s52 offen offset:0 sc1
    buffer_load_dwordx4 v[36:39], v5, s[12:15], s52 offen offset:1024 sc1
    buffer_load_dwordx4 v[40:43], v5, s[12:15], s52 offen offset:2048 sc1
    buffer_load_dwordx4 v[44:47], v5, s[12:15], s52 offen offset:3072 sc1
    buffer_load_dwordx4 v[48:51], v6, s[12:15], s53 offen sc1
    s_waitcnt vmcnt(0)
    s_branch l_st_chk
.p2align 6
h_wo:
l_wo:
    s_mul_i32 s98, s9, 786432
    s_add_u32 s98, s98, 65798144
    s_lshl_b32 s99, s11, 10
    s_add_u32 s98, s98, s99
    s_add_u32 s96, s4, s98
    s_addc_u32 s97, s5, 0
    s_mov_b32 s98, s10
    s_mov_b32 s99, s10
    s_sub_u32 s59, s8, 4
    s_lshl_b32 s60, s59, 7
    s_add_u32 s96, s96, s60
    s_addc_u32 s97, s97, 0
    s_lshl_b32 s60, s9, 2
    s_add_u32 s60, s60, 159504
    v_mov_b32 v10, s60
    s_lshl_b32 s60, 1, s59
    v_mov_b32 v11, s60
    v_lshlrev_b32 v13, 4, v11
    s_mov_b64 exec, 1
    s_waitcnt vmcnt(0)
    ds_or_b32 v10, v13
    s_mov_b32 s3, 0x100000
poll_70:
    s_load_dwordx8 s[88:95], s[96:97], 0 glc
    s_sub_u32 s3, s3, 1
    s_cbranch_scc1 poll_70_ok
    s_waitcnt lgkmcnt(0)
    s_xor_b64 s[100:101], s[88:89], s[98:99]
    s_xor_b64 s[88:89], s[90:91], s[98:99]
    s_or_b64 s[100:101], s[100:101], s[88:89]
    s_xor_b64 s[88:89], s[92:93], s[98:99]
    s_or_b64 s[100:101], s[100:101], s[88:89]
    s_xor_b64 s[88:89], s[94:95], s[98:99]
    s_or_b64 s[100:101], s[100:101], s[88:89]
    s_cbranch_scc1 poll_70
poll_70_ok:
    s_waitcnt lgkmcnt(0)
    ds_or_b32 v10, v11
    s_mov_b64 exec, -1
    s_setprio 0
    s_waitcnt lgkmcnt(0)
    s_cmp_eq_u32 s8, 4
    s_cbranch_scc1 l_wo_end
    s_cmp_lg_u32 s9, 0
    s_cbranch_scc1 l_wo_end
    s_lshl_b32 s53, s8, 7
    s_lshl_b32 s52, s11, 10
    s_add_u32 s53, s53, s52
    s_add_u32 s53, s53, 64487168
    s_add_u32 s96, s4, s53
    s_addc_u32 s97, s5, 0
    s_mov_b32 s98, s10
    s_mov_b32 s99, s10
    s_mov_b32 s3, 0x100000
poll_71:
    s_load_dwordx16 s[80:95], s[96:97], 0 glc
    s_sub_u32 s3, s3, 1
    s_cbranch_scc1 poll_71_ok
    s_waitcnt lgkmcnt(0)
    s_xor_b64 s[100:101], s[80:81], s[98:99]
    s_xor_b64 s[80:81], s[82:83], s[98:99]
    s_or_b64 s[100:101], s[100:101], s[80:81]
    s_xor_b64 s[80:81], s[84:85], s[98:99]
    s_or_b64 s[100:101], s[100:101], s[80:81]
    s_xor_b64 s[80:81], s[86:87], s[98:99]
    s_or_b64 s[100:101], s[100:101], s[80:81]
    s_xor_b64 s[80:81], s[88:89], s[98:99]
    s_or_b64 s[100:101], s[100:101], s[80:81]
    s_xor_b64 s[80:81], s[90:91], s[98:99]
    s_or_b64 s[100:101], s[100:101], s[80:81]
    s_xor_b64 s[80:81], s[92:93], s[98:99]
    s_or_b64 s[100:101], s[100:101], s[80:81]
    s_xor_b64 s[80:81], s[94:95], s[98:99]
    s_or_b64 s[100:101], s[100:101], s[80:81]
    s_cbranch_scc1 poll_71
poll_71_ok:
    s_waitcnt lgkmcnt(0)
l_wo_end:
    s_add_u32 s9, s9, 1
    s_cmp_lg_u32 s9, 4
    s_cbranch_scc1 l_wo_next
    s_branch k_exit
l_wo_next:
    s_cmp_lg_u32 s8, 4
    s_cbranch_scc1 l_qkv
    s_cmp_eq_u32 s9, 2
    s_cbranch_scc1 h_qkvA
    s_branch h_qkvB
.p2align 6
s_attn:
    s_sub_u32 s48, s8, 4
    s_lshl_b32 s3, s7, 7
    v_lshrrev_b32 v20, 3, v1
    v_lshlrev_b32 v21, 11, v20
    v_and_b32 v22, 2, v20
    v_lshrrev_b32 v23, 2, v20
    v_or_b32 v22, v22, v23
    v_bfe_u32 v23, v1, 1, 2
    v_xor_b32 v22, v22, v23
    v_lshl_add_u32 v21, v22, 5, v21
    v_and_b32 v22, 1, v1
    v_lshl_add_u32 v21, v22, 4, v21
    v_add_u32 v7, s3, v21
    s_mov_b32 s24, s42
    s_mov_b32 s25, s43
    s_mov_b32 s26, 2097152
    s_mov_b32 s27, 0x00020000
    s_lshr_b32 s49, s9, 1
    s_lshl_b32 s49, s49, 23
    s_lshl_b32 s52, s7, 19
    s_add_u32 s49, s49, s52
    s_and_b32 s52, s6, 1
    s_lshl_b32 s52, s52, 18
    s_add_u32 s49, s49, s52
    s_add_u32 s49, s49, 33554432
    s_lshr_b32 s61, s6, 1
    s_mul_i32 s54, s9, 786432
    s_add_u32 s54, s54, 66322432
    s_lshl_b32 s55, s11, 10
    s_add_u32 s54, s54, s55
    s_add_u32 s52, s4, s54
    s_addc_u32 s53, s5, 0
    s_mov_b32 s54, s10
    s_mov_b32 s55, s10
    s_lshl_b32 s51, s48, 11
    s_add_u32 s49, s49, s51
    s_add_u32 s51, s51, 81920
    s_mov_b32 s60, s48
    s_setprio 3
    s_barrier
    s_lshl_b32 s58, 1, s61
    s_mov_b32 s57, 0
    s_add_u32 s62, s61, 1
    s_and_b32 s62, s62, 7
    s_lshl_b32 s50, s62, 15
    s_add_u32 s50, s50, s49
    s_lshr_b32 s63, s62, 1
    s_lshl_b32 s63, s63, 7
    s_and_b32 s62, s62, 1
    s_lshl_b32 s62, s62, 4
    s_add_u32 s62, s62, s63
    s_mov_b32 s58, 0x100000
need_72:
    s_load_dwordx4 s[64:67], s[52:53], s62 glc
    s_sub_u32 s58, s58, 1
    s_cbranch_scc1 need_72_ok
    s_waitcnt lgkmcnt(0)
need_72_t:
    s_cmp_ge_u32 s48, 2
    s_cselect_b32 s63, s65, s64
    s_cmp_lg_u32 s63, s10
    s_cbranch_scc1 need_72
need_72_ok:
    s_waitcnt lgkmcnt(0)
    s_add_u32 m0, s51, 32768
    s_nop 0
    buffer_load_dwordx4 v5, s[12:15], s50 offen offset:0 sc1 lds
    buffer_load_dwordx4 v5, s[12:15], s50 offen offset:1024 sc1 lds
    s_add_u32 s50, s50, 8192
    s_add_u32 m0, s51, 40960
    s_nop 0
    buffer_load_dwordx4 v5, s[12:15], s50 offen offset:0 sc1 lds
    buffer_load_dwordx4 v5, s[12:15], s50 offen offset:1024 sc1 lds
    s_add_u32 s50, s50, 8192
    s_waitcnt vmcnt(0)
    s_barrier
    s_branch need_73_t
need_73:
    s_load_dwordx4 s[64:67], s[52:53], s62 glc
    s_sub_u32 s58, s58, 1
    s_cbranch_scc1 need_73_ok
    s_waitcnt lgkmcnt(0)
need_73_t:
    s_cmp_ge_u32 s48, 2
    s_cselect_b32 s63, s67, s66
    s_cmp_lg_u32 s63, s10
    s_cbranch_scc1 need_73
need_73_ok:
    s_waitcnt lgkmcnt(0)
    s_add_u32 m0, s51, 49152
    s_nop 0
    buffer_load_dwordx4 v5, s[12:15], s50 offen offset:0 sc1 lds
    buffer_load_dwordx4 v5, s[12:15], s50 offen offset:1024 sc1 lds
    s_add_u32 s50, s50, 8192
    s_add_u32 m0, s51, 57344
    s_nop 0
    buffer_load_dwordx4 v5, s[12:15], s50 offen offset:0 sc1 lds
    buffer_load_dwordx4 v5, s[12:15], s50 offen offset:1024 sc1 lds
    s_add_u32 s50, s50, 8192
    s_add_u32 s62, s61, 2
    s_and_b32 s62, s62, 7
    s_lshl_b32 s50, s62, 15
    s_add_u32 s50, s50, s49
    s_lshr_b32 s63, s62, 1
    s_lshl_b32 s63, s63, 7
    s_and_b32 s62, s62, 1
    s_lshl_b32 s62, s62, 4
    s_add_u32 s62, s62, s63
    s_mov_b32 s58, 0x100000
need_74:
    s_load_dwordx4 s[64:67], s[52:53], s62 glc
    s_sub_u32 s58, s58, 1
    s_cbranch_scc1 need_74_ok
    s_waitcnt lgkmcnt(0)
need_74_t:
    s_cmp_ge_u32 s48, 2
    s_cselect_b32 s63, s65, s64
    s_cmp_lg_u32 s63, s10
    s_cbranch_scc1 need_74
need_74_ok:
    s_waitcnt lgkmcnt(0)
    s_add_u32 m0, s51, 0
    s_nop 0
    buffer_load_dwordx4 v5, s[12:15], s50 offen offset:0 sc1 lds
    buffer_load_dwordx4 v5, s[12:15], s50 offen offset:1024 sc1 lds
    s_add_u32 s50, s50, 8192
    s_add_u32 m0, s51, 8192
    s_nop 0
    buffer_load_dwordx4 v5, s[12:15], s50 offen offset:0 sc1 lds
    buffer_load_dwordx4 v5, s[12:15], s50 offen offset:1024 sc1 lds
    s_add_u32 s50, s50, 8192
    s_waitcnt vmcnt(4)
    s_barrier
    s_branch need_75_t
need_75:
    s_load_dwordx4 s[64:67], s[52:53], s62 glc
    s_sub_u32 s58, s58, 1
    s_cbranch_scc1 need_75_ok
    s_waitcnt lgkmcnt(0)
need_75_t:
    s_cmp_ge_u32 s48, 2
    s_cselect_b32 s63, s67, s66
    s_cmp_lg_u32 s63, s10
    s_cbranch_scc1 need_75
need_75_ok:
    s_waitcnt lgkmcnt(0)
    s_add_u32 m0, s51, 16384
    s_nop 0
    buffer_load_dwordx4 v5, s[12:15], s50 offen offset:0 sc1 lds
    buffer_load_dwordx4 v5, s[12:15], s50 offen offset:1024 sc1 lds
    s_add_u32 s50, s50, 8192
    s_add_u32 m0, s51, 24576
    s_nop 0
    buffer_load_dwordx4 v5, s[12:15], s50 offen offset:0 sc1 lds
    buffer_load_dwordx4 v5, s[12:15], s50 offen offset:1024 sc1 lds
    s_add_u32 s50, s50, 8192
    s_waitcnt vmcnt(4)
    s_barrier
    s_add_u32 s62, s61, 3
    s_and_b32 s62, s62, 7
    s_lshl_b32 s50, s62, 15
    s_add_u32 s50, s50, s49
    s_lshr_b32 s63, s62, 1
    s_lshl_b32 s63, s63, 7
    s_and_b32 s62, s62, 1
    s_lshl_b32 s62, s62, 4
    s_add_u32 s62, s62, s63
    s_mov_b32 s58, 0x100000
need_76:
    s_load_dwordx4 s[64:67], s[52:53], s62 glc
    s_sub_u32 s58, s58, 1
    s_cbranch_scc1 need_76_ok
    s_waitcnt lgkmcnt(0)
need_76_t:
    s_cmp_ge_u32 s48, 2
    s_cselect_b32 s63, s65, s64
    s_cmp_lg_u32 s63, s10
    s_cbranch_scc1 need_76
need_76_ok:
    s_waitcnt lgkmcnt(0)
    s_add_u32 m0, s51, 32768
    s_nop 0
    buffer_load_dwordx4 v5, s[12:15], s50 offen offset:0 sc1 lds
    buffer_load_dwordx4 v5, s[12:15], s50 offen offset:1024 sc1 lds
    s_add_u32 s50, s50, 8192
    s_add_u32 m0, s51, 40960
    s_nop 0
    buffer_load_dwordx4 v5, s[12:15], s50 offen offset:0 sc1 lds
    buffer_load_dwordx4 v5, s[12:15], s50 offen offset:1024 sc1 lds
    s_add_u32 s50, s50, 8192
    s_lshl_b32 m0, s60, 10
    s_lshl_b32 s3, s60, 14
    buffer_load_dwordx4 v7, s[24:27], s3 offen lds
    s_add_u32 s60, s60, 4
    s_lshl_b32 m0, s60, 10
    s_lshl_b32 s3, s60, 14
    buffer_load_dwordx4 v7, s[24:27], s3 offen lds
    s_add_u32 s60, s60, 4
    s_waitcnt vmcnt(6)
    s_barrier
    s_branch need_77_t
need_77:
    s_load_dwordx4 s[64:67], s[52:53], s62 glc
    s_sub_u32 s58, s58, 1
    s_cbranch_scc1 need_77_ok
    s_waitcnt lgkmcnt(0)
need_77_t:
    s_cmp_ge_u32 s48, 2
    s_cselect_b32 s63, s67, s66
    s_cmp_lg_u32 s63, s10
    s_cbranch_scc1 need_77
need_77_ok:
    s_waitcnt lgkmcnt(0)
    s_add_u32 m0, s51, 49152
    s_nop 0
    buffer_load_dwordx4 v5, s[12:15], s50 offen offset:0 sc1 lds
    buffer_load_dwordx4 v5, s[12:15], s50 offen offset:1024 sc1 lds
    s_add_u32 s50, s50, 8192
    s_add_u32 m0, s51, 57344
    s_nop 0
    buffer_load_dwordx4 v5, s[12:15], s50 offen offset:0 sc1 lds
    buffer_load_dwordx4 v5, s[12:15], s50 offen offset:1024 sc1 lds
    s_add_u32 s50, s50, 8192
    s_lshl_b32 m0, s60, 10
    s_lshl_b32 s3, s60, 14
    buffer_load_dwordx4 v7, s[24:27], s3 offen lds
    s_add_u32 s60, s60, 4
    s_lshl_b32 m0, s60, 10
    s_lshl_b32 s3, s60, 14
    buffer_load_dwordx4 v7, s[24:27], s3 offen lds
    s_add_u32 s60, s60, 4
    s_waitcnt vmcnt(8)
    s_barrier
    s_add_u32 s62, s61, 4
    s_and_b32 s62, s62, 7
    s_lshl_b32 s50, s62, 15
    s_add_u32 s50, s50, s49
    s_lshr_b32 s63, s62, 1
    s_lshl_b32 s63, s63, 7
    s_and_b32 s62, s62, 1
    s_lshl_b32 s62, s62, 4
    s_add_u32 s62, s62, s63
    s_mov_b32 s58, 0x100000
need_78:
    s_load_dwordx4 s[64:67], s[52:53], s62 glc
    s_sub_u32 s58, s58, 1
    s_cbranch_scc1 need_78_ok
    s_waitcnt lgkmcnt(0)
need_78_t:
    s_cmp_ge_u32 s48, 2
    s_cselect_b32 s63, s65, s64
    s_cmp_lg_u32 s63, s10
    s_cbranch_scc1 need_78
need_78_ok:
    s_waitcnt lgkmcnt(0)
    s_add_u32 m0, s51, 0
    s_nop 0
    buffer_load_dwordx4 v5, s[12:15], s50 offen offset:0 sc1 lds
    buffer_load_dwordx4 v5, s[12:15], s50 offen offset:1024 sc1 lds
    s_add_u32 s50, s50, 8192
    s_add_u32 m0, s51, 8192
    s_nop 0
    buffer_load_dwordx4 v5, s[12:15], s50 offen offset:0 sc1 lds
    buffer_load_dwordx4 v5, s[12:15], s50 offen offset:1024 sc1 lds
    s_add_u32 s50, s50, 8192
    s_lshl_b32 m0, s60, 10
    s_lshl_b32 s3, s60, 14
    buffer_load_dwordx4 v7, s[24:27], s3 offen lds
    s_add_u32 s60, s60, 4
    s_lshl_b32 m0, s60, 10
    s_lshl_b32 s3, s60, 14
    buffer_load_dwordx4 v7, s[24:27], s3 offen lds
    s_add_u32 s60, s60, 4
    s_waitcnt vmcnt(8)
    s_barrier
    s_branch need_79_t
need_79:
    s_load_dwordx4 s[64:67], s[52:53], s62 glc
    s_sub_u32 s58, s58, 1
    s_cbranch_scc1 need_79_ok
    s_waitcnt lgkmcnt(0)
need_79_t:
    s_cmp_ge_u32 s48, 2
    s_cselect_b32 s63, s67, s66
    s_cmp_lg_u32 s63, s10
    s_cbranch_scc1 need_79
need_79_ok:
    s_waitcnt lgkmcnt(0)
    s_add_u32 m0, s51, 16384
    s_nop 0
    buffer_load_dwordx4 v5, s[12:15], s50 offen offset:0 sc1 lds
    buffer_load_dwordx4 v5, s[12:15], s50 offen offset:1024 sc1 lds
    s_add_u32 s50, s50, 8192
    s_add_u32 m0, s51, 24576
    s_nop 0
    buffer_load_dwordx4 v5, s[12:15], s50 offen offset:0 sc1 lds
    buffer_load_dwordx4 v5, s[12:15], s50 offen offset:1024 sc1 lds
    s_add_u32 s50, s50, 8192
    s_lshl_b32 m0, s60, 10
    s_lshl_b32 s3, s60, 14
    buffer_load_dwordx4 v7, s[24:27], s3 offen lds
    s_add_u32 s60, s60, 4
    s_lshl_b32 m0, s60, 10
    s_lshl_b32 s3, s60, 14
    buffer_load_dwordx4 v7, s[24:27], s3 offen lds
    s_add_u32 s60, s60, 4
    s_waitcnt vmcnt(8)
    s_barrier
    s_add_u32 s62, s61, 5
    s_and_b32 s62, s62, 7
    s_lshl_b32 s50, s62, 15
    s_add_u32 s50, s50, s49
    s_lshr_b32 s63, s62, 1
    s_lshl_b32 s63, s63, 7
    s_and_b32 s62, s62, 1
    s_lshl_b32 s62, s62, 4
    s_add_u32 s62, s62, s63
    s_mov_b32 s58, 0x100000
need_80:
    s_load_dwordx4 s[64:67], s[52:53], s62 glc
    s_sub_u32 s58, s58, 1
    s_cbranch_scc1 need_80_ok
    s_waitcnt lgkmcnt(0)
need_80_t:
    s_cmp_ge_u32 s48, 2
    s_cselect_b32 s63, s65, s64
    s_cmp_lg_u32 s63, s10
    s_cbranch_scc1 need_80
need_80_ok:
    s_waitcnt lgkmcnt(0)
    s_add_u32 m0, s51, 32768
    s_nop 0
    buffer_load_dwordx4 v5, s[12:15], s50 offen offset:0 sc1 lds
    buffer_load_dwordx4 v5, s[12:15], s50 offen offset:1024 sc1 lds
    s_add_u32 s50, s50, 8192
    s_add_u32 m0, s51, 40960
    s_nop 0
    buffer_load_dwordx4 v5, s[12:15], s50 offen offset:0 sc1 lds
    buffer_load_dwordx4 v5, s[12:15], s50 offen offset:1024 sc1 lds
    s_add_u32 s50, s50, 8192
    s_lshl_b32 m0, s60, 10
    s_lshl_b32 s3, s60, 14
    buffer_load_dwordx4 v7, s[24:27], s3 offen lds
    s_add_u32 s60, s60, 4
    s_lshl_b32 m0, s60, 10
    s_lshl_b32 s3, s60, 14
    buffer_load_dwordx4 v7, s[24:27], s3 offen lds
    s_add_u32 s60, s60, 4
    s_waitcnt vmcnt(8)
    s_barrier
    s_branch need_81_t
need_81:
    s_load_dwordx4 s[64:67], s[52:53], s62 glc
    s_sub_u32 s58, s58, 1
    s_cbranch_scc1 need_81_ok
    s_waitcnt lgkmcnt(0)
need_81_t:
    s_cmp_ge_u32 s48, 2
    s_cselect_b32 s63, s67, s66
    s_cmp_lg_u32 s63, s10
    s_cbranch_scc1 need_81
need_81_ok:
    s_waitcnt lgkmcnt(0)
    s_add_u32 m0, s51, 49152
    s_nop 0
    buffer_load_dwordx4 v5, s[12:15], s50 offen offset:0 sc1 lds
    buffer_load_dwordx4 v5, s[12:15], s50 offen offset:1024 sc1 lds
    s_add_u32 s50, s50, 8192
    s_add_u32 m0, s51, 57344
    s_nop 0
    buffer_load_dwordx4 v5, s[12:15], s50 offen offset:0 sc1 lds
    buffer_load_dwordx4 v5, s[12:15], s50 offen offset:1024 sc1 lds
    s_add_u32 s50, s50, 8192
    s_lshl_b32 m0, s60, 10
    s_lshl_b32 s3, s60, 14
    buffer_load_dwordx4 v7, s[24:27], s3 offen lds
    s_add_u32 s60, s60, 4
    s_lshl_b32 m0, s60, 10
    s_lshl_b32 s3, s60, 14
    buffer_load_dwordx4 v7, s[24:27], s3 offen lds
    s_add_u32 s60, s60, 4
    s_waitcnt vmcnt(8)
    s_barrier
    s_add_u32 s62, s61, 6
    s_and_b32 s62, s62, 7
    s_lshl_b32 s50, s62, 15
    s_add_u32 s50, s50, s49
    s_lshr_b32 s63, s62, 1
    s_lshl_b32 s63, s63, 7
    s_and_b32 s62, s62, 1
    s_lshl_b32 s62, s62, 4
    s_add_u32 s62, s62, s63
    s_mov_b32 s58, 0x100000
need_82:
    s_load_dwordx4 s[64:67], s[52:53], s62 glc
    s_sub_u32 s58, s58, 1
    s_cbranch_scc1 need_82_ok
    s_waitcnt lgkmcnt(0)
need_82_t:
    s_cmp_ge_u32 s48, 2
    s_cselect_b32 s63, s65, s64
    s_cmp_lg_u32 s63, s10
    s_cbranch_scc1 need_82
need_82_ok:
    s_waitcnt lgkmcnt(0)
    s_add_u32 m0, s51, 0
    s_nop 0
    buffer_load_dwordx4 v5, s[12:15], s50 offen offset:0 sc1 lds
    buffer_load_dwordx4 v5, s[12:15], s50 offen offset:1024 sc1 lds
    s_add_u32 s50, s50, 8192
    s_add_u32 m0, s51, 8192
    s_nop 0
    buffer_load_dwordx4 v5, s[12:15], s50 offen offset:0 sc1 lds
    buffer_load_dwordx4 v5, s[12:15], s50 offen offset:1024 sc1 lds
    s_add_u32 s50, s50, 8192
    s_lshl_b32 m0, s60, 10
    s_lshl_b32 s3, s60, 14
    buffer_load_dwordx4 v7, s[24:27], s3 offen lds
    s_add_u32 s60, s60, 4
    s_lshl_b32 m0, s60, 10
    s_lshl_b32 s3, s60, 14
    buffer_load_dwordx4 v7, s[24:27], s3 offen lds
    s_add_u32 s60, s60, 4
    s_waitcnt vmcnt(8)
    s_barrier
    s_branch need_83_t
need_83:
    s_load_dwordx4 s[64:67], s[52:53], s62 glc
    s_sub_u32 s58, s58, 1
    s_cbranch_scc1 need_83_ok
    s_waitcnt lgkmcnt(0)
need_83_t:
    s_cmp_ge_u32 s48, 2
    s_cselect_b32 s63, s67, s66
    s_cmp_lg_u32 s63, s10
    s_cbranch_scc1 need_83
need_83_ok:
    s_waitcnt lgkmcnt(0)
    s_add_u32 m0, s51, 16384
    s_nop 0
    buffer_load_dwordx4 v5, s[12:15], s50 offen offset:0 sc1 lds
    buffer_load_dwordx4 v5, s[12:15], s50 offen offset:1024 sc1 lds
    s_add_u32 s50, s50, 8192
    s_add_u32 m0, s51, 24576
    s_nop 0
    buffer_load_dwordx4 v5, s[12:15], s50 offen offset:0 sc1 lds
    buffer_load_dwordx4 v5, s[12:15], s50 offen offset:1024 sc1 lds
    s_add_u32 s50, s50, 8192
    s_lshl_b32 m0, s60, 10
    s_lshl_b32 s3, s60, 14
    buffer_load_dwordx4 v7, s[24:27], s3 offen lds
    s_add_u32 s60, s60, 4
    s_lshl_b32 m0, s60, 10
    s_lshl_b32 s3, s60, 14
    buffer_load_dwordx4 v7, s[24:27], s3 offen lds
    s_add_u32 s60, s60, 4
    s_waitcnt vmcnt(8)
    s_barrier
    s_add_u32 s62, s61, 7
    s_and_b32 s62, s62, 7
    s_lshl_b32 s50, s62, 15
    s_add_u32 s50, s50, s49
    s_lshr_b32 s63, s62, 1
    s_lshl_b32 s63, s63, 7
    s_and_b32 s62, s62, 1
    s_lshl_b32 s62, s62, 4
    s_add_u32 s62, s62, s63
    s_mov_b32 s58, 0x100000
need_84:
    s_load_dwordx4 s[64:67], s[52:53], s62 glc
    s_sub_u32 s58, s58, 1
    s_cbranch_scc1 need_84_ok
    s_waitcnt lgkmcnt(0)
need_84_t:
    s_cmp_ge_u32 s48, 2
    s_cselect_b32 s63, s65, s64
    s_cmp_lg_u32 s63, s10
    s_cbranch_scc1 need_84
need_84_ok:
    s_waitcnt lgkmcnt(0)
    s_add_u32 m0, s51, 32768
    s_nop 0
    buffer_load_dwordx4 v5, s[12:15], s50 offen offset:0 sc1 lds
    buffer_load_dwordx4 v5, s[12:15], s50 offen offset:1024 sc1 lds
    s_add_u32 s50, s50, 8192
    s_add_u32 m0, s51, 40960
    s_nop 0
    buffer_load_dwordx4 v5, s[12:15], s50 offen offset:0 sc1 lds
    buffer_load_dwordx4 v5, s[12:15], s50 offen offset:1024 sc1 lds
    s_add_u32 s50, s50, 8192
    s_lshl_b32 m0, s60, 10
    s_lshl_b32 s3, s60, 14
    buffer_load_dwordx4 v7, s[24:27], s3 offen lds
    s_add_u32 s60, s60, 4
    s_lshl_b32 m0, s60, 10
    s_lshl_b32 s3, s60, 14
    buffer_load_dwordx4 v7, s[24:27], s3 offen lds
    s_add_u32 s60, s60, 4
    s_waitcnt vmcnt(8)
    s_barrier
    s_branch need_85_t
need_85:
    s_load_dwordx4 s[64:67], s[52:53], s62 glc
    s_sub_u32 s58, s58, 1
    s_cbranch_scc1 need_85_ok
    s_waitcnt lgkmcnt(0)
need_85_t:
    s_cmp_ge_u32 s48, 2
    s_cselect_b32 s63, s67, s66
    s_cmp_lg_u32 s63, s10
    s_cbranch_scc1 need_85
need_85_ok:
    s_waitcnt lgkmcnt(0)
    s_add_u32 m0, s51, 49152
    s_nop 0
    buffer_load_dwordx4 v5, s[12:15], s50 offen offset:0 sc1 lds
    buffer_load_dwordx4 v5, s[12:15], s50 offen offset:1024 sc1 lds
    s_add_u32 s50, s50, 8192
    s_add_u32 m0, s51, 57344
    s_nop 0
    buffer_load_dwordx4 v5, s[12:15], s50 offen offset:0 sc1 lds
    buffer_load_dwordx4 v5, s[12:15], s50 offen offset:1024 sc1 lds
    s_add_u32 s50, s50, 8192
    s_lshl_b32 m0, s60, 10
    s_lshl_b32 s3, s60, 14
    buffer_load_dwordx4 v7, s[24:27], s3 offen lds
    s_add_u32 s60, s60, 4
    s_lshl_b32 m0, s60, 10
    s_lshl_b32 s3, s60, 14
    buffer_load_dwordx4 v7, s[24:27], s3 offen lds
    s_add_u32 s60, s60, 4
    s_waitcnt vmcnt(8)
    s_barrier
    s_lshl_b32 m0, s60, 10
    s_lshl_b32 s3, s60, 14
    buffer_load_dwordx4 v7, s[24:27], s3 offen lds
    s_add_u32 s60, s60, 4
    s_lshl_b32 m0, s60, 10
    s_lshl_b32 s3, s60, 14
    buffer_load_dwordx4 v7, s[24:27], s3 offen lds
    s_add_u32 s60, s60, 4
    s_lshl_b32 m0, s60, 10
    s_lshl_b32 s3, s60, 14
    buffer_load_dwordx4 v7, s[24:27], s3 offen lds
    s_add_u32 s60, s60, 4
    s_lshl_b32 m0, s60, 10
    s_lshl_b32 s3, s60, 14
    buffer_load_dwordx4 v7, s[24:27], s3 offen lds
    s_add_u32 s60, s60, 4
    s_waitcnt vmcnt(6)
    s_barrier
    s_lshl_b32 m0, s60, 10
    s_lshl_b32 s3, s60, 14
    buffer_load_dwordx4 v7, s[24:27], s3 offen lds
    s_add_u32 s60, s60, 4
    s_lshl_b32 m0, s60, 10
    s_lshl_b32 s3, s60, 14
    buffer_load_dwordx4 v7, s[24:27], s3 offen lds
    s_add_u32 s60, s60, 4
    s_lshl_b32 m0, s60, 10
    s_lshl_b32 s3, s60, 14
    buffer_load_dwordx4 v7, s[24:27], s3 offen lds
    s_add_u32 s60, s60, 4
    s_lshl_b32 m0, s60, 10
    s_lshl_b32 s3, s60, 14
    buffer_load_dwordx4 v7, s[24:27], s3 offen lds
    s_add_u32 s60, s60, 4
    s_barrier
    s_lshl_b32 m0, s60, 10
    s_lshl_b32 s3, s60, 14
    buffer_load_dwordx4 v7, s[24:27], s3 offen lds
    s_add_u32 s60, s60, 4
    s_lshl_b32 m0, s60, 10
    s_lshl_b32 s3, s60, 14
    buffer_load_dwordx4 v7, s[24:27], s3 offen lds
    s_add_u32 s60, s60, 4
    s_lshl_b32 m0, s60, 10
    s_lshl_b32 s3, s60, 14
    buffer_load_dwordx4 v7, s[24:27], s3 offen lds
    s_add_u32 s60, s60, 4
    s_lshl_b32 m0, s60, 10
    s_lshl_b32 s3, s60, 14
    buffer_load_dwordx4 v7, s[24:27], s3 offen lds
    s_add_u32 s60, s60, 4
    s_cmp_eq_u32 s8, 4
    s_cbranch_scc1 h_wo
    s_branch l_wo
.p2align 6
c_attn_slow:
    s_waitcnt lgkmcnt(0)
    s_lshr_b32 s56, s9, 1
    s_lshl_b32 s56, s56, 23
    s_lshl_b32 s55, s7, 19
    s_add_u32 s56, s56, s55
    s_and_b32 s55, s6, 1
    s_lshl_b32 s55, s55, 18
    s_add_u32 s56, s56, s55
    s_add_u32 s56, s56, 33554432
    v_mov_b32 v28, 0xff800000
    v_mov_b32 v30, 0xff800000
    s_mov_b32 s57, 0
c_attn_slow1:
    s_lshr_b32 s55, s57, 2
    s_lshl_b32 s55, s55, 14
    s_and_b32 s58, s57, 3
    s_lshl_b32 s58, s58, 11
    s_add_u32 s55, s55, s58
    s_add_u32 s55, s55, s56
    buffer_load_dwordx4 v[128:131], v5, s[12:15], s55 offen offset:0 sc1
    buffer_load_dwordx4 v[132:135], v5, s[12:15], s55 offen offset:1024 sc1
    s_waitcnt vmcnt(0)
    v_mfma_f32_32x32x16_bf16 v[64:79], v[128:131], v[8:11], 0
    v_mfma_f32_32x32x16_bf16 v[80:95], v[128:131], v[16:19], 0
    v_mfma_f32_32x32x16_bf16 v[64:79], v[132:135], v[12:15], v[64:79]
    v_mfma_f32_32x32x16_bf16 v[80:95], v[132:135], v[20:23], v[80:95]
    s_nop 10
    v_max3_f32 v28, v28, v64, v65
    v_max3_f32 v28, v28, v66, v67
    v_max3_f32 v28, v28, v68, v69
    v_max3_f32 v28, v28, v70, v71
    v_max3_f32 v28, v28, v72, v73
    v_max3_f32 v28, v28, v74, v75
    v_max3_f32 v28, v28, v76, v77
    v_max3_f32 v28, v28, v78, v79
    v_max3_f32 v30, v30, v80, v81
    v_max3_f32 v30, v30, v82, v83
    v_max3_f32 v30, v30, v84, v85
    v_max3_f32 v30, v30, v86, v87
    v_max3_f32 v30, v30, v88, v89
    v_max3_f32 v30, v30, v90, v91
    v_max3_f32 v30, v30, v92, v93
    v_max3_f32 v30, v30, v94, v95
    s_add_u32 s57, s57, 1
    s_cmp_lt_u32 s57, 64
    s_cbranch_scc1 c_attn_slow1
    v_mov_b32 v29, v28
    s_nop 1
    v_permlane32_swap_b32 v28, v29
    v_max_f32 v28, v28, v29
    v_sub_f32 v96, 0, v28
    v_sub_f32 v97, 0, v28
    v_sub_f32 v98, 0, v28
    v_sub_f32 v99, 0, v28
    v_sub_f32 v100, 0, v28
    v_sub_f32 v101, 0, v28
    v_sub_f32 v102, 0, v28
    v_sub_f32 v103, 0, v28
    v_sub_f32 v104, 0, v28
    v_sub_f32 v105, 0, v28
    v_sub_f32 v106, 0, v28
    v_sub_f32 v107, 0, v28
    v_sub_f32 v108, 0, v28
    v_sub_f32 v109, 0, v28
    v_sub_f32 v110, 0, v28
    v_sub_f32 v111, 0, v28
    v_mov_b32 v160, 0
    v_mov_b32 v161, 0
    v_mov_b32 v162, 0
    v_mov_b32 v163, 0
    v_mov_b32 v164, 0
    v_mov_b32 v165, 0
    v_mov_b32 v166, 0
    v_mov_b32 v167, 0
    v_mov_b32 v168, 0
    v_mov_b32 v169, 0
    v_mov_b32 v170, 0
    v_mov_b32 v171, 0
    v_mov_b32 v172, 0
    v_mov_b32 v173, 0
    v_mov_b32 v174, 0
    v_mov_b32 v175, 0
    v_mov_b32 v192, 0
    v_mov_b32 v193, 0
    v_mov_b32 v194, 0
    v_mov_b32 v195, 0
    v_mov_b32 v31, v30
    s_nop 1
    v_permlane32_swap_b32 v30, v31
    v_max_f32 v30, v30, v31
    v_sub_f32 v112, 0, v30
    v_sub_f32 v113, 0, v30
    v_sub_f32 v114, 0, v30
    v_sub_f32 v115, 0, v30
    v_sub_f32 v116, 0, v30
    v_sub_f32 v117, 0, v30
    v_sub_f32 v118, 0, v30
    v_sub_f32 v119, 0, v30
    v_sub_f32 v120, 0, v30
    v_sub_f32 v121, 0, v30
    v_sub_f32 v122, 0, v30
    v_sub_f32 v123, 0, v30
    v_sub_f32 v124, 0, v30
    v_sub_f32 v125, 0, v30
    v_sub_f32 v126, 0, v30
    v_sub_f32 v127, 0, v30
    v_mov_b32 v176, 0
    v_mov_b32 v177, 0
    v_mov_b32 v178, 0
    v_mov_b32 v179, 0
    v_mov_b32 v180, 0
    v_mov_b32 v181, 0
    v_mov_b32 v182, 0
    v_mov_b32 v183, 0
    v_mov_b32 v184, 0
    v_mov_b32 v185, 0
    v_mov_b32 v186, 0
    v_mov_b32 v187, 0
    v_mov_b32 v188, 0
    v_mov_b32 v189, 0
    v_mov_b32 v190, 0
    v_mov_b32 v191, 0
    v_mov_b32 v196, 0
    v_mov_b32 v197, 0
    v_mov_b32 v198, 0
    v_mov_b32 v199, 0
    s_mov_b32 s57, 0
c_attn_slow2:
    s_lshr_b32 s55, s57, 2
    s_lshl_b32 s55, s55, 14
    s_and_b32 s58, s57, 3
    s_lshl_b32 s58, s58, 11
    s_add_u32 s55, s55, s58
    s_add_u32 s55, s55, s56
    buffer_load_dwordx4 v[128:131], v5, s[12:15], s55 offen offset:0 sc1
    buffer_load_dwordx4 v[132:135], v5, s[12:15], s55 offen offset:1024 sc1
    s_add_u32 s55, s55, 8192
    buffer_load_dwordx4 v[144:147], v5, s[12:15], s55 offen offset:0 sc1
    buffer_load_dwordx4 v[148:151], v5, s[12:15], s55 offen offset:1024 sc1
    s_waitcnt vmcnt(0)
    v_mfma_f32_32x32x16_bf16 v[64:79], v[128:131], v[8:11], v[96:111]
    v_mfma_f32_32x32x16_bf16 v[80:95], v[128:131], v[16:19], v[112:127]
    v_mfma_f32_32x32x16_bf16 v[64:79], v[132:135], v[12:15], v[64:79]
    v_mfma_f32_32x32x16_bf16 v[80:95], v[132:135], v[20:23], v[80:95]
    s_nop 10
    v_exp_f32 v64, v64
    v_exp_f32 v65, v65
    v_exp_f32 v66, v66
    v_exp_f32 v67, v67
    v_exp_f32 v68, v68
    v_exp_f32 v69, v69
    v_exp_f32 v70, v70
    v_exp_f32 v71, v71
    v_exp_f32 v72, v72
    v_exp_f32 v73, v73
    v_exp_f32 v74, v74
    v_exp_f32 v75, v75
    v_exp_f32 v76, v76
    v_exp_f32 v77, v77
    v_exp_f32 v78, v78
    v_exp_f32 v79, v79
    v_exp_f32 v80, v80
    v_exp_f32 v81, v81
    v_exp_f32 v82, v82
    v_exp_f32 v83, v83
    v_exp_f32 v84, v84
    v_exp_f32 v85, v85
    v_exp_f32 v86, v86
    v_exp_f32 v87, v87
    v_exp_f32 v88, v88
    v_exp_f32 v89, v89
    v_exp_f32 v90, v90
    v_exp_f32 v91, v91
    v_exp_f32 v92, v92
    v_exp_f32 v93, v93
    v_exp_f32 v94, v94
    v_exp_f32 v95, v95
    v_smfmac_f32_32x32x32_bf16 v[160:175], v[144:147], v[64:71], v204
    v_smfmac_f32_16x16x64_bf16 v[192:195], v[200:203], v[64:71], v204
    v_smfmac_f32_32x32x32_bf16 v[160:175], v[148:151], v[72:79], v204
    v_smfmac_f32_16x16x64_bf16 v[192:195], v[200:203], v[72:79], v204
    v_smfmac_f32_32x32x32_bf16 v[176:191], v[144:147], v[80:87], v204
    v_smfmac_f32_16x16x64_bf16 v[196:199], v[200:203], v[80:87], v204
    v_smfmac_f32_32x32x32_bf16 v[176:191], v[148:151], v[88:95], v204
    v_smfmac_f32_16x16x64_bf16 v[196:199], v[200:203], v[88:95], v204
    s_add_u32 s57, s57, 1
    s_cmp_lt_u32 s57, 64
    s_nop 15
    s_cbranch_scc1 c_attn_slow2
    s_branch c_attn_fin
    s_endpgm
k_end:
.section .rodata,"a"
.p2align 6
.amdhsa_kernel interleave_layers__sliding_local_dilated__softmax_full_mha__prompt_kernel
  .amdhsa_next_free_vgpr 256
  .amdhsa_next_free_sgpr 102
  .amdhsa_accum_offset 224
  .amdhsa_group_segment_fixed_size 0
  .amdhsa_kernarg_size 72
  .amdhsa_user_sgpr_count 2
  .amdhsa_user_sgpr_kernarg_segment_ptr 1
  .amdhsa_system_sgpr_workgroup_id_x 1
.end_amdhsa_kernel
```

```asm
; @launch grid=(256,1,1) block=(512,1,1) lds=159744
.amdgcn_target "amdgcn-amd-amdhsa--gfx950"
.text
.globl interleave_layers__sliding_local_dilated__softmax_full_mha__prompt_kernel
.type interleave_layers__sliding_local_dilated__softmax_full_mha__prompt_kernel,@function
.p2align 8
interleave_layers__sliding_local_dilated__softmax_full_mha__prompt_kernel:
    s_cmp_ge_u32 s2, 256
    s_cbranch_scc1 k_exit2
    s_load_dwordx16 s[32:47], s[0:1], 0
    s_load_dwordx2 s[4:5], s[0:1], 64
    v_lshrrev_b32 v2, 6, v0
    v_and_b32 v1, 63, v0
    v_mov_b32 v12, 0
    v_mov_b32 v14, 0
    v_mov_b32 v15, 0
    v_mov_b32 v16, 0
    v_readfirstlane_b32 s8, v2
    s_and_b32 s3, s2, 2
    s_lshl_b32 s3, s3, 2
    s_bfe_u32 s6, s2, 0x30003
    s_add_u32 s6, s3, s6
    s_and_b32 s3, s2, 1
    s_lshl_b32 s3, s3, 3
    s_lshr_b32 s7, s2, 6
    s_add_u32 s7, s3, s7
    s_and_b32 s3, s2, 4
    s_add_u32 s7, s3, s7
    s_lshl_b32 s11, s6, 4
    s_add_u32 s11, s11, s7
    s_mov_b32 s9, -1
    s_mov_b32 s96, 0
    s_mov_b32 s10, 0
    s_cmp_lt_u32 s8, 4
    s_cbranch_scc1 c_prep
    s_cmp_eq_u32 s8, 4
    s_cbranch_scc1 h_first
k_heads:
l_first:
    s_sub_u32 s51, s8, 5
    s_mul_i32 s61, s51, 0
    s_add_u32 s61, s61, s2
    s_and_b32 s61, s61, 255
    s_lshl_b32 s3, s51, 8
    s_add_u32 s61, s61, s3
    s_and_b32 s62, s61, 15
    s_lshr_b32 s63, s61, 4
    v_lshrrev_b32 v20, 3, v1
    v_mul_u32_u24 v12, 6144, v20
    v_and_b32 v21, 7, v1
    v_lshl_add_u32 v12, v21, 4, v12
    s_mul_i32 s52, s62, 393216
    s_lshl_b32 s56, s63, 7
    s_add_u32 s52, s52, s56
    s_waitcnt lgkmcnt(0)
    s_mov_b32 s12, s4
    s_mov_b32 s13, s5
    s_mov_b32 s14, 71303168
    s_mov_b32 s15, 0x00020000
    s_mov_b32 s20, s34
    s_mov_b32 s21, s35
    s_mov_b32 s22, 6291456
    s_mov_b32 s23, 0x00020000
    s_add_u32 s53, s52, 0
    buffer_load_dwordx4 v[160:163], v12, s[20:23], s53 offen nt
    s_add_u32 s53, s52, 49152
    buffer_load_dwordx4 v[164:167], v12, s[20:23], s53 offen nt
    s_add_u32 s53, s52, 98304
    buffer_load_dwordx4 v[168:171], v12, s[20:23], s53 offen nt
    s_add_u32 s53, s52, 147456
    buffer_load_dwordx4 v[172:175], v12, s[20:23], s53 offen nt
    s_add_u32 s53, s52, 196608
    buffer_load_dwordx4 v[176:179], v12, s[20:23], s53 offen nt
    s_add_u32 s53, s52, 245760
    buffer_load_dwordx4 v[180:183], v12, s[20:23], s53 offen nt
    s_add_u32 s53, s52, 294912
    buffer_load_dwordx4 v[184:187], v12, s[20:23], s53 offen nt
    s_add_u32 s53, s52, 344064
    buffer_load_dwordx4 v[188:191], v12, s[20:23], s53 offen nt
    s_barrier
    s_branch l_first_tail
c_prep:
    s_lshl_b32 s48, s6, 2
    s_add_u32 s48, s48, s8
    v_lshrrev_b32 v16, 3, v1
    v_and_b32 v17, 7, v1
    v_lshlrev_b32 v18, 11, v16
    v_lshl_add_u32 v18, v17, 4, v18
    s_lshl_b32 s55, s48, 16
    s_lshl_b32 s56, s7, 7
    s_add_u32 s3, s55, s56
    s_waitcnt lgkmcnt(0)
    s_mov_b32 s12, s4
    s_mov_b32 s13, s5
    s_mov_b32 s14, 71303168
    s_mov_b32 s15, 0x00020000
    s_mov_b32 s28, s32
    s_mov_b32 s29, s33
    s_mov_b32 s30, 4194304
    s_mov_b32 s31, 0x00020000
    buffer_load_dwordx4 v[32:35], v18, s[28:31], s3 offen nt
    s_add_u32 s3, s3, 16384
    buffer_load_dwordx4 v[36:39], v18, s[28:31], s3 offen nt
    s_add_u32 s3, s3, 16384
    buffer_load_dwordx4 v[40:43], v18, s[28:31], s3 offen nt
    s_add_u32 s3, s3, 16384
    buffer_load_dwordx4 v[44:47], v18, s[28:31], s3 offen nt
    s_add_u32 s3, s3, 16384
    s_barrier
    s_branch c_prep_tail
h_first:
    s_memrealtime s[50:51]
    s_getpc_b64 s[52:53]
pc_10:
    s_sub_u32 s52, s52, pc_10-interleave_layers__sliding_local_dilated__softmax_full_mha__prompt_kernel
    s_subb_u32 s53, s53, 0
    s_lshr_b32 s3, s2, 3
    s_lshl_b32 s3, s3, 11
    v_and_b32 v18, 15, v0
    v_lshl_add_u32 v18, v18, 7, s3
    v_min_u32 v18, k_end-interleave_layers__sliding_local_dilated__softmax_full_mha__prompt_kernel-4, v18
    v_mov_b32 v19, s53
    v_add_co_u32 v18, vcc, s52, v18
    s_nop 1
    v_addc_co_u32 v19, vcc, 0, v19, vcc
    s_mov_b64 exec, 0xffff
    global_load_dword v18, v[18:19], off
    s_mov_b64 exec, -1
    s_waitcnt lgkmcnt(0)
    s_mov_b32 s12, s4
    s_mov_b32 s13, s5
    s_mov_b32 s14, 71303168
    s_mov_b32 s15, 0x00020000
    s_cmp_lg_u32 s2, 0
    s_cbranch_scc1 h_first_nonon
    s_mov_b32 s16, s46
    s_mov_b32 s17, s47
    s_mov_b32 s18, 256
    s_mov_b32 s19, 0x00020000
    v_lshlrev_b32 v14, 6, v1
    s_or_b32 s50, s50, 1
    v_mov_b32 v13, s50
    buffer_store_dword v13, v14, s[16:19], 0 offen sc1
h_first_nonon:
    v_mov_b32 v8, 0
    v_mov_b32 v9, 0
    v_mov_b32 v10, 159488
    ds_write_b64 v10, v[8:9]
    ds_write_b64 v10, v[8:9] offset:8
    ds_write_b64 v10, v[8:9] offset:16
    ds_write_b64 v10, v[8:9] offset:24
    s_waitcnt lgkmcnt(0)
    s_barrier
    s_branch h_first_tail
k_exit:
k_exit2:
    s_endpgm
.p2align 6
c_qkvA:
    v_and_b32 v1, 63, v0
    v_lshrrev_b32 v2, 6, v0
    v_lshlrev_b32 v5, 4, v1
    v_lshrrev_b32 v3, 5, v1
    v_and_b32 v4, 15, v0
    v_bfe_u32 v7, v1, 4, 1
    v_lshl_add_u32 v6, v7, 5, v4
    v_lshlrev_b32 v6, 4, v6
    v_lshl_add_u32 v6, v3, 10, v6
    s_lshr_b32 s48, s6, 1
    s_lshl_b32 s48, s48, 2
    s_add_u32 s48, s48, s8
    s_lshl_b32 s55, s48, 17
    s_lshl_b32 s56, s9, 22
    s_add_u32 s55, s55, s56
    s_add_u32 s16, s4, s55
    s_addc_u32 s17, s5, 0
    s_mov_b32 s18, 65536
    s_mov_b32 s19, 0x00020000
    s_add_u32 s56, s55, 65536
    s_add_u32 s20, s4, s56
    s_addc_u32 s21, s5, 0
    s_mov_b32 s22, 65536
    s_mov_b32 s23, 0x00020000
    s_lshl_b32 s49, s7, 12
    s_add_u32 s49, s49, s55
    s_and_b32 s56, s6, 1
    s_lshl_b32 s56, s56, 11
    s_add_u32 s49, s49, s56
    s_add_u32 s49, s49, 16777216
    s_movk_i32 s54, 4096
    v_lshrrev_b32 v16, 2, v4
    v_lshl_add_u32 v18, v7, 2, v16
    v_lshl_add_u32 v18, v3, 4, v18
    v_lshlrev_b32 v18, 6, v18
    v_and_b32 v17, 3, v4
    v_lshl_add_u32 v18, v17, 3, v18
    v_lshl_add_u32 v26, v7, 5, v18
    v_xor_b32 v27, 32, v26
    v_mov_b32 v24, v26
    v_mov_b32 v25, v27
    v_and_b32 v18, 0x30, v1
    v_add_u32 v10, 155648, v18
    v_lshlrev_b32 v11, 2, v4
    v_add_u32 v11, 155648, v11
    v_lshl_add_u32 v8, v2, 8, v11
    v_lshl_add_u32 v9, v2, 8, v10
    s_lshr_b32 s3, s8, 1
    s_and_b32 s55, s8, 1
    s_lshl_b32 s56, s55, 5
    v_xor_b32 v29, s56, v26
    s_lshl_b32 s56, s3, 13
    s_add_u32 s56, s56, 8192
    v_add_u32 v29, s56, v29
    v_mov_b32 v28, v29
    v_add_u32 v30, 147456, v5
    v_lshl_add_u32 v14, v2, 6, v10
    v_lshl_add_u32 v12, v2, 11, v5
    v_add_u32 v12, 131072, v12
    v_lshlrev_b32 v16, 8, v16
    v_lshl_add_u32 v16, v18, 2, v16
    v_lshl_add_u32 v16, v17, 1, v16
    v_add_u32 v16, 1024, v16
    v_cmp_gt_u32 vcc, 2, v2
    s_nop 1
    v_cndmask_b32 v13, v16, v5, vcc
    s_lshl_b32 s56, s55, 3
    s_add_u32 s56, s56, 131072
    v_add_u32 v13, s56, v13
    v_lshrrev_b32 v18, 2, v18
    v_sub_u32 v18, v4, v18
    v_mov_b32 v19, 0xf149f2ca
    v_add_u32 v16, 0x0, v18
    v_and_b32 v16, 0xfffffff1, v16
    v_cmp_eq_u32 vcc, 0, v16
    s_nop 1
    v_cndmask_b32 v196, v19, 0, vcc
    v_add_u32 v16, 0xffffffff, v18
    v_and_b32 v16, 0xfffffff1, v16
    v_cmp_eq_u32 vcc, 0, v16
    s_nop 1
    v_cndmask_b32 v197, v19, 0, vcc
    v_add_u32 v16, 0xfffffffe, v18
    v_and_b32 v16, 0xfffffff1, v16
    v_cmp_eq_u32 vcc, 0, v16
    s_nop 1
    v_cndmask_b32 v198, v19, 0, vcc
    v_add_u32 v16, 0xfffffffd, v18
    v_and_b32 v16, 0xfffffff1, v16
    v_cmp_eq_u32 vcc, 0, v16
    s_nop 1
    v_cndmask_b32 v199, v19, 0, vcc
    v_add_u32 v16, 0x10, v18
    v_and_b32 v16, 0xfffffff1, v16
    v_cmp_eq_u32 vcc, 0, v16
    s_nop 1
    v_cndmask_b32 v200, v19, 0, vcc
    v_add_u32 v16, 0xf, v18
    v_and_b32 v16, 0xfffffff1, v16
    v_cmp_eq_u32 vcc, 0, v16
    s_nop 1
    v_cndmask_b32 v201, v19, 0, vcc
    v_add_u32 v16, 0xe, v18
    v_and_b32 v16, 0xfffffff1, v16
    v_cmp_eq_u32 vcc, 0, v16
    s_nop 1
    v_cndmask_b32 v202, v19, 0, vcc
    v_add_u32 v16, 0xd, v18
    v_and_b32 v16, 0xfffffff1, v16
    v_cmp_eq_u32 vcc, 0, v16
    s_nop 1
    v_cndmask_b32 v203, v19, 0, vcc
    s_cmp_eq_u32 s48, 0
    s_cselect_b64 vcc, -1, 0
    v_cndmask_b32 v204, v200, v19, vcc
    v_cndmask_b32 v205, v201, v19, vcc
    v_cndmask_b32 v206, v202, v19, vcc
    v_cndmask_b32 v207, v203, v19, vcc
    v_mov_b32 v208, 0x3f803f80
    v_mov_b32 v209, 0x3f803f80
    v_mov_b32 v210, 0x3f803f80
    v_mov_b32 v211, 0x3f803f80
    v_mov_b32 v184, 0
    v_mov_b32 v185, 0
    v_mov_b32 v186, 0
    v_mov_b32 v187, 0
    v_mov_b32 v188, 0
    v_mov_b32 v189, 0
    v_mov_b32 v190, 0
    v_mov_b32 v191, 0
    v_mov_b32 v192, 0
    v_mov_b32 v193, 0
    v_mov_b32 v194, 0
    v_mov_b32 v195, 0
    v_mov_b32 v32, 0
    v_mov_b32 v33, 0
    v_mov_b32 v34, 0
    v_mov_b32 v35, 0
    v_mov_b32 v36, 0
    v_mov_b32 v37, 0
    v_mov_b32 v38, 0
    v_mov_b32 v39, 0
    v_mov_b32 v40, 0
    v_mov_b32 v41, 0
    v_mov_b32 v42, 0
    v_mov_b32 v43, 0
    v_mov_b32 v44, 0
    v_mov_b32 v45, 0
    v_mov_b32 v46, 0
    v_mov_b32 v47, 0
    v_mov_b32 v48, 0
    v_mov_b32 v49, 0
    v_mov_b32 v50, 0
    v_mov_b32 v51, 0
    v_mov_b32 v52, 0
    v_mov_b32 v53, 0
    v_mov_b32 v54, 0
    v_mov_b32 v55, 0
    v_mov_b32 v56, 0
    v_mov_b32 v57, 0
    v_mov_b32 v58, 0
    v_mov_b32 v59, 0
    v_mov_b32 v60, 0
    v_mov_b32 v61, 0
    v_mov_b32 v62, 0
    v_mov_b32 v63, 0
    v_mov_b32 v64, 0
    v_mov_b32 v65, 0
    v_mov_b32 v66, 0
    v_mov_b32 v67, 0
    v_mov_b32 v68, 0
    v_mov_b32 v69, 0
    v_mov_b32 v70, 0
    v_mov_b32 v71, 0
    v_mov_b32 v72, 0
    v_mov_b32 v73, 0
    v_mov_b32 v74, 0
    v_mov_b32 v75, 0
    v_mov_b32 v76, 0
    v_mov_b32 v77, 0
    v_mov_b32 v78, 0
    v_mov_b32 v79, 0
    v_mov_b32 v80, 0
    v_mov_b32 v81, 0
    v_mov_b32 v82, 0
    v_mov_b32 v83, 0
    v_mov_b32 v84, 0
    v_mov_b32 v85, 0
    v_mov_b32 v86, 0
    v_mov_b32 v87, 0
    v_mov_b32 v88, 0
    v_mov_b32 v89, 0
    v_mov_b32 v90, 0
    v_mov_b32 v91, 0
    v_mov_b32 v92, 0
    v_mov_b32 v93, 0
    v_mov_b32 v94, 0
    v_mov_b32 v95, 0
    v_mov_b32 v96, 0
    v_mov_b32 v97, 0
    v_mov_b32 v98, 0
    v_mov_b32 v99, 0
    v_mov_b32 v100, 0
    v_mov_b32 v101, 0
    v_mov_b32 v102, 0
    v_mov_b32 v103, 0
    v_mov_b32 v104, 0
    v_mov_b32 v105, 0
    v_mov_b32 v106, 0
    v_mov_b32 v107, 0
    v_mov_b32 v108, 0
    v_mov_b32 v109, 0
    v_mov_b32 v110, 0
    v_mov_b32 v111, 0
    v_mov_b32 v112, 0
    v_mov_b32 v113, 0
    v_mov_b32 v114, 0
    v_mov_b32 v115, 0
    v_mov_b32 v116, 0
    v_mov_b32 v117, 0
    v_mov_b32 v118, 0
    v_mov_b32 v119, 0
    v_mov_b32 v120, 0
    v_mov_b32 v121, 0
    v_mov_b32 v122, 0
    v_mov_b32 v123, 0
    v_mov_b32 v124, 0
    v_mov_b32 v125, 0
    v_mov_b32 v126, 0
    v_mov_b32 v127, 0
    s_mov_b32 s50, 8192
    s_mov_b32 s58, 6144
    s_mov_b32 s51, 12288
    s_mov_b32 s59, 10240
    s_mov_b32 s52, 0
    s_mul_i32 s60, s9, 786432
    s_add_u32 s60, s60, 65273856
    s_lshl_b32 s61, s11, 10
    s_add_u32 s60, s60, s61
    s_and_b32 s61, s8, 2
    s_lshl_b32 s61, s61, 7
    s_add_u32 s60, s60, s61
    s_add_u32 s61, s60, 128
    s_mov_b32 s98, s10
    s_mov_b32 s99, s10
    s_mov_b32 s3, 0x100000
cp_1:
    s_load_dwordx8 s[64:71], s[4:5], s60 glc
    s_load_dwordx8 s[72:79], s[4:5], s61 glc
    s_sub_u32 s3, s3, 1
    s_cbranch_scc1 cp_1_ok
    s_waitcnt lgkmcnt(0)
    s_xor_b64 s[100:101], s[64:65], s[98:99]
    s_xor_b64 s[64:65], s[66:67], s[98:99]
    s_or_b64 s[100:101], s[100:101], s[64:65]
    s_xor_b64 s[64:65], s[68:69], s[98:99]
    s_or_b64 s[100:101], s[100:101], s[64:65]
    s_xor_b64 s[64:65], s[70:71], s[98:99]
    s_or_b64 s[100:101], s[100:101], s[64:65]
    s_xor_b64 s[64:65], s[72:73], s[98:99]
    s_or_b64 s[100:101], s[100:101], s[64:65]
    s_xor_b64 s[64:65], s[74:75], s[98:99]
    s_or_b64 s[100:101], s[100:101], s[64:65]
    s_xor_b64 s[64:65], s[76:77], s[98:99]
    s_or_b64 s[100:101], s[100:101], s[64:65]
    s_xor_b64 s[64:65], s[78:79], s[98:99]
    s_or_b64 s[100:101], s[100:101], s[64:65]
    s_cbranch_scc1 cp_1
cp_1_ok:
    s_waitcnt lgkmcnt(0)
    buffer_load_dwordx4 v[152:155], v6, s[16:19], 0 offen offset:0 sc1
    buffer_load_dwordx4 v[156:159], v6, s[16:19], 0 offen offset:256 sc1
    buffer_load_dwordx4 v[160:163], v6, s[20:23], 0 offen offset:0 sc1
    buffer_load_dwordx4 v[164:167], v6, s[20:23], 0 offen offset:256 sc1
    buffer_load_dwordx4 v[168:171], v6, s[16:19], 0 offen offset:2048 sc1
    buffer_load_dwordx4 v[172:175], v6, s[16:19], 0 offen offset:2304 sc1
    buffer_load_dwordx4 v[176:179], v6, s[20:23], 0 offen offset:2048 sc1
    buffer_load_dwordx4 v[180:183], v6, s[20:23], 0 offen offset:2304 sc1
    s_barrier
    ds_read_b64_tr_b16 v[128:129], v24 offset:0
    ds_read_b64_tr_b16 v[130:131], v24 offset:512
    ds_read_b64_tr_b16 v[132:133], v25 offset:0
    ds_read_b64_tr_b16 v[134:135], v25 offset:512
    ds_read_b64_tr_b16 v[136:137], v24 offset:8192
    ds_read_b64_tr_b16 v[138:139], v24 offset:8704
    ds_read_b64_tr_b16 v[140:141], v25 offset:8192
    ds_read_b64_tr_b16 v[142:143], v25 offset:8704
    ds_read_b64_tr_b16 v[144:145], v24 offset:16384
    ds_read_b64_tr_b16 v[146:147], v24 offset:16896
    buffer_load_dwordx4 a[0:3], v6, s[16:19], s54 offen offset:0 sc1
    buffer_load_dwordx4 a[4:7], v6, s[16:19], s54 offen offset:256 sc1
    buffer_load_dwordx4 a[8:11], v6, s[20:23], s54 offen offset:0 sc1
    buffer_load_dwordx4 a[12:15], v6, s[20:23], s54 offen offset:256 sc1
    buffer_load_dwordx4 a[16:19], v6, s[16:19], s54 offen offset:2048 sc1
    buffer_load_dwordx4 a[20:23], v6, s[16:19], s54 offen offset:2304 sc1
    s_mov_b32 s54, 7
.p2align 3
c_qkvA_loop:
    s_waitcnt vmcnt(12) lgkmcnt(6)
    v_mfma_f32_16x16x32_bf16 v[184:187], v[188:191], v[192:195], v[184:187]
    v_mfma_f32_16x16x32_bf16 v[32:35], v[128:131], v[152:155], v[32:35]
    ds_read_b64_tr_b16 v[148:149], v25 offset:16384
    v_mfma_f32_16x16x32_bf16 v[36:39], v[128:131], v[156:159], v[36:39]
    ds_read_b64_tr_b16 v[150:151], v25 offset:16896
    v_mfma_f32_16x16x32_bf16 v[52:55], v[132:135], v[156:159], v[52:55]
    buffer_load_dwordx4 a[24:27], v6, s[20:23], s58 offen offset:0 sc1
    v_mfma_f32_16x16x32_bf16 v[48:51], v[132:135], v[152:155], v[48:51]
    ds_read_b64_tr_b16 v[188:189], v28 offset:0
    s_waitcnt lgkmcnt(5)
    v_mfma_f32_16x16x32_bf16 v[64:67], v[136:139], v[152:155], v[64:67]
    v_mfma_f32_16x16x32_bf16 v[68:71], v[136:139], v[156:159], v[68:71]
    ds_read_b64_tr_b16 v[190:191], v28 offset:512
    v_mfma_f32_16x16x32_bf16 v[84:87], v[140:143], v[156:159], v[84:87]
    buffer_load_dwordx4 a[28:31], v6, s[20:23], s58 offen offset:256 sc1
    v_mfma_f32_16x16x32_bf16 v[80:83], v[140:143], v[152:155], v[80:83]
    ds_read_b128 v[192:195], v30 offset:0
    s_waitcnt lgkmcnt(3)
    v_mfma_f32_16x16x32_bf16 v[96:99], v[152:155], v[144:147], v[96:99]
    v_mfma_f32_16x16x32_bf16 v[100:103], v[156:159], v[144:147], v[100:103]
    v_mfma_f32_16x16x32_bf16 v[116:119], v[156:159], v[148:151], v[116:119]
    v_mfma_f32_16x16x32_bf16 v[112:115], v[152:155], v[148:151], v[112:115]
    s_waitcnt vmcnt(12)
    v_mfma_f32_16x16x32_bf16 v[40:43], v[128:131], v[160:163], v[40:43]
    buffer_load_dwordx4 v[152:155], v6, s[16:19], s50 offen offset:0 sc1
    v_mfma_f32_16x16x32_bf16 v[44:47], v[128:131], v[164:167], v[44:47]
    v_mfma_f32_16x16x32_bf16 v[60:63], v[132:135], v[164:167], v[60:63]
    ds_read_b64_tr_b16 v[128:129], v24 offset:2048
    v_mfma_f32_16x16x32_bf16 v[56:59], v[132:135], v[160:163], v[56:59]
    ds_read_b64_tr_b16 v[130:131], v24 offset:2560
    v_mfma_f32_16x16x32_bf16 v[72:75], v[136:139], v[160:163], v[72:75]
    ds_read_b64_tr_b16 v[132:133], v25 offset:2048
    v_mfma_f32_16x16x32_bf16 v[76:79], v[136:139], v[164:167], v[76:79]
    ds_read_b64_tr_b16 v[134:135], v25 offset:2560
    v_mfma_f32_16x16x32_bf16 v[92:95], v[140:143], v[164:167], v[92:95]
    ds_read_b64_tr_b16 v[136:137], v24 offset:10240
    buffer_load_dwordx4 v[156:159], v6, s[16:19], s50 offen offset:256 sc1
    v_mfma_f32_16x16x32_bf16 v[88:91], v[140:143], v[160:163], v[88:91]
    ds_read_b64_tr_b16 v[138:139], v24 offset:10752
    v_mfma_f32_16x16x32_bf16 v[104:107], v[160:163], v[144:147], v[104:107]
    ds_read_b64_tr_b16 v[140:141], v25 offset:10240
    v_mfma_f32_16x16x32_bf16 v[108:111], v[164:167], v[144:147], v[108:111]
    ds_read_b64_tr_b16 v[142:143], v25 offset:10752
    v_mfma_f32_16x16x32_bf16 v[124:127], v[164:167], v[148:151], v[124:127]
    ds_read_b64_tr_b16 v[144:145], v24 offset:18432
    v_mfma_f32_16x16x32_bf16 v[120:123], v[160:163], v[148:151], v[120:123]
    ds_read_b64_tr_b16 v[146:147], v24 offset:18944
    s_waitcnt vmcnt(12) lgkmcnt(6)
    v_mfma_f32_16x16x32_bf16 v[184:187], v[188:191], v[192:195], v[184:187]
    v_mfma_f32_16x16x32_bf16 v[32:35], v[128:131], v[168:171], v[32:35]
    ds_read_b64_tr_b16 v[148:149], v25 offset:18432
    v_mfma_f32_16x16x32_bf16 v[36:39], v[128:131], v[172:175], v[36:39]
    ds_read_b64_tr_b16 v[150:151], v25 offset:18944
    v_mfma_f32_16x16x32_bf16 v[52:55], v[132:135], v[172:175], v[52:55]
    buffer_load_dwordx4 v[160:163], v6, s[20:23], s58 offen offset:2048 sc1
    v_mfma_f32_16x16x32_bf16 v[48:51], v[132:135], v[168:171], v[48:51]
    ds_read_b64_tr_b16 v[188:189], v28 offset:2048
    s_waitcnt lgkmcnt(5)
    v_mfma_f32_16x16x32_bf16 v[64:67], v[136:139], v[168:171], v[64:67]
    v_mfma_f32_16x16x32_bf16 v[68:71], v[136:139], v[172:175], v[68:71]
    ds_read_b64_tr_b16 v[190:191], v28 offset:2560
    v_mfma_f32_16x16x32_bf16 v[84:87], v[140:143], v[172:175], v[84:87]
    buffer_load_dwordx4 v[164:167], v6, s[20:23], s58 offen offset:2304 sc1
    v_mfma_f32_16x16x32_bf16 v[80:83], v[140:143], v[168:171], v[80:83]
    ds_read_b128 v[192:195], v30 offset:1024
    s_waitcnt lgkmcnt(3)
    v_mfma_f32_16x16x32_bf16 v[96:99], v[168:171], v[144:147], v[96:99]
    v_mfma_f32_16x16x32_bf16 v[100:103], v[172:175], v[144:147], v[100:103]
    v_mfma_f32_16x16x32_bf16 v[116:119], v[172:175], v[148:151], v[116:119]
    v_mfma_f32_16x16x32_bf16 v[112:115], v[168:171], v[148:151], v[112:115]
    s_waitcnt vmcnt(12)
    v_mfma_f32_16x16x32_bf16 v[40:43], v[128:131], v[176:179], v[40:43]
    buffer_load_dwordx4 v[168:171], v6, s[16:19], s50 offen offset:2048 sc1
    v_mfma_f32_16x16x32_bf16 v[44:47], v[128:131], v[180:183], v[44:47]
    v_mfma_f32_16x16x32_bf16 v[60:63], v[132:135], v[180:183], v[60:63]
    ds_read_b64_tr_b16 v[128:129], v24 offset:4096
    v_mfma_f32_16x16x32_bf16 v[56:59], v[132:135], v[176:179], v[56:59]
    ds_read_b64_tr_b16 v[130:131], v24 offset:4608
    v_mfma_f32_16x16x32_bf16 v[72:75], v[136:139], v[176:179], v[72:75]
    ds_read_b64_tr_b16 v[132:133], v25 offset:4096
    v_mfma_f32_16x16x32_bf16 v[76:79], v[136:139], v[180:183], v[76:79]
    ds_read_b64_tr_b16 v[134:135], v25 offset:4608
    v_mfma_f32_16x16x32_bf16 v[92:95], v[140:143], v[180:183], v[92:95]
    ds_read_b64_tr_b16 v[136:137], v24 offset:12288
    buffer_load_dwordx4 v[172:175], v6, s[16:19], s50 offen offset:2304 sc1
    v_mfma_f32_16x16x32_bf16 v[88:91], v[140:143], v[176:179], v[88:91]
    ds_read_b64_tr_b16 v[138:139], v24 offset:12800
    v_mfma_f32_16x16x32_bf16 v[104:107], v[176:179], v[144:147], v[104:107]
    ds_read_b64_tr_b16 v[140:141], v25 offset:12288
    v_mfma_f32_16x16x32_bf16 v[108:111], v[180:183], v[144:147], v[108:111]
    ds_read_b64_tr_b16 v[142:143], v25 offset:12800
    v_mfma_f32_16x16x32_bf16 v[124:127], v[180:183], v[148:151], v[124:127]
    ds_read_b64_tr_b16 v[144:145], v24 offset:20480
    v_mfma_f32_16x16x32_bf16 v[120:123], v[176:179], v[148:151], v[120:123]
    ds_read_b64_tr_b16 v[146:147], v24 offset:20992
    s_waitcnt vmcnt(12) lgkmcnt(6)
    v_mfma_f32_16x16x32_bf16 v[184:187], v[188:191], v[192:195], v[184:187]
    v_mfma_f32_16x16x32_bf16 v[32:35], v[128:131], a[0:3], v[32:35]
    ds_read_b64_tr_b16 v[148:149], v25 offset:20480
    v_mfma_f32_16x16x32_bf16 v[36:39], v[128:131], a[4:7], v[36:39]
    ds_read_b64_tr_b16 v[150:151], v25 offset:20992
    v_mfma_f32_16x16x32_bf16 v[52:55], v[132:135], a[4:7], v[52:55]
    buffer_load_dwordx4 v[176:179], v6, s[20:23], s59 offen offset:0 sc1
    v_mfma_f32_16x16x32_bf16 v[48:51], v[132:135], a[0:3], v[48:51]
    ds_read_b64_tr_b16 v[188:189], v28 offset:4096
    s_waitcnt lgkmcnt(5)
    v_mfma_f32_16x16x32_bf16 v[64:67], v[136:139], a[0:3], v[64:67]
    s_add_u32 s50, s50, 8192
    v_mfma_f32_16x16x32_bf16 v[68:71], v[136:139], a[4:7], v[68:71]
    ds_read_b64_tr_b16 v[190:191], v28 offset:4608
    v_mfma_f32_16x16x32_bf16 v[84:87], v[140:143], a[4:7], v[84:87]
    buffer_load_dwordx4 v[180:183], v6, s[20:23], s59 offen offset:256 sc1
    v_mfma_f32_16x16x32_bf16 v[80:83], v[140:143], a[0:3], v[80:83]
    ds_read_b128 v[192:195], v30 offset:2048
    s_waitcnt lgkmcnt(3)
    v_mfma_f32_16x16x32_bf16 v[96:99], a[0:3], v[144:147], v[96:99]
    s_add_u32 s52, s52, 24576
    v_mfma_f32_16x16x32_bf16 v[100:103], a[4:7], v[144:147], v[100:103]
    s_cmp_eq_u32 s52, 147456
    v_mfma_f32_16x16x32_bf16 v[116:119], a[4:7], v[148:151], v[116:119]
    s_cselect_b32 s52, 0, s52
    v_mfma_f32_16x16x32_bf16 v[112:115], a[0:3], v[148:151], v[112:115]
    s_add_u32 s58, s58, 8192
    s_waitcnt vmcnt(12)
    v_mfma_f32_16x16x32_bf16 v[40:43], v[128:131], a[8:11], v[40:43]
    buffer_load_dwordx4 a[0:3], v6, s[16:19], s51 offen offset:0 sc1
    v_mfma_f32_16x16x32_bf16 v[44:47], v[128:131], a[12:15], v[44:47]
    s_sub_u32 s54, s54, 1
    v_mfma_f32_16x16x32_bf16 v[60:63], v[132:135], a[12:15], v[60:63]
    ds_read_b64_tr_b16 v[128:129], v24 offset:6144
    v_mfma_f32_16x16x32_bf16 v[56:59], v[132:135], a[8:11], v[56:59]
    ds_read_b64_tr_b16 v[130:131], v24 offset:6656
    v_mfma_f32_16x16x32_bf16 v[72:75], v[136:139], a[8:11], v[72:75]
    ds_read_b64_tr_b16 v[132:133], v25 offset:6144
    v_mfma_f32_16x16x32_bf16 v[76:79], v[136:139], a[12:15], v[76:79]
    ds_read_b64_tr_b16 v[134:135], v25 offset:6656
    v_mfma_f32_16x16x32_bf16 v[92:95], v[140:143], a[12:15], v[92:95]
    ds_read_b64_tr_b16 v[136:137], v24 offset:14336
    buffer_load_dwordx4 a[4:7], v6, s[16:19], s51 offen offset:256 sc1
    v_mfma_f32_16x16x32_bf16 v[88:91], v[140:143], a[8:11], v[88:91]
    ds_read_b64_tr_b16 v[138:139], v24 offset:14848
    v_mfma_f32_16x16x32_bf16 v[104:107], a[8:11], v[144:147], v[104:107]
    ds_read_b64_tr_b16 v[140:141], v25 offset:14336
    v_mfma_f32_16x16x32_bf16 v[108:111], a[12:15], v[144:147], v[108:111]
    ds_read_b64_tr_b16 v[142:143], v25 offset:14848
    v_mfma_f32_16x16x32_bf16 v[124:127], a[12:15], v[148:151], v[124:127]
    ds_read_b64_tr_b16 v[144:145], v24 offset:22528
    v_mfma_f32_16x16x32_bf16 v[120:123], a[8:11], v[148:151], v[120:123]
    ds_read_b64_tr_b16 v[146:147], v24 offset:23040
    s_waitcnt vmcnt(12) lgkmcnt(6)
    v_mfma_f32_16x16x32_bf16 v[184:187], v[188:191], v[192:195], v[184:187]
    v_mfma_f32_16x16x32_bf16 v[32:35], v[128:131], a[16:19], v[32:35]
    ds_read_b64_tr_b16 v[148:149], v25 offset:22528
    v_mfma_f32_16x16x32_bf16 v[36:39], v[128:131], a[20:23], v[36:39]
    ds_read_b64_tr_b16 v[150:151], v25 offset:23040
    v_mfma_f32_16x16x32_bf16 v[52:55], v[132:135], a[20:23], v[52:55]
    buffer_load_dwordx4 a[8:11], v6, s[20:23], s59 offen offset:2048 sc1
    v_mfma_f32_16x16x32_bf16 v[48:51], v[132:135], a[16:19], v[48:51]
    ds_read_b64_tr_b16 v[188:189], v28 offset:6144
    s_waitcnt lgkmcnt(5)
    v_mfma_f32_16x16x32_bf16 v[64:67], v[136:139], a[16:19], v[64:67]
    v_add_u32 v25, s52, v27
    v_mfma_f32_16x16x32_bf16 v[68:71], v[136:139], a[20:23], v[68:71]
    ds_read_b64_tr_b16 v[190:191], v28 offset:6656
    v_mfma_f32_16x16x32_bf16 v[84:87], v[140:143], a[20:23], v[84:87]
    buffer_load_dwordx4 a[12:15], v6, s[20:23], s59 offen offset:2304 sc1
    v_mfma_f32_16x16x32_bf16 v[80:83], v[140:143], a[16:19], v[80:83]
    ds_read_b128 v[192:195], v30 offset:3072
    s_waitcnt lgkmcnt(3)
    v_mfma_f32_16x16x32_bf16 v[96:99], a[16:19], v[144:147], v[96:99]
    v_add_u32 v24, s52, v26
    v_mfma_f32_16x16x32_bf16 v[100:103], a[20:23], v[144:147], v[100:103]
    v_add_u32 v28, s52, v29
    v_mfma_f32_16x16x32_bf16 v[116:119], a[20:23], v[148:151], v[116:119]
    s_add_u32 s59, s59, 8192
    s_waitcnt lgkmcnt(0)
    v_mfma_f32_16x16x32_bf16 v[112:115], a[16:19], v[148:151], v[112:115]
    s_barrier
    s_waitcnt vmcnt(12)
    v_mfma_f32_16x16x32_bf16 v[40:43], v[128:131], a[24:27], v[40:43]
    buffer_load_dwordx4 a[16:19], v6, s[16:19], s51 offen offset:2048 sc1
    v_mfma_f32_16x16x32_bf16 v[44:47], v[128:131], a[28:31], v[44:47]
    v_xor_b32 v30, 4096, v30
    v_mfma_f32_16x16x32_bf16 v[60:63], v[132:135], a[28:31], v[60:63]
    ds_read_b64_tr_b16 v[128:129], v24 offset:0
    v_mfma_f32_16x16x32_bf16 v[56:59], v[132:135], a[24:27], v[56:59]
    ds_read_b64_tr_b16 v[130:131], v24 offset:512
    v_mfma_f32_16x16x32_bf16 v[72:75], v[136:139], a[24:27], v[72:75]
    ds_read_b64_tr_b16 v[132:133], v25 offset:0
    v_mfma_f32_16x16x32_bf16 v[76:79], v[136:139], a[28:31], v[76:79]
    ds_read_b64_tr_b16 v[134:135], v25 offset:512
    v_mfma_f32_16x16x32_bf16 v[92:95], v[140:143], a[28:31], v[92:95]
    ds_read_b64_tr_b16 v[136:137], v24 offset:8192
    buffer_load_dwordx4 a[20:23], v6, s[16:19], s51 offen offset:2304 sc1
    v_mfma_f32_16x16x32_bf16 v[88:91], v[140:143], a[24:27], v[88:91]
    ds_read_b64_tr_b16 v[138:139], v24 offset:8704
    v_mfma_f32_16x16x32_bf16 v[104:107], a[24:27], v[144:147], v[104:107]
    ds_read_b64_tr_b16 v[140:141], v25 offset:8192
    s_add_u32 s51, s51, 8192
    v_mfma_f32_16x16x32_bf16 v[108:111], a[28:31], v[144:147], v[108:111]
    ds_read_b64_tr_b16 v[142:143], v25 offset:8704
    v_mfma_f32_16x16x32_bf16 v[124:127], a[28:31], v[148:151], v[124:127]
    ds_read_b64_tr_b16 v[144:145], v24 offset:16384
    s_cmp_lg_u32 s54, 0
    v_mfma_f32_16x16x32_bf16 v[120:123], a[24:27], v[148:151], v[120:123]
    ds_read_b64_tr_b16 v[146:147], v24 offset:16896
    s_cbranch_scc1 c_qkvA_loop
    s_waitcnt vmcnt(12) lgkmcnt(6)
    v_mfma_f32_16x16x32_bf16 v[184:187], v[188:191], v[192:195], v[184:187]
    v_mfma_f32_16x16x32_bf16 v[32:35], v[128:131], v[152:155], v[32:35]
    ds_read_b64_tr_b16 v[148:149], v25 offset:16384
    v_mfma_f32_16x16x32_bf16 v[36:39], v[128:131], v[156:159], v[36:39]
    ds_read_b64_tr_b16 v[150:151], v25 offset:16896
    v_mfma_f32_16x16x32_bf16 v[52:55], v[132:135], v[156:159], v[52:55]
    buffer_load_dwordx4 a[24:27], v6, s[20:23], s58 offen offset:0 sc1
    ds_read_b32 v16, v8 offset:1280
    v_mfma_f32_16x16x32_bf16 v[48:51], v[132:135], v[152:155], v[48:51]
    ds_read_b64_tr_b16 v[188:189], v28 offset:0
    ds_read_b32 v18, v8 offset:1344
    s_waitcnt lgkmcnt(7)
    v_mfma_f32_16x16x32_bf16 v[64:67], v[136:139], v[152:155], v[64:67]
    ds_read_b32 v20, v8 offset:1408
    v_mfma_f32_16x16x32_bf16 v[68:71], v[136:139], v[156:159], v[68:71]
    ds_read_b64_tr_b16 v[190:191], v28 offset:512
    v_mfma_f32_16x16x32_bf16 v[84:87], v[140:143], v[156:159], v[84:87]
    buffer_load_dwordx4 a[28:31], v6, s[20:23], s58 offen offset:256 sc1
    ds_read_b32 v22, v8 offset:1472
    v_mfma_f32_16x16x32_bf16 v[80:83], v[140:143], v[152:155], v[80:83]
    ds_read_b128 v[192:195], v30 offset:0
    ds_read_b128 v[212:215], v10 offset:128
    s_waitcnt lgkmcnt(8)
    v_mfma_f32_16x16x32_bf16 v[96:99], v[152:155], v[144:147], v[96:99]
    ds_read_b128 v[216:219], v10 offset:192
    v_mfma_f32_16x16x32_bf16 v[100:103], v[156:159], v[144:147], v[100:103]
    v_mfma_f32_16x16x32_bf16 v[116:119], v[156:159], v[148:151], v[116:119]
    v_mfma_f32_16x16x32_bf16 v[112:115], v[152:155], v[148:151], v[112:115]
    s_waitcnt vmcnt(12)
    v_mfma_f32_16x16x32_bf16 v[40:43], v[128:131], v[160:163], v[40:43]
    s_waitcnt lgkmcnt(0)
    v_fma_f32 v64, -v16, v212, v64
    v_fma_f32 v65, -v16, v213, v65
    v_mfma_f32_16x16x32_bf16 v[44:47], v[128:131], v[164:167], v[44:47]
    v_fma_f32 v66, -v16, v214, v66
    v_mfma_f32_16x16x32_bf16 v[60:63], v[132:135], v[164:167], v[60:63]
    ds_read_b64_tr_b16 v[128:129], v24 offset:2048
    v_fma_f32 v67, -v16, v215, v67
    v_mfma_f32_16x16x32_bf16 v[56:59], v[132:135], v[160:163], v[56:59]
    ds_read_b64_tr_b16 v[130:131], v24 offset:2560
    v_fma_f32 v68, -v18, v212, v68
    v_fma_f32 v69, -v18, v213, v69
    v_mfma_f32_16x16x32_bf16 v[72:75], v[136:139], v[160:163], v[72:75]
    ds_read_b64_tr_b16 v[132:133], v25 offset:2048
    v_fma_f32 v70, -v18, v214, v70
    v_mfma_f32_16x16x32_bf16 v[76:79], v[136:139], v[164:167], v[76:79]
    ds_read_b64_tr_b16 v[134:135], v25 offset:2560
    v_fma_f32 v71, -v18, v215, v71
    v_mfma_f32_16x16x32_bf16 v[92:95], v[140:143], v[164:167], v[92:95]
    ds_read_b64_tr_b16 v[136:137], v24 offset:10240
    v_fma_f32 v80, -v16, v216, v80
    v_fma_f32 v81, -v16, v217, v81
    v_mfma_f32_16x16x32_bf16 v[88:91], v[140:143], v[160:163], v[88:91]
    ds_read_b64_tr_b16 v[138:139], v24 offset:10752
    v_fma_f32 v82, -v16, v218, v82
    v_mfma_f32_16x16x32_bf16 v[104:107], v[160:163], v[144:147], v[104:107]
    ds_read_b64_tr_b16 v[140:141], v25 offset:10240
    v_fma_f32 v83, -v16, v219, v83
    v_mfma_f32_16x16x32_bf16 v[108:111], v[164:167], v[144:147], v[108:111]
    ds_read_b64_tr_b16 v[142:143], v25 offset:10752
    v_fma_f32 v84, -v18, v216, v84
    v_fma_f32 v85, -v18, v217, v85
    v_mfma_f32_16x16x32_bf16 v[124:127], v[164:167], v[148:151], v[124:127]
    ds_read_b64_tr_b16 v[144:145], v24 offset:18432
    v_fma_f32 v86, -v18, v218, v86
    v_mfma_f32_16x16x32_bf16 v[120:123], v[160:163], v[148:151], v[120:123]
    ds_read_b64_tr_b16 v[146:147], v24 offset:18944
    v_fma_f32 v87, -v18, v219, v87
    s_waitcnt vmcnt(10) lgkmcnt(6)
    v_mfma_f32_16x16x32_bf16 v[184:187], v[188:191], v[192:195], v[184:187]
    v_mfma_f32_16x16x32_bf16 v[32:35], v[128:131], v[168:171], v[32:35]
    ds_read_b64_tr_b16 v[148:149], v25 offset:18432
    v_fma_f32 v72, -v20, v212, v72
    v_fma_f32 v73, -v20, v213, v73
    v_mfma_f32_16x16x32_bf16 v[36:39], v[128:131], v[172:175], v[36:39]
    ds_read_b64_tr_b16 v[150:151], v25 offset:18944
    v_fma_f32 v74, -v20, v214, v74
    v_mfma_f32_16x16x32_bf16 v[52:55], v[132:135], v[172:175], v[52:55]
    v_fma_f32 v75, -v20, v215, v75
    ds_read_b128 v[152:155], v10 offset:0
    v_mfma_f32_16x16x32_bf16 v[48:51], v[132:135], v[168:171], v[48:51]
    ds_read_b64_tr_b16 v[188:189], v28 offset:2048
    v_fma_f32 v76, -v22, v212, v76
    v_fma_f32 v77, -v22, v213, v77
    ds_read_b128 v[156:159], v10 offset:64
    s_waitcnt lgkmcnt(7)
    v_mfma_f32_16x16x32_bf16 v[64:67], v[136:139], v[168:171], v[64:67]
    v_fma_f32 v78, -v22, v214, v78
    ds_read_b32 v17, v8 offset:2816
    v_mfma_f32_16x16x32_bf16 v[68:71], v[136:139], v[172:175], v[68:71]
    ds_read_b64_tr_b16 v[190:191], v28 offset:2560
    v_fma_f32 v79, -v22, v215, v79
    v_mfma_f32_16x16x32_bf16 v[84:87], v[140:143], v[172:175], v[84:87]
    v_fma_f32 v88, -v20, v216, v88
    v_fma_f32 v89, -v20, v217, v89
    ds_read_b32 v19, v8 offset:2880
    v_mfma_f32_16x16x32_bf16 v[80:83], v[140:143], v[168:171], v[80:83]
    ds_read_b128 v[192:195], v30 offset:1024
    v_fma_f32 v90, -v20, v218, v90
    ds_read_b32 v21, v8 offset:2944
    s_waitcnt lgkmcnt(8)
    v_mfma_f32_16x16x32_bf16 v[96:99], v[168:171], v[144:147], v[96:99]
    v_fma_f32 v91, -v20, v219, v91
    ds_read_b32 v23, v8 offset:3008
    v_mfma_f32_16x16x32_bf16 v[100:103], v[172:175], v[144:147], v[100:103]
    v_fma_f32 v92, -v22, v216, v92
    v_fma_f32 v93, -v22, v217, v93
    v_mfma_f32_16x16x32_bf16 v[116:119], v[172:175], v[148:151], v[116:119]
    v_fma_f32 v94, -v22, v218, v94
    v_mfma_f32_16x16x32_bf16 v[112:115], v[168:171], v[148:151], v[112:115]
    v_fma_f32 v95, -v22, v219, v95
    s_waitcnt vmcnt(8)
    v_mfma_f32_16x16x32_bf16 v[40:43], v[128:131], v[176:179], v[40:43]
    s_waitcnt lgkmcnt(0)
    v_fma_f32 v32, -v16, v152, v32
    v_fma_f32 v33, -v16, v153, v33
    v_mfma_f32_16x16x32_bf16 v[44:47], v[128:131], v[180:183], v[44:47]
    v_fma_f32 v34, -v16, v154, v34
    v_mfma_f32_16x16x32_bf16 v[60:63], v[132:135], v[180:183], v[60:63]
    ds_read_b64_tr_b16 v[128:129], v24 offset:4096
    v_fma_f32 v35, -v16, v155, v35
    v_fma_f32 v36, -v18, v152, v36
    v_mfma_f32_16x16x32_bf16 v[56:59], v[132:135], v[176:179], v[56:59]
    ds_read_b64_tr_b16 v[130:131], v24 offset:4608
    v_fma_f32 v37, -v18, v153, v37
    v_mfma_f32_16x16x32_bf16 v[72:75], v[136:139], v[176:179], v[72:75]
    ds_read_b64_tr_b16 v[132:133], v25 offset:4096
    v_fma_f32 v38, -v18, v154, v38
    v_fma_f32 v39, -v18, v155, v39
    v_mfma_f32_16x16x32_bf16 v[76:79], v[136:139], v[180:183], v[76:79]
    ds_read_b64_tr_b16 v[134:135], v25 offset:4608
    v_fma_f32 v48, -v16, v156, v48
    v_mfma_f32_16x16x32_bf16 v[92:95], v[140:143], v[180:183], v[92:95]
    ds_read_b64_tr_b16 v[136:137], v24 offset:12288
    v_fma_f32 v49, -v16, v157, v49
    v_fma_f32 v50, -v16, v158, v50
    v_mfma_f32_16x16x32_bf16 v[88:91], v[140:143], v[176:179], v[88:91]
    ds_read_b64_tr_b16 v[138:139], v24 offset:12800
    v_fma_f32 v51, -v16, v159, v51
    v_mfma_f32_16x16x32_bf16 v[104:107], v[176:179], v[144:147], v[104:107]
    ds_read_b64_tr_b16 v[140:141], v25 offset:12288
    v_fma_f32 v52, -v18, v156, v52
    v_fma_f32 v53, -v18, v157, v53
    v_mfma_f32_16x16x32_bf16 v[108:111], v[180:183], v[144:147], v[108:111]
    ds_read_b64_tr_b16 v[142:143], v25 offset:12800
    v_fma_f32 v54, -v18, v158, v54
    v_mfma_f32_16x16x32_bf16 v[124:127], v[180:183], v[148:151], v[124:127]
    ds_read_b64_tr_b16 v[144:145], v24 offset:20480
    v_fma_f32 v55, -v18, v159, v55
    v_mfma_f32_16x16x32_bf16 v[120:123], v[176:179], v[148:151], v[120:123]
    ds_read_b64_tr_b16 v[146:147], v24 offset:20992
    s_waitcnt vmcnt(6) lgkmcnt(6)
    v_mfma_f32_16x16x32_bf16 v[184:187], v[188:191], v[192:195], v[184:187]
    v_mfma_f32_16x16x32_bf16 v[32:35], v[128:131], a[0:3], v[32:35]
    ds_read_b64_tr_b16 v[148:149], v25 offset:20480
    v_fma_f32 v40, -v20, v152, v40
    v_fma_f32 v41, -v20, v153, v41
    v_mfma_f32_16x16x32_bf16 v[36:39], v[128:131], a[4:7], v[36:39]
    ds_read_b64_tr_b16 v[150:151], v25 offset:20992
    v_fma_f32 v42, -v20, v154, v42
    v_mfma_f32_16x16x32_bf16 v[52:55], v[132:135], a[4:7], v[52:55]
    v_fma_f32 v43, -v20, v155, v43
    v_fma_f32 v44, -v22, v152, v44
    ds_read_b128 v[168:171], v9 offset:1280
    v_mfma_f32_16x16x32_bf16 v[48:51], v[132:135], a[0:3], v[48:51]
    ds_read_b64_tr_b16 v[188:189], v28 offset:4096
    v_fma_f32 v45, -v22, v153, v45
    ds_read_b128 v[172:175], v9 offset:1344
    s_waitcnt lgkmcnt(7)
    v_mfma_f32_16x16x32_bf16 v[64:67], v[136:139], a[0:3], v[64:67]
    v_fma_f32 v46, -v22, v154, v46
    v_fma_f32 v47, -v22, v155, v47
    v_mfma_f32_16x16x32_bf16 v[68:71], v[136:139], a[4:7], v[68:71]
    ds_read_b64_tr_b16 v[190:191], v28 offset:4608
    v_fma_f32 v56, -v20, v156, v56
    ds_read_b128 v[176:179], v9 offset:1408
    v_mfma_f32_16x16x32_bf16 v[84:87], v[140:143], a[4:7], v[84:87]
    v_fma_f32 v57, -v20, v157, v57
    v_fma_f32 v58, -v20, v158, v58
    ds_read_b128 v[180:183], v9 offset:1472
    v_mfma_f32_16x16x32_bf16 v[80:83], v[140:143], a[0:3], v[80:83]
    ds_read_b128 v[192:195], v30 offset:2048
    v_fma_f32 v59, -v20, v159, v59
    s_waitcnt lgkmcnt(7)
    v_mfma_f32_16x16x32_bf16 v[96:99], a[0:3], v[144:147], v[96:99]
    v_fma_f32 v60, -v22, v156, v60
    v_fma_f32 v61, -v22, v157, v61
    ds_read2_b32 v[220:221], v11 offset0:64 offset1:80
    v_mfma_f32_16x16x32_bf16 v[100:103], a[4:7], v[144:147], v[100:103]
    v_fma_f32 v62, -v22, v158, v62
    v_mfma_f32_16x16x32_bf16 v[116:119], a[4:7], v[148:151], v[116:119]
    v_fma_f32 v63, -v22, v159, v63
    v_mfma_f32_16x16x32_bf16 v[112:115], a[0:3], v[148:151], v[112:115]
    s_waitcnt vmcnt(4)
    v_mfma_f32_16x16x32_bf16 v[40:43], v[128:131], a[8:11], v[40:43]
    v_mfma_f32_16x16x32_bf16 v[44:47], v[128:131], a[12:15], v[44:47]
    s_waitcnt lgkmcnt(0)
    v_fma_f32 v96, -v168, v220, v96
    v_fma_f32 v97, -v169, v220, v97
    v_mfma_f32_16x16x32_bf16 v[60:63], v[132:135], a[12:15], v[60:63]
    ds_read_b64_tr_b16 v[128:129], v24 offset:6144
    v_fma_f32 v98, -v170, v220, v98
    v_mfma_f32_16x16x32_bf16 v[56:59], v[132:135], a[8:11], v[56:59]
    ds_read_b64_tr_b16 v[130:131], v24 offset:6656
    v_fma_f32 v99, -v171, v220, v99
    v_fma_f32 v100, -v172, v220, v100
    v_mfma_f32_16x16x32_bf16 v[72:75], v[136:139], a[8:11], v[72:75]
    ds_read_b64_tr_b16 v[132:133], v25 offset:6144
    v_fma_f32 v101, -v173, v220, v101
    v_mfma_f32_16x16x32_bf16 v[76:79], v[136:139], a[12:15], v[76:79]
    ds_read_b64_tr_b16 v[134:135], v25 offset:6656
    v_fma_f32 v102, -v174, v220, v102
    v_fma_f32 v103, -v175, v220, v103
    v_mfma_f32_16x16x32_bf16 v[92:95], v[140:143], a[12:15], v[92:95]
    ds_read_b64_tr_b16 v[136:137], v24 offset:14336
    v_fma_f32 v112, -v168, v221, v112
    v_mfma_f32_16x16x32_bf16 v[88:91], v[140:143], a[8:11], v[88:91]
    ds_read_b64_tr_b16 v[138:139], v24 offset:14848
    v_fma_f32 v113, -v169, v221, v113
    v_fma_f32 v114, -v170, v221, v114
    v_mfma_f32_16x16x32_bf16 v[104:107], a[8:11], v[144:147], v[104:107]
    ds_read_b64_tr_b16 v[140:141], v25 offset:14336
    v_fma_f32 v115, -v171, v221, v115
    v_mfma_f32_16x16x32_bf16 v[108:111], a[12:15], v[144:147], v[108:111]
    ds_read_b64_tr_b16 v[142:143], v25 offset:14848
    v_fma_f32 v116, -v172, v221, v116
    v_fma_f32 v117, -v173, v221, v117
    v_mfma_f32_16x16x32_bf16 v[124:127], a[12:15], v[148:151], v[124:127]
    ds_read_b64_tr_b16 v[144:145], v24 offset:22528
    v_fma_f32 v118, -v174, v221, v118
    v_mfma_f32_16x16x32_bf16 v[120:123], a[8:11], v[148:151], v[120:123]
    ds_read_b64_tr_b16 v[146:147], v24 offset:23040
    v_fma_f32 v119, -v175, v221, v119
    s_waitcnt vmcnt(2) lgkmcnt(6)
    v_mfma_f32_16x16x32_bf16 v[184:187], v[188:191], v[192:195], v[184:187]
    v_mfma_f32_16x16x32_bf16 v[32:35], v[128:131], a[16:19], v[32:35]
    ds_read_b64_tr_b16 v[148:149], v25 offset:22528
    v_mfma_f32_16x16x32_bf16 v[36:39], v[128:131], a[20:23], v[36:39]
    ds_read_b64_tr_b16 v[150:151], v25 offset:23040
    v_fma_f32 v104, -v176, v220, v104
    v_fma_f32 v105, -v177, v220, v105
    v_mfma_f32_16x16x32_bf16 v[52:55], v[132:135], a[20:23], v[52:55]
    v_fma_f32 v106, -v178, v220, v106
    ds_read_b128 v[152:155], v9 offset:2816
    v_mfma_f32_16x16x32_bf16 v[48:51], v[132:135], a[16:19], v[48:51]
    ds_read_b64_tr_b16 v[188:189], v28 offset:6144
    v_fma_f32 v107, -v179, v220, v107
    v_fma_f32 v108, -v180, v220, v108
    ds_read_b128 v[156:159], v9 offset:2880
    s_waitcnt lgkmcnt(7)
    v_mfma_f32_16x16x32_bf16 v[64:67], v[136:139], a[16:19], v[64:67]
    v_fma_f32 v109, -v181, v220, v109
    ds_read_b128 v[160:163], v9 offset:2944
    v_mfma_f32_16x16x32_bf16 v[68:71], v[136:139], a[20:23], v[68:71]
    ds_read_b64_tr_b16 v[190:191], v28 offset:6656
    v_fma_f32 v110, -v182, v220, v110
    v_fma_f32 v111, -v183, v220, v111
    ds_read_b128 v[164:167], v9 offset:3008
    v_mfma_f32_16x16x32_bf16 v[84:87], v[140:143], a[20:23], v[84:87]
    v_fma_f32 v120, -v176, v221, v120
    ds_read_b128 v[212:215], v14 offset:128
    v_mfma_f32_16x16x32_bf16 v[80:83], v[140:143], a[16:19], v[80:83]
    ds_read_b128 v[192:195], v30 offset:3072
    v_fma_f32 v121, -v177, v221, v121
    v_fma_f32 v122, -v178, v221, v122
    ds_read_b32 v222, v11 offset:1216
    s_waitcnt lgkmcnt(9)
    v_mfma_f32_16x16x32_bf16 v[96:99], a[16:19], v[144:147], v[96:99]
    v_fma_f32 v123, -v179, v221, v123
    ds_read_b32 v223, v11 offset:2752
    v_mfma_f32_16x16x32_bf16 v[100:103], a[20:23], v[144:147], v[100:103]
    v_fma_f32 v124, -v180, v221, v124
    v_fma_f32 v125, -v181, v221, v125
    v_mfma_f32_16x16x32_bf16 v[116:119], a[20:23], v[148:151], v[116:119]
    v_fma_f32 v126, -v182, v221, v126
    s_waitcnt lgkmcnt(2)
    v_mfma_f32_16x16x32_bf16 v[112:115], a[16:19], v[148:151], v[112:115]
    v_fma_f32 v127, -v183, v221, v127
    s_barrier
    s_waitcnt vmcnt(0)
    v_mfma_f32_16x16x32_bf16 v[40:43], v[128:131], a[24:27], v[40:43]
    v_mul_f32 v64, v17, v64
    v_mul_f32 v65, v17, v65
    v_mfma_f32_16x16x32_bf16 v[44:47], v[128:131], a[28:31], v[44:47]
    v_mul_f32 v66, v17, v66
    v_mul_f32 v67, v17, v67
    v_mfma_f32_16x16x32_bf16 v[60:63], v[132:135], a[28:31], v[60:63]
    v_mul_f32 v80, v17, v80
    v_mul_f32 v81, v17, v81
    v_mfma_f32_16x16x32_bf16 v[56:59], v[132:135], a[24:27], v[56:59]
    v_mul_f32 v82, v17, v82
    v_mul_f32 v83, v17, v83
    v_mfma_f32_16x16x32_bf16 v[72:75], v[136:139], a[24:27], v[72:75]
    v_cvt_pk_bf16_f32 v64, v64, v65
    v_cvt_pk_bf16_f32 v65, v66, v67
    v_mfma_f32_16x16x32_bf16 v[76:79], v[136:139], a[28:31], v[76:79]
    v_cvt_pk_bf16_f32 v66, v80, v81
    v_cvt_pk_bf16_f32 v67, v82, v83
    v_mfma_f32_16x16x32_bf16 v[92:95], v[140:143], a[28:31], v[92:95]
    v_mul_f32 v68, v19, v68
    v_mul_f32 v69, v19, v69
    v_mfma_f32_16x16x32_bf16 v[88:91], v[140:143], a[24:27], v[88:91]
    v_mul_f32 v70, v19, v70
    v_mul_f32 v71, v19, v71
    v_mfma_f32_16x16x32_bf16 v[104:107], a[24:27], v[144:147], v[104:107]
    v_mul_f32 v84, v19, v84
    v_mul_f32 v85, v19, v85
    v_mfma_f32_16x16x32_bf16 v[108:111], a[28:31], v[144:147], v[108:111]
    v_mul_f32 v86, v19, v86
    v_mul_f32 v87, v19, v87
    v_mfma_f32_16x16x32_bf16 v[124:127], a[28:31], v[148:151], v[124:127]
    v_cvt_pk_bf16_f32 v68, v68, v69
    v_cvt_pk_bf16_f32 v69, v70, v71
    v_mfma_f32_16x16x32_bf16 v[120:123], a[24:27], v[148:151], v[120:123]
    v_cvt_pk_bf16_f32 v70, v84, v85
    v_cvt_pk_bf16_f32 v71, v86, v87
    v_mfma_f32_16x16x32_bf16 v[184:187], v[188:191], v[192:195], v[184:187]
    v_pk_mul_f32 v[72:73], v[20:21], v[72:73] op_sel:[1,0] op_sel_hi:[1,1]
    v_pk_mul_f32 v[74:75], v[20:21], v[74:75] op_sel:[1,0] op_sel_hi:[1,1]
    v_pk_mul_f32 v[88:89], v[20:21], v[88:89] op_sel:[1,0] op_sel_hi:[1,1]
    v_pk_mul_f32 v[90:91], v[20:21], v[90:91] op_sel:[1,0] op_sel_hi:[1,1]
    v_cvt_pk_bf16_f32 v72, v72, v73
    v_cvt_pk_bf16_f32 v73, v74, v75
    v_cvt_pk_bf16_f32 v74, v88, v89
    v_cvt_pk_bf16_f32 v75, v90, v91
    v_pk_mul_f32 v[76:77], v[22:23], v[76:77] op_sel:[1,0] op_sel_hi:[1,1]
    v_pk_mul_f32 v[78:79], v[22:23], v[78:79] op_sel:[1,0] op_sel_hi:[1,1]
    v_pk_mul_f32 v[92:93], v[22:23], v[92:93] op_sel:[1,0] op_sel_hi:[1,1]
    v_pk_mul_f32 v[94:95], v[22:23], v[94:95] op_sel:[1,0] op_sel_hi:[1,1]
    v_cvt_pk_bf16_f32 v76, v76, v77
    v_cvt_pk_bf16_f32 v77, v78, v79
    v_cvt_pk_bf16_f32 v78, v92, v93
    v_cvt_pk_bf16_f32 v79, v94, v95
    ds_write_b128 v12, v[76:79] offset:2048
    s_waitcnt lgkmcnt(1)
    v_pk_mul_f32 v[96:97], v[152:153], v[96:97]
    v_pk_mul_f32 v[98:99], v[154:155], v[98:99]
    v_pk_mul_f32 v[112:113], v[152:153], v[112:113]
    v_pk_mul_f32 v[114:115], v[154:155], v[114:115]
    v_cvt_pk_bf16_f32 v99, v98, v99
    v_cvt_pk_bf16_f32 v98, v96, v97
    v_cvt_pk_bf16_f32 v115, v114, v115
    v_cvt_pk_bf16_f32 v114, v112, v113
    v_pk_mul_f32 v[100:101], v[156:157], v[100:101]
    v_pk_mul_f32 v[102:103], v[158:159], v[102:103]
    v_pk_mul_f32 v[116:117], v[156:157], v[116:117]
    v_pk_mul_f32 v[118:119], v[158:159], v[118:119]
    v_cvt_pk_bf16_f32 v100, v100, v101
    v_cvt_pk_bf16_f32 v101, v102, v103
    v_cvt_pk_bf16_f32 v116, v116, v117
    v_cvt_pk_bf16_f32 v117, v118, v119
    v_pk_mul_f32 v[104:105], v[160:161], v[104:105]
    v_pk_mul_f32 v[106:107], v[162:163], v[106:107]
    v_pk_mul_f32 v[120:121], v[160:161], v[120:121]
    v_pk_mul_f32 v[122:123], v[162:163], v[122:123]
    v_cvt_pk_bf16_f32 v102, v104, v105
    v_cvt_pk_bf16_f32 v103, v106, v107
    v_cvt_pk_bf16_f32 v118, v120, v121
    v_cvt_pk_bf16_f32 v119, v122, v123
    v_pk_mul_f32 v[108:109], v[164:165], v[108:109]
    v_pk_mul_f32 v[110:111], v[166:167], v[110:111]
    v_pk_mul_f32 v[124:125], v[164:165], v[124:125]
    v_pk_mul_f32 v[126:127], v[166:167], v[126:127]
    v_cvt_pk_bf16_f32 v104, v108, v109
    v_cvt_pk_bf16_f32 v105, v110, v111
    v_cvt_pk_bf16_f32 v120, v124, v125
    v_cvt_pk_bf16_f32 v121, v126, v127
    ds_write_b64 v12, v[104:105] offset:3072
    ds_write_b64 v12, v[120:121] offset:3080
    v_pk_fma_f32 v[184:185], v[222:223], v[212:213], v[184:185] op_sel_hi:[0,1,1] neg_lo:[1,0,0] neg_hi:[1,0,0]
    v_pk_fma_f32 v[186:187], v[222:223], v[214:215], v[186:187] op_sel_hi:[0,1,1] neg_lo:[1,0,0] neg_hi:[1,0,0]
    v_pk_mul_f32 v[184:185], v[222:223], v[184:185] op_sel:[1,0] op_sel_hi:[1,1]
    v_pk_mul_f32 v[186:187], v[222:223], v[186:187] op_sel:[1,0] op_sel_hi:[1,1]
    v_cvt_pk_bf16_f32 v184, v184, v185
    v_cvt_pk_bf16_f32 v185, v186, v187
    s_cmp_ge_u32 s8, 2
    s_cbranch_scc1 c_qkvA_hv
    ds_write_b64 v13, v[184:185]
    s_branch c_qkvA_hd
c_qkvA_hv:
    ds_write_b16 v13, v184 offset:0
    ds_write_b16_d16_hi v13, v184 offset:16
    ds_write_b16 v13, v185 offset:32
    ds_write_b16_d16_hi v13, v185 offset:48
c_qkvA_hd:
    v_cvt_pk_bf16_f32 v44, v44, v45
    v_cvt_pk_bf16_f32 v45, v46, v47
    v_cvt_pk_bf16_f32 v46, v60, v61
    v_cvt_pk_bf16_f32 v47, v62, v63
    v_mul_f32 v23, 0x3e8293ee, v23
    v_cvt_pk_bf16_f32 v40, v40, v41
    v_mfma_f32_16x16x32_bf16 v[156:159], v[76:79], v[44:47], v[196:199]
    v_cvt_pk_bf16_f32 v41, v42, v43
    v_cvt_pk_bf16_f32 v42, v56, v57
    v_mfma_f32_16x16x32_bf16 v[152:155], v[72:75], v[44:47], v[200:203]
    v_cvt_pk_bf16_f32 v43, v58, v59
    v_mul_f32 v21, 0x3e8293ee, v21
    s_waitcnt lgkmcnt(0)
    s_barrier
    ds_read_b128 v[172:175], v12
    ds_read_b64 v[96:97], v12 offset:1024
    ds_read_b64 v[112:113], v12 offset:1032
    v_mfma_f32_16x16x32_bf16 v[148:151], v[72:75], v[40:43], v[196:199]
    v_cvt_pk_bf16_f32 v36, v36, v37
    v_cvt_pk_bf16_f32 v37, v38, v39
    v_mfma_f32_16x16x32_bf16 v[144:147], v[68:71], v[40:43], v[200:203]
    v_cvt_pk_bf16_f32 v38, v52, v53
    v_cvt_pk_bf16_f32 v39, v54, v55
    v_mul_f32 v19, 0x3e8293ee, v19
    v_cvt_pk_bf16_f32 v32, v32, v33
    v_mfma_f32_16x16x32_bf16 v[140:143], v[68:71], v[36:39], v[196:199]
    v_cvt_pk_bf16_f32 v33, v34, v35
    v_cvt_pk_bf16_f32 v34, v48, v49
    v_mfma_f32_16x16x32_bf16 v[136:139], v[64:67], v[36:39], v[200:203]
    v_cvt_pk_bf16_f32 v35, v50, v51
    v_mul_f32 v17, 0x3e8293ee, v17
    v_max3_f32 v179, v152, v153, v154
    s_waitcnt lgkmcnt(2)
    v_mfma_f32_16x16x32_bf16 v[132:135], v[64:67], v[32:35], v[196:199]
    v_max3_f32 v179, v179, v155, v156
    v_max3_f32 v179, v179, v157, v158
    v_mfma_f32_16x16x32_bf16 v[128:131], v[172:175], v[32:35], v[204:207]
    v_max_f32 v179, v179, v159
    v_mov_b32 v183, v179
    v_max3_f32 v178, v144, v145, v146
    v_max3_f32 v178, v178, v147, v148
    v_max3_f32 v178, v178, v149, v150
    v_max_f32 v178, v178, v151
    v_mov_b32 v182, v178
    v_max3_f32 v177, v136, v137, v138
    v_max3_f32 v177, v177, v139, v140
    v_max3_f32 v177, v177, v141, v142
    v_max_f32 v177, v177, v143
    v_mov_b32 v181, v177
    v_permlane32_swap_b32 v179, v183
    v_permlane32_swap_b32 v178, v182
    v_permlane32_swap_b32 v177, v181
    v_max3_f32 v176, v128, v129, v130
    v_max3_f32 v176, v176, v131, v132
    v_max3_f32 v176, v176, v133, v134
    v_max_f32 v176, v176, v135
    v_mov_b32 v180, v176
    v_max_f32 v179, v179, v183
    v_max_f32 v178, v178, v182
    v_max_f32 v177, v177, v181
    v_permlane32_swap_b32 v176, v180
    v_mov_b32 v183, v179
    v_mov_b32 v182, v178
    v_mov_b32 v181, v177
    v_max_f32 v176, v176, v180
    v_mov_b32 v180, v176
    v_permlane16_swap_b32 v179, v183
    v_permlane16_swap_b32 v178, v182
    v_permlane16_swap_b32 v177, v181
    v_permlane16_swap_b32 v176, v180
    v_max_f32 v179, v179, v183
    v_max_f32 v178, v178, v182
    v_max_f32 v177, v177, v181
    v_max_f32 v176, v176, v180
    v_mul_f32_e64 v22, -v179, v23
    v_mul_f32_e64 v20, -v178, v21
    v_mul_f32_e64 v18, -v177, v19
    v_mul_f32_e64 v16, -v176, v17
    s_waitcnt lgkmcnt(0)
    s_add_u32 s51, s49, 65536
    v_pk_fma_f32 v[152:153], v[152:153], v[22:23], v[22:23] op_sel:[0,1,0] op_sel_hi:[1,1,0]
    v_pk_fma_f32 v[154:155], v[154:155], v[22:23], v[22:23] op_sel:[0,1,0] op_sel_hi:[1,1,0]
    v_pk_fma_f32 v[156:157], v[156:157], v[22:23], v[22:23] op_sel:[0,1,0] op_sel_hi:[1,1,0]
    v_pk_fma_f32 v[158:159], v[158:159], v[22:23], v[22:23] op_sel:[0,1,0] op_sel_hi:[1,1,0]
    v_pk_fma_f32 v[144:145], v[144:145], v[20:21], v[20:21] op_sel:[0,1,0] op_sel_hi:[1,1,0]
    v_pk_fma_f32 v[146:147], v[146:147], v[20:21], v[20:21] op_sel:[0,1,0] op_sel_hi:[1,1,0]
    v_pk_fma_f32 v[148:149], v[148:149], v[20:21], v[20:21] op_sel:[0,1,0] op_sel_hi:[1,1,0]
    v_pk_fma_f32 v[150:151], v[150:151], v[20:21], v[20:21] op_sel:[0,1,0] op_sel_hi:[1,1,0]
    v_pk_fma_f32 v[136:137], v[136:137], v[18:19], v[18:19] op_sel:[0,1,0] op_sel_hi:[1,1,0]
    v_pk_fma_f32 v[138:139], v[138:139], v[18:19], v[18:19] op_sel:[0,1,0] op_sel_hi:[1,1,0]
    v_pk_fma_f32 v[140:141], v[140:141], v[18:19], v[18:19] op_sel:[0,1,0] op_sel_hi:[1,1,0]
    v_pk_fma_f32 v[142:143], v[142:143], v[18:19], v[18:19] op_sel:[0,1,0] op_sel_hi:[1,1,0]
    v_pk_fma_f32 v[128:129], v[128:129], v[16:17], v[16:17] op_sel:[0,1,0] op_sel_hi:[1,1,0]
    v_pk_fma_f32 v[130:131], v[130:131], v[16:17], v[16:17] op_sel:[0,1,0] op_sel_hi:[1,1,0]
    v_pk_fma_f32 v[132:133], v[132:133], v[16:17], v[16:17] op_sel:[0,1,0] op_sel_hi:[1,1,0]
    v_pk_fma_f32 v[134:135], v[134:135], v[16:17], v[16:17] op_sel:[0,1,0] op_sel_hi:[1,1,0]
    v_exp_f32 v152, v152
    v_exp_f32 v153, v153
    v_exp_f32 v154, v154
    v_exp_f32 v155, v155
    v_exp_f32 v156, v156
    v_exp_f32 v157, v157
    v_exp_f32 v158, v158
    v_exp_f32 v159, v159
    v_cvt_pk_bf16_f32 v172, v152, v153
    v_cvt_pk_bf16_f32 v173, v154, v155
    v_cvt_pk_bf16_f32 v174, v156, v157
    v_cvt_pk_bf16_f32 v175, v158, v159
    v_exp_f32 v144, v144
    v_exp_f32 v145, v145
    v_mfma_f32_16x16x32_bf16 v[92:95], v[208:211], v[172:175], 0
    v_exp_f32 v146, v146
    v_mfma_f32_16x16x32_bf16 v[60:63], v[102:105], v[172:175], 0
    v_exp_f32 v147, v147
    v_mfma_f32_16x16x32_bf16 v[76:79], v[118:121], v[172:175], 0
    v_exp_f32 v148, v148
    v_exp_f32 v149, v149
    v_exp_f32 v150, v150
    v_exp_f32 v151, v151
    v_rcp_f32 v92, v92
    v_cvt_pk_bf16_f32 v168, v144, v145
    v_cvt_pk_bf16_f32 v169, v146, v147
    v_cvt_pk_bf16_f32 v170, v148, v149
    v_cvt_pk_bf16_f32 v171, v150, v151
    v_pk_mul_f32 v[60:61], v[92:93], v[60:61] op_sel_hi:[0,1]
    v_pk_mul_f32 v[62:63], v[92:93], v[62:63] op_sel_hi:[0,1]
    v_pk_mul_f32 v[76:77], v[92:93], v[76:77] op_sel_hi:[0,1]
    v_pk_mul_f32 v[78:79], v[92:93], v[78:79] op_sel_hi:[0,1]
    v_cvt_pk_bf16_f32 v60, v60, v61
    v_cvt_pk_bf16_f32 v61, v62, v63
    v_cvt_pk_bf16_f32 v62, v76, v77
    v_cvt_pk_bf16_f32 v63, v78, v79
    buffer_store_dwordx4 v[60:63], v6, s[12:15], s51 offen offset:256 sc1
    v_exp_f32 v136, v136
    v_exp_f32 v137, v137
    v_mfma_f32_16x16x32_bf16 v[88:91], v[208:211], v[168:171], 0
    v_exp_f32 v138, v138
    v_mfma_f32_16x16x32_bf16 v[56:59], v[100:103], v[168:171], 0
    v_exp_f32 v139, v139
    v_mfma_f32_16x16x32_bf16 v[72:75], v[116:119], v[168:171], 0
    v_exp_f32 v140, v140
    v_exp_f32 v141, v141
    v_exp_f32 v142, v142
    v_exp_f32 v143, v143
    v_rcp_f32 v88, v88
    v_cvt_pk_bf16_f32 v164, v136, v137
    v_cvt_pk_bf16_f32 v165, v138, v139
    v_cvt_pk_bf16_f32 v166, v140, v141
    v_cvt_pk_bf16_f32 v167, v142, v143
    v_pk_mul_f32 v[56:57], v[88:89], v[56:57] op_sel_hi:[0,1]
    v_pk_mul_f32 v[58:59], v[88:89], v[58:59] op_sel_hi:[0,1]
    v_pk_mul_f32 v[72:73], v[88:89], v[72:73] op_sel_hi:[0,1]
    v_pk_mul_f32 v[74:75], v[88:89], v[74:75] op_sel_hi:[0,1]
    v_cvt_pk_bf16_f32 v56, v56, v57
    v_cvt_pk_bf16_f32 v57, v58, v59
    v_cvt_pk_bf16_f32 v58, v72, v73
    v_cvt_pk_bf16_f32 v59, v74, v75
    buffer_store_dwordx4 v[56:59], v6, s[12:15], s51 offen offset:0 sc1
    v_exp_f32 v128, v128
    v_exp_f32 v129, v129
    v_mfma_f32_16x16x32_bf16 v[84:87], v[208:211], v[164:167], 0
    v_exp_f32 v130, v130
    v_mfma_f32_16x16x32_bf16 v[52:55], v[98:101], v[164:167], 0
    v_exp_f32 v131, v131
    v_mfma_f32_16x16x32_bf16 v[68:71], v[114:117], v[164:167], 0
    v_exp_f32 v132, v132
    v_exp_f32 v133, v133
    v_exp_f32 v134, v134
    v_exp_f32 v135, v135
    v_rcp_f32 v84, v84
    v_cvt_pk_bf16_f32 v160, v128, v129
    v_cvt_pk_bf16_f32 v161, v130, v131
    v_cvt_pk_bf16_f32 v162, v132, v133
    v_cvt_pk_bf16_f32 v163, v134, v135
    v_pk_mul_f32 v[52:53], v[84:85], v[52:53] op_sel_hi:[0,1]
    v_pk_mul_f32 v[54:55], v[84:85], v[54:55] op_sel_hi:[0,1]
    v_mfma_f32_16x16x32_bf16 v[80:83], v[208:211], v[160:163], 0
    v_pk_mul_f32 v[68:69], v[84:85], v[68:69] op_sel_hi:[0,1]
    v_pk_mul_f32 v[70:71], v[84:85], v[70:71] op_sel_hi:[0,1]
    v_mfma_f32_16x16x32_bf16 v[48:51], v[96:99], v[160:163], 0
    v_cvt_pk_bf16_f32 v52, v52, v53
    v_cvt_pk_bf16_f32 v53, v54, v55
    v_mfma_f32_16x16x32_bf16 v[64:67], v[112:115], v[160:163], 0
    v_cvt_pk_bf16_f32 v54, v68, v69
    v_cvt_pk_bf16_f32 v55, v70, v71
    buffer_store_dwordx4 v[52:55], v6, s[12:15], s49 offen offset:256 sc1
    v_rcp_f32 v80, v80
    s_nop 0
    v_pk_mul_f32 v[48:49], v[80:81], v[48:49] op_sel_hi:[0,1]
    v_pk_mul_f32 v[50:51], v[80:81], v[50:51] op_sel_hi:[0,1]
    s_nop 0
    v_pk_mul_f32 v[64:65], v[80:81], v[64:65] op_sel_hi:[0,1]
    v_pk_mul_f32 v[66:67], v[80:81], v[66:67] op_sel_hi:[0,1]
    v_cvt_pk_bf16_f32 v48, v48, v49
    v_cvt_pk_bf16_f32 v49, v50, v51
    v_cvt_pk_bf16_f32 v50, v64, v65
    v_cvt_pk_bf16_f32 v51, v66, v67
    buffer_store_dwordx4 v[48:51], v6, s[12:15], s49 offen offset:0 sc1
    s_branch c_wo
.p2align 6
c_wo:
    v_and_b32 v1, 63, v0
    v_lshrrev_b32 v2, 6, v0
    v_lshlrev_b32 v5, 4, v1
    v_lshrrev_b32 v3, 5, v1
    s_lshl_b32 s48, s6, 2
    s_add_u32 s48, s48, s8
    s_lshl_b32 s55, s48, 16
    s_lshl_b32 s56, s9, 22
    s_add_u32 s55, s55, s56
    s_lshl_b32 s56, s7, 12
    s_add_u32 s58, s55, s56
    s_add_u32 s55, s55, 16777216
    s_add_u32 s16, s4, s55
    s_addc_u32 s17, s5, 0
    s_mov_b32 s18, 65536
    s_mov_b32 s19, 0x00020000
    s_lshl_b32 s60, s9, 2
    s_add_u32 s60, s60, 159504
    v_mov_b32 v28, s60
    s_mul_i32 s55, s9, 786432
    s_add_u32 s55, s55, 65798144
    v_and_b32 v24, 63, v0
    s_and_b32 s56, s11, 0xe0
    v_lshrrev_b32 v25, 5, v24
    v_add_u32 v24, s56, v24
    v_and_b32 v24, 255, v24
    v_lshlrev_b32 v24, 10, v24
    v_lshl_add_u32 v24, v25, 8, v24
    s_bfe_u32 s56, s11, 0x20003
    s_and_b32 s57, s11, 7
    s_lshl_b32 s56, s56, 7
    s_lshl_b32 s57, s57, 2
    s_add_u32 s55, s55, s56
    s_add_u32 s55, s55, s57
    v_mov_b32 v25, 159488
    v_mov_b32 v26, 1
    v_mov_b32 v27, s10
    v_and_b32 v4, 15, v0
    v_bfe_u32 v17, v1, 4, 1
    v_lshl_add_u32 v6, v17, 5, v4
    v_lshlrev_b32 v6, 4, v6
    v_lshl_add_u32 v6, v3, 10, v6
    v_lshrrev_b32 v16, 2, v4
    v_lshl_add_u32 v16, v17, 2, v16
    v_lshl_add_u32 v16, v3, 4, v16
    v_lshlrev_b32 v16, 7, v16
    v_and_b32 v18, 3, v4
    v_lshl_add_u32 v16, v18, 3, v16
    v_lshrrev_b32 v18, 3, v4
    v_lshl_add_u32 v18, v18, 1, v17
    v_lshl_add_u32 v12, v18, 5, v16
    ds_read_b32 v29, v28
    buffer_load_dwordx4 v[96:99], v6, s[12:15], s58 offen offset:0 sc1
    buffer_load_dwordx4 v[100:103], v6, s[12:15], s58 offen offset:256 sc1
    buffer_load_dwordx4 v[104:107], v6, s[12:15], s58 offen offset:2048 sc1
    buffer_load_dwordx4 v[108:111], v6, s[12:15], s58 offen offset:2304 sc1
    s_waitcnt lgkmcnt(0)
    v_readfirstlane_b32 s60, v29
    s_lshr_b32 s51, s60, 2
    s_and_b32 s51, s51, s60
    s_and_b32 s51, s51, 3
    s_cmp_eq_u32 s51, 0
    s_cbranch_scc1 c_wo_late
    s_and_b32 s52, s51, 1
    s_xor_b32 s52, s52, 1
    s_lshl_b32 s50, s52, 15
    buffer_load_dwordx4 v[112:115], v6, s[16:19], s50 offen offset:0 sc1
    buffer_load_dwordx4 v[116:119], v6, s[16:19], s50 offen offset:256 sc1
    buffer_load_dwordx4 v[120:123], v6, s[16:19], s50 offen offset:2048 sc1
    buffer_load_dwordx4 v[124:127], v6, s[16:19], s50 offen offset:2304 sc1
    s_add_u32 s50, s50, 4096
    buffer_load_dwordx4 v[128:131], v6, s[16:19], s50 offen offset:0 sc1
    s_mov_b64 exec, 1
    s_waitcnt vmcnt(9)
    ds_add_rtn_u32 v26, v25, v26
    s_waitcnt lgkmcnt(0)
    v_readfirstlane_b32 s56, v26
    s_and_b32 s56, s56, 3
    s_cmp_lg_u32 s56, 3
    s_cbranch_scc1 pub_2
    s_mov_b32 exec_lo, -1
    buffer_store_dword v27, v24, s[12:15], s55 offen sc1
pub_2:
    s_mov_b64 exec, -1
    s_branch c_wo_run
c_wo_late:
    s_mov_b64 exec, 1
    s_waitcnt vmcnt(4)
    ds_add_rtn_u32 v26, v25, v26
    s_waitcnt lgkmcnt(0)
    v_readfirstlane_b32 s56, v26
    s_and_b32 s56, s56, 3
    s_cmp_lg_u32 s56, 3
    s_cbranch_scc1 pub_3
    s_mov_b32 exec_lo, -1
    buffer_store_dword v27, v24, s[12:15], s55 offen sc1
pub_3:
    s_mov_b64 exec, -1
    s_branch wp_4_t
wp_4:
    ds_read_b32 v29, v28
    s_waitcnt lgkmcnt(0)
    v_readfirstlane_b32 s60, v29
    s_lshr_b32 s51, s60, 2
    s_and_b32 s51, s51, s60
    s_and_b32 s51, s51, 3
wp_4_t:
    s_cmp_lg_u32 s51, 0
    s_cbranch_scc0 wp_4
    s_and_b32 s52, s51, 1
    s_xor_b32 s52, s52, 1
    s_lshl_b32 s50, s52, 15
    buffer_load_dwordx4 v[112:115], v6, s[16:19], s50 offen offset:0 sc1
    buffer_load_dwordx4 v[116:119], v6, s[16:19], s50 offen offset:256 sc1
    buffer_load_dwordx4 v[120:123], v6, s[16:19], s50 offen offset:2048 sc1
    buffer_load_dwordx4 v[124:127], v6, s[16:19], s50 offen offset:2304 sc1
    s_add_u32 s50, s50, 4096
    buffer_load_dwordx4 v[128:131], v6, s[16:19], s50 offen offset:0 sc1
c_wo_run:
    buffer_load_dwordx4 v[132:135], v6, s[16:19], s50 offen offset:256 sc1
    buffer_load_dwordx4 v[136:139], v6, s[16:19], s50 offen offset:2048 sc1
    buffer_load_dwordx4 v[140:143], v6, s[16:19], s50 offen offset:2304 sc1
    s_add_u32 s50, s50, 4096
    s_lshl_b32 s3, s52, 16
    v_add_u32 v12, s3, v12
    v_xor_b32 v13, 32, v12
    v_xor_b32 v14, 64, v12
    v_xor_b32 v15, 96, v12
    s_cmp_eq_u32 s52, 0
    s_mov_b32 s3, 0x0c0c0c0c
    s_cselect_b32 s53, 0x01000c0c, s3
    s_cselect_b32 s54, 0x03020c0c, s3
    s_cselect_b32 s59, s3, 0x01000c0c
    s_cselect_b32 s97, s3, 0x03020c0c
    s_branch wp_5_t
wp_5:
    ds_read_b32 v29, v28
    s_waitcnt lgkmcnt(0)
    v_readfirstlane_b32 s60, v29
    s_lshr_b32 s51, s60, 2
    s_and_b32 s51, s51, s60
    s_and_b32 s51, s51, 3
wp_5_t:
    s_cmp_ge_u32 s60, 0xf0
    s_cbranch_scc0 wp_5
    ds_read_b64_tr_b16 v[64:65], v12 offset:0
    ds_read_b64_tr_b16 v[66:67], v12 offset:1024
    ds_read_b64_tr_b16 v[68:69], v13 offset:0
    ds_read_b64_tr_b16 v[70:71], v13 offset:1024
    ds_read_b64_tr_b16 v[72:73], v14 offset:0
    ds_read_b64_tr_b16 v[74:75], v14 offset:1024
    ds_read_b64_tr_b16 v[76:77], v15 offset:0
    ds_read_b64_tr_b16 v[78:79], v15 offset:1024
    ds_read_b64_tr_b16 v[80:81], v12 offset:4096
    ds_read_b64_tr_b16 v[82:83], v12 offset:5120
    ds_read_b64_tr_b16 v[84:85], v13 offset:4096
    ds_read_b64_tr_b16 v[86:87], v13 offset:5120
    ds_read_b64_tr_b16 v[88:89], v14 offset:4096
    ds_read_b64_tr_b16 v[90:91], v14 offset:5120
    s_waitcnt vmcnt(8)
    v_perm_b32 v32, v96, v96, s53
    v_perm_b32 v33, v96, v96, s54
    v_perm_b32 v34, v97, v97, s53
    v_perm_b32 v35, v97, v97, s54
    v_perm_b32 v36, v98, v98, s53
    v_perm_b32 v37, v98, v98, s54
    v_perm_b32 v38, v99, v99, s53
    v_perm_b32 v39, v99, v99, s54
    v_perm_b32 v40, v100, v100, s53
    v_perm_b32 v41, v100, v100, s54
    v_perm_b32 v42, v101, v101, s53
    v_perm_b32 v43, v101, v101, s54
    v_perm_b32 v44, v102, v102, s53
    v_perm_b32 v45, v102, v102, s54
    v_perm_b32 v46, v103, v103, s53
    v_perm_b32 v47, v103, v103, s54
    v_perm_b32 v48, v104, v104, s53
    v_perm_b32 v49, v104, v104, s54
    v_perm_b32 v50, v105, v105, s53
    v_perm_b32 v51, v105, v105, s54
    v_perm_b32 v52, v106, v106, s53
    v_perm_b32 v53, v106, v106, s54
    v_perm_b32 v54, v107, v107, s53
    v_perm_b32 v55, v107, v107, s54
    v_perm_b32 v56, v108, v108, s53
    v_perm_b32 v57, v108, v108, s54
    v_perm_b32 v58, v109, v109, s53
    v_perm_b32 v59, v109, v109, s54
    v_perm_b32 v60, v110, v110, s53
    v_perm_b32 v61, v110, v110, s54
    v_perm_b32 v62, v111, v111, s53
    v_perm_b32 v63, v111, v111, s54
    buffer_load_dwordx4 v[144:147], v6, s[16:19], s50 offen offset:0 sc1
    buffer_load_dwordx4 v[148:151], v6, s[16:19], s50 offen offset:256 sc1
    buffer_load_dwordx4 v[152:155], v6, s[16:19], s50 offen offset:2048 sc1
    buffer_load_dwordx4 v[156:159], v6, s[16:19], s50 offen offset:2304 sc1
    s_add_u32 s50, s50, 4096
    buffer_load_dwordx4 v[160:163], v6, s[16:19], s50 offen offset:0 sc1
    buffer_load_dwordx4 v[164:167], v6, s[16:19], s50 offen offset:256 sc1
    s_waitcnt vmcnt(12) lgkmcnt(10)
    v_mfma_f32_16x16x32_bf16 v[32:35], v[64:67], v[112:115], v[32:35]
    ds_read_b64_tr_b16 v[92:93], v15 offset:4096
    v_mfma_f32_16x16x32_bf16 v[40:43], v[64:67], v[116:119], v[40:43]
    ds_read_b64_tr_b16 v[94:95], v15 offset:5120
    v_perm_b32 v176, v96, v96, s59
    v_mfma_f32_16x16x32_bf16 v[44:47], v[68:71], v[116:119], v[44:47]
    ds_read_b64_tr_b16 v[64:65], v12 offset:8192
    buffer_load_dwordx4 v[168:171], v6, s[16:19], s50 offen offset:2048 sc1
    v_mfma_f32_16x16x32_bf16 v[36:39], v[68:71], v[112:115], v[36:39]
    ds_read_b64_tr_b16 v[66:67], v12 offset:9216
    v_perm_b32 v177, v96, v96, s97
    s_waitcnt lgkmcnt(10)
    v_mfma_f32_16x16x32_bf16 v[48:51], v[72:75], v[112:115], v[48:51]
    ds_read_b64_tr_b16 v[68:69], v13 offset:8192
    v_mfma_f32_16x16x32_bf16 v[56:59], v[72:75], v[116:119], v[56:59]
    ds_read_b64_tr_b16 v[70:71], v13 offset:9216
    v_perm_b32 v178, v97, v97, s59
    v_mfma_f32_16x16x32_bf16 v[60:63], v[76:79], v[116:119], v[60:63]
    ds_read_b64_tr_b16 v[72:73], v14 offset:8192
    buffer_load_dwordx4 v[172:175], v6, s[16:19], s50 offen offset:2304 sc1
    s_add_u32 s50, s50, 4096
    v_mfma_f32_16x16x32_bf16 v[52:55], v[76:79], v[112:115], v[52:55]
    ds_read_b64_tr_b16 v[74:75], v14 offset:9216
    s_waitcnt vmcnt(12) lgkmcnt(10)
    v_mfma_f32_16x16x32_bf16 v[32:35], v[80:83], v[120:123], v[32:35]
    ds_read_b64_tr_b16 v[76:77], v15 offset:8192
    v_mfma_f32_16x16x32_bf16 v[40:43], v[80:83], v[124:127], v[40:43]
    ds_read_b64_tr_b16 v[78:79], v15 offset:9216
    v_perm_b32 v179, v97, v97, s97
    v_mfma_f32_16x16x32_bf16 v[44:47], v[84:87], v[124:127], v[44:47]
    ds_read_b64_tr_b16 v[80:81], v12 offset:12288
    buffer_load_dwordx4 v[112:115], v6, s[16:19], s50 offen offset:0 sc1
    v_mfma_f32_16x16x32_bf16 v[36:39], v[84:87], v[120:123], v[36:39]
    ds_read_b64_tr_b16 v[82:83], v12 offset:13312
    v_perm_b32 v180, v98, v98, s59
    s_waitcnt lgkmcnt(10)
    v_mfma_f32_16x16x32_bf16 v[48:51], v[88:91], v[120:123], v[48:51]
    ds_read_b64_tr_b16 v[84:85], v13 offset:12288
    v_mfma_f32_16x16x32_bf16 v[56:59], v[88:91], v[124:127], v[56:59]
    ds_read_b64_tr_b16 v[86:87], v13 offset:13312
    v_perm_b32 v181, v98, v98, s97
    v_mfma_f32_16x16x32_bf16 v[60:63], v[92:95], v[124:127], v[60:63]
    ds_read_b64_tr_b16 v[88:89], v14 offset:12288
    buffer_load_dwordx4 v[116:119], v6, s[16:19], s50 offen offset:256 sc1
    v_mfma_f32_16x16x32_bf16 v[52:55], v[92:95], v[120:123], v[52:55]
    ds_read_b64_tr_b16 v[90:91], v14 offset:13312
    s_waitcnt vmcnt(12) lgkmcnt(10)
    v_mfma_f32_16x16x32_bf16 v[32:35], v[64:67], v[128:131], v[32:35]
    ds_read_b64_tr_b16 v[92:93], v15 offset:12288
    v_mfma_f32_16x16x32_bf16 v[40:43], v[64:67], v[132:135], v[40:43]
    ds_read_b64_tr_b16 v[94:95], v15 offset:13312
    v_perm_b32 v182, v99, v99, s59
    v_mfma_f32_16x16x32_bf16 v[44:47], v[68:71], v[132:135], v[44:47]
    ds_read_b64_tr_b16 v[64:65], v12 offset:16384
    buffer_load_dwordx4 v[120:123], v6, s[16:19], s50 offen offset:2048 sc1
    v_mfma_f32_16x16x32_bf16 v[36:39], v[68:71], v[128:131], v[36:39]
    ds_read_b64_tr_b16 v[66:67], v12 offset:17408
    v_perm_b32 v183, v99, v99, s97
    s_waitcnt lgkmcnt(10)
    v_mfma_f32_16x16x32_bf16 v[48:51], v[72:75], v[128:131], v[48:51]
    ds_read_b64_tr_b16 v[68:69], v13 offset:16384
    v_mfma_f32_16x16x32_bf16 v[56:59], v[72:75], v[132:135], v[56:59]
    ds_read_b64_tr_b16 v[70:71], v13 offset:17408
    v_perm_b32 v184, v100, v100, s59
    v_mfma_f32_16x16x32_bf16 v[60:63], v[76:79], v[132:135], v[60:63]
    ds_read_b64_tr_b16 v[72:73], v14 offset:16384
    buffer_load_dwordx4 v[124:127], v6, s[16:19], s50 offen offset:2304 sc1
    s_add_u32 s50, s50, 4096
    v_mfma_f32_16x16x32_bf16 v[52:55], v[76:79], v[128:131], v[52:55]
    ds_read_b64_tr_b16 v[74:75], v14 offset:17408
    s_waitcnt vmcnt(12) lgkmcnt(10)
    v_mfma_f32_16x16x32_bf16 v[32:35], v[80:83], v[136:139], v[32:35]
    ds_read_b64_tr_b16 v[76:77], v15 offset:16384
    v_mfma_f32_16x16x32_bf16 v[40:43], v[80:83], v[140:143], v[40:43]
    ds_read_b64_tr_b16 v[78:79], v15 offset:17408
    v_perm_b32 v185, v100, v100, s97
    v_mfma_f32_16x16x32_bf16 v[44:47], v[84:87], v[140:143], v[44:47]
    ds_read_b64_tr_b16 v[80:81], v12 offset:20480
    buffer_load_dwordx4 v[128:131], v6, s[16:19], s50 offen offset:0 sc1
    v_mfma_f32_16x16x32_bf16 v[36:39], v[84:87], v[136:139], v[36:39]
    ds_read_b64_tr_b16 v[82:83], v12 offset:21504
    v_perm_b32 v186, v101, v101, s59
    s_waitcnt lgkmcnt(10)
    v_mfma_f32_16x16x32_bf16 v[48:51], v[88:91], v[136:139], v[48:51]
    ds_read_b64_tr_b16 v[84:85], v13 offset:20480
    v_mfma_f32_16x16x32_bf16 v[56:59], v[88:91], v[140:143], v[56:59]
    ds_read_b64_tr_b16 v[86:87], v13 offset:21504
    v_perm_b32 v187, v101, v101, s97
    v_mfma_f32_16x16x32_bf16 v[60:63], v[92:95], v[140:143], v[60:63]
    ds_read_b64_tr_b16 v[88:89], v14 offset:20480
    buffer_load_dwordx4 v[132:135], v6, s[16:19], s50 offen offset:256 sc1
    v_mfma_f32_16x16x32_bf16 v[52:55], v[92:95], v[136:139], v[52:55]
    ds_read_b64_tr_b16 v[90:91], v14 offset:21504
    s_waitcnt vmcnt(12) lgkmcnt(10)
    v_mfma_f32_16x16x32_bf16 v[32:35], v[64:67], v[144:147], v[32:35]
    ds_read_b64_tr_b16 v[92:93], v15 offset:20480
    v_mfma_f32_16x16x32_bf16 v[40:43], v[64:67], v[148:151], v[40:43]
    ds_read_b64_tr_b16 v[94:95], v15 offset:21504
    v_perm_b32 v188, v102, v102, s59
    v_mfma_f32_16x16x32_bf16 v[44:47], v[68:71], v[148:151], v[44:47]
    ds_read_b64_tr_b16 v[64:65], v12 offset:24576
    buffer_load_dwordx4 v[136:139], v6, s[16:19], s50 offen offset:2048 sc1
    v_mfma_f32_16x16x32_bf16 v[36:39], v[68:71], v[144:147], v[36:39]
    ds_read_b64_tr_b16 v[66:67], v12 offset:25600
    v_perm_b32 v189, v102, v102, s97
    s_waitcnt lgkmcnt(10)
    v_mfma_f32_16x16x32_bf16 v[48:51], v[72:75], v[144:147], v[48:51]
    ds_read_b64_tr_b16 v[68:69], v13 offset:24576
    v_mfma_f32_16x16x32_bf16 v[56:59], v[72:75], v[148:151], v[56:59]
    ds_read_b64_tr_b16 v[70:71], v13 offset:25600
    v_perm_b32 v190, v103, v103, s59
    v_mfma_f32_16x16x32_bf16 v[60:63], v[76:79], v[148:151], v[60:63]
    ds_read_b64_tr_b16 v[72:73], v14 offset:24576
    buffer_load_dwordx4 v[140:143], v6, s[16:19], s50 offen offset:2304 sc1
    s_add_u32 s50, s50, 4096
    v_mfma_f32_16x16x32_bf16 v[52:55], v[76:79], v[144:147], v[52:55]
    ds_read_b64_tr_b16 v[74:75], v14 offset:25600
    s_waitcnt vmcnt(12) lgkmcnt(10)
    v_mfma_f32_16x16x32_bf16 v[32:35], v[80:83], v[152:155], v[32:35]
    ds_read_b64_tr_b16 v[76:77], v15 offset:24576
    v_mfma_f32_16x16x32_bf16 v[40:43], v[80:83], v[156:159], v[40:43]
    ds_read_b64_tr_b16 v[78:79], v15 offset:25600
    v_perm_b32 v191, v103, v103, s97
    v_mfma_f32_16x16x32_bf16 v[44:47], v[84:87], v[156:159], v[44:47]
    ds_read_b64_tr_b16 v[80:81], v12 offset:28672
    buffer_load_dwordx4 v[144:147], v6, s[16:19], s50 offen offset:0 sc1
    v_mfma_f32_16x16x32_bf16 v[36:39], v[84:87], v[152:155], v[36:39]
    ds_read_b64_tr_b16 v[82:83], v12 offset:29696
    v_perm_b32 v192, v104, v104, s59
    s_waitcnt lgkmcnt(10)
    v_mfma_f32_16x16x32_bf16 v[48:51], v[88:91], v[152:155], v[48:51]
    ds_read_b64_tr_b16 v[84:85], v13 offset:28672
    v_mfma_f32_16x16x32_bf16 v[56:59], v[88:91], v[156:159], v[56:59]
    ds_read_b64_tr_b16 v[86:87], v13 offset:29696
    v_perm_b32 v193, v104, v104, s97
    v_mfma_f32_16x16x32_bf16 v[60:63], v[92:95], v[156:159], v[60:63]
    ds_read_b64_tr_b16 v[88:89], v14 offset:28672
    buffer_load_dwordx4 v[148:151], v6, s[16:19], s50 offen offset:256 sc1
    v_mfma_f32_16x16x32_bf16 v[52:55], v[92:95], v[152:155], v[52:55]
    ds_read_b64_tr_b16 v[90:91], v14 offset:29696
    s_waitcnt vmcnt(12) lgkmcnt(10)
    v_mfma_f32_16x16x32_bf16 v[32:35], v[64:67], v[160:163], v[32:35]
    ds_read_b64_tr_b16 v[92:93], v15 offset:28672
    v_mfma_f32_16x16x32_bf16 v[40:43], v[64:67], v[164:167], v[40:43]
    ds_read_b64_tr_b16 v[94:95], v15 offset:29696
    v_perm_b32 v194, v105, v105, s59
    v_mfma_f32_16x16x32_bf16 v[44:47], v[68:71], v[164:167], v[44:47]
    ds_read_b64_tr_b16 v[64:65], v12 offset:32768
    buffer_load_dwordx4 v[152:155], v6, s[16:19], s50 offen offset:2048 sc1
    v_mfma_f32_16x16x32_bf16 v[36:39], v[68:71], v[160:163], v[36:39]
    ds_read_b64_tr_b16 v[66:67], v12 offset:33792
    v_perm_b32 v195, v105, v105, s97
    s_waitcnt lgkmcnt(10)
    v_mfma_f32_16x16x32_bf16 v[48:51], v[72:75], v[160:163], v[48:51]
    ds_read_b64_tr_b16 v[68:69], v13 offset:32768
    v_mfma_f32_16x16x32_bf16 v[56:59], v[72:75], v[164:167], v[56:59]
    ds_read_b64_tr_b16 v[70:71], v13 offset:33792
    v_perm_b32 v196, v106, v106, s59
    v_mfma_f32_16x16x32_bf16 v[60:63], v[76:79], v[164:167], v[60:63]
    ds_read_b64_tr_b16 v[72:73], v14 offset:32768
    buffer_load_dwordx4 v[156:159], v6, s[16:19], s50 offen offset:2304 sc1
    s_add_u32 s50, s50, 4096
    v_mfma_f32_16x16x32_bf16 v[52:55], v[76:79], v[160:163], v[52:55]
    ds_read_b64_tr_b16 v[74:75], v14 offset:33792
    s_waitcnt vmcnt(12) lgkmcnt(10)
    v_mfma_f32_16x16x32_bf16 v[32:35], v[80:83], v[168:171], v[32:35]
    ds_read_b64_tr_b16 v[76:77], v15 offset:32768
    v_mfma_f32_16x16x32_bf16 v[40:43], v[80:83], v[172:175], v[40:43]
    ds_read_b64_tr_b16 v[78:79], v15 offset:33792
    v_perm_b32 v197, v106, v106, s97
    v_mfma_f32_16x16x32_bf16 v[44:47], v[84:87], v[172:175], v[44:47]
    ds_read_b64_tr_b16 v[80:81], v12 offset:36864
    buffer_load_dwordx4 v[160:163], v6, s[16:19], s50 offen offset:0 sc1
    v_mfma_f32_16x16x32_bf16 v[36:39], v[84:87], v[168:171], v[36:39]
    ds_read_b64_tr_b16 v[82:83], v12 offset:37888
    v_perm_b32 v198, v107, v107, s59
    s_waitcnt lgkmcnt(10)
    v_mfma_f32_16x16x32_bf16 v[48:51], v[88:91], v[168:171], v[48:51]
    ds_read_b64_tr_b16 v[84:85], v13 offset:36864
    v_mfma_f32_16x16x32_bf16 v[56:59], v[88:91], v[172:175], v[56:59]
    ds_read_b64_tr_b16 v[86:87], v13 offset:37888
    v_perm_b32 v199, v107, v107, s97
    v_mfma_f32_16x16x32_bf16 v[60:63], v[92:95], v[172:175], v[60:63]
    ds_read_b64_tr_b16 v[88:89], v14 offset:36864
    buffer_load_dwordx4 v[164:167], v6, s[16:19], s50 offen offset:256 sc1
    v_mfma_f32_16x16x32_bf16 v[52:55], v[92:95], v[168:171], v[52:55]
    ds_read_b64_tr_b16 v[90:91], v14 offset:37888
    s_waitcnt vmcnt(12) lgkmcnt(10)
    v_mfma_f32_16x16x32_bf16 v[32:35], v[64:67], v[112:115], v[32:35]
    ds_read_b64_tr_b16 v[92:93], v15 offset:36864
    v_mfma_f32_16x16x32_bf16 v[40:43], v[64:67], v[116:119], v[40:43]
    ds_read_b64_tr_b16 v[94:95], v15 offset:37888
    v_perm_b32 v200, v108, v108, s59
    v_mfma_f32_16x16x32_bf16 v[44:47], v[68:71], v[116:119], v[44:47]
    ds_read_b64_tr_b16 v[64:65], v12 offset:40960
    buffer_load_dwordx4 v[168:171], v6, s[16:19], s50 offen offset:2048 sc1
    v_mfma_f32_16x16x32_bf16 v[36:39], v[68:71], v[112:115], v[36:39]
    ds_read_b64_tr_b16 v[66:67], v12 offset:41984
    v_perm_b32 v201, v108, v108, s97
    s_waitcnt lgkmcnt(10)
    v_mfma_f32_16x16x32_bf16 v[48:51], v[72:75], v[112:115], v[48:51]
    ds_read_b64_tr_b16 v[68:69], v13 offset:40960
    v_mfma_f32_16x16x32_bf16 v[56:59], v[72:75], v[116:119], v[56:59]
    ds_read_b64_tr_b16 v[70:71], v13 offset:41984
    v_perm_b32 v202, v109, v109, s59
    v_mfma_f32_16x16x32_bf16 v[60:63], v[76:79], v[116:119], v[60:63]
    ds_read_b64_tr_b16 v[72:73], v14 offset:40960
    buffer_load_dwordx4 v[172:175], v6, s[16:19], s50 offen offset:2304 sc1
    s_add_u32 s50, s50, 4096
    v_mfma_f32_16x16x32_bf16 v[52:55], v[76:79], v[112:115], v[52:55]
    ds_read_b64_tr_b16 v[74:75], v14 offset:41984
    s_waitcnt vmcnt(12) lgkmcnt(10)
    v_mfma_f32_16x16x32_bf16 v[32:35], v[80:83], v[120:123], v[32:35]
    ds_read_b64_tr_b16 v[76:77], v15 offset:40960
    v_mfma_f32_16x16x32_bf16 v[40:43], v[80:83], v[124:127], v[40:43]
    ds_read_b64_tr_b16 v[78:79], v15 offset:41984
    v_perm_b32 v203, v109, v109, s97
    v_mfma_f32_16x16x32_bf16 v[44:47], v[84:87], v[124:127], v[44:47]
    ds_read_b64_tr_b16 v[80:81], v12 offset:45056
    s_branch wp_6_t
wp_6:
    ds_read_b32 v29, v28
    s_waitcnt lgkmcnt(0)
    v_readfirstlane_b32 s60, v29
    s_lshr_b32 s51, s60, 2
    s_and_b32 s51, s51, s60
    s_and_b32 s51, s51, 3
wp_6_t:
    s_cmp_eq_u32 s51, 3
    s_cbranch_scc0 wp_6
    s_lshl_b32 s50, s52, 15
    s_xor_b32 s50, s50, 32768
    buffer_load_dwordx4 v[112:115], v6, s[16:19], s50 offen offset:0 sc1
    v_mfma_f32_16x16x32_bf16 v[36:39], v[84:87], v[120:123], v[36:39]
    ds_read_b64_tr_b16 v[82:83], v12 offset:46080
    v_perm_b32 v204, v110, v110, s59
    s_waitcnt lgkmcnt(10)
    v_mfma_f32_16x16x32_bf16 v[48:51], v[88:91], v[120:123], v[48:51]
    ds_read_b64_tr_b16 v[84:85], v13 offset:45056
    v_mfma_f32_16x16x32_bf16 v[56:59], v[88:91], v[124:127], v[56:59]
    ds_read_b64_tr_b16 v[86:87], v13 offset:46080
    v_perm_b32 v205, v110, v110, s97
    v_mfma_f32_16x16x32_bf16 v[60:63], v[92:95], v[124:127], v[60:63]
    ds_read_b64_tr_b16 v[88:89], v14 offset:45056
    buffer_load_dwordx4 v[116:119], v6, s[16:19], s50 offen offset:256 sc1
    v_mfma_f32_16x16x32_bf16 v[52:55], v[92:95], v[120:123], v[52:55]
    ds_read_b64_tr_b16 v[90:91], v14 offset:46080
    s_waitcnt vmcnt(12) lgkmcnt(10)
    v_mfma_f32_16x16x32_bf16 v[32:35], v[64:67], v[128:131], v[32:35]
    ds_read_b64_tr_b16 v[92:93], v15 offset:45056
    v_mfma_f32_16x16x32_bf16 v[40:43], v[64:67], v[132:135], v[40:43]
    ds_read_b64_tr_b16 v[94:95], v15 offset:46080
    v_perm_b32 v206, v111, v111, s59
    v_mfma_f32_16x16x32_bf16 v[44:47], v[68:71], v[132:135], v[44:47]
    ds_read_b64_tr_b16 v[64:65], v12 offset:49152
    buffer_load_dwordx4 v[120:123], v6, s[16:19], s50 offen offset:2048 sc1
    v_mfma_f32_16x16x32_bf16 v[36:39], v[68:71], v[128:131], v[36:39]
    ds_read_b64_tr_b16 v[66:67], v12 offset:50176
    v_perm_b32 v207, v111, v111, s97
    s_waitcnt lgkmcnt(10)
    v_mfma_f32_16x16x32_bf16 v[48:51], v[72:75], v[128:131], v[48:51]
    ds_read_b64_tr_b16 v[68:69], v13 offset:49152
    v_mfma_f32_16x16x32_bf16 v[56:59], v[72:75], v[132:135], v[56:59]
    ds_read_b64_tr_b16 v[70:71], v13 offset:50176
    v_mul_u32_u24 v8, 144, v4
    v_mfma_f32_16x16x32_bf16 v[60:63], v[76:79], v[132:135], v[60:63]
    ds_read_b64_tr_b16 v[72:73], v14 offset:49152
    buffer_load_dwordx4 v[124:127], v6, s[16:19], s50 offen offset:2304 sc1
    s_add_u32 s50, s50, 4096
    v_mfma_f32_16x16x32_bf16 v[52:55], v[76:79], v[128:131], v[52:55]
    ds_read_b64_tr_b16 v[74:75], v14 offset:50176
    s_waitcnt vmcnt(12) lgkmcnt(10)
    v_mfma_f32_16x16x32_bf16 v[32:35], v[80:83], v[136:139], v[32:35]
    ds_read_b64_tr_b16 v[76:77], v15 offset:49152
    v_mfma_f32_16x16x32_bf16 v[40:43], v[80:83], v[140:143], v[40:43]
    ds_read_b64_tr_b16 v[78:79], v15 offset:50176
    v_lshrrev_b32 v11, 4, v1
    v_mfma_f32_16x16x32_bf16 v[44:47], v[84:87], v[140:143], v[44:47]
    ds_read_b64_tr_b16 v[80:81], v12 offset:53248
    buffer_load_dwordx4 v[128:131], v6, s[16:19], s50 offen offset:0 sc1
    v_mfma_f32_16x16x32_bf16 v[36:39], v[84:87], v[136:139], v[36:39]
    ds_read_b64_tr_b16 v[82:83], v12 offset:54272
    v_lshl_add_u32 v8, v11, 3, v8
    s_waitcnt lgkmcnt(10)
    v_mfma_f32_16x16x32_bf16 v[48:51], v[88:91], v[136:139], v[48:51]
    ds_read_b64_tr_b16 v[84:85], v13 offset:53248
    v_mfma_f32_16x16x32_bf16 v[56:59], v[88:91], v[140:143], v[56:59]
    ds_read_b64_tr_b16 v[86:87], v13 offset:54272
    v_mul_u32_u24 v7, 4608, v2
    v_mfma_f32_16x16x32_bf16 v[60:63], v[92:95], v[140:143], v[60:63]
    ds_read_b64_tr_b16 v[88:89], v14 offset:53248
    buffer_load_dwordx4 v[132:135], v6, s[16:19], s50 offen offset:256 sc1
    v_mfma_f32_16x16x32_bf16 v[52:55], v[92:95], v[136:139], v[52:55]
    ds_read_b64_tr_b16 v[90:91], v14 offset:54272
    s_waitcnt vmcnt(12) lgkmcnt(10)
    v_mfma_f32_16x16x32_bf16 v[32:35], v[64:67], v[144:147], v[32:35]
    ds_read_b64_tr_b16 v[92:93], v15 offset:53248
    v_mfma_f32_16x16x32_bf16 v[40:43], v[64:67], v[148:151], v[40:43]
    ds_read_b64_tr_b16 v[94:95], v15 offset:54272
    v_add_u32 v7, 131072, v7
    v_mfma_f32_16x16x32_bf16 v[44:47], v[68:71], v[148:151], v[44:47]
    ds_read_b64_tr_b16 v[64:65], v12 offset:57344
    buffer_load_dwordx4 v[136:139], v6, s[16:19], s50 offen offset:2048 sc1
    v_mfma_f32_16x16x32_bf16 v[36:39], v[68:71], v[144:147], v[36:39]
    ds_read_b64_tr_b16 v[66:67], v12 offset:58368
    v_add_u32 v8, v8, v7
    s_waitcnt lgkmcnt(10)
    v_mfma_f32_16x16x32_bf16 v[48:51], v[72:75], v[144:147], v[48:51]
    ds_read_b64_tr_b16 v[68:69], v13 offset:57344
    v_mfma_f32_16x16x32_bf16 v[56:59], v[72:75], v[148:151], v[56:59]
    ds_read_b64_tr_b16 v[70:71], v13 offset:58368
    v_lshrrev_b32 v10, 3, v1
    v_mfma_f32_16x16x32_bf16 v[60:63], v[76:79], v[148:151], v[60:63]
    ds_read_b64_tr_b16 v[72:73], v14 offset:57344
    buffer_load_dwordx4 v[140:143], v6, s[16:19], s50 offen offset:2304 sc1
    s_add_u32 s50, s50, 4096
    v_mfma_f32_16x16x32_bf16 v[52:55], v[76:79], v[144:147], v[52:55]
    ds_read_b64_tr_b16 v[74:75], v14 offset:58368
    s_waitcnt vmcnt(12) lgkmcnt(10)
    v_mfma_f32_16x16x32_bf16 v[32:35], v[80:83], v[152:155], v[32:35]
    ds_read_b64_tr_b16 v[76:77], v15 offset:57344
    v_mfma_f32_16x16x32_bf16 v[40:43], v[80:83], v[156:159], v[40:43]
    ds_read_b64_tr_b16 v[78:79], v15 offset:58368
    v_and_b32 v11, 7, v1
    v_mfma_f32_16x16x32_bf16 v[44:47], v[84:87], v[156:159], v[44:47]
    ds_read_b64_tr_b16 v[80:81], v12 offset:61440
    buffer_load_dwordx4 v[144:147], v6, s[16:19], s50 offen offset:0 sc1
    v_mfma_f32_16x16x32_bf16 v[36:39], v[84:87], v[152:155], v[36:39]
    ds_read_b64_tr_b16 v[82:83], v12 offset:62464
    v_mul_u32_u24 v9, 144, v10
    s_waitcnt lgkmcnt(10)
    v_mfma_f32_16x16x32_bf16 v[48:51], v[88:91], v[152:155], v[48:51]
    ds_read_b64_tr_b16 v[84:85], v13 offset:61440
    v_mfma_f32_16x16x32_bf16 v[56:59], v[88:91], v[156:159], v[56:59]
    ds_read_b64_tr_b16 v[86:87], v13 offset:62464
    v_lshl_add_u32 v9, v11, 4, v9
    v_mfma_f32_16x16x32_bf16 v[60:63], v[92:95], v[156:159], v[60:63]
    ds_read_b64_tr_b16 v[88:89], v14 offset:61440
    buffer_load_dwordx4 v[148:151], v6, s[16:19], s50 offen offset:256 sc1
    v_mfma_f32_16x16x32_bf16 v[52:55], v[92:95], v[152:155], v[52:55]
    ds_read_b64_tr_b16 v[90:91], v14 offset:62464
    s_waitcnt vmcnt(12) lgkmcnt(10)
    v_mfma_f32_16x16x32_bf16 v[32:35], v[64:67], v[160:163], v[32:35]
    ds_read_b64_tr_b16 v[92:93], v15 offset:61440
    v_mfma_f32_16x16x32_bf16 v[40:43], v[64:67], v[164:167], v[40:43]
    ds_read_b64_tr_b16 v[94:95], v15 offset:62464
    v_add_u32 v9, v9, v7
    v_mfma_f32_16x16x32_bf16 v[44:47], v[68:71], v[164:167], v[44:47]
    v_xor_b32 v12, 0x10000, v12
    ds_read_b64_tr_b16 v[64:65], v12 offset:0
    buffer_load_dwordx4 v[152:155], v6, s[16:19], s50 offen offset:2048 sc1
    v_mfma_f32_16x16x32_bf16 v[36:39], v[68:71], v[160:163], v[36:39]
    ds_read_b64_tr_b16 v[66:67], v12 offset:1024
    v_lshlrev_b32 v10, 11, v10
    s_waitcnt lgkmcnt(10)
    v_mfma_f32_16x16x32_bf16 v[48:51], v[72:75], v[160:163], v[48:51]
    v_xor_b32 v13, 0x10000, v13
    ds_read_b64_tr_b16 v[68:69], v13 offset:0
    v_mfma_f32_16x16x32_bf16 v[56:59], v[72:75], v[164:167], v[56:59]
    ds_read_b64_tr_b16 v[70:71], v13 offset:1024
    v_lshl_add_u32 v10, v11, 4, v10
    v_mfma_f32_16x16x32_bf16 v[60:63], v[76:79], v[164:167], v[60:63]
    v_xor_b32 v14, 0x10000, v14
    ds_read_b64_tr_b16 v[72:73], v14 offset:0
    buffer_load_dwordx4 v[156:159], v6, s[16:19], s50 offen offset:2304 sc1
    s_add_u32 s50, s50, 4096
    v_mfma_f32_16x16x32_bf16 v[52:55], v[76:79], v[160:163], v[52:55]
    ds_read_b64_tr_b16 v[74:75], v14 offset:1024
    s_waitcnt vmcnt(12) lgkmcnt(10)
    v_mfma_f32_16x16x32_bf16 v[32:35], v[80:83], v[168:171], v[32:35]
    v_xor_b32 v15, 0x10000, v15
    ds_read_b64_tr_b16 v[76:77], v15 offset:0
    v_mfma_f32_16x16x32_bf16 v[40:43], v[80:83], v[172:175], v[40:43]
    ds_read_b64_tr_b16 v[78:79], v15 offset:1024
    v_mfma_f32_16x16x32_bf16 v[44:47], v[84:87], v[172:175], v[44:47]
    ds_read_b64_tr_b16 v[80:81], v12 offset:4096
    buffer_load_dwordx4 v[160:163], v6, s[16:19], s50 offen offset:0 sc1
    v_mfma_f32_16x16x32_bf16 v[36:39], v[84:87], v[168:171], v[36:39]
    ds_read_b64_tr_b16 v[82:83], v12 offset:5120
    s_waitcnt lgkmcnt(10)
    v_mfma_f32_16x16x32_bf16 v[48:51], v[88:91], v[168:171], v[48:51]
    ds_read_b64_tr_b16 v[84:85], v13 offset:4096
    v_mfma_f32_16x16x32_bf16 v[56:59], v[88:91], v[172:175], v[56:59]
    ds_read_b64_tr_b16 v[86:87], v13 offset:5120
    v_mfma_f32_16x16x32_bf16 v[60:63], v[92:95], v[172:175], v[60:63]
    ds_read_b64_tr_b16 v[88:89], v14 offset:4096
    buffer_load_dwordx4 v[164:167], v6, s[16:19], s50 offen offset:256 sc1
    v_mfma_f32_16x16x32_bf16 v[52:55], v[92:95], v[168:171], v[52:55]
    ds_read_b64_tr_b16 v[90:91], v14 offset:5120
    s_waitcnt vmcnt(12) lgkmcnt(10)
    v_mfma_f32_16x16x32_bf16 v[176:179], v[64:67], v[112:115], v[176:179]
    ds_read_b64_tr_b16 v[92:93], v15 offset:4096
    v_mfma_f32_16x16x32_bf16 v[184:187], v[64:67], v[116:119], v[184:187]
    ds_read_b64_tr_b16 v[94:95], v15 offset:5120
    v_mfma_f32_16x16x32_bf16 v[188:191], v[68:71], v[116:119], v[188:191]
    ds_read_b64_tr_b16 v[64:65], v12 offset:8192
    buffer_load_dwordx4 v[168:171], v6, s[16:19], s50 offen offset:2048 sc1
    v_mfma_f32_16x16x32_bf16 v[180:183], v[68:71], v[112:115], v[180:183]
    ds_read_b64_tr_b16 v[66:67], v12 offset:9216
    s_waitcnt lgkmcnt(10)
    v_mfma_f32_16x16x32_bf16 v[192:195], v[72:75], v[112:115], v[192:195]
    ds_read_b64_tr_b16 v[68:69], v13 offset:8192
    v_mfma_f32_16x16x32_bf16 v[200:203], v[72:75], v[116:119], v[200:203]
    ds_read_b64_tr_b16 v[70:71], v13 offset:9216
    v_mfma_f32_16x16x32_bf16 v[204:207], v[76:79], v[116:119], v[204:207]
    ds_read_b64_tr_b16 v[72:73], v14 offset:8192
    buffer_load_dwordx4 v[172:175], v6, s[16:19], s50 offen offset:2304 sc1
    s_add_u32 s50, s50, 4096
    v_mfma_f32_16x16x32_bf16 v[196:199], v[76:79], v[112:115], v[196:199]
    ds_read_b64_tr_b16 v[74:75], v14 offset:9216
    s_waitcnt vmcnt(12) lgkmcnt(10)
    v_mfma_f32_16x16x32_bf16 v[176:179], v[80:83], v[120:123], v[176:179]
    ds_read_b64_tr_b16 v[76:77], v15 offset:8192
    v_mfma_f32_16x16x32_bf16 v[184:187], v[80:83], v[124:127], v[184:187]
    ds_read_b64_tr_b16 v[78:79], v15 offset:9216
    v_mfma_f32_16x16x32_bf16 v[188:191], v[84:87], v[124:127], v[188:191]
    ds_read_b64_tr_b16 v[80:81], v12 offset:12288
    buffer_load_dwordx4 v[112:115], v6, s[16:19], s50 offen offset:0 sc1
    v_mfma_f32_16x16x32_bf16 v[180:183], v[84:87], v[120:123], v[180:183]
    ds_read_b64_tr_b16 v[82:83], v12 offset:13312
    s_waitcnt lgkmcnt(10)
    v_mfma_f32_16x16x32_bf16 v[192:195], v[88:91], v[120:123], v[192:195]
    ds_read_b64_tr_b16 v[84:85], v13 offset:12288
    v_mfma_f32_16x16x32_bf16 v[200:203], v[88:91], v[124:127], v[200:203]
    ds_read_b64_tr_b16 v[86:87], v13 offset:13312
    v_mfma_f32_16x16x32_bf16 v[204:207], v[92:95], v[124:127], v[204:207]
    ds_read_b64_tr_b16 v[88:89], v14 offset:12288
    buffer_load_dwordx4 v[116:119], v6, s[16:19], s50 offen offset:256 sc1
    v_mfma_f32_16x16x32_bf16 v[196:199], v[92:95], v[120:123], v[196:199]
    ds_read_b64_tr_b16 v[90:91], v14 offset:13312
    s_waitcnt vmcnt(12) lgkmcnt(10)
    v_mfma_f32_16x16x32_bf16 v[176:179], v[64:67], v[128:131], v[176:179]
    ds_read_b64_tr_b16 v[92:93], v15 offset:12288
    v_mfma_f32_16x16x32_bf16 v[184:187], v[64:67], v[132:135], v[184:187]
    ds_read_b64_tr_b16 v[94:95], v15 offset:13312
    v_mfma_f32_16x16x32_bf16 v[188:191], v[68:71], v[132:135], v[188:191]
    ds_read_b64_tr_b16 v[64:65], v12 offset:16384
    buffer_load_dwordx4 v[120:123], v6, s[16:19], s50 offen offset:2048 sc1
    v_mfma_f32_16x16x32_bf16 v[180:183], v[68:71], v[128:131], v[180:183]
    ds_read_b64_tr_b16 v[66:67], v12 offset:17408
    s_waitcnt lgkmcnt(10)
    v_mfma_f32_16x16x32_bf16 v[192:195], v[72:75], v[128:131], v[192:195]
    ds_read_b64_tr_b16 v[68:69], v13 offset:16384
    v_mfma_f32_16x16x32_bf16 v[200:203], v[72:75], v[132:135], v[200:203]
    ds_read_b64_tr_b16 v[70:71], v13 offset:17408
    v_mfma_f32_16x16x32_bf16 v[204:207], v[76:79], v[132:135], v[204:207]
    ds_read_b64_tr_b16 v[72:73], v14 offset:16384
    buffer_load_dwordx4 v[124:127], v6, s[16:19], s50 offen offset:2304 sc1
    s_add_u32 s50, s50, 4096
    v_mfma_f32_16x16x32_bf16 v[196:199], v[76:79], v[128:131], v[196:199]
    ds_read_b64_tr_b16 v[74:75], v14 offset:17408
    s_waitcnt vmcnt(12) lgkmcnt(10)
    v_mfma_f32_16x16x32_bf16 v[176:179], v[80:83], v[136:139], v[176:179]
    ds_read_b64_tr_b16 v[76:77], v15 offset:16384
    v_mfma_f32_16x16x32_bf16 v[184:187], v[80:83], v[140:143], v[184:187]
    ds_read_b64_tr_b16 v[78:79], v15 offset:17408
    v_mfma_f32_16x16x32_bf16 v[188:191], v[84:87], v[140:143], v[188:191]
    ds_read_b64_tr_b16 v[80:81], v12 offset:20480
    buffer_load_dwordx4 v[128:131], v6, s[16:19], s50 offen offset:0 sc1
    v_mfma_f32_16x16x32_bf16 v[180:183], v[84:87], v[136:139], v[180:183]
    ds_read_b64_tr_b16 v[82:83], v12 offset:21504
    s_waitcnt lgkmcnt(10)
    v_mfma_f32_16x16x32_bf16 v[192:195], v[88:91], v[136:139], v[192:195]
    ds_read_b64_tr_b16 v[84:85], v13 offset:20480
    v_mfma_f32_16x16x32_bf16 v[200:203], v[88:91], v[140:143], v[200:203]
    ds_read_b64_tr_b16 v[86:87], v13 offset:21504
    v_mfma_f32_16x16x32_bf16 v[204:207], v[92:95], v[140:143], v[204:207]
    ds_read_b64_tr_b16 v[88:89], v14 offset:20480
    buffer_load_dwordx4 v[132:135], v6, s[16:19], s50 offen offset:256 sc1
    v_mfma_f32_16x16x32_bf16 v[196:199], v[92:95], v[136:139], v[196:199]
    ds_read_b64_tr_b16 v[90:91], v14 offset:21504
    s_waitcnt vmcnt(12) lgkmcnt(10)
    v_mfma_f32_16x16x32_bf16 v[176:179], v[64:67], v[144:147], v[176:179]
    ds_read_b64_tr_b16 v[92:93], v15 offset:20480
    v_mfma_f32_16x16x32_bf16 v[184:187], v[64:67], v[148:151], v[184:187]
    ds_read_b64_tr_b16 v[94:95], v15 offset:21504
    v_mfma_f32_16x16x32_bf16 v[188:191], v[68:71], v[148:151], v[188:191]
    ds_read_b64_tr_b16 v[64:65], v12 offset:24576
    buffer_load_dwordx4 v[136:139], v6, s[16:19], s50 offen offset:2048 sc1
    v_mfma_f32_16x16x32_bf16 v[180:183], v[68:71], v[144:147], v[180:183]
    ds_read_b64_tr_b16 v[66:67], v12 offset:25600
    s_waitcnt lgkmcnt(10)
    v_mfma_f32_16x16x32_bf16 v[192:195], v[72:75], v[144:147], v[192:195]
    ds_read_b64_tr_b16 v[68:69], v13 offset:24576
    v_mfma_f32_16x16x32_bf16 v[200:203], v[72:75], v[148:151], v[200:203]
    ds_read_b64_tr_b16 v[70:71], v13 offset:25600
    v_mfma_f32_16x16x32_bf16 v[204:207], v[76:79], v[148:151], v[204:207]
    ds_read_b64_tr_b16 v[72:73], v14 offset:24576
    buffer_load_dwordx4 v[140:143], v6, s[16:19], s50 offen offset:2304 sc1
    s_add_u32 s50, s50, 4096
    v_mfma_f32_16x16x32_bf16 v[196:199], v[76:79], v[144:147], v[196:199]
    ds_read_b64_tr_b16 v[74:75], v14 offset:25600
    s_waitcnt vmcnt(12) lgkmcnt(10)
    v_mfma_f32_16x16x32_bf16 v[176:179], v[80:83], v[152:155], v[176:179]
    ds_read_b64_tr_b16 v[76:77], v15 offset:24576
    v_mfma_f32_16x16x32_bf16 v[184:187], v[80:83], v[156:159], v[184:187]
    ds_read_b64_tr_b16 v[78:79], v15 offset:25600
    v_mfma_f32_16x16x32_bf16 v[188:191], v[84:87], v[156:159], v[188:191]
    ds_read_b64_tr_b16 v[80:81], v12 offset:28672
    buffer_load_dwordx4 v[144:147], v6, s[16:19], s50 offen offset:0 sc1
    v_mfma_f32_16x16x32_bf16 v[180:183], v[84:87], v[152:155], v[180:183]
    ds_read_b64_tr_b16 v[82:83], v12 offset:29696
    s_waitcnt lgkmcnt(10)
    v_mfma_f32_16x16x32_bf16 v[192:195], v[88:91], v[152:155], v[192:195]
    ds_read_b64_tr_b16 v[84:85], v13 offset:28672
    v_mfma_f32_16x16x32_bf16 v[200:203], v[88:91], v[156:159], v[200:203]
    ds_read_b64_tr_b16 v[86:87], v13 offset:29696
    v_mfma_f32_16x16x32_bf16 v[204:207], v[92:95], v[156:159], v[204:207]
    ds_read_b64_tr_b16 v[88:89], v14 offset:28672
    buffer_load_dwordx4 v[148:151], v6, s[16:19], s50 offen offset:256 sc1
    v_mfma_f32_16x16x32_bf16 v[196:199], v[92:95], v[152:155], v[196:199]
    ds_read_b64_tr_b16 v[90:91], v14 offset:29696
    s_waitcnt vmcnt(12) lgkmcnt(10)
    v_mfma_f32_16x16x32_bf16 v[176:179], v[64:67], v[160:163], v[176:179]
    ds_read_b64_tr_b16 v[92:93], v15 offset:28672
    v_mfma_f32_16x16x32_bf16 v[184:187], v[64:67], v[164:167], v[184:187]
    ds_read_b64_tr_b16 v[94:95], v15 offset:29696
    v_mfma_f32_16x16x32_bf16 v[188:191], v[68:71], v[164:167], v[188:191]
    ds_read_b64_tr_b16 v[64:65], v12 offset:32768
    buffer_load_dwordx4 v[152:155], v6, s[16:19], s50 offen offset:2048 sc1
    v_mfma_f32_16x16x32_bf16 v[180:183], v[68:71], v[160:163], v[180:183]
    ds_read_b64_tr_b16 v[66:67], v12 offset:33792
    s_waitcnt lgkmcnt(10)
    v_mfma_f32_16x16x32_bf16 v[192:195], v[72:75], v[160:163], v[192:195]
    ds_read_b64_tr_b16 v[68:69], v13 offset:32768
    v_mfma_f32_16x16x32_bf16 v[200:203], v[72:75], v[164:167], v[200:203]
    ds_read_b64_tr_b16 v[70:71], v13 offset:33792
    v_mfma_f32_16x16x32_bf16 v[204:207], v[76:79], v[164:167], v[204:207]
    ds_read_b64_tr_b16 v[72:73], v14 offset:32768
    buffer_load_dwordx4 v[156:159], v6, s[16:19], s50 offen offset:2304 sc1
    s_add_u32 s50, s50, 4096
    v_mfma_f32_16x16x32_bf16 v[196:199], v[76:79], v[160:163], v[196:199]
    ds_read_b64_tr_b16 v[74:75], v14 offset:33792
    s_waitcnt vmcnt(12) lgkmcnt(10)
    v_mfma_f32_16x16x32_bf16 v[176:179], v[80:83], v[168:171], v[176:179]
    ds_read_b64_tr_b16 v[76:77], v15 offset:32768
    v_mfma_f32_16x16x32_bf16 v[184:187], v[80:83], v[172:175], v[184:187]
    ds_read_b64_tr_b16 v[78:79], v15 offset:33792
    v_mfma_f32_16x16x32_bf16 v[188:191], v[84:87], v[172:175], v[188:191]
    ds_read_b64_tr_b16 v[80:81], v12 offset:36864
    buffer_load_dwordx4 v[160:163], v6, s[16:19], s50 offen offset:0 sc1
    v_mfma_f32_16x16x32_bf16 v[180:183], v[84:87], v[168:171], v[180:183]
    ds_read_b64_tr_b16 v[82:83], v12 offset:37888
    s_waitcnt lgkmcnt(10)
    v_mfma_f32_16x16x32_bf16 v[192:195], v[88:91], v[168:171], v[192:195]
    ds_read_b64_tr_b16 v[84:85], v13 offset:36864
    v_mfma_f32_16x16x32_bf16 v[200:203], v[88:91], v[172:175], v[200:203]
    ds_read_b64_tr_b16 v[86:87], v13 offset:37888
    v_mfma_f32_16x16x32_bf16 v[204:207], v[92:95], v[172:175], v[204:207]
    ds_read_b64_tr_b16 v[88:89], v14 offset:36864
    buffer_load_dwordx4 v[164:167], v6, s[16:19], s50 offen offset:256 sc1
    v_mfma_f32_16x16x32_bf16 v[196:199], v[92:95], v[168:171], v[196:199]
    ds_read_b64_tr_b16 v[90:91], v14 offset:37888
    s_waitcnt vmcnt(12) lgkmcnt(10)
    v_mfma_f32_16x16x32_bf16 v[176:179], v[64:67], v[112:115], v[176:179]
    ds_read_b64_tr_b16 v[92:93], v15 offset:36864
    v_mfma_f32_16x16x32_bf16 v[184:187], v[64:67], v[116:119], v[184:187]
    ds_read_b64_tr_b16 v[94:95], v15 offset:37888
    v_mfma_f32_16x16x32_bf16 v[188:191], v[68:71], v[116:119], v[188:191]
    ds_read_b64_tr_b16 v[64:65], v12 offset:40960
    buffer_load_dwordx4 v[168:171], v6, s[16:19], s50 offen offset:2048 sc1
    v_mfma_f32_16x16x32_bf16 v[180:183], v[68:71], v[112:115], v[180:183]
    ds_read_b64_tr_b16 v[66:67], v12 offset:41984
    s_waitcnt lgkmcnt(10)
    v_mfma_f32_16x16x32_bf16 v[192:195], v[72:75], v[112:115], v[192:195]
    ds_read_b64_tr_b16 v[68:69], v13 offset:40960
    v_mfma_f32_16x16x32_bf16 v[200:203], v[72:75], v[116:119], v[200:203]
    ds_read_b64_tr_b16 v[70:71], v13 offset:41984
    v_mfma_f32_16x16x32_bf16 v[204:207], v[76:79], v[116:119], v[204:207]
    ds_read_b64_tr_b16 v[72:73], v14 offset:40960
    buffer_load_dwordx4 v[172:175], v6, s[16:19], s50 offen offset:2304 sc1
    s_add_u32 s50, s50, 4096
    v_mfma_f32_16x16x32_bf16 v[196:199], v[76:79], v[112:115], v[196:199]
    ds_read_b64_tr_b16 v[74:75], v14 offset:41984
    s_waitcnt vmcnt(12) lgkmcnt(10)
    v_mfma_f32_16x16x32_bf16 v[176:179], v[80:83], v[120:123], v[176:179]
    ds_read_b64_tr_b16 v[76:77], v15 offset:40960
    v_mfma_f32_16x16x32_bf16 v[184:187], v[80:83], v[124:127], v[184:187]
    ds_read_b64_tr_b16 v[78:79], v15 offset:41984
    v_mfma_f32_16x16x32_bf16 v[188:191], v[84:87], v[124:127], v[188:191]
    ds_read_b64_tr_b16 v[80:81], v12 offset:45056
    v_mfma_f32_16x16x32_bf16 v[180:183], v[84:87], v[120:123], v[180:183]
    ds_read_b64_tr_b16 v[82:83], v12 offset:46080
    s_waitcnt lgkmcnt(10)
    v_mfma_f32_16x16x32_bf16 v[192:195], v[88:91], v[120:123], v[192:195]
    ds_read_b64_tr_b16 v[84:85], v13 offset:45056
    v_mfma_f32_16x16x32_bf16 v[200:203], v[88:91], v[124:127], v[200:203]
    ds_read_b64_tr_b16 v[86:87], v13 offset:46080
    v_mfma_f32_16x16x32_bf16 v[204:207], v[92:95], v[124:127], v[204:207]
    ds_read_b64_tr_b16 v[88:89], v14 offset:45056
    v_mfma_f32_16x16x32_bf16 v[196:199], v[92:95], v[120:123], v[196:199]
    ds_read_b64_tr_b16 v[90:91], v14 offset:46080
    s_waitcnt vmcnt(10) lgkmcnt(10)
    v_mfma_f32_16x16x32_bf16 v[176:179], v[64:67], v[128:131], v[176:179]
    ds_read_b64_tr_b16 v[92:93], v15 offset:45056
    v_mfma_f32_16x16x32_bf16 v[184:187], v[64:67], v[132:135], v[184:187]
    ds_read_b64_tr_b16 v[94:95], v15 offset:46080
    v_mfma_f32_16x16x32_bf16 v[188:191], v[68:71], v[132:135], v[188:191]
    ds_read_b64_tr_b16 v[64:65], v12 offset:49152
    v_mfma_f32_16x16x32_bf16 v[180:183], v[68:71], v[128:131], v[180:183]
    ds_read_b64_tr_b16 v[66:67], v12 offset:50176
    s_waitcnt lgkmcnt(10)
    v_mfma_f32_16x16x32_bf16 v[192:195], v[72:75], v[128:131], v[192:195]
    ds_read_b64_tr_b16 v[68:69], v13 offset:49152
    v_mfma_f32_16x16x32_bf16 v[200:203], v[72:75], v[132:135], v[200:203]
    ds_read_b64_tr_b16 v[70:71], v13 offset:50176
    v_mfma_f32_16x16x32_bf16 v[204:207], v[76:79], v[132:135], v[204:207]
    ds_read_b64_tr_b16 v[72:73], v14 offset:49152
    v_mfma_f32_16x16x32_bf16 v[196:199], v[76:79], v[128:131], v[196:199]
    ds_read_b64_tr_b16 v[74:75], v14 offset:50176
    s_waitcnt vmcnt(8) lgkmcnt(10)
    v_mfma_f32_16x16x32_bf16 v[176:179], v[80:83], v[136:139], v[176:179]
    ds_read_b64_tr_b16 v[76:77], v15 offset:49152
    v_mfma_f32_16x16x32_bf16 v[184:187], v[80:83], v[140:143], v[184:187]
    ds_read_b64_tr_b16 v[78:79], v15 offset:50176
    v_mfma_f32_16x16x32_bf16 v[188:191], v[84:87], v[140:143], v[188:191]
    ds_read_b64_tr_b16 v[80:81], v12 offset:53248
    v_mfma_f32_16x16x32_bf16 v[180:183], v[84:87], v[136:139], v[180:183]
    ds_read_b64_tr_b16 v[82:83], v12 offset:54272
    s_waitcnt lgkmcnt(10)
    v_mfma_f32_16x16x32_bf16 v[192:195], v[88:91], v[136:139], v[192:195]
    ds_read_b64_tr_b16 v[84:85], v13 offset:53248
    v_mfma_f32_16x16x32_bf16 v[200:203], v[88:91], v[140:143], v[200:203]
    ds_read_b64_tr_b16 v[86:87], v13 offset:54272
    v_mfma_f32_16x16x32_bf16 v[204:207], v[92:95], v[140:143], v[204:207]
    ds_read_b64_tr_b16 v[88:89], v14 offset:53248
    v_mfma_f32_16x16x32_bf16 v[196:199], v[92:95], v[136:139], v[196:199]
    ds_read_b64_tr_b16 v[90:91], v14 offset:54272
    s_waitcnt vmcnt(6) lgkmcnt(10)
    v_mfma_f32_16x16x32_bf16 v[176:179], v[64:67], v[144:147], v[176:179]
    ds_read_b64_tr_b16 v[92:93], v15 offset:53248
    v_mfma_f32_16x16x32_bf16 v[184:187], v[64:67], v[148:151], v[184:187]
    ds_read_b64_tr_b16 v[94:95], v15 offset:54272
    v_mfma_f32_16x16x32_bf16 v[188:191], v[68:71], v[148:151], v[188:191]
    ds_read_b64_tr_b16 v[64:65], v12 offset:57344
    v_mfma_f32_16x16x32_bf16 v[180:183], v[68:71], v[144:147], v[180:183]
    ds_read_b64_tr_b16 v[66:67], v12 offset:58368
    s_waitcnt lgkmcnt(10)
    v_mfma_f32_16x16x32_bf16 v[192:195], v[72:75], v[144:147], v[192:195]
    ds_read_b64_tr_b16 v[68:69], v13 offset:57344
    v_mfma_f32_16x16x32_bf16 v[200:203], v[72:75], v[148:151], v[200:203]
    ds_read_b64_tr_b16 v[70:71], v13 offset:58368
    v_mfma_f32_16x16x32_bf16 v[204:207], v[76:79], v[148:151], v[204:207]
    ds_read_b64_tr_b16 v[72:73], v14 offset:57344
    v_mfma_f32_16x16x32_bf16 v[196:199], v[76:79], v[144:147], v[196:199]
    ds_read_b64_tr_b16 v[74:75], v14 offset:58368
    s_waitcnt vmcnt(4) lgkmcnt(10)
    v_mfma_f32_16x16x32_bf16 v[176:179], v[80:83], v[152:155], v[176:179]
    ds_read_b64_tr_b16 v[76:77], v15 offset:57344
    v_mfma_f32_16x16x32_bf16 v[184:187], v[80:83], v[156:159], v[184:187]
    ds_read_b64_tr_b16 v[78:79], v15 offset:58368
    v_mfma_f32_16x16x32_bf16 v[188:191], v[84:87], v[156:159], v[188:191]
    ds_read_b64_tr_b16 v[80:81], v12 offset:61440
    v_mfma_f32_16x16x32_bf16 v[180:183], v[84:87], v[152:155], v[180:183]
    ds_read_b64_tr_b16 v[82:83], v12 offset:62464
    s_waitcnt lgkmcnt(10)
    v_mfma_f32_16x16x32_bf16 v[192:195], v[88:91], v[152:155], v[192:195]
    ds_read_b64_tr_b16 v[84:85], v13 offset:61440
    v_mfma_f32_16x16x32_bf16 v[200:203], v[88:91], v[156:159], v[200:203]
    ds_read_b64_tr_b16 v[86:87], v13 offset:62464
    v_mfma_f32_16x16x32_bf16 v[204:207], v[92:95], v[156:159], v[204:207]
    ds_read_b64_tr_b16 v[88:89], v14 offset:61440
    v_mfma_f32_16x16x32_bf16 v[196:199], v[92:95], v[152:155], v[196:199]
    ds_read_b64_tr_b16 v[90:91], v14 offset:62464
    s_waitcnt vmcnt(2) lgkmcnt(10)
    v_mfma_f32_16x16x32_bf16 v[176:179], v[64:67], v[160:163], v[176:179]
    ds_read_b64_tr_b16 v[92:93], v15 offset:61440
    v_mfma_f32_16x16x32_bf16 v[184:187], v[64:67], v[164:167], v[184:187]
    ds_read_b64_tr_b16 v[94:95], v15 offset:62464
    v_mfma_f32_16x16x32_bf16 v[188:191], v[68:71], v[164:167], v[188:191]
    v_mfma_f32_16x16x32_bf16 v[180:183], v[68:71], v[160:163], v[180:183]
    s_waitcnt lgkmcnt(8)
    v_mfma_f32_16x16x32_bf16 v[192:195], v[72:75], v[160:163], v[192:195]
    v_mfma_f32_16x16x32_bf16 v[200:203], v[72:75], v[164:167], v[200:203]
    v_mfma_f32_16x16x32_bf16 v[204:207], v[76:79], v[164:167], v[204:207]
    v_mfma_f32_16x16x32_bf16 v[196:199], v[76:79], v[160:163], v[196:199]
    s_waitcnt vmcnt(0) lgkmcnt(4)
    v_mfma_f32_16x16x32_bf16 v[176:179], v[80:83], v[168:171], v[176:179]
    v_mfma_f32_16x16x32_bf16 v[184:187], v[80:83], v[172:175], v[184:187]
    v_mfma_f32_16x16x32_bf16 v[188:191], v[84:87], v[172:175], v[188:191]
    v_mfma_f32_16x16x32_bf16 v[180:183], v[84:87], v[168:171], v[180:183]
    s_waitcnt lgkmcnt(0)
    v_mfma_f32_16x16x32_bf16 v[192:195], v[88:91], v[168:171], v[192:195]
    v_mfma_f32_16x16x32_bf16 v[200:203], v[88:91], v[172:175], v[200:203]
    v_mfma_f32_16x16x32_bf16 v[204:207], v[92:95], v[172:175], v[204:207]
    v_mfma_f32_16x16x32_bf16 v[196:199], v[92:95], v[168:171], v[196:199]
    s_cmp_eq_u32 s9, 3
    s_cbranch_scc1 c_wo_fin
    s_add_u32 s58, s58, 4194304
    v_pk_add_f32 v[32:33], v[32:33], v[176:177]
    v_pk_add_f32 v[34:35], v[34:35], v[178:179]
    v_pk_add_f32 v[36:37], v[36:37], v[180:181]
    v_pk_add_f32 v[38:39], v[38:39], v[182:183]
    v_cvt_pk_bf16_f32 v96, v32, v33
    v_cvt_pk_bf16_f32 v97, v34, v35
    v_cvt_pk_bf16_f32 v98, v36, v37
    v_cvt_pk_bf16_f32 v99, v38, v39
    buffer_store_dwordx4 v[96:99], v6, s[12:15], s58 offen offset:0 sc1
    v_pk_add_f32 v[40:41], v[40:41], v[184:185]
    v_pk_add_f32 v[42:43], v[42:43], v[186:187]
    v_pk_add_f32 v[44:45], v[44:45], v[188:189]
    v_pk_add_f32 v[46:47], v[46:47], v[190:191]
    v_cvt_pk_bf16_f32 v100, v40, v41
    v_cvt_pk_bf16_f32 v101, v42, v43
    v_cvt_pk_bf16_f32 v102, v44, v45
    v_cvt_pk_bf16_f32 v103, v46, v47
    buffer_store_dwordx4 v[100:103], v6, s[12:15], s58 offen offset:256 sc1
    v_pk_add_f32 v[48:49], v[48:49], v[192:193]
    v_pk_add_f32 v[50:51], v[50:51], v[194:195]
    v_pk_add_f32 v[52:53], v[52:53], v[196:197]
    v_pk_add_f32 v[54:55], v[54:55], v[198:199]
    v_cvt_pk_bf16_f32 v104, v48, v49
    v_cvt_pk_bf16_f32 v105, v50, v51
    v_cvt_pk_bf16_f32 v106, v52, v53
    v_cvt_pk_bf16_f32 v107, v54, v55
    buffer_store_dwordx4 v[104:107], v6, s[12:15], s58 offen offset:2048 sc1
    v_pk_add_f32 v[56:57], v[56:57], v[200:201]
    v_pk_add_f32 v[58:59], v[58:59], v[202:203]
    v_pk_add_f32 v[60:61], v[60:61], v[204:205]
    v_pk_add_f32 v[62:63], v[62:63], v[206:207]
    v_cvt_pk_bf16_f32 v108, v56, v57
    v_cvt_pk_bf16_f32 v109, v58, v59
    v_cvt_pk_bf16_f32 v110, v60, v61
    v_cvt_pk_bf16_f32 v111, v62, v63
    buffer_store_dwordx4 v[108:111], v6, s[12:15], s58 offen offset:2304 sc1
    s_barrier
c_wo_stat:
    s_mov_b32 s55, 0x3f803f80
    v_dot2_f32_bf16 v18, v96, s55, 0
    v_dot2_f32_bf16 v19, v96, v96, 0
    v_dot2_f32_bf16 v20, v100, s55, 0
    v_dot2_f32_bf16 v21, v100, v100, 0
    v_dot2_f32_bf16 v18, v97, s55, v18
    v_dot2_f32_bf16 v19, v97, v97, v19
    v_dot2_f32_bf16 v20, v101, s55, v20
    v_dot2_f32_bf16 v21, v101, v101, v21
    v_dot2_f32_bf16 v18, v98, s55, v18
    v_dot2_f32_bf16 v19, v98, v98, v19
    v_dot2_f32_bf16 v20, v102, s55, v20
    v_dot2_f32_bf16 v21, v102, v102, v21
    v_dot2_f32_bf16 v18, v99, s55, v18
    v_dot2_f32_bf16 v19, v99, v99, v19
    v_dot2_f32_bf16 v20, v103, s55, v20
    v_dot2_f32_bf16 v21, v103, v103, v21
    v_dot2_f32_bf16 v18, v104, s55, v18
    v_dot2_f32_bf16 v19, v104, v104, v19
    v_dot2_f32_bf16 v20, v108, s55, v20
    v_dot2_f32_bf16 v21, v108, v108, v21
    v_dot2_f32_bf16 v18, v105, s55, v18
    v_dot2_f32_bf16 v19, v105, v105, v19
    v_dot2_f32_bf16 v20, v109, s55, v20
    v_dot2_f32_bf16 v21, v109, v109, v21
    v_dot2_f32_bf16 v18, v106, s55, v18
    v_dot2_f32_bf16 v19, v106, v106, v19
    v_dot2_f32_bf16 v20, v110, s55, v20
    v_dot2_f32_bf16 v21, v110, v110, v21
    v_dot2_f32_bf16 v18, v107, s55, v18
    v_dot2_f32_bf16 v19, v107, v107, v19
    v_dot2_f32_bf16 v20, v111, s55, v20
    v_dot2_f32_bf16 v21, v111, v111, v21
    v_lshlrev_b32 v16, 3, v1
    s_lshl_b32 s3, s48, 12
    s_lshl_b32 s55, s7, 8
    s_add_u32 s3, s3, s55
    v_permlane16_swap_b32 v18, v20
    v_permlane16_swap_b32 v19, v21
    s_lshl_b32 s55, s9, 18
    v_pk_add_f32 v[18:19], v[18:19], v[20:21]
    s_add_u32 s3, s3, s55
    s_add_u32 s3, s3, 63176704
    v_permlane32_swap_b32 v18, v20
    v_permlane32_swap_b32 v19, v21
    v_pk_add_f32 v[18:19], v[18:19], v[20:21]
    s_mov_b32 exec_hi, 0
    buffer_store_dwordx2 v[18:19], v16, s[12:15], s3 offen sc1
    s_mov_b64 exec, -1
    s_cmp_lg_u32 s9, -1
    s_cbranch_scc1 c_wo_pub
    v_mov_b32 v24, 159492
non_7:
    ds_read_b32 v25, v24
    s_waitcnt lgkmcnt(0)
    v_readfirstlane_b32 s10, v25
    s_cmp_eq_u32 s10, 0
    s_cbranch_scc1 non_7
c_wo_pub:
    s_mul_i32 s55, s9, 786432
    s_add_u32 s55, s55, 66060288
    v_and_b32 v24, 63, v0
    s_and_b32 s56, s11, 0xe0
    v_lshrrev_b32 v25, 5, v24
    v_add_u32 v24, s56, v24
    v_and_b32 v24, 255, v24
    v_lshlrev_b32 v24, 10, v24
    v_lshl_add_u32 v24, v25, 8, v24
    s_bfe_u32 s56, s11, 0x20003
    s_and_b32 s57, s11, 7
    s_lshl_b32 s56, s56, 7
    s_lshl_b32 s57, s57, 2
    s_add_u32 s55, s55, s56
    s_add_u32 s55, s55, s57
    s_and_b32 s57, s6, s9
    s_bfe_i32 s57, s57, 0x10000
    v_mov_b32 v25, 159488
    v_mov_b32 v26, 1
    v_mov_b32 v27, s10
    s_mov_b64 exec, 1
    s_waitcnt vmcnt(0)
    ds_add_rtn_u32 v26, v25, v26
    s_waitcnt lgkmcnt(0)
    v_readfirstlane_b32 s56, v26
    s_and_b32 s56, s56, 3
    s_cmp_lg_u32 s56, 3
    s_cbranch_scc1 pub_8
    s_mov_b32 exec_lo, -1
    s_mov_b32 exec_hi, s57
    buffer_store_dword v27, v24, s[12:15], s55 offen sc1
pub_8:
    s_mov_b64 exec, -1
    s_cmp_eq_u32 s9, -1
    s_cbranch_scc1 c_wo_pub3
    s_barrier
c_wo_pub3:
    s_add_u32 s9, s9, 1
    s_bitcmp1_b32 s9, 0
    s_cbranch_scc1 c_qkvB
    s_branch c_qkvA
c_wo_fin:
    s_mov_b32 s28, s44
    s_mov_b32 s29, s45
    s_mov_b32 s30, 4194304
    s_mov_b32 s31, 0x00020000
    s_lshl_b32 s3, s48, 16
    s_lshl_b32 s55, s7, 7
    s_add_u32 s3, s3, s55
    v_pk_add_f32 v[32:33], v[32:33], v[176:177]
    v_pk_add_f32 v[34:35], v[34:35], v[178:179]
    v_pk_add_f32 v[36:37], v[36:37], v[180:181]
    v_pk_add_f32 v[38:39], v[38:39], v[182:183]
    v_cvt_pk_bf16_f32 v96, v32, v33
    v_cvt_pk_bf16_f32 v97, v34, v35
    v_cvt_pk_bf16_f32 v98, v36, v37
    v_cvt_pk_bf16_f32 v99, v38, v39
    ds_write_b64 v8, v[96:97] offset:0
    ds_write_b64 v8, v[98:99] offset:32
    v_pk_add_f32 v[40:41], v[40:41], v[184:185]
    v_pk_add_f32 v[42:43], v[42:43], v[186:187]
    v_pk_add_f32 v[44:45], v[44:45], v[188:189]
    v_pk_add_f32 v[46:47], v[46:47], v[190:191]
    v_cvt_pk_bf16_f32 v100, v40, v41
    v_cvt_pk_bf16_f32 v101, v42, v43
    v_cvt_pk_bf16_f32 v102, v44, v45
    v_cvt_pk_bf16_f32 v103, v46, v47
    ds_write_b64 v8, v[100:101] offset:2304
    ds_write_b64 v8, v[102:103] offset:2336
    v_pk_add_f32 v[48:49], v[48:49], v[192:193]
    v_pk_add_f32 v[50:51], v[50:51], v[194:195]
    v_pk_add_f32 v[52:53], v[52:53], v[196:197]
    v_pk_add_f32 v[54:55], v[54:55], v[198:199]
    v_cvt_pk_bf16_f32 v104, v48, v49
    v_cvt_pk_bf16_f32 v105, v50, v51
    v_cvt_pk_bf16_f32 v106, v52, v53
    v_cvt_pk_bf16_f32 v107, v54, v55
    ds_write_b64 v8, v[104:105] offset:64
    ds_write_b64 v8, v[106:107] offset:96
    v_pk_add_f32 v[56:57], v[56:57], v[200:201]
    v_pk_add_f32 v[58:59], v[58:59], v[202:203]
    v_pk_add_f32 v[60:61], v[60:61], v[204:205]
    v_pk_add_f32 v[62:63], v[62:63], v[206:207]
    v_cvt_pk_bf16_f32 v108, v56, v57
    v_cvt_pk_bf16_f32 v109, v58, v59
    v_cvt_pk_bf16_f32 v110, v60, v61
    v_cvt_pk_bf16_f32 v111, v62, v63
    ds_write_b64 v8, v[108:109] offset:2368
    ds_write_b64 v8, v[110:111] offset:2400
    s_waitcnt lgkmcnt(0)
    ds_read_b128 v[32:35], v9 offset:0
    ds_read_b128 v[36:39], v9 offset:1152
    ds_read_b128 v[40:43], v9 offset:2304
    ds_read_b128 v[44:47], v9 offset:3456
    s_waitcnt lgkmcnt(3)
    buffer_store_dwordx4 v[32:35], v10, s[28:31], s3 offen sc1
    s_add_u32 s3, s3, 16384
    s_waitcnt lgkmcnt(2)
    buffer_store_dwordx4 v[36:39], v10, s[28:31], s3 offen sc1
    s_add_u32 s3, s3, 16384
    s_waitcnt lgkmcnt(1)
    buffer_store_dwordx4 v[40:43], v10, s[28:31], s3 offen sc1
    s_add_u32 s3, s3, 16384
    s_waitcnt lgkmcnt(0)
    buffer_store_dwordx4 v[44:47], v10, s[28:31], s3 offen sc1
    s_add_u32 s3, s3, 16384
    s_branch k_exit
c_prep_tail:
    s_lshl_b32 s56, s7, 12
    s_add_u32 s58, s55, s56
    s_lshl_b32 s3, s8, 12
    s_add_u32 s3, s3, 131072
    v_lshrrev_b32 v18, 2, v17
    v_and_b32 v19, 1, v17
    v_lshl_add_u32 v18, v18, 1, v19
    v_lshlrev_b32 v18, 10, v18
    v_lshl_add_u32 v18, v16, 4, v18
    v_bfe_u32 v17, v17, 1, 1
    v_lshl_add_u32 v18, v17, 3, v18
    v_add_u32 v18, s3, v18
    v_and_b32 v16, 15, v1
    v_bfe_u32 v17, v1, 4, 1
    v_lshl_add_u32 v6, v17, 5, v16
    v_lshlrev_b32 v6, 4, v6
    v_lshrrev_b32 v17, 5, v1
    v_lshl_add_u32 v6, v17, 10, v6
    v_add_u32 v19, s3, v6
    s_waitcnt vmcnt(3)
    ds_write_b64 v18, v[32:33] offset:0
    ds_write_b64 v18, v[34:35] offset:512
    s_waitcnt vmcnt(2)
    ds_write_b64 v18, v[36:37] offset:128
    ds_write_b64 v18, v[38:39] offset:640
    s_waitcnt vmcnt(1)
    ds_write_b64 v18, v[40:41] offset:256
    ds_write_b64 v18, v[42:43] offset:768
    s_waitcnt vmcnt(0)
    ds_write_b64 v18, v[44:45] offset:384
    ds_write_b64 v18, v[46:47] offset:896
    s_waitcnt lgkmcnt(0)
    ds_read_b128 v[96:99], v19 offset:0
    ds_read_b128 v[100:103], v19 offset:256
    ds_read_b128 v[104:107], v19 offset:2048
    ds_read_b128 v[108:111], v19 offset:2304
    s_waitcnt lgkmcnt(3)
    buffer_store_dwordx4 v[96:99], v6, s[12:15], s58 offen offset:0 sc1
    s_waitcnt lgkmcnt(2)
    buffer_store_dwordx4 v[100:103], v6, s[12:15], s58 offen offset:256 sc1
    s_waitcnt lgkmcnt(1)
    buffer_store_dwordx4 v[104:107], v6, s[12:15], s58 offen offset:2048 sc1
    s_waitcnt lgkmcnt(0)
    buffer_store_dwordx4 v[108:111], v6, s[12:15], s58 offen offset:2304 sc1
    s_branch c_wo_stat
.p2align 6
c_qkvB:
    v_and_b32 v1, 63, v0
    v_lshrrev_b32 v2, 6, v0
    v_lshlrev_b32 v5, 4, v1
    v_lshrrev_b32 v3, 5, v1
    v_and_b32 v4, 15, v0
    v_bfe_u32 v7, v1, 4, 1
    v_lshl_add_u32 v6, v7, 5, v4
    v_lshlrev_b32 v6, 4, v6
    v_lshl_add_u32 v6, v3, 10, v6
    s_lshr_b32 s48, s6, 1
    s_lshl_b32 s48, s48, 2
    s_add_u32 s48, s48, s8
    s_lshl_b32 s55, s48, 17
    s_lshl_b32 s56, s9, 22
    s_add_u32 s55, s55, s56
    s_add_u32 s16, s4, s55
    s_addc_u32 s17, s5, 0
    s_mov_b32 s18, 65536
    s_mov_b32 s19, 0x00020000
    s_add_u32 s56, s55, 65536
    s_add_u32 s20, s4, s56
    s_addc_u32 s21, s5, 0
    s_mov_b32 s22, 65536
    s_mov_b32 s23, 0x00020000
    s_lshl_b32 s49, s7, 12
    s_add_u32 s49, s49, s55
    s_and_b32 s56, s6, 1
    s_lshl_b32 s56, s56, 11
    s_add_u32 s49, s49, s56
    s_add_u32 s49, s49, 16777216
    s_movk_i32 s54, 4096
    v_lshrrev_b32 v16, 2, v4
    v_lshl_add_u32 v18, v7, 2, v16
    v_lshl_add_u32 v18, v3, 4, v18
    v_lshlrev_b32 v18, 6, v18
    v_and_b32 v17, 3, v4
    v_lshl_add_u32 v18, v17, 3, v18
    v_lshl_add_u32 v26, v7, 5, v18
    v_xor_b32 v27, 32, v26
    v_mov_b32 v24, v26
    v_mov_b32 v25, v27
    v_and_b32 v18, 0x30, v1
    v_add_u32 v10, 155648, v18
    v_lshlrev_b32 v11, 2, v4
    v_add_u32 v11, 155648, v11
    v_lshl_add_u32 v8, v2, 8, v11
    v_lshl_add_u32 v9, v2, 8, v10
    s_lshr_b32 s3, s8, 1
    s_and_b32 s55, s8, 1
    s_lshl_b32 s3, s3, 14
    s_lshl_b32 s55, s55, 12
    s_add_u32 s3, s3, s55
    s_add_u32 s3, s3, 81920
    v_lshl_add_u32 v12, v3, 5, v4
    v_lshlrev_b32 v12, 4, v12
    v_lshl_add_u32 v12, v7, 10, v12
    v_add_u32 v12, s3, v12
    v_add_u32 v13, s3, v5
    s_lshr_b32 s84, s9, 1
    s_lshl_b32 s84, s84, 23
    s_lshl_b32 s3, s7, 19
    s_add_u32 s84, s84, s3
    s_and_b32 s3, s6, 1
    s_lshl_b32 s3, s3, 18
    s_add_u32 s84, s84, s3
    s_add_u32 s84, s84, 33554432
    s_lshr_b32 s86, s6, 1
    s_lshl_b32 s3, s86, 15
    s_add_u32 s84, s84, s3
    s_sub_u32 s84, s84, 81920
    s_add_u32 s85, s84, 8192
    s_mul_i32 s53, s9, 786432
    s_add_u32 s53, s53, 66322432
    s_and_b32 s3, s11, 31
    s_lshl_b32 s3, s3, 10
    s_add_u32 s53, s53, s3
    s_lshr_b32 s3, s86, 1
    s_lshl_b32 s3, s3, 7
    s_add_u32 s53, s53, s3
    s_and_b32 s3, s86, 1
    s_lshl_b32 s3, s3, 2
    s_add_u32 s3, s3, s8
    s_lshl_b32 s3, s3, 2
    s_add_u32 s53, s53, s3
    v_lshlrev_b32 v28, 15, v1
    v_mov_b32 v29, s10
    v_mov_b32 v32, 0
    v_mov_b32 v33, 0
    v_mov_b32 v34, 0
    v_mov_b32 v35, 0
    v_mov_b32 v36, 0
    v_mov_b32 v37, 0
    v_mov_b32 v38, 0
    v_mov_b32 v39, 0
    v_mov_b32 v40, 0
    v_mov_b32 v41, 0
    v_mov_b32 v42, 0
    v_mov_b32 v43, 0
    v_mov_b32 v44, 0
    v_mov_b32 v45, 0
    v_mov_b32 v46, 0
    v_mov_b32 v47, 0
    v_mov_b32 v48, 0
    v_mov_b32 v49, 0
    v_mov_b32 v50, 0
    v_mov_b32 v51, 0
    v_mov_b32 v52, 0
    v_mov_b32 v53, 0
    v_mov_b32 v54, 0
    v_mov_b32 v55, 0
    v_mov_b32 v56, 0
    v_mov_b32 v57, 0
    v_mov_b32 v58, 0
    v_mov_b32 v59, 0
    v_mov_b32 v60, 0
    v_mov_b32 v61, 0
    v_mov_b32 v62, 0
    v_mov_b32 v63, 0
    v_mov_b32 v64, 0
    v_mov_b32 v65, 0
    v_mov_b32 v66, 0
    v_mov_b32 v67, 0
    v_mov_b32 v68, 0
    v_mov_b32 v69, 0
    v_mov_b32 v70, 0
    v_mov_b32 v71, 0
    v_mov_b32 v72, 0
    v_mov_b32 v73, 0
    v_mov_b32 v74, 0
    v_mov_b32 v75, 0
    v_mov_b32 v76, 0
    v_mov_b32 v77, 0
    v_mov_b32 v78, 0
    v_mov_b32 v79, 0
    v_mov_b32 v80, 0
    v_mov_b32 v81, 0
    v_mov_b32 v82, 0
    v_mov_b32 v83, 0
    v_mov_b32 v84, 0
    v_mov_b32 v85, 0
    v_mov_b32 v86, 0
    v_mov_b32 v87, 0
    v_mov_b32 v88, 0
    v_mov_b32 v89, 0
    v_mov_b32 v90, 0
    v_mov_b32 v91, 0
    v_mov_b32 v92, 0
    v_mov_b32 v93, 0
    v_mov_b32 v94, 0
    v_mov_b32 v95, 0
    v_mov_b32 v96, 0
    v_mov_b32 v97, 0
    v_mov_b32 v98, 0
    v_mov_b32 v99, 0
    v_mov_b32 v100, 0
    v_mov_b32 v101, 0
    v_mov_b32 v102, 0
    v_mov_b32 v103, 0
    v_mov_b32 v104, 0
    v_mov_b32 v105, 0
    v_mov_b32 v106, 0
    v_mov_b32 v107, 0
    v_mov_b32 v108, 0
    v_mov_b32 v109, 0
    v_mov_b32 v110, 0
    v_mov_b32 v111, 0
    v_mov_b32 v112, 0
    v_mov_b32 v113, 0
    v_mov_b32 v114, 0
    v_mov_b32 v115, 0
    v_mov_b32 v116, 0
    v_mov_b32 v117, 0
    v_mov_b32 v118, 0
    v_mov_b32 v119, 0
    v_mov_b32 v120, 0
    v_mov_b32 v121, 0
    v_mov_b32 v122, 0
    v_mov_b32 v123, 0
    v_mov_b32 v124, 0
    v_mov_b32 v125, 0
    v_mov_b32 v126, 0
    v_mov_b32 v127, 0
    s_mov_b32 s50, 8192
    s_mov_b32 s58, 6144
    s_mov_b32 s51, 12288
    s_mov_b32 s59, 10240
    s_mov_b32 s52, 0
    s_mul_i32 s60, s9, 786432
    s_add_u32 s60, s60, 65273856
    s_lshl_b32 s61, s11, 10
    s_add_u32 s60, s60, s61
    s_and_b32 s61, s8, 2
    s_lshl_b32 s61, s61, 7
    s_add_u32 s60, s60, s61
    s_add_u32 s61, s60, 128
    s_mov_b32 s98, s10
    s_mov_b32 s99, s10
    s_mov_b32 s3, 0x100000
cp_9:
    s_load_dwordx8 s[64:71], s[4:5], s60 glc
    s_load_dwordx8 s[72:79], s[4:5], s61 glc
    s_sub_u32 s3, s3, 1
    s_cbranch_scc1 cp_9_ok
    s_waitcnt lgkmcnt(0)
    s_xor_b64 s[100:101], s[64:65], s[98:99]
    s_xor_b64 s[64:65], s[66:67], s[98:99]
    s_or_b64 s[100:101], s[100:101], s[64:65]
    s_xor_b64 s[64:65], s[68:69], s[98:99]
    s_or_b64 s[100:101], s[100:101], s[64:65]
    s_xor_b64 s[64:65], s[70:71], s[98:99]
    s_or_b64 s[100:101], s[100:101], s[64:65]
    s_xor_b64 s[64:65], s[72:73], s[98:99]
    s_or_b64 s[100:101], s[100:101], s[64:65]
    s_xor_b64 s[64:65], s[74:75], s[98:99]
    s_or_b64 s[100:101], s[100:101], s[64:65]
    s_xor_b64 s[64:65], s[76:77], s[98:99]
    s_or_b64 s[100:101], s[100:101], s[64:65]
    s_xor_b64 s[64:65], s[78:79], s[98:99]
    s_or_b64 s[100:101], s[100:101], s[64:65]
    s_cbranch_scc1 cp_9
cp_9_ok:
    s_waitcnt lgkmcnt(0)
    buffer_load_dwordx4 v[152:155], v6, s[16:19], 0 offen offset:0 sc1
    buffer_load_dwordx4 v[156:159], v6, s[16:19], 0 offen offset:256 sc1
    buffer_load_dwordx4 v[160:163], v6, s[20:23], 0 offen offset:0 sc1
    buffer_load_dwordx4 v[164:167], v6, s[20:23], 0 offen offset:256 sc1
    buffer_load_dwordx4 v[168:171], v6, s[16:19], 0 offen offset:2048 sc1
    buffer_load_dwordx4 v[172:175], v6, s[16:19], 0 offen offset:2304 sc1
    buffer_load_dwordx4 v[176:179], v6, s[20:23], 0 offen offset:2048 sc1
    buffer_load_dwordx4 v[180:183], v6, s[20:23], 0 offen offset:2304 sc1
    s_barrier
    ds_read_b64_tr_b16 v[128:129], v24 offset:0
    ds_read_b64_tr_b16 v[130:131], v24 offset:512
    ds_read_b64_tr_b16 v[132:133], v25 offset:0
    ds_read_b64_tr_b16 v[134:135], v25 offset:512
    ds_read_b64_tr_b16 v[136:137], v24 offset:8192
    ds_read_b64_tr_b16 v[138:139], v24 offset:8704
    ds_read_b64_tr_b16 v[140:141], v25 offset:8192
    ds_read_b64_tr_b16 v[142:143], v25 offset:8704
    ds_read_b64_tr_b16 v[144:145], v24 offset:16384
    ds_read_b64_tr_b16 v[146:147], v24 offset:16896
    buffer_load_dwordx4 a[0:3], v6, s[16:19], s54 offen offset:0 sc1
    buffer_load_dwordx4 a[4:7], v6, s[16:19], s54 offen offset:256 sc1
    buffer_load_dwordx4 a[8:11], v6, s[20:23], s54 offen offset:0 sc1
    buffer_load_dwordx4 a[12:15], v6, s[20:23], s54 offen offset:256 sc1
    buffer_load_dwordx4 a[16:19], v6, s[16:19], s54 offen offset:2048 sc1
    buffer_load_dwordx4 a[20:23], v6, s[16:19], s54 offen offset:2304 sc1
    s_mov_b32 s54, 7
.p2align 3
c_qkvB_loop:
    s_waitcnt vmcnt(12) lgkmcnt(6)
    v_mfma_f32_16x16x32_bf16 v[32:35], v[128:131], v[152:155], v[32:35]
    ds_read_b64_tr_b16 v[148:149], v25 offset:16384
    v_mfma_f32_16x16x32_bf16 v[36:39], v[128:131], v[156:159], v[36:39]
    ds_read_b64_tr_b16 v[150:151], v25 offset:16896
    v_mfma_f32_16x16x32_bf16 v[52:55], v[132:135], v[156:159], v[52:55]
    buffer_load_dwordx4 a[24:27], v6, s[20:23], s58 offen offset:0 sc1
    v_mfma_f32_16x16x32_bf16 v[48:51], v[132:135], v[152:155], v[48:51]
    s_waitcnt lgkmcnt(4)
    v_mfma_f32_16x16x32_bf16 v[64:67], v[136:139], v[152:155], v[64:67]
    v_mfma_f32_16x16x32_bf16 v[68:71], v[136:139], v[156:159], v[68:71]
    v_mfma_f32_16x16x32_bf16 v[84:87], v[140:143], v[156:159], v[84:87]
    buffer_load_dwordx4 a[28:31], v6, s[20:23], s58 offen offset:256 sc1
    v_mfma_f32_16x16x32_bf16 v[80:83], v[140:143], v[152:155], v[80:83]
    s_waitcnt lgkmcnt(0)
    v_mfma_f32_16x16x32_bf16 v[96:99], v[152:155], v[144:147], v[96:99]
    v_mfma_f32_16x16x32_bf16 v[100:103], v[156:159], v[144:147], v[100:103]
    v_mfma_f32_16x16x32_bf16 v[116:119], v[156:159], v[148:151], v[116:119]
    v_mfma_f32_16x16x32_bf16 v[112:115], v[152:155], v[148:151], v[112:115]
    s_waitcnt vmcnt(12)
    v_mfma_f32_16x16x32_bf16 v[40:43], v[128:131], v[160:163], v[40:43]
    buffer_load_dwordx4 v[152:155], v6, s[16:19], s50 offen offset:0 sc1
    v_mfma_f32_16x16x32_bf16 v[44:47], v[128:131], v[164:167], v[44:47]
    v_mfma_f32_16x16x32_bf16 v[60:63], v[132:135], v[164:167], v[60:63]
    ds_read_b64_tr_b16 v[128:129], v24 offset:2048
    v_mfma_f32_16x16x32_bf16 v[56:59], v[132:135], v[160:163], v[56:59]
    ds_read_b64_tr_b16 v[130:131], v24 offset:2560
    v_mfma_f32_16x16x32_bf16 v[72:75], v[136:139], v[160:163], v[72:75]
    ds_read_b64_tr_b16 v[132:133], v25 offset:2048
    v_mfma_f32_16x16x32_bf16 v[76:79], v[136:139], v[164:167], v[76:79]
    ds_read_b64_tr_b16 v[134:135], v25 offset:2560
    v_mfma_f32_16x16x32_bf16 v[92:95], v[140:143], v[164:167], v[92:95]
    ds_read_b64_tr_b16 v[136:137], v24 offset:10240
    buffer_load_dwordx4 v[156:159], v6, s[16:19], s50 offen offset:256 sc1
    v_mfma_f32_16x16x32_bf16 v[88:91], v[140:143], v[160:163], v[88:91]
    ds_read_b64_tr_b16 v[138:139], v24 offset:10752
    v_mfma_f32_16x16x32_bf16 v[104:107], v[160:163], v[144:147], v[104:107]
    ds_read_b64_tr_b16 v[140:141], v25 offset:10240
    v_mfma_f32_16x16x32_bf16 v[108:111], v[164:167], v[144:147], v[108:111]
    ds_read_b64_tr_b16 v[142:143], v25 offset:10752
    v_mfma_f32_16x16x32_bf16 v[124:127], v[164:167], v[148:151], v[124:127]
    ds_read_b64_tr_b16 v[144:145], v24 offset:18432
    v_mfma_f32_16x16x32_bf16 v[120:123], v[160:163], v[148:151], v[120:123]
    ds_read_b64_tr_b16 v[146:147], v24 offset:18944
    s_waitcnt vmcnt(12) lgkmcnt(6)
    v_mfma_f32_16x16x32_bf16 v[32:35], v[128:131], v[168:171], v[32:35]
    ds_read_b64_tr_b16 v[148:149], v25 offset:18432
    v_mfma_f32_16x16x32_bf16 v[36:39], v[128:131], v[172:175], v[36:39]
    ds_read_b64_tr_b16 v[150:151], v25 offset:18944
    v_mfma_f32_16x16x32_bf16 v[52:55], v[132:135], v[172:175], v[52:55]
    buffer_load_dwordx4 v[160:163], v6, s[20:23], s58 offen offset:2048 sc1
    v_mfma_f32_16x16x32_bf16 v[48:51], v[132:135], v[168:171], v[48:51]
    s_waitcnt lgkmcnt(4)
    v_mfma_f32_16x16x32_bf16 v[64:67], v[136:139], v[168:171], v[64:67]
    v_mfma_f32_16x16x32_bf16 v[68:71], v[136:139], v[172:175], v[68:71]
    v_mfma_f32_16x16x32_bf16 v[84:87], v[140:143], v[172:175], v[84:87]
    buffer_load_dwordx4 v[164:167], v6, s[20:23], s58 offen offset:2304 sc1
    v_mfma_f32_16x16x32_bf16 v[80:83], v[140:143], v[168:171], v[80:83]
    s_waitcnt lgkmcnt(0)
    v_mfma_f32_16x16x32_bf16 v[96:99], v[168:171], v[144:147], v[96:99]
    v_mfma_f32_16x16x32_bf16 v[100:103], v[172:175], v[144:147], v[100:103]
    v_mfma_f32_16x16x32_bf16 v[116:119], v[172:175], v[148:151], v[116:119]
    v_mfma_f32_16x16x32_bf16 v[112:115], v[168:171], v[148:151], v[112:115]
    s_waitcnt vmcnt(12)
    v_mfma_f32_16x16x32_bf16 v[40:43], v[128:131], v[176:179], v[40:43]
    buffer_load_dwordx4 v[168:171], v6, s[16:19], s50 offen offset:2048 sc1
    v_mfma_f32_16x16x32_bf16 v[44:47], v[128:131], v[180:183], v[44:47]
    v_mfma_f32_16x16x32_bf16 v[60:63], v[132:135], v[180:183], v[60:63]
    ds_read_b64_tr_b16 v[128:129], v24 offset:4096
    v_mfma_f32_16x16x32_bf16 v[56:59], v[132:135], v[176:179], v[56:59]
    ds_read_b64_tr_b16 v[130:131], v24 offset:4608
    v_mfma_f32_16x16x32_bf16 v[72:75], v[136:139], v[176:179], v[72:75]
    ds_read_b64_tr_b16 v[132:133], v25 offset:4096
    v_mfma_f32_16x16x32_bf16 v[76:79], v[136:139], v[180:183], v[76:79]
    ds_read_b64_tr_b16 v[134:135], v25 offset:4608
    v_mfma_f32_16x16x32_bf16 v[92:95], v[140:143], v[180:183], v[92:95]
    ds_read_b64_tr_b16 v[136:137], v24 offset:12288
    buffer_load_dwordx4 v[172:175], v6, s[16:19], s50 offen offset:2304 sc1
    v_mfma_f32_16x16x32_bf16 v[88:91], v[140:143], v[176:179], v[88:91]
    ds_read_b64_tr_b16 v[138:139], v24 offset:12800
    v_mfma_f32_16x16x32_bf16 v[104:107], v[176:179], v[144:147], v[104:107]
    ds_read_b64_tr_b16 v[140:141], v25 offset:12288
    v_mfma_f32_16x16x32_bf16 v[108:111], v[180:183], v[144:147], v[108:111]
    ds_read_b64_tr_b16 v[142:143], v25 offset:12800
    v_mfma_f32_16x16x32_bf16 v[124:127], v[180:183], v[148:151], v[124:127]
    ds_read_b64_tr_b16 v[144:145], v24 offset:20480
    v_mfma_f32_16x16x32_bf16 v[120:123], v[176:179], v[148:151], v[120:123]
    ds_read_b64_tr_b16 v[146:147], v24 offset:20992
    s_waitcnt vmcnt(12) lgkmcnt(6)
    v_mfma_f32_16x16x32_bf16 v[32:35], v[128:131], a[0:3], v[32:35]
    ds_read_b64_tr_b16 v[148:149], v25 offset:20480
    v_mfma_f32_16x16x32_bf16 v[36:39], v[128:131], a[4:7], v[36:39]
    ds_read_b64_tr_b16 v[150:151], v25 offset:20992
    v_mfma_f32_16x16x32_bf16 v[52:55], v[132:135], a[4:7], v[52:55]
    buffer_load_dwordx4 v[176:179], v6, s[20:23], s59 offen offset:0 sc1
    v_mfma_f32_16x16x32_bf16 v[48:51], v[132:135], a[0:3], v[48:51]
    s_waitcnt lgkmcnt(4)
    v_mfma_f32_16x16x32_bf16 v[64:67], v[136:139], a[0:3], v[64:67]
    s_add_u32 s50, s50, 8192
    v_mfma_f32_16x16x32_bf16 v[68:71], v[136:139], a[4:7], v[68:71]
    v_mfma_f32_16x16x32_bf16 v[84:87], v[140:143], a[4:7], v[84:87]
    buffer_load_dwordx4 v[180:183], v6, s[20:23], s59 offen offset:256 sc1
    v_mfma_f32_16x16x32_bf16 v[80:83], v[140:143], a[0:3], v[80:83]
    s_waitcnt lgkmcnt(0)
    v_mfma_f32_16x16x32_bf16 v[96:99], a[0:3], v[144:147], v[96:99]
    s_add_u32 s52, s52, 24576
    v_mfma_f32_16x16x32_bf16 v[100:103], a[4:7], v[144:147], v[100:103]
    s_cmp_eq_u32 s52, 147456
    v_mfma_f32_16x16x32_bf16 v[116:119], a[4:7], v[148:151], v[116:119]
    s_cselect_b32 s52, 0, s52
    v_mfma_f32_16x16x32_bf16 v[112:115], a[0:3], v[148:151], v[112:115]
    s_add_u32 s58, s58, 8192
    s_waitcnt vmcnt(12)
    v_mfma_f32_16x16x32_bf16 v[40:43], v[128:131], a[8:11], v[40:43]
    buffer_load_dwordx4 a[0:3], v6, s[16:19], s51 offen offset:0 sc1
    v_mfma_f32_16x16x32_bf16 v[44:47], v[128:131], a[12:15], v[44:47]
    s_sub_u32 s54, s54, 1
    v_mfma_f32_16x16x32_bf16 v[60:63], v[132:135], a[12:15], v[60:63]
    ds_read_b64_tr_b16 v[128:129], v24 offset:6144
    v_mfma_f32_16x16x32_bf16 v[56:59], v[132:135], a[8:11], v[56:59]
    ds_read_b64_tr_b16 v[130:131], v24 offset:6656
    v_mfma_f32_16x16x32_bf16 v[72:75], v[136:139], a[8:11], v[72:75]
    ds_read_b64_tr_b16 v[132:133], v25 offset:6144
    v_mfma_f32_16x16x32_bf16 v[76:79], v[136:139], a[12:15], v[76:79]
    ds_read_b64_tr_b16 v[134:135], v25 offset:6656
    v_mfma_f32_16x16x32_bf16 v[92:95], v[140:143], a[12:15], v[92:95]
    ds_read_b64_tr_b16 v[136:137], v24 offset:14336
    buffer_load_dwordx4 a[4:7], v6, s[16:19], s51 offen offset:256 sc1
    v_mfma_f32_16x16x32_bf16 v[88:91], v[140:143], a[8:11], v[88:91]
    ds_read_b64_tr_b16 v[138:139], v24 offset:14848
    v_mfma_f32_16x16x32_bf16 v[104:107], a[8:11], v[144:147], v[104:107]
    ds_read_b64_tr_b16 v[140:141], v25 offset:14336
    v_mfma_f32_16x16x32_bf16 v[108:111], a[12:15], v[144:147], v[108:111]
    ds_read_b64_tr_b16 v[142:143], v25 offset:14848
    v_mfma_f32_16x16x32_bf16 v[124:127], a[12:15], v[148:151], v[124:127]
    ds_read_b64_tr_b16 v[144:145], v24 offset:22528
    v_mfma_f32_16x16x32_bf16 v[120:123], a[8:11], v[148:151], v[120:123]
    ds_read_b64_tr_b16 v[146:147], v24 offset:23040
    s_waitcnt vmcnt(12) lgkmcnt(6)
    v_mfma_f32_16x16x32_bf16 v[32:35], v[128:131], a[16:19], v[32:35]
    ds_read_b64_tr_b16 v[148:149], v25 offset:22528
    v_mfma_f32_16x16x32_bf16 v[36:39], v[128:131], a[20:23], v[36:39]
    ds_read_b64_tr_b16 v[150:151], v25 offset:23040
    v_mfma_f32_16x16x32_bf16 v[52:55], v[132:135], a[20:23], v[52:55]
    buffer_load_dwordx4 a[8:11], v6, s[20:23], s59 offen offset:2048 sc1
    v_mfma_f32_16x16x32_bf16 v[48:51], v[132:135], a[16:19], v[48:51]
    s_waitcnt lgkmcnt(4)
    v_mfma_f32_16x16x32_bf16 v[64:67], v[136:139], a[16:19], v[64:67]
    v_add_u32 v25, s52, v27
    v_mfma_f32_16x16x32_bf16 v[68:71], v[136:139], a[20:23], v[68:71]
    v_mfma_f32_16x16x32_bf16 v[84:87], v[140:143], a[20:23], v[84:87]
    buffer_load_dwordx4 a[12:15], v6, s[20:23], s59 offen offset:2304 sc1
    v_mfma_f32_16x16x32_bf16 v[80:83], v[140:143], a[16:19], v[80:83]
    s_waitcnt lgkmcnt(0)
    v_mfma_f32_16x16x32_bf16 v[96:99], a[16:19], v[144:147], v[96:99]
    v_add_u32 v24, s52, v26
    v_mfma_f32_16x16x32_bf16 v[100:103], a[20:23], v[144:147], v[100:103]
    v_mfma_f32_16x16x32_bf16 v[116:119], a[20:23], v[148:151], v[116:119]
    s_add_u32 s59, s59, 8192
    v_mfma_f32_16x16x32_bf16 v[112:115], a[16:19], v[148:151], v[112:115]
    s_barrier
    s_waitcnt vmcnt(12)
    v_mfma_f32_16x16x32_bf16 v[40:43], v[128:131], a[24:27], v[40:43]
    buffer_load_dwordx4 a[16:19], v6, s[16:19], s51 offen offset:2048 sc1
    v_mfma_f32_16x16x32_bf16 v[44:47], v[128:131], a[28:31], v[44:47]
    v_mfma_f32_16x16x32_bf16 v[60:63], v[132:135], a[28:31], v[60:63]
    ds_read_b64_tr_b16 v[128:129], v24 offset:0
    v_mfma_f32_16x16x32_bf16 v[56:59], v[132:135], a[24:27], v[56:59]
    ds_read_b64_tr_b16 v[130:131], v24 offset:512
    v_mfma_f32_16x16x32_bf16 v[72:75], v[136:139], a[24:27], v[72:75]
    ds_read_b64_tr_b16 v[132:133], v25 offset:0
    v_mfma_f32_16x16x32_bf16 v[76:79], v[136:139], a[28:31], v[76:79]
    ds_read_b64_tr_b16 v[134:135], v25 offset:512
    v_mfma_f32_16x16x32_bf16 v[92:95], v[140:143], a[28:31], v[92:95]
    ds_read_b64_tr_b16 v[136:137], v24 offset:8192
    buffer_load_dwordx4 a[20:23], v6, s[16:19], s51 offen offset:2304 sc1
    v_mfma_f32_16x16x32_bf16 v[88:91], v[140:143], a[24:27], v[88:91]
    ds_read_b64_tr_b16 v[138:139], v24 offset:8704
    v_mfma_f32_16x16x32_bf16 v[104:107], a[24:27], v[144:147], v[104:107]
    ds_read_b64_tr_b16 v[140:141], v25 offset:8192
    s_add_u32 s51, s51, 8192
    v_mfma_f32_16x16x32_bf16 v[108:111], a[28:31], v[144:147], v[108:111]
    ds_read_b64_tr_b16 v[142:143], v25 offset:8704
    v_mfma_f32_16x16x32_bf16 v[124:127], a[28:31], v[148:151], v[124:127]
    ds_read_b64_tr_b16 v[144:145], v24 offset:16384
    s_cmp_lg_u32 s54, 0
    v_mfma_f32_16x16x32_bf16 v[120:123], a[24:27], v[148:151], v[120:123]
    ds_read_b64_tr_b16 v[146:147], v24 offset:16896
    s_cbranch_scc1 c_qkvB_loop
    s_waitcnt vmcnt(12) lgkmcnt(6)
    v_mfma_f32_16x16x32_bf16 v[32:35], v[128:131], v[152:155], v[32:35]
    ds_read_b64_tr_b16 v[148:149], v25 offset:16384
    v_mfma_f32_16x16x32_bf16 v[36:39], v[128:131], v[156:159], v[36:39]
    ds_read_b64_tr_b16 v[150:151], v25 offset:16896
    v_mfma_f32_16x16x32_bf16 v[52:55], v[132:135], v[156:159], v[52:55]
    buffer_load_dwordx4 a[24:27], v6, s[20:23], s58 offen offset:0 sc1
    ds_read_b32 v184, v8 offset:1280
    v_mfma_f32_16x16x32_bf16 v[48:51], v[132:135], v[152:155], v[48:51]
    ds_read_b32 v186, v8 offset:1344
    s_waitcnt lgkmcnt(6)
    v_mfma_f32_16x16x32_bf16 v[64:67], v[136:139], v[152:155], v[64:67]
    ds_read_b32 v188, v8 offset:1408
    v_mfma_f32_16x16x32_bf16 v[68:71], v[136:139], v[156:159], v[68:71]
    v_mfma_f32_16x16x32_bf16 v[84:87], v[140:143], v[156:159], v[84:87]
    buffer_load_dwordx4 a[28:31], v6, s[20:23], s58 offen offset:256 sc1
    ds_read_b32 v190, v8 offset:1472
    v_mfma_f32_16x16x32_bf16 v[80:83], v[140:143], v[152:155], v[80:83]
    ds_read_b128 v[212:215], v10 offset:512
    s_waitcnt lgkmcnt(5)
    v_mfma_f32_16x16x32_bf16 v[96:99], v[152:155], v[144:147], v[96:99]
    ds_read_b128 v[216:219], v10 offset:576
    v_mfma_f32_16x16x32_bf16 v[100:103], v[156:159], v[144:147], v[100:103]
    v_mfma_f32_16x16x32_bf16 v[116:119], v[156:159], v[148:151], v[116:119]
    v_mfma_f32_16x16x32_bf16 v[112:115], v[152:155], v[148:151], v[112:115]
    s_waitcnt vmcnt(12)
    v_mfma_f32_16x16x32_bf16 v[40:43], v[128:131], v[160:163], v[40:43]
    s_waitcnt lgkmcnt(0)
    v_fma_f32 v64, -v184, v212, v64
    v_fma_f32 v65, -v184, v213, v65
    v_mfma_f32_16x16x32_bf16 v[44:47], v[128:131], v[164:167], v[44:47]
    v_fma_f32 v66, -v184, v214, v66
    v_mfma_f32_16x16x32_bf16 v[60:63], v[132:135], v[164:167], v[60:63]
    ds_read_b64_tr_b16 v[128:129], v24 offset:2048
    v_fma_f32 v67, -v184, v215, v67
    v_mfma_f32_16x16x32_bf16 v[56:59], v[132:135], v[160:163], v[56:59]
    ds_read_b64_tr_b16 v[130:131], v24 offset:2560
    v_fma_f32 v68, -v186, v212, v68
    v_fma_f32 v69, -v186, v213, v69
    v_mfma_f32_16x16x32_bf16 v[72:75], v[136:139], v[160:163], v[72:75]
    ds_read_b64_tr_b16 v[132:133], v25 offset:2048
    v_fma_f32 v70, -v186, v214, v70
    v_mfma_f32_16x16x32_bf16 v[76:79], v[136:139], v[164:167], v[76:79]
    ds_read_b64_tr_b16 v[134:135], v25 offset:2560
    v_fma_f32 v71, -v186, v215, v71
    v_mfma_f32_16x16x32_bf16 v[92:95], v[140:143], v[164:167], v[92:95]
    ds_read_b64_tr_b16 v[136:137], v24 offset:10240
    v_fma_f32 v80, -v184, v216, v80
    v_fma_f32 v81, -v184, v217, v81
    v_mfma_f32_16x16x32_bf16 v[88:91], v[140:143], v[160:163], v[88:91]
    ds_read_b64_tr_b16 v[138:139], v24 offset:10752
    v_fma_f32 v82, -v184, v218, v82
    v_mfma_f32_16x16x32_bf16 v[104:107], v[160:163], v[144:147], v[104:107]
    ds_read_b64_tr_b16 v[140:141], v25 offset:10240
    v_fma_f32 v83, -v184, v219, v83
    v_mfma_f32_16x16x32_bf16 v[108:111], v[164:167], v[144:147], v[108:111]
    ds_read_b64_tr_b16 v[142:143], v25 offset:10752
    v_fma_f32 v84, -v186, v216, v84
    v_fma_f32 v85, -v186, v217, v85
    v_mfma_f32_16x16x32_bf16 v[124:127], v[164:167], v[148:151], v[124:127]
    ds_read_b64_tr_b16 v[144:145], v24 offset:18432
    v_fma_f32 v86, -v186, v218, v86
    v_mfma_f32_16x16x32_bf16 v[120:123], v[160:163], v[148:151], v[120:123]
    ds_read_b64_tr_b16 v[146:147], v24 offset:18944
    v_fma_f32 v87, -v186, v219, v87
    s_waitcnt vmcnt(10) lgkmcnt(6)
    v_mfma_f32_16x16x32_bf16 v[32:35], v[128:131], v[168:171], v[32:35]
    ds_read_b64_tr_b16 v[148:149], v25 offset:18432
    v_fma_f32 v72, -v188, v212, v72
    v_fma_f32 v73, -v188, v213, v73
    v_mfma_f32_16x16x32_bf16 v[36:39], v[128:131], v[172:175], v[36:39]
    ds_read_b64_tr_b16 v[150:151], v25 offset:18944
    v_fma_f32 v74, -v188, v214, v74
    v_mfma_f32_16x16x32_bf16 v[52:55], v[132:135], v[172:175], v[52:55]
    v_fma_f32 v75, -v188, v215, v75
    ds_read_b128 v[152:155], v10 offset:384
    v_mfma_f32_16x16x32_bf16 v[48:51], v[132:135], v[168:171], v[48:51]
    v_fma_f32 v76, -v190, v212, v76
    v_fma_f32 v77, -v190, v213, v77
    ds_read_b128 v[156:159], v10 offset:448
    s_waitcnt lgkmcnt(6)
    v_mfma_f32_16x16x32_bf16 v[64:67], v[136:139], v[168:171], v[64:67]
    v_fma_f32 v78, -v190, v214, v78
    ds_read_b32 v185, v8 offset:2816
    v_mfma_f32_16x16x32_bf16 v[68:71], v[136:139], v[172:175], v[68:71]
    v_fma_f32 v79, -v190, v215, v79
    v_mfma_f32_16x16x32_bf16 v[84:87], v[140:143], v[172:175], v[84:87]
    v_fma_f32 v88, -v188, v216, v88
    v_fma_f32 v89, -v188, v217, v89
    ds_read_b32 v187, v8 offset:2880
    v_mfma_f32_16x16x32_bf16 v[80:83], v[140:143], v[168:171], v[80:83]
    v_fma_f32 v90, -v188, v218, v90
    ds_read_b32 v189, v8 offset:2944
    s_waitcnt lgkmcnt(5)
    v_mfma_f32_16x16x32_bf16 v[96:99], v[168:171], v[144:147], v[96:99]
    v_fma_f32 v91, -v188, v219, v91
    ds_read_b32 v191, v8 offset:3008
    v_mfma_f32_16x16x32_bf16 v[100:103], v[172:175], v[144:147], v[100:103]
    v_fma_f32 v92, -v190, v216, v92
    v_fma_f32 v93, -v190, v217, v93
    v_mfma_f32_16x16x32_bf16 v[116:119], v[172:175], v[148:151], v[116:119]
    v_fma_f32 v94, -v190, v218, v94
    v_mfma_f32_16x16x32_bf16 v[112:115], v[168:171], v[148:151], v[112:115]
    v_fma_f32 v95, -v190, v219, v95
    s_waitcnt vmcnt(8)
    v_mfma_f32_16x16x32_bf16 v[40:43], v[128:131], v[176:179], v[40:43]
    s_waitcnt lgkmcnt(0)
    v_fma_f32 v32, -v184, v152, v32
    v_fma_f32 v33, -v184, v153, v33
    v_mfma_f32_16x16x32_bf16 v[44:47], v[128:131], v[180:183], v[44:47]
    v_fma_f32 v34, -v184, v154, v34
    v_mfma_f32_16x16x32_bf16 v[60:63], v[132:135], v[180:183], v[60:63]
    ds_read_b64_tr_b16 v[128:129], v24 offset:4096
    v_fma_f32 v35, -v184, v155, v35
    v_fma_f32 v36, -v186, v152, v36
    v_mfma_f32_16x16x32_bf16 v[56:59], v[132:135], v[176:179], v[56:59]
    ds_read_b64_tr_b16 v[130:131], v24 offset:4608
    v_fma_f32 v37, -v186, v153, v37
    v_mfma_f32_16x16x32_bf16 v[72:75], v[136:139], v[176:179], v[72:75]
    ds_read_b64_tr_b16 v[132:133], v25 offset:4096
    v_fma_f32 v38, -v186, v154, v38
    v_fma_f32 v39, -v186, v155, v39
    v_mfma_f32_16x16x32_bf16 v[76:79], v[136:139], v[180:183], v[76:79]
    ds_read_b64_tr_b16 v[134:135], v25 offset:4608
    v_fma_f32 v48, -v184, v156, v48
    v_mfma_f32_16x16x32_bf16 v[92:95], v[140:143], v[180:183], v[92:95]
    ds_read_b64_tr_b16 v[136:137], v24 offset:12288
    v_fma_f32 v49, -v184, v157, v49
    v_fma_f32 v50, -v184, v158, v50
    v_mfma_f32_16x16x32_bf16 v[88:91], v[140:143], v[176:179], v[88:91]
    ds_read_b64_tr_b16 v[138:139], v24 offset:12800
    v_fma_f32 v51, -v184, v159, v51
    v_mfma_f32_16x16x32_bf16 v[104:107], v[176:179], v[144:147], v[104:107]
    ds_read_b64_tr_b16 v[140:141], v25 offset:12288
    v_fma_f32 v52, -v186, v156, v52
    v_fma_f32 v53, -v186, v157, v53
    v_mfma_f32_16x16x32_bf16 v[108:111], v[180:183], v[144:147], v[108:111]
    ds_read_b64_tr_b16 v[142:143], v25 offset:12800
    v_fma_f32 v54, -v186, v158, v54
    v_mfma_f32_16x16x32_bf16 v[124:127], v[180:183], v[148:151], v[124:127]
    ds_read_b64_tr_b16 v[144:145], v24 offset:20480
    v_fma_f32 v55, -v186, v159, v55
    v_mfma_f32_16x16x32_bf16 v[120:123], v[176:179], v[148:151], v[120:123]
    ds_read_b64_tr_b16 v[146:147], v24 offset:20992
    s_waitcnt vmcnt(6) lgkmcnt(6)
    v_mfma_f32_16x16x32_bf16 v[32:35], v[128:131], a[0:3], v[32:35]
    ds_read_b64_tr_b16 v[148:149], v25 offset:20480
    v_fma_f32 v40, -v188, v152, v40
    v_fma_f32 v41, -v188, v153, v41
    v_mfma_f32_16x16x32_bf16 v[36:39], v[128:131], a[4:7], v[36:39]
    ds_read_b64_tr_b16 v[150:151], v25 offset:20992
    v_fma_f32 v42, -v188, v154, v42
    v_mfma_f32_16x16x32_bf16 v[52:55], v[132:135], a[4:7], v[52:55]
    v_fma_f32 v43, -v188, v155, v43
    v_fma_f32 v44, -v190, v152, v44
    ds_read_b128 v[168:171], v9 offset:1280
    v_mfma_f32_16x16x32_bf16 v[48:51], v[132:135], a[0:3], v[48:51]
    v_fma_f32 v45, -v190, v153, v45
    ds_read_b128 v[172:175], v9 offset:1344
    s_waitcnt lgkmcnt(6)
    v_mfma_f32_16x16x32_bf16 v[64:67], v[136:139], a[0:3], v[64:67]
    v_fma_f32 v46, -v190, v154, v46
    v_fma_f32 v47, -v190, v155, v47
    v_mfma_f32_16x16x32_bf16 v[68:71], v[136:139], a[4:7], v[68:71]
    v_fma_f32 v56, -v188, v156, v56
    ds_read_b128 v[176:179], v9 offset:1408
    v_mfma_f32_16x16x32_bf16 v[84:87], v[140:143], a[4:7], v[84:87]
    v_fma_f32 v57, -v188, v157, v57
    v_fma_f32 v58, -v188, v158, v58
    ds_read_b128 v[180:183], v9 offset:1472
    v_mfma_f32_16x16x32_bf16 v[80:83], v[140:143], a[0:3], v[80:83]
    v_fma_f32 v59, -v188, v159, v59
    s_waitcnt lgkmcnt(4)
    v_mfma_f32_16x16x32_bf16 v[96:99], a[0:3], v[144:147], v[96:99]
    v_fma_f32 v60, -v190, v156, v60
    v_fma_f32 v61, -v190, v157, v61
    ds_read2_b32 v[220:221], v11 offset0:160 offset1:176
    v_mfma_f32_16x16x32_bf16 v[100:103], a[4:7], v[144:147], v[100:103]
    v_fma_f32 v62, -v190, v158, v62
    v_mfma_f32_16x16x32_bf16 v[116:119], a[4:7], v[148:151], v[116:119]
    v_fma_f32 v63, -v190, v159, v63
    v_mfma_f32_16x16x32_bf16 v[112:115], a[0:3], v[148:151], v[112:115]
    s_waitcnt vmcnt(4)
    v_mfma_f32_16x16x32_bf16 v[40:43], v[128:131], a[8:11], v[40:43]
    v_mfma_f32_16x16x32_bf16 v[44:47], v[128:131], a[12:15], v[44:47]
    s_waitcnt lgkmcnt(0)
    v_fma_f32 v96, -v168, v220, v96
    v_fma_f32 v97, -v169, v220, v97
    v_mfma_f32_16x16x32_bf16 v[60:63], v[132:135], a[12:15], v[60:63]
    ds_read_b64_tr_b16 v[128:129], v24 offset:6144
    v_fma_f32 v98, -v170, v220, v98
    v_mfma_f32_16x16x32_bf16 v[56:59], v[132:135], a[8:11], v[56:59]
    ds_read_b64_tr_b16 v[130:131], v24 offset:6656
    v_fma_f32 v99, -v171, v220, v99
    v_fma_f32 v100, -v172, v220, v100
    v_mfma_f32_16x16x32_bf16 v[72:75], v[136:139], a[8:11], v[72:75]
    ds_read_b64_tr_b16 v[132:133], v25 offset:6144
    v_fma_f32 v101, -v173, v220, v101
    v_mfma_f32_16x16x32_bf16 v[76:79], v[136:139], a[12:15], v[76:79]
    ds_read_b64_tr_b16 v[134:135], v25 offset:6656
    v_fma_f32 v102, -v174, v220, v102
    v_fma_f32 v103, -v175, v220, v103
    v_mfma_f32_16x16x32_bf16 v[92:95], v[140:143], a[12:15], v[92:95]
    ds_read_b64_tr_b16 v[136:137], v24 offset:14336
    v_fma_f32 v112, -v168, v221, v112
    v_mfma_f32_16x16x32_bf16 v[88:91], v[140:143], a[8:11], v[88:91]
    ds_read_b64_tr_b16 v[138:139], v24 offset:14848
    v_fma_f32 v113, -v169, v221, v113
    v_fma_f32 v114, -v170, v221, v114
    v_mfma_f32_16x16x32_bf16 v[104:107], a[8:11], v[144:147], v[104:107]
    ds_read_b64_tr_b16 v[140:141], v25 offset:14336
    v_fma_f32 v115, -v171, v221, v115
    v_mfma_f32_16x16x32_bf16 v[108:111], a[12:15], v[144:147], v[108:111]
    ds_read_b64_tr_b16 v[142:143], v25 offset:14848
    v_fma_f32 v116, -v172, v221, v116
    v_fma_f32 v117, -v173, v221, v117
    v_mfma_f32_16x16x32_bf16 v[124:127], a[12:15], v[148:151], v[124:127]
    ds_read_b64_tr_b16 v[144:145], v24 offset:22528
    v_fma_f32 v118, -v174, v221, v118
    v_mfma_f32_16x16x32_bf16 v[120:123], a[8:11], v[148:151], v[120:123]
    ds_read_b64_tr_b16 v[146:147], v24 offset:23040
    v_fma_f32 v119, -v175, v221, v119
    s_waitcnt vmcnt(2) lgkmcnt(6)
    v_mfma_f32_16x16x32_bf16 v[32:35], v[128:131], a[16:19], v[32:35]
    ds_read_b64_tr_b16 v[148:149], v25 offset:22528
    v_mfma_f32_16x16x32_bf16 v[36:39], v[128:131], a[20:23], v[36:39]
    ds_read_b64_tr_b16 v[150:151], v25 offset:23040
    v_fma_f32 v104, -v176, v220, v104
    v_fma_f32 v105, -v177, v220, v105
    v_mfma_f32_16x16x32_bf16 v[52:55], v[132:135], a[20:23], v[52:55]
    v_fma_f32 v106, -v178, v220, v106
    ds_read_b128 v[152:155], v9 offset:2816
    v_mfma_f32_16x16x32_bf16 v[48:51], v[132:135], a[16:19], v[48:51]
    v_fma_f32 v107, -v179, v220, v107
    v_fma_f32 v108, -v180, v220, v108
    s_waitcnt lgkmcnt(5)
    v_mfma_f32_16x16x32_bf16 v[64:67], v[136:139], a[16:19], v[64:67]
    v_fma_f32 v109, -v181, v220, v109
    ds_read_b128 v[156:159], v9 offset:2880
    v_mfma_f32_16x16x32_bf16 v[68:71], v[136:139], a[20:23], v[68:71]
    v_fma_f32 v110, -v182, v220, v110
    v_fma_f32 v111, -v183, v220, v111
    v_mfma_f32_16x16x32_bf16 v[84:87], v[140:143], a[20:23], v[84:87]
    v_fma_f32 v120, -v176, v221, v120
    ds_read_b128 v[160:163], v9 offset:2944
    v_mfma_f32_16x16x32_bf16 v[80:83], v[140:143], a[16:19], v[80:83]
    v_fma_f32 v121, -v177, v221, v121
    v_fma_f32 v122, -v178, v221, v122
    s_waitcnt lgkmcnt(3)
    v_mfma_f32_16x16x32_bf16 v[96:99], a[16:19], v[144:147], v[96:99]
    v_fma_f32 v123, -v179, v221, v123
    ds_read_b128 v[164:167], v9 offset:3008
    v_mfma_f32_16x16x32_bf16 v[100:103], a[20:23], v[144:147], v[100:103]
    v_fma_f32 v124, -v180, v221, v124
    v_fma_f32 v125, -v181, v221, v125
    v_mfma_f32_16x16x32_bf16 v[116:119], a[20:23], v[148:151], v[116:119]
    v_fma_f32 v126, -v182, v221, v126
    v_mfma_f32_16x16x32_bf16 v[112:115], a[16:19], v[148:151], v[112:115]
    v_fma_f32 v127, -v183, v221, v127
    s_barrier
    s_waitcnt vmcnt(0)
    v_mfma_f32_16x16x32_bf16 v[40:43], v[128:131], a[24:27], v[40:43]
    v_mul_f32 v64, v185, v64
    v_mul_f32 v65, v185, v65
    v_mfma_f32_16x16x32_bf16 v[44:47], v[128:131], a[28:31], v[44:47]
    v_mul_f32 v66, v185, v66
    v_mul_f32 v67, v185, v67
    v_mfma_f32_16x16x32_bf16 v[60:63], v[132:135], a[28:31], v[60:63]
    v_mul_f32 v80, v185, v80
    v_mul_f32 v81, v185, v81
    v_mfma_f32_16x16x32_bf16 v[56:59], v[132:135], a[24:27], v[56:59]
    v_mul_f32 v82, v185, v82
    v_mul_f32 v83, v185, v83
    v_mfma_f32_16x16x32_bf16 v[72:75], v[136:139], a[24:27], v[72:75]
    v_cvt_pk_bf16_f32 v64, v64, v65
    v_cvt_pk_bf16_f32 v65, v66, v67
    v_mfma_f32_16x16x32_bf16 v[76:79], v[136:139], a[28:31], v[76:79]
    v_cvt_pk_bf16_f32 v66, v80, v81
    v_cvt_pk_bf16_f32 v67, v82, v83
    v_mfma_f32_16x16x32_bf16 v[92:95], v[140:143], a[28:31], v[92:95]
    v_mul_f32 v68, v187, v68
    v_mul_f32 v69, v187, v69
    v_mfma_f32_16x16x32_bf16 v[88:91], v[140:143], a[24:27], v[88:91]
    v_mul_f32 v70, v187, v70
    v_mul_f32 v71, v187, v71
    v_mfma_f32_16x16x32_bf16 v[104:107], a[24:27], v[144:147], v[104:107]
    v_mul_f32 v84, v187, v84
    v_mul_f32 v85, v187, v85
    v_mfma_f32_16x16x32_bf16 v[108:111], a[28:31], v[144:147], v[108:111]
    v_mul_f32 v86, v187, v86
    v_mul_f32 v87, v187, v87
    v_mfma_f32_16x16x32_bf16 v[124:127], a[28:31], v[148:151], v[124:127]
    v_cvt_pk_bf16_f32 v68, v68, v69
    v_cvt_pk_bf16_f32 v69, v70, v71
    v_mfma_f32_16x16x32_bf16 v[120:123], a[24:27], v[148:151], v[120:123]
    v_cvt_pk_bf16_f32 v70, v84, v85
    v_cvt_pk_bf16_f32 v71, v86, v87
    buffer_store_dwordx4 v[64:67], v12, s[12:15], s84 offen offset:0 sc1
    ds_write_b128 v12, v[64:67] offset:0
    buffer_store_dwordx4 v[68:71], v12, s[12:15], s84 offen offset:256 sc1
    ds_write_b128 v12, v[68:71] offset:256
    v_pk_mul_f32 v[72:73], v[188:189], v[72:73] op_sel:[1,0] op_sel_hi:[1,1]
    v_pk_mul_f32 v[74:75], v[188:189], v[74:75] op_sel:[1,0] op_sel_hi:[1,1]
    v_pk_mul_f32 v[88:89], v[188:189], v[88:89] op_sel:[1,0] op_sel_hi:[1,1]
    v_pk_mul_f32 v[90:91], v[188:189], v[90:91] op_sel:[1,0] op_sel_hi:[1,1]
    v_cvt_pk_bf16_f32 v72, v72, v73
    v_cvt_pk_bf16_f32 v73, v74, v75
    v_cvt_pk_bf16_f32 v74, v88, v89
    v_cvt_pk_bf16_f32 v75, v90, v91
    buffer_store_dwordx4 v[72:75], v12, s[12:15], s84 offen offset:2048 sc1
    ds_write_b128 v12, v[72:75] offset:2048
    v_pk_mul_f32 v[76:77], v[190:191], v[76:77] op_sel:[1,0] op_sel_hi:[1,1]
    v_pk_mul_f32 v[78:79], v[190:191], v[78:79] op_sel:[1,0] op_sel_hi:[1,1]
    v_pk_mul_f32 v[92:93], v[190:191], v[92:93] op_sel:[1,0] op_sel_hi:[1,1]
    v_pk_mul_f32 v[94:95], v[190:191], v[94:95] op_sel:[1,0] op_sel_hi:[1,1]
    v_cvt_pk_bf16_f32 v76, v76, v77
    v_cvt_pk_bf16_f32 v77, v78, v79
    v_cvt_pk_bf16_f32 v78, v92, v93
    v_cvt_pk_bf16_f32 v79, v94, v95
    buffer_store_dwordx4 v[76:79], v12, s[12:15], s84 offen offset:2304 sc1
    ds_write_b128 v12, v[76:79] offset:2304
    s_waitcnt lgkmcnt(4)
    v_pk_mul_f32 v[96:97], v[152:153], v[96:97]
    v_pk_mul_f32 v[98:99], v[154:155], v[98:99]
    v_pk_mul_f32 v[112:113], v[152:153], v[112:113]
    v_pk_mul_f32 v[114:115], v[154:155], v[114:115]
    v_cvt_pk_bf16_f32 v96, v96, v97
    v_cvt_pk_bf16_f32 v97, v98, v99
    v_cvt_pk_bf16_f32 v98, v112, v113
    v_cvt_pk_bf16_f32 v99, v114, v115
    v_mul_f32 v185, 0x3e8293ee, v185
    v_permlane16_swap_b32 v96, v98
    v_permlane16_swap_b32 v97, v99
    buffer_store_dwordx4 v[96:99], v13, s[12:15], s85 offen offset:0 sc1
    ds_write_b128 v13, v[96:99] offset:8192
    v_pk_mul_f32 v[100:101], v[156:157], v[100:101]
    v_pk_mul_f32 v[102:103], v[158:159], v[102:103]
    v_pk_mul_f32 v[116:117], v[156:157], v[116:117]
    v_pk_mul_f32 v[118:119], v[158:159], v[118:119]
    v_cvt_pk_bf16_f32 v100, v100, v101
    v_cvt_pk_bf16_f32 v101, v102, v103
    v_cvt_pk_bf16_f32 v102, v116, v117
    v_cvt_pk_bf16_f32 v103, v118, v119
    v_mul_f32 v187, 0x3e8293ee, v187
    v_permlane16_swap_b32 v100, v102
    v_permlane16_swap_b32 v101, v103
    buffer_store_dwordx4 v[100:103], v13, s[12:15], s85 offen offset:1024 sc1
    ds_write_b128 v13, v[100:103] offset:9216
    v_pk_mul_f32 v[104:105], v[160:161], v[104:105]
    v_pk_mul_f32 v[106:107], v[162:163], v[106:107]
    v_pk_mul_f32 v[120:121], v[160:161], v[120:121]
    v_pk_mul_f32 v[122:123], v[162:163], v[122:123]
    v_cvt_pk_bf16_f32 v104, v104, v105
    v_cvt_pk_bf16_f32 v105, v106, v107
    v_cvt_pk_bf16_f32 v106, v120, v121
    v_cvt_pk_bf16_f32 v107, v122, v123
    v_mul_f32 v189, 0x3e8293ee, v189
    v_permlane16_swap_b32 v104, v106
    v_permlane16_swap_b32 v105, v107
    buffer_store_dwordx4 v[104:107], v13, s[12:15], s85 offen offset:2048 sc1
    ds_write_b128 v13, v[104:107] offset:10240
    v_pk_mul_f32 v[108:109], v[164:165], v[108:109]
    v_pk_mul_f32 v[110:111], v[166:167], v[110:111]
    v_pk_mul_f32 v[124:125], v[164:165], v[124:125]
    v_pk_mul_f32 v[126:127], v[166:167], v[126:127]
    v_cvt_pk_bf16_f32 v108, v108, v109
    v_cvt_pk_bf16_f32 v109, v110, v111
    v_cvt_pk_bf16_f32 v110, v124, v125
    v_cvt_pk_bf16_f32 v111, v126, v127
    v_mul_f32 v191, 0x3e8293ee, v191
    v_permlane16_swap_b32 v108, v110
    v_permlane16_swap_b32 v109, v111
    buffer_store_dwordx4 v[108:111], v13, s[12:15], s85 offen offset:3072 sc1
    ds_write_b128 v13, v[108:111] offset:11264
    v_add_u32 v24, 81920, v5
    s_waitcnt lgkmcnt(0)
    s_barrier
    ds_read_b128 v[128:131], v24 offset:0
    ds_read_b128 v[132:135], v24 offset:1024
    ds_read_b128 v[136:139], v24 offset:2048
    ds_read_b128 v[140:143], v24 offset:3072
    v_pk_mul_f32 v[32:33], v[184:185], v[32:33] op_sel:[1,0] op_sel_hi:[1,1]
    v_pk_mul_f32 v[34:35], v[184:185], v[34:35] op_sel:[1,0] op_sel_hi:[1,1]
    v_pk_mul_f32 v[48:49], v[184:185], v[48:49] op_sel:[1,0] op_sel_hi:[1,1]
    v_pk_mul_f32 v[50:51], v[184:185], v[50:51] op_sel:[1,0] op_sel_hi:[1,1]
    v_cvt_pk_bf16_f32 v8, v32, v33
    v_cvt_pk_bf16_f32 v9, v34, v35
    v_cvt_pk_bf16_f32 v10, v48, v49
    v_cvt_pk_bf16_f32 v11, v50, v51
    v_pk_mul_f32 v[36:37], v[186:187], v[36:37] op_sel:[1,0] op_sel_hi:[1,1]
    v_pk_mul_f32 v[38:39], v[186:187], v[38:39] op_sel:[1,0] op_sel_hi:[1,1]
    v_pk_mul_f32 v[52:53], v[186:187], v[52:53] op_sel:[1,0] op_sel_hi:[1,1]
    v_pk_mul_f32 v[54:55], v[186:187], v[54:55] op_sel:[1,0] op_sel_hi:[1,1]
    v_cvt_pk_bf16_f32 v12, v36, v37
    v_cvt_pk_bf16_f32 v13, v38, v39
    v_cvt_pk_bf16_f32 v14, v52, v53
    v_cvt_pk_bf16_f32 v15, v54, v55
    v_pk_mul_f32 v[40:41], v[188:189], v[40:41] op_sel:[1,0] op_sel_hi:[1,1]
    v_pk_mul_f32 v[42:43], v[188:189], v[42:43] op_sel:[1,0] op_sel_hi:[1,1]
    v_pk_mul_f32 v[56:57], v[188:189], v[56:57] op_sel:[1,0] op_sel_hi:[1,1]
    v_pk_mul_f32 v[58:59], v[188:189], v[58:59] op_sel:[1,0] op_sel_hi:[1,1]
    v_cvt_pk_bf16_f32 v16, v40, v41
    v_cvt_pk_bf16_f32 v17, v42, v43
    v_cvt_pk_bf16_f32 v18, v56, v57
    v_cvt_pk_bf16_f32 v19, v58, v59
    v_pk_mul_f32 v[44:45], v[190:191], v[44:45] op_sel:[1,0] op_sel_hi:[1,1]
    v_pk_mul_f32 v[46:47], v[190:191], v[46:47] op_sel:[1,0] op_sel_hi:[1,1]
    v_pk_mul_f32 v[60:61], v[190:191], v[60:61] op_sel:[1,0] op_sel_hi:[1,1]
    v_pk_mul_f32 v[62:63], v[190:191], v[62:63] op_sel:[1,0] op_sel_hi:[1,1]
    v_cvt_pk_bf16_f32 v20, v44, v45
    v_cvt_pk_bf16_f32 v21, v46, v47
    v_cvt_pk_bf16_f32 v22, v60, v61
    v_cvt_pk_bf16_f32 v23, v62, v63
    v_permlane16_swap_b32 v8, v12
    v_permlane16_swap_b32 v9, v13
    v_permlane16_swap_b32 v10, v14
    v_permlane16_swap_b32 v11, v15
    v_permlane16_swap_b32 v16, v20
    v_permlane16_swap_b32 v17, v21
    v_permlane16_swap_b32 v18, v22
    v_permlane16_swap_b32 v19, v23
    s_waitcnt lgkmcnt(0)
    v_mfma_f32_32x32x16_bf16 v[64:79], v[128:131], v[8:11], 0
    v_mfma_f32_32x32x16_bf16 v[64:79], v[132:135], v[12:15], v[64:79]
    v_and_b32 v25, 7, v1
    v_mov_b32 v26, 0x3f803f80
    v_cmp_eq_u32 vcc, 0, v25
    s_nop 1
    v_cndmask_b32 v200, 0, v26, vcc
    v_cndmask_b32 v201, 0, v26, vcc
    v_cmp_eq_u32 vcc, 4, v25
    s_nop 1
    v_cndmask_b32 v202, 0, v26, vcc
    v_cndmask_b32 v203, 0, v26, vcc
    v_mov_b32 v204, 0xdddddddd
    v_mov_b32 v160, 0
    v_mov_b32 v161, 0
    v_mov_b32 v162, 0
    v_mov_b32 v163, 0
    v_mov_b32 v164, 0
    v_mov_b32 v165, 0
    v_mov_b32 v166, 0
    v_mov_b32 v167, 0
    v_mov_b32 v168, 0
    v_mov_b32 v169, 0
    v_mov_b32 v170, 0
    v_mov_b32 v171, 0
    v_mov_b32 v172, 0
    v_mov_b32 v173, 0
    v_mov_b32 v174, 0
    v_mov_b32 v175, 0
    v_mov_b32 v192, 0
    v_mov_b32 v193, 0
    v_mov_b32 v194, 0
    v_mov_b32 v195, 0
    v_mov_b32 v176, 0
    v_mov_b32 v177, 0
    v_mov_b32 v178, 0
    v_mov_b32 v179, 0
    v_mov_b32 v180, 0
    v_mov_b32 v181, 0
    v_mov_b32 v182, 0
    v_mov_b32 v183, 0
    v_mov_b32 v184, 0
    v_mov_b32 v185, 0
    v_mov_b32 v186, 0
    v_mov_b32 v187, 0
    v_mov_b32 v188, 0
    v_mov_b32 v189, 0
    v_mov_b32 v190, 0
    v_mov_b32 v191, 0
    v_mov_b32 v196, 0
    v_mov_b32 v197, 0
    v_mov_b32 v198, 0
    v_mov_b32 v199, 0
    v_mov_b32 v112, 0
    v_mov_b32 v113, 0
    v_mov_b32 v114, 0
    v_mov_b32 v115, 0
    v_mov_b32 v116, 0
    v_mov_b32 v117, 0
    v_mov_b32 v118, 0
    v_mov_b32 v119, 0
    v_mov_b32 v120, 0
    v_mov_b32 v121, 0
    v_mov_b32 v122, 0
    v_mov_b32 v123, 0
    v_mov_b32 v124, 0
    v_mov_b32 v125, 0
    v_mov_b32 v126, 0
    v_mov_b32 v127, 0
    v_mov_b32 v152, 0
    v_mov_b32 v153, 0
    v_mov_b32 v154, 0
    v_mov_b32 v155, 0
    v_mov_b32 v156, 0
    v_mov_b32 v157, 0
    v_mov_b32 v158, 0
    v_mov_b32 v159, 0
    s_mov_b32 s54, 4
.p2align 3
c_attn_loop:
    v_mfma_f32_32x32x16_bf16 v[80:95], v[128:131], v[16:19], 0
    v_exp_f32 v64, v64
    v_exp_f32 v65, v65
    v_exp_f32 v66, v66
    v_mfma_f32_32x32x16_bf16 v[80:95], v[132:135], v[20:23], v[80:95]
    v_exp_f32 v67, v67
    v_exp_f32 v68, v68
    v_exp_f32 v69, v69
    v_smfmac_f32_32x32x32_bf16 v[176:191], v[152:155], v[112:119], v204
    s_waitcnt lgkmcnt(0)
    v_exp_f32 v70, v70
    v_exp_f32 v71, v71
    v_exp_f32 v72, v72
    v_smfmac_f32_16x16x64_bf16 v[196:199], v[200:203], v[112:119], v204
    ds_read_b128 v[144:147], v24 offset:8192
    v_exp_f32 v73, v73
    v_exp_f32 v74, v74
    v_smfmac_f32_32x32x32_bf16 v[176:191], v[156:159], v[120:127], v204
    v_exp_f32 v75, v75
    v_exp_f32 v76, v76
    v_exp_f32 v77, v77
    v_smfmac_f32_16x16x64_bf16 v[196:199], v[200:203], v[120:127], v204
    ds_read_b128 v[148:151], v24 offset:9216
    v_exp_f32 v78, v78
    v_exp_f32 v79, v79
    v_mfma_f32_32x32x16_bf16 v[96:111], v[136:139], v[8:11], 0
    v_exp_f32 v80, v80
    v_exp_f32 v81, v81
    v_exp_f32 v82, v82
    v_mfma_f32_32x32x16_bf16 v[96:111], v[140:143], v[12:15], v[96:111]
    s_waitcnt lgkmcnt(1)
    v_exp_f32 v83, v83
    v_exp_f32 v84, v84
    v_exp_f32 v85, v85
    v_smfmac_f32_32x32x32_bf16 v[160:175], v[144:147], v[64:71], v204
    s_waitcnt lgkmcnt(0)
    v_exp_f32 v86, v86
    v_exp_f32 v87, v87
    v_exp_f32 v88, v88
    v_smfmac_f32_16x16x64_bf16 v[192:195], v[200:203], v[64:71], v204
    ds_read_b128 v[128:131], v24 offset:4096
    v_exp_f32 v89, v89
    v_exp_f32 v90, v90
    v_smfmac_f32_32x32x32_bf16 v[160:175], v[148:151], v[72:79], v204
    v_exp_f32 v91, v91
    v_exp_f32 v92, v92
    v_exp_f32 v93, v93
    v_smfmac_f32_16x16x64_bf16 v[192:195], v[200:203], v[72:79], v204
    ds_read_b128 v[132:135], v24 offset:5120
    v_exp_f32 v94, v94
    v_exp_f32 v95, v95
    v_mfma_f32_32x32x16_bf16 v[112:127], v[136:139], v[16:19], 0
    s_cmp_eq_u32 s54, 4
    v_exp_f32 v96, v96
    v_exp_f32 v97, v97
    v_exp_f32 v98, v98
    v_mfma_f32_32x32x16_bf16 v[112:127], v[140:143], v[20:23], v[112:127]
    v_exp_f32 v99, v99
    v_exp_f32 v100, v100
    v_exp_f32 v101, v101
    v_smfmac_f32_32x32x32_bf16 v[176:191], v[144:147], v[80:87], v204
    s_waitcnt lgkmcnt(0)
    v_exp_f32 v102, v102
    v_exp_f32 v103, v103
    v_exp_f32 v104, v104
    v_smfmac_f32_16x16x64_bf16 v[196:199], v[200:203], v[80:87], v204
    ds_read_b128 v[152:155], v24 offset:10240
    v_exp_f32 v105, v105
    v_exp_f32 v106, v106
    v_smfmac_f32_32x32x32_bf16 v[176:191], v[148:151], v[88:95], v204
    v_exp_f32 v107, v107
    v_exp_f32 v108, v108
    v_exp_f32 v109, v109
    v_smfmac_f32_16x16x64_bf16 v[196:199], v[200:203], v[88:95], v204
    ds_read_b128 v[156:159], v24 offset:11264
    v_exp_f32 v110, v110
    v_exp_f32 v111, v111
    v_mfma_f32_32x32x16_bf16 v[64:79], v[128:131], v[8:11], 0
    s_cbranch_scc0 c_attn_nofl
    s_mov_b64 exec, 0xff
    s_waitcnt vmcnt(0)
    buffer_store_dword v29, v28, s[12:15], s53 offen sc1
    s_mov_b64 exec, -1
c_attn_nofl:
    v_exp_f32 v112, v112
    v_exp_f32 v113, v113
    v_exp_f32 v114, v114
    v_mfma_f32_32x32x16_bf16 v[64:79], v[132:135], v[12:15], v[64:79]
    s_waitcnt lgkmcnt(1)
    v_exp_f32 v115, v115
    v_exp_f32 v116, v116
    v_exp_f32 v117, v117
    v_smfmac_f32_32x32x32_bf16 v[160:175], v[152:155], v[96:103], v204
    s_waitcnt lgkmcnt(0)
    v_exp_f32 v118, v118
    v_exp_f32 v119, v119
    v_exp_f32 v120, v120
    v_smfmac_f32_16x16x64_bf16 v[192:195], v[200:203], v[96:103], v204
    ds_read_b128 v[136:139], v24 offset:6144
    v_exp_f32 v121, v121
    v_exp_f32 v122, v122
    v_smfmac_f32_32x32x32_bf16 v[160:175], v[156:159], v[104:111], v204
    v_exp_f32 v123, v123
    v_exp_f32 v124, v124
    v_exp_f32 v125, v125
    v_smfmac_f32_16x16x64_bf16 v[192:195], v[200:203], v[104:111], v204
    ds_read_b128 v[140:143], v24 offset:7168
    v_exp_f32 v126, v126
    v_exp_f32 v127, v127
    v_mfma_f32_32x32x16_bf16 v[80:95], v[128:131], v[16:19], 0
    s_cmp_eq_u32 s54, 4
    v_exp_f32 v64, v64
    v_exp_f32 v65, v65
    v_exp_f32 v66, v66
    v_mfma_f32_32x32x16_bf16 v[80:95], v[132:135], v[20:23], v[80:95]
    v_exp_f32 v67, v67
    v_exp_f32 v68, v68
    v_exp_f32 v69, v69
    v_smfmac_f32_32x32x32_bf16 v[176:191], v[152:155], v[112:119], v204
    s_waitcnt lgkmcnt(0)
    v_exp_f32 v70, v70
    v_exp_f32 v71, v71
    v_exp_f32 v72, v72
    v_smfmac_f32_16x16x64_bf16 v[196:199], v[200:203], v[112:119], v204
    ds_read_b128 v[144:147], v24 offset:12288
    v_exp_f32 v73, v73
    v_exp_f32 v74, v74
    v_smfmac_f32_32x32x32_bf16 v[176:191], v[156:159], v[120:127], v204
    v_exp_f32 v75, v75
    v_exp_f32 v76, v76
    v_exp_f32 v77, v77
    v_smfmac_f32_16x16x64_bf16 v[196:199], v[200:203], v[120:127], v204
    ds_read_b128 v[148:151], v24 offset:13312
    v_exp_f32 v78, v78
    v_exp_f32 v79, v79
    v_mfma_f32_32x32x16_bf16 v[96:111], v[136:139], v[8:11], 0
    s_cbranch_scc1 c_attn_nobar
    s_barrier
c_attn_nobar:
    v_exp_f32 v80, v80
    v_exp_f32 v81, v81
    v_exp_f32 v82, v82
    v_mfma_f32_32x32x16_bf16 v[96:111], v[140:143], v[12:15], v[96:111]
    s_waitcnt lgkmcnt(1)
    v_exp_f32 v83, v83
    v_exp_f32 v84, v84
    v_exp_f32 v85, v85
    v_smfmac_f32_32x32x32_bf16 v[160:175], v[144:147], v[64:71], v204
    s_waitcnt lgkmcnt(0)
    v_exp_f32 v86, v86
    v_exp_f32 v87, v87
    v_exp_f32 v88, v88
    v_smfmac_f32_16x16x64_bf16 v[192:195], v[200:203], v[64:71], v204
    ds_read_b128 v[128:131], v24 offset:16384
    v_exp_f32 v89, v89
    v_exp_f32 v90, v90
    v_smfmac_f32_32x32x32_bf16 v[160:175], v[148:151], v[72:79], v204
    v_exp_f32 v91, v91
    v_exp_f32 v92, v92
    v_exp_f32 v93, v93
    v_smfmac_f32_16x16x64_bf16 v[192:195], v[200:203], v[72:79], v204
    ds_read_b128 v[132:135], v24 offset:17408
    v_exp_f32 v94, v94
    v_exp_f32 v95, v95
    v_mfma_f32_32x32x16_bf16 v[112:127], v[136:139], v[16:19], 0
    v_exp_f32 v96, v96
    v_exp_f32 v97, v97
    v_exp_f32 v98, v98
    v_mfma_f32_32x32x16_bf16 v[112:127], v[140:143], v[20:23], v[112:127]
    v_exp_f32 v99, v99
    v_exp_f32 v100, v100
    v_exp_f32 v101, v101
    v_smfmac_f32_32x32x32_bf16 v[176:191], v[144:147], v[80:87], v204
    s_waitcnt lgkmcnt(0)
    v_exp_f32 v102, v102
    v_exp_f32 v103, v103
    v_exp_f32 v104, v104
    v_smfmac_f32_16x16x64_bf16 v[196:199], v[200:203], v[80:87], v204
    ds_read_b128 v[152:155], v24 offset:14336
    v_exp_f32 v105, v105
    v_exp_f32 v106, v106
    v_smfmac_f32_32x32x32_bf16 v[176:191], v[148:151], v[88:95], v204
    v_exp_f32 v107, v107
    v_exp_f32 v108, v108
    v_exp_f32 v109, v109
    v_smfmac_f32_16x16x64_bf16 v[196:199], v[200:203], v[88:95], v204
    ds_read_b128 v[156:159], v24 offset:15360
    v_exp_f32 v110, v110
    v_exp_f32 v111, v111
    v_mfma_f32_32x32x16_bf16 v[64:79], v[128:131], v[8:11], 0
    v_exp_f32 v112, v112
    v_exp_f32 v113, v113
    v_exp_f32 v114, v114
    v_mfma_f32_32x32x16_bf16 v[64:79], v[132:135], v[12:15], v[64:79]
    s_waitcnt lgkmcnt(1)
    v_exp_f32 v115, v115
    v_exp_f32 v116, v116
    v_exp_f32 v117, v117
    v_smfmac_f32_32x32x32_bf16 v[160:175], v[152:155], v[96:103], v204
    s_waitcnt lgkmcnt(0)
    v_exp_f32 v118, v118
    v_exp_f32 v119, v119
    v_exp_f32 v120, v120
    v_smfmac_f32_16x16x64_bf16 v[192:195], v[200:203], v[96:103], v204
    ds_read_b128 v[136:139], v24 offset:18432
    v_exp_f32 v121, v121
    v_exp_f32 v122, v122
    v_smfmac_f32_32x32x32_bf16 v[160:175], v[156:159], v[104:111], v204
    v_exp_f32 v123, v123
    v_exp_f32 v124, v124
    v_exp_f32 v125, v125
    v_smfmac_f32_16x16x64_bf16 v[192:195], v[200:203], v[104:111], v204
    ds_read_b128 v[140:143], v24 offset:19456
    v_exp_f32 v126, v126
    v_exp_f32 v127, v127
    v_mfma_f32_32x32x16_bf16 v[80:95], v[128:131], v[16:19], 0
    v_exp_f32 v64, v64
    v_exp_f32 v65, v65
    v_exp_f32 v66, v66
    v_mfma_f32_32x32x16_bf16 v[80:95], v[132:135], v[20:23], v[80:95]
    v_exp_f32 v67, v67
    v_exp_f32 v68, v68
    v_exp_f32 v69, v69
    v_smfmac_f32_32x32x32_bf16 v[176:191], v[152:155], v[112:119], v204
    s_waitcnt lgkmcnt(0)
    v_exp_f32 v70, v70
    v_exp_f32 v71, v71
    v_exp_f32 v72, v72
    v_smfmac_f32_16x16x64_bf16 v[196:199], v[200:203], v[112:119], v204
    ds_read_b128 v[144:147], v24 offset:24576
    v_exp_f32 v73, v73
    v_exp_f32 v74, v74
    v_smfmac_f32_32x32x32_bf16 v[176:191], v[156:159], v[120:127], v204
    v_exp_f32 v75, v75
    v_exp_f32 v76, v76
    v_exp_f32 v77, v77
    v_smfmac_f32_16x16x64_bf16 v[196:199], v[200:203], v[120:127], v204
    ds_read_b128 v[148:151], v24 offset:25600
    v_exp_f32 v78, v78
    v_exp_f32 v79, v79
    v_mfma_f32_32x32x16_bf16 v[96:111], v[136:139], v[8:11], 0
    v_exp_f32 v80, v80
    v_exp_f32 v81, v81
    v_exp_f32 v82, v82
    v_mfma_f32_32x32x16_bf16 v[96:111], v[140:143], v[12:15], v[96:111]
    s_waitcnt lgkmcnt(1)
    v_exp_f32 v83, v83
    v_exp_f32 v84, v84
    v_exp_f32 v85, v85
    v_smfmac_f32_32x32x32_bf16 v[160:175], v[144:147], v[64:71], v204
    s_waitcnt lgkmcnt(0)
    v_exp_f32 v86, v86
    v_exp_f32 v87, v87
    v_exp_f32 v88, v88
    v_smfmac_f32_16x16x64_bf16 v[192:195], v[200:203], v[64:71], v204
    ds_read_b128 v[128:131], v24 offset:20480
    v_exp_f32 v89, v89
    v_exp_f32 v90, v90
    v_smfmac_f32_32x32x32_bf16 v[160:175], v[148:151], v[72:79], v204
    v_exp_f32 v91, v91
    v_exp_f32 v92, v92
    v_exp_f32 v93, v93
    v_smfmac_f32_16x16x64_bf16 v[192:195], v[200:203], v[72:79], v204
    ds_read_b128 v[132:135], v24 offset:21504
    v_exp_f32 v94, v94
    v_exp_f32 v95, v95
    v_mfma_f32_32x32x16_bf16 v[112:127], v[136:139], v[16:19], 0
    v_exp_f32 v96, v96
    v_exp_f32 v97, v97
    v_exp_f32 v98, v98
    v_mfma_f32_32x32x16_bf16 v[112:127], v[140:143], v[20:23], v[112:127]
    v_exp_f32 v99, v99
    v_exp_f32 v100, v100
    v_exp_f32 v101, v101
    v_smfmac_f32_32x32x32_bf16 v[176:191], v[144:147], v[80:87], v204
    s_waitcnt lgkmcnt(0)
    v_exp_f32 v102, v102
    v_exp_f32 v103, v103
    v_exp_f32 v104, v104
    v_smfmac_f32_16x16x64_bf16 v[196:199], v[200:203], v[80:87], v204
    ds_read_b128 v[152:155], v24 offset:26624
    v_exp_f32 v105, v105
    v_exp_f32 v106, v106
    v_smfmac_f32_32x32x32_bf16 v[176:191], v[148:151], v[88:95], v204
    v_exp_f32 v107, v107
    v_exp_f32 v108, v108
    v_exp_f32 v109, v109
    v_smfmac_f32_16x16x64_bf16 v[196:199], v[200:203], v[88:95], v204
    ds_read_b128 v[156:159], v24 offset:27648
    v_exp_f32 v110, v110
    v_exp_f32 v111, v111
    v_mfma_f32_32x32x16_bf16 v[64:79], v[128:131], v[8:11], 0
    v_exp_f32 v112, v112
    v_exp_f32 v113, v113
    v_exp_f32 v114, v114
    v_mfma_f32_32x32x16_bf16 v[64:79], v[132:135], v[12:15], v[64:79]
    s_waitcnt lgkmcnt(1)
    v_exp_f32 v115, v115
    v_exp_f32 v116, v116
    v_exp_f32 v117, v117
    v_smfmac_f32_32x32x32_bf16 v[160:175], v[152:155], v[96:103], v204
    s_waitcnt lgkmcnt(0)
    v_exp_f32 v118, v118
    v_exp_f32 v119, v119
    v_exp_f32 v120, v120
    v_smfmac_f32_16x16x64_bf16 v[192:195], v[200:203], v[96:103], v204
    ds_read_b128 v[136:139], v24 offset:22528
    v_exp_f32 v121, v121
    v_exp_f32 v122, v122
    v_smfmac_f32_32x32x32_bf16 v[160:175], v[156:159], v[104:111], v204
    v_exp_f32 v123, v123
    v_exp_f32 v124, v124
    v_exp_f32 v125, v125
    v_smfmac_f32_16x16x64_bf16 v[192:195], v[200:203], v[104:111], v204
    ds_read_b128 v[140:143], v24 offset:23552
    v_exp_f32 v126, v126
    v_exp_f32 v127, v127
    v_mfma_f32_32x32x16_bf16 v[80:95], v[128:131], v[16:19], 0
    v_exp_f32 v64, v64
    v_exp_f32 v65, v65
    v_exp_f32 v66, v66
    v_mfma_f32_32x32x16_bf16 v[80:95], v[132:135], v[20:23], v[80:95]
    v_exp_f32 v67, v67
    v_exp_f32 v68, v68
    v_exp_f32 v69, v69
    v_smfmac_f32_32x32x32_bf16 v[176:191], v[152:155], v[112:119], v204
    s_waitcnt lgkmcnt(0)
    v_exp_f32 v70, v70
    v_exp_f32 v71, v71
    v_exp_f32 v72, v72
    v_smfmac_f32_16x16x64_bf16 v[196:199], v[200:203], v[112:119], v204
    ds_read_b128 v[144:147], v24 offset:28672
    v_exp_f32 v73, v73
    v_exp_f32 v74, v74
    v_smfmac_f32_32x32x32_bf16 v[176:191], v[156:159], v[120:127], v204
    v_exp_f32 v75, v75
    v_exp_f32 v76, v76
    v_exp_f32 v77, v77
    v_smfmac_f32_16x16x64_bf16 v[196:199], v[200:203], v[120:127], v204
    ds_read_b128 v[148:151], v24 offset:29696
    v_exp_f32 v78, v78
    v_exp_f32 v79, v79
    v_mfma_f32_32x32x16_bf16 v[96:111], v[136:139], v[8:11], 0
    v_exp_f32 v80, v80
    v_exp_f32 v81, v81
    v_exp_f32 v82, v82
    v_mfma_f32_32x32x16_bf16 v[96:111], v[140:143], v[12:15], v[96:111]
    s_waitcnt lgkmcnt(1)
    v_exp_f32 v83, v83
    v_exp_f32 v84, v84
    v_exp_f32 v85, v85
    v_smfmac_f32_32x32x32_bf16 v[160:175], v[144:147], v[64:71], v204
    s_waitcnt lgkmcnt(0)
    s_barrier
    v_exp_f32 v86, v86
    v_exp_f32 v87, v87
    v_exp_f32 v88, v88
    v_smfmac_f32_16x16x64_bf16 v[192:195], v[200:203], v[64:71], v204
    ds_read_b128 v[128:131], v24 offset:32768
    v_exp_f32 v89, v89
    v_exp_f32 v90, v90
    v_smfmac_f32_32x32x32_bf16 v[160:175], v[148:151], v[72:79], v204
    v_exp_f32 v91, v91
    v_exp_f32 v92, v92
    v_exp_f32 v93, v93
    v_smfmac_f32_16x16x64_bf16 v[192:195], v[200:203], v[72:79], v204
    ds_read_b128 v[132:135], v24 offset:33792
    v_exp_f32 v94, v94
    v_exp_f32 v95, v95
    v_mfma_f32_32x32x16_bf16 v[112:127], v[136:139], v[16:19], 0
    v_exp_f32 v96, v96
    v_exp_f32 v97, v97
    v_exp_f32 v98, v98
    v_mfma_f32_32x32x16_bf16 v[112:127], v[140:143], v[20:23], v[112:127]
    v_exp_f32 v99, v99
    v_exp_f32 v100, v100
    v_exp_f32 v101, v101
    v_smfmac_f32_32x32x32_bf16 v[176:191], v[144:147], v[80:87], v204
    s_waitcnt lgkmcnt(0)
    v_exp_f32 v102, v102
    v_exp_f32 v103, v103
    v_exp_f32 v104, v104
    v_smfmac_f32_16x16x64_bf16 v[196:199], v[200:203], v[80:87], v204
    ds_read_b128 v[152:155], v24 offset:30720
    v_exp_f32 v105, v105
    v_exp_f32 v106, v106
    v_smfmac_f32_32x32x32_bf16 v[176:191], v[148:151], v[88:95], v204
    v_exp_f32 v107, v107
    v_exp_f32 v108, v108
    v_exp_f32 v109, v109
    v_smfmac_f32_16x16x64_bf16 v[196:199], v[200:203], v[88:95], v204
    ds_read_b128 v[156:159], v24 offset:31744
    v_exp_f32 v110, v110
    v_exp_f32 v111, v111
    v_mfma_f32_32x32x16_bf16 v[64:79], v[128:131], v[8:11], 0
    v_exp_f32 v112, v112
    v_exp_f32 v113, v113
    v_exp_f32 v114, v114
    v_mfma_f32_32x32x16_bf16 v[64:79], v[132:135], v[12:15], v[64:79]
    s_waitcnt lgkmcnt(1)
    v_exp_f32 v115, v115
    v_exp_f32 v116, v116
    v_exp_f32 v117, v117
    v_smfmac_f32_32x32x32_bf16 v[160:175], v[152:155], v[96:103], v204
    s_waitcnt lgkmcnt(0)
    v_exp_f32 v118, v118
    v_exp_f32 v119, v119
    v_exp_f32 v120, v120
    v_smfmac_f32_16x16x64_bf16 v[192:195], v[200:203], v[96:103], v204
    ds_read_b128 v[136:139], v24 offset:34816
    v_exp_f32 v121, v121
    v_exp_f32 v122, v122
    v_smfmac_f32_32x32x32_bf16 v[160:175], v[156:159], v[104:111], v204
    v_exp_f32 v123, v123
    v_exp_f32 v124, v124
    v_exp_f32 v125, v125
    v_smfmac_f32_16x16x64_bf16 v[192:195], v[200:203], v[104:111], v204
    ds_read_b128 v[140:143], v24 offset:35840
    v_exp_f32 v126, v126
    v_exp_f32 v127, v127
    v_mfma_f32_32x32x16_bf16 v[80:95], v[128:131], v[16:19], 0
    v_exp_f32 v64, v64
    v_exp_f32 v65, v65
    v_exp_f32 v66, v66
    v_mfma_f32_32x32x16_bf16 v[80:95], v[132:135], v[20:23], v[80:95]
    v_exp_f32 v67, v67
    v_exp_f32 v68, v68
    v_exp_f32 v69, v69
    v_smfmac_f32_32x32x32_bf16 v[176:191], v[152:155], v[112:119], v204
    s_waitcnt lgkmcnt(0)
    v_exp_f32 v70, v70
    v_exp_f32 v71, v71
    v_exp_f32 v72, v72
    v_smfmac_f32_16x16x64_bf16 v[196:199], v[200:203], v[112:119], v204
    ds_read_b128 v[144:147], v24 offset:40960
    v_exp_f32 v73, v73
    v_exp_f32 v74, v74
    v_smfmac_f32_32x32x32_bf16 v[176:191], v[156:159], v[120:127], v204
    v_exp_f32 v75, v75
    v_exp_f32 v76, v76
    v_exp_f32 v77, v77
    v_smfmac_f32_16x16x64_bf16 v[196:199], v[200:203], v[120:127], v204
    ds_read_b128 v[148:151], v24 offset:41984
    v_exp_f32 v78, v78
    v_exp_f32 v79, v79
    v_mfma_f32_32x32x16_bf16 v[96:111], v[136:139], v[8:11], 0
    v_exp_f32 v80, v80
    v_exp_f32 v81, v81
    v_exp_f32 v82, v82
    v_mfma_f32_32x32x16_bf16 v[96:111], v[140:143], v[12:15], v[96:111]
    s_waitcnt lgkmcnt(1)
    v_exp_f32 v83, v83
    v_exp_f32 v84, v84
    v_exp_f32 v85, v85
    v_smfmac_f32_32x32x32_bf16 v[160:175], v[144:147], v[64:71], v204
    s_waitcnt lgkmcnt(0)
    v_exp_f32 v86, v86
    v_exp_f32 v87, v87
    v_exp_f32 v88, v88
    v_smfmac_f32_16x16x64_bf16 v[192:195], v[200:203], v[64:71], v204
    ds_read_b128 v[128:131], v24 offset:36864
    v_exp_f32 v89, v89
    v_exp_f32 v90, v90
    v_smfmac_f32_32x32x32_bf16 v[160:175], v[148:151], v[72:79], v204
    v_exp_f32 v91, v91
    v_exp_f32 v92, v92
    v_exp_f32 v93, v93
    v_smfmac_f32_16x16x64_bf16 v[192:195], v[200:203], v[72:79], v204
    ds_read_b128 v[132:135], v24 offset:37888
    v_exp_f32 v94, v94
    v_exp_f32 v95, v95
    v_mfma_f32_32x32x16_bf16 v[112:127], v[136:139], v[16:19], 0
    v_exp_f32 v96, v96
    v_exp_f32 v97, v97
    v_exp_f32 v98, v98
    v_mfma_f32_32x32x16_bf16 v[112:127], v[140:143], v[20:23], v[112:127]
    v_exp_f32 v99, v99
    v_exp_f32 v100, v100
    v_exp_f32 v101, v101
    v_smfmac_f32_32x32x32_bf16 v[176:191], v[144:147], v[80:87], v204
    s_waitcnt lgkmcnt(0)
    v_exp_f32 v102, v102
    v_exp_f32 v103, v103
    v_exp_f32 v104, v104
    v_smfmac_f32_16x16x64_bf16 v[196:199], v[200:203], v[80:87], v204
    ds_read_b128 v[152:155], v24 offset:43008
    v_exp_f32 v105, v105
    v_exp_f32 v106, v106
    v_smfmac_f32_32x32x32_bf16 v[176:191], v[148:151], v[88:95], v204
    v_exp_f32 v107, v107
    v_exp_f32 v108, v108
    v_exp_f32 v109, v109
    v_smfmac_f32_16x16x64_bf16 v[196:199], v[200:203], v[88:95], v204
    ds_read_b128 v[156:159], v24 offset:44032
    v_exp_f32 v110, v110
    v_exp_f32 v111, v111
    v_mfma_f32_32x32x16_bf16 v[64:79], v[128:131], v[8:11], 0
    v_exp_f32 v112, v112
    v_exp_f32 v113, v113
    v_exp_f32 v114, v114
    v_mfma_f32_32x32x16_bf16 v[64:79], v[132:135], v[12:15], v[64:79]
    s_waitcnt lgkmcnt(1)
    v_exp_f32 v115, v115
    v_exp_f32 v116, v116
    v_exp_f32 v117, v117
    v_smfmac_f32_32x32x32_bf16 v[160:175], v[152:155], v[96:103], v204
    s_waitcnt lgkmcnt(0)
    v_exp_f32 v118, v118
    v_exp_f32 v119, v119
    v_exp_f32 v120, v120
    v_smfmac_f32_16x16x64_bf16 v[192:195], v[200:203], v[96:103], v204
    ds_read_b128 v[136:139], v24 offset:38912
    v_exp_f32 v121, v121
    v_exp_f32 v122, v122
    v_smfmac_f32_32x32x32_bf16 v[160:175], v[156:159], v[104:111], v204
    v_exp_f32 v123, v123
    v_exp_f32 v124, v124
    v_exp_f32 v125, v125
    v_smfmac_f32_16x16x64_bf16 v[192:195], v[200:203], v[104:111], v204
    ds_read_b128 v[140:143], v24 offset:39936
    v_exp_f32 v126, v126
    v_exp_f32 v127, v127
    v_mfma_f32_32x32x16_bf16 v[80:95], v[128:131], v[16:19], 0
    v_exp_f32 v64, v64
    v_exp_f32 v65, v65
    v_exp_f32 v66, v66
    v_mfma_f32_32x32x16_bf16 v[80:95], v[132:135], v[20:23], v[80:95]
    v_exp_f32 v67, v67
    v_exp_f32 v68, v68
    v_exp_f32 v69, v69
    v_smfmac_f32_32x32x32_bf16 v[176:191], v[152:155], v[112:119], v204
    s_waitcnt lgkmcnt(0)
    v_exp_f32 v70, v70
    v_exp_f32 v71, v71
    v_exp_f32 v72, v72
    v_smfmac_f32_16x16x64_bf16 v[196:199], v[200:203], v[112:119], v204
    ds_read_b128 v[144:147], v24 offset:45056
    v_exp_f32 v73, v73
    v_exp_f32 v74, v74
    v_smfmac_f32_32x32x32_bf16 v[176:191], v[156:159], v[120:127], v204
    v_exp_f32 v75, v75
    v_exp_f32 v76, v76
    v_exp_f32 v77, v77
    v_smfmac_f32_16x16x64_bf16 v[196:199], v[200:203], v[120:127], v204
    ds_read_b128 v[148:151], v24 offset:46080
    v_exp_f32 v78, v78
    v_exp_f32 v79, v79
    v_mfma_f32_32x32x16_bf16 v[96:111], v[136:139], v[8:11], 0
    v_exp_f32 v80, v80
    v_exp_f32 v81, v81
    v_exp_f32 v82, v82
    v_mfma_f32_32x32x16_bf16 v[96:111], v[140:143], v[12:15], v[96:111]
    s_waitcnt lgkmcnt(1)
    v_exp_f32 v83, v83
    v_exp_f32 v84, v84
    v_exp_f32 v85, v85
    v_smfmac_f32_32x32x32_bf16 v[160:175], v[144:147], v[64:71], v204
    s_waitcnt lgkmcnt(0)
    s_barrier
    v_exp_f32 v86, v86
    v_exp_f32 v87, v87
    v_exp_f32 v88, v88
    v_smfmac_f32_16x16x64_bf16 v[192:195], v[200:203], v[64:71], v204
    ds_read_b128 v[128:131], v24 offset:49152
    v_exp_f32 v89, v89
    v_exp_f32 v90, v90
    v_smfmac_f32_32x32x32_bf16 v[160:175], v[148:151], v[72:79], v204
    v_exp_f32 v91, v91
    v_exp_f32 v92, v92
    v_exp_f32 v93, v93
    v_smfmac_f32_16x16x64_bf16 v[192:195], v[200:203], v[72:79], v204
    ds_read_b128 v[132:135], v24 offset:50176
    v_exp_f32 v94, v94
    v_exp_f32 v95, v95
    v_mfma_f32_32x32x16_bf16 v[112:127], v[136:139], v[16:19], 0
    v_exp_f32 v96, v96
    v_exp_f32 v97, v97
    v_exp_f32 v98, v98
    v_mfma_f32_32x32x16_bf16 v[112:127], v[140:143], v[20:23], v[112:127]
    v_exp_f32 v99, v99
    v_exp_f32 v100, v100
    v_exp_f32 v101, v101
    v_smfmac_f32_32x32x32_bf16 v[176:191], v[144:147], v[80:87], v204
    s_waitcnt lgkmcnt(0)
    v_exp_f32 v102, v102
    v_exp_f32 v103, v103
    v_exp_f32 v104, v104
    v_smfmac_f32_16x16x64_bf16 v[196:199], v[200:203], v[80:87], v204
    ds_read_b128 v[152:155], v24 offset:47104
    v_exp_f32 v105, v105
    v_exp_f32 v106, v106
    v_smfmac_f32_32x32x32_bf16 v[176:191], v[148:151], v[88:95], v204
    v_exp_f32 v107, v107
    v_exp_f32 v108, v108
    v_exp_f32 v109, v109
    v_smfmac_f32_16x16x64_bf16 v[196:199], v[200:203], v[88:95], v204
    ds_read_b128 v[156:159], v24 offset:48128
    v_exp_f32 v110, v110
    v_exp_f32 v111, v111
    v_mfma_f32_32x32x16_bf16 v[64:79], v[128:131], v[8:11], 0
    v_exp_f32 v112, v112
    v_exp_f32 v113, v113
    v_exp_f32 v114, v114
    v_mfma_f32_32x32x16_bf16 v[64:79], v[132:135], v[12:15], v[64:79]
    s_waitcnt lgkmcnt(1)
    v_exp_f32 v115, v115
    v_exp_f32 v116, v116
    v_exp_f32 v117, v117
    v_smfmac_f32_32x32x32_bf16 v[160:175], v[152:155], v[96:103], v204
    s_waitcnt lgkmcnt(0)
    v_exp_f32 v118, v118
    v_exp_f32 v119, v119
    v_exp_f32 v120, v120
    v_smfmac_f32_16x16x64_bf16 v[192:195], v[200:203], v[96:103], v204
    ds_read_b128 v[136:139], v24 offset:51200
    v_exp_f32 v121, v121
    v_exp_f32 v122, v122
    v_smfmac_f32_32x32x32_bf16 v[160:175], v[156:159], v[104:111], v204
    v_exp_f32 v123, v123
    v_exp_f32 v124, v124
    v_exp_f32 v125, v125
    v_smfmac_f32_16x16x64_bf16 v[192:195], v[200:203], v[104:111], v204
    ds_read_b128 v[140:143], v24 offset:52224
    v_exp_f32 v126, v126
    v_exp_f32 v127, v127
    v_mfma_f32_32x32x16_bf16 v[80:95], v[128:131], v[16:19], 0
    v_exp_f32 v64, v64
    v_exp_f32 v65, v65
    v_exp_f32 v66, v66
    v_mfma_f32_32x32x16_bf16 v[80:95], v[132:135], v[20:23], v[80:95]
    v_exp_f32 v67, v67
    v_exp_f32 v68, v68
    v_exp_f32 v69, v69
    v_smfmac_f32_32x32x32_bf16 v[176:191], v[152:155], v[112:119], v204
    s_waitcnt lgkmcnt(0)
    v_exp_f32 v70, v70
    v_exp_f32 v71, v71
    v_exp_f32 v72, v72
    v_smfmac_f32_16x16x64_bf16 v[196:199], v[200:203], v[112:119], v204
    ds_read_b128 v[144:147], v24 offset:57344
    v_exp_f32 v73, v73
    v_exp_f32 v74, v74
    v_smfmac_f32_32x32x32_bf16 v[176:191], v[156:159], v[120:127], v204
    v_exp_f32 v75, v75
    v_exp_f32 v76, v76
    v_exp_f32 v77, v77
    v_smfmac_f32_16x16x64_bf16 v[196:199], v[200:203], v[120:127], v204
    ds_read_b128 v[148:151], v24 offset:58368
    v_exp_f32 v78, v78
    v_exp_f32 v79, v79
    v_mfma_f32_32x32x16_bf16 v[96:111], v[136:139], v[8:11], 0
    v_exp_f32 v80, v80
    v_exp_f32 v81, v81
    v_exp_f32 v82, v82
    v_mfma_f32_32x32x16_bf16 v[96:111], v[140:143], v[12:15], v[96:111]
    s_waitcnt lgkmcnt(1)
    v_exp_f32 v83, v83
    v_exp_f32 v84, v84
    v_exp_f32 v85, v85
    v_smfmac_f32_32x32x32_bf16 v[160:175], v[144:147], v[64:71], v204
    s_waitcnt lgkmcnt(0)
    v_exp_f32 v86, v86
    v_exp_f32 v87, v87
    v_exp_f32 v88, v88
    v_smfmac_f32_16x16x64_bf16 v[192:195], v[200:203], v[64:71], v204
    ds_read_b128 v[128:131], v24 offset:53248
    v_exp_f32 v89, v89
    v_exp_f32 v90, v90
    v_smfmac_f32_32x32x32_bf16 v[160:175], v[148:151], v[72:79], v204
    v_exp_f32 v91, v91
    v_exp_f32 v92, v92
    v_exp_f32 v93, v93
    v_smfmac_f32_16x16x64_bf16 v[192:195], v[200:203], v[72:79], v204
    ds_read_b128 v[132:135], v24 offset:54272
    v_exp_f32 v94, v94
    v_exp_f32 v95, v95
    v_mfma_f32_32x32x16_bf16 v[112:127], v[136:139], v[16:19], 0
    v_exp_f32 v96, v96
    v_exp_f32 v97, v97
    v_exp_f32 v98, v98
    v_mfma_f32_32x32x16_bf16 v[112:127], v[140:143], v[20:23], v[112:127]
    v_exp_f32 v99, v99
    v_exp_f32 v100, v100
    v_exp_f32 v101, v101
    v_smfmac_f32_32x32x32_bf16 v[176:191], v[144:147], v[80:87], v204
    s_waitcnt lgkmcnt(0)
    v_exp_f32 v102, v102
    v_exp_f32 v103, v103
    v_exp_f32 v104, v104
    v_smfmac_f32_16x16x64_bf16 v[196:199], v[200:203], v[80:87], v204
    ds_read_b128 v[152:155], v24 offset:59392
    v_exp_f32 v105, v105
    v_exp_f32 v106, v106
    v_smfmac_f32_32x32x32_bf16 v[176:191], v[148:151], v[88:95], v204
    v_exp_f32 v107, v107
    v_exp_f32 v108, v108
    v_exp_f32 v109, v109
    v_smfmac_f32_16x16x64_bf16 v[196:199], v[200:203], v[88:95], v204
    ds_read_b128 v[156:159], v24 offset:60416
    v_exp_f32 v110, v110
    v_exp_f32 v111, v111
    v_mfma_f32_32x32x16_bf16 v[64:79], v[128:131], v[8:11], 0
    v_exp_f32 v112, v112
    v_exp_f32 v113, v113
    v_exp_f32 v114, v114
    v_mfma_f32_32x32x16_bf16 v[64:79], v[132:135], v[12:15], v[64:79]
    s_waitcnt lgkmcnt(1)
    v_exp_f32 v115, v115
    v_exp_f32 v116, v116
    v_exp_f32 v117, v117
    v_smfmac_f32_32x32x32_bf16 v[160:175], v[152:155], v[96:103], v204
    s_waitcnt lgkmcnt(0)
    v_exp_f32 v118, v118
    v_exp_f32 v119, v119
    v_exp_f32 v120, v120
    v_smfmac_f32_16x16x64_bf16 v[192:195], v[200:203], v[96:103], v204
    ds_read_b128 v[136:139], v24 offset:55296
    v_exp_f32 v121, v121
    v_exp_f32 v122, v122
    v_smfmac_f32_32x32x32_bf16 v[160:175], v[156:159], v[104:111], v204
    v_exp_f32 v123, v123
    v_exp_f32 v124, v124
    v_exp_f32 v125, v125
    v_smfmac_f32_16x16x64_bf16 v[192:195], v[200:203], v[104:111], v204
    ds_read_b128 v[140:143], v24 offset:56320
    v_exp_f32 v126, v126
    v_exp_f32 v127, v127
    v_mfma_f32_32x32x16_bf16 v[80:95], v[128:131], v[16:19], 0
    v_exp_f32 v64, v64
    v_exp_f32 v65, v65
    v_exp_f32 v66, v66
    v_mfma_f32_32x32x16_bf16 v[80:95], v[132:135], v[20:23], v[80:95]
    v_exp_f32 v67, v67
    v_exp_f32 v68, v68
    v_exp_f32 v69, v69
    v_smfmac_f32_32x32x32_bf16 v[176:191], v[152:155], v[112:119], v204
    s_waitcnt lgkmcnt(0)
    v_exp_f32 v70, v70
    v_exp_f32 v71, v71
    v_exp_f32 v72, v72
    v_smfmac_f32_16x16x64_bf16 v[196:199], v[200:203], v[112:119], v204
    ds_read_b128 v[144:147], v24 offset:61440
    v_exp_f32 v73, v73
    v_exp_f32 v74, v74
    v_smfmac_f32_32x32x32_bf16 v[176:191], v[156:159], v[120:127], v204
    v_exp_f32 v75, v75
    v_exp_f32 v76, v76
    v_exp_f32 v77, v77
    v_smfmac_f32_16x16x64_bf16 v[196:199], v[200:203], v[120:127], v204
    ds_read_b128 v[148:151], v24 offset:62464
    v_exp_f32 v78, v78
    v_exp_f32 v79, v79
    v_mfma_f32_32x32x16_bf16 v[96:111], v[136:139], v[8:11], 0
    v_exp_f32 v80, v80
    v_exp_f32 v81, v81
    v_exp_f32 v82, v82
    v_mfma_f32_32x32x16_bf16 v[96:111], v[140:143], v[12:15], v[96:111]
    s_waitcnt lgkmcnt(1)
    v_exp_f32 v83, v83
    v_exp_f32 v84, v84
    v_exp_f32 v85, v85
    v_smfmac_f32_32x32x32_bf16 v[160:175], v[144:147], v[64:71], v204
    s_waitcnt lgkmcnt(0)
    s_barrier
    v_exp_f32 v86, v86
    v_exp_f32 v87, v87
    v_exp_f32 v88, v88
    v_smfmac_f32_16x16x64_bf16 v[192:195], v[200:203], v[64:71], v204
    ds_read_b128 v[128:131], v24 offset:0
    v_exp_f32 v89, v89
    v_exp_f32 v90, v90
    v_smfmac_f32_32x32x32_bf16 v[160:175], v[148:151], v[72:79], v204
    v_exp_f32 v91, v91
    v_exp_f32 v92, v92
    v_exp_f32 v93, v93
    v_smfmac_f32_16x16x64_bf16 v[192:195], v[200:203], v[72:79], v204
    ds_read_b128 v[132:135], v24 offset:1024
    v_exp_f32 v94, v94
    v_exp_f32 v95, v95
    v_mfma_f32_32x32x16_bf16 v[112:127], v[136:139], v[16:19], 0
    v_exp_f32 v96, v96
    v_exp_f32 v97, v97
    v_exp_f32 v98, v98
    v_mfma_f32_32x32x16_bf16 v[112:127], v[140:143], v[20:23], v[112:127]
    v_exp_f32 v99, v99
    v_exp_f32 v100, v100
    v_exp_f32 v101, v101
    v_smfmac_f32_32x32x32_bf16 v[176:191], v[144:147], v[80:87], v204
    s_waitcnt lgkmcnt(0)
    v_exp_f32 v102, v102
    v_exp_f32 v103, v103
    v_exp_f32 v104, v104
    v_smfmac_f32_16x16x64_bf16 v[196:199], v[200:203], v[80:87], v204
    ds_read_b128 v[152:155], v24 offset:63488
    v_exp_f32 v105, v105
    v_exp_f32 v106, v106
    v_smfmac_f32_32x32x32_bf16 v[176:191], v[148:151], v[88:95], v204
    v_exp_f32 v107, v107
    v_exp_f32 v108, v108
    v_exp_f32 v109, v109
    v_smfmac_f32_16x16x64_bf16 v[196:199], v[200:203], v[88:95], v204
    ds_read_b128 v[156:159], v24 offset:64512
    v_exp_f32 v110, v110
    v_exp_f32 v111, v111
    v_mfma_f32_32x32x16_bf16 v[64:79], v[128:131], v[8:11], 0
    s_sub_u32 s54, s54, 1
    v_exp_f32 v112, v112
    v_exp_f32 v113, v113
    v_exp_f32 v114, v114
    v_mfma_f32_32x32x16_bf16 v[64:79], v[132:135], v[12:15], v[64:79]
    s_waitcnt lgkmcnt(1)
    v_exp_f32 v115, v115
    v_exp_f32 v116, v116
    v_exp_f32 v117, v117
    v_smfmac_f32_32x32x32_bf16 v[160:175], v[152:155], v[96:103], v204
    s_waitcnt lgkmcnt(0)
    v_exp_f32 v118, v118
    v_exp_f32 v119, v119
    v_exp_f32 v120, v120
    v_smfmac_f32_16x16x64_bf16 v[192:195], v[200:203], v[96:103], v204
    ds_read_b128 v[136:139], v24 offset:2048
    v_exp_f32 v121, v121
    v_exp_f32 v122, v122
    v_smfmac_f32_32x32x32_bf16 v[160:175], v[156:159], v[104:111], v204
    s_cmp_lg_u32 s54, 0
    v_exp_f32 v123, v123
    v_exp_f32 v124, v124
    v_exp_f32 v125, v125
    v_smfmac_f32_16x16x64_bf16 v[192:195], v[200:203], v[104:111], v204
    ds_read_b128 v[140:143], v24 offset:3072
    v_exp_f32 v126, v126
    v_exp_f32 v127, v127
    s_cbranch_scc1 c_attn_loop
    v_smfmac_f32_32x32x32_bf16 v[176:191], v[152:155], v[112:119], v204
    v_mov_b32 v25, 0x5f000000
    v_mov_b32 v26, 0x2b800000
    s_add_u32 s51, s49, 65536
    v_cmp_lt_f32 s[56:57], v192, v25
    v_cmp_gt_f32 vcc, v192, v26
    s_and_b64 s[56:57], s[56:57], vcc
    v_smfmac_f32_16x16x64_bf16 v[196:199], v[200:203], v[112:119], v204
    v_rcp_f32 v193, v192
    s_nop 0
    v_mul_f32 v160, v193, v160
    v_smfmac_f32_32x32x32_bf16 v[176:191], v[156:159], v[120:127], v204
    v_mul_f32 v161, v193, v161
    v_mul_f32 v162, v193, v162
    v_mul_f32 v163, v193, v163
    v_mul_f32 v164, v193, v164
    v_mul_f32 v165, v193, v165
    v_smfmac_f32_16x16x64_bf16 v[196:199], v[200:203], v[120:127], v204
    v_mul_f32 v166, v193, v166
    v_mul_f32 v167, v193, v167
    v_cvt_pk_bf16_f32 v160, v160, v161
    v_cvt_pk_bf16_f32 v161, v162, v163
    v_cvt_pk_bf16_f32 v162, v164, v165
    v_cvt_pk_bf16_f32 v163, v166, v167
    buffer_store_dwordx4 v[160:163], v5, s[12:15], s49 offen offset:0 sc1
    v_pk_mul_f32 v[168:169], v[192:193], v[168:169] op_sel:[1,0] op_sel_hi:[1,1]
    v_pk_mul_f32 v[170:171], v[192:193], v[170:171] op_sel:[1,0] op_sel_hi:[1,1]
    v_pk_mul_f32 v[172:173], v[192:193], v[172:173] op_sel:[1,0] op_sel_hi:[1,1]
    v_pk_mul_f32 v[174:175], v[192:193], v[174:175] op_sel:[1,0] op_sel_hi:[1,1]
    v_cvt_pk_bf16_f32 v168, v168, v169
    v_cvt_pk_bf16_f32 v169, v170, v171
    v_cvt_pk_bf16_f32 v170, v172, v173
    v_cvt_pk_bf16_f32 v171, v174, v175
    buffer_store_dwordx4 v[168:171], v5, s[12:15], s49 offen offset:1024 sc1
    v_cmp_lt_f32 vcc, v196, v25
    s_and_b64 s[56:57], s[56:57], vcc
    v_cmp_gt_f32 vcc, v196, v26
    s_and_b64 s[56:57], s[56:57], vcc
    s_cmp_lg_u64 s[56:57], -1
    s_cbranch_scc1 c_attn_slow
    v_rcp_f32 v197, v196
    s_nop 0
    v_pk_mul_f32 v[176:177], v[196:197], v[176:177] op_sel:[1,0] op_sel_hi:[1,1]
    v_pk_mul_f32 v[178:179], v[196:197], v[178:179] op_sel:[1,0] op_sel_hi:[1,1]
    v_pk_mul_f32 v[180:181], v[196:197], v[180:181] op_sel:[1,0] op_sel_hi:[1,1]
    v_pk_mul_f32 v[182:183], v[196:197], v[182:183] op_sel:[1,0] op_sel_hi:[1,1]
    v_cvt_pk_bf16_f32 v176, v176, v177
    v_cvt_pk_bf16_f32 v177, v178, v179
    v_cvt_pk_bf16_f32 v178, v180, v181
    v_cvt_pk_bf16_f32 v179, v182, v183
    buffer_store_dwordx4 v[176:179], v5, s[12:15], s51 offen offset:0 sc1
    v_pk_mul_f32 v[184:185], v[196:197], v[184:185] op_sel:[1,0] op_sel_hi:[1,1]
    v_pk_mul_f32 v[186:187], v[196:197], v[186:187] op_sel:[1,0] op_sel_hi:[1,1]
    v_pk_mul_f32 v[188:189], v[196:197], v[188:189] op_sel:[1,0] op_sel_hi:[1,1]
    v_pk_mul_f32 v[190:191], v[196:197], v[190:191] op_sel:[1,0] op_sel_hi:[1,1]
    v_cvt_pk_bf16_f32 v184, v184, v185
    v_cvt_pk_bf16_f32 v185, v186, v187
    v_cvt_pk_bf16_f32 v186, v188, v189
    v_cvt_pk_bf16_f32 v187, v190, v191
    buffer_store_dwordx4 v[184:187], v5, s[12:15], s51 offen offset:1024 sc1
c_attn_done:
    s_branch c_wo
c_attn_fin:
    v_rcp_f32 v193, v192
    s_nop 0
    v_pk_mul_f32 v[160:161], v[192:193], v[160:161] op_sel:[1,0] op_sel_hi:[1,1]
    v_pk_mul_f32 v[162:163], v[192:193], v[162:163] op_sel:[1,0] op_sel_hi:[1,1]
    v_pk_mul_f32 v[164:165], v[192:193], v[164:165] op_sel:[1,0] op_sel_hi:[1,1]
    v_pk_mul_f32 v[166:167], v[192:193], v[166:167] op_sel:[1,0] op_sel_hi:[1,1]
    v_cvt_pk_bf16_f32 v160, v160, v161
    v_cvt_pk_bf16_f32 v161, v162, v163
    v_cvt_pk_bf16_f32 v162, v164, v165
    v_cvt_pk_bf16_f32 v163, v166, v167
    buffer_store_dwordx4 v[160:163], v5, s[12:15], s49 offen offset:0 sc1
    v_pk_mul_f32 v[168:169], v[192:193], v[168:169] op_sel:[1,0] op_sel_hi:[1,1]
    v_pk_mul_f32 v[170:171], v[192:193], v[170:171] op_sel:[1,0] op_sel_hi:[1,1]
    v_pk_mul_f32 v[172:173], v[192:193], v[172:173] op_sel:[1,0] op_sel_hi:[1,1]
    v_pk_mul_f32 v[174:175], v[192:193], v[174:175] op_sel:[1,0] op_sel_hi:[1,1]
    v_cvt_pk_bf16_f32 v168, v168, v169
    v_cvt_pk_bf16_f32 v169, v170, v171
    v_cvt_pk_bf16_f32 v170, v172, v173
    v_cvt_pk_bf16_f32 v171, v174, v175
    buffer_store_dwordx4 v[168:171], v5, s[12:15], s49 offen offset:1024 sc1
    v_rcp_f32 v197, v196
    s_nop 0
    v_pk_mul_f32 v[176:177], v[196:197], v[176:177] op_sel:[1,0] op_sel_hi:[1,1]
    v_pk_mul_f32 v[178:179], v[196:197], v[178:179] op_sel:[1,0] op_sel_hi:[1,1]
    v_pk_mul_f32 v[180:181], v[196:197], v[180:181] op_sel:[1,0] op_sel_hi:[1,1]
    v_pk_mul_f32 v[182:183], v[196:197], v[182:183] op_sel:[1,0] op_sel_hi:[1,1]
    v_cvt_pk_bf16_f32 v176, v176, v177
    v_cvt_pk_bf16_f32 v177, v178, v179
    v_cvt_pk_bf16_f32 v178, v180, v181
    v_cvt_pk_bf16_f32 v179, v182, v183
    buffer_store_dwordx4 v[176:179], v5, s[12:15], s51 offen offset:0 sc1
    v_pk_mul_f32 v[184:185], v[196:197], v[184:185] op_sel:[1,0] op_sel_hi:[1,1]
    v_pk_mul_f32 v[186:187], v[196:197], v[186:187] op_sel:[1,0] op_sel_hi:[1,1]
    v_pk_mul_f32 v[188:189], v[196:197], v[188:189] op_sel:[1,0] op_sel_hi:[1,1]
    v_pk_mul_f32 v[190:191], v[196:197], v[190:191] op_sel:[1,0] op_sel_hi:[1,1]
    v_cvt_pk_bf16_f32 v184, v184, v185
    v_cvt_pk_bf16_f32 v185, v186, v187
    v_cvt_pk_bf16_f32 v186, v188, v189
    v_cvt_pk_bf16_f32 v187, v190, v191
    buffer_store_dwordx4 v[184:187], v5, s[12:15], s51 offen offset:1024 sc1
    s_branch c_attn_done
.p2align 6
h_first_tail:
    s_waitcnt vmcnt(0)
    s_sub_u32 s50, s50, 8000
    s_load_dword s10, s[46:47], 0
    s_waitcnt lgkmcnt(0)
    s_sub_u32 s51, s10, s50
    s_and_b32 s3, s10, 1
    s_cselect_b32 s51, s51, -1
    s_cmp_ge_i32 s51, 0
    s_cbranch_scc1 h_first_non_ok
    s_load_dword s10, s[46:47], 128
    s_waitcnt lgkmcnt(0)
    s_sub_u32 s51, s10, s50
    s_and_b32 s3, s10, 1
    s_cselect_b32 s51, s51, -1
    s_cmp_ge_i32 s51, 0
    s_cbranch_scc1 h_first_non_ok
    s_load_dword s10, s[46:47], 64
    s_waitcnt lgkmcnt(0)
    s_sub_u32 s51, s10, s50
    s_and_b32 s3, s10, 1
    s_cselect_b32 s51, s51, -1
    s_cmp_ge_i32 s51, 0
    s_cbranch_scc1 h_first_non_ok
    s_load_dword s10, s[46:47], 192
    s_waitcnt lgkmcnt(0)
    s_sub_u32 s51, s10, s50
    s_and_b32 s3, s10, 1
    s_cselect_b32 s51, s51, -1
    s_cmp_ge_i32 s51, 0
    s_cbranch_scc1 h_first_non_ok
    s_mov_b32 s58, 0
    s_and_b32 s57, s2, 0xc0
h_first_non:
    s_load_dword s10, s[46:47], s57 glc
    s_waitcnt lgkmcnt(0)
    s_sub_u32 s51, s10, s50
    s_and_b32 s3, s10, 1
    s_cselect_b32 s51, s51, -1
    s_cmp_ge_i32 s51, 0
    s_cbranch_scc1 h_first_non_ok
    s_add_u32 s58, s58, 1
    s_cmp_gt_u32 s58, 100
    s_cselect_b32 s50, s10, s50
    s_cmp_lt_u32 s58, 0x100000
    s_cbranch_scc1 h_first_non
    s_mov_b32 s10, 1
h_first_non_ok:
    v_mov_b32 v12, s10
    ds_write_b32 v10, v12 offset:4
    v_lshlrev_b32 v13, 7, v1
    s_lshl_b32 s50, s2, 13
    s_mov_b32 s28, s36
    s_mov_b32 s29, s37
    s_mov_b32 s30, 2097152
    s_mov_b32 s31, 0x00020000
    buffer_load_dword v14, v13, s[28:31], s50 offen
    s_mov_b32 s9, 0
h_qkvA:
    s_mul_i32 s98, s9, 786432
    s_add_u32 s98, s98, 65273856
    s_lshl_b32 s99, s11, 10
    s_add_u32 s98, s98, s99
    s_add_u32 s96, s4, s98
    s_addc_u32 s97, s5, 0
    s_mov_b32 s98, s10
    s_mov_b32 s99, s10
    v_and_b32 v1, 63, v0
    v_lshlrev_b32 v5, 4, v1
    v_and_b32 v20, 15, v1
    v_lshrrev_b32 v11, 4, v1
    v_min_u32 v11, 2, v11
    v_lshlrev_b32 v21, 3, v20
    v_lshl_add_u32 v12, v11, 7, v21
    v_add_u32 v12, 155648, v12
    v_lshl_add_u32 v11, v11, 16, v21
    v_mov_b32 v10, 159496
    s_add_u32 s3, s9, 1
    v_mov_b32 v13, s3
    s_and_b32 s3, s6, 14
    s_lshl_b32 s3, s3, 2
    s_sub_u32 s3, s3, 1
    s_max_i32 s3, s3, 0
    s_lshl_b32 s3, s3, 16
    s_lshl_b32 s48, s9, 22
    s_add_u32 s3, s3, s48
    s_add_u32 s20, s4, s3
    s_addc_u32 s21, s5, 0
    s_mov_b32 s22, 65536
    s_mov_b32 s23, 0x00020000
    s_cmp_lt_u32 s6, 2
    s_cselect_b32 s22, 0, s22
    s_cselect_b32 s3, 0, 512
    s_add_u32 s96, s96, s3
    s_addc_u32 s97, s97, 0
    v_bfe_u32 v21, v1, 4, 1
    v_lshl_add_u32 v6, v21, 5, v20
    v_lshlrev_b32 v6, 4, v6
    v_lshrrev_b32 v21, 5, v1
    v_lshl_add_u32 v6, v21, 10, v6
    v_add_u32 v6, 256, v6
    v_mov_b32 v16, v5
    s_cmp_eq_u32 s9, 0
    s_cbranch_scc1 h_qkvA_noend
    s_barrier
    s_cmp_lt_u32 s9, 2
    s_cbranch_scc1 c4_11
    ds_write_b128 v16, v[64:67] offset:0
    ds_write_b128 v16, v[68:71] offset:1024
    ds_write_b128 v16, v[72:75] offset:2048
    ds_write_b128 v16, v[76:79] offset:3072
    ds_write_b128 v16, v[80:83] offset:4096
    ds_write_b128 v16, v[84:87] offset:5120
    ds_write_b128 v16, v[88:91] offset:6144
    ds_write_b128 v16, v[92:95] offset:7168
    ds_write_b128 v16, v[96:99] offset:8192
    ds_write_b128 v16, v[100:103] offset:9216
    ds_write_b128 v16, v[104:107] offset:10240
    ds_write_b128 v16, v[108:111] offset:11264
    ds_write_b128 v16, v[112:115] offset:12288
    ds_write_b128 v16, v[116:119] offset:13312
    ds_write_b128 v16, v[120:123] offset:14336
    ds_write_b128 v16, v[124:127] offset:15360
    ds_write_b128 v16, v[128:131] offset:16384
    ds_write_b128 v16, v[132:135] offset:17408
    ds_write_b128 v16, v[136:139] offset:18432
    ds_write_b128 v16, v[140:143] offset:19456
    ds_write_b128 v16, v[144:147] offset:20480
    ds_write_b128 v16, v[148:151] offset:21504
    ds_write_b128 v16, v[152:155] offset:22528
    ds_write_b128 v16, v[156:159] offset:23552
    s_waitcnt lgkmcnt(0)
c4_11:
    s_barrier
h_qkvA_noend:
    s_mov_b32 s3, 0x100000
poll_12:
    s_load_dwordx8 s[80:87], s[96:97], 0 glc
    s_load_dwordx8 s[88:95], s[96:97], 128 glc
    s_sub_u32 s3, s3, 1
    s_cbranch_scc1 poll_12_ok
    s_waitcnt lgkmcnt(0)
    s_xor_b64 s[100:101], s[80:81], s[98:99]
    s_xor_b64 s[80:81], s[82:83], s[98:99]
    s_or_b64 s[100:101], s[100:101], s[80:81]
    s_xor_b64 s[80:81], s[84:85], s[98:99]
    s_or_b64 s[100:101], s[100:101], s[80:81]
    s_xor_b64 s[80:81], s[86:87], s[98:99]
    s_or_b64 s[100:101], s[100:101], s[80:81]
    s_xor_b64 s[80:81], s[88:89], s[98:99]
    s_or_b64 s[100:101], s[100:101], s[80:81]
    s_xor_b64 s[80:81], s[90:91], s[98:99]
    s_or_b64 s[100:101], s[100:101], s[80:81]
    s_xor_b64 s[80:81], s[92:93], s[98:99]
    s_or_b64 s[100:101], s[100:101], s[80:81]
    s_xor_b64 s[80:81], s[94:95], s[98:99]
    s_or_b64 s[100:101], s[100:101], s[80:81]
    s_cbranch_scc1 poll_12
poll_12_ok:
    s_waitcnt lgkmcnt(0)
    ds_write_b32 v10, v13
    s_mov_b32 m0, 147456
    s_mov_b32 s48, 0
    buffer_load_dwordx4 v6, s[20:23], s48 offen sc1 lds
    s_mov_b32 m0, 148480
    s_mov_b32 s48, 2048
    buffer_load_dwordx4 v6, s[20:23], s48 offen sc1 lds
    s_mov_b32 m0, 149504
    s_mov_b32 s48, 4096
    buffer_load_dwordx4 v6, s[20:23], s48 offen sc1 lds
    s_mov_b32 m0, 150528
    s_mov_b32 s48, 6144
    buffer_load_dwordx4 v6, s[20:23], s48 offen sc1 lds
    s_mov_b32 m0, 151552
    s_mov_b32 s48, 8192
    buffer_load_dwordx4 v6, s[20:23], s48 offen sc1 lds
    s_mov_b32 m0, 152576
    s_mov_b32 s48, 10240
    buffer_load_dwordx4 v6, s[20:23], s48 offen sc1 lds
    s_mov_b32 m0, 153600
    s_mov_b32 s48, 12288
    buffer_load_dwordx4 v6, s[20:23], s48 offen sc1 lds
    s_mov_b32 m0, 154624
    s_mov_b32 s48, 14336
    buffer_load_dwordx4 v6, s[20:23], s48 offen sc1 lds
    s_lshl_b32 s56, s7, 12
    s_and_b32 s57, s6, 1
    s_lshl_b32 s57, s57, 7
    s_add_u32 s56, s56, s57
    s_add_u32 s56, s56, 63963136
    v_lshlrev_b32 v15, 7, v1
    s_lshr_b32 s59, s2, 3
    s_mul_i32 s59, s59, 3
    s_lshr_b32 s59, s59, 5
    s_lshl_b32 s3, s9, 4
    s_add_u32 s59, s59, s3
    s_waitcnt vmcnt(4)
    s_barrier
    s_cmp_ge_u32 s9, 2
    s_cbranch_scc1 c4_13
    ds_read_b128 v[64:67], v16 offset:0
    ds_read_b128 v[68:71], v16 offset:1024
    ds_read_b128 v[72:75], v16 offset:2048
    ds_read_b128 v[76:79], v16 offset:3072
    ds_read_b128 v[80:83], v16 offset:4096
    ds_read_b128 v[84:87], v16 offset:5120
    ds_read_b128 v[88:91], v16 offset:6144
    ds_read_b128 v[92:95], v16 offset:7168
    ds_read_b128 v[96:99], v16 offset:8192
    ds_read_b128 v[100:103], v16 offset:9216
    ds_read_b128 v[104:107], v16 offset:10240
    ds_read_b128 v[108:111], v16 offset:11264
    ds_read_b128 v[112:115], v16 offset:12288
    ds_read_b128 v[116:119], v16 offset:13312
    ds_read_b128 v[120:123], v16 offset:14336
    ds_read_b128 v[124:127], v16 offset:15360
    ds_read_b128 v[128:131], v16 offset:16384
    ds_read_b128 v[132:135], v16 offset:17408
    ds_read_b128 v[136:139], v16 offset:18432
    ds_read_b128 v[140:143], v16 offset:19456
    ds_read_b128 v[144:147], v16 offset:20480
    ds_read_b128 v[148:151], v16 offset:21504
    ds_read_b128 v[152:155], v16 offset:22528
    ds_read_b128 v[156:159], v16 offset:23552
    s_waitcnt lgkmcnt(0)
c4_13:
    s_waitcnt vmcnt(0)
    s_barrier
    s_mov_b32 m0, 147456
    s_mov_b32 s48, 16384
    buffer_load_dwordx4 v6, s[20:23], s48 offen sc1 lds
    s_mov_b32 m0, 148480
    s_mov_b32 s48, 18432
    buffer_load_dwordx4 v6, s[20:23], s48 offen sc1 lds
    s_mov_b32 m0, 149504
    s_mov_b32 s48, 20480
    buffer_load_dwordx4 v6, s[20:23], s48 offen sc1 lds
    s_mov_b32 m0, 150528
    s_mov_b32 s48, 22528
    buffer_load_dwordx4 v6, s[20:23], s48 offen sc1 lds
    s_waitcnt vmcnt(0)
    s_waitcnt vmcnt(0)
    s_barrier
    s_mov_b32 m0, 151552
    s_mov_b32 s48, 24576
    buffer_load_dwordx4 v6, s[20:23], s48 offen sc1 lds
    s_mov_b32 m0, 152576
    s_mov_b32 s48, 26624
    buffer_load_dwordx4 v6, s[20:23], s48 offen sc1 lds
    s_mov_b32 m0, 153600
    s_mov_b32 s48, 28672
    buffer_load_dwordx4 v6, s[20:23], s48 offen sc1 lds
    s_mov_b32 m0, 154624
    s_mov_b32 s48, 30720
    buffer_load_dwordx4 v6, s[20:23], s48 offen sc1 lds
    s_cmp_ge_u32 s9, 2
    s_cbranch_scc1 cs_15
    buffer_load_dwordx2 v[32:33], v11, s[12:15], s56 offen offset:0 sc1
    buffer_load_dwordx2 v[34:35], v11, s[12:15], s56 offen offset:256 sc1
    buffer_load_dwordx2 v[36:37], v11, s[12:15], s56 offen offset:512 sc1
    buffer_load_dwordx2 v[38:39], v11, s[12:15], s56 offen offset:768 sc1
    buffer_load_dwordx2 v[40:41], v11, s[12:15], s56 offen offset:1024 sc1
    buffer_load_dwordx2 v[42:43], v11, s[12:15], s56 offen offset:1280 sc1
    buffer_load_dwordx2 v[44:45], v11, s[12:15], s56 offen offset:1536 sc1
    buffer_load_dwordx2 v[46:47], v11, s[12:15], s56 offen offset:1792 sc1
    buffer_load_dwordx2 v[48:49], v11, s[12:15], s56 offen offset:2048 sc1
    buffer_load_dwordx2 v[50:51], v11, s[12:15], s56 offen offset:2304 sc1
    buffer_load_dwordx2 v[52:53], v11, s[12:15], s56 offen offset:2560 sc1
    buffer_load_dwordx2 v[54:55], v11, s[12:15], s56 offen offset:2816 sc1
cs_15:
    s_waitcnt vmcnt(0)
    s_waitcnt vmcnt(12)
    s_barrier
    s_mov_b32 m0, 147456
    s_mov_b32 s48, 32768
    buffer_load_dwordx4 v6, s[20:23], s48 offen sc1 lds
    s_mov_b32 m0, 148480
    s_mov_b32 s48, 34816
    buffer_load_dwordx4 v6, s[20:23], s48 offen sc1 lds
    s_mov_b32 m0, 149504
    s_mov_b32 s48, 36864
    buffer_load_dwordx4 v6, s[20:23], s48 offen sc1 lds
    s_mov_b32 m0, 150528
    s_mov_b32 s48, 38912
    buffer_load_dwordx4 v6, s[20:23], s48 offen sc1 lds
    s_cmp_ge_u32 s9, 2
    s_cbranch_scc1 cs_16
    buffer_load_dwordx2 v[56:57], v11, s[12:15], s56 offen offset:3072 sc1
    buffer_load_dwordx2 v[58:59], v11, s[12:15], s56 offen offset:3328 sc1
    buffer_load_dwordx2 v[60:61], v11, s[12:15], s56 offen offset:3584 sc1
    buffer_load_dwordx2 v[62:63], v11, s[12:15], s56 offen offset:3840 sc1
cs_16:
    s_waitcnt vmcnt(0)
    s_waitcnt vmcnt(4)
    s_barrier
    s_mov_b32 m0, 151552
    s_mov_b32 s48, 40960
    buffer_load_dwordx4 v6, s[20:23], s48 offen sc1 lds
    s_mov_b32 m0, 152576
    s_mov_b32 s48, 43008
    buffer_load_dwordx4 v6, s[20:23], s48 offen sc1 lds
    s_mov_b32 m0, 153600
    s_mov_b32 s48, 45056
    buffer_load_dwordx4 v6, s[20:23], s48 offen sc1 lds
    s_mov_b32 m0, 154624
    s_mov_b32 s48, 47104
    buffer_load_dwordx4 v6, s[20:23], s48 offen sc1 lds
    s_cmp_ge_u32 s9, 2
    s_cbranch_scc1 cs_17
    s_waitcnt vmcnt(4)
    v_add_f32 v32, v32, v48
    v_add_f32 v33, v33, v49
    v_add_f32 v34, v34, v50
    v_add_f32 v35, v35, v51
    v_add_f32 v36, v36, v52
    v_add_f32 v37, v37, v53
    v_add_f32 v38, v38, v54
    v_add_f32 v39, v39, v55
    v_add_f32 v40, v40, v56
    v_add_f32 v41, v41, v57
    v_add_f32 v42, v42, v58
    v_add_f32 v43, v43, v59
cs_17:
    s_waitcnt vmcnt(0)
    s_waitcnt vmcnt(0)
    s_barrier
    s_mov_b32 m0, 147456
    s_mov_b32 s48, 49152
    buffer_load_dwordx4 v6, s[20:23], s48 offen sc1 lds
    s_mov_b32 m0, 148480
    s_mov_b32 s48, 51200
    buffer_load_dwordx4 v6, s[20:23], s48 offen sc1 lds
    s_mov_b32 m0, 149504
    s_mov_b32 s48, 53248
    buffer_load_dwordx4 v6, s[20:23], s48 offen sc1 lds
    s_mov_b32 m0, 150528
    s_mov_b32 s48, 55296
    buffer_load_dwordx4 v6, s[20:23], s48 offen sc1 lds
    s_cmp_ge_u32 s9, 2
    s_cbranch_scc1 cs_18
    v_add_f32 v44, v44, v60
    v_add_f32 v45, v45, v61
    v_add_f32 v46, v46, v62
    v_add_f32 v47, v47, v63
    v_add_f32 v32, v32, v40
    v_add_f32 v33, v33, v41
    v_add_f32 v34, v34, v42
    v_add_f32 v35, v35, v43
    v_add_f32 v36, v36, v44
    v_add_f32 v37, v37, v45
    v_add_f32 v38, v38, v46
    v_add_f32 v39, v39, v47
cs_18:
    s_waitcnt vmcnt(0)
    s_waitcnt vmcnt(0)
    s_barrier
    s_mov_b32 m0, 151552
    s_mov_b32 s48, 57344
    buffer_load_dwordx4 v6, s[20:23], s48 offen sc1 lds
    s_mov_b32 m0, 152576
    s_mov_b32 s48, 59392
    buffer_load_dwordx4 v6, s[20:23], s48 offen sc1 lds
    s_mov_b32 m0, 153600
    s_mov_b32 s48, 61440
    buffer_load_dwordx4 v6, s[20:23], s48 offen sc1 lds
    s_mov_b32 m0, 154624
    s_mov_b32 s48, 63488
    buffer_load_dwordx4 v6, s[20:23], s48 offen sc1 lds
    s_cmp_ge_u32 s9, 2
    s_cbranch_scc1 cs_19
    v_add_f32 v32, v32, v36
    v_add_f32 v33, v33, v37
    v_add_f32 v34, v34, v38
    v_add_f32 v35, v35, v39
    v_add_f32 v32, v32, v34
    v_add_f32 v33, v33, v35
    ds_write_b64 v12, v[32:33]
    s_waitcnt lgkmcnt(0)
cs_19:
    s_waitcnt vmcnt(0)
    s_waitcnt vmcnt(0)
    s_barrier
    s_barrier
    s_barrier
    s_branch h_wo
h_qkvB:
    s_mul_i32 s98, s9, 786432
    s_add_u32 s98, s98, 65273856
    s_lshl_b32 s99, s11, 10
    s_add_u32 s98, s98, s99
    s_add_u32 s96, s4, s98
    s_addc_u32 s97, s5, 0
    s_mov_b32 s98, s10
    s_mov_b32 s99, s10
    v_and_b32 v1, 63, v0
    v_lshlrev_b32 v5, 4, v1
    v_and_b32 v20, 15, v1
    v_lshrrev_b32 v11, 4, v1
    v_min_u32 v11, 2, v11
    v_lshlrev_b32 v21, 3, v20
    v_lshl_add_u32 v12, v11, 7, v21
    v_add_u32 v12, 156032, v12
    v_lshl_add_u32 v11, v11, 16, v21
    v_mov_b32 v10, 159496
    s_add_u32 s3, s9, 1
    v_mov_b32 v13, s3
    v_mov_b32 v16, v5
    s_barrier
    s_cmp_lt_u32 s9, 2
    s_cbranch_scc1 c4_22
    ds_write_b128 v16, v[160:163] offset:0
    ds_write_b128 v16, v[164:167] offset:1024
    ds_write_b128 v16, v[168:171] offset:2048
    ds_write_b128 v16, v[172:175] offset:3072
    ds_write_b128 v16, v[176:179] offset:4096
    ds_write_b128 v16, v[180:183] offset:5120
    ds_write_b128 v16, v[184:187] offset:6144
    ds_write_b128 v16, v[188:191] offset:7168
    ds_write_b128 v16, v[192:195] offset:8192
    ds_write_b128 v16, v[196:199] offset:9216
    ds_write_b128 v16, v[200:203] offset:10240
    ds_write_b128 v16, v[204:207] offset:11264
    ds_write_b128 v16, v[208:211] offset:12288
    ds_write_b128 v16, v[212:215] offset:13312
    ds_write_b128 v16, v[216:219] offset:14336
    ds_write_b128 v16, v[220:223] offset:15360
    ds_write_b128 v16, a[0:3] offset:16384
    ds_write_b128 v16, a[4:7] offset:17408
    ds_write_b128 v16, a[8:11] offset:18432
    ds_write_b128 v16, a[12:15] offset:19456
    ds_write_b128 v16, a[16:19] offset:20480
    ds_write_b128 v16, a[20:23] offset:21504
    ds_write_b128 v16, a[24:27] offset:22528
    ds_write_b128 v16, a[28:31] offset:23552
    s_waitcnt lgkmcnt(0)
c4_22:
    s_barrier
    s_mov_b32 s3, 0x100000
poll_23:
    s_load_dwordx8 s[88:95], s[96:97], 0 glc
    s_sub_u32 s3, s3, 1
    s_cbranch_scc1 poll_23_ok
    s_waitcnt lgkmcnt(0)
    s_xor_b64 s[100:101], s[88:89], s[98:99]
    s_xor_b64 s[88:89], s[90:91], s[98:99]
    s_or_b64 s[100:101], s[100:101], s[88:89]
    s_xor_b64 s[88:89], s[92:93], s[98:99]
    s_or_b64 s[100:101], s[100:101], s[88:89]
    s_xor_b64 s[88:89], s[94:95], s[98:99]
    s_or_b64 s[100:101], s[100:101], s[88:89]
    s_cbranch_scc1 poll_23
poll_23_ok:
    s_waitcnt lgkmcnt(0)
    ds_write_b32 v10, v13
    s_lshl_b32 s56, s7, 12
    s_and_b32 s57, s6, 1
    s_lshl_b32 s57, s57, 7
    s_add_u32 s56, s56, s57
    s_add_u32 s56, s56, 64159744
    s_barrier
    s_cmp_ge_u32 s9, 2
    s_cbranch_scc1 c4_24
    ds_read_b128 v[160:163], v16 offset:0
    ds_read_b128 v[164:167], v16 offset:1024
    ds_read_b128 v[168:171], v16 offset:2048
    ds_read_b128 v[172:175], v16 offset:3072
    ds_read_b128 v[176:179], v16 offset:4096
    ds_read_b128 v[180:183], v16 offset:5120
    ds_read_b128 v[184:187], v16 offset:6144
    ds_read_b128 v[188:191], v16 offset:7168
    ds_read_b128 v[192:195], v16 offset:8192
    ds_read_b128 v[196:199], v16 offset:9216
    ds_read_b128 v[200:203], v16 offset:10240
    ds_read_b128 v[204:207], v16 offset:11264
    ds_read_b128 v[208:211], v16 offset:12288
    ds_read_b128 v[212:215], v16 offset:13312
    ds_read_b128 v[216:219], v16 offset:14336
    ds_read_b128 v[220:223], v16 offset:15360
    ds_read_b128 a[0:3], v16 offset:16384
    ds_read_b128 a[4:7], v16 offset:17408
    ds_read_b128 a[8:11], v16 offset:18432
    ds_read_b128 a[12:15], v16 offset:19456
    ds_read_b128 a[16:19], v16 offset:20480
    ds_read_b128 a[20:23], v16 offset:21504
    ds_read_b128 a[24:27], v16 offset:22528
    ds_read_b128 a[28:31], v16 offset:23552
    s_waitcnt lgkmcnt(0)
c4_24:
    s_barrier
    s_barrier
    s_cmp_ge_u32 s9, 2
    s_cbranch_scc1 cs_26
    buffer_load_dwordx2 v[32:33], v11, s[12:15], s56 offen offset:0 sc1
    buffer_load_dwordx2 v[34:35], v11, s[12:15], s56 offen offset:256 sc1
    buffer_load_dwordx2 v[36:37], v11, s[12:15], s56 offen offset:512 sc1
    buffer_load_dwordx2 v[38:39], v11, s[12:15], s56 offen offset:768 sc1
    buffer_load_dwordx2 v[40:41], v11, s[12:15], s56 offen offset:1024 sc1
    buffer_load_dwordx2 v[42:43], v11, s[12:15], s56 offen offset:1280 sc1
    buffer_load_dwordx2 v[44:45], v11, s[12:15], s56 offen offset:1536 sc1
    buffer_load_dwordx2 v[46:47], v11, s[12:15], s56 offen offset:1792 sc1
    buffer_load_dwordx2 v[48:49], v11, s[12:15], s56 offen offset:2048 sc1
    buffer_load_dwordx2 v[50:51], v11, s[12:15], s56 offen offset:2304 sc1
    buffer_load_dwordx2 v[52:53], v11, s[12:15], s56 offen offset:2560 sc1
    buffer_load_dwordx2 v[54:55], v11, s[12:15], s56 offen offset:2816 sc1
cs_26:
    s_barrier
    s_cmp_ge_u32 s9, 2
    s_cbranch_scc1 cs_27
    buffer_load_dwordx2 v[56:57], v11, s[12:15], s56 offen offset:3072 sc1
    buffer_load_dwordx2 v[58:59], v11, s[12:15], s56 offen offset:3328 sc1
    buffer_load_dwordx2 v[60:61], v11, s[12:15], s56 offen offset:3584 sc1
    buffer_load_dwordx2 v[62:63], v11, s[12:15], s56 offen offset:3840 sc1
cs_27:
    s_barrier
    s_cmp_ge_u32 s9, 2
    s_cbranch_scc1 cs_28
    s_waitcnt vmcnt(0)
    v_add_f32 v32, v32, v48
    v_add_f32 v33, v33, v49
    v_add_f32 v34, v34, v50
    v_add_f32 v35, v35, v51
    v_add_f32 v36, v36, v52
    v_add_f32 v37, v37, v53
    v_add_f32 v38, v38, v54
    v_add_f32 v39, v39, v55
    v_add_f32 v40, v40, v56
    v_add_f32 v41, v41, v57
    v_add_f32 v42, v42, v58
    v_add_f32 v43, v43, v59
cs_28:
    s_barrier
    s_cmp_ge_u32 s9, 2
    s_cbranch_scc1 cs_29
    v_add_f32 v44, v44, v60
    v_add_f32 v45, v45, v61
    v_add_f32 v46, v46, v62
    v_add_f32 v47, v47, v63
    v_add_f32 v32, v32, v40
    v_add_f32 v33, v33, v41
    v_add_f32 v34, v34, v42
    v_add_f32 v35, v35, v43
    v_add_f32 v36, v36, v44
    v_add_f32 v37, v37, v45
    v_add_f32 v38, v38, v46
    v_add_f32 v39, v39, v47
cs_29:
    s_barrier
    s_cmp_ge_u32 s9, 2
    s_cbranch_scc1 cs_30
    v_add_f32 v32, v32, v36
    v_add_f32 v33, v33, v37
    v_add_f32 v34, v34, v38
    v_add_f32 v35, v35, v39
    v_add_f32 v32, v32, v34
    v_add_f32 v33, v33, v35
    ds_write_b64 v12, v[32:33]
    s_waitcnt lgkmcnt(0)
cs_30:
    s_barrier
    s_barrier
    s_branch s_attn
.p2align 6
l_first_tail:
    s_mov_b32 s28, s40
    s_mov_b32 s29, s41
    s_mov_b32 s30, 6291456
    s_mov_b32 s31, 0x00020000
    v_lshlrev_b32 v14, 6, v20
    v_lshrrev_b32 v22, 5, v1
    v_bfe_u32 v23, v1, 1, 1
    v_xor_b32 v22, v22, v23
    v_lshl_add_u32 v14, v22, 5, v14
    v_and_b32 v22, 1, v1
    v_lshl_add_u32 v14, v22, 4, v14
    v_bfe_u32 v23, v1, 2, 1
    v_mul_u32_u24 v23, 196608, v23
    v_add_u32 v14, v14, v23
    v_lshlrev_b32 v22, 4, v22
    v_mov_b32 v23, 0x3f80
    v_lshlrev_b32 v23, v22, v23
    v_bfe_u32 v22, v1, 1, 3
    v_cmp_eq_u32 vcc, 0, v22
    s_nop 1
    v_cndmask_b32 v24, 0, v23, vcc
    v_cmp_eq_u32 vcc, 1, v22
    s_nop 1
    v_cndmask_b32 v25, 0, v23, vcc
    v_cmp_eq_u32 vcc, 2, v22
    s_nop 1
    v_cndmask_b32 v26, 0, v23, vcc
    v_cmp_eq_u32 vcc, 3, v22
    s_nop 1
    v_cndmask_b32 v27, 0, v23, vcc
    v_lshlrev_b32 v15, 5, v21
    v_and_b32 v22, 16, v1
    v_add_u32 v15, v15, v22
    v_lshlrev_b32 v16, 14, v1
    s_mov_b32 s9, 0
    s_lshr_b32 s55, s63, 4
    s_and_b32 s56, s63, 15
    s_lshl_b32 s57, s56, 4
    s_lshr_b32 s58, s62, 1
    s_add_u32 s57, s57, s58
    s_mul_i32 s57, s57, 3
    s_add_u32 s57, s57, s55
    s_lshl_b32 s57, s57, 13
    s_and_b32 s58, s62, 1
    s_lshl_b32 s58, s58, 12
    s_add_u32 s57, s57, s58
    s_add_u32 s57, s57, 50331648
    s_lshl_b32 s54, s61, 8
    s_add_u32 s54, s54, 63963136
    s_lshl_b32 s56, s56, 10
    s_lshl_b32 s55, s55, 7
    s_add_u32 s55, s55, s56
    s_lshl_b32 s56, s62, 2
    s_add_u32 s55, s55, s56
    s_add_u32 s55, s55, 64487424
    s_waitcnt vmcnt(7)
    buffer_store_dwordx4 v[160:163], v14, s[12:15], s57 offen offset:0 sc1
    v_mfma_f32_16x16x32_bf16 v[28:31], v[24:27], v[160:163], 0
    s_waitcnt vmcnt(7)
    buffer_store_dwordx4 v[164:167], v14, s[12:15], s57 offen offset:1024 sc1
    v_mfma_f32_16x16x32_bf16 v[28:31], v[24:27], v[164:167], v[28:31]
    s_waitcnt vmcnt(7)
    buffer_store_dwordx4 v[168:171], v14, s[12:15], s57 offen offset:512 sc1
    v_mfma_f32_16x16x32_bf16 v[28:31], v[24:27], v[168:171], v[28:31]
    s_waitcnt vmcnt(7)
    buffer_store_dwordx4 v[172:175], v14, s[12:15], s57 offen offset:1536 sc1
    v_mfma_f32_16x16x32_bf16 v[28:31], v[24:27], v[172:175], v[28:31]
    s_waitcnt vmcnt(7)
    buffer_store_dwordx4 v[176:179], v14, s[12:15], s57 offen offset:2048 sc1
    v_mfma_f32_16x16x32_bf16 v[28:31], v[24:27], v[176:179], v[28:31]
    s_waitcnt vmcnt(7)
    buffer_store_dwordx4 v[180:183], v14, s[12:15], s57 offen offset:3072 sc1
    v_mfma_f32_16x16x32_bf16 v[28:31], v[24:27], v[180:183], v[28:31]
    s_waitcnt vmcnt(7)
    buffer_store_dwordx4 v[184:187], v14, s[12:15], s57 offen offset:2560 sc1
    v_mfma_f32_16x16x32_bf16 v[28:31], v[24:27], v[184:187], v[28:31]
    s_waitcnt vmcnt(7)
    buffer_store_dwordx4 v[188:191], v14, s[12:15], s57 offen offset:3584 sc1
    v_mfma_f32_16x16x32_bf16 v[28:31], v[24:27], v[188:191], v[28:31]
    s_nop 7
    v_add_f32_dpp v28, v28, v28 row_ror:8 row_mask:0xf bank_mask:0xf
    v_add_f32_dpp v29, v29, v29 row_ror:8 row_mask:0xf bank_mask:0xf
    v_add_f32_dpp v30, v30, v30 row_ror:8 row_mask:0xf bank_mask:0xf
    v_add_f32_dpp v31, v31, v31 row_ror:8 row_mask:0xf bank_mask:0xf
    s_mov_b64 exec, 0x00ff00ff
    buffer_store_dwordx4 v[28:31], v15, s[12:15], s54 offen sc1
    s_mov_b64 exec, -1
    s_add_u32 s57, s57, 6291456
    s_add_u32 s54, s54, 196608
    v_mov_b32 v8, 159492
non_33:
    ds_read_b32 v9, v8
    s_waitcnt lgkmcnt(0)
    v_readfirstlane_b32 s10, v9
    s_cmp_eq_u32 s10, 0
    s_cbranch_scc1 non_33
    s_mov_b64 exec, 0xffff
    s_waitcnt vmcnt(0)
    buffer_store_dword v9, v16, s[12:15], s55 offen offset:0 sc1
    s_mov_b64 exec, -1
    s_add_u32 s53, s52, 0
    buffer_load_dwordx4 v[192:195], v12, s[28:31], s53 offen nt
    s_add_u32 s53, s52, 49152
    buffer_load_dwordx4 v[196:199], v12, s[28:31], s53 offen nt
    s_add_u32 s53, s52, 98304
    buffer_load_dwordx4 v[200:203], v12, s[28:31], s53 offen nt
    s_add_u32 s53, s52, 147456
    buffer_load_dwordx4 v[204:207], v12, s[28:31], s53 offen nt
    s_add_u32 s53, s52, 196608
    buffer_load_dwordx4 v[208:211], v12, s[28:31], s53 offen nt
    s_add_u32 s53, s52, 245760
    buffer_load_dwordx4 v[212:215], v12, s[28:31], s53 offen nt
    s_add_u32 s53, s52, 294912
    buffer_load_dwordx4 v[216:219], v12, s[28:31], s53 offen nt
    s_add_u32 s53, s52, 344064
    buffer_load_dwordx4 v[220:223], v12, s[28:31], s53 offen nt
    s_mov_b32 s58, s52
    s_lshr_b32 s60, s2, 3
    s_mul_i32 s60, s60, 3
    s_lshr_b32 s60, s60, 5
    s_add_u32 s60, s60, 1
    s_branch l_qkv2
l_qkv:
    s_mov_b32 s60, 0
l_qkv2:
    v_and_b32 v1, 63, v0
    v_lshlrev_b32 v5, 4, v1
    s_sub_u32 s51, s8, 5
    s_lshl_b32 s48, s51, 13
    s_and_b32 s53, s9, 1
    s_lshl_b32 s52, s53, 4
    s_add_u32 s49, s7, s52
    s_lshl_b32 s49, s49, 1
    s_and_b32 s52, s6, 1
    s_add_u32 s49, s49, s52
    s_mul_i32 s49, s49, 196608
    s_add_u32 s49, s49, s48
    s_add_u32 s49, s49, 50331648
    v_mov_b32 v13, 159496
    s_mov_b32 s50, 0
    v_lshrrev_b32 v10, 2, v1
    v_and_b32 v11, 3, v1
    v_lshlrev_b32 v10, 8, v10
    v_lshl_add_u32 v10, v11, 4, v10
    v_lshlrev_b32 v7, 5, v11
    v_lshlrev_b32 v11, 2, v1
    v_add_u32 v11, 155648, v11
    s_lshr_b32 s59, s11, 2
    s_lshl_b32 s59, s59, 12
    s_and_b32 s3, s11, 3
    s_lshl_b32 s3, s3, 6
    s_add_u32 s59, s59, s3
    s_lshl_b32 s3, s9, 18
    s_add_u32 s59, s59, s3
    s_add_u32 s59, s59, 62914560
    s_lshl_b32 s56, s9, 15
    s_add_u32 s56, s56, 64749568
    v_mov_b32 v41, s10
    v_mov_b32 v43, s10
    v_mov_b32 v45, s10
    v_mov_b32 v47, s10
    v_and_b32 v6, 0xff, v5
    s_lshl_b32 s3, s7, 7
    v_lshrrev_b32 v20, 3, v1
    v_lshlrev_b32 v21, 11, v20
    v_and_b32 v22, 2, v20
    v_lshrrev_b32 v23, 2, v20
    v_or_b32 v22, v22, v23
    v_bfe_u32 v23, v1, 1, 2
    v_xor_b32 v22, v22, v23
    v_lshl_add_u32 v21, v22, 5, v21
    v_and_b32 v22, 1, v1
    v_lshl_add_u32 v21, v22, 4, v21
    v_add_u32 v17, s3, v21
    s_lshl_b32 s3, s51, 13
    s_add_u32 s3, s3, 24576
    v_add_u32 v3, s3, v5
    s_cmp_lg_u32 s9, 0
    s_cbranch_scc1 l_qkv_tiled
    s_lshl_b32 s53, s8, 7
    s_lshl_b32 s52, s11, 10
    s_add_u32 s53, s53, s52
    s_add_u32 s53, s53, 64486784
    s_add_u32 s96, s4, s53
    s_addc_u32 s97, s5, 0
    s_mov_b32 s98, s10
    s_mov_b32 s99, s10
    s_mov_b32 s3, 0x100000
poll_34:
    s_load_dwordx16 s[80:95], s[96:97], 0 glc
    s_sub_u32 s3, s3, 1
    s_cbranch_scc1 poll_34_ok
    s_waitcnt lgkmcnt(0)
    s_xor_b64 s[100:101], s[80:81], s[98:99]
    s_xor_b64 s[80:81], s[82:83], s[98:99]
    s_or_b64 s[100:101], s[100:101], s[80:81]
    s_xor_b64 s[80:81], s[84:85], s[98:99]
    s_or_b64 s[100:101], s[100:101], s[80:81]
    s_xor_b64 s[80:81], s[86:87], s[98:99]
    s_or_b64 s[100:101], s[100:101], s[80:81]
    s_xor_b64 s[80:81], s[88:89], s[98:99]
    s_or_b64 s[100:101], s[100:101], s[80:81]
    s_xor_b64 s[80:81], s[90:91], s[98:99]
    s_or_b64 s[100:101], s[100:101], s[80:81]
    s_xor_b64 s[80:81], s[92:93], s[98:99]
    s_or_b64 s[100:101], s[100:101], s[80:81]
    s_xor_b64 s[80:81], s[94:95], s[98:99]
    s_or_b64 s[100:101], s[100:101], s[80:81]
    s_cbranch_scc1 poll_34
poll_34_ok:
    s_waitcnt lgkmcnt(0)
    s_branch l_qkv_fill
l_qkv_tiled:
    s_barrier
    s_cmp_lt_u32 s9, 2
    s_cbranch_scc1 l_qkv_nocache
    s_bitcmp1_b32 s9, 0
    s_cbranch_scc1 l_qkv_c_b
    ds_write_b128 v3, v[64:67] offset:0
    ds_write_b128 v3, v[68:71] offset:1024
    ds_write_b128 v3, v[72:75] offset:2048
    ds_write_b128 v3, v[76:79] offset:3072
    ds_write_b128 v3, v[80:83] offset:4096
    ds_write_b128 v3, v[84:87] offset:5120
    ds_write_b128 v3, v[88:91] offset:6144
    ds_write_b128 v3, v[92:95] offset:7168
    ds_write_b128 v3, v[96:99] offset:24576
    ds_write_b128 v3, v[100:103] offset:25600
    ds_write_b128 v3, v[104:107] offset:26624
    ds_write_b128 v3, v[108:111] offset:27648
    ds_write_b128 v3, v[112:115] offset:28672
    ds_write_b128 v3, v[116:119] offset:29696
    ds_write_b128 v3, v[120:123] offset:30720
    ds_write_b128 v3, v[124:127] offset:31744
    ds_write_b128 v3, v[128:131] offset:49152
    ds_write_b128 v3, v[132:135] offset:50176
    ds_write_b128 v3, v[136:139] offset:51200
    ds_write_b128 v3, v[140:143] offset:52224
    ds_write_b128 v3, v[144:147] offset:53248
    ds_write_b128 v3, v[148:151] offset:54272
    ds_write_b128 v3, v[152:155] offset:55296
    ds_write_b128 v3, v[156:159] offset:56320
    s_branch l_qkv_c_w
l_qkv_c_b:
    ds_write_b128 v3, v[160:163] offset:0
    ds_write_b128 v3, v[164:167] offset:1024
    ds_write_b128 v3, v[168:171] offset:2048
    ds_write_b128 v3, v[172:175] offset:3072
    ds_write_b128 v3, v[176:179] offset:4096
    ds_write_b128 v3, v[180:183] offset:5120
    ds_write_b128 v3, v[184:187] offset:6144
    ds_write_b128 v3, v[188:191] offset:7168
    ds_write_b128 v3, v[192:195] offset:24576
    ds_write_b128 v3, v[196:199] offset:25600
    ds_write_b128 v3, v[200:203] offset:26624
    ds_write_b128 v3, v[204:207] offset:27648
    ds_write_b128 v3, v[208:211] offset:28672
    ds_write_b128 v3, v[212:215] offset:29696
    ds_write_b128 v3, v[216:219] offset:30720
    ds_write_b128 v3, v[220:223] offset:31744
    ds_write_b128 v3, a[0:3] offset:49152
    ds_write_b128 v3, a[4:7] offset:50176
    ds_write_b128 v3, a[8:11] offset:51200
    ds_write_b128 v3, a[12:15] offset:52224
    ds_write_b128 v3, a[16:19] offset:53248
    ds_write_b128 v3, a[20:23] offset:54272
    ds_write_b128 v3, a[24:27] offset:55296
    ds_write_b128 v3, a[28:31] offset:56320
l_qkv_c_w:
    s_waitcnt lgkmcnt(0)
    s_mov_b32 s50, 8
    s_add_u32 s49, s49, 98304
    s_add_u32 s48, s48, 98304
    s_barrier
    s_mov_b32 m0, s48
    s_add_u32 s50, s50, 1
    buffer_load_dwordx4 v5, s[12:15], s49 offen offset:0 sc1 lds
    buffer_load_dwordx4 v5, s[12:15], s49 offen offset:1024 sc1 lds
    buffer_load_dwordx4 v5, s[12:15], s49 offen offset:2048 sc1 lds
    buffer_load_dwordx4 v5, s[12:15], s49 offen offset:3072 sc1 lds
    s_add_u32 s49, s49, 4096
    s_bitcmp1_b32 s50, 0
    s_cselect_b32 s3, 0, 16384
    s_add_u32 s48, s48, s3
    s_add_u32 s49, s49, s3
    s_cmp_eq_u32 s50, 12
    s_cselect_b32 s3, 4294819840, 0
    s_add_u32 s48, s48, 4096
    s_add_u32 s48, s48, s3
    s_mov_b32 m0, s48
    s_add_u32 s50, s50, 1
    buffer_load_dwordx4 v5, s[12:15], s49 offen offset:0 sc1 lds
    buffer_load_dwordx4 v5, s[12:15], s49 offen offset:1024 sc1 lds
    buffer_load_dwordx4 v5, s[12:15], s49 offen offset:2048 sc1 lds
    buffer_load_dwordx4 v5, s[12:15], s49 offen offset:3072 sc1 lds
    s_add_u32 s49, s49, 4096
    s_bitcmp1_b32 s50, 0
    s_cselect_b32 s3, 0, 16384
    s_add_u32 s48, s48, s3
    s_add_u32 s49, s49, s3
    s_cmp_eq_u32 s50, 12
    s_cselect_b32 s3, 4294819840, 0
    s_add_u32 s48, s48, 4096
    s_add_u32 s48, s48, s3
    s_mov_b32 m0, s48
    s_add_u32 s50, s50, 1
    buffer_load_dwordx4 v5, s[12:15], s49 offen offset:0 sc1 lds
    buffer_load_dwordx4 v5, s[12:15], s49 offen offset:1024 sc1 lds
    buffer_load_dwordx4 v5, s[12:15], s49 offen offset:2048 sc1 lds
    buffer_load_dwordx4 v5, s[12:15], s49 offen offset:3072 sc1 lds
    s_add_u32 s49, s49, 4096
    s_bitcmp1_b32 s50, 0
    s_cselect_b32 s3, 0, 16384
    s_add_u32 s48, s48, s3
    s_add_u32 s49, s49, s3
    s_cmp_eq_u32 s50, 12
    s_cselect_b32 s3, 4294819840, 0
    s_add_u32 s48, s48, 4096
    s_add_u32 s48, s48, s3
    s_mov_b32 m0, s48
    s_add_u32 s50, s50, 1
    buffer_load_dwordx4 v5, s[12:15], s49 offen offset:0 sc1 lds
    buffer_load_dwordx4 v5, s[12:15], s49 offen offset:1024 sc1 lds
    buffer_load_dwordx4 v5, s[12:15], s49 offen offset:2048 sc1 lds
    buffer_load_dwordx4 v5, s[12:15], s49 offen offset:3072 sc1 lds
    s_add_u32 s49, s49, 4096
    s_bitcmp1_b32 s50, 0
    s_cselect_b32 s3, 0, 16384
    s_add_u32 s48, s48, s3
    s_add_u32 s49, s49, s3
    s_cmp_eq_u32 s50, 12
    s_cselect_b32 s3, 4294819840, 0
    s_add_u32 s48, s48, 4096
    s_add_u32 s48, s48, s3
    s_barrier
    s_branch l_qkv_gone
l_qkv_nocache:
    s_barrier
l_qkv_fill:
    s_mov_b32 m0, s48
    s_add_u32 s50, s50, 1
    buffer_load_dwordx4 v5, s[12:15], s49 offen offset:0 sc1 lds
    buffer_load_dwordx4 v5, s[12:15], s49 offen offset:1024 sc1 lds
    buffer_load_dwordx4 v5, s[12:15], s49 offen offset:2048 sc1 lds
    buffer_load_dwordx4 v5, s[12:15], s49 offen offset:3072 sc1 lds
    s_add_u32 s49, s49, 4096
    s_bitcmp1_b32 s50, 0
    s_cselect_b32 s3, 0, 16384
    s_add_u32 s48, s48, s3
    s_add_u32 s49, s49, s3
    s_cmp_eq_u32 s50, 12
    s_cselect_b32 s3, 4294819840, 0
    s_add_u32 s48, s48, 4096
    s_add_u32 s48, s48, s3
l_qkv_fill1:
    s_mov_b32 m0, s48
    s_add_u32 s50, s50, 1
    buffer_load_dwordx4 v5, s[12:15], s49 offen offset:0 sc1 lds
    buffer_load_dwordx4 v5, s[12:15], s49 offen offset:1024 sc1 lds
    buffer_load_dwordx4 v5, s[12:15], s49 offen offset:2048 sc1 lds
    buffer_load_dwordx4 v5, s[12:15], s49 offen offset:3072 sc1 lds
    s_add_u32 s49, s49, 4096
    s_bitcmp1_b32 s50, 0
    s_cselect_b32 s3, 0, 16384
    s_add_u32 s48, s48, s3
    s_add_u32 s49, s49, s3
    s_cmp_eq_u32 s50, 12
    s_cselect_b32 s3, 4294819840, 0
    s_add_u32 s48, s48, 4096
    s_add_u32 s48, s48, s3
l_qkv_fill2:
    s_add_u32 s52, s9, 1
    s_mov_b32 m0, s48
    s_add_u32 s50, s50, 1
    buffer_load_dwordx4 v5, s[12:15], s49 offen offset:0 sc1 lds
    s_waitcnt vmcnt(10)
    buffer_load_dwordx4 v5, s[12:15], s49 offen offset:1024 sc1 lds
    s_waitcnt vmcnt(10)
    buffer_load_dwordx4 v5, s[12:15], s49 offen offset:2048 sc1 lds
    s_waitcnt vmcnt(10)
    buffer_load_dwordx4 v5, s[12:15], s49 offen offset:3072 sc1 lds
    s_waitcnt vmcnt(10)
    s_add_u32 s49, s49, 4096
    s_bitcmp1_b32 s50, 0
    s_cselect_b32 s3, 0, 16384
    s_add_u32 s48, s48, s3
    s_add_u32 s49, s49, s3
    s_cmp_eq_u32 s50, 12
    s_cselect_b32 s3, 4294819840, 0
    s_add_u32 s48, s48, 4096
    s_add_u32 s48, s48, s3
l_qkv_pre:
    s_mov_b32 m0, s48
    s_add_u32 s50, s50, 1
    buffer_load_dwordx4 v5, s[12:15], s49 offen offset:0 sc1 lds
    s_waitcnt vmcnt(10)
    buffer_load_dwordx4 v5, s[12:15], s49 offen offset:1024 sc1 lds
    s_waitcnt vmcnt(10)
    buffer_load_dwordx4 v5, s[12:15], s49 offen offset:2048 sc1 lds
    s_waitcnt vmcnt(10)
    buffer_load_dwordx4 v5, s[12:15], s49 offen offset:3072 sc1 lds
    s_waitcnt vmcnt(10)
    s_add_u32 s49, s49, 4096
    s_bitcmp1_b32 s50, 0
    s_cselect_b32 s3, 0, 16384
    s_add_u32 s48, s48, s3
    s_add_u32 s49, s49, s3
    s_cmp_eq_u32 s50, 12
    s_cselect_b32 s3, 4294819840, 0
    s_add_u32 s48, s48, 4096
    s_add_u32 s48, s48, s3
    ds_read_b32 v8, v13
    s_cmp_ge_u32 s50, 12
    s_cbranch_scc1 l_qkv_go
    s_waitcnt lgkmcnt(0)
    v_readfirstlane_b32 s3, v8
    s_cmp_lg_u32 s3, s52
    s_cbranch_scc1 l_qkv_pre
    s_cmp_ge_u32 s50, 5
    s_cbranch_scc1 l_qkv_go
    s_waitcnt vmcnt(8)
l_qkv_go:
    s_waitcnt lgkmcnt(0)
    s_barrier
l_qkv_gone:
    s_bitcmp0_b32 s50, 0
    s_cbranch_scc1 l_qkv_even
    s_mov_b32 m0, s48
    s_add_u32 s50, s50, 1
    buffer_load_dwordx4 v5, s[12:15], s49 offen offset:0 sc1 lds
    buffer_load_dwordx4 v5, s[12:15], s49 offen offset:1024 sc1 lds
    buffer_load_dwordx4 v5, s[12:15], s49 offen offset:2048 sc1 lds
    buffer_load_dwordx4 v5, s[12:15], s49 offen offset:3072 sc1 lds
    s_add_u32 s49, s49, 4096
    s_bitcmp1_b32 s50, 0
    s_cselect_b32 s3, 0, 16384
    s_add_u32 s48, s48, s3
    s_add_u32 s49, s49, s3
    s_cmp_eq_u32 s50, 12
    s_cselect_b32 s3, 4294819840, 0
    s_add_u32 s48, s48, 4096
    s_add_u32 s48, s48, s3
l_qkv_even:
    s_cmp_gt_u32 s50, 11
    s_cbranch_scc1 stg_35
    s_mov_b32 m0, s48
    s_add_u32 s50, s50, 1
    buffer_load_dwordx4 v5, s[12:15], s49 offen offset:0 sc1 lds
    buffer_load_dwordx4 v5, s[12:15], s49 offen offset:1024 sc1 lds
    buffer_load_dwordx4 v5, s[12:15], s49 offen offset:2048 sc1 lds
    buffer_load_dwordx4 v5, s[12:15], s49 offen offset:3072 sc1 lds
    s_add_u32 s49, s49, 4096
    s_bitcmp1_b32 s50, 0
    s_cselect_b32 s3, 0, 16384
    s_add_u32 s48, s48, s3
    s_add_u32 s49, s49, s3
    s_cmp_eq_u32 s50, 12
    s_cselect_b32 s3, 4294819840, 0
    s_add_u32 s48, s48, 4096
    s_add_u32 s48, s48, s3
    s_cmp_ge_u32 s9, 2
    s_cbranch_scc1 stg_35
stg_35:
    s_cmp_lg_u32 s51, 0
    s_cbranch_scc1 role_36
    buffer_load_dwordx4 v[32:35], v10, s[12:15], s59 offen sc1
role_36:
    s_lshr_b32 s3, s9, 1
    s_andn2_b32 s3, s50, s3
    s_bitcmp0_b32 s3, 0
    s_cbranch_scc1 str_37
    s_waitcnt vmcnt(1)
    s_mov_b32 m0, s48
    s_add_u32 s50, s50, 1
    buffer_load_dwordx4 v5, s[12:15], s49 offen offset:0 sc1 lds
    buffer_load_dwordx4 v5, s[12:15], s49 offen offset:1024 sc1 lds
    buffer_load_dwordx4 v5, s[12:15], s49 offen offset:2048 sc1 lds
    buffer_load_dwordx4 v5, s[12:15], s49 offen offset:3072 sc1 lds
    s_add_u32 s49, s49, 4096
    s_bitcmp1_b32 s50, 0
    s_cselect_b32 s3, 0, 16384
    s_add_u32 s48, s48, s3
    s_add_u32 s49, s49, s3
    s_cmp_eq_u32 s50, 12
    s_cselect_b32 s3, 4294819840, 0
    s_add_u32 s48, s48, 4096
    s_add_u32 s48, s48, s3
str_37:
    s_waitcnt vmcnt(8)
    s_barrier
    s_waitcnt vmcnt(0)
l_qkv_b0:
    s_cmp_gt_u32 s50, 13
    s_cbranch_scc1 stg_38
    s_mov_b32 m0, s48
    s_add_u32 s50, s50, 1
    buffer_load_dwordx4 v5, s[12:15], s49 offen offset:0 sc1 lds
    buffer_load_dwordx4 v5, s[12:15], s49 offen offset:1024 sc1 lds
    buffer_load_dwordx4 v5, s[12:15], s49 offen offset:2048 sc1 lds
    buffer_load_dwordx4 v5, s[12:15], s49 offen offset:3072 sc1 lds
    s_add_u32 s49, s49, 4096
    s_bitcmp1_b32 s50, 0
    s_cselect_b32 s3, 0, 16384
    s_add_u32 s48, s48, s3
    s_add_u32 s49, s49, s3
    s_cmp_eq_u32 s50, 12
    s_cselect_b32 s3, 4294819840, 0
    s_add_u32 s48, s48, 4096
    s_add_u32 s48, s48, s3
    s_cmp_ge_u32 s9, 2
    s_cbranch_scc1 stg_38
stg_38:
    s_cmp_eq_u32 s60, 0
    s_cbranch_scc1 ub_39
    buffer_store_dwordx4 v[192:195], v14, s[12:15], s57 offen offset:0 sc1
    v_mfma_f32_16x16x32_bf16 v[28:31], v[24:27], v[192:195], 0
    buffer_store_dwordx4 v[196:199], v14, s[12:15], s57 offen offset:1024 sc1
    v_mfma_f32_16x16x32_bf16 v[28:31], v[24:27], v[196:199], v[28:31]
ub_39:
    s_cmp_ge_u32 s9, 2
    s_cbranch_scc1 wc_40
    s_bitcmp1_b32 s9, 0
    s_cbranch_scc1 wc_40_b
    ds_read_b128 v[64:67], v3 offset:0
    ds_read_b128 v[68:71], v3 offset:1024
    ds_read_b128 v[72:75], v3 offset:2048
    ds_read_b128 v[76:79], v3 offset:3072
    ds_read_b128 v[80:83], v3 offset:4096
    ds_read_b128 v[84:87], v3 offset:5120
    ds_read_b128 v[88:91], v3 offset:6144
    ds_read_b128 v[92:95], v3 offset:7168
    s_branch wc_40_w
wc_40_b:
    ds_read_b128 v[160:163], v3 offset:0
    ds_read_b128 v[164:167], v3 offset:1024
    ds_read_b128 v[168:171], v3 offset:2048
    ds_read_b128 v[172:175], v3 offset:3072
    ds_read_b128 v[176:179], v3 offset:4096
    ds_read_b128 v[180:183], v3 offset:5120
    ds_read_b128 v[184:187], v3 offset:6144
    ds_read_b128 v[188:191], v3 offset:7168
wc_40_w:
    s_waitcnt lgkmcnt(0)
wc_40:
    s_cmp_lg_u32 s51, 0
    s_cbranch_scc1 role_41
    v_add_f32_dpp v32, v32, v32 row_ror:4 row_mask:0xf bank_mask:0xf
    v_add_f32_dpp v33, v33, v33 row_ror:4 row_mask:0xf bank_mask:0xf
    v_add_f32_dpp v34, v34, v34 row_ror:4 row_mask:0xf bank_mask:0xf
    v_add_f32_dpp v35, v35, v35 row_ror:4 row_mask:0xf bank_mask:0xf
    v_add_f32_dpp v32, v32, v32 row_ror:8 row_mask:0xf bank_mask:0xf
    v_add_f32_dpp v33, v33, v33 row_ror:8 row_mask:0xf bank_mask:0xf
    v_add_f32_dpp v34, v34, v34 row_ror:8 row_mask:0xf bank_mask:0xf
    v_add_f32_dpp v35, v35, v35 row_ror:8 row_mask:0xf bank_mask:0xf
    v_mov_b32 v36, v32
    v_mov_b32 v37, v33
    v_mov_b32 v38, v34
    v_mov_b32 v39, v35
    v_permlane16_swap_b32 v32, v36
    v_permlane16_swap_b32 v33, v37
    v_permlane16_swap_b32 v34, v38
    v_permlane16_swap_b32 v35, v39
    v_add_f32 v32, v32, v36
    v_add_f32 v33, v33, v37
    v_add_f32 v34, v34, v38
    v_add_f32 v35, v35, v39
    v_mov_b32 v36, v32
    v_mov_b32 v37, v33
    v_mov_b32 v38, v34
    v_mov_b32 v39, v35
    v_permlane32_swap_b32 v32, v36
    v_permlane32_swap_b32 v33, v37
    v_permlane32_swap_b32 v34, v38
    v_permlane32_swap_b32 v35, v39
    v_add_f32 v40, v32, v36
    v_add_f32 v42, v33, v37
    v_add_f32 v44, v34, v38
    v_add_f32 v46, v35, v39
role_41:
    s_lshr_b32 s3, s9, 1
    s_andn2_b32 s3, s50, s3
    s_bitcmp0_b32 s3, 0
    s_cbranch_scc1 str_42
    s_waitcnt vmcnt(1)
    s_mov_b32 m0, s48
    s_add_u32 s50, s50, 1
    buffer_load_dwordx4 v5, s[12:15], s49 offen offset:0 sc1 lds
    buffer_load_dwordx4 v5, s[12:15], s49 offen offset:1024 sc1 lds
    buffer_load_dwordx4 v5, s[12:15], s49 offen offset:2048 sc1 lds
    buffer_load_dwordx4 v5, s[12:15], s49 offen offset:3072 sc1 lds
    s_add_u32 s49, s49, 4096
    s_bitcmp1_b32 s50, 0
    s_cselect_b32 s3, 0, 16384
    s_add_u32 s48, s48, s3
    s_add_u32 s49, s49, s3
    s_cmp_eq_u32 s50, 12
    s_cselect_b32 s3, 4294819840, 0
    s_add_u32 s48, s48, 4096
    s_add_u32 s48, s48, s3
str_42:
    s_waitcnt vmcnt(8)
    s_barrier
    s_cmp_gt_u32 s50, 15
    s_cbranch_scc1 stg_43
    s_mov_b32 m0, s48
    s_add_u32 s50, s50, 1
    buffer_load_dwordx4 v5, s[12:15], s49 offen offset:0 sc1 lds
    buffer_load_dwordx4 v5, s[12:15], s49 offen offset:1024 sc1 lds
    buffer_load_dwordx4 v5, s[12:15], s49 offen offset:2048 sc1 lds
    buffer_load_dwordx4 v5, s[12:15], s49 offen offset:3072 sc1 lds
    s_add_u32 s49, s49, 4096
    s_bitcmp1_b32 s50, 0
    s_cselect_b32 s3, 0, 16384
    s_add_u32 s48, s48, s3
    s_add_u32 s49, s49, s3
    s_cmp_eq_u32 s50, 12
    s_cselect_b32 s3, 4294819840, 0
    s_add_u32 s48, s48, 4096
    s_add_u32 s48, s48, s3
    s_cmp_ge_u32 s9, 2
    s_cbranch_scc1 stg_43
stg_43:
    s_cmp_eq_u32 s60, 0
    s_cbranch_scc1 ub_44
    buffer_store_dwordx4 v[200:203], v14, s[12:15], s57 offen offset:512 sc1
    v_mfma_f32_16x16x32_bf16 v[28:31], v[24:27], v[200:203], v[28:31]
    buffer_store_dwordx4 v[204:207], v14, s[12:15], s57 offen offset:1536 sc1
    v_mfma_f32_16x16x32_bf16 v[28:31], v[24:27], v[204:207], v[28:31]
ub_44:
    s_cmp_lg_u32 s51, 0
    s_cbranch_scc1 role_45
    v_mul_f32 v40, 0x3a800000, v40
    v_mul_f32 v44, 0x3a800000, v44
    v_mul_f32 v42, 0x3a800000, v42
    v_mul_f32 v46, 0x3a800000, v46
    v_fma_f32 v42, -v40, v40, v42
    v_fma_f32 v46, -v44, v44, v46
    v_max_f32 v42, 0, v42
    v_max_f32 v46, 0, v46
    v_add_f32 v42, 0x3727c5ac, v42
    v_add_f32 v46, 0x3727c5ac, v46
    v_rsq_f32 v42, v42
    v_rsq_f32 v46, v46
    s_lshl_b32 s3, s11, 7
    s_add_u32 s3, s3, s56
    s_mov_b64 exec, 0xf
    buffer_store_dwordx4 v[40:43], v7, s[12:15], s3 offen offset:0 sc1
    buffer_store_dwordx4 v[44:47], v7, s[12:15], s3 offen offset:16 sc1
    s_mov_b64 exec, -1
role_45:
    s_lshr_b32 s3, s9, 1
    s_andn2_b32 s3, s50, s3
    s_bitcmp0_b32 s3, 0
    s_cbranch_scc1 str_46
    s_waitcnt vmcnt(1)
    s_mov_b32 m0, s48
    s_add_u32 s50, s50, 1
    buffer_load_dwordx4 v5, s[12:15], s49 offen offset:0 sc1 lds
    buffer_load_dwordx4 v5, s[12:15], s49 offen offset:1024 sc1 lds
    buffer_load_dwordx4 v5, s[12:15], s49 offen offset:2048 sc1 lds
    buffer_load_dwordx4 v5, s[12:15], s49 offen offset:3072 sc1 lds
    s_add_u32 s49, s49, 4096
    s_bitcmp1_b32 s50, 0
    s_cselect_b32 s3, 0, 16384
    s_add_u32 s48, s48, s3
    s_add_u32 s49, s49, s3
    s_cmp_eq_u32 s50, 12
    s_cselect_b32 s3, 4294819840, 0
    s_add_u32 s48, s48, 4096
    s_add_u32 s48, s48, s3
str_46:
    s_waitcnt vmcnt(8)
    s_barrier
    s_cmp_gt_u32 s50, 15
    s_cbranch_scc1 stg_47
    s_mov_b32 m0, s48
    s_add_u32 s50, s50, 1
    buffer_load_dwordx4 v5, s[12:15], s49 offen offset:0 sc1 lds
    buffer_load_dwordx4 v5, s[12:15], s49 offen offset:1024 sc1 lds
    buffer_load_dwordx4 v5, s[12:15], s49 offen offset:2048 sc1 lds
    buffer_load_dwordx4 v5, s[12:15], s49 offen offset:3072 sc1 lds
    s_add_u32 s49, s49, 4096
    s_bitcmp1_b32 s50, 0
    s_cselect_b32 s3, 0, 16384
    s_add_u32 s48, s48, s3
    s_add_u32 s49, s49, s3
    s_cmp_eq_u32 s50, 12
    s_cselect_b32 s3, 4294819840, 0
    s_add_u32 s48, s48, 4096
    s_add_u32 s48, s48, s3
    s_cmp_ge_u32 s9, 2
    s_cbranch_scc1 stg_47
stg_47:
    s_cmp_eq_u32 s60, 0
    s_cbranch_scc1 ub_48
    buffer_store_dwordx4 v[208:211], v14, s[12:15], s57 offen offset:2048 sc1
    v_mfma_f32_16x16x32_bf16 v[28:31], v[24:27], v[208:211], v[28:31]
    buffer_store_dwordx4 v[212:215], v14, s[12:15], s57 offen offset:3072 sc1
    v_mfma_f32_16x16x32_bf16 v[28:31], v[24:27], v[212:215], v[28:31]
ub_48:
    s_cmp_ge_u32 s9, 2
    s_cbranch_scc1 wc_49
    s_bitcmp1_b32 s9, 0
    s_cbranch_scc1 wc_49_b
    ds_read_b128 v[96:99], v3 offset:24576
    ds_read_b128 v[100:103], v3 offset:25600
    ds_read_b128 v[104:107], v3 offset:26624
    ds_read_b128 v[108:111], v3 offset:27648
    ds_read_b128 v[112:115], v3 offset:28672
    ds_read_b128 v[116:119], v3 offset:29696
    ds_read_b128 v[120:123], v3 offset:30720
    ds_read_b128 v[124:127], v3 offset:31744
    s_branch wc_49_w
wc_49_b:
    ds_read_b128 v[192:195], v3 offset:24576
    ds_read_b128 v[196:199], v3 offset:25600
    ds_read_b128 v[200:203], v3 offset:26624
    ds_read_b128 v[204:207], v3 offset:27648
    ds_read_b128 v[208:211], v3 offset:28672
    ds_read_b128 v[212:215], v3 offset:29696
    ds_read_b128 v[216:219], v3 offset:30720
    ds_read_b128 v[220:223], v3 offset:31744
wc_49_w:
    s_waitcnt lgkmcnt(0)
wc_49:
    s_lshr_b32 s3, s9, 1
    s_andn2_b32 s3, s50, s3
    s_bitcmp0_b32 s3, 0
    s_cbranch_scc1 str_50
    s_waitcnt vmcnt(1)
    s_mov_b32 m0, s48
    s_add_u32 s50, s50, 1
    buffer_load_dwordx4 v5, s[12:15], s49 offen offset:0 sc1 lds
    buffer_load_dwordx4 v5, s[12:15], s49 offen offset:1024 sc1 lds
    buffer_load_dwordx4 v5, s[12:15], s49 offen offset:2048 sc1 lds
    buffer_load_dwordx4 v5, s[12:15], s49 offen offset:3072 sc1 lds
    s_add_u32 s49, s49, 4096
    s_bitcmp1_b32 s50, 0
    s_cselect_b32 s3, 0, 16384
    s_add_u32 s48, s48, s3
    s_add_u32 s49, s49, s3
    s_cmp_eq_u32 s50, 12
    s_cselect_b32 s3, 4294819840, 0
    s_add_u32 s48, s48, 4096
    s_add_u32 s48, s48, s3
str_50:
    s_waitcnt vmcnt(8)
    s_barrier
    s_cmp_gt_u32 s50, 15
    s_cbranch_scc1 stg_51
    s_mov_b32 m0, s48
    s_add_u32 s50, s50, 1
    buffer_load_dwordx4 v5, s[12:15], s49 offen offset:0 sc1 lds
    buffer_load_dwordx4 v5, s[12:15], s49 offen offset:1024 sc1 lds
    buffer_load_dwordx4 v5, s[12:15], s49 offen offset:2048 sc1 lds
    buffer_load_dwordx4 v5, s[12:15], s49 offen offset:3072 sc1 lds
    s_add_u32 s49, s49, 4096
    s_bitcmp1_b32 s50, 0
    s_cselect_b32 s3, 0, 16384
    s_add_u32 s48, s48, s3
    s_add_u32 s49, s49, s3
    s_cmp_eq_u32 s50, 12
    s_cselect_b32 s3, 4294819840, 0
    s_add_u32 s48, s48, 4096
    s_add_u32 s48, s48, s3
    s_cmp_ge_u32 s9, 2
    s_cbranch_scc1 stg_51
stg_51:
    s_cmp_eq_u32 s60, 0
    s_cbranch_scc1 ub_52
    buffer_store_dwordx4 v[216:219], v14, s[12:15], s57 offen offset:2560 sc1
    v_mfma_f32_16x16x32_bf16 v[28:31], v[24:27], v[216:219], v[28:31]
    buffer_store_dwordx4 v[220:223], v14, s[12:15], s57 offen offset:3584 sc1
    v_mfma_f32_16x16x32_bf16 v[28:31], v[24:27], v[220:223], v[28:31]
ub_52:
    s_cmp_ge_u32 s9, 2
    s_cbranch_scc1 wc_53
    s_bitcmp1_b32 s9, 0
    s_cbranch_scc1 wc_53_b
    ds_read_b128 v[128:131], v3 offset:49152
    ds_read_b128 v[132:135], v3 offset:50176
    ds_read_b128 v[136:139], v3 offset:51200
    ds_read_b128 v[140:143], v3 offset:52224
    ds_read_b128 v[144:147], v3 offset:53248
    ds_read_b128 v[148:151], v3 offset:54272
    ds_read_b128 v[152:155], v3 offset:55296
    ds_read_b128 v[156:159], v3 offset:56320
    s_branch wc_53_w
wc_53_b:
    ds_read_b128 a[0:3], v3 offset:49152
    ds_read_b128 a[4:7], v3 offset:50176
    ds_read_b128 a[8:11], v3 offset:51200
    ds_read_b128 a[12:15], v3 offset:52224
    ds_read_b128 a[16:19], v3 offset:53248
    ds_read_b128 a[20:23], v3 offset:54272
    ds_read_b128 a[24:27], v3 offset:55296
    ds_read_b128 a[28:31], v3 offset:56320
wc_53_w:
    s_waitcnt lgkmcnt(0)
wc_53:
    s_cmp_lg_u32 s51, 1
    s_cbranch_scc1 role_54
    s_and_b32 s52, s11, 0xe0
    s_lshl_b32 s52, s52, 7
    s_add_u32 s52, s52, s56
    s_lshr_b32 s3, s6, 1
    s_min_u32 s3, s3, 1
    s_andn2_b32 s3, s3, s9
    s_lshl_b32 s3, s3, 8
    s_sub_u32 s53, s52, s3
    buffer_load_dwordx4 v[32:35], v5, s[12:15], s52 offen offset:0 sc1
    buffer_load_dwordx4 v[36:39], v5, s[12:15], s52 offen offset:1024 sc1
    buffer_load_dwordx4 v[40:43], v5, s[12:15], s52 offen offset:2048 sc1
    buffer_load_dwordx4 v[44:47], v5, s[12:15], s52 offen offset:3072 sc1
    buffer_load_dwordx4 v[48:51], v6, s[12:15], s53 offen sc1
role_54:
    s_lshr_b32 s3, s9, 1
    s_andn2_b32 s3, s50, s3
    s_bitcmp0_b32 s3, 0
    s_cbranch_scc1 str_55
    s_waitcnt vmcnt(1)
    s_mov_b32 m0, s48
    s_add_u32 s50, s50, 1
    buffer_load_dwordx4 v5, s[12:15], s49 offen offset:0 sc1 lds
    buffer_load_dwordx4 v5, s[12:15], s49 offen offset:1024 sc1 lds
    buffer_load_dwordx4 v5, s[12:15], s49 offen offset:2048 sc1 lds
    buffer_load_dwordx4 v5, s[12:15], s49 offen offset:3072 sc1 lds
    s_add_u32 s49, s49, 4096
    s_bitcmp1_b32 s50, 0
    s_cselect_b32 s3, 0, 16384
    s_add_u32 s48, s48, s3
    s_add_u32 s49, s49, s3
    s_cmp_eq_u32 s50, 12
    s_cselect_b32 s3, 4294819840, 0
    s_add_u32 s48, s48, 4096
    s_add_u32 s48, s48, s3
str_55:
    s_waitcnt vmcnt(8)
    s_barrier
    s_waitcnt vmcnt(0)
    s_cmp_gt_u32 s50, 15
    s_cbranch_scc1 stg_56
    s_mov_b32 m0, s48
    s_add_u32 s50, s50, 1
    buffer_load_dwordx4 v5, s[12:15], s49 offen offset:0 sc1 lds
    buffer_load_dwordx4 v5, s[12:15], s49 offen offset:1024 sc1 lds
    buffer_load_dwordx4 v5, s[12:15], s49 offen offset:2048 sc1 lds
    buffer_load_dwordx4 v5, s[12:15], s49 offen offset:3072 sc1 lds
    s_add_u32 s49, s49, 4096
    s_bitcmp1_b32 s50, 0
    s_cselect_b32 s3, 0, 16384
    s_add_u32 s48, s48, s3
    s_add_u32 s49, s49, s3
    s_cmp_eq_u32 s50, 12
    s_cselect_b32 s3, 4294819840, 0
    s_add_u32 s48, s48, 4096
    s_add_u32 s48, s48, s3
    s_cmp_ge_u32 s9, 2
    s_cbranch_scc1 stg_56
stg_56:
    s_cmp_eq_u32 s60, 0
    s_cbranch_scc1 ub_57
    v_add_f32_dpp v28, v28, v28 row_ror:8 row_mask:0xf bank_mask:0xf
    v_add_f32_dpp v29, v29, v29 row_ror:8 row_mask:0xf bank_mask:0xf
    v_add_f32_dpp v30, v30, v30 row_ror:8 row_mask:0xf bank_mask:0xf
    v_add_f32_dpp v31, v31, v31 row_ror:8 row_mask:0xf bank_mask:0xf
    s_mov_b64 exec, 0x00ff00ff
    buffer_store_dwordx4 v[28:31], v15, s[12:15], s54 offen sc1
    s_mov_b64 exec, -1
ub_57:
    s_cmp_lg_u32 s51, 1
    s_cbranch_scc1 role_58
    s_mov_b32 s3, 0x100000
l_st_chk:
    v_cmp_ne_u32 s[64:65], s10, v33
    v_cmp_ne_u32 vcc, s10, v35
    s_or_b64 s[64:65], s[64:65], vcc
    v_cmp_ne_u32 vcc, s10, v37
    s_or_b64 s[64:65], s[64:65], vcc
    v_cmp_ne_u32 vcc, s10, v39
    s_or_b64 s[64:65], s[64:65], vcc
    v_cmp_ne_u32 vcc, s10, v41
    s_or_b64 s[64:65], s[64:65], vcc
    v_cmp_ne_u32 vcc, s10, v43
    s_or_b64 s[64:65], s[64:65], vcc
    v_cmp_ne_u32 vcc, s10, v45
    s_or_b64 s[64:65], s[64:65], vcc
    v_cmp_ne_u32 vcc, s10, v47
    s_or_b64 s[64:65], s[64:65], vcc
    v_cmp_ne_u32 vcc, s10, v49
    s_or_b64 s[64:65], s[64:65], vcc
    v_cmp_ne_u32 vcc, s10, v51
    s_or_b64 s[64:65], s[64:65], vcc
    s_cbranch_scc0 l_st_ok
    s_sub_u32 s3, s3, 1
    s_cbranch_scc0 l_st_again
l_st_ok:
    ds_write_b32 v11, v32 offset:1280
    ds_write_b32 v11, v34 offset:2816
    ds_write_b32 v11, v36 offset:1536
    ds_write_b32 v11, v38 offset:3072
    ds_write_b32 v11, v40 offset:1792
    ds_write_b32 v11, v42 offset:3328
    ds_write_b32 v11, v44 offset:2048
    ds_write_b32 v11, v46 offset:3584
    s_mov_b64 exec, 0xffff
    ds_write_b32 v11, v48 offset:1216
    ds_write_b32 v11, v50 offset:2752
    s_mov_b64 exec, -1
    s_waitcnt lgkmcnt(0)
role_58:
    s_lshr_b32 s3, s9, 1
    s_andn2_b32 s3, s50, s3
    s_bitcmp0_b32 s3, 0
    s_cbranch_scc1 str_59
    s_waitcnt vmcnt(1)
    s_mov_b32 m0, s48
    s_add_u32 s50, s50, 1
    buffer_load_dwordx4 v5, s[12:15], s49 offen offset:0 sc1 lds
    buffer_load_dwordx4 v5, s[12:15], s49 offen offset:1024 sc1 lds
    buffer_load_dwordx4 v5, s[12:15], s49 offen offset:2048 sc1 lds
    buffer_load_dwordx4 v5, s[12:15], s49 offen offset:3072 sc1 lds
    s_add_u32 s49, s49, 4096
    s_bitcmp1_b32 s50, 0
    s_cselect_b32 s3, 0, 16384
    s_add_u32 s48, s48, s3
    s_add_u32 s49, s49, s3
    s_cmp_eq_u32 s50, 12
    s_cselect_b32 s3, 4294819840, 0
    s_add_u32 s48, s48, 4096
    s_add_u32 s48, s48, s3
str_59:
    s_add_u32 s61, s51, 48
    s_bitcmp1_b32 s9, 0
    s_cbranch_scc1 wo_60
    s_mov_b32 s24, s36
    s_mov_b32 s25, s37
    s_mov_b32 s26, 2097152
    s_mov_b32 s27, 0x00020000
    s_and_b32 s3, s7, 7
    s_cmp_eq_u32 s3, 3
    s_cbranch_scc0 wo_60
    s_cmp_eq_u32 s9, 0
    s_cbranch_scc1 wo_60
wop_61:
    s_lshl_b32 m0, s61, 10
    s_lshr_b32 s3, s61, 1
    s_xor_b32 s3, s3, s61
    s_and_b32 s3, s3, 1
    s_mul_i32 s3, s3, 3
    s_xor_b32 s3, s3, s61
    s_lshl_b32 s3, s3, 14
    buffer_load_dwordx4 v17, s[24:27], s3 offen lds
    s_add_u32 s61, s61, 3
    s_waitcnt vmcnt(4)
    s_cmp_lt_u32 s61, 66
    s_cbranch_scc1 wop_61
wo_60:
    s_waitcnt vmcnt(8)
    s_barrier
    s_cmp_eq_u32 s60, 0
    s_cbranch_scc1 ub_62
    s_waitcnt vmcnt(0)
    s_mov_b64 exec, 0xffff
    buffer_store_dword v9, v16, s[12:15], s55 offen offset:384 sc1
    s_mov_b64 exec, -1
ub_62:
    s_bitcmp1_b32 s9, 0
    s_cbranch_scc1 wo_63
    s_mov_b32 s24, s36
    s_mov_b32 s25, s37
    s_mov_b32 s26, 2097152
    s_mov_b32 s27, 0x00020000
    s_and_b32 s3, s7, 7
    s_cmp_eq_u32 s3, 3
    s_cbranch_scc0 wo_63
    s_cmp_eq_u32 s9, 0
    s_cbranch_scc1 wo_63
wop_64:
    s_lshl_b32 m0, s61, 10
    s_lshr_b32 s3, s61, 1
    s_xor_b32 s3, s3, s61
    s_and_b32 s3, s3, 1
    s_mul_i32 s3, s3, 3
    s_xor_b32 s3, s3, s61
    s_lshl_b32 s3, s3, 14
    buffer_load_dwordx4 v17, s[24:27], s3 offen lds
    s_add_u32 s61, s61, 3
    s_waitcnt vmcnt(4)
    s_cmp_lt_u32 s61, 84
    s_cbranch_scc1 wop_64
wo_63:
    s_waitcnt vmcnt(0)
    s_barrier
    s_bitcmp1_b32 s9, 0
    s_cbranch_scc1 wo_65
    s_mov_b32 s24, s36
    s_mov_b32 s25, s37
    s_mov_b32 s26, 2097152
    s_mov_b32 s27, 0x00020000
    s_and_b32 s3, s7, 7
    s_cmp_eq_u32 s3, 3
    s_cselect_b32 s62, 27, 48
    s_cselect_b32 s63, 12, 24
    s_add_u32 s62, s62, s61
    s_sub_u32 s62, s62, s51
    s_add_u32 s63, s63, s62
wop_66:
    s_lshl_b32 m0, s61, 10
    s_lshr_b32 s3, s61, 1
    s_xor_b32 s3, s3, s61
    s_and_b32 s3, s3, 1
    s_mul_i32 s3, s3, 3
    s_xor_b32 s3, s3, s61
    s_lshl_b32 s3, s3, 14
    buffer_load_dwordx4 v17, s[24:27], s3 offen lds
    s_add_u32 s61, s61, 3
    s_waitcnt vmcnt(7)
    s_cmp_lt_u32 s61, s62
    s_cbranch_scc1 wop_66
wo_65:
    s_barrier
    s_bitcmp1_b32 s9, 0
    s_cbranch_scc1 s_attn
    s_mov_b32 s24, s36
    s_mov_b32 s25, s37
    s_mov_b32 s26, 2097152
    s_mov_b32 s27, 0x00020000
wop_67:
    s_lshl_b32 m0, s61, 10
    s_lshr_b32 s3, s61, 1
    s_xor_b32 s3, s3, s61
    s_and_b32 s3, s3, 1
    s_mul_i32 s3, s3, 3
    s_xor_b32 s3, s3, s61
    s_lshl_b32 s3, s3, 14
    buffer_load_dwordx4 v17, s[24:27], s3 offen lds
    s_add_u32 s61, s61, 3
    s_waitcnt vmcnt(7)
    s_cmp_lt_u32 s61, s63
    s_cbranch_scc1 wop_67
    s_barrier
wop_68:
    s_lshl_b32 m0, s61, 10
    s_lshr_b32 s3, s61, 1
    s_xor_b32 s3, s3, s61
    s_and_b32 s3, s3, 1
    s_mul_i32 s3, s3, 3
    s_xor_b32 s3, s3, s61
    s_lshl_b32 s3, s3, 14
    buffer_load_dwordx4 v17, s[24:27], s3 offen lds
    s_add_u32 s61, s61, 3
    s_waitcnt vmcnt(7)
    s_cmp_lt_u32 s61, 128
    s_cbranch_scc1 wop_68
    s_mov_b32 s61, s51
wop_69:
    s_lshl_b32 m0, s61, 10
    s_lshr_b32 s3, s61, 1
    s_xor_b32 s3, s3, s61
    s_and_b32 s3, s3, 1
    s_mul_i32 s3, s3, 3
    s_xor_b32 s3, s3, s61
    s_lshl_b32 s3, s3, 14
    buffer_load_dwordx4 v17, s[24:27], s3 offen lds
    s_add_u32 s61, s61, 3
    s_waitcnt vmcnt(7)
    s_cmp_lt_u32 s61, 48
    s_cbranch_scc1 wop_69
    s_branch l_wo
l_st_again:
    buffer_load_dwordx4 v[32:35], v5, s[12:15], s52 offen offset:0 sc1
    buffer_load_dwordx4 v[36:39], v5, s[12:15], s52 offen offset:1024 sc1
    buffer_load_dwordx4 v[40:43], v5, s[12:15], s52 offen offset:2048 sc1
    buffer_load_dwordx4 v[44:47], v5, s[12:15], s52 offen offset:3072 sc1
    buffer_load_dwordx4 v[48:51], v6, s[12:15], s53 offen sc1
    s_waitcnt vmcnt(0)
    s_branch l_st_chk
.p2align 6
h_wo:
l_wo:
    s_mul_i32 s98, s9, 786432
    s_add_u32 s98, s98, 65798144
    s_lshl_b32 s99, s11, 10
    s_add_u32 s98, s98, s99
    s_add_u32 s96, s4, s98
    s_addc_u32 s97, s5, 0
    s_mov_b32 s98, s10
    s_mov_b32 s99, s10
    s_sub_u32 s59, s8, 4
    s_lshl_b32 s60, s59, 7
    s_add_u32 s96, s96, s60
    s_addc_u32 s97, s97, 0
    s_lshl_b32 s60, s9, 2
    s_add_u32 s60, s60, 159504
    v_mov_b32 v10, s60
    s_lshl_b32 s60, 1, s59
    v_mov_b32 v11, s60
    v_lshlrev_b32 v13, 4, v11
    s_mov_b64 exec, 1
    s_waitcnt vmcnt(0)
    ds_or_b32 v10, v13
    s_mov_b32 s3, 0x100000
poll_70:
    s_load_dwordx8 s[88:95], s[96:97], 0 glc
    s_sub_u32 s3, s3, 1
    s_cbranch_scc1 poll_70_ok
    s_waitcnt lgkmcnt(0)
    s_xor_b64 s[100:101], s[88:89], s[98:99]
    s_xor_b64 s[88:89], s[90:91], s[98:99]
    s_or_b64 s[100:101], s[100:101], s[88:89]
    s_xor_b64 s[88:89], s[92:93], s[98:99]
    s_or_b64 s[100:101], s[100:101], s[88:89]
    s_xor_b64 s[88:89], s[94:95], s[98:99]
    s_or_b64 s[100:101], s[100:101], s[88:89]
    s_cbranch_scc1 poll_70
poll_70_ok:
    s_waitcnt lgkmcnt(0)
    ds_or_b32 v10, v11
    s_mov_b64 exec, -1
    s_setprio 0
    s_waitcnt lgkmcnt(0)
    s_cmp_eq_u32 s8, 4
    s_cbranch_scc1 l_wo_end
    s_cmp_lg_u32 s9, 0
    s_cbranch_scc1 l_wo_end
    s_lshl_b32 s53, s8, 7
    s_lshl_b32 s52, s11, 10
    s_add_u32 s53, s53, s52
    s_add_u32 s53, s53, 64487168
    s_add_u32 s96, s4, s53
    s_addc_u32 s97, s5, 0
    s_mov_b32 s98, s10
    s_mov_b32 s99, s10
    s_mov_b32 s3, 0x100000
poll_71:
    s_load_dwordx16 s[80:95], s[96:97], 0 glc
    s_sub_u32 s3, s3, 1
    s_cbranch_scc1 poll_71_ok
    s_waitcnt lgkmcnt(0)
    s_xor_b64 s[100:101], s[80:81], s[98:99]
    s_xor_b64 s[80:81], s[82:83], s[98:99]
    s_or_b64 s[100:101], s[100:101], s[80:81]
    s_xor_b64 s[80:81], s[84:85], s[98:99]
    s_or_b64 s[100:101], s[100:101], s[80:81]
    s_xor_b64 s[80:81], s[86:87], s[98:99]
    s_or_b64 s[100:101], s[100:101], s[80:81]
    s_xor_b64 s[80:81], s[88:89], s[98:99]
    s_or_b64 s[100:101], s[100:101], s[80:81]
    s_xor_b64 s[80:81], s[90:91], s[98:99]
    s_or_b64 s[100:101], s[100:101], s[80:81]
    s_xor_b64 s[80:81], s[92:93], s[98:99]
    s_or_b64 s[100:101], s[100:101], s[80:81]
    s_xor_b64 s[80:81], s[94:95], s[98:99]
    s_or_b64 s[100:101], s[100:101], s[80:81]
    s_cbranch_scc1 poll_71
poll_71_ok:
    s_waitcnt lgkmcnt(0)
l_wo_end:
    s_add_u32 s9, s9, 1
    s_cmp_lg_u32 s9, 4
    s_cbranch_scc1 l_wo_next
    s_branch k_exit
l_wo_next:
    s_cmp_lg_u32 s8, 4
    s_cbranch_scc1 l_qkv
    s_cmp_eq_u32 s9, 2
    s_cbranch_scc1 h_qkvA
    s_branch h_qkvB
.p2align 6
s_attn:
    s_sub_u32 s48, s8, 4
    s_lshl_b32 s3, s7, 7
    v_lshrrev_b32 v20, 3, v1
    v_lshlrev_b32 v21, 11, v20
    v_and_b32 v22, 2, v20
    v_lshrrev_b32 v23, 2, v20
    v_or_b32 v22, v22, v23
    v_bfe_u32 v23, v1, 1, 2
    v_xor_b32 v22, v22, v23
    v_lshl_add_u32 v21, v22, 5, v21
    v_and_b32 v22, 1, v1
    v_lshl_add_u32 v21, v22, 4, v21
    v_add_u32 v7, s3, v21
    s_mov_b32 s24, s42
    s_mov_b32 s25, s43
    s_mov_b32 s26, 2097152
    s_mov_b32 s27, 0x00020000
    s_lshr_b32 s49, s9, 1
    s_lshl_b32 s49, s49, 23
    s_lshl_b32 s52, s7, 19
    s_add_u32 s49, s49, s52
    s_and_b32 s52, s6, 1
    s_lshl_b32 s52, s52, 18
    s_add_u32 s49, s49, s52
    s_add_u32 s49, s49, 33554432
    s_lshr_b32 s61, s6, 1
    s_mul_i32 s54, s9, 786432
    s_add_u32 s54, s54, 66322432
    s_lshl_b32 s55, s11, 10
    s_add_u32 s54, s54, s55
    s_add_u32 s52, s4, s54
    s_addc_u32 s53, s5, 0
    s_mov_b32 s54, s10
    s_mov_b32 s55, s10
    s_lshl_b32 s51, s48, 11
    s_add_u32 s49, s49, s51
    s_add_u32 s51, s51, 81920
    s_mov_b32 s60, s48
    s_setprio 3
    s_barrier
    s_lshl_b32 s58, 1, s61
    s_mov_b32 s57, 0
    s_add_u32 s62, s61, 1
    s_and_b32 s62, s62, 7
    s_lshl_b32 s50, s62, 15
    s_add_u32 s50, s50, s49
    s_lshr_b32 s63, s62, 1
    s_lshl_b32 s63, s63, 7
    s_and_b32 s62, s62, 1
    s_lshl_b32 s62, s62, 4
    s_add_u32 s62, s62, s63
    s_mov_b32 s58, 0x100000
need_72:
    s_load_dwordx4 s[64:67], s[52:53], s62 glc
    s_sub_u32 s58, s58, 1
    s_cbranch_scc1 need_72_ok
    s_waitcnt lgkmcnt(0)
need_72_t:
    s_cmp_ge_u32 s48, 2
    s_cselect_b32 s63, s65, s64
    s_cmp_lg_u32 s63, s10
    s_cbranch_scc1 need_72
need_72_ok:
    s_waitcnt lgkmcnt(0)
    s_add_u32 m0, s51, 32768
    s_nop 0
    buffer_load_dwordx4 v5, s[12:15], s50 offen offset:0 sc1 lds
    buffer_load_dwordx4 v5, s[12:15], s50 offen offset:1024 sc1 lds
    s_add_u32 s50, s50, 8192
    s_add_u32 m0, s51, 40960
    s_nop 0
    buffer_load_dwordx4 v5, s[12:15], s50 offen offset:0 sc1 lds
    buffer_load_dwordx4 v5, s[12:15], s50 offen offset:1024 sc1 lds
    s_add_u32 s50, s50, 8192
    s_waitcnt vmcnt(0)
    s_barrier
    s_branch need_73_t
need_73:
    s_load_dwordx4 s[64:67], s[52:53], s62 glc
    s_sub_u32 s58, s58, 1
    s_cbranch_scc1 need_73_ok
    s_waitcnt lgkmcnt(0)
need_73_t:
    s_cmp_ge_u32 s48, 2
    s_cselect_b32 s63, s67, s66
    s_cmp_lg_u32 s63, s10
    s_cbranch_scc1 need_73
need_73_ok:
    s_waitcnt lgkmcnt(0)
    s_add_u32 m0, s51, 49152
    s_nop 0
    buffer_load_dwordx4 v5, s[12:15], s50 offen offset:0 sc1 lds
    buffer_load_dwordx4 v5, s[12:15], s50 offen offset:1024 sc1 lds
    s_add_u32 s50, s50, 8192
    s_add_u32 m0, s51, 57344
    s_nop 0
    buffer_load_dwordx4 v5, s[12:15], s50 offen offset:0 sc1 lds
    buffer_load_dwordx4 v5, s[12:15], s50 offen offset:1024 sc1 lds
    s_add_u32 s50, s50, 8192
    s_add_u32 s62, s61, 2
    s_and_b32 s62, s62, 7
    s_lshl_b32 s50, s62, 15
    s_add_u32 s50, s50, s49
    s_lshr_b32 s63, s62, 1
    s_lshl_b32 s63, s63, 7
    s_and_b32 s62, s62, 1
    s_lshl_b32 s62, s62, 4
    s_add_u32 s62, s62, s63
    s_mov_b32 s58, 0x100000
need_74:
    s_load_dwordx4 s[64:67], s[52:53], s62 glc
    s_sub_u32 s58, s58, 1
    s_cbranch_scc1 need_74_ok
    s_waitcnt lgkmcnt(0)
need_74_t:
    s_cmp_ge_u32 s48, 2
    s_cselect_b32 s63, s65, s64
    s_cmp_lg_u32 s63, s10
    s_cbranch_scc1 need_74
need_74_ok:
    s_waitcnt lgkmcnt(0)
    s_add_u32 m0, s51, 0
    s_nop 0
    buffer_load_dwordx4 v5, s[12:15], s50 offen offset:0 sc1 lds
    buffer_load_dwordx4 v5, s[12:15], s50 offen offset:1024 sc1 lds
    s_add_u32 s50, s50, 8192
    s_add_u32 m0, s51, 8192
    s_nop 0
    buffer_load_dwordx4 v5, s[12:15], s50 offen offset:0 sc1 lds
    buffer_load_dwordx4 v5, s[12:15], s50 offen offset:1024 sc1 lds
    s_add_u32 s50, s50, 8192
    s_waitcnt vmcnt(4)
    s_barrier
    s_branch need_75_t
need_75:
    s_load_dwordx4 s[64:67], s[52:53], s62 glc
    s_sub_u32 s58, s58, 1
    s_cbranch_scc1 need_75_ok
    s_waitcnt lgkmcnt(0)
need_75_t:
    s_cmp_ge_u32 s48, 2
    s_cselect_b32 s63, s67, s66
    s_cmp_lg_u32 s63, s10
    s_cbranch_scc1 need_75
need_75_ok:
    s_waitcnt lgkmcnt(0)
    s_add_u32 m0, s51, 16384
    s_nop 0
    buffer_load_dwordx4 v5, s[12:15], s50 offen offset:0 sc1 lds
    buffer_load_dwordx4 v5, s[12:15], s50 offen offset:1024 sc1 lds
    s_add_u32 s50, s50, 8192
    s_add_u32 m0, s51, 24576
    s_nop 0
    buffer_load_dwordx4 v5, s[12:15], s50 offen offset:0 sc1 lds
    buffer_load_dwordx4 v5, s[12:15], s50 offen offset:1024 sc1 lds
    s_add_u32 s50, s50, 8192
    s_waitcnt vmcnt(4)
    s_barrier
    s_add_u32 s62, s61, 3
    s_and_b32 s62, s62, 7
    s_lshl_b32 s50, s62, 15
    s_add_u32 s50, s50, s49
    s_lshr_b32 s63, s62, 1
    s_lshl_b32 s63, s63, 7
    s_and_b32 s62, s62, 1
    s_lshl_b32 s62, s62, 4
    s_add_u32 s62, s62, s63
    s_mov_b32 s58, 0x100000
need_76:
    s_load_dwordx4 s[64:67], s[52:53], s62 glc
    s_sub_u32 s58, s58, 1
    s_cbranch_scc1 need_76_ok
    s_waitcnt lgkmcnt(0)
need_76_t:
    s_cmp_ge_u32 s48, 2
    s_cselect_b32 s63, s65, s64
    s_cmp_lg_u32 s63, s10
    s_cbranch_scc1 need_76
need_76_ok:
    s_waitcnt lgkmcnt(0)
    s_add_u32 m0, s51, 32768
    s_nop 0
    buffer_load_dwordx4 v5, s[12:15], s50 offen offset:0 sc1 lds
    buffer_load_dwordx4 v5, s[12:15], s50 offen offset:1024 sc1 lds
    s_add_u32 s50, s50, 8192
    s_add_u32 m0, s51, 40960
    s_nop 0
    buffer_load_dwordx4 v5, s[12:15], s50 offen offset:0 sc1 lds
    buffer_load_dwordx4 v5, s[12:15], s50 offen offset:1024 sc1 lds
    s_add_u32 s50, s50, 8192
    s_lshl_b32 m0, s60, 10
    s_lshl_b32 s3, s60, 14
    buffer_load_dwordx4 v7, s[24:27], s3 offen lds
    s_add_u32 s60, s60, 4
    s_lshl_b32 m0, s60, 10
    s_lshl_b32 s3, s60, 14
    buffer_load_dwordx4 v7, s[24:27], s3 offen lds
    s_add_u32 s60, s60, 4
    s_waitcnt vmcnt(6)
    s_barrier
    s_branch need_77_t
need_77:
    s_load_dwordx4 s[64:67], s[52:53], s62 glc
    s_sub_u32 s58, s58, 1
    s_cbranch_scc1 need_77_ok
    s_waitcnt lgkmcnt(0)
need_77_t:
    s_cmp_ge_u32 s48, 2
    s_cselect_b32 s63, s67, s66
    s_cmp_lg_u32 s63, s10
    s_cbranch_scc1 need_77
need_77_ok:
    s_waitcnt lgkmcnt(0)
    s_add_u32 m0, s51, 49152
    s_nop 0
    buffer_load_dwordx4 v5, s[12:15], s50 offen offset:0 sc1 lds
    buffer_load_dwordx4 v5, s[12:15], s50 offen offset:1024 sc1 lds
    s_add_u32 s50, s50, 8192
    s_add_u32 m0, s51, 57344
    s_nop 0
    buffer_load_dwordx4 v5, s[12:15], s50 offen offset:0 sc1 lds
    buffer_load_dwordx4 v5, s[12:15], s50 offen offset:1024 sc1 lds
    s_add_u32 s50, s50, 8192
    s_lshl_b32 m0, s60, 10
    s_lshl_b32 s3, s60, 14
    buffer_load_dwordx4 v7, s[24:27], s3 offen lds
    s_add_u32 s60, s60, 4
    s_lshl_b32 m0, s60, 10
    s_lshl_b32 s3, s60, 14
    buffer_load_dwordx4 v7, s[24:27], s3 offen lds
    s_add_u32 s60, s60, 4
    s_waitcnt vmcnt(8)
    s_barrier
    s_add_u32 s62, s61, 4
    s_and_b32 s62, s62, 7
    s_lshl_b32 s50, s62, 15
    s_add_u32 s50, s50, s49
    s_lshr_b32 s63, s62, 1
    s_lshl_b32 s63, s63, 7
    s_and_b32 s62, s62, 1
    s_lshl_b32 s62, s62, 4
    s_add_u32 s62, s62, s63
    s_mov_b32 s58, 0x100000
need_78:
    s_load_dwordx4 s[64:67], s[52:53], s62 glc
    s_sub_u32 s58, s58, 1
    s_cbranch_scc1 need_78_ok
    s_waitcnt lgkmcnt(0)
need_78_t:
    s_cmp_ge_u32 s48, 2
    s_cselect_b32 s63, s65, s64
    s_cmp_lg_u32 s63, s10
    s_cbranch_scc1 need_78
need_78_ok:
    s_waitcnt lgkmcnt(0)
    s_add_u32 m0, s51, 0
    s_nop 0
    buffer_load_dwordx4 v5, s[12:15], s50 offen offset:0 sc1 lds
    buffer_load_dwordx4 v5, s[12:15], s50 offen offset:1024 sc1 lds
    s_add_u32 s50, s50, 8192
    s_add_u32 m0, s51, 8192
    s_nop 0
    buffer_load_dwordx4 v5, s[12:15], s50 offen offset:0 sc1 lds
    buffer_load_dwordx4 v5, s[12:15], s50 offen offset:1024 sc1 lds
    s_add_u32 s50, s50, 8192
    s_lshl_b32 m0, s60, 10
    s_lshl_b32 s3, s60, 14
    buffer_load_dwordx4 v7, s[24:27], s3 offen lds
    s_add_u32 s60, s60, 4
    s_lshl_b32 m0, s60, 10
    s_lshl_b32 s3, s60, 14
    buffer_load_dwordx4 v7, s[24:27], s3 offen lds
    s_add_u32 s60, s60, 4
    s_waitcnt vmcnt(8)
    s_barrier
    s_branch need_79_t
need_79:
    s_load_dwordx4 s[64:67], s[52:53], s62 glc
    s_sub_u32 s58, s58, 1
    s_cbranch_scc1 need_79_ok
    s_waitcnt lgkmcnt(0)
need_79_t:
    s_cmp_ge_u32 s48, 2
    s_cselect_b32 s63, s67, s66
    s_cmp_lg_u32 s63, s10
    s_cbranch_scc1 need_79
need_79_ok:
    s_waitcnt lgkmcnt(0)
    s_add_u32 m0, s51, 16384
    s_nop 0
    buffer_load_dwordx4 v5, s[12:15], s50 offen offset:0 sc1 lds
    buffer_load_dwordx4 v5, s[12:15], s50 offen offset:1024 sc1 lds
    s_add_u32 s50, s50, 8192
    s_add_u32 m0, s51, 24576
    s_nop 0
    buffer_load_dwordx4 v5, s[12:15], s50 offen offset:0 sc1 lds
    buffer_load_dwordx4 v5, s[12:15], s50 offen offset:1024 sc1 lds
    s_add_u32 s50, s50, 8192
    s_lshl_b32 m0, s60, 10
    s_lshl_b32 s3, s60, 14
    buffer_load_dwordx4 v7, s[24:27], s3 offen lds
    s_add_u32 s60, s60, 4
    s_lshl_b32 m0, s60, 10
    s_lshl_b32 s3, s60, 14
    buffer_load_dwordx4 v7, s[24:27], s3 offen lds
    s_add_u32 s60, s60, 4
    s_waitcnt vmcnt(8)
    s_barrier
    s_add_u32 s62, s61, 5
    s_and_b32 s62, s62, 7
    s_lshl_b32 s50, s62, 15
    s_add_u32 s50, s50, s49
    s_lshr_b32 s63, s62, 1
    s_lshl_b32 s63, s63, 7
    s_and_b32 s62, s62, 1
    s_lshl_b32 s62, s62, 4
    s_add_u32 s62, s62, s63
    s_mov_b32 s58, 0x100000
need_80:
    s_load_dwordx4 s[64:67], s[52:53], s62 glc
    s_sub_u32 s58, s58, 1
    s_cbranch_scc1 need_80_ok
    s_waitcnt lgkmcnt(0)
need_80_t:
    s_cmp_ge_u32 s48, 2
    s_cselect_b32 s63, s65, s64
    s_cmp_lg_u32 s63, s10
    s_cbranch_scc1 need_80
need_80_ok:
    s_waitcnt lgkmcnt(0)
    s_add_u32 m0, s51, 32768
    s_nop 0
    buffer_load_dwordx4 v5, s[12:15], s50 offen offset:0 sc1 lds
    buffer_load_dwordx4 v5, s[12:15], s50 offen offset:1024 sc1 lds
    s_add_u32 s50, s50, 8192
    s_add_u32 m0, s51, 40960
    s_nop 0
    buffer_load_dwordx4 v5, s[12:15], s50 offen offset:0 sc1 lds
    buffer_load_dwordx4 v5, s[12:15], s50 offen offset:1024 sc1 lds
    s_add_u32 s50, s50, 8192
    s_lshl_b32 m0, s60, 10
    s_lshl_b32 s3, s60, 14
    buffer_load_dwordx4 v7, s[24:27], s3 offen lds
    s_add_u32 s60, s60, 4
    s_lshl_b32 m0, s60, 10
    s_lshl_b32 s3, s60, 14
    buffer_load_dwordx4 v7, s[24:27], s3 offen lds
    s_add_u32 s60, s60, 4
    s_waitcnt vmcnt(8)
    s_barrier
    s_branch need_81_t
need_81:
    s_load_dwordx4 s[64:67], s[52:53], s62 glc
    s_sub_u32 s58, s58, 1
    s_cbranch_scc1 need_81_ok
    s_waitcnt lgkmcnt(0)
need_81_t:
    s_cmp_ge_u32 s48, 2
    s_cselect_b32 s63, s67, s66
    s_cmp_lg_u32 s63, s10
    s_cbranch_scc1 need_81
need_81_ok:
    s_waitcnt lgkmcnt(0)
    s_add_u32 m0, s51, 49152
    s_nop 0
    buffer_load_dwordx4 v5, s[12:15], s50 offen offset:0 sc1 lds
    buffer_load_dwordx4 v5, s[12:15], s50 offen offset:1024 sc1 lds
    s_add_u32 s50, s50, 8192
    s_add_u32 m0, s51, 57344
    s_nop 0
    buffer_load_dwordx4 v5, s[12:15], s50 offen offset:0 sc1 lds
    buffer_load_dwordx4 v5, s[12:15], s50 offen offset:1024 sc1 lds
    s_add_u32 s50, s50, 8192
    s_lshl_b32 m0, s60, 10
    s_lshl_b32 s3, s60, 14
    buffer_load_dwordx4 v7, s[24:27], s3 offen lds
    s_add_u32 s60, s60, 4
    s_lshl_b32 m0, s60, 10
    s_lshl_b32 s3, s60, 14
    buffer_load_dwordx4 v7, s[24:27], s3 offen lds
    s_add_u32 s60, s60, 4
    s_waitcnt vmcnt(8)
    s_barrier
    s_add_u32 s62, s61, 6
    s_and_b32 s62, s62, 7
    s_lshl_b32 s50, s62, 15
    s_add_u32 s50, s50, s49
    s_lshr_b32 s63, s62, 1
    s_lshl_b32 s63, s63, 7
    s_and_b32 s62, s62, 1
    s_lshl_b32 s62, s62, 4
    s_add_u32 s62, s62, s63
    s_mov_b32 s58, 0x100000
need_82:
    s_load_dwordx4 s[64:67], s[52:53], s62 glc
    s_sub_u32 s58, s58, 1
    s_cbranch_scc1 need_82_ok
    s_waitcnt lgkmcnt(0)
need_82_t:
    s_cmp_ge_u32 s48, 2
    s_cselect_b32 s63, s65, s64
    s_cmp_lg_u32 s63, s10
    s_cbranch_scc1 need_82
need_82_ok:
    s_waitcnt lgkmcnt(0)
    s_add_u32 m0, s51, 0
    s_nop 0
    buffer_load_dwordx4 v5, s[12:15], s50 offen offset:0 sc1 lds
    buffer_load_dwordx4 v5, s[12:15], s50 offen offset:1024 sc1 lds
    s_add_u32 s50, s50, 8192
    s_add_u32 m0, s51, 8192
    s_nop 0
    buffer_load_dwordx4 v5, s[12:15], s50 offen offset:0 sc1 lds
    buffer_load_dwordx4 v5, s[12:15], s50 offen offset:1024 sc1 lds
    s_add_u32 s50, s50, 8192
    s_lshl_b32 m0, s60, 10
    s_lshl_b32 s3, s60, 14
    buffer_load_dwordx4 v7, s[24:27], s3 offen lds
    s_add_u32 s60, s60, 4
    s_lshl_b32 m0, s60, 10
    s_lshl_b32 s3, s60, 14
    buffer_load_dwordx4 v7, s[24:27], s3 offen lds
    s_add_u32 s60, s60, 4
    s_waitcnt vmcnt(8)
    s_barrier
    s_branch need_83_t
need_83:
    s_load_dwordx4 s[64:67], s[52:53], s62 glc
    s_sub_u32 s58, s58, 1
    s_cbranch_scc1 need_83_ok
    s_waitcnt lgkmcnt(0)
need_83_t:
    s_cmp_ge_u32 s48, 2
    s_cselect_b32 s63, s67, s66
    s_cmp_lg_u32 s63, s10
    s_cbranch_scc1 need_83
need_83_ok:
    s_waitcnt lgkmcnt(0)
    s_add_u32 m0, s51, 16384
    s_nop 0
    buffer_load_dwordx4 v5, s[12:15], s50 offen offset:0 sc1 lds
    buffer_load_dwordx4 v5, s[12:15], s50 offen offset:1024 sc1 lds
    s_add_u32 s50, s50, 8192
    s_add_u32 m0, s51, 24576
    s_nop 0
    buffer_load_dwordx4 v5, s[12:15], s50 offen offset:0 sc1 lds
    buffer_load_dwordx4 v5, s[12:15], s50 offen offset:1024 sc1 lds
    s_add_u32 s50, s50, 8192
    s_lshl_b32 m0, s60, 10
    s_lshl_b32 s3, s60, 14
    buffer_load_dwordx4 v7, s[24:27], s3 offen lds
    s_add_u32 s60, s60, 4
    s_lshl_b32 m0, s60, 10
    s_lshl_b32 s3, s60, 14
    buffer_load_dwordx4 v7, s[24:27], s3 offen lds
    s_add_u32 s60, s60, 4
    s_waitcnt vmcnt(8)
    s_barrier
    s_add_u32 s62, s61, 7
    s_and_b32 s62, s62, 7
    s_lshl_b32 s50, s62, 15
    s_add_u32 s50, s50, s49
    s_lshr_b32 s63, s62, 1
    s_lshl_b32 s63, s63, 7
    s_and_b32 s62, s62, 1
    s_lshl_b32 s62, s62, 4
    s_add_u32 s62, s62, s63
    s_mov_b32 s58, 0x100000
need_84:
    s_load_dwordx4 s[64:67], s[52:53], s62 glc
    s_sub_u32 s58, s58, 1
    s_cbranch_scc1 need_84_ok
    s_waitcnt lgkmcnt(0)
need_84_t:
    s_cmp_ge_u32 s48, 2
    s_cselect_b32 s63, s65, s64
    s_cmp_lg_u32 s63, s10
    s_cbranch_scc1 need_84
need_84_ok:
    s_waitcnt lgkmcnt(0)
    s_add_u32 m0, s51, 32768
    s_nop 0
    buffer_load_dwordx4 v5, s[12:15], s50 offen offset:0 sc1 lds
    buffer_load_dwordx4 v5, s[12:15], s50 offen offset:1024 sc1 lds
    s_add_u32 s50, s50, 8192
    s_add_u32 m0, s51, 40960
    s_nop 0
    buffer_load_dwordx4 v5, s[12:15], s50 offen offset:0 sc1 lds
    buffer_load_dwordx4 v5, s[12:15], s50 offen offset:1024 sc1 lds
    s_add_u32 s50, s50, 8192
    s_lshl_b32 m0, s60, 10
    s_lshl_b32 s3, s60, 14
    buffer_load_dwordx4 v7, s[24:27], s3 offen lds
    s_add_u32 s60, s60, 4
    s_lshl_b32 m0, s60, 10
    s_lshl_b32 s3, s60, 14
    buffer_load_dwordx4 v7, s[24:27], s3 offen lds
    s_add_u32 s60, s60, 4
    s_waitcnt vmcnt(8)
    s_barrier
    s_branch need_85_t
need_85:
    s_load_dwordx4 s[64:67], s[52:53], s62 glc
    s_sub_u32 s58, s58, 1
    s_cbranch_scc1 need_85_ok
    s_waitcnt lgkmcnt(0)
need_85_t:
    s_cmp_ge_u32 s48, 2
    s_cselect_b32 s63, s67, s66
    s_cmp_lg_u32 s63, s10
    s_cbranch_scc1 need_85
need_85_ok:
    s_waitcnt lgkmcnt(0)
    s_add_u32 m0, s51, 49152
    s_nop 0
    buffer_load_dwordx4 v5, s[12:15], s50 offen offset:0 sc1 lds
    buffer_load_dwordx4 v5, s[12:15], s50 offen offset:1024 sc1 lds
    s_add_u32 s50, s50, 8192
    s_add_u32 m0, s51, 57344
    s_nop 0
    buffer_load_dwordx4 v5, s[12:15], s50 offen offset:0 sc1 lds
    buffer_load_dwordx4 v5, s[12:15], s50 offen offset:1024 sc1 lds
    s_add_u32 s50, s50, 8192
    s_lshl_b32 m0, s60, 10
    s_lshl_b32 s3, s60, 14
    buffer_load_dwordx4 v7, s[24:27], s3 offen lds
    s_add_u32 s60, s60, 4
    s_lshl_b32 m0, s60, 10
    s_lshl_b32 s3, s60, 14
    buffer_load_dwordx4 v7, s[24:27], s3 offen lds
    s_add_u32 s60, s60, 4
    s_waitcnt vmcnt(8)
    s_barrier
    s_lshl_b32 m0, s60, 10
    s_lshl_b32 s3, s60, 14
    buffer_load_dwordx4 v7, s[24:27], s3 offen lds
    s_add_u32 s60, s60, 4
    s_lshl_b32 m0, s60, 10
    s_lshl_b32 s3, s60, 14
    buffer_load_dwordx4 v7, s[24:27], s3 offen lds
    s_add_u32 s60, s60, 4
    s_lshl_b32 m0, s60, 10
    s_lshl_b32 s3, s60, 14
    buffer_load_dwordx4 v7, s[24:27], s3 offen lds
    s_add_u32 s60, s60, 4
    s_lshl_b32 m0, s60, 10
    s_lshl_b32 s3, s60, 14
    buffer_load_dwordx4 v7, s[24:27], s3 offen lds
    s_add_u32 s60, s60, 4
    s_waitcnt vmcnt(6)
    s_barrier
    s_lshl_b32 m0, s60, 10
    s_lshl_b32 s3, s60, 14
    buffer_load_dwordx4 v7, s[24:27], s3 offen lds
    s_add_u32 s60, s60, 4
    s_lshl_b32 m0, s60, 10
    s_lshl_b32 s3, s60, 14
    buffer_load_dwordx4 v7, s[24:27], s3 offen lds
    s_add_u32 s60, s60, 4
    s_lshl_b32 m0, s60, 10
    s_lshl_b32 s3, s60, 14
    buffer_load_dwordx4 v7, s[24:27], s3 offen lds
    s_add_u32 s60, s60, 4
    s_lshl_b32 m0, s60, 10
    s_lshl_b32 s3, s60, 14
    buffer_load_dwordx4 v7, s[24:27], s3 offen lds
    s_add_u32 s60, s60, 4
    s_barrier
    s_lshl_b32 m0, s60, 10
    s_lshl_b32 s3, s60, 14
    buffer_load_dwordx4 v7, s[24:27], s3 offen lds
    s_add_u32 s60, s60, 4
    s_lshl_b32 m0, s60, 10
    s_lshl_b32 s3, s60, 14
    buffer_load_dwordx4 v7, s[24:27], s3 offen lds
    s_add_u32 s60, s60, 4
    s_lshl_b32 m0, s60, 10
    s_lshl_b32 s3, s60, 14
    buffer_load_dwordx4 v7, s[24:27], s3 offen lds
    s_add_u32 s60, s60, 4
    s_lshl_b32 m0, s60, 10
    s_lshl_b32 s3, s60, 14
    buffer_load_dwordx4 v7, s[24:27], s3 offen lds
    s_add_u32 s60, s60, 4
    s_cmp_eq_u32 s8, 4
    s_cbranch_scc1 h_wo
    s_branch l_wo
.p2align 6
c_attn_slow:
    s_waitcnt lgkmcnt(0)
    s_lshr_b32 s56, s9, 1
    s_lshl_b32 s56, s56, 23
    s_lshl_b32 s55, s7, 19
    s_add_u32 s56, s56, s55
    s_and_b32 s55, s6, 1
    s_lshl_b32 s55, s55, 18
    s_add_u32 s56, s56, s55
    s_add_u32 s56, s56, 33554432
    v_mov_b32 v28, 0xff800000
    v_mov_b32 v30, 0xff800000
    s_mov_b32 s57, 0
c_attn_slow1:
    s_lshr_b32 s55, s57, 2
    s_lshl_b32 s55, s55, 14
    s_and_b32 s58, s57, 3
    s_lshl_b32 s58, s58, 11
    s_add_u32 s55, s55, s58
    s_add_u32 s55, s55, s56
    buffer_load_dwordx4 v[128:131], v5, s[12:15], s55 offen offset:0 sc1
    buffer_load_dwordx4 v[132:135], v5, s[12:15], s55 offen offset:1024 sc1
    s_waitcnt vmcnt(0)
    v_mfma_f32_32x32x16_bf16 v[64:79], v[128:131], v[8:11], 0
    v_mfma_f32_32x32x16_bf16 v[80:95], v[128:131], v[16:19], 0
    v_mfma_f32_32x32x16_bf16 v[64:79], v[132:135], v[12:15], v[64:79]
    v_mfma_f32_32x32x16_bf16 v[80:95], v[132:135], v[20:23], v[80:95]
    s_nop 10
    v_max3_f32 v28, v28, v64, v65
    v_max3_f32 v28, v28, v66, v67
    v_max3_f32 v28, v28, v68, v69
    v_max3_f32 v28, v28, v70, v71
    v_max3_f32 v28, v28, v72, v73
    v_max3_f32 v28, v28, v74, v75
    v_max3_f32 v28, v28, v76, v77
    v_max3_f32 v28, v28, v78, v79
    v_max3_f32 v30, v30, v80, v81
    v_max3_f32 v30, v30, v82, v83
    v_max3_f32 v30, v30, v84, v85
    v_max3_f32 v30, v30, v86, v87
    v_max3_f32 v30, v30, v88, v89
    v_max3_f32 v30, v30, v90, v91
    v_max3_f32 v30, v30, v92, v93
    v_max3_f32 v30, v30, v94, v95
    s_add_u32 s57, s57, 1
    s_cmp_lt_u32 s57, 64
    s_cbranch_scc1 c_attn_slow1
    v_mov_b32 v29, v28
    s_nop 1
    v_permlane32_swap_b32 v28, v29
    v_max_f32 v28, v28, v29
    v_sub_f32 v96, 0, v28
    v_sub_f32 v97, 0, v28
    v_sub_f32 v98, 0, v28
    v_sub_f32 v99, 0, v28
    v_sub_f32 v100, 0, v28
    v_sub_f32 v101, 0, v28
    v_sub_f32 v102, 0, v28
    v_sub_f32 v103, 0, v28
    v_sub_f32 v104, 0, v28
    v_sub_f32 v105, 0, v28
    v_sub_f32 v106, 0, v28
    v_sub_f32 v107, 0, v28
    v_sub_f32 v108, 0, v28
    v_sub_f32 v109, 0, v28
    v_sub_f32 v110, 0, v28
    v_sub_f32 v111, 0, v28
    v_mov_b32 v160, 0
    v_mov_b32 v161, 0
    v_mov_b32 v162, 0
    v_mov_b32 v163, 0
    v_mov_b32 v164, 0
    v_mov_b32 v165, 0
    v_mov_b32 v166, 0
    v_mov_b32 v167, 0
    v_mov_b32 v168, 0
    v_mov_b32 v169, 0
    v_mov_b32 v170, 0
    v_mov_b32 v171, 0
    v_mov_b32 v172, 0
    v_mov_b32 v173, 0
    v_mov_b32 v174, 0
    v_mov_b32 v175, 0
    v_mov_b32 v192, 0
    v_mov_b32 v193, 0
    v_mov_b32 v194, 0
    v_mov_b32 v195, 0
    v_mov_b32 v31, v30
    s_nop 1
    v_permlane32_swap_b32 v30, v31
    v_max_f32 v30, v30, v31
    v_sub_f32 v112, 0, v30
    v_sub_f32 v113, 0, v30
    v_sub_f32 v114, 0, v30
    v_sub_f32 v115, 0, v30
    v_sub_f32 v116, 0, v30
    v_sub_f32 v117, 0, v30
    v_sub_f32 v118, 0, v30
    v_sub_f32 v119, 0, v30
    v_sub_f32 v120, 0, v30
    v_sub_f32 v121, 0, v30
    v_sub_f32 v122, 0, v30
    v_sub_f32 v123, 0, v30
    v_sub_f32 v124, 0, v30
    v_sub_f32 v125, 0, v30
    v_sub_f32 v126, 0, v30
    v_sub_f32 v127, 0, v30
    v_mov_b32 v176, 0
    v_mov_b32 v177, 0
    v_mov_b32 v178, 0
    v_mov_b32 v179, 0
    v_mov_b32 v180, 0
    v_mov_b32 v181, 0
    v_mov_b32 v182, 0
    v_mov_b32 v183, 0
    v_mov_b32 v184, 0
    v_mov_b32 v185, 0
    v_mov_b32 v186, 0
    v_mov_b32 v187, 0
    v_mov_b32 v188, 0
    v_mov_b32 v189, 0
    v_mov_b32 v190, 0
    v_mov_b32 v191, 0
    v_mov_b32 v196, 0
    v_mov_b32 v197, 0
    v_mov_b32 v198, 0
    v_mov_b32 v199, 0
    s_mov_b32 s57, 0
c_attn_slow2:
    s_lshr_b32 s55, s57, 2
    s_lshl_b32 s55, s55, 14
    s_and_b32 s58, s57, 3
    s_lshl_b32 s58, s58, 11
    s_add_u32 s55, s55, s58
    s_add_u32 s55, s55, s56
    buffer_load_dwordx4 v[128:131], v5, s[12:15], s55 offen offset:0 sc1
    buffer_load_dwordx4 v[132:135], v5, s[12:15], s55 offen offset:1024 sc1
    s_add_u32 s55, s55, 8192
    buffer_load_dwordx4 v[144:147], v5, s[12:15], s55 offen offset:0 sc1
    buffer_load_dwordx4 v[148:151], v5, s[12:15], s55 offen offset:1024 sc1
    s_waitcnt vmcnt(0)
    v_mfma_f32_32x32x16_bf16 v[64:79], v[128:131], v[8:11], v[96:111]
    v_mfma_f32_32x32x16_bf16 v[80:95], v[128:131], v[16:19], v[112:127]
    v_mfma_f32_32x32x16_bf16 v[64:79], v[132:135], v[12:15], v[64:79]
    v_mfma_f32_32x32x16_bf16 v[80:95], v[132:135], v[20:23], v[80:95]
    s_nop 10
    v_exp_f32 v64, v64
    v_exp_f32 v65, v65
    v_exp_f32 v66, v66
    v_exp_f32 v67, v67
    v_exp_f32 v68, v68
    v_exp_f32 v69, v69
    v_exp_f32 v70, v70
    v_exp_f32 v71, v71
    v_exp_f32 v72, v72
    v_exp_f32 v73, v73
    v_exp_f32 v74, v74
    v_exp_f32 v75, v75
    v_exp_f32 v76, v76
    v_exp_f32 v77, v77
    v_exp_f32 v78, v78
    v_exp_f32 v79, v79
    v_exp_f32 v80, v80
    v_exp_f32 v81, v81
    v_exp_f32 v82, v82
    v_exp_f32 v83, v83
    v_exp_f32 v84, v84
    v_exp_f32 v85, v85
    v_exp_f32 v86, v86
    v_exp_f32 v87, v87
    v_exp_f32 v88, v88
    v_exp_f32 v89, v89
    v_exp_f32 v90, v90
    v_exp_f32 v91, v91
    v_exp_f32 v92, v92
    v_exp_f32 v93, v93
    v_exp_f32 v94, v94
    v_exp_f32 v95, v95
    v_smfmac_f32_32x32x32_bf16 v[160:175], v[144:147], v[64:71], v204
    v_smfmac_f32_16x16x64_bf16 v[192:195], v[200:203], v[64:71], v204
    v_smfmac_f32_32x32x32_bf16 v[160:175], v[148:151], v[72:79], v204
    v_smfmac_f32_16x16x64_bf16 v[192:195], v[200:203], v[72:79], v204
    v_smfmac_f32_32x32x32_bf16 v[176:191], v[144:147], v[80:87], v204
    v_smfmac_f32_16x16x64_bf16 v[196:199], v[200:203], v[80:87], v204
    v_smfmac_f32_32x32x32_bf16 v[176:191], v[148:151], v[88:95], v204
    v_smfmac_f32_16x16x64_bf16 v[196:199], v[200:203], v[88:95], v204
    s_add_u32 s57, s57, 1
    s_cmp_lt_u32 s57, 64
    s_nop 15
    s_cbranch_scc1 c_attn_slow2
    s_branch c_attn_fin
    s_endpgm
k_end:
.section .rodata,"a"
.p2align 6
.amdhsa_kernel interleave_layers__sliding_local_dilated__softmax_full_mha__prompt_kernel
  .amdhsa_next_free_vgpr 256
  .amdhsa_next_free_sgpr 102
  .amdhsa_accum_offset 224
  .amdhsa_group_segment_fixed_size 0
  .amdhsa_kernarg_size 72
  .amdhsa_user_sgpr_count 2
  .amdhsa_user_sgpr_kernarg_segment_ptr 1
  .amdhsa_system_sgpr_workgroup_id_x 1
.end_amdhsa_kernel
```

```asm
; @launch grid=(256,1,1) block=(512,1,1) lds=159744
.amdgcn_target "amdgcn-amd-amdhsa--gfx950"
.text
.globl interleave_layers__sliding_local_dilated__softmax_full_mha__prompt_kernel
.type interleave_layers__sliding_local_dilated__softmax_full_mha__prompt_kernel,@function
.p2align 8
interleave_layers__sliding_local_dilated__softmax_full_mha__prompt_kernel:
    s_cmp_ge_u32 s2, 256
    s_cbranch_scc1 k_exit2
    s_load_dwordx16 s[32:47], s[0:1], 0
    s_load_dwordx2 s[4:5], s[0:1], 64
    v_lshrrev_b32 v2, 6, v0
    v_and_b32 v1, 63, v0
    v_mov_b32 v12, 0
    v_mov_b32 v14, 0
    v_mov_b32 v15, 0
    v_mov_b32 v16, 0
    v_readfirstlane_b32 s8, v2
    s_and_b32 s3, s2, 2
    s_lshl_b32 s3, s3, 2
    s_bfe_u32 s6, s2, 0x30003
    s_add_u32 s6, s3, s6
    s_and_b32 s3, s2, 1
    s_lshl_b32 s3, s3, 3
    s_lshr_b32 s7, s2, 6
    s_add_u32 s7, s3, s7
    s_and_b32 s3, s2, 4
    s_add_u32 s7, s3, s7
    s_lshl_b32 s11, s6, 4
    s_add_u32 s11, s11, s7
    s_mov_b32 s9, -1
    s_mov_b32 s96, 0
    s_mov_b32 s10, 0
    s_cmp_lt_u32 s8, 4
    s_cbranch_scc1 c_prep
    s_cmp_eq_u32 s8, 4
    s_cbranch_scc1 h_first
k_heads:
l_first:
    s_sub_u32 s51, s8, 5
    s_mul_i32 s61, s51, 0
    s_add_u32 s61, s61, s2
    s_and_b32 s61, s61, 255
    s_lshl_b32 s3, s51, 8
    s_add_u32 s61, s61, s3
    s_and_b32 s62, s61, 15
    s_lshr_b32 s63, s61, 4
    v_lshrrev_b32 v20, 3, v1
    v_mul_u32_u24 v12, 6144, v20
    v_and_b32 v21, 7, v1
    v_lshl_add_u32 v12, v21, 4, v12
    s_mul_i32 s52, s62, 393216
    s_lshl_b32 s56, s63, 7
    s_add_u32 s52, s52, s56
    s_waitcnt lgkmcnt(0)
    s_mov_b32 s12, s4
    s_mov_b32 s13, s5
    s_mov_b32 s14, 71303168
    s_mov_b32 s15, 0x00020000
    s_mov_b32 s20, s34
    s_mov_b32 s21, s35
    s_mov_b32 s22, 6291456
    s_mov_b32 s23, 0x00020000
    s_add_u32 s53, s52, 0
    buffer_load_dwordx4 v[160:163], v12, s[20:23], s53 offen nt
    s_add_u32 s53, s52, 49152
    buffer_load_dwordx4 v[164:167], v12, s[20:23], s53 offen nt
    s_add_u32 s53, s52, 98304
    buffer_load_dwordx4 v[168:171], v12, s[20:23], s53 offen nt
    s_add_u32 s53, s52, 147456
    buffer_load_dwordx4 v[172:175], v12, s[20:23], s53 offen nt
    s_add_u32 s53, s52, 196608
    buffer_load_dwordx4 v[176:179], v12, s[20:23], s53 offen nt
    s_add_u32 s53, s52, 245760
    buffer_load_dwordx4 v[180:183], v12, s[20:23], s53 offen nt
    s_add_u32 s53, s52, 294912
    buffer_load_dwordx4 v[184:187], v12, s[20:23], s53 offen nt
    s_add_u32 s53, s52, 344064
    buffer_load_dwordx4 v[188:191], v12, s[20:23], s53 offen nt
    s_barrier
    s_branch l_first_tail
c_prep:
    s_lshl_b32 s48, s6, 2
    s_add_u32 s48, s48, s8
    v_lshrrev_b32 v16, 3, v1
    v_and_b32 v17, 7, v1
    v_lshlrev_b32 v18, 11, v16
    v_lshl_add_u32 v18, v17, 4, v18
    s_lshl_b32 s55, s48, 16
    s_lshl_b32 s56, s7, 7
    s_add_u32 s3, s55, s56
    s_waitcnt lgkmcnt(0)
    s_mov_b32 s12, s4
    s_mov_b32 s13, s5
    s_mov_b32 s14, 71303168
    s_mov_b32 s15, 0x00020000
    s_mov_b32 s28, s32
    s_mov_b32 s29, s33
    s_mov_b32 s30, 4194304
    s_mov_b32 s31, 0x00020000
    buffer_load_dwordx4 v[32:35], v18, s[28:31], s3 offen nt
    s_add_u32 s3, s3, 16384
    buffer_load_dwordx4 v[36:39], v18, s[28:31], s3 offen nt
    s_add_u32 s3, s3, 16384
    buffer_load_dwordx4 v[40:43], v18, s[28:31], s3 offen nt
    s_add_u32 s3, s3, 16384
    buffer_load_dwordx4 v[44:47], v18, s[28:31], s3 offen nt
    s_add_u32 s3, s3, 16384
    s_barrier
    s_branch c_prep_tail
h_first:
    s_memrealtime s[50:51]
    s_getpc_b64 s[52:53]
pc_10:
    s_sub_u32 s52, s52, pc_10-interleave_layers__sliding_local_dilated__softmax_full_mha__prompt_kernel
    s_subb_u32 s53, s53, 0
    s_lshr_b32 s3, s2, 3
    s_lshl_b32 s3, s3, 11
    v_and_b32 v18, 15, v0
    v_lshl_add_u32 v18, v18, 7, s3
    v_min_u32 v18, k_end-interleave_layers__sliding_local_dilated__softmax_full_mha__prompt_kernel-4, v18
    v_mov_b32 v19, s53
    v_add_co_u32 v18, vcc, s52, v18
    s_nop 1
    v_addc_co_u32 v19, vcc, 0, v19, vcc
    s_mov_b64 exec, 0xffff
    global_load_dword v18, v[18:19], off
    s_mov_b64 exec, -1
    s_waitcnt lgkmcnt(0)
    s_mov_b32 s12, s4
    s_mov_b32 s13, s5
    s_mov_b32 s14, 71303168
    s_mov_b32 s15, 0x00020000
    s_cmp_lg_u32 s2, 0
    s_cbranch_scc1 h_first_nonon
    s_mov_b32 s16, s46
    s_mov_b32 s17, s47
    s_mov_b32 s18, 256
    s_mov_b32 s19, 0x00020000
    v_lshlrev_b32 v14, 6, v1
    s_or_b32 s50, s50, 1
    v_mov_b32 v13, s50
    buffer_store_dword v13, v14, s[16:19], 0 offen sc1
h_first_nonon:
    v_mov_b32 v8, 0
    v_mov_b32 v9, 0
    v_mov_b32 v10, 159488
    ds_write_b64 v10, v[8:9]
    ds_write_b64 v10, v[8:9] offset:8
    ds_write_b64 v10, v[8:9] offset:16
    ds_write_b64 v10, v[8:9] offset:24
    s_waitcnt lgkmcnt(0)
    s_barrier
    s_branch h_first_tail
k_exit:
k_exit2:
    s_endpgm
.p2align 6
c_qkvA:
    v_and_b32 v1, 63, v0
    v_lshrrev_b32 v2, 6, v0
    v_lshlrev_b32 v5, 4, v1
    v_lshrrev_b32 v3, 5, v1
    v_and_b32 v4, 15, v0
    v_bfe_u32 v7, v1, 4, 1
    v_lshl_add_u32 v6, v7, 5, v4
    v_lshlrev_b32 v6, 4, v6
    v_lshl_add_u32 v6, v3, 10, v6
    s_lshr_b32 s48, s6, 1
    s_lshl_b32 s48, s48, 2
    s_add_u32 s48, s48, s8
    s_lshl_b32 s55, s48, 17
    s_lshl_b32 s56, s9, 22
    s_add_u32 s55, s55, s56
    s_add_u32 s16, s4, s55
    s_addc_u32 s17, s5, 0
    s_mov_b32 s18, 65536
    s_mov_b32 s19, 0x00020000
    s_add_u32 s56, s55, 65536
    s_add_u32 s20, s4, s56
    s_addc_u32 s21, s5, 0
    s_mov_b32 s22, 65536
    s_mov_b32 s23, 0x00020000
    s_lshl_b32 s49, s7, 12
    s_add_u32 s49, s49, s55
    s_and_b32 s56, s6, 1
    s_lshl_b32 s56, s56, 11
    s_add_u32 s49, s49, s56
    s_add_u32 s49, s49, 16777216
    s_movk_i32 s54, 4096
    v_lshrrev_b32 v16, 2, v4
    v_lshl_add_u32 v18, v7, 2, v16
    v_lshl_add_u32 v18, v3, 4, v18
    v_lshlrev_b32 v18, 6, v18
    v_and_b32 v17, 3, v4
    v_lshl_add_u32 v18, v17, 3, v18
    v_lshl_add_u32 v26, v7, 5, v18
    v_xor_b32 v27, 32, v26
    v_mov_b32 v24, v26
    v_mov_b32 v25, v27
    v_and_b32 v18, 0x30, v1
    v_add_u32 v10, 155648, v18
    v_lshlrev_b32 v11, 2, v4
    v_add_u32 v11, 155648, v11
    v_lshl_add_u32 v8, v2, 8, v11
    v_lshl_add_u32 v9, v2, 8, v10
    s_lshr_b32 s3, s8, 1
    s_and_b32 s55, s8, 1
    s_lshl_b32 s56, s55, 5
    v_xor_b32 v29, s56, v26
    s_lshl_b32 s56, s3, 13
    s_add_u32 s56, s56, 8192
    v_add_u32 v29, s56, v29
    v_mov_b32 v28, v29
    v_add_u32 v30, 147456, v5
    v_lshl_add_u32 v14, v2, 6, v10
    v_lshl_add_u32 v12, v2, 11, v5
    v_add_u32 v12, 131072, v12
    v_lshlrev_b32 v16, 8, v16
    v_lshl_add_u32 v16, v18, 2, v16
    v_lshl_add_u32 v16, v17, 1, v16
    v_add_u32 v16, 1024, v16
    v_cmp_gt_u32 vcc, 2, v2
    s_nop 1
    v_cndmask_b32 v13, v16, v5, vcc
    s_lshl_b32 s56, s55, 3
    s_add_u32 s56, s56, 131072
    v_add_u32 v13, s56, v13
    v_lshrrev_b32 v18, 2, v18
    v_sub_u32 v18, v4, v18
    v_mov_b32 v19, 0xf149f2ca
    v_add_u32 v16, 0x0, v18
    v_and_b32 v16, 0xfffffff1, v16
    v_cmp_eq_u32 vcc, 0, v16
    s_nop 1
    v_cndmask_b32 v196, v19, 0, vcc
    v_add_u32 v16, 0xffffffff, v18
    v_and_b32 v16, 0xfffffff1, v16
    v_cmp_eq_u32 vcc, 0, v16
    s_nop 1
    v_cndmask_b32 v197, v19, 0, vcc
    v_add_u32 v16, 0xfffffffe, v18
    v_and_b32 v16, 0xfffffff1, v16
    v_cmp_eq_u32 vcc, 0, v16
    s_nop 1
    v_cndmask_b32 v198, v19, 0, vcc
    v_add_u32 v16, 0xfffffffd, v18
    v_and_b32 v16, 0xfffffff1, v16
    v_cmp_eq_u32 vcc, 0, v16
    s_nop 1
    v_cndmask_b32 v199, v19, 0, vcc
    v_add_u32 v16, 0x10, v18
    v_and_b32 v16, 0xfffffff1, v16
    v_cmp_eq_u32 vcc, 0, v16
    s_nop 1
    v_cndmask_b32 v200, v19, 0, vcc
    v_add_u32 v16, 0xf, v18
    v_and_b32 v16, 0xfffffff1, v16
    v_cmp_eq_u32 vcc, 0, v16
    s_nop 1
    v_cndmask_b32 v201, v19, 0, vcc
    v_add_u32 v16, 0xe, v18
    v_and_b32 v16, 0xfffffff1, v16
    v_cmp_eq_u32 vcc, 0, v16
    s_nop 1
    v_cndmask_b32 v202, v19, 0, vcc
    v_add_u32 v16, 0xd, v18
    v_and_b32 v16, 0xfffffff1, v16
    v_cmp_eq_u32 vcc, 0, v16
    s_nop 1
    v_cndmask_b32 v203, v19, 0, vcc
    s_cmp_eq_u32 s48, 0
    s_cselect_b64 vcc, -1, 0
    v_cndmask_b32 v204, v200, v19, vcc
    v_cndmask_b32 v205, v201, v19, vcc
    v_cndmask_b32 v206, v202, v19, vcc
    v_cndmask_b32 v207, v203, v19, vcc
    v_mov_b32 v208, 0x3f803f80
    v_mov_b32 v209, 0x3f803f80
    v_mov_b32 v210, 0x3f803f80
    v_mov_b32 v211, 0x3f803f80
    v_mov_b32 v184, 0
    v_mov_b32 v185, 0
    v_mov_b32 v186, 0
    v_mov_b32 v187, 0
    v_mov_b32 v188, 0
    v_mov_b32 v189, 0
    v_mov_b32 v190, 0
    v_mov_b32 v191, 0
    v_mov_b32 v192, 0
    v_mov_b32 v193, 0
    v_mov_b32 v194, 0
    v_mov_b32 v195, 0
    v_mov_b32 v32, 0
    v_mov_b32 v33, 0
    v_mov_b32 v34, 0
    v_mov_b32 v35, 0
    v_mov_b32 v36, 0
    v_mov_b32 v37, 0
    v_mov_b32 v38, 0
    v_mov_b32 v39, 0
    v_mov_b32 v40, 0
    v_mov_b32 v41, 0
    v_mov_b32 v42, 0
    v_mov_b32 v43, 0
    v_mov_b32 v44, 0
    v_mov_b32 v45, 0
    v_mov_b32 v46, 0
    v_mov_b32 v47, 0
    v_mov_b32 v48, 0
    v_mov_b32 v49, 0
    v_mov_b32 v50, 0
    v_mov_b32 v51, 0
    v_mov_b32 v52, 0
    v_mov_b32 v53, 0
    v_mov_b32 v54, 0
    v_mov_b32 v55, 0
    v_mov_b32 v56, 0
    v_mov_b32 v57, 0
    v_mov_b32 v58, 0
    v_mov_b32 v59, 0
    v_mov_b32 v60, 0
    v_mov_b32 v61, 0
    v_mov_b32 v62, 0
    v_mov_b32 v63, 0
    v_mov_b32 v64, 0
    v_mov_b32 v65, 0
    v_mov_b32 v66, 0
    v_mov_b32 v67, 0
    v_mov_b32 v68, 0
    v_mov_b32 v69, 0
    v_mov_b32 v70, 0
    v_mov_b32 v71, 0
    v_mov_b32 v72, 0
    v_mov_b32 v73, 0
    v_mov_b32 v74, 0
    v_mov_b32 v75, 0
    v_mov_b32 v76, 0
    v_mov_b32 v77, 0
    v_mov_b32 v78, 0
    v_mov_b32 v79, 0
    v_mov_b32 v80, 0
    v_mov_b32 v81, 0
    v_mov_b32 v82, 0
    v_mov_b32 v83, 0
    v_mov_b32 v84, 0
    v_mov_b32 v85, 0
    v_mov_b32 v86, 0
    v_mov_b32 v87, 0
    v_mov_b32 v88, 0
    v_mov_b32 v89, 0
    v_mov_b32 v90, 0
    v_mov_b32 v91, 0
    v_mov_b32 v92, 0
    v_mov_b32 v93, 0
    v_mov_b32 v94, 0
    v_mov_b32 v95, 0
    v_mov_b32 v96, 0
    v_mov_b32 v97, 0
    v_mov_b32 v98, 0
    v_mov_b32 v99, 0
    v_mov_b32 v100, 0
    v_mov_b32 v101, 0
    v_mov_b32 v102, 0
    v_mov_b32 v103, 0
    v_mov_b32 v104, 0
    v_mov_b32 v105, 0
    v_mov_b32 v106, 0
    v_mov_b32 v107, 0
    v_mov_b32 v108, 0
    v_mov_b32 v109, 0
    v_mov_b32 v110, 0
    v_mov_b32 v111, 0
    v_mov_b32 v112, 0
    v_mov_b32 v113, 0
    v_mov_b32 v114, 0
    v_mov_b32 v115, 0
    v_mov_b32 v116, 0
    v_mov_b32 v117, 0
    v_mov_b32 v118, 0
    v_mov_b32 v119, 0
    v_mov_b32 v120, 0
    v_mov_b32 v121, 0
    v_mov_b32 v122, 0
    v_mov_b32 v123, 0
    v_mov_b32 v124, 0
    v_mov_b32 v125, 0
    v_mov_b32 v126, 0
    v_mov_b32 v127, 0
    s_mov_b32 s50, 8192
    s_mov_b32 s58, 6144
    s_mov_b32 s51, 12288
    s_mov_b32 s59, 10240
    s_mov_b32 s52, 0
    s_mul_i32 s60, s9, 786432
    s_add_u32 s60, s60, 65273856
    s_lshl_b32 s61, s11, 10
    s_add_u32 s60, s60, s61
    s_and_b32 s61, s8, 2
    s_lshl_b32 s61, s61, 7
    s_add_u32 s60, s60, s61
    s_add_u32 s61, s60, 128
    s_mov_b32 s98, s10
    s_mov_b32 s99, s10
    s_mov_b32 s3, 0x100000
cp_1:
    s_load_dwordx8 s[64:71], s[4:5], s60 glc
    s_load_dwordx8 s[72:79], s[4:5], s61 glc
    s_sub_u32 s3, s3, 1
    s_cbranch_scc1 cp_1_ok
    s_waitcnt lgkmcnt(0)
    s_xor_b64 s[100:101], s[64:65], s[98:99]
    s_xor_b64 s[64:65], s[66:67], s[98:99]
    s_or_b64 s[100:101], s[100:101], s[64:65]
    s_xor_b64 s[64:65], s[68:69], s[98:99]
    s_or_b64 s[100:101], s[100:101], s[64:65]
    s_xor_b64 s[64:65], s[70:71], s[98:99]
    s_or_b64 s[100:101], s[100:101], s[64:65]
    s_xor_b64 s[64:65], s[72:73], s[98:99]
    s_or_b64 s[100:101], s[100:101], s[64:65]
    s_xor_b64 s[64:65], s[74:75], s[98:99]
    s_or_b64 s[100:101], s[100:101], s[64:65]
    s_xor_b64 s[64:65], s[76:77], s[98:99]
    s_or_b64 s[100:101], s[100:101], s[64:65]
    s_xor_b64 s[64:65], s[78:79], s[98:99]
    s_or_b64 s[100:101], s[100:101], s[64:65]
    s_cbranch_scc1 cp_1
cp_1_ok:
    s_waitcnt lgkmcnt(0)
    buffer_load_dwordx4 v[152:155], v6, s[16:19], 0 offen offset:0 sc1
    buffer_load_dwordx4 v[156:159], v6, s[16:19], 0 offen offset:256 sc1
    buffer_load_dwordx4 v[160:163], v6, s[20:23], 0 offen offset:0 sc1
    buffer_load_dwordx4 v[164:167], v6, s[20:23], 0 offen offset:256 sc1
    buffer_load_dwordx4 v[168:171], v6, s[16:19], 0 offen offset:2048 sc1
    buffer_load_dwordx4 v[172:175], v6, s[16:19], 0 offen offset:2304 sc1
    buffer_load_dwordx4 v[176:179], v6, s[20:23], 0 offen offset:2048 sc1
    buffer_load_dwordx4 v[180:183], v6, s[20:23], 0 offen offset:2304 sc1
    s_barrier
    ds_read_b64_tr_b16 v[128:129], v24 offset:0
    ds_read_b64_tr_b16 v[130:131], v24 offset:512
    ds_read_b64_tr_b16 v[132:133], v25 offset:0
    ds_read_b64_tr_b16 v[134:135], v25 offset:512
    ds_read_b64_tr_b16 v[136:137], v24 offset:8192
    ds_read_b64_tr_b16 v[138:139], v24 offset:8704
    ds_read_b64_tr_b16 v[140:141], v25 offset:8192
    ds_read_b64_tr_b16 v[142:143], v25 offset:8704
    ds_read_b64_tr_b16 v[144:145], v24 offset:16384
    ds_read_b64_tr_b16 v[146:147], v24 offset:16896
    buffer_load_dwordx4 a[0:3], v6, s[16:19], s54 offen offset:0 sc1
    buffer_load_dwordx4 a[4:7], v6, s[16:19], s54 offen offset:256 sc1
    buffer_load_dwordx4 a[8:11], v6, s[20:23], s54 offen offset:0 sc1
    buffer_load_dwordx4 a[12:15], v6, s[20:23], s54 offen offset:256 sc1
    buffer_load_dwordx4 a[16:19], v6, s[16:19], s54 offen offset:2048 sc1
    buffer_load_dwordx4 a[20:23], v6, s[16:19], s54 offen offset:2304 sc1
    s_mov_b32 s54, 7
.p2align 3
c_qkvA_loop:
    s_waitcnt vmcnt(12) lgkmcnt(6)
    v_mfma_f32_16x16x32_bf16 v[184:187], v[188:191], v[192:195], v[184:187]
    v_mfma_f32_16x16x32_bf16 v[32:35], v[128:131], v[152:155], v[32:35]
    ds_read_b64_tr_b16 v[148:149], v25 offset:16384
    v_mfma_f32_16x16x32_bf16 v[36:39], v[128:131], v[156:159], v[36:39]
    ds_read_b64_tr_b16 v[150:151], v25 offset:16896
    v_mfma_f32_16x16x32_bf16 v[52:55], v[132:135], v[156:159], v[52:55]
    buffer_load_dwordx4 a[24:27], v6, s[20:23], s58 offen offset:0 sc1
    v_mfma_f32_16x16x32_bf16 v[48:51], v[132:135], v[152:155], v[48:51]
    ds_read_b64_tr_b16 v[188:189], v28 offset:0
    s_waitcnt lgkmcnt(5)
    v_mfma_f32_16x16x32_bf16 v[64:67], v[136:139], v[152:155], v[64:67]
    v_mfma_f32_16x16x32_bf16 v[68:71], v[136:139], v[156:159], v[68:71]
    ds_read_b64_tr_b16 v[190:191], v28 offset:512
    v_mfma_f32_16x16x32_bf16 v[84:87], v[140:143], v[156:159], v[84:87]
    buffer_load_dwordx4 a[28:31], v6, s[20:23], s58 offen offset:256 sc1
    v_mfma_f32_16x16x32_bf16 v[80:83], v[140:143], v[152:155], v[80:83]
    ds_read_b128 v[192:195], v30 offset:0
    s_waitcnt lgkmcnt(3)
    v_mfma_f32_16x16x32_bf16 v[96:99], v[152:155], v[144:147], v[96:99]
    v_mfma_f32_16x16x32_bf16 v[100:103], v[156:159], v[144:147], v[100:103]
    v_mfma_f32_16x16x32_bf16 v[116:119], v[156:159], v[148:151], v[116:119]
    v_mfma_f32_16x16x32_bf16 v[112:115], v[152:155], v[148:151], v[112:115]
    s_waitcnt vmcnt(12)
    v_mfma_f32_16x16x32_bf16 v[40:43], v[128:131], v[160:163], v[40:43]
    buffer_load_dwordx4 v[152:155], v6, s[16:19], s50 offen offset:0 sc1
    v_mfma_f32_16x16x32_bf16 v[44:47], v[128:131], v[164:167], v[44:47]
    v_mfma_f32_16x16x32_bf16 v[60:63], v[132:135], v[164:167], v[60:63]
    ds_read_b64_tr_b16 v[128:129], v24 offset:2048
    v_mfma_f32_16x16x32_bf16 v[56:59], v[132:135], v[160:163], v[56:59]
    ds_read_b64_tr_b16 v[130:131], v24 offset:2560
    v_mfma_f32_16x16x32_bf16 v[72:75], v[136:139], v[160:163], v[72:75]
    ds_read_b64_tr_b16 v[132:133], v25 offset:2048
    v_mfma_f32_16x16x32_bf16 v[76:79], v[136:139], v[164:167], v[76:79]
    ds_read_b64_tr_b16 v[134:135], v25 offset:2560
    v_mfma_f32_16x16x32_bf16 v[92:95], v[140:143], v[164:167], v[92:95]
    ds_read_b64_tr_b16 v[136:137], v24 offset:10240
    buffer_load_dwordx4 v[156:159], v6, s[16:19], s50 offen offset:256 sc1
    v_mfma_f32_16x16x32_bf16 v[88:91], v[140:143], v[160:163], v[88:91]
    ds_read_b64_tr_b16 v[138:139], v24 offset:10752
    v_mfma_f32_16x16x32_bf16 v[104:107], v[160:163], v[144:147], v[104:107]
    ds_read_b64_tr_b16 v[140:141], v25 offset:10240
    v_mfma_f32_16x16x32_bf16 v[108:111], v[164:167], v[144:147], v[108:111]
    ds_read_b64_tr_b16 v[142:143], v25 offset:10752
    v_mfma_f32_16x16x32_bf16 v[124:127], v[164:167], v[148:151], v[124:127]
    ds_read_b64_tr_b16 v[144:145], v24 offset:18432
    v_mfma_f32_16x16x32_bf16 v[120:123], v[160:163], v[148:151], v[120:123]
    ds_read_b64_tr_b16 v[146:147], v24 offset:18944
    s_waitcnt vmcnt(12) lgkmcnt(6)
    v_mfma_f32_16x16x32_bf16 v[184:187], v[188:191], v[192:195], v[184:187]
    v_mfma_f32_16x16x32_bf16 v[32:35], v[128:131], v[168:171], v[32:35]
    ds_read_b64_tr_b16 v[148:149], v25 offset:18432
    v_mfma_f32_16x16x32_bf16 v[36:39], v[128:131], v[172:175], v[36:39]
    ds_read_b64_tr_b16 v[150:151], v25 offset:18944
    v_mfma_f32_16x16x32_bf16 v[52:55], v[132:135], v[172:175], v[52:55]
    buffer_load_dwordx4 v[160:163], v6, s[20:23], s58 offen offset:2048 sc1
    v_mfma_f32_16x16x32_bf16 v[48:51], v[132:135], v[168:171], v[48:51]
    ds_read_b64_tr_b16 v[188:189], v28 offset:2048
    s_waitcnt lgkmcnt(5)
    v_mfma_f32_16x16x32_bf16 v[64:67], v[136:139], v[168:171], v[64:67]
    v_mfma_f32_16x16x32_bf16 v[68:71], v[136:139], v[172:175], v[68:71]
    ds_read_b64_tr_b16 v[190:191], v28 offset:2560
    v_mfma_f32_16x16x32_bf16 v[84:87], v[140:143], v[172:175], v[84:87]
    buffer_load_dwordx4 v[164:167], v6, s[20:23], s58 offen offset:2304 sc1
    v_mfma_f32_16x16x32_bf16 v[80:83], v[140:143], v[168:171], v[80:83]
    ds_read_b128 v[192:195], v30 offset:1024
    s_waitcnt lgkmcnt(3)
    v_mfma_f32_16x16x32_bf16 v[96:99], v[168:171], v[144:147], v[96:99]
    v_mfma_f32_16x16x32_bf16 v[100:103], v[172:175], v[144:147], v[100:103]
    v_mfma_f32_16x16x32_bf16 v[116:119], v[172:175], v[148:151], v[116:119]
    v_mfma_f32_16x16x32_bf16 v[112:115], v[168:171], v[148:151], v[112:115]
    s_waitcnt vmcnt(12)
    v_mfma_f32_16x16x32_bf16 v[40:43], v[128:131], v[176:179], v[40:43]
    buffer_load_dwordx4 v[168:171], v6, s[16:19], s50 offen offset:2048 sc1
    v_mfma_f32_16x16x32_bf16 v[44:47], v[128:131], v[180:183], v[44:47]
    v_mfma_f32_16x16x32_bf16 v[60:63], v[132:135], v[180:183], v[60:63]
    ds_read_b64_tr_b16 v[128:129], v24 offset:4096
    v_mfma_f32_16x16x32_bf16 v[56:59], v[132:135], v[176:179], v[56:59]
    ds_read_b64_tr_b16 v[130:131], v24 offset:4608
    v_mfma_f32_16x16x32_bf16 v[72:75], v[136:139], v[176:179], v[72:75]
    ds_read_b64_tr_b16 v[132:133], v25 offset:4096
    v_mfma_f32_16x16x32_bf16 v[76:79], v[136:139], v[180:183], v[76:79]
    ds_read_b64_tr_b16 v[134:135], v25 offset:4608
    v_mfma_f32_16x16x32_bf16 v[92:95], v[140:143], v[180:183], v[92:95]
    ds_read_b64_tr_b16 v[136:137], v24 offset:12288
    buffer_load_dwordx4 v[172:175], v6, s[16:19], s50 offen offset:2304 sc1
    v_mfma_f32_16x16x32_bf16 v[88:91], v[140:143], v[176:179], v[88:91]
    ds_read_b64_tr_b16 v[138:139], v24 offset:12800
    v_mfma_f32_16x16x32_bf16 v[104:107], v[176:179], v[144:147], v[104:107]
    ds_read_b64_tr_b16 v[140:141], v25 offset:12288
    v_mfma_f32_16x16x32_bf16 v[108:111], v[180:183], v[144:147], v[108:111]
    ds_read_b64_tr_b16 v[142:143], v25 offset:12800
    v_mfma_f32_16x16x32_bf16 v[124:127], v[180:183], v[148:151], v[124:127]
    ds_read_b64_tr_b16 v[144:145], v24 offset:20480
    v_mfma_f32_16x16x32_bf16 v[120:123], v[176:179], v[148:151], v[120:123]
    ds_read_b64_tr_b16 v[146:147], v24 offset:20992
    s_waitcnt vmcnt(12) lgkmcnt(6)
    v_mfma_f32_16x16x32_bf16 v[184:187], v[188:191], v[192:195], v[184:187]
    v_mfma_f32_16x16x32_bf16 v[32:35], v[128:131], a[0:3], v[32:35]
    ds_read_b64_tr_b16 v[148:149], v25 offset:20480
    v_mfma_f32_16x16x32_bf16 v[36:39], v[128:131], a[4:7], v[36:39]
    ds_read_b64_tr_b16 v[150:151], v25 offset:20992
    v_mfma_f32_16x16x32_bf16 v[52:55], v[132:135], a[4:7], v[52:55]
    buffer_load_dwordx4 v[176:179], v6, s[20:23], s59 offen offset:0 sc1
    v_mfma_f32_16x16x32_bf16 v[48:51], v[132:135], a[0:3], v[48:51]
    ds_read_b64_tr_b16 v[188:189], v28 offset:4096
    s_waitcnt lgkmcnt(5)
    v_mfma_f32_16x16x32_bf16 v[64:67], v[136:139], a[0:3], v[64:67]
    s_add_u32 s50, s50, 8192
    v_mfma_f32_16x16x32_bf16 v[68:71], v[136:139], a[4:7], v[68:71]
    ds_read_b64_tr_b16 v[190:191], v28 offset:4608
    v_mfma_f32_16x16x32_bf16 v[84:87], v[140:143], a[4:7], v[84:87]
    buffer_load_dwordx4 v[180:183], v6, s[20:23], s59 offen offset:256 sc1
    v_mfma_f32_16x16x32_bf16 v[80:83], v[140:143], a[0:3], v[80:83]
    ds_read_b128 v[192:195], v30 offset:2048
    s_waitcnt lgkmcnt(3)
    v_mfma_f32_16x16x32_bf16 v[96:99], a[0:3], v[144:147], v[96:99]
    s_add_u32 s52, s52, 24576
    v_mfma_f32_16x16x32_bf16 v[100:103], a[4:7], v[144:147], v[100:103]
    s_cmp_eq_u32 s52, 147456
    v_mfma_f32_16x16x32_bf16 v[116:119], a[4:7], v[148:151], v[116:119]
    s_cselect_b32 s52, 0, s52
    v_mfma_f32_16x16x32_bf16 v[112:115], a[0:3], v[148:151], v[112:115]
    s_add_u32 s58, s58, 8192
    s_waitcnt vmcnt(12)
    v_mfma_f32_16x16x32_bf16 v[40:43], v[128:131], a[8:11], v[40:43]
    buffer_load_dwordx4 a[0:3], v6, s[16:19], s51 offen offset:0 sc1
    v_mfma_f32_16x16x32_bf16 v[44:47], v[128:131], a[12:15], v[44:47]
    s_sub_u32 s54, s54, 1
    v_mfma_f32_16x16x32_bf16 v[60:63], v[132:135], a[12:15], v[60:63]
    ds_read_b64_tr_b16 v[128:129], v24 offset:6144
    v_mfma_f32_16x16x32_bf16 v[56:59], v[132:135], a[8:11], v[56:59]
    ds_read_b64_tr_b16 v[130:131], v24 offset:6656
    v_mfma_f32_16x16x32_bf16 v[72:75], v[136:139], a[8:11], v[72:75]
    ds_read_b64_tr_b16 v[132:133], v25 offset:6144
    v_mfma_f32_16x16x32_bf16 v[76:79], v[136:139], a[12:15], v[76:79]
    ds_read_b64_tr_b16 v[134:135], v25 offset:6656
    v_mfma_f32_16x16x32_bf16 v[92:95], v[140:143], a[12:15], v[92:95]
    ds_read_b64_tr_b16 v[136:137], v24 offset:14336
    buffer_load_dwordx4 a[4:7], v6, s[16:19], s51 offen offset:256 sc1
    v_mfma_f32_16x16x32_bf16 v[88:91], v[140:143], a[8:11], v[88:91]
    ds_read_b64_tr_b16 v[138:139], v24 offset:14848
    v_mfma_f32_16x16x32_bf16 v[104:107], a[8:11], v[144:147], v[104:107]
    ds_read_b64_tr_b16 v[140:141], v25 offset:14336
    v_mfma_f32_16x16x32_bf16 v[108:111], a[12:15], v[144:147], v[108:111]
    ds_read_b64_tr_b16 v[142:143], v25 offset:14848
    v_mfma_f32_16x16x32_bf16 v[124:127], a[12:15], v[148:151], v[124:127]
    ds_read_b64_tr_b16 v[144:145], v24 offset:22528
    v_mfma_f32_16x16x32_bf16 v[120:123], a[8:11], v[148:151], v[120:123]
    ds_read_b64_tr_b16 v[146:147], v24 offset:23040
    s_waitcnt vmcnt(12) lgkmcnt(6)
    v_mfma_f32_16x16x32_bf16 v[184:187], v[188:191], v[192:195], v[184:187]
    v_mfma_f32_16x16x32_bf16 v[32:35], v[128:131], a[16:19], v[32:35]
    ds_read_b64_tr_b16 v[148:149], v25 offset:22528
    v_mfma_f32_16x16x32_bf16 v[36:39], v[128:131], a[20:23], v[36:39]
    ds_read_b64_tr_b16 v[150:151], v25 offset:23040
    v_mfma_f32_16x16x32_bf16 v[52:55], v[132:135], a[20:23], v[52:55]
    buffer_load_dwordx4 a[8:11], v6, s[20:23], s59 offen offset:2048 sc1
    v_mfma_f32_16x16x32_bf16 v[48:51], v[132:135], a[16:19], v[48:51]
    ds_read_b64_tr_b16 v[188:189], v28 offset:6144
    s_waitcnt lgkmcnt(5)
    v_mfma_f32_16x16x32_bf16 v[64:67], v[136:139], a[16:19], v[64:67]
    v_add_u32 v25, s52, v27
    v_mfma_f32_16x16x32_bf16 v[68:71], v[136:139], a[20:23], v[68:71]
    ds_read_b64_tr_b16 v[190:191], v28 offset:6656
    v_mfma_f32_16x16x32_bf16 v[84:87], v[140:143], a[20:23], v[84:87]
    buffer_load_dwordx4 a[12:15], v6, s[20:23], s59 offen offset:2304 sc1
    v_mfma_f32_16x16x32_bf16 v[80:83], v[140:143], a[16:19], v[80:83]
    ds_read_b128 v[192:195], v30 offset:3072
    s_waitcnt lgkmcnt(3)
    v_mfma_f32_16x16x32_bf16 v[96:99], a[16:19], v[144:147], v[96:99]
    v_add_u32 v24, s52, v26
    v_mfma_f32_16x16x32_bf16 v[100:103], a[20:23], v[144:147], v[100:103]
    v_add_u32 v28, s52, v29
    v_mfma_f32_16x16x32_bf16 v[116:119], a[20:23], v[148:151], v[116:119]
    s_add_u32 s59, s59, 8192
    s_waitcnt lgkmcnt(0)
    v_mfma_f32_16x16x32_bf16 v[112:115], a[16:19], v[148:151], v[112:115]
    s_barrier
    s_waitcnt vmcnt(12)
    v_mfma_f32_16x16x32_bf16 v[40:43], v[128:131], a[24:27], v[40:43]
    buffer_load_dwordx4 a[16:19], v6, s[16:19], s51 offen offset:2048 sc1
    v_mfma_f32_16x16x32_bf16 v[44:47], v[128:131], a[28:31], v[44:47]
    v_xor_b32 v30, 4096, v30
    v_mfma_f32_16x16x32_bf16 v[60:63], v[132:135], a[28:31], v[60:63]
    ds_read_b64_tr_b16 v[128:129], v24 offset:0
    v_mfma_f32_16x16x32_bf16 v[56:59], v[132:135], a[24:27], v[56:59]
    ds_read_b64_tr_b16 v[130:131], v24 offset:512
    v_mfma_f32_16x16x32_bf16 v[72:75], v[136:139], a[24:27], v[72:75]
    ds_read_b64_tr_b16 v[132:133], v25 offset:0
    v_mfma_f32_16x16x32_bf16 v[76:79], v[136:139], a[28:31], v[76:79]
    ds_read_b64_tr_b16 v[134:135], v25 offset:512
    v_mfma_f32_16x16x32_bf16 v[92:95], v[140:143], a[28:31], v[92:95]
    ds_read_b64_tr_b16 v[136:137], v24 offset:8192
    buffer_load_dwordx4 a[20:23], v6, s[16:19], s51 offen offset:2304 sc1
    v_mfma_f32_16x16x32_bf16 v[88:91], v[140:143], a[24:27], v[88:91]
    ds_read_b64_tr_b16 v[138:139], v24 offset:8704
    v_mfma_f32_16x16x32_bf16 v[104:107], a[24:27], v[144:147], v[104:107]
    ds_read_b64_tr_b16 v[140:141], v25 offset:8192
    s_add_u32 s51, s51, 8192
    v_mfma_f32_16x16x32_bf16 v[108:111], a[28:31], v[144:147], v[108:111]
    ds_read_b64_tr_b16 v[142:143], v25 offset:8704
    v_mfma_f32_16x16x32_bf16 v[124:127], a[28:31], v[148:151], v[124:127]
    ds_read_b64_tr_b16 v[144:145], v24 offset:16384
    s_cmp_lg_u32 s54, 0
    v_mfma_f32_16x16x32_bf16 v[120:123], a[24:27], v[148:151], v[120:123]
    ds_read_b64_tr_b16 v[146:147], v24 offset:16896
    s_cbranch_scc1 c_qkvA_loop
    s_waitcnt vmcnt(12) lgkmcnt(6)
    v_mfma_f32_16x16x32_bf16 v[184:187], v[188:191], v[192:195], v[184:187]
    v_mfma_f32_16x16x32_bf16 v[32:35], v[128:131], v[152:155], v[32:35]
    ds_read_b64_tr_b16 v[148:149], v25 offset:16384
    v_mfma_f32_16x16x32_bf16 v[36:39], v[128:131], v[156:159], v[36:39]
    ds_read_b64_tr_b16 v[150:151], v25 offset:16896
    v_mfma_f32_16x16x32_bf16 v[52:55], v[132:135], v[156:159], v[52:55]
    buffer_load_dwordx4 a[24:27], v6, s[20:23], s58 offen offset:0 sc1
    ds_read_b32 v16, v8 offset:1280
    v_mfma_f32_16x16x32_bf16 v[48:51], v[132:135], v[152:155], v[48:51]
    ds_read_b64_tr_b16 v[188:189], v28 offset:0
    ds_read_b32 v18, v8 offset:1344
    s_waitcnt lgkmcnt(7)
    v_mfma_f32_16x16x32_bf16 v[64:67], v[136:139], v[152:155], v[64:67]
    ds_read_b32 v20, v8 offset:1408
    v_mfma_f32_16x16x32_bf16 v[68:71], v[136:139], v[156:159], v[68:71]
    ds_read_b64_tr_b16 v[190:191], v28 offset:512
    v_mfma_f32_16x16x32_bf16 v[84:87], v[140:143], v[156:159], v[84:87]
    buffer_load_dwordx4 a[28:31], v6, s[20:23], s58 offen offset:256 sc1
    ds_read_b32 v22, v8 offset:1472
    v_mfma_f32_16x16x32_bf16 v[80:83], v[140:143], v[152:155], v[80:83]
    ds_read_b128 v[192:195], v30 offset:0
    ds_read_b128 v[212:215], v10 offset:128
    s_waitcnt lgkmcnt(8)
    v_mfma_f32_16x16x32_bf16 v[96:99], v[152:155], v[144:147], v[96:99]
    ds_read_b128 v[216:219], v10 offset:192
    v_mfma_f32_16x16x32_bf16 v[100:103], v[156:159], v[144:147], v[100:103]
    v_mfma_f32_16x16x32_bf16 v[116:119], v[156:159], v[148:151], v[116:119]
    v_mfma_f32_16x16x32_bf16 v[112:115], v[152:155], v[148:151], v[112:115]
    s_waitcnt vmcnt(12)
    v_mfma_f32_16x16x32_bf16 v[40:43], v[128:131], v[160:163], v[40:43]
    s_waitcnt lgkmcnt(0)
    v_fma_f32 v64, -v16, v212, v64
    v_fma_f32 v65, -v16, v213, v65
    v_mfma_f32_16x16x32_bf16 v[44:47], v[128:131], v[164:167], v[44:47]
    v_fma_f32 v66, -v16, v214, v66
    v_mfma_f32_16x16x32_bf16 v[60:63], v[132:135], v[164:167], v[60:63]
    ds_read_b64_tr_b16 v[128:129], v24 offset:2048
    v_fma_f32 v67, -v16, v215, v67
    v_mfma_f32_16x16x32_bf16 v[56:59], v[132:135], v[160:163], v[56:59]
    ds_read_b64_tr_b16 v[130:131], v24 offset:2560
    v_fma_f32 v68, -v18, v212, v68
    v_fma_f32 v69, -v18, v213, v69
    v_mfma_f32_16x16x32_bf16 v[72:75], v[136:139], v[160:163], v[72:75]
    ds_read_b64_tr_b16 v[132:133], v25 offset:2048
    v_fma_f32 v70, -v18, v214, v70
    v_mfma_f32_16x16x32_bf16 v[76:79], v[136:139], v[164:167], v[76:79]
    ds_read_b64_tr_b16 v[134:135], v25 offset:2560
    v_fma_f32 v71, -v18, v215, v71
    v_mfma_f32_16x16x32_bf16 v[92:95], v[140:143], v[164:167], v[92:95]
    ds_read_b64_tr_b16 v[136:137], v24 offset:10240
    v_fma_f32 v80, -v16, v216, v80
    v_fma_f32 v81, -v16, v217, v81
    v_mfma_f32_16x16x32_bf16 v[88:91], v[140:143], v[160:163], v[88:91]
    ds_read_b64_tr_b16 v[138:139], v24 offset:10752
    v_fma_f32 v82, -v16, v218, v82
    v_mfma_f32_16x16x32_bf16 v[104:107], v[160:163], v[144:147], v[104:107]
    ds_read_b64_tr_b16 v[140:141], v25 offset:10240
    v_fma_f32 v83, -v16, v219, v83
    v_mfma_f32_16x16x32_bf16 v[108:111], v[164:167], v[144:147], v[108:111]
    ds_read_b64_tr_b16 v[142:143], v25 offset:10752
    v_fma_f32 v84, -v18, v216, v84
    v_fma_f32 v85, -v18, v217, v85
    v_mfma_f32_16x16x32_bf16 v[124:127], v[164:167], v[148:151], v[124:127]
    ds_read_b64_tr_b16 v[144:145], v24 offset:18432
    v_fma_f32 v86, -v18, v218, v86
    v_mfma_f32_16x16x32_bf16 v[120:123], v[160:163], v[148:151], v[120:123]
    ds_read_b64_tr_b16 v[146:147], v24 offset:18944
    v_fma_f32 v87, -v18, v219, v87
    s_waitcnt vmcnt(10) lgkmcnt(6)
    v_mfma_f32_16x16x32_bf16 v[184:187], v[188:191], v[192:195], v[184:187]
    v_mfma_f32_16x16x32_bf16 v[32:35], v[128:131], v[168:171], v[32:35]
    ds_read_b64_tr_b16 v[148:149], v25 offset:18432
    v_fma_f32 v72, -v20, v212, v72
    v_fma_f32 v73, -v20, v213, v73
    v_mfma_f32_16x16x32_bf16 v[36:39], v[128:131], v[172:175], v[36:39]
    ds_read_b64_tr_b16 v[150:151], v25 offset:18944
    v_fma_f32 v74, -v20, v214, v74
    v_mfma_f32_16x16x32_bf16 v[52:55], v[132:135], v[172:175], v[52:55]
    v_fma_f32 v75, -v20, v215, v75
    ds_read_b128 v[152:155], v10 offset:0
    v_mfma_f32_16x16x32_bf16 v[48:51], v[132:135], v[168:171], v[48:51]
    ds_read_b64_tr_b16 v[188:189], v28 offset:2048
    v_fma_f32 v76, -v22, v212, v76
    v_fma_f32 v77, -v22, v213, v77
    ds_read_b128 v[156:159], v10 offset:64
    s_waitcnt lgkmcnt(7)
    v_mfma_f32_16x16x32_bf16 v[64:67], v[136:139], v[168:171], v[64:67]
    v_fma_f32 v78, -v22, v214, v78
    ds_read_b32 v17, v8 offset:2816
    v_mfma_f32_16x16x32_bf16 v[68:71], v[136:139], v[172:175], v[68:71]
    ds_read_b64_tr_b16 v[190:191], v28 offset:2560
    v_fma_f32 v79, -v22, v215, v79
    v_mfma_f32_16x16x32_bf16 v[84:87], v[140:143], v[172:175], v[84:87]
    v_fma_f32 v88, -v20, v216, v88
    v_fma_f32 v89, -v20, v217, v89
    ds_read_b32 v19, v8 offset:2880
    v_mfma_f32_16x16x32_bf16 v[80:83], v[140:143], v[168:171], v[80:83]
    ds_read_b128 v[192:195], v30 offset:1024
    v_fma_f32 v90, -v20, v218, v90
    ds_read_b32 v21, v8 offset:2944
    s_waitcnt lgkmcnt(8)
    v_mfma_f32_16x16x32_bf16 v[96:99], v[168:171], v[144:147], v[96:99]
    v_fma_f32 v91, -v20, v219, v91
    ds_read_b32 v23, v8 offset:3008
    v_mfma_f32_16x16x32_bf16 v[100:103], v[172:175], v[144:147], v[100:103]
    v_fma_f32 v92, -v22, v216, v92
    v_fma_f32 v93, -v22, v217, v93
    v_mfma_f32_16x16x32_bf16 v[116:119], v[172:175], v[148:151], v[116:119]
    v_fma_f32 v94, -v22, v218, v94
    v_mfma_f32_16x16x32_bf16 v[112:115], v[168:171], v[148:151], v[112:115]
    v_fma_f32 v95, -v22, v219, v95
    s_waitcnt vmcnt(8)
    v_mfma_f32_16x16x32_bf16 v[40:43], v[128:131], v[176:179], v[40:43]
    s_waitcnt lgkmcnt(0)
    v_fma_f32 v32, -v16, v152, v32
    v_fma_f32 v33, -v16, v153, v33
    v_mfma_f32_16x16x32_bf16 v[44:47], v[128:131], v[180:183], v[44:47]
    v_fma_f32 v34, -v16, v154, v34
    v_mfma_f32_16x16x32_bf16 v[60:63], v[132:135], v[180:183], v[60:63]
    ds_read_b64_tr_b16 v[128:129], v24 offset:4096
    v_fma_f32 v35, -v16, v155, v35
    v_fma_f32 v36, -v18, v152, v36
    v_mfma_f32_16x16x32_bf16 v[56:59], v[132:135], v[176:179], v[56:59]
    ds_read_b64_tr_b16 v[130:131], v24 offset:4608
    v_fma_f32 v37, -v18, v153, v37
    v_mfma_f32_16x16x32_bf16 v[72:75], v[136:139], v[176:179], v[72:75]
    ds_read_b64_tr_b16 v[132:133], v25 offset:4096
    v_fma_f32 v38, -v18, v154, v38
    v_fma_f32 v39, -v18, v155, v39
    v_mfma_f32_16x16x32_bf16 v[76:79], v[136:139], v[180:183], v[76:79]
    ds_read_b64_tr_b16 v[134:135], v25 offset:4608
    v_fma_f32 v48, -v16, v156, v48
    v_mfma_f32_16x16x32_bf16 v[92:95], v[140:143], v[180:183], v[92:95]
    ds_read_b64_tr_b16 v[136:137], v24 offset:12288
    v_fma_f32 v49, -v16, v157, v49
    v_fma_f32 v50, -v16, v158, v50
    v_mfma_f32_16x16x32_bf16 v[88:91], v[140:143], v[176:179], v[88:91]
    ds_read_b64_tr_b16 v[138:139], v24 offset:12800
    v_fma_f32 v51, -v16, v159, v51
    v_mfma_f32_16x16x32_bf16 v[104:107], v[176:179], v[144:147], v[104:107]
    ds_read_b64_tr_b16 v[140:141], v25 offset:12288
    v_fma_f32 v52, -v18, v156, v52
    v_fma_f32 v53, -v18, v157, v53
    v_mfma_f32_16x16x32_bf16 v[108:111], v[180:183], v[144:147], v[108:111]
    ds_read_b64_tr_b16 v[142:143], v25 offset:12800
    v_fma_f32 v54, -v18, v158, v54
    v_mfma_f32_16x16x32_bf16 v[124:127], v[180:183], v[148:151], v[124:127]
    ds_read_b64_tr_b16 v[144:145], v24 offset:20480
    v_fma_f32 v55, -v18, v159, v55
    v_mfma_f32_16x16x32_bf16 v[120:123], v[176:179], v[148:151], v[120:123]
    ds_read_b64_tr_b16 v[146:147], v24 offset:20992
    s_waitcnt vmcnt(6) lgkmcnt(6)
    v_mfma_f32_16x16x32_bf16 v[184:187], v[188:191], v[192:195], v[184:187]
    v_mfma_f32_16x16x32_bf16 v[32:35], v[128:131], a[0:3], v[32:35]
    ds_read_b64_tr_b16 v[148:149], v25 offset:20480
    v_fma_f32 v40, -v20, v152, v40
    v_fma_f32 v41, -v20, v153, v41
    v_mfma_f32_16x16x32_bf16 v[36:39], v[128:131], a[4:7], v[36:39]
    ds_read_b64_tr_b16 v[150:151], v25 offset:20992
    v_fma_f32 v42, -v20, v154, v42
    v_mfma_f32_16x16x32_bf16 v[52:55], v[132:135], a[4:7], v[52:55]
    v_fma_f32 v43, -v20, v155, v43
    v_fma_f32 v44, -v22, v152, v44
    ds_read_b128 v[168:171], v9 offset:1280
    v_mfma_f32_16x16x32_bf16 v[48:51], v[132:135], a[0:3], v[48:51]
    ds_read_b64_tr_b16 v[188:189], v28 offset:4096
    v_fma_f32 v45, -v22, v153, v45
    ds_read_b128 v[172:175], v9 offset:1344
    s_waitcnt lgkmcnt(7)
    v_mfma_f32_16x16x32_bf16 v[64:67], v[136:139], a[0:3], v[64:67]
    v_fma_f32 v46, -v22, v154, v46
    v_fma_f32 v47, -v22, v155, v47
    v_mfma_f32_16x16x32_bf16 v[68:71], v[136:139], a[4:7], v[68:71]
    ds_read_b64_tr_b16 v[190:191], v28 offset:4608
    v_fma_f32 v56, -v20, v156, v56
    ds_read_b128 v[176:179], v9 offset:1408
    v_mfma_f32_16x16x32_bf16 v[84:87], v[140:143], a[4:7], v[84:87]
    v_fma_f32 v57, -v20, v157, v57
    v_fma_f32 v58, -v20, v158, v58
    ds_read_b128 v[180:183], v9 offset:1472
    v_mfma_f32_16x16x32_bf16 v[80:83], v[140:143], a[0:3], v[80:83]
    ds_read_b128 v[192:195], v30 offset:2048
    v_fma_f32 v59, -v20, v159, v59
    s_waitcnt lgkmcnt(7)
    v_mfma_f32_16x16x32_bf16 v[96:99], a[0:3], v[144:147], v[96:99]
    v_fma_f32 v60, -v22, v156, v60
    v_fma_f32 v61, -v22, v157, v61
    ds_read2_b32 v[220:221], v11 offset0:64 offset1:80
    v_mfma_f32_16x16x32_bf16 v[100:103], a[4:7], v[144:147], v[100:103]
    v_fma_f32 v62, -v22, v158, v62
    v_mfma_f32_16x16x32_bf16 v[116:119], a[4:7], v[148:151], v[116:119]
    v_fma_f32 v63, -v22, v159, v63
    v_mfma_f32_16x16x32_bf16 v[112:115], a[0:3], v[148:151], v[112:115]
    s_waitcnt vmcnt(4)
    v_mfma_f32_16x16x32_bf16 v[40:43], v[128:131], a[8:11], v[40:43]
    v_mfma_f32_16x16x32_bf16 v[44:47], v[128:131], a[12:15], v[44:47]
    s_waitcnt lgkmcnt(0)
    v_fma_f32 v96, -v168, v220, v96
    v_fma_f32 v97, -v169, v220, v97
    v_mfma_f32_16x16x32_bf16 v[60:63], v[132:135], a[12:15], v[60:63]
    ds_read_b64_tr_b16 v[128:129], v24 offset:6144
    v_fma_f32 v98, -v170, v220, v98
    v_mfma_f32_16x16x32_bf16 v[56:59], v[132:135], a[8:11], v[56:59]
    ds_read_b64_tr_b16 v[130:131], v24 offset:6656
    v_fma_f32 v99, -v171, v220, v99
    v_fma_f32 v100, -v172, v220, v100
    v_mfma_f32_16x16x32_bf16 v[72:75], v[136:139], a[8:11], v[72:75]
    ds_read_b64_tr_b16 v[132:133], v25 offset:6144
    v_fma_f32 v101, -v173, v220, v101
    v_mfma_f32_16x16x32_bf16 v[76:79], v[136:139], a[12:15], v[76:79]
    ds_read_b64_tr_b16 v[134:135], v25 offset:6656
    v_fma_f32 v102, -v174, v220, v102
    v_fma_f32 v103, -v175, v220, v103
    v_mfma_f32_16x16x32_bf16 v[92:95], v[140:143], a[12:15], v[92:95]
    ds_read_b64_tr_b16 v[136:137], v24 offset:14336
    v_fma_f32 v112, -v168, v221, v112
    v_mfma_f32_16x16x32_bf16 v[88:91], v[140:143], a[8:11], v[88:91]
    ds_read_b64_tr_b16 v[138:139], v24 offset:14848
    v_fma_f32 v113, -v169, v221, v113
    v_fma_f32 v114, -v170, v221, v114
    v_mfma_f32_16x16x32_bf16 v[104:107], a[8:11], v[144:147], v[104:107]
    ds_read_b64_tr_b16 v[140:141], v25 offset:14336
    v_fma_f32 v115, -v171, v221, v115
    v_mfma_f32_16x16x32_bf16 v[108:111], a[12:15], v[144:147], v[108:111]
    ds_read_b64_tr_b16 v[142:143], v25 offset:14848
    v_fma_f32 v116, -v172, v221, v116
    v_fma_f32 v117, -v173, v221, v117
    v_mfma_f32_16x16x32_bf16 v[124:127], a[12:15], v[148:151], v[124:127]
    ds_read_b64_tr_b16 v[144:145], v24 offset:22528
    v_fma_f32 v118, -v174, v221, v118
    v_mfma_f32_16x16x32_bf16 v[120:123], a[8:11], v[148:151], v[120:123]
    ds_read_b64_tr_b16 v[146:147], v24 offset:23040
    v_fma_f32 v119, -v175, v221, v119
    s_waitcnt vmcnt(2) lgkmcnt(6)
    v_mfma_f32_16x16x32_bf16 v[184:187], v[188:191], v[192:195], v[184:187]
    v_mfma_f32_16x16x32_bf16 v[32:35], v[128:131], a[16:19], v[32:35]
    ds_read_b64_tr_b16 v[148:149], v25 offset:22528
    v_mfma_f32_16x16x32_bf16 v[36:39], v[128:131], a[20:23], v[36:39]
    ds_read_b64_tr_b16 v[150:151], v25 offset:23040
    v_fma_f32 v104, -v176, v220, v104
    v_fma_f32 v105, -v177, v220, v105
    v_mfma_f32_16x16x32_bf16 v[52:55], v[132:135], a[20:23], v[52:55]
    v_fma_f32 v106, -v178, v220, v106
    ds_read_b128 v[152:155], v9 offset:2816
    v_mfma_f32_16x16x32_bf16 v[48:51], v[132:135], a[16:19], v[48:51]
    ds_read_b64_tr_b16 v[188:189], v28 offset:6144
    v_fma_f32 v107, -v179, v220, v107
    v_fma_f32 v108, -v180, v220, v108
    ds_read_b128 v[156:159], v9 offset:2880
    s_waitcnt lgkmcnt(7)
    v_mfma_f32_16x16x32_bf16 v[64:67], v[136:139], a[16:19], v[64:67]
    v_fma_f32 v109, -v181, v220, v109
    ds_read_b128 v[160:163], v9 offset:2944
    v_mfma_f32_16x16x32_bf16 v[68:71], v[136:139], a[20:23], v[68:71]
    ds_read_b64_tr_b16 v[190:191], v28 offset:6656
    v_fma_f32 v110, -v182, v220, v110
    v_fma_f32 v111, -v183, v220, v111
    ds_read_b128 v[164:167], v9 offset:3008
    v_mfma_f32_16x16x32_bf16 v[84:87], v[140:143], a[20:23], v[84:87]
    v_fma_f32 v120, -v176, v221, v120
    ds_read_b128 v[212:215], v14 offset:128
    v_mfma_f32_16x16x32_bf16 v[80:83], v[140:143], a[16:19], v[80:83]
    ds_read_b128 v[192:195], v30 offset:3072
    v_fma_f32 v121, -v177, v221, v121
    v_fma_f32 v122, -v178, v221, v122
    ds_read_b32 v222, v11 offset:1216
    s_waitcnt lgkmcnt(9)
    v_mfma_f32_16x16x32_bf16 v[96:99], a[16:19], v[144:147], v[96:99]
    v_fma_f32 v123, -v179, v221, v123
    ds_read_b32 v223, v11 offset:2752
    v_mfma_f32_16x16x32_bf16 v[100:103], a[20:23], v[144:147], v[100:103]
    v_fma_f32 v124, -v180, v221, v124
    v_fma_f32 v125, -v181, v221, v125
    v_mfma_f32_16x16x32_bf16 v[116:119], a[20:23], v[148:151], v[116:119]
    v_fma_f32 v126, -v182, v221, v126
    s_waitcnt lgkmcnt(2)
    v_mfma_f32_16x16x32_bf16 v[112:115], a[16:19], v[148:151], v[112:115]
    v_fma_f32 v127, -v183, v221, v127
    s_barrier
    s_waitcnt vmcnt(0)
    v_mfma_f32_16x16x32_bf16 v[40:43], v[128:131], a[24:27], v[40:43]
    v_mul_f32 v64, v17, v64
    v_mul_f32 v65, v17, v65
    v_mfma_f32_16x16x32_bf16 v[44:47], v[128:131], a[28:31], v[44:47]
    v_mul_f32 v66, v17, v66
    v_mul_f32 v67, v17, v67
    v_mfma_f32_16x16x32_bf16 v[60:63], v[132:135], a[28:31], v[60:63]
    v_mul_f32 v80, v17, v80
    v_mul_f32 v81, v17, v81
    v_mfma_f32_16x16x32_bf16 v[56:59], v[132:135], a[24:27], v[56:59]
    v_mul_f32 v82, v17, v82
    v_mul_f32 v83, v17, v83
    v_mfma_f32_16x16x32_bf16 v[72:75], v[136:139], a[24:27], v[72:75]
    v_cvt_pk_bf16_f32 v64, v64, v65
    v_cvt_pk_bf16_f32 v65, v66, v67
    v_mfma_f32_16x16x32_bf16 v[76:79], v[136:139], a[28:31], v[76:79]
    v_cvt_pk_bf16_f32 v66, v80, v81
    v_cvt_pk_bf16_f32 v67, v82, v83
    v_mfma_f32_16x16x32_bf16 v[92:95], v[140:143], a[28:31], v[92:95]
    v_mul_f32 v68, v19, v68
    v_mul_f32 v69, v19, v69
    v_mfma_f32_16x16x32_bf16 v[88:91], v[140:143], a[24:27], v[88:91]
    v_mul_f32 v70, v19, v70
    v_mul_f32 v71, v19, v71
    v_mfma_f32_16x16x32_bf16 v[104:107], a[24:27], v[144:147], v[104:107]
    v_mul_f32 v84, v19, v84
    v_mul_f32 v85, v19, v85
    v_mfma_f32_16x16x32_bf16 v[108:111], a[28:31], v[144:147], v[108:111]
    v_mul_f32 v86, v19, v86
    v_mul_f32 v87, v19, v87
    v_mfma_f32_16x16x32_bf16 v[124:127], a[28:31], v[148:151], v[124:127]
    v_cvt_pk_bf16_f32 v68, v68, v69
    v_cvt_pk_bf16_f32 v69, v70, v71
    v_mfma_f32_16x16x32_bf16 v[120:123], a[24:27], v[148:151], v[120:123]
    v_cvt_pk_bf16_f32 v70, v84, v85
    v_cvt_pk_bf16_f32 v71, v86, v87
    v_mfma_f32_16x16x32_bf16 v[184:187], v[188:191], v[192:195], v[184:187]
    v_pk_mul_f32 v[72:73], v[20:21], v[72:73] op_sel:[1,0] op_sel_hi:[1,1]
    v_pk_mul_f32 v[74:75], v[20:21], v[74:75] op_sel:[1,0] op_sel_hi:[1,1]
    v_pk_mul_f32 v[88:89], v[20:21], v[88:89] op_sel:[1,0] op_sel_hi:[1,1]
    v_pk_mul_f32 v[90:91], v[20:21], v[90:91] op_sel:[1,0] op_sel_hi:[1,1]
    v_cvt_pk_bf16_f32 v72, v72, v73
    v_cvt_pk_bf16_f32 v73, v74, v75
    v_cvt_pk_bf16_f32 v74, v88, v89
    v_cvt_pk_bf16_f32 v75, v90, v91
    v_pk_mul_f32 v[76:77], v[22:23], v[76:77] op_sel:[1,0] op_sel_hi:[1,1]
    v_pk_mul_f32 v[78:79], v[22:23], v[78:79] op_sel:[1,0] op_sel_hi:[1,1]
    v_pk_mul_f32 v[92:93], v[22:23], v[92:93] op_sel:[1,0] op_sel_hi:[1,1]
    v_pk_mul_f32 v[94:95], v[22:23], v[94:95] op_sel:[1,0] op_sel_hi:[1,1]
    v_cvt_pk_bf16_f32 v76, v76, v77
    v_cvt_pk_bf16_f32 v77, v78, v79
    v_cvt_pk_bf16_f32 v78, v92, v93
    v_cvt_pk_bf16_f32 v79, v94, v95
    ds_write_b128 v12, v[76:79] offset:2048
    s_waitcnt lgkmcnt(1)
    v_pk_mul_f32 v[96:97], v[152:153], v[96:97]
    v_pk_mul_f32 v[98:99], v[154:155], v[98:99]
    v_pk_mul_f32 v[112:113], v[152:153], v[112:113]
    v_pk_mul_f32 v[114:115], v[154:155], v[114:115]
    v_cvt_pk_bf16_f32 v99, v98, v99
    v_cvt_pk_bf16_f32 v98, v96, v97
    v_cvt_pk_bf16_f32 v115, v114, v115
    v_cvt_pk_bf16_f32 v114, v112, v113
    v_pk_mul_f32 v[100:101], v[156:157], v[100:101]
    v_pk_mul_f32 v[102:103], v[158:159], v[102:103]
    v_pk_mul_f32 v[116:117], v[156:157], v[116:117]
    v_pk_mul_f32 v[118:119], v[158:159], v[118:119]
    v_cvt_pk_bf16_f32 v100, v100, v101
    v_cvt_pk_bf16_f32 v101, v102, v103
    v_cvt_pk_bf16_f32 v116, v116, v117
    v_cvt_pk_bf16_f32 v117, v118, v119
    v_pk_mul_f32 v[104:105], v[160:161], v[104:105]
    v_pk_mul_f32 v[106:107], v[162:163], v[106:107]
    v_pk_mul_f32 v[120:121], v[160:161], v[120:121]
    v_pk_mul_f32 v[122:123], v[162:163], v[122:123]
    v_cvt_pk_bf16_f32 v102, v104, v105
    v_cvt_pk_bf16_f32 v103, v106, v107
    v_cvt_pk_bf16_f32 v118, v120, v121
    v_cvt_pk_bf16_f32 v119, v122, v123
    v_pk_mul_f32 v[108:109], v[164:165], v[108:109]
    v_pk_mul_f32 v[110:111], v[166:167], v[110:111]
    v_pk_mul_f32 v[124:125], v[164:165], v[124:125]
    v_pk_mul_f32 v[126:127], v[166:167], v[126:127]
    v_cvt_pk_bf16_f32 v104, v108, v109
    v_cvt_pk_bf16_f32 v105, v110, v111
    v_cvt_pk_bf16_f32 v120, v124, v125
    v_cvt_pk_bf16_f32 v121, v126, v127
    ds_write_b64 v12, v[104:105] offset:3072
    ds_write_b64 v12, v[120:121] offset:3080
    v_pk_fma_f32 v[184:185], v[222:223], v[212:213], v[184:185] op_sel_hi:[0,1,1] neg_lo:[1,0,0] neg_hi:[1,0,0]
    v_pk_fma_f32 v[186:187], v[222:223], v[214:215], v[186:187] op_sel_hi:[0,1,1] neg_lo:[1,0,0] neg_hi:[1,0,0]
    v_pk_mul_f32 v[184:185], v[222:223], v[184:185] op_sel:[1,0] op_sel_hi:[1,1]
    v_pk_mul_f32 v[186:187], v[222:223], v[186:187] op_sel:[1,0] op_sel_hi:[1,1]
    v_cvt_pk_bf16_f32 v184, v184, v185
    v_cvt_pk_bf16_f32 v185, v186, v187
    s_cmp_ge_u32 s8, 2
    s_cbranch_scc1 c_qkvA_hv
    ds_write_b64 v13, v[184:185]
    s_branch c_qkvA_hd
c_qkvA_hv:
    ds_write_b16 v13, v184 offset:0
    ds_write_b16_d16_hi v13, v184 offset:16
    ds_write_b16 v13, v185 offset:32
    ds_write_b16_d16_hi v13, v185 offset:48
c_qkvA_hd:
    v_cvt_pk_bf16_f32 v44, v44, v45
    v_cvt_pk_bf16_f32 v45, v46, v47
    v_cvt_pk_bf16_f32 v46, v60, v61
    v_cvt_pk_bf16_f32 v47, v62, v63
    v_mul_f32 v23, 0x3e8293ee, v23
    v_cvt_pk_bf16_f32 v40, v40, v41
    v_mfma_f32_16x16x32_bf16 v[156:159], v[76:79], v[44:47], v[196:199]
    v_cvt_pk_bf16_f32 v41, v42, v43
    v_cvt_pk_bf16_f32 v42, v56, v57
    v_mfma_f32_16x16x32_bf16 v[152:155], v[72:75], v[44:47], v[200:203]
    v_cvt_pk_bf16_f32 v43, v58, v59
    v_mul_f32 v21, 0x3e8293ee, v21
    s_waitcnt lgkmcnt(0)
    s_barrier
    ds_read_b128 v[172:175], v12
    ds_read_b64 v[96:97], v12 offset:1024
    ds_read_b64 v[112:113], v12 offset:1032
    v_mfma_f32_16x16x32_bf16 v[148:151], v[72:75], v[40:43], v[196:199]
    v_cvt_pk_bf16_f32 v36, v36, v37
    v_cvt_pk_bf16_f32 v37, v38, v39
    v_mfma_f32_16x16x32_bf16 v[144:147], v[68:71], v[40:43], v[200:203]
    v_cvt_pk_bf16_f32 v38, v52, v53
    v_cvt_pk_bf16_f32 v39, v54, v55
    v_mul_f32 v19, 0x3e8293ee, v19
    v_cvt_pk_bf16_f32 v32, v32, v33
    v_mfma_f32_16x16x32_bf16 v[140:143], v[68:71], v[36:39], v[196:199]
    v_cvt_pk_bf16_f32 v33, v34, v35
    v_cvt_pk_bf16_f32 v34, v48, v49
    v_mfma_f32_16x16x32_bf16 v[136:139], v[64:67], v[36:39], v[200:203]
    v_cvt_pk_bf16_f32 v35, v50, v51
    v_mul_f32 v17, 0x3e8293ee, v17
    v_max3_f32 v179, v152, v153, v154
    s_waitcnt lgkmcnt(2)
    v_mfma_f32_16x16x32_bf16 v[132:135], v[64:67], v[32:35], v[196:199]
    v_max3_f32 v179, v179, v155, v156
    v_max3_f32 v179, v179, v157, v158
    v_mfma_f32_16x16x32_bf16 v[128:131], v[172:175], v[32:35], v[204:207]
    v_max_f32 v179, v179, v159
    v_mov_b32 v183, v179
    v_max3_f32 v178, v144, v145, v146
    v_max3_f32 v178, v178, v147, v148
    v_max3_f32 v178, v178, v149, v150
    v_max_f32 v178, v178, v151
    v_mov_b32 v182, v178
    v_max3_f32 v177, v136, v137, v138
    v_max3_f32 v177, v177, v139, v140
    v_max3_f32 v177, v177, v141, v142
    v_max_f32 v177, v177, v143
    v_mov_b32 v181, v177
    v_permlane32_swap_b32 v179, v183
    v_permlane32_swap_b32 v178, v182
    v_permlane32_swap_b32 v177, v181
    v_max3_f32 v176, v128, v129, v130
    v_max3_f32 v176, v176, v131, v132
    v_max3_f32 v176, v176, v133, v134
    v_max_f32 v176, v176, v135
    v_mov_b32 v180, v176
    v_max_f32 v179, v179, v183
    v_max_f32 v178, v178, v182
    v_max_f32 v177, v177, v181
    v_permlane32_swap_b32 v176, v180
    v_mov_b32 v183, v179
    v_mov_b32 v182, v178
    v_mov_b32 v181, v177
    v_max_f32 v176, v176, v180
    v_mov_b32 v180, v176
    v_permlane16_swap_b32 v179, v183
    v_permlane16_swap_b32 v178, v182
    v_permlane16_swap_b32 v177, v181
    v_permlane16_swap_b32 v176, v180
    v_max_f32 v179, v179, v183
    v_max_f32 v178, v178, v182
    v_max_f32 v177, v177, v181
    v_max_f32 v176, v176, v180
    v_mul_f32_e64 v22, -v179, v23
    v_mul_f32_e64 v20, -v178, v21
    v_mul_f32_e64 v18, -v177, v19
    v_mul_f32_e64 v16, -v176, v17
    s_waitcnt lgkmcnt(0)
    s_add_u32 s51, s49, 65536
    v_pk_fma_f32 v[152:153], v[152:153], v[22:23], v[22:23] op_sel:[0,1,0] op_sel_hi:[1,1,0]
    v_pk_fma_f32 v[154:155], v[154:155], v[22:23], v[22:23] op_sel:[0,1,0] op_sel_hi:[1,1,0]
    v_pk_fma_f32 v[156:157], v[156:157], v[22:23], v[22:23] op_sel:[0,1,0] op_sel_hi:[1,1,0]
    v_pk_fma_f32 v[158:159], v[158:159], v[22:23], v[22:23] op_sel:[0,1,0] op_sel_hi:[1,1,0]
    v_pk_fma_f32 v[144:145], v[144:145], v[20:21], v[20:21] op_sel:[0,1,0] op_sel_hi:[1,1,0]
    v_pk_fma_f32 v[146:147], v[146:147], v[20:21], v[20:21] op_sel:[0,1,0] op_sel_hi:[1,1,0]
    v_pk_fma_f32 v[148:149], v[148:149], v[20:21], v[20:21] op_sel:[0,1,0] op_sel_hi:[1,1,0]
    v_pk_fma_f32 v[150:151], v[150:151], v[20:21], v[20:21] op_sel:[0,1,0] op_sel_hi:[1,1,0]
    v_pk_fma_f32 v[136:137], v[136:137], v[18:19], v[18:19] op_sel:[0,1,0] op_sel_hi:[1,1,0]
    v_pk_fma_f32 v[138:139], v[138:139], v[18:19], v[18:19] op_sel:[0,1,0] op_sel_hi:[1,1,0]
    v_pk_fma_f32 v[140:141], v[140:141], v[18:19], v[18:19] op_sel:[0,1,0] op_sel_hi:[1,1,0]
    v_pk_fma_f32 v[142:143], v[142:143], v[18:19], v[18:19] op_sel:[0,1,0] op_sel_hi:[1,1,0]
    v_pk_fma_f32 v[128:129], v[128:129], v[16:17], v[16:17] op_sel:[0,1,0] op_sel_hi:[1,1,0]
    v_pk_fma_f32 v[130:131], v[130:131], v[16:17], v[16:17] op_sel:[0,1,0] op_sel_hi:[1,1,0]
    v_pk_fma_f32 v[132:133], v[132:133], v[16:17], v[16:17] op_sel:[0,1,0] op_sel_hi:[1,1,0]
    v_pk_fma_f32 v[134:135], v[134:135], v[16:17], v[16:17] op_sel:[0,1,0] op_sel_hi:[1,1,0]
    v_exp_f32 v152, v152
    v_exp_f32 v153, v153
    v_exp_f32 v154, v154
    v_exp_f32 v155, v155
    v_exp_f32 v156, v156
    v_exp_f32 v157, v157
    v_exp_f32 v158, v158
    v_exp_f32 v159, v159
    v_cvt_pk_bf16_f32 v172, v152, v153
    v_cvt_pk_bf16_f32 v173, v154, v155
    v_cvt_pk_bf16_f32 v174, v156, v157
    v_cvt_pk_bf16_f32 v175, v158, v159
    v_exp_f32 v144, v144
    v_exp_f32 v145, v145
    v_mfma_f32_16x16x32_bf16 v[92:95], v[208:211], v[172:175], 0
    v_exp_f32 v146, v146
    v_mfma_f32_16x16x32_bf16 v[60:63], v[102:105], v[172:175], 0
    v_exp_f32 v147, v147
    v_mfma_f32_16x16x32_bf16 v[76:79], v[118:121], v[172:175], 0
    v_exp_f32 v148, v148
    v_exp_f32 v149, v149
    v_exp_f32 v150, v150
    v_exp_f32 v151, v151
    v_rcp_f32 v92, v92
    v_cvt_pk_bf16_f32 v168, v144, v145
    v_cvt_pk_bf16_f32 v169, v146, v147
    v_cvt_pk_bf16_f32 v170, v148, v149
    v_cvt_pk_bf16_f32 v171, v150, v151
    v_pk_mul_f32 v[60:61], v[92:93], v[60:61] op_sel_hi:[0,1]
    v_pk_mul_f32 v[62:63], v[92:93], v[62:63] op_sel_hi:[0,1]
    v_pk_mul_f32 v[76:77], v[92:93], v[76:77] op_sel_hi:[0,1]
    v_pk_mul_f32 v[78:79], v[92:93], v[78:79] op_sel_hi:[0,1]
    v_cvt_pk_bf16_f32 v60, v60, v61
    v_cvt_pk_bf16_f32 v61, v62, v63
    v_cvt_pk_bf16_f32 v62, v76, v77
    v_cvt_pk_bf16_f32 v63, v78, v79
    buffer_store_dwordx4 v[60:63], v6, s[12:15], s51 offen offset:256 sc1
    v_exp_f32 v136, v136
    v_exp_f32 v137, v137
    v_mfma_f32_16x16x32_bf16 v[88:91], v[208:211], v[168:171], 0
    v_exp_f32 v138, v138
    v_mfma_f32_16x16x32_bf16 v[56:59], v[100:103], v[168:171], 0
    v_exp_f32 v139, v139
    v_mfma_f32_16x16x32_bf16 v[72:75], v[116:119], v[168:171], 0
    v_exp_f32 v140, v140
    v_exp_f32 v141, v141
    v_exp_f32 v142, v142
    v_exp_f32 v143, v143
    v_rcp_f32 v88, v88
    v_cvt_pk_bf16_f32 v164, v136, v137
    v_cvt_pk_bf16_f32 v165, v138, v139
    v_cvt_pk_bf16_f32 v166, v140, v141
    v_cvt_pk_bf16_f32 v167, v142, v143
    v_pk_mul_f32 v[56:57], v[88:89], v[56:57] op_sel_hi:[0,1]
    v_pk_mul_f32 v[58:59], v[88:89], v[58:59] op_sel_hi:[0,1]
    v_pk_mul_f32 v[72:73], v[88:89], v[72:73] op_sel_hi:[0,1]
    v_pk_mul_f32 v[74:75], v[88:89], v[74:75] op_sel_hi:[0,1]
    v_cvt_pk_bf16_f32 v56, v56, v57
    v_cvt_pk_bf16_f32 v57, v58, v59
    v_cvt_pk_bf16_f32 v58, v72, v73
    v_cvt_pk_bf16_f32 v59, v74, v75
    buffer_store_dwordx4 v[56:59], v6, s[12:15], s51 offen offset:0 sc1
    v_exp_f32 v128, v128
    v_exp_f32 v129, v129
    v_mfma_f32_16x16x32_bf16 v[84:87], v[208:211], v[164:167], 0
    v_exp_f32 v130, v130
    v_mfma_f32_16x16x32_bf16 v[52:55], v[98:101], v[164:167], 0
    v_exp_f32 v131, v131
    v_mfma_f32_16x16x32_bf16 v[68:71], v[114:117], v[164:167], 0
    v_exp_f32 v132, v132
    v_exp_f32 v133, v133
    v_exp_f32 v134, v134
    v_exp_f32 v135, v135
    v_rcp_f32 v84, v84
    v_cvt_pk_bf16_f32 v160, v128, v129
    v_cvt_pk_bf16_f32 v161, v130, v131
    v_cvt_pk_bf16_f32 v162, v132, v133
    v_cvt_pk_bf16_f32 v163, v134, v135
    v_pk_mul_f32 v[52:53], v[84:85], v[52:53] op_sel_hi:[0,1]
    v_pk_mul_f32 v[54:55], v[84:85], v[54:55] op_sel_hi:[0,1]
    v_mfma_f32_16x16x32_bf16 v[80:83], v[208:211], v[160:163], 0
    v_pk_mul_f32 v[68:69], v[84:85], v[68:69] op_sel_hi:[0,1]
    v_pk_mul_f32 v[70:71], v[84:85], v[70:71] op_sel_hi:[0,1]
    v_mfma_f32_16x16x32_bf16 v[48:51], v[96:99], v[160:163], 0
    v_cvt_pk_bf16_f32 v52, v52, v53
    v_cvt_pk_bf16_f32 v53, v54, v55
    v_mfma_f32_16x16x32_bf16 v[64:67], v[112:115], v[160:163], 0
    v_cvt_pk_bf16_f32 v54, v68, v69
    v_cvt_pk_bf16_f32 v55, v70, v71
    buffer_store_dwordx4 v[52:55], v6, s[12:15], s49 offen offset:256 sc1
    v_rcp_f32 v80, v80
    s_nop 0
    v_pk_mul_f32 v[48:49], v[80:81], v[48:49] op_sel_hi:[0,1]
    v_pk_mul_f32 v[50:51], v[80:81], v[50:51] op_sel_hi:[0,1]
    s_nop 0
    v_pk_mul_f32 v[64:65], v[80:81], v[64:65] op_sel_hi:[0,1]
    v_pk_mul_f32 v[66:67], v[80:81], v[66:67] op_sel_hi:[0,1]
    v_cvt_pk_bf16_f32 v48, v48, v49
    v_cvt_pk_bf16_f32 v49, v50, v51
    v_cvt_pk_bf16_f32 v50, v64, v65
    v_cvt_pk_bf16_f32 v51, v66, v67
    buffer_store_dwordx4 v[48:51], v6, s[12:15], s49 offen offset:0 sc1
    s_branch c_wo
.p2align 6
c_wo:
    v_and_b32 v1, 63, v0
    v_lshrrev_b32 v2, 6, v0
    v_lshlrev_b32 v5, 4, v1
    v_lshrrev_b32 v3, 5, v1
    s_lshl_b32 s48, s6, 2
    s_add_u32 s48, s48, s8
    s_lshl_b32 s55, s48, 16
    s_lshl_b32 s56, s9, 22
    s_add_u32 s55, s55, s56
    s_lshl_b32 s56, s7, 12
    s_add_u32 s58, s55, s56
    s_add_u32 s55, s55, 16777216
    s_add_u32 s16, s4, s55
    s_addc_u32 s17, s5, 0
    s_mov_b32 s18, 65536
    s_mov_b32 s19, 0x00020000
    s_lshl_b32 s60, s9, 2
    s_add_u32 s60, s60, 159504
    v_mov_b32 v28, s60
    s_mul_i32 s55, s9, 786432
    s_add_u32 s55, s55, 65798144
    v_and_b32 v24, 63, v0
    s_and_b32 s56, s11, 0xe0
    v_lshrrev_b32 v25, 5, v24
    v_add_u32 v24, s56, v24
    v_and_b32 v24, 255, v24
    v_lshlrev_b32 v24, 10, v24
    v_lshl_add_u32 v24, v25, 8, v24
    s_bfe_u32 s56, s11, 0x20003
    s_and_b32 s57, s11, 7
    s_lshl_b32 s56, s56, 7
    s_lshl_b32 s57, s57, 2
    s_add_u32 s55, s55, s56
    s_add_u32 s55, s55, s57
    v_mov_b32 v25, 159488
    v_mov_b32 v26, 1
    v_mov_b32 v27, s10
    v_and_b32 v4, 15, v0
    v_bfe_u32 v17, v1, 4, 1
    v_lshl_add_u32 v6, v17, 5, v4
    v_lshlrev_b32 v6, 4, v6
    v_lshl_add_u32 v6, v3, 10, v6
    v_lshrrev_b32 v16, 2, v4
    v_lshl_add_u32 v16, v17, 2, v16
    v_lshl_add_u32 v16, v3, 4, v16
    v_lshlrev_b32 v16, 7, v16
    v_and_b32 v18, 3, v4
    v_lshl_add_u32 v16, v18, 3, v16
    v_lshrrev_b32 v18, 3, v4
    v_lshl_add_u32 v18, v18, 1, v17
    v_lshl_add_u32 v12, v18, 5, v16
    ds_read_b32 v29, v28
    buffer_load_dwordx4 v[96:99], v6, s[12:15], s58 offen offset:0 sc1
    buffer_load_dwordx4 v[100:103], v6, s[12:15], s58 offen offset:256 sc1
    buffer_load_dwordx4 v[104:107], v6, s[12:15], s58 offen offset:2048 sc1
    buffer_load_dwordx4 v[108:111], v6, s[12:15], s58 offen offset:2304 sc1
    s_waitcnt lgkmcnt(0)
    v_readfirstlane_b32 s60, v29
    s_lshr_b32 s51, s60, 2
    s_and_b32 s51, s51, s60
    s_and_b32 s51, s51, 3
    s_cmp_eq_u32 s51, 0
    s_cbranch_scc1 c_wo_late
    s_and_b32 s52, s51, 1
    s_xor_b32 s52, s52, 1
    s_lshl_b32 s50, s52, 15
    buffer_load_dwordx4 v[112:115], v6, s[16:19], s50 offen offset:0 sc1
    buffer_load_dwordx4 v[116:119], v6, s[16:19], s50 offen offset:256 sc1
    buffer_load_dwordx4 v[120:123], v6, s[16:19], s50 offen offset:2048 sc1
    buffer_load_dwordx4 v[124:127], v6, s[16:19], s50 offen offset:2304 sc1
    s_add_u32 s50, s50, 4096
    buffer_load_dwordx4 v[128:131], v6, s[16:19], s50 offen offset:0 sc1
    s_mov_b64 exec, 1
    s_waitcnt vmcnt(9)
    ds_add_rtn_u32 v26, v25, v26
    s_waitcnt lgkmcnt(0)
    v_readfirstlane_b32 s56, v26
    s_and_b32 s56, s56, 3
    s_cmp_lg_u32 s56, 3
    s_cbranch_scc1 pub_2
    s_mov_b32 exec_lo, -1
    buffer_store_dword v27, v24, s[12:15], s55 offen sc1
pub_2:
    s_mov_b64 exec, -1
    s_branch c_wo_run
c_wo_late:
    s_mov_b64 exec, 1
    s_waitcnt vmcnt(4)
    ds_add_rtn_u32 v26, v25, v26
    s_waitcnt lgkmcnt(0)
    v_readfirstlane_b32 s56, v26
    s_and_b32 s56, s56, 3
    s_cmp_lg_u32 s56, 3
    s_cbranch_scc1 pub_3
    s_mov_b32 exec_lo, -1
    buffer_store_dword v27, v24, s[12:15], s55 offen sc1
pub_3:
    s_mov_b64 exec, -1
    s_branch wp_4_t
wp_4:
    ds_read_b32 v29, v28
    s_waitcnt lgkmcnt(0)
    v_readfirstlane_b32 s60, v29
    s_lshr_b32 s51, s60, 2
    s_and_b32 s51, s51, s60
    s_and_b32 s51, s51, 3
wp_4_t:
    s_cmp_lg_u32 s51, 0
    s_cbranch_scc0 wp_4
    s_and_b32 s52, s51, 1
    s_xor_b32 s52, s52, 1
    s_lshl_b32 s50, s52, 15
    buffer_load_dwordx4 v[112:115], v6, s[16:19], s50 offen offset:0 sc1
    buffer_load_dwordx4 v[116:119], v6, s[16:19], s50 offen offset:256 sc1
    buffer_load_dwordx4 v[120:123], v6, s[16:19], s50 offen offset:2048 sc1
    buffer_load_dwordx4 v[124:127], v6, s[16:19], s50 offen offset:2304 sc1
    s_add_u32 s50, s50, 4096
    buffer_load_dwordx4 v[128:131], v6, s[16:19], s50 offen offset:0 sc1
c_wo_run:
    buffer_load_dwordx4 v[132:135], v6, s[16:19], s50 offen offset:256 sc1
    buffer_load_dwordx4 v[136:139], v6, s[16:19], s50 offen offset:2048 sc1
    buffer_load_dwordx4 v[140:143], v6, s[16:19], s50 offen offset:2304 sc1
    s_add_u32 s50, s50, 4096
    s_lshl_b32 s3, s52, 16
    v_add_u32 v12, s3, v12
    v_xor_b32 v13, 32, v12
    v_xor_b32 v14, 64, v12
    v_xor_b32 v15, 96, v12
    s_cmp_eq_u32 s52, 0
    s_mov_b32 s3, 0x0c0c0c0c
    s_cselect_b32 s53, 0x01000c0c, s3
    s_cselect_b32 s54, 0x03020c0c, s3
    s_cselect_b32 s59, s3, 0x01000c0c
    s_cselect_b32 s97, s3, 0x03020c0c
    s_branch wp_5_t
wp_5:
    ds_read_b32 v29, v28
    s_waitcnt lgkmcnt(0)
    v_readfirstlane_b32 s60, v29
    s_lshr_b32 s51, s60, 2
    s_and_b32 s51, s51, s60
    s_and_b32 s51, s51, 3
wp_5_t:
    s_cmp_ge_u32 s60, 0xf0
    s_cbranch_scc0 wp_5
    ds_read_b64_tr_b16 v[64:65], v12 offset:0
    ds_read_b64_tr_b16 v[66:67], v12 offset:1024
    ds_read_b64_tr_b16 v[68:69], v13 offset:0
    ds_read_b64_tr_b16 v[70:71], v13 offset:1024
    ds_read_b64_tr_b16 v[72:73], v14 offset:0
    ds_read_b64_tr_b16 v[74:75], v14 offset:1024
    ds_read_b64_tr_b16 v[76:77], v15 offset:0
    ds_read_b64_tr_b16 v[78:79], v15 offset:1024
    ds_read_b64_tr_b16 v[80:81], v12 offset:4096
    ds_read_b64_tr_b16 v[82:83], v12 offset:5120
    ds_read_b64_tr_b16 v[84:85], v13 offset:4096
    ds_read_b64_tr_b16 v[86:87], v13 offset:5120
    ds_read_b64_tr_b16 v[88:89], v14 offset:4096
    ds_read_b64_tr_b16 v[90:91], v14 offset:5120
    s_waitcnt vmcnt(8)
    v_perm_b32 v32, v96, v96, s53
    v_perm_b32 v33, v96, v96, s54
    v_perm_b32 v34, v97, v97, s53
    v_perm_b32 v35, v97, v97, s54
    v_perm_b32 v36, v98, v98, s53
    v_perm_b32 v37, v98, v98, s54
    v_perm_b32 v38, v99, v99, s53
    v_perm_b32 v39, v99, v99, s54
    v_perm_b32 v40, v100, v100, s53
    v_perm_b32 v41, v100, v100, s54
    v_perm_b32 v42, v101, v101, s53
    v_perm_b32 v43, v101, v101, s54
    v_perm_b32 v44, v102, v102, s53
    v_perm_b32 v45, v102, v102, s54
    v_perm_b32 v46, v103, v103, s53
    v_perm_b32 v47, v103, v103, s54
    v_perm_b32 v48, v104, v104, s53
    v_perm_b32 v49, v104, v104, s54
    v_perm_b32 v50, v105, v105, s53
    v_perm_b32 v51, v105, v105, s54
    v_perm_b32 v52, v106, v106, s53
    v_perm_b32 v53, v106, v106, s54
    v_perm_b32 v54, v107, v107, s53
    v_perm_b32 v55, v107, v107, s54
    v_perm_b32 v56, v108, v108, s53
    v_perm_b32 v57, v108, v108, s54
    v_perm_b32 v58, v109, v109, s53
    v_perm_b32 v59, v109, v109, s54
    v_perm_b32 v60, v110, v110, s53
    v_perm_b32 v61, v110, v110, s54
    v_perm_b32 v62, v111, v111, s53
    v_perm_b32 v63, v111, v111, s54
    buffer_load_dwordx4 v[144:147], v6, s[16:19], s50 offen offset:0 sc1
    buffer_load_dwordx4 v[148:151], v6, s[16:19], s50 offen offset:256 sc1
    buffer_load_dwordx4 v[152:155], v6, s[16:19], s50 offen offset:2048 sc1
    buffer_load_dwordx4 v[156:159], v6, s[16:19], s50 offen offset:2304 sc1
    s_add_u32 s50, s50, 4096
    buffer_load_dwordx4 v[160:163], v6, s[16:19], s50 offen offset:0 sc1
    buffer_load_dwordx4 v[164:167], v6, s[16:19], s50 offen offset:256 sc1
    s_waitcnt vmcnt(12) lgkmcnt(10)
    v_mfma_f32_16x16x32_bf16 v[32:35], v[64:67], v[112:115], v[32:35]
    ds_read_b64_tr_b16 v[92:93], v15 offset:4096
    v_mfma_f32_16x16x32_bf16 v[40:43], v[64:67], v[116:119], v[40:43]
    ds_read_b64_tr_b16 v[94:95], v15 offset:5120
    v_perm_b32 v176, v96, v96, s59
    v_mfma_f32_16x16x32_bf16 v[44:47], v[68:71], v[116:119], v[44:47]
    ds_read_b64_tr_b16 v[64:65], v12 offset:8192
    buffer_load_dwordx4 v[168:171], v6, s[16:19], s50 offen offset:2048 sc1
    v_mfma_f32_16x16x32_bf16 v[36:39], v[68:71], v[112:115], v[36:39]
    ds_read_b64_tr_b16 v[66:67], v12 offset:9216
    v_perm_b32 v177, v96, v96, s97
    s_waitcnt lgkmcnt(10)
    v_mfma_f32_16x16x32_bf16 v[48:51], v[72:75], v[112:115], v[48:51]
    ds_read_b64_tr_b16 v[68:69], v13 offset:8192
    v_mfma_f32_16x16x32_bf16 v[56:59], v[72:75], v[116:119], v[56:59]
    ds_read_b64_tr_b16 v[70:71], v13 offset:9216
    v_perm_b32 v178, v97, v97, s59
    v_mfma_f32_16x16x32_bf16 v[60:63], v[76:79], v[116:119], v[60:63]
    ds_read_b64_tr_b16 v[72:73], v14 offset:8192
    buffer_load_dwordx4 v[172:175], v6, s[16:19], s50 offen offset:2304 sc1
    s_add_u32 s50, s50, 4096
    v_mfma_f32_16x16x32_bf16 v[52:55], v[76:79], v[112:115], v[52:55]
    ds_read_b64_tr_b16 v[74:75], v14 offset:9216
    s_waitcnt vmcnt(12) lgkmcnt(10)
    v_mfma_f32_16x16x32_bf16 v[32:35], v[80:83], v[120:123], v[32:35]
    ds_read_b64_tr_b16 v[76:77], v15 offset:8192
    v_mfma_f32_16x16x32_bf16 v[40:43], v[80:83], v[124:127], v[40:43]
    ds_read_b64_tr_b16 v[78:79], v15 offset:9216
    v_perm_b32 v179, v97, v97, s97
    v_mfma_f32_16x16x32_bf16 v[44:47], v[84:87], v[124:127], v[44:47]
    ds_read_b64_tr_b16 v[80:81], v12 offset:12288
    buffer_load_dwordx4 v[112:115], v6, s[16:19], s50 offen offset:0 sc1
    v_mfma_f32_16x16x32_bf16 v[36:39], v[84:87], v[120:123], v[36:39]
    ds_read_b64_tr_b16 v[82:83], v12 offset:13312
    v_perm_b32 v180, v98, v98, s59
    s_waitcnt lgkmcnt(10)
    v_mfma_f32_16x16x32_bf16 v[48:51], v[88:91], v[120:123], v[48:51]
    ds_read_b64_tr_b16 v[84:85], v13 offset:12288
    v_mfma_f32_16x16x32_bf16 v[56:59], v[88:91], v[124:127], v[56:59]
    ds_read_b64_tr_b16 v[86:87], v13 offset:13312
    v_perm_b32 v181, v98, v98, s97
    v_mfma_f32_16x16x32_bf16 v[60:63], v[92:95], v[124:127], v[60:63]
    ds_read_b64_tr_b16 v[88:89], v14 offset:12288
    buffer_load_dwordx4 v[116:119], v6, s[16:19], s50 offen offset:256 sc1
    v_mfma_f32_16x16x32_bf16 v[52:55], v[92:95], v[120:123], v[52:55]
    ds_read_b64_tr_b16 v[90:91], v14 offset:13312
    s_waitcnt vmcnt(12) lgkmcnt(10)
    v_mfma_f32_16x16x32_bf16 v[32:35], v[64:67], v[128:131], v[32:35]
    ds_read_b64_tr_b16 v[92:93], v15 offset:12288
    v_mfma_f32_16x16x32_bf16 v[40:43], v[64:67], v[132:135], v[40:43]
    ds_read_b64_tr_b16 v[94:95], v15 offset:13312
    v_perm_b32 v182, v99, v99, s59
    v_mfma_f32_16x16x32_bf16 v[44:47], v[68:71], v[132:135], v[44:47]
    ds_read_b64_tr_b16 v[64:65], v12 offset:16384
    buffer_load_dwordx4 v[120:123], v6, s[16:19], s50 offen offset:2048 sc1
    v_mfma_f32_16x16x32_bf16 v[36:39], v[68:71], v[128:131], v[36:39]
    ds_read_b64_tr_b16 v[66:67], v12 offset:17408
    v_perm_b32 v183, v99, v99, s97
    s_waitcnt lgkmcnt(10)
    v_mfma_f32_16x16x32_bf16 v[48:51], v[72:75], v[128:131], v[48:51]
    ds_read_b64_tr_b16 v[68:69], v13 offset:16384
    v_mfma_f32_16x16x32_bf16 v[56:59], v[72:75], v[132:135], v[56:59]
    ds_read_b64_tr_b16 v[70:71], v13 offset:17408
    v_perm_b32 v184, v100, v100, s59
    v_mfma_f32_16x16x32_bf16 v[60:63], v[76:79], v[132:135], v[60:63]
    ds_read_b64_tr_b16 v[72:73], v14 offset:16384
    buffer_load_dwordx4 v[124:127], v6, s[16:19], s50 offen offset:2304 sc1
    s_add_u32 s50, s50, 4096
    v_mfma_f32_16x16x32_bf16 v[52:55], v[76:79], v[128:131], v[52:55]
    ds_read_b64_tr_b16 v[74:75], v14 offset:17408
    s_waitcnt vmcnt(12) lgkmcnt(10)
    v_mfma_f32_16x16x32_bf16 v[32:35], v[80:83], v[136:139], v[32:35]
    ds_read_b64_tr_b16 v[76:77], v15 offset:16384
    v_mfma_f32_16x16x32_bf16 v[40:43], v[80:83], v[140:143], v[40:43]
    ds_read_b64_tr_b16 v[78:79], v15 offset:17408
    v_perm_b32 v185, v100, v100, s97
    v_mfma_f32_16x16x32_bf16 v[44:47], v[84:87], v[140:143], v[44:47]
    ds_read_b64_tr_b16 v[80:81], v12 offset:20480
    buffer_load_dwordx4 v[128:131], v6, s[16:19], s50 offen offset:0 sc1
    v_mfma_f32_16x16x32_bf16 v[36:39], v[84:87], v[136:139], v[36:39]
    ds_read_b64_tr_b16 v[82:83], v12 offset:21504
    v_perm_b32 v186, v101, v101, s59
    s_waitcnt lgkmcnt(10)
    v_mfma_f32_16x16x32_bf16 v[48:51], v[88:91], v[136:139], v[48:51]
    ds_read_b64_tr_b16 v[84:85], v13 offset:20480
    v_mfma_f32_16x16x32_bf16 v[56:59], v[88:91], v[140:143], v[56:59]
    ds_read_b64_tr_b16 v[86:87], v13 offset:21504
    v_perm_b32 v187, v101, v101, s97
    v_mfma_f32_16x16x32_bf16 v[60:63], v[92:95], v[140:143], v[60:63]
    ds_read_b64_tr_b16 v[88:89], v14 offset:20480
    buffer_load_dwordx4 v[132:135], v6, s[16:19], s50 offen offset:256 sc1
    v_mfma_f32_16x16x32_bf16 v[52:55], v[92:95], v[136:139], v[52:55]
    ds_read_b64_tr_b16 v[90:91], v14 offset:21504
    s_waitcnt vmcnt(12) lgkmcnt(10)
    v_mfma_f32_16x16x32_bf16 v[32:35], v[64:67], v[144:147], v[32:35]
    ds_read_b64_tr_b16 v[92:93], v15 offset:20480
    v_mfma_f32_16x16x32_bf16 v[40:43], v[64:67], v[148:151], v[40:43]
    ds_read_b64_tr_b16 v[94:95], v15 offset:21504
    v_perm_b32 v188, v102, v102, s59
    v_mfma_f32_16x16x32_bf16 v[44:47], v[68:71], v[148:151], v[44:47]
    ds_read_b64_tr_b16 v[64:65], v12 offset:24576
    buffer_load_dwordx4 v[136:139], v6, s[16:19], s50 offen offset:2048 sc1
    v_mfma_f32_16x16x32_bf16 v[36:39], v[68:71], v[144:147], v[36:39]
    ds_read_b64_tr_b16 v[66:67], v12 offset:25600
    v_perm_b32 v189, v102, v102, s97
    s_waitcnt lgkmcnt(10)
    v_mfma_f32_16x16x32_bf16 v[48:51], v[72:75], v[144:147], v[48:51]
    ds_read_b64_tr_b16 v[68:69], v13 offset:24576
    v_mfma_f32_16x16x32_bf16 v[56:59], v[72:75], v[148:151], v[56:59]
    ds_read_b64_tr_b16 v[70:71], v13 offset:25600
    v_perm_b32 v190, v103, v103, s59
    v_mfma_f32_16x16x32_bf16 v[60:63], v[76:79], v[148:151], v[60:63]
    ds_read_b64_tr_b16 v[72:73], v14 offset:24576
    buffer_load_dwordx4 v[140:143], v6, s[16:19], s50 offen offset:2304 sc1
    s_add_u32 s50, s50, 4096
    v_mfma_f32_16x16x32_bf16 v[52:55], v[76:79], v[144:147], v[52:55]
    ds_read_b64_tr_b16 v[74:75], v14 offset:25600
    s_waitcnt vmcnt(12) lgkmcnt(10)
    v_mfma_f32_16x16x32_bf16 v[32:35], v[80:83], v[152:155], v[32:35]
    ds_read_b64_tr_b16 v[76:77], v15 offset:24576
    v_mfma_f32_16x16x32_bf16 v[40:43], v[80:83], v[156:159], v[40:43]
    ds_read_b64_tr_b16 v[78:79], v15 offset:25600
    v_perm_b32 v191, v103, v103, s97
    v_mfma_f32_16x16x32_bf16 v[44:47], v[84:87], v[156:159], v[44:47]
    ds_read_b64_tr_b16 v[80:81], v12 offset:28672
    buffer_load_dwordx4 v[144:147], v6, s[16:19], s50 offen offset:0 sc1
    v_mfma_f32_16x16x32_bf16 v[36:39], v[84:87], v[152:155], v[36:39]
    ds_read_b64_tr_b16 v[82:83], v12 offset:29696
    v_perm_b32 v192, v104, v104, s59
    s_waitcnt lgkmcnt(10)
    v_mfma_f32_16x16x32_bf16 v[48:51], v[88:91], v[152:155], v[48:51]
    ds_read_b64_tr_b16 v[84:85], v13 offset:28672
    v_mfma_f32_16x16x32_bf16 v[56:59], v[88:91], v[156:159], v[56:59]
    ds_read_b64_tr_b16 v[86:87], v13 offset:29696
    v_perm_b32 v193, v104, v104, s97
    v_mfma_f32_16x16x32_bf16 v[60:63], v[92:95], v[156:159], v[60:63]
    ds_read_b64_tr_b16 v[88:89], v14 offset:28672
    buffer_load_dwordx4 v[148:151], v6, s[16:19], s50 offen offset:256 sc1
    v_mfma_f32_16x16x32_bf16 v[52:55], v[92:95], v[152:155], v[52:55]
    ds_read_b64_tr_b16 v[90:91], v14 offset:29696
    s_waitcnt vmcnt(12) lgkmcnt(10)
    v_mfma_f32_16x16x32_bf16 v[32:35], v[64:67], v[160:163], v[32:35]
    ds_read_b64_tr_b16 v[92:93], v15 offset:28672
    v_mfma_f32_16x16x32_bf16 v[40:43], v[64:67], v[164:167], v[40:43]
    ds_read_b64_tr_b16 v[94:95], v15 offset:29696
    v_perm_b32 v194, v105, v105, s59
    v_mfma_f32_16x16x32_bf16 v[44:47], v[68:71], v[164:167], v[44:47]
    ds_read_b64_tr_b16 v[64:65], v12 offset:32768
    buffer_load_dwordx4 v[152:155], v6, s[16:19], s50 offen offset:2048 sc1
    v_mfma_f32_16x16x32_bf16 v[36:39], v[68:71], v[160:163], v[36:39]
    ds_read_b64_tr_b16 v[66:67], v12 offset:33792
    v_perm_b32 v195, v105, v105, s97
    s_waitcnt lgkmcnt(10)
    v_mfma_f32_16x16x32_bf16 v[48:51], v[72:75], v[160:163], v[48:51]
    ds_read_b64_tr_b16 v[68:69], v13 offset:32768
    v_mfma_f32_16x16x32_bf16 v[56:59], v[72:75], v[164:167], v[56:59]
    ds_read_b64_tr_b16 v[70:71], v13 offset:33792
    v_perm_b32 v196, v106, v106, s59
    v_mfma_f32_16x16x32_bf16 v[60:63], v[76:79], v[164:167], v[60:63]
    ds_read_b64_tr_b16 v[72:73], v14 offset:32768
    buffer_load_dwordx4 v[156:159], v6, s[16:19], s50 offen offset:2304 sc1
    s_add_u32 s50, s50, 4096
    v_mfma_f32_16x16x32_bf16 v[52:55], v[76:79], v[160:163], v[52:55]
    ds_read_b64_tr_b16 v[74:75], v14 offset:33792
    s_waitcnt vmcnt(12) lgkmcnt(10)
    v_mfma_f32_16x16x32_bf16 v[32:35], v[80:83], v[168:171], v[32:35]
    ds_read_b64_tr_b16 v[76:77], v15 offset:32768
    v_mfma_f32_16x16x32_bf16 v[40:43], v[80:83], v[172:175], v[40:43]
    ds_read_b64_tr_b16 v[78:79], v15 offset:33792
    v_perm_b32 v197, v106, v106, s97
    v_mfma_f32_16x16x32_bf16 v[44:47], v[84:87], v[172:175], v[44:47]
    ds_read_b64_tr_b16 v[80:81], v12 offset:36864
    buffer_load_dwordx4 v[160:163], v6, s[16:19], s50 offen offset:0 sc1
    v_mfma_f32_16x16x32_bf16 v[36:39], v[84:87], v[168:171], v[36:39]
    ds_read_b64_tr_b16 v[82:83], v12 offset:37888
    v_perm_b32 v198, v107, v107, s59
    s_waitcnt lgkmcnt(10)
    v_mfma_f32_16x16x32_bf16 v[48:51], v[88:91], v[168:171], v[48:51]
    ds_read_b64_tr_b16 v[84:85], v13 offset:36864
    v_mfma_f32_16x16x32_bf16 v[56:59], v[88:91], v[172:175], v[56:59]
    ds_read_b64_tr_b16 v[86:87], v13 offset:37888
    v_perm_b32 v199, v107, v107, s97
    v_mfma_f32_16x16x32_bf16 v[60:63], v[92:95], v[172:175], v[60:63]
    ds_read_b64_tr_b16 v[88:89], v14 offset:36864
    buffer_load_dwordx4 v[164:167], v6, s[16:19], s50 offen offset:256 sc1
    v_mfma_f32_16x16x32_bf16 v[52:55], v[92:95], v[168:171], v[52:55]
    ds_read_b64_tr_b16 v[90:91], v14 offset:37888
    s_waitcnt vmcnt(12) lgkmcnt(10)
    v_mfma_f32_16x16x32_bf16 v[32:35], v[64:67], v[112:115], v[32:35]
    ds_read_b64_tr_b16 v[92:93], v15 offset:36864
    v_mfma_f32_16x16x32_bf16 v[40:43], v[64:67], v[116:119], v[40:43]
    ds_read_b64_tr_b16 v[94:95], v15 offset:37888
    v_perm_b32 v200, v108, v108, s59
    v_mfma_f32_16x16x32_bf16 v[44:47], v[68:71], v[116:119], v[44:47]
    ds_read_b64_tr_b16 v[64:65], v12 offset:40960
    buffer_load_dwordx4 v[168:171], v6, s[16:19], s50 offen offset:2048 sc1
    v_mfma_f32_16x16x32_bf16 v[36:39], v[68:71], v[112:115], v[36:39]
    ds_read_b64_tr_b16 v[66:67], v12 offset:41984
    v_perm_b32 v201, v108, v108, s97
    s_waitcnt lgkmcnt(10)
    v_mfma_f32_16x16x32_bf16 v[48:51], v[72:75], v[112:115], v[48:51]
    ds_read_b64_tr_b16 v[68:69], v13 offset:40960
    v_mfma_f32_16x16x32_bf16 v[56:59], v[72:75], v[116:119], v[56:59]
    ds_read_b64_tr_b16 v[70:71], v13 offset:41984
    v_perm_b32 v202, v109, v109, s59
    v_mfma_f32_16x16x32_bf16 v[60:63], v[76:79], v[116:119], v[60:63]
    ds_read_b64_tr_b16 v[72:73], v14 offset:40960
    buffer_load_dwordx4 v[172:175], v6, s[16:19], s50 offen offset:2304 sc1
    s_add_u32 s50, s50, 4096
    v_mfma_f32_16x16x32_bf16 v[52:55], v[76:79], v[112:115], v[52:55]
    ds_read_b64_tr_b16 v[74:75], v14 offset:41984
    s_waitcnt vmcnt(12) lgkmcnt(10)
    v_mfma_f32_16x16x32_bf16 v[32:35], v[80:83], v[120:123], v[32:35]
    ds_read_b64_tr_b16 v[76:77], v15 offset:40960
    v_mfma_f32_16x16x32_bf16 v[40:43], v[80:83], v[124:127], v[40:43]
    ds_read_b64_tr_b16 v[78:79], v15 offset:41984
    v_perm_b32 v203, v109, v109, s97
    v_mfma_f32_16x16x32_bf16 v[44:47], v[84:87], v[124:127], v[44:47]
    ds_read_b64_tr_b16 v[80:81], v12 offset:45056
    s_branch wp_6_t
wp_6:
    ds_read_b32 v29, v28
    s_waitcnt lgkmcnt(0)
    v_readfirstlane_b32 s60, v29
    s_lshr_b32 s51, s60, 2
    s_and_b32 s51, s51, s60
    s_and_b32 s51, s51, 3
wp_6_t:
    s_cmp_eq_u32 s51, 3
    s_cbranch_scc0 wp_6
    s_lshl_b32 s50, s52, 15
    s_xor_b32 s50, s50, 32768
    buffer_load_dwordx4 v[112:115], v6, s[16:19], s50 offen offset:0 sc1
    v_mfma_f32_16x16x32_bf16 v[36:39], v[84:87], v[120:123], v[36:39]
    ds_read_b64_tr_b16 v[82:83], v12 offset:46080
    v_perm_b32 v204, v110, v110, s59
    s_waitcnt lgkmcnt(10)
    v_mfma_f32_16x16x32_bf16 v[48:51], v[88:91], v[120:123], v[48:51]
    ds_read_b64_tr_b16 v[84:85], v13 offset:45056
    v_mfma_f32_16x16x32_bf16 v[56:59], v[88:91], v[124:127], v[56:59]
    ds_read_b64_tr_b16 v[86:87], v13 offset:46080
    v_perm_b32 v205, v110, v110, s97
    v_mfma_f32_16x16x32_bf16 v[60:63], v[92:95], v[124:127], v[60:63]
    ds_read_b64_tr_b16 v[88:89], v14 offset:45056
    buffer_load_dwordx4 v[116:119], v6, s[16:19], s50 offen offset:256 sc1
    v_mfma_f32_16x16x32_bf16 v[52:55], v[92:95], v[120:123], v[52:55]
    ds_read_b64_tr_b16 v[90:91], v14 offset:46080
    s_waitcnt vmcnt(12) lgkmcnt(10)
    v_mfma_f32_16x16x32_bf16 v[32:35], v[64:67], v[128:131], v[32:35]
    ds_read_b64_tr_b16 v[92:93], v15 offset:45056
    v_mfma_f32_16x16x32_bf16 v[40:43], v[64:67], v[132:135], v[40:43]
    ds_read_b64_tr_b16 v[94:95], v15 offset:46080
    v_perm_b32 v206, v111, v111, s59
    v_mfma_f32_16x16x32_bf16 v[44:47], v[68:71], v[132:135], v[44:47]
    ds_read_b64_tr_b16 v[64:65], v12 offset:49152
    buffer_load_dwordx4 v[120:123], v6, s[16:19], s50 offen offset:2048 sc1
    v_mfma_f32_16x16x32_bf16 v[36:39], v[68:71], v[128:131], v[36:39]
    ds_read_b64_tr_b16 v[66:67], v12 offset:50176
    v_perm_b32 v207, v111, v111, s97
    s_waitcnt lgkmcnt(10)
    v_mfma_f32_16x16x32_bf16 v[48:51], v[72:75], v[128:131], v[48:51]
    ds_read_b64_tr_b16 v[68:69], v13 offset:49152
    v_mfma_f32_16x16x32_bf16 v[56:59], v[72:75], v[132:135], v[56:59]
    ds_read_b64_tr_b16 v[70:71], v13 offset:50176
    v_mul_u32_u24 v8, 144, v4
    v_mfma_f32_16x16x32_bf16 v[60:63], v[76:79], v[132:135], v[60:63]
    ds_read_b64_tr_b16 v[72:73], v14 offset:49152
    buffer_load_dwordx4 v[124:127], v6, s[16:19], s50 offen offset:2304 sc1
    s_add_u32 s50, s50, 4096
    v_mfma_f32_16x16x32_bf16 v[52:55], v[76:79], v[128:131], v[52:55]
    ds_read_b64_tr_b16 v[74:75], v14 offset:50176
    s_waitcnt vmcnt(12) lgkmcnt(10)
    v_mfma_f32_16x16x32_bf16 v[32:35], v[80:83], v[136:139], v[32:35]
    ds_read_b64_tr_b16 v[76:77], v15 offset:49152
    v_mfma_f32_16x16x32_bf16 v[40:43], v[80:83], v[140:143], v[40:43]
    ds_read_b64_tr_b16 v[78:79], v15 offset:50176
    v_lshrrev_b32 v11, 4, v1
    v_mfma_f32_16x16x32_bf16 v[44:47], v[84:87], v[140:143], v[44:47]
    ds_read_b64_tr_b16 v[80:81], v12 offset:53248
    buffer_load_dwordx4 v[128:131], v6, s[16:19], s50 offen offset:0 sc1
    v_mfma_f32_16x16x32_bf16 v[36:39], v[84:87], v[136:139], v[36:39]
    ds_read_b64_tr_b16 v[82:83], v12 offset:54272
    v_lshl_add_u32 v8, v11, 3, v8
    s_waitcnt lgkmcnt(10)
    v_mfma_f32_16x16x32_bf16 v[48:51], v[88:91], v[136:139], v[48:51]
    ds_read_b64_tr_b16 v[84:85], v13 offset:53248
    v_mfma_f32_16x16x32_bf16 v[56:59], v[88:91], v[140:143], v[56:59]
    ds_read_b64_tr_b16 v[86:87], v13 offset:54272
    v_mul_u32_u24 v7, 4608, v2
    v_mfma_f32_16x16x32_bf16 v[60:63], v[92:95], v[140:143], v[60:63]
    ds_read_b64_tr_b16 v[88:89], v14 offset:53248
    buffer_load_dwordx4 v[132:135], v6, s[16:19], s50 offen offset:256 sc1
    v_mfma_f32_16x16x32_bf16 v[52:55], v[92:95], v[136:139], v[52:55]
    ds_read_b64_tr_b16 v[90:91], v14 offset:54272
    s_waitcnt vmcnt(12) lgkmcnt(10)
    v_mfma_f32_16x16x32_bf16 v[32:35], v[64:67], v[144:147], v[32:35]
    ds_read_b64_tr_b16 v[92:93], v15 offset:53248
    v_mfma_f32_16x16x32_bf16 v[40:43], v[64:67], v[148:151], v[40:43]
    ds_read_b64_tr_b16 v[94:95], v15 offset:54272
    v_add_u32 v7, 131072, v7
    v_mfma_f32_16x16x32_bf16 v[44:47], v[68:71], v[148:151], v[44:47]
    ds_read_b64_tr_b16 v[64:65], v12 offset:57344
    buffer_load_dwordx4 v[136:139], v6, s[16:19], s50 offen offset:2048 sc1
    v_mfma_f32_16x16x32_bf16 v[36:39], v[68:71], v[144:147], v[36:39]
    ds_read_b64_tr_b16 v[66:67], v12 offset:58368
    v_add_u32 v8, v8, v7
    s_waitcnt lgkmcnt(10)
    v_mfma_f32_16x16x32_bf16 v[48:51], v[72:75], v[144:147], v[48:51]
    ds_read_b64_tr_b16 v[68:69], v13 offset:57344
    v_mfma_f32_16x16x32_bf16 v[56:59], v[72:75], v[148:151], v[56:59]
    ds_read_b64_tr_b16 v[70:71], v13 offset:58368
    v_lshrrev_b32 v10, 3, v1
    v_mfma_f32_16x16x32_bf16 v[60:63], v[76:79], v[148:151], v[60:63]
    ds_read_b64_tr_b16 v[72:73], v14 offset:57344
    buffer_load_dwordx4 v[140:143], v6, s[16:19], s50 offen offset:2304 sc1
    s_add_u32 s50, s50, 4096
    v_mfma_f32_16x16x32_bf16 v[52:55], v[76:79], v[144:147], v[52:55]
    ds_read_b64_tr_b16 v[74:75], v14 offset:58368
    s_waitcnt vmcnt(12) lgkmcnt(10)
    v_mfma_f32_16x16x32_bf16 v[32:35], v[80:83], v[152:155], v[32:35]
    ds_read_b64_tr_b16 v[76:77], v15 offset:57344
    v_mfma_f32_16x16x32_bf16 v[40:43], v[80:83], v[156:159], v[40:43]
    ds_read_b64_tr_b16 v[78:79], v15 offset:58368
    v_and_b32 v11, 7, v1
    v_mfma_f32_16x16x32_bf16 v[44:47], v[84:87], v[156:159], v[44:47]
    ds_read_b64_tr_b16 v[80:81], v12 offset:61440
    buffer_load_dwordx4 v[144:147], v6, s[16:19], s50 offen offset:0 sc1
    v_mfma_f32_16x16x32_bf16 v[36:39], v[84:87], v[152:155], v[36:39]
    ds_read_b64_tr_b16 v[82:83], v12 offset:62464
    v_mul_u32_u24 v9, 144, v10
    s_waitcnt lgkmcnt(10)
    v_mfma_f32_16x16x32_bf16 v[48:51], v[88:91], v[152:155], v[48:51]
    ds_read_b64_tr_b16 v[84:85], v13 offset:61440
    v_mfma_f32_16x16x32_bf16 v[56:59], v[88:91], v[156:159], v[56:59]
    ds_read_b64_tr_b16 v[86:87], v13 offset:62464
    v_lshl_add_u32 v9, v11, 4, v9
    v_mfma_f32_16x16x32_bf16 v[60:63], v[92:95], v[156:159], v[60:63]
    ds_read_b64_tr_b16 v[88:89], v14 offset:61440
    buffer_load_dwordx4 v[148:151], v6, s[16:19], s50 offen offset:256 sc1
    v_mfma_f32_16x16x32_bf16 v[52:55], v[92:95], v[152:155], v[52:55]
    ds_read_b64_tr_b16 v[90:91], v14 offset:62464
    s_waitcnt vmcnt(12) lgkmcnt(10)
    v_mfma_f32_16x16x32_bf16 v[32:35], v[64:67], v[160:163], v[32:35]
    ds_read_b64_tr_b16 v[92:93], v15 offset:61440
    v_mfma_f32_16x16x32_bf16 v[40:43], v[64:67], v[164:167], v[40:43]
    ds_read_b64_tr_b16 v[94:95], v15 offset:62464
    v_add_u32 v9, v9, v7
    v_mfma_f32_16x16x32_bf16 v[44:47], v[68:71], v[164:167], v[44:47]
    v_xor_b32 v12, 0x10000, v12
    ds_read_b64_tr_b16 v[64:65], v12 offset:0
    buffer_load_dwordx4 v[152:155], v6, s[16:19], s50 offen offset:2048 sc1
    v_mfma_f32_16x16x32_bf16 v[36:39], v[68:71], v[160:163], v[36:39]
    ds_read_b64_tr_b16 v[66:67], v12 offset:1024
    v_lshlrev_b32 v10, 11, v10
    s_waitcnt lgkmcnt(10)
    v_mfma_f32_16x16x32_bf16 v[48:51], v[72:75], v[160:163], v[48:51]
    v_xor_b32 v13, 0x10000, v13
    ds_read_b64_tr_b16 v[68:69], v13 offset:0
    v_mfma_f32_16x16x32_bf16 v[56:59], v[72:75], v[164:167], v[56:59]
    ds_read_b64_tr_b16 v[70:71], v13 offset:1024
    v_lshl_add_u32 v10, v11, 4, v10
    v_mfma_f32_16x16x32_bf16 v[60:63], v[76:79], v[164:167], v[60:63]
    v_xor_b32 v14, 0x10000, v14
    ds_read_b64_tr_b16 v[72:73], v14 offset:0
    buffer_load_dwordx4 v[156:159], v6, s[16:19], s50 offen offset:2304 sc1
    s_add_u32 s50, s50, 4096
    v_mfma_f32_16x16x32_bf16 v[52:55], v[76:79], v[160:163], v[52:55]
    ds_read_b64_tr_b16 v[74:75], v14 offset:1024
    s_waitcnt vmcnt(12) lgkmcnt(10)
    v_mfma_f32_16x16x32_bf16 v[32:35], v[80:83], v[168:171], v[32:35]
    v_xor_b32 v15, 0x10000, v15
    ds_read_b64_tr_b16 v[76:77], v15 offset:0
    v_mfma_f32_16x16x32_bf16 v[40:43], v[80:83], v[172:175], v[40:43]
    ds_read_b64_tr_b16 v[78:79], v15 offset:1024
    v_mfma_f32_16x16x32_bf16 v[44:47], v[84:87], v[172:175], v[44:47]
    ds_read_b64_tr_b16 v[80:81], v12 offset:4096
    buffer_load_dwordx4 v[160:163], v6, s[16:19], s50 offen offset:0 sc1
    v_mfma_f32_16x16x32_bf16 v[36:39], v[84:87], v[168:171], v[36:39]
    ds_read_b64_tr_b16 v[82:83], v12 offset:5120
    s_waitcnt lgkmcnt(10)
    v_mfma_f32_16x16x32_bf16 v[48:51], v[88:91], v[168:171], v[48:51]
    ds_read_b64_tr_b16 v[84:85], v13 offset:4096
    v_mfma_f32_16x16x32_bf16 v[56:59], v[88:91], v[172:175], v[56:59]
    ds_read_b64_tr_b16 v[86:87], v13 offset:5120
    v_mfma_f32_16x16x32_bf16 v[60:63], v[92:95], v[172:175], v[60:63]
    ds_read_b64_tr_b16 v[88:89], v14 offset:4096
    buffer_load_dwordx4 v[164:167], v6, s[16:19], s50 offen offset:256 sc1
    v_mfma_f32_16x16x32_bf16 v[52:55], v[92:95], v[168:171], v[52:55]
    ds_read_b64_tr_b16 v[90:91], v14 offset:5120
    s_waitcnt vmcnt(12) lgkmcnt(10)
    v_mfma_f32_16x16x32_bf16 v[176:179], v[64:67], v[112:115], v[176:179]
    ds_read_b64_tr_b16 v[92:93], v15 offset:4096
    v_mfma_f32_16x16x32_bf16 v[184:187], v[64:67], v[116:119], v[184:187]
    ds_read_b64_tr_b16 v[94:95], v15 offset:5120
    v_mfma_f32_16x16x32_bf16 v[188:191], v[68:71], v[116:119], v[188:191]
    ds_read_b64_tr_b16 v[64:65], v12 offset:8192
    buffer_load_dwordx4 v[168:171], v6, s[16:19], s50 offen offset:2048 sc1
    v_mfma_f32_16x16x32_bf16 v[180:183], v[68:71], v[112:115], v[180:183]
    ds_read_b64_tr_b16 v[66:67], v12 offset:9216
    s_waitcnt lgkmcnt(10)
    v_mfma_f32_16x16x32_bf16 v[192:195], v[72:75], v[112:115], v[192:195]
    ds_read_b64_tr_b16 v[68:69], v13 offset:8192
    v_mfma_f32_16x16x32_bf16 v[200:203], v[72:75], v[116:119], v[200:203]
    ds_read_b64_tr_b16 v[70:71], v13 offset:9216
    v_mfma_f32_16x16x32_bf16 v[204:207], v[76:79], v[116:119], v[204:207]
    ds_read_b64_tr_b16 v[72:73], v14 offset:8192
    buffer_load_dwordx4 v[172:175], v6, s[16:19], s50 offen offset:2304 sc1
    s_add_u32 s50, s50, 4096
    v_mfma_f32_16x16x32_bf16 v[196:199], v[76:79], v[112:115], v[196:199]
    ds_read_b64_tr_b16 v[74:75], v14 offset:9216
    s_waitcnt vmcnt(12) lgkmcnt(10)
    v_mfma_f32_16x16x32_bf16 v[176:179], v[80:83], v[120:123], v[176:179]
    ds_read_b64_tr_b16 v[76:77], v15 offset:8192
    v_mfma_f32_16x16x32_bf16 v[184:187], v[80:83], v[124:127], v[184:187]
    ds_read_b64_tr_b16 v[78:79], v15 offset:9216
    v_mfma_f32_16x16x32_bf16 v[188:191], v[84:87], v[124:127], v[188:191]
    ds_read_b64_tr_b16 v[80:81], v12 offset:12288
    buffer_load_dwordx4 v[112:115], v6, s[16:19], s50 offen offset:0 sc1
    v_mfma_f32_16x16x32_bf16 v[180:183], v[84:87], v[120:123], v[180:183]
    ds_read_b64_tr_b16 v[82:83], v12 offset:13312
    s_waitcnt lgkmcnt(10)
    v_mfma_f32_16x16x32_bf16 v[192:195], v[88:91], v[120:123], v[192:195]
    ds_read_b64_tr_b16 v[84:85], v13 offset:12288
    v_mfma_f32_16x16x32_bf16 v[200:203], v[88:91], v[124:127], v[200:203]
    ds_read_b64_tr_b16 v[86:87], v13 offset:13312
    v_mfma_f32_16x16x32_bf16 v[204:207], v[92:95], v[124:127], v[204:207]
    ds_read_b64_tr_b16 v[88:89], v14 offset:12288
    buffer_load_dwordx4 v[116:119], v6, s[16:19], s50 offen offset:256 sc1
    v_mfma_f32_16x16x32_bf16 v[196:199], v[92:95], v[120:123], v[196:199]
    ds_read_b64_tr_b16 v[90:91], v14 offset:13312
    s_waitcnt vmcnt(12) lgkmcnt(10)
    v_mfma_f32_16x16x32_bf16 v[176:179], v[64:67], v[128:131], v[176:179]
    ds_read_b64_tr_b16 v[92:93], v15 offset:12288
    v_mfma_f32_16x16x32_bf16 v[184:187], v[64:67], v[132:135], v[184:187]
    ds_read_b64_tr_b16 v[94:95], v15 offset:13312
    v_mfma_f32_16x16x32_bf16 v[188:191], v[68:71], v[132:135], v[188:191]
    ds_read_b64_tr_b16 v[64:65], v12 offset:16384
    buffer_load_dwordx4 v[120:123], v6, s[16:19], s50 offen offset:2048 sc1
    v_mfma_f32_16x16x32_bf16 v[180:183], v[68:71], v[128:131], v[180:183]
    ds_read_b64_tr_b16 v[66:67], v12 offset:17408
    s_waitcnt lgkmcnt(10)
    v_mfma_f32_16x16x32_bf16 v[192:195], v[72:75], v[128:131], v[192:195]
    ds_read_b64_tr_b16 v[68:69], v13 offset:16384
    v_mfma_f32_16x16x32_bf16 v[200:203], v[72:75], v[132:135], v[200:203]
    ds_read_b64_tr_b16 v[70:71], v13 offset:17408
    v_mfma_f32_16x16x32_bf16 v[204:207], v[76:79], v[132:135], v[204:207]
    ds_read_b64_tr_b16 v[72:73], v14 offset:16384
    buffer_load_dwordx4 v[124:127], v6, s[16:19], s50 offen offset:2304 sc1
    s_add_u32 s50, s50, 4096
    v_mfma_f32_16x16x32_bf16 v[196:199], v[76:79], v[128:131], v[196:199]
    ds_read_b64_tr_b16 v[74:75], v14 offset:17408
    s_waitcnt vmcnt(12) lgkmcnt(10)
    v_mfma_f32_16x16x32_bf16 v[176:179], v[80:83], v[136:139], v[176:179]
    ds_read_b64_tr_b16 v[76:77], v15 offset:16384
    v_mfma_f32_16x16x32_bf16 v[184:187], v[80:83], v[140:143], v[184:187]
    ds_read_b64_tr_b16 v[78:79], v15 offset:17408
    v_mfma_f32_16x16x32_bf16 v[188:191], v[84:87], v[140:143], v[188:191]
    ds_read_b64_tr_b16 v[80:81], v12 offset:20480
    buffer_load_dwordx4 v[128:131], v6, s[16:19], s50 offen offset:0 sc1
    v_mfma_f32_16x16x32_bf16 v[180:183], v[84:87], v[136:139], v[180:183]
    ds_read_b64_tr_b16 v[82:83], v12 offset:21504
    s_waitcnt lgkmcnt(10)
    v_mfma_f32_16x16x32_bf16 v[192:195], v[88:91], v[136:139], v[192:195]
    ds_read_b64_tr_b16 v[84:85], v13 offset:20480
    v_mfma_f32_16x16x32_bf16 v[200:203], v[88:91], v[140:143], v[200:203]
    ds_read_b64_tr_b16 v[86:87], v13 offset:21504
    v_mfma_f32_16x16x32_bf16 v[204:207], v[92:95], v[140:143], v[204:207]
    ds_read_b64_tr_b16 v[88:89], v14 offset:20480
    buffer_load_dwordx4 v[132:135], v6, s[16:19], s50 offen offset:256 sc1
    v_mfma_f32_16x16x32_bf16 v[196:199], v[92:95], v[136:139], v[196:199]
    ds_read_b64_tr_b16 v[90:91], v14 offset:21504
    s_waitcnt vmcnt(12) lgkmcnt(10)
    v_mfma_f32_16x16x32_bf16 v[176:179], v[64:67], v[144:147], v[176:179]
    ds_read_b64_tr_b16 v[92:93], v15 offset:20480
    v_mfma_f32_16x16x32_bf16 v[184:187], v[64:67], v[148:151], v[184:187]
    ds_read_b64_tr_b16 v[94:95], v15 offset:21504
    v_mfma_f32_16x16x32_bf16 v[188:191], v[68:71], v[148:151], v[188:191]
    ds_read_b64_tr_b16 v[64:65], v12 offset:24576
    buffer_load_dwordx4 v[136:139], v6, s[16:19], s50 offen offset:2048 sc1
    v_mfma_f32_16x16x32_bf16 v[180:183], v[68:71], v[144:147], v[180:183]
    ds_read_b64_tr_b16 v[66:67], v12 offset:25600
    s_waitcnt lgkmcnt(10)
    v_mfma_f32_16x16x32_bf16 v[192:195], v[72:75], v[144:147], v[192:195]
    ds_read_b64_tr_b16 v[68:69], v13 offset:24576
    v_mfma_f32_16x16x32_bf16 v[200:203], v[72:75], v[148:151], v[200:203]
    ds_read_b64_tr_b16 v[70:71], v13 offset:25600
    v_mfma_f32_16x16x32_bf16 v[204:207], v[76:79], v[148:151], v[204:207]
    ds_read_b64_tr_b16 v[72:73], v14 offset:24576
    buffer_load_dwordx4 v[140:143], v6, s[16:19], s50 offen offset:2304 sc1
    s_add_u32 s50, s50, 4096
    v_mfma_f32_16x16x32_bf16 v[196:199], v[76:79], v[144:147], v[196:199]
    ds_read_b64_tr_b16 v[74:75], v14 offset:25600
    s_waitcnt vmcnt(12) lgkmcnt(10)
    v_mfma_f32_16x16x32_bf16 v[176:179], v[80:83], v[152:155], v[176:179]
    ds_read_b64_tr_b16 v[76:77], v15 offset:24576
    v_mfma_f32_16x16x32_bf16 v[184:187], v[80:83], v[156:159], v[184:187]
    ds_read_b64_tr_b16 v[78:79], v15 offset:25600
    v_mfma_f32_16x16x32_bf16 v[188:191], v[84:87], v[156:159], v[188:191]
    ds_read_b64_tr_b16 v[80:81], v12 offset:28672
    buffer_load_dwordx4 v[144:147], v6, s[16:19], s50 offen offset:0 sc1
    v_mfma_f32_16x16x32_bf16 v[180:183], v[84:87], v[152:155], v[180:183]
    ds_read_b64_tr_b16 v[82:83], v12 offset:29696
    s_waitcnt lgkmcnt(10)
    v_mfma_f32_16x16x32_bf16 v[192:195], v[88:91], v[152:155], v[192:195]
    ds_read_b64_tr_b16 v[84:85], v13 offset:28672
    v_mfma_f32_16x16x32_bf16 v[200:203], v[88:91], v[156:159], v[200:203]
    ds_read_b64_tr_b16 v[86:87], v13 offset:29696
    v_mfma_f32_16x16x32_bf16 v[204:207], v[92:95], v[156:159], v[204:207]
    ds_read_b64_tr_b16 v[88:89], v14 offset:28672
    buffer_load_dwordx4 v[148:151], v6, s[16:19], s50 offen offset:256 sc1
    v_mfma_f32_16x16x32_bf16 v[196:199], v[92:95], v[152:155], v[196:199]
    ds_read_b64_tr_b16 v[90:91], v14 offset:29696
    s_waitcnt vmcnt(12) lgkmcnt(10)
    v_mfma_f32_16x16x32_bf16 v[176:179], v[64:67], v[160:163], v[176:179]
    ds_read_b64_tr_b16 v[92:93], v15 offset:28672
    v_mfma_f32_16x16x32_bf16 v[184:187], v[64:67], v[164:167], v[184:187]
    ds_read_b64_tr_b16 v[94:95], v15 offset:29696
    v_mfma_f32_16x16x32_bf16 v[188:191], v[68:71], v[164:167], v[188:191]
    ds_read_b64_tr_b16 v[64:65], v12 offset:32768
    buffer_load_dwordx4 v[152:155], v6, s[16:19], s50 offen offset:2048 sc1
    v_mfma_f32_16x16x32_bf16 v[180:183], v[68:71], v[160:163], v[180:183]
    ds_read_b64_tr_b16 v[66:67], v12 offset:33792
    s_waitcnt lgkmcnt(10)
    v_mfma_f32_16x16x32_bf16 v[192:195], v[72:75], v[160:163], v[192:195]
    ds_read_b64_tr_b16 v[68:69], v13 offset:32768
    v_mfma_f32_16x16x32_bf16 v[200:203], v[72:75], v[164:167], v[200:203]
    ds_read_b64_tr_b16 v[70:71], v13 offset:33792
    v_mfma_f32_16x16x32_bf16 v[204:207], v[76:79], v[164:167], v[204:207]
    ds_read_b64_tr_b16 v[72:73], v14 offset:32768
    buffer_load_dwordx4 v[156:159], v6, s[16:19], s50 offen offset:2304 sc1
    s_add_u32 s50, s50, 4096
    v_mfma_f32_16x16x32_bf16 v[196:199], v[76:79], v[160:163], v[196:199]
    ds_read_b64_tr_b16 v[74:75], v14 offset:33792
    s_waitcnt vmcnt(12) lgkmcnt(10)
    v_mfma_f32_16x16x32_bf16 v[176:179], v[80:83], v[168:171], v[176:179]
    ds_read_b64_tr_b16 v[76:77], v15 offset:32768
    v_mfma_f32_16x16x32_bf16 v[184:187], v[80:83], v[172:175], v[184:187]
    ds_read_b64_tr_b16 v[78:79], v15 offset:33792
    v_mfma_f32_16x16x32_bf16 v[188:191], v[84:87], v[172:175], v[188:191]
    ds_read_b64_tr_b16 v[80:81], v12 offset:36864
    buffer_load_dwordx4 v[160:163], v6, s[16:19], s50 offen offset:0 sc1
    v_mfma_f32_16x16x32_bf16 v[180:183], v[84:87], v[168:171], v[180:183]
    ds_read_b64_tr_b16 v[82:83], v12 offset:37888
    s_waitcnt lgkmcnt(10)
    v_mfma_f32_16x16x32_bf16 v[192:195], v[88:91], v[168:171], v[192:195]
    ds_read_b64_tr_b16 v[84:85], v13 offset:36864
    v_mfma_f32_16x16x32_bf16 v[200:203], v[88:91], v[172:175], v[200:203]
    ds_read_b64_tr_b16 v[86:87], v13 offset:37888
    v_mfma_f32_16x16x32_bf16 v[204:207], v[92:95], v[172:175], v[204:207]
    ds_read_b64_tr_b16 v[88:89], v14 offset:36864
    buffer_load_dwordx4 v[164:167], v6, s[16:19], s50 offen offset:256 sc1
    v_mfma_f32_16x16x32_bf16 v[196:199], v[92:95], v[168:171], v[196:199]
    ds_read_b64_tr_b16 v[90:91], v14 offset:37888
    s_waitcnt vmcnt(12) lgkmcnt(10)
    v_mfma_f32_16x16x32_bf16 v[176:179], v[64:67], v[112:115], v[176:179]
    ds_read_b64_tr_b16 v[92:93], v15 offset:36864
    v_mfma_f32_16x16x32_bf16 v[184:187], v[64:67], v[116:119], v[184:187]
    ds_read_b64_tr_b16 v[94:95], v15 offset:37888
    v_mfma_f32_16x16x32_bf16 v[188:191], v[68:71], v[116:119], v[188:191]
    ds_read_b64_tr_b16 v[64:65], v12 offset:40960
    buffer_load_dwordx4 v[168:171], v6, s[16:19], s50 offen offset:2048 sc1
    v_mfma_f32_16x16x32_bf16 v[180:183], v[68:71], v[112:115], v[180:183]
    ds_read_b64_tr_b16 v[66:67], v12 offset:41984
    s_waitcnt lgkmcnt(10)
    v_mfma_f32_16x16x32_bf16 v[192:195], v[72:75], v[112:115], v[192:195]
    ds_read_b64_tr_b16 v[68:69], v13 offset:40960
    v_mfma_f32_16x16x32_bf16 v[200:203], v[72:75], v[116:119], v[200:203]
    ds_read_b64_tr_b16 v[70:71], v13 offset:41984
    v_mfma_f32_16x16x32_bf16 v[204:207], v[76:79], v[116:119], v[204:207]
    ds_read_b64_tr_b16 v[72:73], v14 offset:40960
    buffer_load_dwordx4 v[172:175], v6, s[16:19], s50 offen offset:2304 sc1
    s_add_u32 s50, s50, 4096
    v_mfma_f32_16x16x32_bf16 v[196:199], v[76:79], v[112:115], v[196:199]
    ds_read_b64_tr_b16 v[74:75], v14 offset:41984
    s_waitcnt vmcnt(12) lgkmcnt(10)
    v_mfma_f32_16x16x32_bf16 v[176:179], v[80:83], v[120:123], v[176:179]
    ds_read_b64_tr_b16 v[76:77], v15 offset:40960
    v_mfma_f32_16x16x32_bf16 v[184:187], v[80:83], v[124:127], v[184:187]
    ds_read_b64_tr_b16 v[78:79], v15 offset:41984
    v_mfma_f32_16x16x32_bf16 v[188:191], v[84:87], v[124:127], v[188:191]
    ds_read_b64_tr_b16 v[80:81], v12 offset:45056
    v_mfma_f32_16x16x32_bf16 v[180:183], v[84:87], v[120:123], v[180:183]
    ds_read_b64_tr_b16 v[82:83], v12 offset:46080
    s_waitcnt lgkmcnt(10)
    v_mfma_f32_16x16x32_bf16 v[192:195], v[88:91], v[120:123], v[192:195]
    ds_read_b64_tr_b16 v[84:85], v13 offset:45056
    v_mfma_f32_16x16x32_bf16 v[200:203], v[88:91], v[124:127], v[200:203]
    ds_read_b64_tr_b16 v[86:87], v13 offset:46080
    v_mfma_f32_16x16x32_bf16 v[204:207], v[92:95], v[124:127], v[204:207]
    ds_read_b64_tr_b16 v[88:89], v14 offset:45056
    v_mfma_f32_16x16x32_bf16 v[196:199], v[92:95], v[120:123], v[196:199]
    ds_read_b64_tr_b16 v[90:91], v14 offset:46080
    s_waitcnt vmcnt(10) lgkmcnt(10)
    v_mfma_f32_16x16x32_bf16 v[176:179], v[64:67], v[128:131], v[176:179]
    ds_read_b64_tr_b16 v[92:93], v15 offset:45056
    v_mfma_f32_16x16x32_bf16 v[184:187], v[64:67], v[132:135], v[184:187]
    ds_read_b64_tr_b16 v[94:95], v15 offset:46080
    v_mfma_f32_16x16x32_bf16 v[188:191], v[68:71], v[132:135], v[188:191]
    ds_read_b64_tr_b16 v[64:65], v12 offset:49152
    v_mfma_f32_16x16x32_bf16 v[180:183], v[68:71], v[128:131], v[180:183]
    ds_read_b64_tr_b16 v[66:67], v12 offset:50176
    s_waitcnt lgkmcnt(10)
    v_mfma_f32_16x16x32_bf16 v[192:195], v[72:75], v[128:131], v[192:195]
    ds_read_b64_tr_b16 v[68:69], v13 offset:49152
    v_mfma_f32_16x16x32_bf16 v[200:203], v[72:75], v[132:135], v[200:203]
    ds_read_b64_tr_b16 v[70:71], v13 offset:50176
    v_mfma_f32_16x16x32_bf16 v[204:207], v[76:79], v[132:135], v[204:207]
    ds_read_b64_tr_b16 v[72:73], v14 offset:49152
    v_mfma_f32_16x16x32_bf16 v[196:199], v[76:79], v[128:131], v[196:199]
    ds_read_b64_tr_b16 v[74:75], v14 offset:50176
    s_waitcnt vmcnt(8) lgkmcnt(10)
    v_mfma_f32_16x16x32_bf16 v[176:179], v[80:83], v[136:139], v[176:179]
    ds_read_b64_tr_b16 v[76:77], v15 offset:49152
    v_mfma_f32_16x16x32_bf16 v[184:187], v[80:83], v[140:143], v[184:187]
    ds_read_b64_tr_b16 v[78:79], v15 offset:50176
    v_mfma_f32_16x16x32_bf16 v[188:191], v[84:87], v[140:143], v[188:191]
    ds_read_b64_tr_b16 v[80:81], v12 offset:53248
    v_mfma_f32_16x16x32_bf16 v[180:183], v[84:87], v[136:139], v[180:183]
    ds_read_b64_tr_b16 v[82:83], v12 offset:54272
    s_waitcnt lgkmcnt(10)
    v_mfma_f32_16x16x32_bf16 v[192:195], v[88:91], v[136:139], v[192:195]
    ds_read_b64_tr_b16 v[84:85], v13 offset:53248
    v_mfma_f32_16x16x32_bf16 v[200:203], v[88:91], v[140:143], v[200:203]
    ds_read_b64_tr_b16 v[86:87], v13 offset:54272
    v_mfma_f32_16x16x32_bf16 v[204:207], v[92:95], v[140:143], v[204:207]
    ds_read_b64_tr_b16 v[88:89], v14 offset:53248
    v_mfma_f32_16x16x32_bf16 v[196:199], v[92:95], v[136:139], v[196:199]
    ds_read_b64_tr_b16 v[90:91], v14 offset:54272
    s_waitcnt vmcnt(6) lgkmcnt(10)
    v_mfma_f32_16x16x32_bf16 v[176:179], v[64:67], v[144:147], v[176:179]
    ds_read_b64_tr_b16 v[92:93], v15 offset:53248
    v_mfma_f32_16x16x32_bf16 v[184:187], v[64:67], v[148:151], v[184:187]
    ds_read_b64_tr_b16 v[94:95], v15 offset:54272
    v_mfma_f32_16x16x32_bf16 v[188:191], v[68:71], v[148:151], v[188:191]
    ds_read_b64_tr_b16 v[64:65], v12 offset:57344
    v_mfma_f32_16x16x32_bf16 v[180:183], v[68:71], v[144:147], v[180:183]
    ds_read_b64_tr_b16 v[66:67], v12 offset:58368
    s_waitcnt lgkmcnt(10)
    v_mfma_f32_16x16x32_bf16 v[192:195], v[72:75], v[144:147], v[192:195]
    ds_read_b64_tr_b16 v[68:69], v13 offset:57344
    v_mfma_f32_16x16x32_bf16 v[200:203], v[72:75], v[148:151], v[200:203]
    ds_read_b64_tr_b16 v[70:71], v13 offset:58368
    v_mfma_f32_16x16x32_bf16 v[204:207], v[76:79], v[148:151], v[204:207]
    ds_read_b64_tr_b16 v[72:73], v14 offset:57344
    v_mfma_f32_16x16x32_bf16 v[196:199], v[76:79], v[144:147], v[196:199]
    ds_read_b64_tr_b16 v[74:75], v14 offset:58368
    s_waitcnt vmcnt(4) lgkmcnt(10)
    v_mfma_f32_16x16x32_bf16 v[176:179], v[80:83], v[152:155], v[176:179]
    ds_read_b64_tr_b16 v[76:77], v15 offset:57344
    v_mfma_f32_16x16x32_bf16 v[184:187], v[80:83], v[156:159], v[184:187]
    ds_read_b64_tr_b16 v[78:79], v15 offset:58368
    v_mfma_f32_16x16x32_bf16 v[188:191], v[84:87], v[156:159], v[188:191]
    ds_read_b64_tr_b16 v[80:81], v12 offset:61440
    v_mfma_f32_16x16x32_bf16 v[180:183], v[84:87], v[152:155], v[180:183]
    ds_read_b64_tr_b16 v[82:83], v12 offset:62464
    s_waitcnt lgkmcnt(10)
    v_mfma_f32_16x16x32_bf16 v[192:195], v[88:91], v[152:155], v[192:195]
    ds_read_b64_tr_b16 v[84:85], v13 offset:61440
    v_mfma_f32_16x16x32_bf16 v[200:203], v[88:91], v[156:159], v[200:203]
    ds_read_b64_tr_b16 v[86:87], v13 offset:62464
    v_mfma_f32_16x16x32_bf16 v[204:207], v[92:95], v[156:159], v[204:207]
    ds_read_b64_tr_b16 v[88:89], v14 offset:61440
    v_mfma_f32_16x16x32_bf16 v[196:199], v[92:95], v[152:155], v[196:199]
    ds_read_b64_tr_b16 v[90:91], v14 offset:62464
    s_waitcnt vmcnt(2) lgkmcnt(10)
    v_mfma_f32_16x16x32_bf16 v[176:179], v[64:67], v[160:163], v[176:179]
    ds_read_b64_tr_b16 v[92:93], v15 offset:61440
    v_mfma_f32_16x16x32_bf16 v[184:187], v[64:67], v[164:167], v[184:187]
    ds_read_b64_tr_b16 v[94:95], v15 offset:62464
    v_mfma_f32_16x16x32_bf16 v[188:191], v[68:71], v[164:167], v[188:191]
    v_mfma_f32_16x16x32_bf16 v[180:183], v[68:71], v[160:163], v[180:183]
    s_waitcnt lgkmcnt(8)
    v_mfma_f32_16x16x32_bf16 v[192:195], v[72:75], v[160:163], v[192:195]
    v_mfma_f32_16x16x32_bf16 v[200:203], v[72:75], v[164:167], v[200:203]
    v_mfma_f32_16x16x32_bf16 v[204:207], v[76:79], v[164:167], v[204:207]
    v_mfma_f32_16x16x32_bf16 v[196:199], v[76:79], v[160:163], v[196:199]
    s_waitcnt vmcnt(0) lgkmcnt(4)
    v_mfma_f32_16x16x32_bf16 v[176:179], v[80:83], v[168:171], v[176:179]
    v_mfma_f32_16x16x32_bf16 v[184:187], v[80:83], v[172:175], v[184:187]
    v_mfma_f32_16x16x32_bf16 v[188:191], v[84:87], v[172:175], v[188:191]
    v_mfma_f32_16x16x32_bf16 v[180:183], v[84:87], v[168:171], v[180:183]
    s_waitcnt lgkmcnt(0)
    v_mfma_f32_16x16x32_bf16 v[192:195], v[88:91], v[168:171], v[192:195]
    v_mfma_f32_16x16x32_bf16 v[200:203], v[88:91], v[172:175], v[200:203]
    v_mfma_f32_16x16x32_bf16 v[204:207], v[92:95], v[172:175], v[204:207]
    v_mfma_f32_16x16x32_bf16 v[196:199], v[92:95], v[168:171], v[196:199]
    s_cmp_eq_u32 s9, 3
    s_cbranch_scc1 c_wo_fin
    s_add_u32 s58, s58, 4194304
    v_pk_add_f32 v[32:33], v[32:33], v[176:177]
    v_pk_add_f32 v[34:35], v[34:35], v[178:179]
    v_pk_add_f32 v[36:37], v[36:37], v[180:181]
    v_pk_add_f32 v[38:39], v[38:39], v[182:183]
    v_cvt_pk_bf16_f32 v96, v32, v33
    v_cvt_pk_bf16_f32 v97, v34, v35
    v_cvt_pk_bf16_f32 v98, v36, v37
    v_cvt_pk_bf16_f32 v99, v38, v39
    buffer_store_dwordx4 v[96:99], v6, s[12:15], s58 offen offset:0 sc1
    v_pk_add_f32 v[40:41], v[40:41], v[184:185]
    v_pk_add_f32 v[42:43], v[42:43], v[186:187]
    v_pk_add_f32 v[44:45], v[44:45], v[188:189]
    v_pk_add_f32 v[46:47], v[46:47], v[190:191]
    v_cvt_pk_bf16_f32 v100, v40, v41
    v_cvt_pk_bf16_f32 v101, v42, v43
    v_cvt_pk_bf16_f32 v102, v44, v45
    v_cvt_pk_bf16_f32 v103, v46, v47
    buffer_store_dwordx4 v[100:103], v6, s[12:15], s58 offen offset:256 sc1
    v_pk_add_f32 v[48:49], v[48:49], v[192:193]
    v_pk_add_f32 v[50:51], v[50:51], v[194:195]
    v_pk_add_f32 v[52:53], v[52:53], v[196:197]
    v_pk_add_f32 v[54:55], v[54:55], v[198:199]
    v_cvt_pk_bf16_f32 v104, v48, v49
    v_cvt_pk_bf16_f32 v105, v50, v51
    v_cvt_pk_bf16_f32 v106, v52, v53
    v_cvt_pk_bf16_f32 v107, v54, v55
    buffer_store_dwordx4 v[104:107], v6, s[12:15], s58 offen offset:2048 sc1
    v_pk_add_f32 v[56:57], v[56:57], v[200:201]
    v_pk_add_f32 v[58:59], v[58:59], v[202:203]
    v_pk_add_f32 v[60:61], v[60:61], v[204:205]
    v_pk_add_f32 v[62:63], v[62:63], v[206:207]
    v_cvt_pk_bf16_f32 v108, v56, v57
    v_cvt_pk_bf16_f32 v109, v58, v59
    v_cvt_pk_bf16_f32 v110, v60, v61
    v_cvt_pk_bf16_f32 v111, v62, v63
    buffer_store_dwordx4 v[108:111], v6, s[12:15], s58 offen offset:2304 sc1
    s_barrier
c_wo_stat:
    s_mov_b32 s55, 0x3f803f80
    v_dot2_f32_bf16 v18, v96, s55, 0
    v_dot2_f32_bf16 v19, v96, v96, 0
    v_dot2_f32_bf16 v20, v100, s55, 0
    v_dot2_f32_bf16 v21, v100, v100, 0
    v_dot2_f32_bf16 v18, v97, s55, v18
    v_dot2_f32_bf16 v19, v97, v97, v19
    v_dot2_f32_bf16 v20, v101, s55, v20
    v_dot2_f32_bf16 v21, v101, v101, v21
    v_dot2_f32_bf16 v18, v98, s55, v18
    v_dot2_f32_bf16 v19, v98, v98, v19
    v_dot2_f32_bf16 v20, v102, s55, v20
    v_dot2_f32_bf16 v21, v102, v102, v21
    v_dot2_f32_bf16 v18, v99, s55, v18
    v_dot2_f32_bf16 v19, v99, v99, v19
    v_dot2_f32_bf16 v20, v103, s55, v20
    v_dot2_f32_bf16 v21, v103, v103, v21
    v_dot2_f32_bf16 v18, v104, s55, v18
    v_dot2_f32_bf16 v19, v104, v104, v19
    v_dot2_f32_bf16 v20, v108, s55, v20
    v_dot2_f32_bf16 v21, v108, v108, v21
    v_dot2_f32_bf16 v18, v105, s55, v18
    v_dot2_f32_bf16 v19, v105, v105, v19
    v_dot2_f32_bf16 v20, v109, s55, v20
    v_dot2_f32_bf16 v21, v109, v109, v21
    v_dot2_f32_bf16 v18, v106, s55, v18
    v_dot2_f32_bf16 v19, v106, v106, v19
    v_dot2_f32_bf16 v20, v110, s55, v20
    v_dot2_f32_bf16 v21, v110, v110, v21
    v_dot2_f32_bf16 v18, v107, s55, v18
    v_dot2_f32_bf16 v19, v107, v107, v19
    v_dot2_f32_bf16 v20, v111, s55, v20
    v_dot2_f32_bf16 v21, v111, v111, v21
    v_lshlrev_b32 v16, 3, v1
    s_lshl_b32 s3, s48, 12
    s_lshl_b32 s55, s7, 8
    s_add_u32 s3, s3, s55
    v_permlane16_swap_b32 v18, v20
    v_permlane16_swap_b32 v19, v21
    s_lshl_b32 s55, s9, 18
    v_pk_add_f32 v[18:19], v[18:19], v[20:21]
    s_add_u32 s3, s3, s55
    s_add_u32 s3, s3, 63176704
    v_permlane32_swap_b32 v18, v20
    v_permlane32_swap_b32 v19, v21
    v_pk_add_f32 v[18:19], v[18:19], v[20:21]
    s_mov_b32 exec_hi, 0
    buffer_store_dwordx2 v[18:19], v16, s[12:15], s3 offen sc1
    s_mov_b64 exec, -1
    s_cmp_lg_u32 s9, -1
    s_cbranch_scc1 c_wo_pub
    v_mov_b32 v24, 159492
non_7:
    ds_read_b32 v25, v24
    s_waitcnt lgkmcnt(0)
    v_readfirstlane_b32 s10, v25
    s_cmp_eq_u32 s10, 0
    s_cbranch_scc1 non_7
c_wo_pub:
    s_mul_i32 s55, s9, 786432
    s_add_u32 s55, s55, 66060288
    v_and_b32 v24, 63, v0
    s_and_b32 s56, s11, 0xe0
    v_lshrrev_b32 v25, 5, v24
    v_add_u32 v24, s56, v24
    v_and_b32 v24, 255, v24
    v_lshlrev_b32 v24, 10, v24
    v_lshl_add_u32 v24, v25, 8, v24
    s_bfe_u32 s56, s11, 0x20003
    s_and_b32 s57, s11, 7
    s_lshl_b32 s56, s56, 7
    s_lshl_b32 s57, s57, 2
    s_add_u32 s55, s55, s56
    s_add_u32 s55, s55, s57
    s_and_b32 s57, s6, s9
    s_bfe_i32 s57, s57, 0x10000
    v_mov_b32 v25, 159488
    v_mov_b32 v26, 1
    v_mov_b32 v27, s10
    s_mov_b64 exec, 1
    s_waitcnt vmcnt(0)
    ds_add_rtn_u32 v26, v25, v26
    s_waitcnt lgkmcnt(0)
    v_readfirstlane_b32 s56, v26
    s_and_b32 s56, s56, 3
    s_cmp_lg_u32 s56, 3
    s_cbranch_scc1 pub_8
    s_mov_b32 exec_lo, -1
    s_mov_b32 exec_hi, s57
    buffer_store_dword v27, v24, s[12:15], s55 offen sc1
pub_8:
    s_mov_b64 exec, -1
    s_cmp_eq_u32 s9, -1
    s_cbranch_scc1 c_wo_pub3
    s_barrier
c_wo_pub3:
    s_add_u32 s9, s9, 1
    s_bitcmp1_b32 s9, 0
    s_cbranch_scc1 c_qkvB
    s_branch c_qkvA
c_wo_fin:
    s_mov_b32 s28, s44
    s_mov_b32 s29, s45
    s_mov_b32 s30, 4194304
    s_mov_b32 s31, 0x00020000
    s_lshl_b32 s3, s48, 16
    s_lshl_b32 s55, s7, 7
    s_add_u32 s3, s3, s55
    v_pk_add_f32 v[32:33], v[32:33], v[176:177]
    v_pk_add_f32 v[34:35], v[34:35], v[178:179]
    v_pk_add_f32 v[36:37], v[36:37], v[180:181]
    v_pk_add_f32 v[38:39], v[38:39], v[182:183]
    v_cvt_pk_bf16_f32 v96, v32, v33
    v_cvt_pk_bf16_f32 v97, v34, v35
    v_cvt_pk_bf16_f32 v98, v36, v37
    v_cvt_pk_bf16_f32 v99, v38, v39
    ds_write_b64 v8, v[96:97] offset:0
    ds_write_b64 v8, v[98:99] offset:32
    v_pk_add_f32 v[40:41], v[40:41], v[184:185]
    v_pk_add_f32 v[42:43], v[42:43], v[186:187]
    v_pk_add_f32 v[44:45], v[44:45], v[188:189]
    v_pk_add_f32 v[46:47], v[46:47], v[190:191]
    v_cvt_pk_bf16_f32 v100, v40, v41
    v_cvt_pk_bf16_f32 v101, v42, v43
    v_cvt_pk_bf16_f32 v102, v44, v45
    v_cvt_pk_bf16_f32 v103, v46, v47
    ds_write_b64 v8, v[100:101] offset:2304
    ds_write_b64 v8, v[102:103] offset:2336
    v_pk_add_f32 v[48:49], v[48:49], v[192:193]
    v_pk_add_f32 v[50:51], v[50:51], v[194:195]
    v_pk_add_f32 v[52:53], v[52:53], v[196:197]
    v_pk_add_f32 v[54:55], v[54:55], v[198:199]
    v_cvt_pk_bf16_f32 v104, v48, v49
    v_cvt_pk_bf16_f32 v105, v50, v51
    v_cvt_pk_bf16_f32 v106, v52, v53
    v_cvt_pk_bf16_f32 v107, v54, v55
    ds_write_b64 v8, v[104:105] offset:64
    ds_write_b64 v8, v[106:107] offset:96
    v_pk_add_f32 v[56:57], v[56:57], v[200:201]
    v_pk_add_f32 v[58:59], v[58:59], v[202:203]
    v_pk_add_f32 v[60:61], v[60:61], v[204:205]
    v_pk_add_f32 v[62:63], v[62:63], v[206:207]
    v_cvt_pk_bf16_f32 v108, v56, v57
    v_cvt_pk_bf16_f32 v109, v58, v59
    v_cvt_pk_bf16_f32 v110, v60, v61
    v_cvt_pk_bf16_f32 v111, v62, v63
    ds_write_b64 v8, v[108:109] offset:2368
    ds_write_b64 v8, v[110:111] offset:2400
    s_waitcnt lgkmcnt(0)
    ds_read_b128 v[32:35], v9 offset:0
    ds_read_b128 v[36:39], v9 offset:1152
    ds_read_b128 v[40:43], v9 offset:2304
    ds_read_b128 v[44:47], v9 offset:3456
    s_waitcnt lgkmcnt(3)
    buffer_store_dwordx4 v[32:35], v10, s[28:31], s3 offen sc1
    s_add_u32 s3, s3, 16384
    s_waitcnt lgkmcnt(2)
    buffer_store_dwordx4 v[36:39], v10, s[28:31], s3 offen sc1
    s_add_u32 s3, s3, 16384
    s_waitcnt lgkmcnt(1)
    buffer_store_dwordx4 v[40:43], v10, s[28:31], s3 offen sc1
    s_add_u32 s3, s3, 16384
    s_waitcnt lgkmcnt(0)
    buffer_store_dwordx4 v[44:47], v10, s[28:31], s3 offen sc1
    s_add_u32 s3, s3, 16384
    s_branch k_exit
c_prep_tail:
    s_lshl_b32 s56, s7, 12
    s_add_u32 s58, s55, s56
    s_lshl_b32 s3, s8, 12
    s_add_u32 s3, s3, 131072
    v_lshrrev_b32 v18, 2, v17
    v_and_b32 v19, 1, v17
    v_lshl_add_u32 v18, v18, 1, v19
    v_lshlrev_b32 v18, 10, v18
    v_lshl_add_u32 v18, v16, 4, v18
    v_bfe_u32 v17, v17, 1, 1
    v_lshl_add_u32 v18, v17, 3, v18
    v_add_u32 v18, s3, v18
    v_and_b32 v16, 15, v1
    v_bfe_u32 v17, v1, 4, 1
    v_lshl_add_u32 v6, v17, 5, v16
    v_lshlrev_b32 v6, 4, v6
    v_lshrrev_b32 v17, 5, v1
    v_lshl_add_u32 v6, v17, 10, v6
    v_add_u32 v19, s3, v6
    s_waitcnt vmcnt(3)
    ds_write_b64 v18, v[32:33] offset:0
    ds_write_b64 v18, v[34:35] offset:512
    s_waitcnt vmcnt(2)
    ds_write_b64 v18, v[36:37] offset:128
    ds_write_b64 v18, v[38:39] offset:640
    s_waitcnt vmcnt(1)
    ds_write_b64 v18, v[40:41] offset:256
    ds_write_b64 v18, v[42:43] offset:768
    s_waitcnt vmcnt(0)
    ds_write_b64 v18, v[44:45] offset:384
    ds_write_b64 v18, v[46:47] offset:896
    s_waitcnt lgkmcnt(0)
    ds_read_b128 v[96:99], v19 offset:0
    ds_read_b128 v[100:103], v19 offset:256
    ds_read_b128 v[104:107], v19 offset:2048
    ds_read_b128 v[108:111], v19 offset:2304
    s_waitcnt lgkmcnt(3)
    buffer_store_dwordx4 v[96:99], v6, s[12:15], s58 offen offset:0 sc1
    s_waitcnt lgkmcnt(2)
    buffer_store_dwordx4 v[100:103], v6, s[12:15], s58 offen offset:256 sc1
    s_waitcnt lgkmcnt(1)
    buffer_store_dwordx4 v[104:107], v6, s[12:15], s58 offen offset:2048 sc1
    s_waitcnt lgkmcnt(0)
    buffer_store_dwordx4 v[108:111], v6, s[12:15], s58 offen offset:2304 sc1
    s_branch c_wo_stat
.p2align 6
c_qkvB:
    v_and_b32 v1, 63, v0
    v_lshrrev_b32 v2, 6, v0
    v_lshlrev_b32 v5, 4, v1
    v_lshrrev_b32 v3, 5, v1
    v_and_b32 v4, 15, v0
    v_bfe_u32 v7, v1, 4, 1
    v_lshl_add_u32 v6, v7, 5, v4
    v_lshlrev_b32 v6, 4, v6
    v_lshl_add_u32 v6, v3, 10, v6
    s_lshr_b32 s48, s6, 1
    s_lshl_b32 s48, s48, 2
    s_add_u32 s48, s48, s8
    s_lshl_b32 s55, s48, 17
    s_lshl_b32 s56, s9, 22
    s_add_u32 s55, s55, s56
    s_add_u32 s16, s4, s55
    s_addc_u32 s17, s5, 0
    s_mov_b32 s18, 65536
    s_mov_b32 s19, 0x00020000
    s_add_u32 s56, s55, 65536
    s_add_u32 s20, s4, s56
    s_addc_u32 s21, s5, 0
    s_mov_b32 s22, 65536
    s_mov_b32 s23, 0x00020000
    s_lshl_b32 s49, s7, 12
    s_add_u32 s49, s49, s55
    s_and_b32 s56, s6, 1
    s_lshl_b32 s56, s56, 11
    s_add_u32 s49, s49, s56
    s_add_u32 s49, s49, 16777216
    s_movk_i32 s54, 4096
    v_lshrrev_b32 v16, 2, v4
    v_lshl_add_u32 v18, v7, 2, v16
    v_lshl_add_u32 v18, v3, 4, v18
    v_lshlrev_b32 v18, 6, v18
    v_and_b32 v17, 3, v4
    v_lshl_add_u32 v18, v17, 3, v18
    v_lshl_add_u32 v26, v7, 5, v18
    v_xor_b32 v27, 32, v26
    v_mov_b32 v24, v26
    v_mov_b32 v25, v27
    v_and_b32 v18, 0x30, v1
    v_add_u32 v10, 155648, v18
    v_lshlrev_b32 v11, 2, v4
    v_add_u32 v11, 155648, v11
    v_lshl_add_u32 v8, v2, 8, v11
    v_lshl_add_u32 v9, v2, 8, v10
    s_lshr_b32 s3, s8, 1
    s_and_b32 s55, s8, 1
    s_lshl_b32 s3, s3, 14
    s_lshl_b32 s55, s55, 12
    s_add_u32 s3, s3, s55
    s_add_u32 s3, s3, 81920
    v_lshl_add_u32 v12, v3, 5, v4
    v_lshlrev_b32 v12, 4, v12
    v_lshl_add_u32 v12, v7, 10, v12
    v_add_u32 v12, s3, v12
    v_add_u32 v13, s3, v5
    s_lshr_b32 s84, s9, 1
    s_lshl_b32 s84, s84, 23
    s_lshl_b32 s3, s7, 19
    s_add_u32 s84, s84, s3
    s_and_b32 s3, s6, 1
    s_lshl_b32 s3, s3, 18
    s_add_u32 s84, s84, s3
    s_add_u32 s84, s84, 33554432
    s_lshr_b32 s86, s6, 1
    s_lshl_b32 s3, s86, 15
    s_add_u32 s84, s84, s3
    s_sub_u32 s84, s84, 81920
    s_add_u32 s85, s84, 8192
    s_mul_i32 s53, s9, 786432
    s_add_u32 s53, s53, 66322432
    s_and_b32 s3, s11, 31
    s_lshl_b32 s3, s3, 10
    s_add_u32 s53, s53, s3
    s_lshr_b32 s3, s86, 1
    s_lshl_b32 s3, s3, 7
    s_add_u32 s53, s53, s3
    s_and_b32 s3, s86, 1
    s_lshl_b32 s3, s3, 2
    s_add_u32 s3, s3, s8
    s_lshl_b32 s3, s3, 2
    s_add_u32 s53, s53, s3
    v_lshlrev_b32 v28, 15, v1
    v_mov_b32 v29, s10
    v_mov_b32 v32, 0
    v_mov_b32 v33, 0
    v_mov_b32 v34, 0
    v_mov_b32 v35, 0
    v_mov_b32 v36, 0
    v_mov_b32 v37, 0
    v_mov_b32 v38, 0
    v_mov_b32 v39, 0
    v_mov_b32 v40, 0
    v_mov_b32 v41, 0
    v_mov_b32 v42, 0
    v_mov_b32 v43, 0
    v_mov_b32 v44, 0
    v_mov_b32 v45, 0
    v_mov_b32 v46, 0
    v_mov_b32 v47, 0
    v_mov_b32 v48, 0
    v_mov_b32 v49, 0
    v_mov_b32 v50, 0
    v_mov_b32 v51, 0
    v_mov_b32 v52, 0
    v_mov_b32 v53, 0
    v_mov_b32 v54, 0
    v_mov_b32 v55, 0
    v_mov_b32 v56, 0
    v_mov_b32 v57, 0
    v_mov_b32 v58, 0
    v_mov_b32 v59, 0
    v_mov_b32 v60, 0
    v_mov_b32 v61, 0
    v_mov_b32 v62, 0
    v_mov_b32 v63, 0
    v_mov_b32 v64, 0
    v_mov_b32 v65, 0
    v_mov_b32 v66, 0
    v_mov_b32 v67, 0
    v_mov_b32 v68, 0
    v_mov_b32 v69, 0
    v_mov_b32 v70, 0
    v_mov_b32 v71, 0
    v_mov_b32 v72, 0
    v_mov_b32 v73, 0
    v_mov_b32 v74, 0
    v_mov_b32 v75, 0
    v_mov_b32 v76, 0
    v_mov_b32 v77, 0
    v_mov_b32 v78, 0
    v_mov_b32 v79, 0
    v_mov_b32 v80, 0
    v_mov_b32 v81, 0
    v_mov_b32 v82, 0
    v_mov_b32 v83, 0
    v_mov_b32 v84, 0
    v_mov_b32 v85, 0
    v_mov_b32 v86, 0
    v_mov_b32 v87, 0
    v_mov_b32 v88, 0
    v_mov_b32 v89, 0
    v_mov_b32 v90, 0
    v_mov_b32 v91, 0
    v_mov_b32 v92, 0
    v_mov_b32 v93, 0
    v_mov_b32 v94, 0
    v_mov_b32 v95, 0
    v_mov_b32 v96, 0
    v_mov_b32 v97, 0
    v_mov_b32 v98, 0
    v_mov_b32 v99, 0
    v_mov_b32 v100, 0
    v_mov_b32 v101, 0
    v_mov_b32 v102, 0
    v_mov_b32 v103, 0
    v_mov_b32 v104, 0
    v_mov_b32 v105, 0
    v_mov_b32 v106, 0
    v_mov_b32 v107, 0
    v_mov_b32 v108, 0
    v_mov_b32 v109, 0
    v_mov_b32 v110, 0
    v_mov_b32 v111, 0
    v_mov_b32 v112, 0
    v_mov_b32 v113, 0
    v_mov_b32 v114, 0
    v_mov_b32 v115, 0
    v_mov_b32 v116, 0
    v_mov_b32 v117, 0
    v_mov_b32 v118, 0
    v_mov_b32 v119, 0
    v_mov_b32 v120, 0
    v_mov_b32 v121, 0
    v_mov_b32 v122, 0
    v_mov_b32 v123, 0
    v_mov_b32 v124, 0
    v_mov_b32 v125, 0
    v_mov_b32 v126, 0
    v_mov_b32 v127, 0
    s_mov_b32 s50, 8192
    s_mov_b32 s58, 6144
    s_mov_b32 s51, 12288
    s_mov_b32 s59, 10240
    s_mov_b32 s52, 0
    s_mul_i32 s60, s9, 786432
    s_add_u32 s60, s60, 65273856
    s_lshl_b32 s61, s11, 10
    s_add_u32 s60, s60, s61
    s_and_b32 s61, s8, 2
    s_lshl_b32 s61, s61, 7
    s_add_u32 s60, s60, s61
    s_add_u32 s61, s60, 128
    s_mov_b32 s98, s10
    s_mov_b32 s99, s10
    s_mov_b32 s3, 0x100000
cp_9:
    s_load_dwordx8 s[64:71], s[4:5], s60 glc
    s_load_dwordx8 s[72:79], s[4:5], s61 glc
    s_sub_u32 s3, s3, 1
    s_cbranch_scc1 cp_9_ok
    s_waitcnt lgkmcnt(0)
    s_xor_b64 s[100:101], s[64:65], s[98:99]
    s_xor_b64 s[64:65], s[66:67], s[98:99]
    s_or_b64 s[100:101], s[100:101], s[64:65]
    s_xor_b64 s[64:65], s[68:69], s[98:99]
    s_or_b64 s[100:101], s[100:101], s[64:65]
    s_xor_b64 s[64:65], s[70:71], s[98:99]
    s_or_b64 s[100:101], s[100:101], s[64:65]
    s_xor_b64 s[64:65], s[72:73], s[98:99]
    s_or_b64 s[100:101], s[100:101], s[64:65]
    s_xor_b64 s[64:65], s[74:75], s[98:99]
    s_or_b64 s[100:101], s[100:101], s[64:65]
    s_xor_b64 s[64:65], s[76:77], s[98:99]
    s_or_b64 s[100:101], s[100:101], s[64:65]
    s_xor_b64 s[64:65], s[78:79], s[98:99]
    s_or_b64 s[100:101], s[100:101], s[64:65]
    s_cbranch_scc1 cp_9
cp_9_ok:
    s_waitcnt lgkmcnt(0)
    buffer_load_dwordx4 v[152:155], v6, s[16:19], 0 offen offset:0 sc1
    buffer_load_dwordx4 v[156:159], v6, s[16:19], 0 offen offset:256 sc1
    buffer_load_dwordx4 v[160:163], v6, s[20:23], 0 offen offset:0 sc1
    buffer_load_dwordx4 v[164:167], v6, s[20:23], 0 offen offset:256 sc1
    buffer_load_dwordx4 v[168:171], v6, s[16:19], 0 offen offset:2048 sc1
    buffer_load_dwordx4 v[172:175], v6, s[16:19], 0 offen offset:2304 sc1
    buffer_load_dwordx4 v[176:179], v6, s[20:23], 0 offen offset:2048 sc1
    buffer_load_dwordx4 v[180:183], v6, s[20:23], 0 offen offset:2304 sc1
    s_barrier
    ds_read_b64_tr_b16 v[128:129], v24 offset:0
    ds_read_b64_tr_b16 v[130:131], v24 offset:512
    ds_read_b64_tr_b16 v[132:133], v25 offset:0
    ds_read_b64_tr_b16 v[134:135], v25 offset:512
    ds_read_b64_tr_b16 v[136:137], v24 offset:8192
    ds_read_b64_tr_b16 v[138:139], v24 offset:8704
    ds_read_b64_tr_b16 v[140:141], v25 offset:8192
    ds_read_b64_tr_b16 v[142:143], v25 offset:8704
    ds_read_b64_tr_b16 v[144:145], v24 offset:16384
    ds_read_b64_tr_b16 v[146:147], v24 offset:16896
    buffer_load_dwordx4 a[0:3], v6, s[16:19], s54 offen offset:0 sc1
    buffer_load_dwordx4 a[4:7], v6, s[16:19], s54 offen offset:256 sc1
    buffer_load_dwordx4 a[8:11], v6, s[20:23], s54 offen offset:0 sc1
    buffer_load_dwordx4 a[12:15], v6, s[20:23], s54 offen offset:256 sc1
    buffer_load_dwordx4 a[16:19], v6, s[16:19], s54 offen offset:2048 sc1
    buffer_load_dwordx4 a[20:23], v6, s[16:19], s54 offen offset:2304 sc1
    s_mov_b32 s54, 7
.p2align 3
c_qkvB_loop:
    s_waitcnt vmcnt(12) lgkmcnt(6)
    v_mfma_f32_16x16x32_bf16 v[32:35], v[128:131], v[152:155], v[32:35]
    ds_read_b64_tr_b16 v[148:149], v25 offset:16384
    v_mfma_f32_16x16x32_bf16 v[36:39], v[128:131], v[156:159], v[36:39]
    ds_read_b64_tr_b16 v[150:151], v25 offset:16896
    v_mfma_f32_16x16x32_bf16 v[52:55], v[132:135], v[156:159], v[52:55]
    buffer_load_dwordx4 a[24:27], v6, s[20:23], s58 offen offset:0 sc1
    v_mfma_f32_16x16x32_bf16 v[48:51], v[132:135], v[152:155], v[48:51]
    s_waitcnt lgkmcnt(4)
    v_mfma_f32_16x16x32_bf16 v[64:67], v[136:139], v[152:155], v[64:67]
    v_mfma_f32_16x16x32_bf16 v[68:71], v[136:139], v[156:159], v[68:71]
    v_mfma_f32_16x16x32_bf16 v[84:87], v[140:143], v[156:159], v[84:87]
    buffer_load_dwordx4 a[28:31], v6, s[20:23], s58 offen offset:256 sc1
    v_mfma_f32_16x16x32_bf16 v[80:83], v[140:143], v[152:155], v[80:83]
    s_waitcnt lgkmcnt(0)
    v_mfma_f32_16x16x32_bf16 v[96:99], v[152:155], v[144:147], v[96:99]
    v_mfma_f32_16x16x32_bf16 v[100:103], v[156:159], v[144:147], v[100:103]
    v_mfma_f32_16x16x32_bf16 v[116:119], v[156:159], v[148:151], v[116:119]
    v_mfma_f32_16x16x32_bf16 v[112:115], v[152:155], v[148:151], v[112:115]
    s_waitcnt vmcnt(12)
    v_mfma_f32_16x16x32_bf16 v[40:43], v[128:131], v[160:163], v[40:43]
    buffer_load_dwordx4 v[152:155], v6, s[16:19], s50 offen offset:0 sc1
    v_mfma_f32_16x16x32_bf16 v[44:47], v[128:131], v[164:167], v[44:47]
    v_mfma_f32_16x16x32_bf16 v[60:63], v[132:135], v[164:167], v[60:63]
    ds_read_b64_tr_b16 v[128:129], v24 offset:2048
    v_mfma_f32_16x16x32_bf16 v[56:59], v[132:135], v[160:163], v[56:59]
    ds_read_b64_tr_b16 v[130:131], v24 offset:2560
    v_mfma_f32_16x16x32_bf16 v[72:75], v[136:139], v[160:163], v[72:75]
    ds_read_b64_tr_b16 v[132:133], v25 offset:2048
    v_mfma_f32_16x16x32_bf16 v[76:79], v[136:139], v[164:167], v[76:79]
    ds_read_b64_tr_b16 v[134:135], v25 offset:2560
    v_mfma_f32_16x16x32_bf16 v[92:95], v[140:143], v[164:167], v[92:95]
    ds_read_b64_tr_b16 v[136:137], v24 offset:10240
    buffer_load_dwordx4 v[156:159], v6, s[16:19], s50 offen offset:256 sc1
    v_mfma_f32_16x16x32_bf16 v[88:91], v[140:143], v[160:163], v[88:91]
    ds_read_b64_tr_b16 v[138:139], v24 offset:10752
    v_mfma_f32_16x16x32_bf16 v[104:107], v[160:163], v[144:147], v[104:107]
    ds_read_b64_tr_b16 v[140:141], v25 offset:10240
    v_mfma_f32_16x16x32_bf16 v[108:111], v[164:167], v[144:147], v[108:111]
    ds_read_b64_tr_b16 v[142:143], v25 offset:10752
    v_mfma_f32_16x16x32_bf16 v[124:127], v[164:167], v[148:151], v[124:127]
    ds_read_b64_tr_b16 v[144:145], v24 offset:18432
    v_mfma_f32_16x16x32_bf16 v[120:123], v[160:163], v[148:151], v[120:123]
    ds_read_b64_tr_b16 v[146:147], v24 offset:18944
    s_waitcnt vmcnt(12) lgkmcnt(6)
    v_mfma_f32_16x16x32_bf16 v[32:35], v[128:131], v[168:171], v[32:35]
    ds_read_b64_tr_b16 v[148:149], v25 offset:18432
    v_mfma_f32_16x16x32_bf16 v[36:39], v[128:131], v[172:175], v[36:39]
    ds_read_b64_tr_b16 v[150:151], v25 offset:18944
    v_mfma_f32_16x16x32_bf16 v[52:55], v[132:135], v[172:175], v[52:55]
    buffer_load_dwordx4 v[160:163], v6, s[20:23], s58 offen offset:2048 sc1
    v_mfma_f32_16x16x32_bf16 v[48:51], v[132:135], v[168:171], v[48:51]
    s_waitcnt lgkmcnt(4)
    v_mfma_f32_16x16x32_bf16 v[64:67], v[136:139], v[168:171], v[64:67]
    v_mfma_f32_16x16x32_bf16 v[68:71], v[136:139], v[172:175], v[68:71]
    v_mfma_f32_16x16x32_bf16 v[84:87], v[140:143], v[172:175], v[84:87]
    buffer_load_dwordx4 v[164:167], v6, s[20:23], s58 offen offset:2304 sc1
    v_mfma_f32_16x16x32_bf16 v[80:83], v[140:143], v[168:171], v[80:83]
    s_waitcnt lgkmcnt(0)
    v_mfma_f32_16x16x32_bf16 v[96:99], v[168:171], v[144:147], v[96:99]
    v_mfma_f32_16x16x32_bf16 v[100:103], v[172:175], v[144:147], v[100:103]
    v_mfma_f32_16x16x32_bf16 v[116:119], v[172:175], v[148:151], v[116:119]
    v_mfma_f32_16x16x32_bf16 v[112:115], v[168:171], v[148:151], v[112:115]
    s_waitcnt vmcnt(12)
    v_mfma_f32_16x16x32_bf16 v[40:43], v[128:131], v[176:179], v[40:43]
    buffer_load_dwordx4 v[168:171], v6, s[16:19], s50 offen offset:2048 sc1
    v_mfma_f32_16x16x32_bf16 v[44:47], v[128:131], v[180:183], v[44:47]
    v_mfma_f32_16x16x32_bf16 v[60:63], v[132:135], v[180:183], v[60:63]
    ds_read_b64_tr_b16 v[128:129], v24 offset:4096
    v_mfma_f32_16x16x32_bf16 v[56:59], v[132:135], v[176:179], v[56:59]
    ds_read_b64_tr_b16 v[130:131], v24 offset:4608
    v_mfma_f32_16x16x32_bf16 v[72:75], v[136:139], v[176:179], v[72:75]
    ds_read_b64_tr_b16 v[132:133], v25 offset:4096
    v_mfma_f32_16x16x32_bf16 v[76:79], v[136:139], v[180:183], v[76:79]
    ds_read_b64_tr_b16 v[134:135], v25 offset:4608
    v_mfma_f32_16x16x32_bf16 v[92:95], v[140:143], v[180:183], v[92:95]
    ds_read_b64_tr_b16 v[136:137], v24 offset:12288
    buffer_load_dwordx4 v[172:175], v6, s[16:19], s50 offen offset:2304 sc1
    v_mfma_f32_16x16x32_bf16 v[88:91], v[140:143], v[176:179], v[88:91]
    ds_read_b64_tr_b16 v[138:139], v24 offset:12800
    v_mfma_f32_16x16x32_bf16 v[104:107], v[176:179], v[144:147], v[104:107]
    ds_read_b64_tr_b16 v[140:141], v25 offset:12288
    v_mfma_f32_16x16x32_bf16 v[108:111], v[180:183], v[144:147], v[108:111]
    ds_read_b64_tr_b16 v[142:143], v25 offset:12800
    v_mfma_f32_16x16x32_bf16 v[124:127], v[180:183], v[148:151], v[124:127]
    ds_read_b64_tr_b16 v[144:145], v24 offset:20480
    v_mfma_f32_16x16x32_bf16 v[120:123], v[176:179], v[148:151], v[120:123]
    ds_read_b64_tr_b16 v[146:147], v24 offset:20992
    s_waitcnt vmcnt(12) lgkmcnt(6)
    v_mfma_f32_16x16x32_bf16 v[32:35], v[128:131], a[0:3], v[32:35]
    ds_read_b64_tr_b16 v[148:149], v25 offset:20480
    v_mfma_f32_16x16x32_bf16 v[36:39], v[128:131], a[4:7], v[36:39]
    ds_read_b64_tr_b16 v[150:151], v25 offset:20992
    v_mfma_f32_16x16x32_bf16 v[52:55], v[132:135], a[4:7], v[52:55]
    buffer_load_dwordx4 v[176:179], v6, s[20:23], s59 offen offset:0 sc1
    v_mfma_f32_16x16x32_bf16 v[48:51], v[132:135], a[0:3], v[48:51]
    s_waitcnt lgkmcnt(4)
    v_mfma_f32_16x16x32_bf16 v[64:67], v[136:139], a[0:3], v[64:67]
    s_add_u32 s50, s50, 8192
    v_mfma_f32_16x16x32_bf16 v[68:71], v[136:139], a[4:7], v[68:71]
    v_mfma_f32_16x16x32_bf16 v[84:87], v[140:143], a[4:7], v[84:87]
    buffer_load_dwordx4 v[180:183], v6, s[20:23], s59 offen offset:256 sc1
    v_mfma_f32_16x16x32_bf16 v[80:83], v[140:143], a[0:3], v[80:83]
    s_waitcnt lgkmcnt(0)
    v_mfma_f32_16x16x32_bf16 v[96:99], a[0:3], v[144:147], v[96:99]
    s_add_u32 s52, s52, 24576
    v_mfma_f32_16x16x32_bf16 v[100:103], a[4:7], v[144:147], v[100:103]
    s_cmp_eq_u32 s52, 147456
    v_mfma_f32_16x16x32_bf16 v[116:119], a[4:7], v[148:151], v[116:119]
    s_cselect_b32 s52, 0, s52
    v_mfma_f32_16x16x32_bf16 v[112:115], a[0:3], v[148:151], v[112:115]
    s_add_u32 s58, s58, 8192
    s_waitcnt vmcnt(12)
    v_mfma_f32_16x16x32_bf16 v[40:43], v[128:131], a[8:11], v[40:43]
    buffer_load_dwordx4 a[0:3], v6, s[16:19], s51 offen offset:0 sc1
    v_mfma_f32_16x16x32_bf16 v[44:47], v[128:131], a[12:15], v[44:47]
    s_sub_u32 s54, s54, 1
    v_mfma_f32_16x16x32_bf16 v[60:63], v[132:135], a[12:15], v[60:63]
    ds_read_b64_tr_b16 v[128:129], v24 offset:6144
    v_mfma_f32_16x16x32_bf16 v[56:59], v[132:135], a[8:11], v[56:59]
    ds_read_b64_tr_b16 v[130:131], v24 offset:6656
    v_mfma_f32_16x16x32_bf16 v[72:75], v[136:139], a[8:11], v[72:75]
    ds_read_b64_tr_b16 v[132:133], v25 offset:6144
    v_mfma_f32_16x16x32_bf16 v[76:79], v[136:139], a[12:15], v[76:79]
    ds_read_b64_tr_b16 v[134:135], v25 offset:6656
    v_mfma_f32_16x16x32_bf16 v[92:95], v[140:143], a[12:15], v[92:95]
    ds_read_b64_tr_b16 v[136:137], v24 offset:14336
    buffer_load_dwordx4 a[4:7], v6, s[16:19], s51 offen offset:256 sc1
    v_mfma_f32_16x16x32_bf16 v[88:91], v[140:143], a[8:11], v[88:91]
    ds_read_b64_tr_b16 v[138:139], v24 offset:14848
    v_mfma_f32_16x16x32_bf16 v[104:107], a[8:11], v[144:147], v[104:107]
    ds_read_b64_tr_b16 v[140:141], v25 offset:14336
    v_mfma_f32_16x16x32_bf16 v[108:111], a[12:15], v[144:147], v[108:111]
    ds_read_b64_tr_b16 v[142:143], v25 offset:14848
    v_mfma_f32_16x16x32_bf16 v[124:127], a[12:15], v[148:151], v[124:127]
    ds_read_b64_tr_b16 v[144:145], v24 offset:22528
    v_mfma_f32_16x16x32_bf16 v[120:123], a[8:11], v[148:151], v[120:123]
    ds_read_b64_tr_b16 v[146:147], v24 offset:23040
    s_waitcnt vmcnt(12) lgkmcnt(6)
    v_mfma_f32_16x16x32_bf16 v[32:35], v[128:131], a[16:19], v[32:35]
    ds_read_b64_tr_b16 v[148:149], v25 offset:22528
    v_mfma_f32_16x16x32_bf16 v[36:39], v[128:131], a[20:23], v[36:39]
    ds_read_b64_tr_b16 v[150:151], v25 offset:23040
    v_mfma_f32_16x16x32_bf16 v[52:55], v[132:135], a[20:23], v[52:55]
    buffer_load_dwordx4 a[8:11], v6, s[20:23], s59 offen offset:2048 sc1
    v_mfma_f32_16x16x32_bf16 v[48:51], v[132:135], a[16:19], v[48:51]
    s_waitcnt lgkmcnt(4)
    v_mfma_f32_16x16x32_bf16 v[64:67], v[136:139], a[16:19], v[64:67]
    v_add_u32 v25, s52, v27
    v_mfma_f32_16x16x32_bf16 v[68:71], v[136:139], a[20:23], v[68:71]
    v_mfma_f32_16x16x32_bf16 v[84:87], v[140:143], a[20:23], v[84:87]
    buffer_load_dwordx4 a[12:15], v6, s[20:23], s59 offen offset:2304 sc1
    v_mfma_f32_16x16x32_bf16 v[80:83], v[140:143], a[16:19], v[80:83]
    s_waitcnt lgkmcnt(0)
    v_mfma_f32_16x16x32_bf16 v[96:99], a[16:19], v[144:147], v[96:99]
    v_add_u32 v24, s52, v26
    v_mfma_f32_16x16x32_bf16 v[100:103], a[20:23], v[144:147], v[100:103]
    v_mfma_f32_16x16x32_bf16 v[116:119], a[20:23], v[148:151], v[116:119]
    s_add_u32 s59, s59, 8192
    v_mfma_f32_16x16x32_bf16 v[112:115], a[16:19], v[148:151], v[112:115]
    s_barrier
    s_waitcnt vmcnt(12)
    v_mfma_f32_16x16x32_bf16 v[40:43], v[128:131], a[24:27], v[40:43]
    buffer_load_dwordx4 a[16:19], v6, s[16:19], s51 offen offset:2048 sc1
    v_mfma_f32_16x16x32_bf16 v[44:47], v[128:131], a[28:31], v[44:47]
    v_mfma_f32_16x16x32_bf16 v[60:63], v[132:135], a[28:31], v[60:63]
    ds_read_b64_tr_b16 v[128:129], v24 offset:0
    v_mfma_f32_16x16x32_bf16 v[56:59], v[132:135], a[24:27], v[56:59]
    ds_read_b64_tr_b16 v[130:131], v24 offset:512
    v_mfma_f32_16x16x32_bf16 v[72:75], v[136:139], a[24:27], v[72:75]
    ds_read_b64_tr_b16 v[132:133], v25 offset:0
    v_mfma_f32_16x16x32_bf16 v[76:79], v[136:139], a[28:31], v[76:79]
    ds_read_b64_tr_b16 v[134:135], v25 offset:512
    v_mfma_f32_16x16x32_bf16 v[92:95], v[140:143], a[28:31], v[92:95]
    ds_read_b64_tr_b16 v[136:137], v24 offset:8192
    buffer_load_dwordx4 a[20:23], v6, s[16:19], s51 offen offset:2304 sc1
    v_mfma_f32_16x16x32_bf16 v[88:91], v[140:143], a[24:27], v[88:91]
    ds_read_b64_tr_b16 v[138:139], v24 offset:8704
    v_mfma_f32_16x16x32_bf16 v[104:107], a[24:27], v[144:147], v[104:107]
    ds_read_b64_tr_b16 v[140:141], v25 offset:8192
    s_add_u32 s51, s51, 8192
    v_mfma_f32_16x16x32_bf16 v[108:111], a[28:31], v[144:147], v[108:111]
    ds_read_b64_tr_b16 v[142:143], v25 offset:8704
    v_mfma_f32_16x16x32_bf16 v[124:127], a[28:31], v[148:151], v[124:127]
    ds_read_b64_tr_b16 v[144:145], v24 offset:16384
    s_cmp_lg_u32 s54, 0
    v_mfma_f32_16x16x32_bf16 v[120:123], a[24:27], v[148:151], v[120:123]
    ds_read_b64_tr_b16 v[146:147], v24 offset:16896
    s_cbranch_scc1 c_qkvB_loop
    s_waitcnt vmcnt(12) lgkmcnt(6)
    v_mfma_f32_16x16x32_bf16 v[32:35], v[128:131], v[152:155], v[32:35]
    ds_read_b64_tr_b16 v[148:149], v25 offset:16384
    v_mfma_f32_16x16x32_bf16 v[36:39], v[128:131], v[156:159], v[36:39]
    ds_read_b64_tr_b16 v[150:151], v25 offset:16896
    v_mfma_f32_16x16x32_bf16 v[52:55], v[132:135], v[156:159], v[52:55]
    buffer_load_dwordx4 a[24:27], v6, s[20:23], s58 offen offset:0 sc1
    ds_read_b32 v184, v8 offset:1280
    v_mfma_f32_16x16x32_bf16 v[48:51], v[132:135], v[152:155], v[48:51]
    ds_read_b32 v186, v8 offset:1344
    s_waitcnt lgkmcnt(6)
    v_mfma_f32_16x16x32_bf16 v[64:67], v[136:139], v[152:155], v[64:67]
    ds_read_b32 v188, v8 offset:1408
    v_mfma_f32_16x16x32_bf16 v[68:71], v[136:139], v[156:159], v[68:71]
    v_mfma_f32_16x16x32_bf16 v[84:87], v[140:143], v[156:159], v[84:87]
    buffer_load_dwordx4 a[28:31], v6, s[20:23], s58 offen offset:256 sc1
    ds_read_b32 v190, v8 offset:1472
    v_mfma_f32_16x16x32_bf16 v[80:83], v[140:143], v[152:155], v[80:83]
    ds_read_b128 v[212:215], v10 offset:512
    s_waitcnt lgkmcnt(5)
    v_mfma_f32_16x16x32_bf16 v[96:99], v[152:155], v[144:147], v[96:99]
    ds_read_b128 v[216:219], v10 offset:576
    v_mfma_f32_16x16x32_bf16 v[100:103], v[156:159], v[144:147], v[100:103]
    v_mfma_f32_16x16x32_bf16 v[116:119], v[156:159], v[148:151], v[116:119]
    v_mfma_f32_16x16x32_bf16 v[112:115], v[152:155], v[148:151], v[112:115]
    s_waitcnt vmcnt(12)
    v_mfma_f32_16x16x32_bf16 v[40:43], v[128:131], v[160:163], v[40:43]
    s_waitcnt lgkmcnt(0)
    v_fma_f32 v64, -v184, v212, v64
    v_fma_f32 v65, -v184, v213, v65
    v_mfma_f32_16x16x32_bf16 v[44:47], v[128:131], v[164:167], v[44:47]
    v_fma_f32 v66, -v184, v214, v66
    v_mfma_f32_16x16x32_bf16 v[60:63], v[132:135], v[164:167], v[60:63]
    ds_read_b64_tr_b16 v[128:129], v24 offset:2048
    v_fma_f32 v67, -v184, v215, v67
    v_mfma_f32_16x16x32_bf16 v[56:59], v[132:135], v[160:163], v[56:59]
    ds_read_b64_tr_b16 v[130:131], v24 offset:2560
    v_fma_f32 v68, -v186, v212, v68
    v_fma_f32 v69, -v186, v213, v69
    v_mfma_f32_16x16x32_bf16 v[72:75], v[136:139], v[160:163], v[72:75]
    ds_read_b64_tr_b16 v[132:133], v25 offset:2048
    v_fma_f32 v70, -v186, v214, v70
    v_mfma_f32_16x16x32_bf16 v[76:79], v[136:139], v[164:167], v[76:79]
    ds_read_b64_tr_b16 v[134:135], v25 offset:2560
    v_fma_f32 v71, -v186, v215, v71
    v_mfma_f32_16x16x32_bf16 v[92:95], v[140:143], v[164:167], v[92:95]
    ds_read_b64_tr_b16 v[136:137], v24 offset:10240
    v_fma_f32 v80, -v184, v216, v80
    v_fma_f32 v81, -v184, v217, v81
    v_mfma_f32_16x16x32_bf16 v[88:91], v[140:143], v[160:163], v[88:91]
    ds_read_b64_tr_b16 v[138:139], v24 offset:10752
    v_fma_f32 v82, -v184, v218, v82
    v_mfma_f32_16x16x32_bf16 v[104:107], v[160:163], v[144:147], v[104:107]
    ds_read_b64_tr_b16 v[140:141], v25 offset:10240
    v_fma_f32 v83, -v184, v219, v83
    v_mfma_f32_16x16x32_bf16 v[108:111], v[164:167], v[144:147], v[108:111]
    ds_read_b64_tr_b16 v[142:143], v25 offset:10752
    v_fma_f32 v84, -v186, v216, v84
    v_fma_f32 v85, -v186, v217, v85
    v_mfma_f32_16x16x32_bf16 v[124:127], v[164:167], v[148:151], v[124:127]
    ds_read_b64_tr_b16 v[144:145], v24 offset:18432
    v_fma_f32 v86, -v186, v218, v86
    v_mfma_f32_16x16x32_bf16 v[120:123], v[160:163], v[148:151], v[120:123]
    ds_read_b64_tr_b16 v[146:147], v24 offset:18944
    v_fma_f32 v87, -v186, v219, v87
    s_waitcnt vmcnt(10) lgkmcnt(6)
    v_mfma_f32_16x16x32_bf16 v[32:35], v[128:131], v[168:171], v[32:35]
    ds_read_b64_tr_b16 v[148:149], v25 offset:18432
    v_fma_f32 v72, -v188, v212, v72
    v_fma_f32 v73, -v188, v213, v73
    v_mfma_f32_16x16x32_bf16 v[36:39], v[128:131], v[172:175], v[36:39]
    ds_read_b64_tr_b16 v[150:151], v25 offset:18944
    v_fma_f32 v74, -v188, v214, v74
    v_mfma_f32_16x16x32_bf16 v[52:55], v[132:135], v[172:175], v[52:55]
    v_fma_f32 v75, -v188, v215, v75
    ds_read_b128 v[152:155], v10 offset:384
    v_mfma_f32_16x16x32_bf16 v[48:51], v[132:135], v[168:171], v[48:51]
    v_fma_f32 v76, -v190, v212, v76
    v_fma_f32 v77, -v190, v213, v77
    ds_read_b128 v[156:159], v10 offset:448
    s_waitcnt lgkmcnt(6)
    v_mfma_f32_16x16x32_bf16 v[64:67], v[136:139], v[168:171], v[64:67]
    v_fma_f32 v78, -v190, v214, v78
    ds_read_b32 v185, v8 offset:2816
    v_mfma_f32_16x16x32_bf16 v[68:71], v[136:139], v[172:175], v[68:71]
    v_fma_f32 v79, -v190, v215, v79
    v_mfma_f32_16x16x32_bf16 v[84:87], v[140:143], v[172:175], v[84:87]
    v_fma_f32 v88, -v188, v216, v88
    v_fma_f32 v89, -v188, v217, v89
    ds_read_b32 v187, v8 offset:2880
    v_mfma_f32_16x16x32_bf16 v[80:83], v[140:143], v[168:171], v[80:83]
    v_fma_f32 v90, -v188, v218, v90
    ds_read_b32 v189, v8 offset:2944
    s_waitcnt lgkmcnt(5)
    v_mfma_f32_16x16x32_bf16 v[96:99], v[168:171], v[144:147], v[96:99]
    v_fma_f32 v91, -v188, v219, v91
    ds_read_b32 v191, v8 offset:3008
    v_mfma_f32_16x16x32_bf16 v[100:103], v[172:175], v[144:147], v[100:103]
    v_fma_f32 v92, -v190, v216, v92
    v_fma_f32 v93, -v190, v217, v93
    v_mfma_f32_16x16x32_bf16 v[116:119], v[172:175], v[148:151], v[116:119]
    v_fma_f32 v94, -v190, v218, v94
    v_mfma_f32_16x16x32_bf16 v[112:115], v[168:171], v[148:151], v[112:115]
    v_fma_f32 v95, -v190, v219, v95
    s_waitcnt vmcnt(8)
    v_mfma_f32_16x16x32_bf16 v[40:43], v[128:131], v[176:179], v[40:43]
    s_waitcnt lgkmcnt(0)
    v_fma_f32 v32, -v184, v152, v32
    v_fma_f32 v33, -v184, v153, v33
    v_mfma_f32_16x16x32_bf16 v[44:47], v[128:131], v[180:183], v[44:47]
    v_fma_f32 v34, -v184, v154, v34
    v_mfma_f32_16x16x32_bf16 v[60:63], v[132:135], v[180:183], v[60:63]
    ds_read_b64_tr_b16 v[128:129], v24 offset:4096
    v_fma_f32 v35, -v184, v155, v35
    v_fma_f32 v36, -v186, v152, v36
    v_mfma_f32_16x16x32_bf16 v[56:59], v[132:135], v[176:179], v[56:59]
    ds_read_b64_tr_b16 v[130:131], v24 offset:4608
    v_fma_f32 v37, -v186, v153, v37
    v_mfma_f32_16x16x32_bf16 v[72:75], v[136:139], v[176:179], v[72:75]
    ds_read_b64_tr_b16 v[132:133], v25 offset:4096
    v_fma_f32 v38, -v186, v154, v38
    v_fma_f32 v39, -v186, v155, v39
    v_mfma_f32_16x16x32_bf16 v[76:79], v[136:139], v[180:183], v[76:79]
    ds_read_b64_tr_b16 v[134:135], v25 offset:4608
    v_fma_f32 v48, -v184, v156, v48
    v_mfma_f32_16x16x32_bf16 v[92:95], v[140:143], v[180:183], v[92:95]
    ds_read_b64_tr_b16 v[136:137], v24 offset:12288
    v_fma_f32 v49, -v184, v157, v49
    v_fma_f32 v50, -v184, v158, v50
    v_mfma_f32_16x16x32_bf16 v[88:91], v[140:143], v[176:179], v[88:91]
    ds_read_b64_tr_b16 v[138:139], v24 offset:12800
    v_fma_f32 v51, -v184, v159, v51
    v_mfma_f32_16x16x32_bf16 v[104:107], v[176:179], v[144:147], v[104:107]
    ds_read_b64_tr_b16 v[140:141], v25 offset:12288
    v_fma_f32 v52, -v186, v156, v52
    v_fma_f32 v53, -v186, v157, v53
    v_mfma_f32_16x16x32_bf16 v[108:111], v[180:183], v[144:147], v[108:111]
    ds_read_b64_tr_b16 v[142:143], v25 offset:12800
    v_fma_f32 v54, -v186, v158, v54
    v_mfma_f32_16x16x32_bf16 v[124:127], v[180:183], v[148:151], v[124:127]
    ds_read_b64_tr_b16 v[144:145], v24 offset:20480
    v_fma_f32 v55, -v186, v159, v55
    v_mfma_f32_16x16x32_bf16 v[120:123], v[176:179], v[148:151], v[120:123]
    ds_read_b64_tr_b16 v[146:147], v24 offset:20992
    s_waitcnt vmcnt(6) lgkmcnt(6)
    v_mfma_f32_16x16x32_bf16 v[32:35], v[128:131], a[0:3], v[32:35]
    ds_read_b64_tr_b16 v[148:149], v25 offset:20480
    v_fma_f32 v40, -v188, v152, v40
    v_fma_f32 v41, -v188, v153, v41
    v_mfma_f32_16x16x32_bf16 v[36:39], v[128:131], a[4:7], v[36:39]
    ds_read_b64_tr_b16 v[150:151], v25 offset:20992
    v_fma_f32 v42, -v188, v154, v42
    v_mfma_f32_16x16x32_bf16 v[52:55], v[132:135], a[4:7], v[52:55]
    v_fma_f32 v43, -v188, v155, v43
    v_fma_f32 v44, -v190, v152, v44
    ds_read_b128 v[168:171], v9 offset:1280
    v_mfma_f32_16x16x32_bf16 v[48:51], v[132:135], a[0:3], v[48:51]
    v_fma_f32 v45, -v190, v153, v45
    ds_read_b128 v[172:175], v9 offset:1344
    s_waitcnt lgkmcnt(6)
    v_mfma_f32_16x16x32_bf16 v[64:67], v[136:139], a[0:3], v[64:67]
    v_fma_f32 v46, -v190, v154, v46
    v_fma_f32 v47, -v190, v155, v47
    v_mfma_f32_16x16x32_bf16 v[68:71], v[136:139], a[4:7], v[68:71]
    v_fma_f32 v56, -v188, v156, v56
    ds_read_b128 v[176:179], v9 offset:1408
    v_mfma_f32_16x16x32_bf16 v[84:87], v[140:143], a[4:7], v[84:87]
    v_fma_f32 v57, -v188, v157, v57
    v_fma_f32 v58, -v188, v158, v58
    ds_read_b128 v[180:183], v9 offset:1472
    v_mfma_f32_16x16x32_bf16 v[80:83], v[140:143], a[0:3], v[80:83]
    v_fma_f32 v59, -v188, v159, v59
    s_waitcnt lgkmcnt(4)
    v_mfma_f32_16x16x32_bf16 v[96:99], a[0:3], v[144:147], v[96:99]
    v_fma_f32 v60, -v190, v156, v60
    v_fma_f32 v61, -v190, v157, v61
    ds_read2_b32 v[220:221], v11 offset0:160 offset1:176
    v_mfma_f32_16x16x32_bf16 v[100:103], a[4:7], v[144:147], v[100:103]
    v_fma_f32 v62, -v190, v158, v62
    v_mfma_f32_16x16x32_bf16 v[116:119], a[4:7], v[148:151], v[116:119]
    v_fma_f32 v63, -v190, v159, v63
    v_mfma_f32_16x16x32_bf16 v[112:115], a[0:3], v[148:151], v[112:115]
    s_waitcnt vmcnt(4)
    v_mfma_f32_16x16x32_bf16 v[40:43], v[128:131], a[8:11], v[40:43]
    v_mfma_f32_16x16x32_bf16 v[44:47], v[128:131], a[12:15], v[44:47]
    s_waitcnt lgkmcnt(0)
    v_fma_f32 v96, -v168, v220, v96
    v_fma_f32 v97, -v169, v220, v97
    v_mfma_f32_16x16x32_bf16 v[60:63], v[132:135], a[12:15], v[60:63]
    ds_read_b64_tr_b16 v[128:129], v24 offset:6144
    v_fma_f32 v98, -v170, v220, v98
    v_mfma_f32_16x16x32_bf16 v[56:59], v[132:135], a[8:11], v[56:59]
    ds_read_b64_tr_b16 v[130:131], v24 offset:6656
    v_fma_f32 v99, -v171, v220, v99
    v_fma_f32 v100, -v172, v220, v100
    v_mfma_f32_16x16x32_bf16 v[72:75], v[136:139], a[8:11], v[72:75]
    ds_read_b64_tr_b16 v[132:133], v25 offset:6144
    v_fma_f32 v101, -v173, v220, v101
    v_mfma_f32_16x16x32_bf16 v[76:79], v[136:139], a[12:15], v[76:79]
    ds_read_b64_tr_b16 v[134:135], v25 offset:6656
    v_fma_f32 v102, -v174, v220, v102
    v_fma_f32 v103, -v175, v220, v103
    v_mfma_f32_16x16x32_bf16 v[92:95], v[140:143], a[12:15], v[92:95]
    ds_read_b64_tr_b16 v[136:137], v24 offset:14336
    v_fma_f32 v112, -v168, v221, v112
    v_mfma_f32_16x16x32_bf16 v[88:91], v[140:143], a[8:11], v[88:91]
    ds_read_b64_tr_b16 v[138:139], v24 offset:14848
    v_fma_f32 v113, -v169, v221, v113
    v_fma_f32 v114, -v170, v221, v114
    v_mfma_f32_16x16x32_bf16 v[104:107], a[8:11], v[144:147], v[104:107]
    ds_read_b64_tr_b16 v[140:141], v25 offset:14336
    v_fma_f32 v115, -v171, v221, v115
    v_mfma_f32_16x16x32_bf16 v[108:111], a[12:15], v[144:147], v[108:111]
    ds_read_b64_tr_b16 v[142:143], v25 offset:14848
    v_fma_f32 v116, -v172, v221, v116
    v_fma_f32 v117, -v173, v221, v117
    v_mfma_f32_16x16x32_bf16 v[124:127], a[12:15], v[148:151], v[124:127]
    ds_read_b64_tr_b16 v[144:145], v24 offset:22528
    v_fma_f32 v118, -v174, v221, v118
    v_mfma_f32_16x16x32_bf16 v[120:123], a[8:11], v[148:151], v[120:123]
    ds_read_b64_tr_b16 v[146:147], v24 offset:23040
    v_fma_f32 v119, -v175, v221, v119
    s_waitcnt vmcnt(2) lgkmcnt(6)
    v_mfma_f32_16x16x32_bf16 v[32:35], v[128:131], a[16:19], v[32:35]
    ds_read_b64_tr_b16 v[148:149], v25 offset:22528
    v_mfma_f32_16x16x32_bf16 v[36:39], v[128:131], a[20:23], v[36:39]
    ds_read_b64_tr_b16 v[150:151], v25 offset:23040
    v_fma_f32 v104, -v176, v220, v104
    v_fma_f32 v105, -v177, v220, v105
    v_mfma_f32_16x16x32_bf16 v[52:55], v[132:135], a[20:23], v[52:55]
    v_fma_f32 v106, -v178, v220, v106
    ds_read_b128 v[152:155], v9 offset:2816
    v_mfma_f32_16x16x32_bf16 v[48:51], v[132:135], a[16:19], v[48:51]
    v_fma_f32 v107, -v179, v220, v107
    v_fma_f32 v108, -v180, v220, v108
    s_waitcnt lgkmcnt(5)
    v_mfma_f32_16x16x32_bf16 v[64:67], v[136:139], a[16:19], v[64:67]
    v_fma_f32 v109, -v181, v220, v109
    ds_read_b128 v[156:159], v9 offset:2880
    v_mfma_f32_16x16x32_bf16 v[68:71], v[136:139], a[20:23], v[68:71]
    v_fma_f32 v110, -v182, v220, v110
    v_fma_f32 v111, -v183, v220, v111
    v_mfma_f32_16x16x32_bf16 v[84:87], v[140:143], a[20:23], v[84:87]
    v_fma_f32 v120, -v176, v221, v120
    ds_read_b128 v[160:163], v9 offset:2944
    v_mfma_f32_16x16x32_bf16 v[80:83], v[140:143], a[16:19], v[80:83]
    v_fma_f32 v121, -v177, v221, v121
    v_fma_f32 v122, -v178, v221, v122
    s_waitcnt lgkmcnt(3)
    v_mfma_f32_16x16x32_bf16 v[96:99], a[16:19], v[144:147], v[96:99]
    v_fma_f32 v123, -v179, v221, v123
    ds_read_b128 v[164:167], v9 offset:3008
    v_mfma_f32_16x16x32_bf16 v[100:103], a[20:23], v[144:147], v[100:103]
    v_fma_f32 v124, -v180, v221, v124
    v_fma_f32 v125, -v181, v221, v125
    v_mfma_f32_16x16x32_bf16 v[116:119], a[20:23], v[148:151], v[116:119]
    v_fma_f32 v126, -v182, v221, v126
    v_mfma_f32_16x16x32_bf16 v[112:115], a[16:19], v[148:151], v[112:115]
    v_fma_f32 v127, -v183, v221, v127
    s_barrier
    s_waitcnt vmcnt(0)
    v_mfma_f32_16x16x32_bf16 v[40:43], v[128:131], a[24:27], v[40:43]
    v_mul_f32 v64, v185, v64
    v_mul_f32 v65, v185, v65
    v_mfma_f32_16x16x32_bf16 v[44:47], v[128:131], a[28:31], v[44:47]
    v_mul_f32 v66, v185, v66
    v_mul_f32 v67, v185, v67
    v_mfma_f32_16x16x32_bf16 v[60:63], v[132:135], a[28:31], v[60:63]
    v_mul_f32 v80, v185, v80
    v_mul_f32 v81, v185, v81
    v_mfma_f32_16x16x32_bf16 v[56:59], v[132:135], a[24:27], v[56:59]
    v_mul_f32 v82, v185, v82
    v_mul_f32 v83, v185, v83
    v_mfma_f32_16x16x32_bf16 v[72:75], v[136:139], a[24:27], v[72:75]
    v_cvt_pk_bf16_f32 v64, v64, v65
    v_cvt_pk_bf16_f32 v65, v66, v67
    v_mfma_f32_16x16x32_bf16 v[76:79], v[136:139], a[28:31], v[76:79]
    v_cvt_pk_bf16_f32 v66, v80, v81
    v_cvt_pk_bf16_f32 v67, v82, v83
    v_mfma_f32_16x16x32_bf16 v[92:95], v[140:143], a[28:31], v[92:95]
    v_mul_f32 v68, v187, v68
    v_mul_f32 v69, v187, v69
    v_mfma_f32_16x16x32_bf16 v[88:91], v[140:143], a[24:27], v[88:91]
    v_mul_f32 v70, v187, v70
    v_mul_f32 v71, v187, v71
    v_mfma_f32_16x16x32_bf16 v[104:107], a[24:27], v[144:147], v[104:107]
    v_mul_f32 v84, v187, v84
    v_mul_f32 v85, v187, v85
    v_mfma_f32_16x16x32_bf16 v[108:111], a[28:31], v[144:147], v[108:111]
    v_mul_f32 v86, v187, v86
    v_mul_f32 v87, v187, v87
    v_mfma_f32_16x16x32_bf16 v[124:127], a[28:31], v[148:151], v[124:127]
    v_cvt_pk_bf16_f32 v68, v68, v69
    v_cvt_pk_bf16_f32 v69, v70, v71
    v_mfma_f32_16x16x32_bf16 v[120:123], a[24:27], v[148:151], v[120:123]
    v_cvt_pk_bf16_f32 v70, v84, v85
    v_cvt_pk_bf16_f32 v71, v86, v87
    buffer_store_dwordx4 v[64:67], v12, s[12:15], s84 offen offset:0 sc1
    ds_write_b128 v12, v[64:67] offset:0
    buffer_store_dwordx4 v[68:71], v12, s[12:15], s84 offen offset:256 sc1
    ds_write_b128 v12, v[68:71] offset:256
    v_pk_mul_f32 v[72:73], v[188:189], v[72:73] op_sel:[1,0] op_sel_hi:[1,1]
    v_pk_mul_f32 v[74:75], v[188:189], v[74:75] op_sel:[1,0] op_sel_hi:[1,1]
    v_pk_mul_f32 v[88:89], v[188:189], v[88:89] op_sel:[1,0] op_sel_hi:[1,1]
    v_pk_mul_f32 v[90:91], v[188:189], v[90:91] op_sel:[1,0] op_sel_hi:[1,1]
    v_cvt_pk_bf16_f32 v72, v72, v73
    v_cvt_pk_bf16_f32 v73, v74, v75
    v_cvt_pk_bf16_f32 v74, v88, v89
    v_cvt_pk_bf16_f32 v75, v90, v91
    buffer_store_dwordx4 v[72:75], v12, s[12:15], s84 offen offset:2048 sc1
    ds_write_b128 v12, v[72:75] offset:2048
    v_pk_mul_f32 v[76:77], v[190:191], v[76:77] op_sel:[1,0] op_sel_hi:[1,1]
    v_pk_mul_f32 v[78:79], v[190:191], v[78:79] op_sel:[1,0] op_sel_hi:[1,1]
    v_pk_mul_f32 v[92:93], v[190:191], v[92:93] op_sel:[1,0] op_sel_hi:[1,1]
    v_pk_mul_f32 v[94:95], v[190:191], v[94:95] op_sel:[1,0] op_sel_hi:[1,1]
    v_cvt_pk_bf16_f32 v76, v76, v77
    v_cvt_pk_bf16_f32 v77, v78, v79
    v_cvt_pk_bf16_f32 v78, v92, v93
    v_cvt_pk_bf16_f32 v79, v94, v95
    buffer_store_dwordx4 v[76:79], v12, s[12:15], s84 offen offset:2304 sc1
    ds_write_b128 v12, v[76:79] offset:2304
    s_waitcnt lgkmcnt(4)
    v_pk_mul_f32 v[96:97], v[152:153], v[96:97]
    v_pk_mul_f32 v[98:99], v[154:155], v[98:99]
    v_pk_mul_f32 v[112:113], v[152:153], v[112:113]
    v_pk_mul_f32 v[114:115], v[154:155], v[114:115]
    v_cvt_pk_bf16_f32 v96, v96, v97
    v_cvt_pk_bf16_f32 v97, v98, v99
    v_cvt_pk_bf16_f32 v98, v112, v113
    v_cvt_pk_bf16_f32 v99, v114, v115
    v_mul_f32 v185, 0x3e8293ee, v185
    v_permlane16_swap_b32 v96, v98
    v_permlane16_swap_b32 v97, v99
    buffer_store_dwordx4 v[96:99], v13, s[12:15], s85 offen offset:0 sc1
    ds_write_b128 v13, v[96:99] offset:8192
    v_pk_mul_f32 v[100:101], v[156:157], v[100:101]
    v_pk_mul_f32 v[102:103], v[158:159], v[102:103]
    v_pk_mul_f32 v[116:117], v[156:157], v[116:117]
    v_pk_mul_f32 v[118:119], v[158:159], v[118:119]
    v_cvt_pk_bf16_f32 v100, v100, v101
    v_cvt_pk_bf16_f32 v101, v102, v103
    v_cvt_pk_bf16_f32 v102, v116, v117
    v_cvt_pk_bf16_f32 v103, v118, v119
    v_mul_f32 v187, 0x3e8293ee, v187
    v_permlane16_swap_b32 v100, v102
    v_permlane16_swap_b32 v101, v103
    buffer_store_dwordx4 v[100:103], v13, s[12:15], s85 offen offset:1024 sc1
    ds_write_b128 v13, v[100:103] offset:9216
    v_pk_mul_f32 v[104:105], v[160:161], v[104:105]
    v_pk_mul_f32 v[106:107], v[162:163], v[106:107]
    v_pk_mul_f32 v[120:121], v[160:161], v[120:121]
    v_pk_mul_f32 v[122:123], v[162:163], v[122:123]
    v_cvt_pk_bf16_f32 v104, v104, v105
    v_cvt_pk_bf16_f32 v105, v106, v107
    v_cvt_pk_bf16_f32 v106, v120, v121
    v_cvt_pk_bf16_f32 v107, v122, v123
    v_mul_f32 v189, 0x3e8293ee, v189
    v_permlane16_swap_b32 v104, v106
    v_permlane16_swap_b32 v105, v107
    buffer_store_dwordx4 v[104:107], v13, s[12:15], s85 offen offset:2048 sc1
    ds_write_b128 v13, v[104:107] offset:10240
    v_pk_mul_f32 v[108:109], v[164:165], v[108:109]
    v_pk_mul_f32 v[110:111], v[166:167], v[110:111]
    v_pk_mul_f32 v[124:125], v[164:165], v[124:125]
    v_pk_mul_f32 v[126:127], v[166:167], v[126:127]
    v_cvt_pk_bf16_f32 v108, v108, v109
    v_cvt_pk_bf16_f32 v109, v110, v111
    v_cvt_pk_bf16_f32 v110, v124, v125
    v_cvt_pk_bf16_f32 v111, v126, v127
    v_mul_f32 v191, 0x3e8293ee, v191
    v_permlane16_swap_b32 v108, v110
    v_permlane16_swap_b32 v109, v111
    buffer_store_dwordx4 v[108:111], v13, s[12:15], s85 offen offset:3072 sc1
    ds_write_b128 v13, v[108:111] offset:11264
    v_add_u32 v24, 81920, v5
    s_waitcnt lgkmcnt(0)
    s_barrier
    ds_read_b128 v[128:131], v24 offset:0
    ds_read_b128 v[132:135], v24 offset:1024
    ds_read_b128 v[136:139], v24 offset:2048
    ds_read_b128 v[140:143], v24 offset:3072
    v_pk_mul_f32 v[32:33], v[184:185], v[32:33] op_sel:[1,0] op_sel_hi:[1,1]
    v_pk_mul_f32 v[34:35], v[184:185], v[34:35] op_sel:[1,0] op_sel_hi:[1,1]
    v_pk_mul_f32 v[48:49], v[184:185], v[48:49] op_sel:[1,0] op_sel_hi:[1,1]
    v_pk_mul_f32 v[50:51], v[184:185], v[50:51] op_sel:[1,0] op_sel_hi:[1,1]
    v_cvt_pk_bf16_f32 v8, v32, v33
    v_cvt_pk_bf16_f32 v9, v34, v35
    v_cvt_pk_bf16_f32 v10, v48, v49
    v_cvt_pk_bf16_f32 v11, v50, v51
    v_pk_mul_f32 v[36:37], v[186:187], v[36:37] op_sel:[1,0] op_sel_hi:[1,1]
    v_pk_mul_f32 v[38:39], v[186:187], v[38:39] op_sel:[1,0] op_sel_hi:[1,1]
    v_pk_mul_f32 v[52:53], v[186:187], v[52:53] op_sel:[1,0] op_sel_hi:[1,1]
    v_pk_mul_f32 v[54:55], v[186:187], v[54:55] op_sel:[1,0] op_sel_hi:[1,1]
    v_cvt_pk_bf16_f32 v12, v36, v37
    v_cvt_pk_bf16_f32 v13, v38, v39
    v_cvt_pk_bf16_f32 v14, v52, v53
    v_cvt_pk_bf16_f32 v15, v54, v55
    v_pk_mul_f32 v[40:41], v[188:189], v[40:41] op_sel:[1,0] op_sel_hi:[1,1]
    v_pk_mul_f32 v[42:43], v[188:189], v[42:43] op_sel:[1,0] op_sel_hi:[1,1]
    v_pk_mul_f32 v[56:57], v[188:189], v[56:57] op_sel:[1,0] op_sel_hi:[1,1]
    v_pk_mul_f32 v[58:59], v[188:189], v[58:59] op_sel:[1,0] op_sel_hi:[1,1]
    v_cvt_pk_bf16_f32 v16, v40, v41
    v_cvt_pk_bf16_f32 v17, v42, v43
    v_cvt_pk_bf16_f32 v18, v56, v57
    v_cvt_pk_bf16_f32 v19, v58, v59
    v_pk_mul_f32 v[44:45], v[190:191], v[44:45] op_sel:[1,0] op_sel_hi:[1,1]
    v_pk_mul_f32 v[46:47], v[190:191], v[46:47] op_sel:[1,0] op_sel_hi:[1,1]
    v_pk_mul_f32 v[60:61], v[190:191], v[60:61] op_sel:[1,0] op_sel_hi:[1,1]
    v_pk_mul_f32 v[62:63], v[190:191], v[62:63] op_sel:[1,0] op_sel_hi:[1,1]
    v_cvt_pk_bf16_f32 v20, v44, v45
    v_cvt_pk_bf16_f32 v21, v46, v47
    v_cvt_pk_bf16_f32 v22, v60, v61
    v_cvt_pk_bf16_f32 v23, v62, v63
    v_permlane16_swap_b32 v8, v12
    v_permlane16_swap_b32 v9, v13
    v_permlane16_swap_b32 v10, v14
    v_permlane16_swap_b32 v11, v15
    v_permlane16_swap_b32 v16, v20
    v_permlane16_swap_b32 v17, v21
    v_permlane16_swap_b32 v18, v22
    v_permlane16_swap_b32 v19, v23
    s_waitcnt lgkmcnt(0)
    v_mfma_f32_32x32x16_bf16 v[64:79], v[128:131], v[8:11], 0
    v_mfma_f32_32x32x16_bf16 v[64:79], v[132:135], v[12:15], v[64:79]
    v_and_b32 v25, 7, v1
    v_mov_b32 v26, 0x3f803f80
    v_cmp_eq_u32 vcc, 0, v25
    s_nop 1
    v_cndmask_b32 v200, 0, v26, vcc
    v_cndmask_b32 v201, 0, v26, vcc
    v_cmp_eq_u32 vcc, 4, v25
    s_nop 1
    v_cndmask_b32 v202, 0, v26, vcc
    v_cndmask_b32 v203, 0, v26, vcc
    v_mov_b32 v204, 0xdddddddd
    v_mov_b32 v160, 0
    v_mov_b32 v161, 0
    v_mov_b32 v162, 0
    v_mov_b32 v163, 0
    v_mov_b32 v164, 0
    v_mov_b32 v165, 0
    v_mov_b32 v166, 0
    v_mov_b32 v167, 0
    v_mov_b32 v168, 0
    v_mov_b32 v169, 0
    v_mov_b32 v170, 0
    v_mov_b32 v171, 0
    v_mov_b32 v172, 0
    v_mov_b32 v173, 0
    v_mov_b32 v174, 0
    v_mov_b32 v175, 0
    v_mov_b32 v192, 0
    v_mov_b32 v193, 0
    v_mov_b32 v194, 0
    v_mov_b32 v195, 0
    v_mov_b32 v176, 0
    v_mov_b32 v177, 0
    v_mov_b32 v178, 0
    v_mov_b32 v179, 0
    v_mov_b32 v180, 0
    v_mov_b32 v181, 0
    v_mov_b32 v182, 0
    v_mov_b32 v183, 0
    v_mov_b32 v184, 0
    v_mov_b32 v185, 0
    v_mov_b32 v186, 0
    v_mov_b32 v187, 0
    v_mov_b32 v188, 0
    v_mov_b32 v189, 0
    v_mov_b32 v190, 0
    v_mov_b32 v191, 0
    v_mov_b32 v196, 0
    v_mov_b32 v197, 0
    v_mov_b32 v198, 0
    v_mov_b32 v199, 0
    v_mov_b32 v112, 0
    v_mov_b32 v113, 0
    v_mov_b32 v114, 0
    v_mov_b32 v115, 0
    v_mov_b32 v116, 0
    v_mov_b32 v117, 0
    v_mov_b32 v118, 0
    v_mov_b32 v119, 0
    v_mov_b32 v120, 0
    v_mov_b32 v121, 0
    v_mov_b32 v122, 0
    v_mov_b32 v123, 0
    v_mov_b32 v124, 0
    v_mov_b32 v125, 0
    v_mov_b32 v126, 0
    v_mov_b32 v127, 0
    v_mov_b32 v152, 0
    v_mov_b32 v153, 0
    v_mov_b32 v154, 0
    v_mov_b32 v155, 0
    v_mov_b32 v156, 0
    v_mov_b32 v157, 0
    v_mov_b32 v158, 0
    v_mov_b32 v159, 0
    s_mov_b32 s54, 4
.p2align 3
c_attn_loop:
    v_mfma_f32_32x32x16_bf16 v[80:95], v[128:131], v[16:19], 0
    v_exp_f32 v64, v64
    v_exp_f32 v65, v65
    v_exp_f32 v66, v66
    v_mfma_f32_32x32x16_bf16 v[80:95], v[132:135], v[20:23], v[80:95]
    v_exp_f32 v67, v67
    v_exp_f32 v68, v68
    v_exp_f32 v69, v69
    v_smfmac_f32_32x32x32_bf16 v[176:191], v[152:155], v[112:119], v204
    s_waitcnt lgkmcnt(0)
    v_exp_f32 v70, v70
    v_exp_f32 v71, v71
    v_exp_f32 v72, v72
    v_smfmac_f32_16x16x64_bf16 v[196:199], v[200:203], v[112:119], v204
    ds_read_b128 v[144:147], v24 offset:8192
    v_exp_f32 v73, v73
    v_exp_f32 v74, v74
    v_smfmac_f32_32x32x32_bf16 v[176:191], v[156:159], v[120:127], v204
    v_exp_f32 v75, v75
    v_exp_f32 v76, v76
    v_exp_f32 v77, v77
    v_smfmac_f32_16x16x64_bf16 v[196:199], v[200:203], v[120:127], v204
    ds_read_b128 v[148:151], v24 offset:9216
    v_exp_f32 v78, v78
    v_exp_f32 v79, v79
    v_mfma_f32_32x32x16_bf16 v[96:111], v[136:139], v[8:11], 0
    v_exp_f32 v80, v80
    v_exp_f32 v81, v81
    v_exp_f32 v82, v82
    v_mfma_f32_32x32x16_bf16 v[96:111], v[140:143], v[12:15], v[96:111]
    s_waitcnt lgkmcnt(1)
    v_exp_f32 v83, v83
    v_exp_f32 v84, v84
    v_exp_f32 v85, v85
    v_smfmac_f32_32x32x32_bf16 v[160:175], v[144:147], v[64:71], v204
    s_waitcnt lgkmcnt(0)
    v_exp_f32 v86, v86
    v_exp_f32 v87, v87
    v_exp_f32 v88, v88
    v_smfmac_f32_16x16x64_bf16 v[192:195], v[200:203], v[64:71], v204
    ds_read_b128 v[128:131], v24 offset:4096
    v_exp_f32 v89, v89
    v_exp_f32 v90, v90
    v_smfmac_f32_32x32x32_bf16 v[160:175], v[148:151], v[72:79], v204
    v_exp_f32 v91, v91
    v_exp_f32 v92, v92
    v_exp_f32 v93, v93
    v_smfmac_f32_16x16x64_bf16 v[192:195], v[200:203], v[72:79], v204
    ds_read_b128 v[132:135], v24 offset:5120
    v_exp_f32 v94, v94
    v_exp_f32 v95, v95
    v_mfma_f32_32x32x16_bf16 v[112:127], v[136:139], v[16:19], 0
    s_cmp_eq_u32 s54, 4
    v_exp_f32 v96, v96
    v_exp_f32 v97, v97
    v_exp_f32 v98, v98
    v_mfma_f32_32x32x16_bf16 v[112:127], v[140:143], v[20:23], v[112:127]
    v_exp_f32 v99, v99
    v_exp_f32 v100, v100
    v_exp_f32 v101, v101
    v_smfmac_f32_32x32x32_bf16 v[176:191], v[144:147], v[80:87], v204
    s_waitcnt lgkmcnt(0)
    v_exp_f32 v102, v102
    v_exp_f32 v103, v103
    v_exp_f32 v104, v104
    v_smfmac_f32_16x16x64_bf16 v[196:199], v[200:203], v[80:87], v204
    ds_read_b128 v[152:155], v24 offset:10240
    v_exp_f32 v105, v105
    v_exp_f32 v106, v106
    v_smfmac_f32_32x32x32_bf16 v[176:191], v[148:151], v[88:95], v204
    v_exp_f32 v107, v107
    v_exp_f32 v108, v108
    v_exp_f32 v109, v109
    v_smfmac_f32_16x16x64_bf16 v[196:199], v[200:203], v[88:95], v204
    ds_read_b128 v[156:159], v24 offset:11264
    v_exp_f32 v110, v110
    v_exp_f32 v111, v111
    v_mfma_f32_32x32x16_bf16 v[64:79], v[128:131], v[8:11], 0
    s_cbranch_scc0 c_attn_nofl
    s_mov_b64 exec, 0xff
    s_waitcnt vmcnt(0)
    buffer_store_dword v29, v28, s[12:15], s53 offen sc1
    s_mov_b64 exec, -1
c_attn_nofl:
    v_exp_f32 v112, v112
    v_exp_f32 v113, v113
    v_exp_f32 v114, v114
    v_mfma_f32_32x32x16_bf16 v[64:79], v[132:135], v[12:15], v[64:79]
    s_waitcnt lgkmcnt(1)
    v_exp_f32 v115, v115
    v_exp_f32 v116, v116
    v_exp_f32 v117, v117
    v_smfmac_f32_32x32x32_bf16 v[160:175], v[152:155], v[96:103], v204
    s_waitcnt lgkmcnt(0)
    v_exp_f32 v118, v118
    v_exp_f32 v119, v119
    v_exp_f32 v120, v120
    v_smfmac_f32_16x16x64_bf16 v[192:195], v[200:203], v[96:103], v204
    ds_read_b128 v[136:139], v24 offset:6144
    v_exp_f32 v121, v121
    v_exp_f32 v122, v122
    v_smfmac_f32_32x32x32_bf16 v[160:175], v[156:159], v[104:111], v204
    v_exp_f32 v123, v123
    v_exp_f32 v124, v124
    v_exp_f32 v125, v125
    v_smfmac_f32_16x16x64_bf16 v[192:195], v[200:203], v[104:111], v204
    ds_read_b128 v[140:143], v24 offset:7168
    v_exp_f32 v126, v126
    v_exp_f32 v127, v127
    v_mfma_f32_32x32x16_bf16 v[80:95], v[128:131], v[16:19], 0
    s_cmp_eq_u32 s54, 4
    v_exp_f32 v64, v64
    v_exp_f32 v65, v65
    v_exp_f32 v66, v66
    v_mfma_f32_32x32x16_bf16 v[80:95], v[132:135], v[20:23], v[80:95]
    v_exp_f32 v67, v67
    v_exp_f32 v68, v68
    v_exp_f32 v69, v69
    v_smfmac_f32_32x32x32_bf16 v[176:191], v[152:155], v[112:119], v204
    s_waitcnt lgkmcnt(0)
    v_exp_f32 v70, v70
    v_exp_f32 v71, v71
    v_exp_f32 v72, v72
    v_smfmac_f32_16x16x64_bf16 v[196:199], v[200:203], v[112:119], v204
    ds_read_b128 v[144:147], v24 offset:12288
    v_exp_f32 v73, v73
    v_exp_f32 v74, v74
    v_smfmac_f32_32x32x32_bf16 v[176:191], v[156:159], v[120:127], v204
    v_exp_f32 v75, v75
    v_exp_f32 v76, v76
    v_exp_f32 v77, v77
    v_smfmac_f32_16x16x64_bf16 v[196:199], v[200:203], v[120:127], v204
    ds_read_b128 v[148:151], v24 offset:13312
    v_exp_f32 v78, v78
    v_exp_f32 v79, v79
    v_mfma_f32_32x32x16_bf16 v[96:111], v[136:139], v[8:11], 0
    s_cbranch_scc1 c_attn_nobar
    s_barrier
c_attn_nobar:
    v_exp_f32 v80, v80
    v_exp_f32 v81, v81
    v_exp_f32 v82, v82
    v_mfma_f32_32x32x16_bf16 v[96:111], v[140:143], v[12:15], v[96:111]
    s_waitcnt lgkmcnt(1)
    v_exp_f32 v83, v83
    v_exp_f32 v84, v84
    v_exp_f32 v85, v85
    v_smfmac_f32_32x32x32_bf16 v[160:175], v[144:147], v[64:71], v204
    s_waitcnt lgkmcnt(0)
    v_exp_f32 v86, v86
    v_exp_f32 v87, v87
    v_exp_f32 v88, v88
    v_smfmac_f32_16x16x64_bf16 v[192:195], v[200:203], v[64:71], v204
    ds_read_b128 v[128:131], v24 offset:16384
    v_exp_f32 v89, v89
    v_exp_f32 v90, v90
    v_smfmac_f32_32x32x32_bf16 v[160:175], v[148:151], v[72:79], v204
    v_exp_f32 v91, v91
    v_exp_f32 v92, v92
    v_exp_f32 v93, v93
    v_smfmac_f32_16x16x64_bf16 v[192:195], v[200:203], v[72:79], v204
    ds_read_b128 v[132:135], v24 offset:17408
    v_exp_f32 v94, v94
    v_exp_f32 v95, v95
    v_mfma_f32_32x32x16_bf16 v[112:127], v[136:139], v[16:19], 0
    v_exp_f32 v96, v96
    v_exp_f32 v97, v97
    v_exp_f32 v98, v98
    v_mfma_f32_32x32x16_bf16 v[112:127], v[140:143], v[20:23], v[112:127]
    v_exp_f32 v99, v99
    v_exp_f32 v100, v100
    v_exp_f32 v101, v101
    v_smfmac_f32_32x32x32_bf16 v[176:191], v[144:147], v[80:87], v204
    s_waitcnt lgkmcnt(0)
    v_exp_f32 v102, v102
    v_exp_f32 v103, v103
    v_exp_f32 v104, v104
    v_smfmac_f32_16x16x64_bf16 v[196:199], v[200:203], v[80:87], v204
    ds_read_b128 v[152:155], v24 offset:14336
    v_exp_f32 v105, v105
    v_exp_f32 v106, v106
    v_smfmac_f32_32x32x32_bf16 v[176:191], v[148:151], v[88:95], v204
    v_exp_f32 v107, v107
    v_exp_f32 v108, v108
    v_exp_f32 v109, v109
    v_smfmac_f32_16x16x64_bf16 v[196:199], v[200:203], v[88:95], v204
    ds_read_b128 v[156:159], v24 offset:15360
    v_exp_f32 v110, v110
    v_exp_f32 v111, v111
    v_mfma_f32_32x32x16_bf16 v[64:79], v[128:131], v[8:11], 0
    v_exp_f32 v112, v112
    v_exp_f32 v113, v113
    v_exp_f32 v114, v114
    v_mfma_f32_32x32x16_bf16 v[64:79], v[132:135], v[12:15], v[64:79]
    s_waitcnt lgkmcnt(1)
    v_exp_f32 v115, v115
    v_exp_f32 v116, v116
    v_exp_f32 v117, v117
    v_smfmac_f32_32x32x32_bf16 v[160:175], v[152:155], v[96:103], v204
    s_waitcnt lgkmcnt(0)
    v_exp_f32 v118, v118
    v_exp_f32 v119, v119
    v_exp_f32 v120, v120
    v_smfmac_f32_16x16x64_bf16 v[192:195], v[200:203], v[96:103], v204
    ds_read_b128 v[136:139], v24 offset:18432
    v_exp_f32 v121, v121
    v_exp_f32 v122, v122
    v_smfmac_f32_32x32x32_bf16 v[160:175], v[156:159], v[104:111], v204
    v_exp_f32 v123, v123
    v_exp_f32 v124, v124
    v_exp_f32 v125, v125
    v_smfmac_f32_16x16x64_bf16 v[192:195], v[200:203], v[104:111], v204
    ds_read_b128 v[140:143], v24 offset:19456
    v_exp_f32 v126, v126
    v_exp_f32 v127, v127
    v_mfma_f32_32x32x16_bf16 v[80:95], v[128:131], v[16:19], 0
    v_exp_f32 v64, v64
    v_exp_f32 v65, v65
    v_exp_f32 v66, v66
    v_mfma_f32_32x32x16_bf16 v[80:95], v[132:135], v[20:23], v[80:95]
    v_exp_f32 v67, v67
    v_exp_f32 v68, v68
    v_exp_f32 v69, v69
    v_smfmac_f32_32x32x32_bf16 v[176:191], v[152:155], v[112:119], v204
    s_waitcnt lgkmcnt(0)
    v_exp_f32 v70, v70
    v_exp_f32 v71, v71
    v_exp_f32 v72, v72
    v_smfmac_f32_16x16x64_bf16 v[196:199], v[200:203], v[112:119], v204
    ds_read_b128 v[144:147], v24 offset:24576
    v_exp_f32 v73, v73
    v_exp_f32 v74, v74
    v_smfmac_f32_32x32x32_bf16 v[176:191], v[156:159], v[120:127], v204
    v_exp_f32 v75, v75
    v_exp_f32 v76, v76
    v_exp_f32 v77, v77
    v_smfmac_f32_16x16x64_bf16 v[196:199], v[200:203], v[120:127], v204
    ds_read_b128 v[148:151], v24 offset:25600
    v_exp_f32 v78, v78
    v_exp_f32 v79, v79
    v_mfma_f32_32x32x16_bf16 v[96:111], v[136:139], v[8:11], 0
    v_exp_f32 v80, v80
    v_exp_f32 v81, v81
    v_exp_f32 v82, v82
    v_mfma_f32_32x32x16_bf16 v[96:111], v[140:143], v[12:15], v[96:111]
    s_waitcnt lgkmcnt(1)
    v_exp_f32 v83, v83
    v_exp_f32 v84, v84
    v_exp_f32 v85, v85
    v_smfmac_f32_32x32x32_bf16 v[160:175], v[144:147], v[64:71], v204
    s_waitcnt lgkmcnt(0)
    v_exp_f32 v86, v86
    v_exp_f32 v87, v87
    v_exp_f32 v88, v88
    v_smfmac_f32_16x16x64_bf16 v[192:195], v[200:203], v[64:71], v204
    ds_read_b128 v[128:131], v24 offset:20480
    v_exp_f32 v89, v89
    v_exp_f32 v90, v90
    v_smfmac_f32_32x32x32_bf16 v[160:175], v[148:151], v[72:79], v204
    v_exp_f32 v91, v91
    v_exp_f32 v92, v92
    v_exp_f32 v93, v93
    v_smfmac_f32_16x16x64_bf16 v[192:195], v[200:203], v[72:79], v204
    ds_read_b128 v[132:135], v24 offset:21504
    v_exp_f32 v94, v94
    v_exp_f32 v95, v95
    v_mfma_f32_32x32x16_bf16 v[112:127], v[136:139], v[16:19], 0
    v_exp_f32 v96, v96
    v_exp_f32 v97, v97
    v_exp_f32 v98, v98
    v_mfma_f32_32x32x16_bf16 v[112:127], v[140:143], v[20:23], v[112:127]
    v_exp_f32 v99, v99
    v_exp_f32 v100, v100
    v_exp_f32 v101, v101
    v_smfmac_f32_32x32x32_bf16 v[176:191], v[144:147], v[80:87], v204
    s_waitcnt lgkmcnt(0)
    v_exp_f32 v102, v102
    v_exp_f32 v103, v103
    v_exp_f32 v104, v104
    v_smfmac_f32_16x16x64_bf16 v[196:199], v[200:203], v[80:87], v204
    ds_read_b128 v[152:155], v24 offset:26624
    v_exp_f32 v105, v105
    v_exp_f32 v106, v106
    v_smfmac_f32_32x32x32_bf16 v[176:191], v[148:151], v[88:95], v204
    v_exp_f32 v107, v107
    v_exp_f32 v108, v108
    v_exp_f32 v109, v109
    v_smfmac_f32_16x16x64_bf16 v[196:199], v[200:203], v[88:95], v204
    ds_read_b128 v[156:159], v24 offset:27648
    v_exp_f32 v110, v110
    v_exp_f32 v111, v111
    v_mfma_f32_32x32x16_bf16 v[64:79], v[128:131], v[8:11], 0
    v_exp_f32 v112, v112
    v_exp_f32 v113, v113
    v_exp_f32 v114, v114
    v_mfma_f32_32x32x16_bf16 v[64:79], v[132:135], v[12:15], v[64:79]
    s_waitcnt lgkmcnt(1)
    v_exp_f32 v115, v115
    v_exp_f32 v116, v116
    v_exp_f32 v117, v117
    v_smfmac_f32_32x32x32_bf16 v[160:175], v[152:155], v[96:103], v204
    s_waitcnt lgkmcnt(0)
    v_exp_f32 v118, v118
    v_exp_f32 v119, v119
    v_exp_f32 v120, v120
    v_smfmac_f32_16x16x64_bf16 v[192:195], v[200:203], v[96:103], v204
    ds_read_b128 v[136:139], v24 offset:22528
    v_exp_f32 v121, v121
    v_exp_f32 v122, v122
    v_smfmac_f32_32x32x32_bf16 v[160:175], v[156:159], v[104:111], v204
    v_exp_f32 v123, v123
    v_exp_f32 v124, v124
    v_exp_f32 v125, v125
    v_smfmac_f32_16x16x64_bf16 v[192:195], v[200:203], v[104:111], v204
    ds_read_b128 v[140:143], v24 offset:23552
    v_exp_f32 v126, v126
    v_exp_f32 v127, v127
    v_mfma_f32_32x32x16_bf16 v[80:95], v[128:131], v[16:19], 0
    v_exp_f32 v64, v64
    v_exp_f32 v65, v65
    v_exp_f32 v66, v66
    v_mfma_f32_32x32x16_bf16 v[80:95], v[132:135], v[20:23], v[80:95]
    v_exp_f32 v67, v67
    v_exp_f32 v68, v68
    v_exp_f32 v69, v69
    v_smfmac_f32_32x32x32_bf16 v[176:191], v[152:155], v[112:119], v204
    s_waitcnt lgkmcnt(0)
    v_exp_f32 v70, v70
    v_exp_f32 v71, v71
    v_exp_f32 v72, v72
    v_smfmac_f32_16x16x64_bf16 v[196:199], v[200:203], v[112:119], v204
    ds_read_b128 v[144:147], v24 offset:28672
    v_exp_f32 v73, v73
    v_exp_f32 v74, v74
    v_smfmac_f32_32x32x32_bf16 v[176:191], v[156:159], v[120:127], v204
    v_exp_f32 v75, v75
    v_exp_f32 v76, v76
    v_exp_f32 v77, v77
    v_smfmac_f32_16x16x64_bf16 v[196:199], v[200:203], v[120:127], v204
    ds_read_b128 v[148:151], v24 offset:29696
    v_exp_f32 v78, v78
    v_exp_f32 v79, v79
    v_mfma_f32_32x32x16_bf16 v[96:111], v[136:139], v[8:11], 0
    v_exp_f32 v80, v80
    v_exp_f32 v81, v81
    v_exp_f32 v82, v82
    v_mfma_f32_32x32x16_bf16 v[96:111], v[140:143], v[12:15], v[96:111]
    s_waitcnt lgkmcnt(1)
    v_exp_f32 v83, v83
    v_exp_f32 v84, v84
    v_exp_f32 v85, v85
    v_smfmac_f32_32x32x32_bf16 v[160:175], v[144:147], v[64:71], v204
    s_waitcnt lgkmcnt(0)
    s_barrier
    v_exp_f32 v86, v86
    v_exp_f32 v87, v87
    v_exp_f32 v88, v88
    v_smfmac_f32_16x16x64_bf16 v[192:195], v[200:203], v[64:71], v204
    ds_read_b128 v[128:131], v24 offset:32768
    v_exp_f32 v89, v89
    v_exp_f32 v90, v90
    v_smfmac_f32_32x32x32_bf16 v[160:175], v[148:151], v[72:79], v204
    v_exp_f32 v91, v91
    v_exp_f32 v92, v92
    v_exp_f32 v93, v93
    v_smfmac_f32_16x16x64_bf16 v[192:195], v[200:203], v[72:79], v204
    ds_read_b128 v[132:135], v24 offset:33792
    v_exp_f32 v94, v94
    v_exp_f32 v95, v95
    v_mfma_f32_32x32x16_bf16 v[112:127], v[136:139], v[16:19], 0
    v_exp_f32 v96, v96
    v_exp_f32 v97, v97
    v_exp_f32 v98, v98
    v_mfma_f32_32x32x16_bf16 v[112:127], v[140:143], v[20:23], v[112:127]
    v_exp_f32 v99, v99
    v_exp_f32 v100, v100
    v_exp_f32 v101, v101
    v_smfmac_f32_32x32x32_bf16 v[176:191], v[144:147], v[80:87], v204
    s_waitcnt lgkmcnt(0)
    v_exp_f32 v102, v102
    v_exp_f32 v103, v103
    v_exp_f32 v104, v104
    v_smfmac_f32_16x16x64_bf16 v[196:199], v[200:203], v[80:87], v204
    ds_read_b128 v[152:155], v24 offset:30720
    v_exp_f32 v105, v105
    v_exp_f32 v106, v106
    v_smfmac_f32_32x32x32_bf16 v[176:191], v[148:151], v[88:95], v204
    v_exp_f32 v107, v107
    v_exp_f32 v108, v108
    v_exp_f32 v109, v109
    v_smfmac_f32_16x16x64_bf16 v[196:199], v[200:203], v[88:95], v204
    ds_read_b128 v[156:159], v24 offset:31744
    v_exp_f32 v110, v110
    v_exp_f32 v111, v111
    v_mfma_f32_32x32x16_bf16 v[64:79], v[128:131], v[8:11], 0
    v_exp_f32 v112, v112
    v_exp_f32 v113, v113
    v_exp_f32 v114, v114
    v_mfma_f32_32x32x16_bf16 v[64:79], v[132:135], v[12:15], v[64:79]
    s_waitcnt lgkmcnt(1)
    v_exp_f32 v115, v115
    v_exp_f32 v116, v116
    v_exp_f32 v117, v117
    v_smfmac_f32_32x32x32_bf16 v[160:175], v[152:155], v[96:103], v204
    s_waitcnt lgkmcnt(0)
    v_exp_f32 v118, v118
    v_exp_f32 v119, v119
    v_exp_f32 v120, v120
    v_smfmac_f32_16x16x64_bf16 v[192:195], v[200:203], v[96:103], v204
    ds_read_b128 v[136:139], v24 offset:34816
    v_exp_f32 v121, v121
    v_exp_f32 v122, v122
    v_smfmac_f32_32x32x32_bf16 v[160:175], v[156:159], v[104:111], v204
    v_exp_f32 v123, v123
    v_exp_f32 v124, v124
    v_exp_f32 v125, v125
    v_smfmac_f32_16x16x64_bf16 v[192:195], v[200:203], v[104:111], v204
    ds_read_b128 v[140:143], v24 offset:35840
    v_exp_f32 v126, v126
    v_exp_f32 v127, v127
    v_mfma_f32_32x32x16_bf16 v[80:95], v[128:131], v[16:19], 0
    v_exp_f32 v64, v64
    v_exp_f32 v65, v65
    v_exp_f32 v66, v66
    v_mfma_f32_32x32x16_bf16 v[80:95], v[132:135], v[20:23], v[80:95]
    v_exp_f32 v67, v67
    v_exp_f32 v68, v68
    v_exp_f32 v69, v69
    v_smfmac_f32_32x32x32_bf16 v[176:191], v[152:155], v[112:119], v204
    s_waitcnt lgkmcnt(0)
    v_exp_f32 v70, v70
    v_exp_f32 v71, v71
    v_exp_f32 v72, v72
    v_smfmac_f32_16x16x64_bf16 v[196:199], v[200:203], v[112:119], v204
    ds_read_b128 v[144:147], v24 offset:40960
    v_exp_f32 v73, v73
    v_exp_f32 v74, v74
    v_smfmac_f32_32x32x32_bf16 v[176:191], v[156:159], v[120:127], v204
    v_exp_f32 v75, v75
    v_exp_f32 v76, v76
    v_exp_f32 v77, v77
    v_smfmac_f32_16x16x64_bf16 v[196:199], v[200:203], v[120:127], v204
    ds_read_b128 v[148:151], v24 offset:41984
    v_exp_f32 v78, v78
    v_exp_f32 v79, v79
    v_mfma_f32_32x32x16_bf16 v[96:111], v[136:139], v[8:11], 0
    v_exp_f32 v80, v80
    v_exp_f32 v81, v81
    v_exp_f32 v82, v82
    v_mfma_f32_32x32x16_bf16 v[96:111], v[140:143], v[12:15], v[96:111]
    s_waitcnt lgkmcnt(1)
    v_exp_f32 v83, v83
    v_exp_f32 v84, v84
    v_exp_f32 v85, v85
    v_smfmac_f32_32x32x32_bf16 v[160:175], v[144:147], v[64:71], v204
    s_waitcnt lgkmcnt(0)
    v_exp_f32 v86, v86
    v_exp_f32 v87, v87
    v_exp_f32 v88, v88
    v_smfmac_f32_16x16x64_bf16 v[192:195], v[200:203], v[64:71], v204
    ds_read_b128 v[128:131], v24 offset:36864
    v_exp_f32 v89, v89
    v_exp_f32 v90, v90
    v_smfmac_f32_32x32x32_bf16 v[160:175], v[148:151], v[72:79], v204
    v_exp_f32 v91, v91
    v_exp_f32 v92, v92
    v_exp_f32 v93, v93
    v_smfmac_f32_16x16x64_bf16 v[192:195], v[200:203], v[72:79], v204
    ds_read_b128 v[132:135], v24 offset:37888
    v_exp_f32 v94, v94
    v_exp_f32 v95, v95
    v_mfma_f32_32x32x16_bf16 v[112:127], v[136:139], v[16:19], 0
    v_exp_f32 v96, v96
    v_exp_f32 v97, v97
    v_exp_f32 v98, v98
    v_mfma_f32_32x32x16_bf16 v[112:127], v[140:143], v[20:23], v[112:127]
    v_exp_f32 v99, v99
    v_exp_f32 v100, v100
    v_exp_f32 v101, v101
    v_smfmac_f32_32x32x32_bf16 v[176:191], v[144:147], v[80:87], v204
    s_waitcnt lgkmcnt(0)
    v_exp_f32 v102, v102
    v_exp_f32 v103, v103
    v_exp_f32 v104, v104
    v_smfmac_f32_16x16x64_bf16 v[196:199], v[200:203], v[80:87], v204
    ds_read_b128 v[152:155], v24 offset:43008
    v_exp_f32 v105, v105
    v_exp_f32 v106, v106
    v_smfmac_f32_32x32x32_bf16 v[176:191], v[148:151], v[88:95], v204
    v_exp_f32 v107, v107
    v_exp_f32 v108, v108
    v_exp_f32 v109, v109
    v_smfmac_f32_16x16x64_bf16 v[196:199], v[200:203], v[88:95], v204
    ds_read_b128 v[156:159], v24 offset:44032
    v_exp_f32 v110, v110
    v_exp_f32 v111, v111
    v_mfma_f32_32x32x16_bf16 v[64:79], v[128:131], v[8:11], 0
    v_exp_f32 v112, v112
    v_exp_f32 v113, v113
    v_exp_f32 v114, v114
    v_mfma_f32_32x32x16_bf16 v[64:79], v[132:135], v[12:15], v[64:79]
    s_waitcnt lgkmcnt(1)
    v_exp_f32 v115, v115
    v_exp_f32 v116, v116
    v_exp_f32 v117, v117
    v_smfmac_f32_32x32x32_bf16 v[160:175], v[152:155], v[96:103], v204
    s_waitcnt lgkmcnt(0)
    v_exp_f32 v118, v118
    v_exp_f32 v119, v119
    v_exp_f32 v120, v120
    v_smfmac_f32_16x16x64_bf16 v[192:195], v[200:203], v[96:103], v204
    ds_read_b128 v[136:139], v24 offset:38912
    v_exp_f32 v121, v121
    v_exp_f32 v122, v122
    v_smfmac_f32_32x32x32_bf16 v[160:175], v[156:159], v[104:111], v204
    v_exp_f32 v123, v123
    v_exp_f32 v124, v124
    v_exp_f32 v125, v125
    v_smfmac_f32_16x16x64_bf16 v[192:195], v[200:203], v[104:111], v204
    ds_read_b128 v[140:143], v24 offset:39936
    v_exp_f32 v126, v126
    v_exp_f32 v127, v127
    v_mfma_f32_32x32x16_bf16 v[80:95], v[128:131], v[16:19], 0
    v_exp_f32 v64, v64
    v_exp_f32 v65, v65
    v_exp_f32 v66, v66
    v_mfma_f32_32x32x16_bf16 v[80:95], v[132:135], v[20:23], v[80:95]
    v_exp_f32 v67, v67
    v_exp_f32 v68, v68
    v_exp_f32 v69, v69
    v_smfmac_f32_32x32x32_bf16 v[176:191], v[152:155], v[112:119], v204
    s_waitcnt lgkmcnt(0)
    v_exp_f32 v70, v70
    v_exp_f32 v71, v71
    v_exp_f32 v72, v72
    v_smfmac_f32_16x16x64_bf16 v[196:199], v[200:203], v[112:119], v204
    ds_read_b128 v[144:147], v24 offset:45056
    v_exp_f32 v73, v73
    v_exp_f32 v74, v74
    v_smfmac_f32_32x32x32_bf16 v[176:191], v[156:159], v[120:127], v204
    v_exp_f32 v75, v75
    v_exp_f32 v76, v76
    v_exp_f32 v77, v77
    v_smfmac_f32_16x16x64_bf16 v[196:199], v[200:203], v[120:127], v204
    ds_read_b128 v[148:151], v24 offset:46080
    v_exp_f32 v78, v78
    v_exp_f32 v79, v79
    v_mfma_f32_32x32x16_bf16 v[96:111], v[136:139], v[8:11], 0
    v_exp_f32 v80, v80
    v_exp_f32 v81, v81
    v_exp_f32 v82, v82
    v_mfma_f32_32x32x16_bf16 v[96:111], v[140:143], v[12:15], v[96:111]
    s_waitcnt lgkmcnt(1)
    v_exp_f32 v83, v83
    v_exp_f32 v84, v84
    v_exp_f32 v85, v85
    v_smfmac_f32_32x32x32_bf16 v[160:175], v[144:147], v[64:71], v204
    s_waitcnt lgkmcnt(0)
    s_barrier
    v_exp_f32 v86, v86
    v_exp_f32 v87, v87
    v_exp_f32 v88, v88
    v_smfmac_f32_16x16x64_bf16 v[192:195], v[200:203], v[64:71], v204
    ds_read_b128 v[128:131], v24 offset:49152
    v_exp_f32 v89, v89
    v_exp_f32 v90, v90
    v_smfmac_f32_32x32x32_bf16 v[160:175], v[148:151], v[72:79], v204
    v_exp_f32 v91, v91
    v_exp_f32 v92, v92
    v_exp_f32 v93, v93
    v_smfmac_f32_16x16x64_bf16 v[192:195], v[200:203], v[72:79], v204
    ds_read_b128 v[132:135], v24 offset:50176
    v_exp_f32 v94, v94
    v_exp_f32 v95, v95
    v_mfma_f32_32x32x16_bf16 v[112:127], v[136:139], v[16:19], 0
    v_exp_f32 v96, v96
    v_exp_f32 v97, v97
    v_exp_f32 v98, v98
    v_mfma_f32_32x32x16_bf16 v[112:127], v[140:143], v[20:23], v[112:127]
    v_exp_f32 v99, v99
    v_exp_f32 v100, v100
    v_exp_f32 v101, v101
    v_smfmac_f32_32x32x32_bf16 v[176:191], v[144:147], v[80:87], v204
    s_waitcnt lgkmcnt(0)
    v_exp_f32 v102, v102
    v_exp_f32 v103, v103
    v_exp_f32 v104, v104
    v_smfmac_f32_16x16x64_bf16 v[196:199], v[200:203], v[80:87], v204
    ds_read_b128 v[152:155], v24 offset:47104
    v_exp_f32 v105, v105
    v_exp_f32 v106, v106
    v_smfmac_f32_32x32x32_bf16 v[176:191], v[148:151], v[88:95], v204
    v_exp_f32 v107, v107
    v_exp_f32 v108, v108
    v_exp_f32 v109, v109
    v_smfmac_f32_16x16x64_bf16 v[196:199], v[200:203], v[88:95], v204
    ds_read_b128 v[156:159], v24 offset:48128
    v_exp_f32 v110, v110
    v_exp_f32 v111, v111
    v_mfma_f32_32x32x16_bf16 v[64:79], v[128:131], v[8:11], 0
    v_exp_f32 v112, v112
    v_exp_f32 v113, v113
    v_exp_f32 v114, v114
    v_mfma_f32_32x32x16_bf16 v[64:79], v[132:135], v[12:15], v[64:79]
    s_waitcnt lgkmcnt(1)
    v_exp_f32 v115, v115
    v_exp_f32 v116, v116
    v_exp_f32 v117, v117
    v_smfmac_f32_32x32x32_bf16 v[160:175], v[152:155], v[96:103], v204
    s_waitcnt lgkmcnt(0)
    v_exp_f32 v118, v118
    v_exp_f32 v119, v119
    v_exp_f32 v120, v120
    v_smfmac_f32_16x16x64_bf16 v[192:195], v[200:203], v[96:103], v204
    ds_read_b128 v[136:139], v24 offset:51200
    v_exp_f32 v121, v121
    v_exp_f32 v122, v122
    v_smfmac_f32_32x32x32_bf16 v[160:175], v[156:159], v[104:111], v204
    v_exp_f32 v123, v123
    v_exp_f32 v124, v124
    v_exp_f32 v125, v125
    v_smfmac_f32_16x16x64_bf16 v[192:195], v[200:203], v[104:111], v204
    ds_read_b128 v[140:143], v24 offset:52224
    v_exp_f32 v126, v126
    v_exp_f32 v127, v127
    v_mfma_f32_32x32x16_bf16 v[80:95], v[128:131], v[16:19], 0
    v_exp_f32 v64, v64
    v_exp_f32 v65, v65
    v_exp_f32 v66, v66
    v_mfma_f32_32x32x16_bf16 v[80:95], v[132:135], v[20:23], v[80:95]
    v_exp_f32 v67, v67
    v_exp_f32 v68, v68
    v_exp_f32 v69, v69
    v_smfmac_f32_32x32x32_bf16 v[176:191], v[152:155], v[112:119], v204
    s_waitcnt lgkmcnt(0)
    v_exp_f32 v70, v70
    v_exp_f32 v71, v71
    v_exp_f32 v72, v72
    v_smfmac_f32_16x16x64_bf16 v[196:199], v[200:203], v[112:119], v204
    ds_read_b128 v[144:147], v24 offset:57344
    v_exp_f32 v73, v73
    v_exp_f32 v74, v74
    v_smfmac_f32_32x32x32_bf16 v[176:191], v[156:159], v[120:127], v204
    v_exp_f32 v75, v75
    v_exp_f32 v76, v76
    v_exp_f32 v77, v77
    v_smfmac_f32_16x16x64_bf16 v[196:199], v[200:203], v[120:127], v204
    ds_read_b128 v[148:151], v24 offset:58368
    v_exp_f32 v78, v78
    v_exp_f32 v79, v79
    v_mfma_f32_32x32x16_bf16 v[96:111], v[136:139], v[8:11], 0
    v_exp_f32 v80, v80
    v_exp_f32 v81, v81
    v_exp_f32 v82, v82
    v_mfma_f32_32x32x16_bf16 v[96:111], v[140:143], v[12:15], v[96:111]
    s_waitcnt lgkmcnt(1)
    v_exp_f32 v83, v83
    v_exp_f32 v84, v84
    v_exp_f32 v85, v85
    v_smfmac_f32_32x32x32_bf16 v[160:175], v[144:147], v[64:71], v204
    s_waitcnt lgkmcnt(0)
    v_exp_f32 v86, v86
    v_exp_f32 v87, v87
    v_exp_f32 v88, v88
    v_smfmac_f32_16x16x64_bf16 v[192:195], v[200:203], v[64:71], v204
    ds_read_b128 v[128:131], v24 offset:53248
    v_exp_f32 v89, v89
    v_exp_f32 v90, v90
    v_smfmac_f32_32x32x32_bf16 v[160:175], v[148:151], v[72:79], v204
    v_exp_f32 v91, v91
    v_exp_f32 v92, v92
    v_exp_f32 v93, v93
    v_smfmac_f32_16x16x64_bf16 v[192:195], v[200:203], v[72:79], v204
    ds_read_b128 v[132:135], v24 offset:54272
    v_exp_f32 v94, v94
    v_exp_f32 v95, v95
    v_mfma_f32_32x32x16_bf16 v[112:127], v[136:139], v[16:19], 0
    v_exp_f32 v96, v96
    v_exp_f32 v97, v97
    v_exp_f32 v98, v98
    v_mfma_f32_32x32x16_bf16 v[112:127], v[140:143], v[20:23], v[112:127]
    v_exp_f32 v99, v99
    v_exp_f32 v100, v100
    v_exp_f32 v101, v101
    v_smfmac_f32_32x32x32_bf16 v[176:191], v[144:147], v[80:87], v204
    s_waitcnt lgkmcnt(0)
    v_exp_f32 v102, v102
    v_exp_f32 v103, v103
    v_exp_f32 v104, v104
    v_smfmac_f32_16x16x64_bf16 v[196:199], v[200:203], v[80:87], v204
    ds_read_b128 v[152:155], v24 offset:59392
    v_exp_f32 v105, v105
    v_exp_f32 v106, v106
    v_smfmac_f32_32x32x32_bf16 v[176:191], v[148:151], v[88:95], v204
    v_exp_f32 v107, v107
    v_exp_f32 v108, v108
    v_exp_f32 v109, v109
    v_smfmac_f32_16x16x64_bf16 v[196:199], v[200:203], v[88:95], v204
    ds_read_b128 v[156:159], v24 offset:60416
    v_exp_f32 v110, v110
    v_exp_f32 v111, v111
    v_mfma_f32_32x32x16_bf16 v[64:79], v[128:131], v[8:11], 0
    v_exp_f32 v112, v112
    v_exp_f32 v113, v113
    v_exp_f32 v114, v114
    v_mfma_f32_32x32x16_bf16 v[64:79], v[132:135], v[12:15], v[64:79]
    s_waitcnt lgkmcnt(1)
    v_exp_f32 v115, v115
    v_exp_f32 v116, v116
    v_exp_f32 v117, v117
    v_smfmac_f32_32x32x32_bf16 v[160:175], v[152:155], v[96:103], v204
    s_waitcnt lgkmcnt(0)
    v_exp_f32 v118, v118
    v_exp_f32 v119, v119
    v_exp_f32 v120, v120
    v_smfmac_f32_16x16x64_bf16 v[192:195], v[200:203], v[96:103], v204
    ds_read_b128 v[136:139], v24 offset:55296
    v_exp_f32 v121, v121
    v_exp_f32 v122, v122
    v_smfmac_f32_32x32x32_bf16 v[160:175], v[156:159], v[104:111], v204
    v_exp_f32 v123, v123
    v_exp_f32 v124, v124
    v_exp_f32 v125, v125
    v_smfmac_f32_16x16x64_bf16 v[192:195], v[200:203], v[104:111], v204
    ds_read_b128 v[140:143], v24 offset:56320
    v_exp_f32 v126, v126
    v_exp_f32 v127, v127
    v_mfma_f32_32x32x16_bf16 v[80:95], v[128:131], v[16:19], 0
    v_exp_f32 v64, v64
    v_exp_f32 v65, v65
    v_exp_f32 v66, v66
    v_mfma_f32_32x32x16_bf16 v[80:95], v[132:135], v[20:23], v[80:95]
    v_exp_f32 v67, v67
    v_exp_f32 v68, v68
    v_exp_f32 v69, v69
    v_smfmac_f32_32x32x32_bf16 v[176:191], v[152:155], v[112:119], v204
    s_waitcnt lgkmcnt(0)
    v_exp_f32 v70, v70
    v_exp_f32 v71, v71
    v_exp_f32 v72, v72
    v_smfmac_f32_16x16x64_bf16 v[196:199], v[200:203], v[112:119], v204
    ds_read_b128 v[144:147], v24 offset:61440
    v_exp_f32 v73, v73
    v_exp_f32 v74, v74
    v_smfmac_f32_32x32x32_bf16 v[176:191], v[156:159], v[120:127], v204
    v_exp_f32 v75, v75
    v_exp_f32 v76, v76
    v_exp_f32 v77, v77
    v_smfmac_f32_16x16x64_bf16 v[196:199], v[200:203], v[120:127], v204
    ds_read_b128 v[148:151], v24 offset:62464
    v_exp_f32 v78, v78
    v_exp_f32 v79, v79
    v_mfma_f32_32x32x16_bf16 v[96:111], v[136:139], v[8:11], 0
    v_exp_f32 v80, v80
    v_exp_f32 v81, v81
    v_exp_f32 v82, v82
    v_mfma_f32_32x32x16_bf16 v[96:111], v[140:143], v[12:15], v[96:111]
    s_waitcnt lgkmcnt(1)
    v_exp_f32 v83, v83
    v_exp_f32 v84, v84
    v_exp_f32 v85, v85
    v_smfmac_f32_32x32x32_bf16 v[160:175], v[144:147], v[64:71], v204
    s_waitcnt lgkmcnt(0)
    s_barrier
    v_exp_f32 v86, v86
    v_exp_f32 v87, v87
    v_exp_f32 v88, v88
    v_smfmac_f32_16x16x64_bf16 v[192:195], v[200:203], v[64:71], v204
    ds_read_b128 v[128:131], v24 offset:0
    v_exp_f32 v89, v89
    v_exp_f32 v90, v90
    v_smfmac_f32_32x32x32_bf16 v[160:175], v[148:151], v[72:79], v204
    v_exp_f32 v91, v91
    v_exp_f32 v92, v92
    v_exp_f32 v93, v93
    v_smfmac_f32_16x16x64_bf16 v[192:195], v[200:203], v[72:79], v204
    ds_read_b128 v[132:135], v24 offset:1024
    v_exp_f32 v94, v94
    v_exp_f32 v95, v95
    v_mfma_f32_32x32x16_bf16 v[112:127], v[136:139], v[16:19], 0
    v_exp_f32 v96, v96
    v_exp_f32 v97, v97
    v_exp_f32 v98, v98
    v_mfma_f32_32x32x16_bf16 v[112:127], v[140:143], v[20:23], v[112:127]
    v_exp_f32 v99, v99
    v_exp_f32 v100, v100
    v_exp_f32 v101, v101
    v_smfmac_f32_32x32x32_bf16 v[176:191], v[144:147], v[80:87], v204
    s_waitcnt lgkmcnt(0)
    v_exp_f32 v102, v102
    v_exp_f32 v103, v103
    v_exp_f32 v104, v104
    v_smfmac_f32_16x16x64_bf16 v[196:199], v[200:203], v[80:87], v204
    ds_read_b128 v[152:155], v24 offset:63488
    v_exp_f32 v105, v105
    v_exp_f32 v106, v106
    v_smfmac_f32_32x32x32_bf16 v[176:191], v[148:151], v[88:95], v204
    v_exp_f32 v107, v107
    v_exp_f32 v108, v108
    v_exp_f32 v109, v109
    v_smfmac_f32_16x16x64_bf16 v[196:199], v[200:203], v[88:95], v204
    ds_read_b128 v[156:159], v24 offset:64512
    v_exp_f32 v110, v110
    v_exp_f32 v111, v111
    v_mfma_f32_32x32x16_bf16 v[64:79], v[128:131], v[8:11], 0
    s_sub_u32 s54, s54, 1
    v_exp_f32 v112, v112
    v_exp_f32 v113, v113
    v_exp_f32 v114, v114
    v_mfma_f32_32x32x16_bf16 v[64:79], v[132:135], v[12:15], v[64:79]
    s_waitcnt lgkmcnt(1)
    v_exp_f32 v115, v115
    v_exp_f32 v116, v116
    v_exp_f32 v117, v117
    v_smfmac_f32_32x32x32_bf16 v[160:175], v[152:155], v[96:103], v204
    s_waitcnt lgkmcnt(0)
    v_exp_f32 v118, v118
    v_exp_f32 v119, v119
    v_exp_f32 v120, v120
    v_smfmac_f32_16x16x64_bf16 v[192:195], v[200:203], v[96:103], v204
    ds_read_b128 v[136:139], v24 offset:2048
    v_exp_f32 v121, v121
    v_exp_f32 v122, v122
    v_smfmac_f32_32x32x32_bf16 v[160:175], v[156:159], v[104:111], v204
    s_cmp_lg_u32 s54, 0
    v_exp_f32 v123, v123
    v_exp_f32 v124, v124
    v_exp_f32 v125, v125
    v_smfmac_f32_16x16x64_bf16 v[192:195], v[200:203], v[104:111], v204
    ds_read_b128 v[140:143], v24 offset:3072
    v_exp_f32 v126, v126
    v_exp_f32 v127, v127
    s_cbranch_scc1 c_attn_loop
    v_smfmac_f32_32x32x32_bf16 v[176:191], v[152:155], v[112:119], v204
    v_mov_b32 v25, 0x5f000000
    v_mov_b32 v26, 0x2b800000
    s_add_u32 s51, s49, 65536
    v_cmp_lt_f32 s[56:57], v192, v25
    v_cmp_gt_f32 vcc, v192, v26
    s_and_b64 s[56:57], s[56:57], vcc
    v_smfmac_f32_16x16x64_bf16 v[196:199], v[200:203], v[112:119], v204
    v_rcp_f32 v193, v192
    s_nop 0
    v_mul_f32 v160, v193, v160
    v_smfmac_f32_32x32x32_bf16 v[176:191], v[156:159], v[120:127], v204
    v_mul_f32 v161, v193, v161
    v_mul_f32 v162, v193, v162
    v_mul_f32 v163, v193, v163
    v_mul_f32 v164, v193, v164
    v_mul_f32 v165, v193, v165
    v_smfmac_f32_16x16x64_bf16 v[196:199], v[200:203], v[120:127], v204
    v_mul_f32 v166, v193, v166
    v_mul_f32 v167, v193, v167
    v_cvt_pk_bf16_f32 v160, v160, v161
    v_cvt_pk_bf16_f32 v161, v162, v163
    v_cvt_pk_bf16_f32 v162, v164, v165
    v_cvt_pk_bf16_f32 v163, v166, v167
    buffer_store_dwordx4 v[160:163], v5, s[12:15], s49 offen offset:0 sc1
    v_pk_mul_f32 v[168:169], v[192:193], v[168:169] op_sel:[1,0] op_sel_hi:[1,1]
    v_pk_mul_f32 v[170:171], v[192:193], v[170:171] op_sel:[1,0] op_sel_hi:[1,1]
    v_pk_mul_f32 v[172:173], v[192:193], v[172:173] op_sel:[1,0] op_sel_hi:[1,1]
    v_pk_mul_f32 v[174:175], v[192:193], v[174:175] op_sel:[1,0] op_sel_hi:[1,1]
    v_cvt_pk_bf16_f32 v168, v168, v169
    v_cvt_pk_bf16_f32 v169, v170, v171
    v_cvt_pk_bf16_f32 v170, v172, v173
    v_cvt_pk_bf16_f32 v171, v174, v175
    buffer_store_dwordx4 v[168:171], v5, s[12:15], s49 offen offset:1024 sc1
    v_cmp_lt_f32 vcc, v196, v25
    s_and_b64 s[56:57], s[56:57], vcc
    v_cmp_gt_f32 vcc, v196, v26
    s_and_b64 s[56:57], s[56:57], vcc
    s_cmp_lg_u64 s[56:57], -1
    s_cbranch_scc1 c_attn_slow
    v_rcp_f32 v197, v196
    s_nop 0
    v_pk_mul_f32 v[176:177], v[196:197], v[176:177] op_sel:[1,0] op_sel_hi:[1,1]
    v_pk_mul_f32 v[178:179], v[196:197], v[178:179] op_sel:[1,0] op_sel_hi:[1,1]
    v_pk_mul_f32 v[180:181], v[196:197], v[180:181] op_sel:[1,0] op_sel_hi:[1,1]
    v_pk_mul_f32 v[182:183], v[196:197], v[182:183] op_sel:[1,0] op_sel_hi:[1,1]
    v_cvt_pk_bf16_f32 v176, v176, v177
    v_cvt_pk_bf16_f32 v177, v178, v179
    v_cvt_pk_bf16_f32 v178, v180, v181
    v_cvt_pk_bf16_f32 v179, v182, v183
    buffer_store_dwordx4 v[176:179], v5, s[12:15], s51 offen offset:0 sc1
    v_pk_mul_f32 v[184:185], v[196:197], v[184:185] op_sel:[1,0] op_sel_hi:[1,1]
    v_pk_mul_f32 v[186:187], v[196:197], v[186:187] op_sel:[1,0] op_sel_hi:[1,1]
    v_pk_mul_f32 v[188:189], v[196:197], v[188:189] op_sel:[1,0] op_sel_hi:[1,1]
    v_pk_mul_f32 v[190:191], v[196:197], v[190:191] op_sel:[1,0] op_sel_hi:[1,1]
    v_cvt_pk_bf16_f32 v184, v184, v185
    v_cvt_pk_bf16_f32 v185, v186, v187
    v_cvt_pk_bf16_f32 v186, v188, v189
    v_cvt_pk_bf16_f32 v187, v190, v191
    buffer_store_dwordx4 v[184:187], v5, s[12:15], s51 offen offset:1024 sc1
c_attn_done:
    s_branch c_wo
c_attn_fin:
    v_rcp_f32 v193, v192
    s_nop 0
    v_pk_mul_f32 v[160:161], v[192:193], v[160:161] op_sel:[1,0] op_sel_hi:[1,1]
    v_pk_mul_f32 v[162:163], v[192:193], v[162:163] op_sel:[1,0] op_sel_hi:[1,1]
    v_pk_mul_f32 v[164:165], v[192:193], v[164:165] op_sel:[1,0] op_sel_hi:[1,1]
    v_pk_mul_f32 v[166:167], v[192:193], v[166:167] op_sel:[1,0] op_sel_hi:[1,1]
    v_cvt_pk_bf16_f32 v160, v160, v161
    v_cvt_pk_bf16_f32 v161, v162, v163
    v_cvt_pk_bf16_f32 v162, v164, v165
    v_cvt_pk_bf16_f32 v163, v166, v167
    buffer_store_dwordx4 v[160:163], v5, s[12:15], s49 offen offset:0 sc1
    v_pk_mul_f32 v[168:169], v[192:193], v[168:169] op_sel:[1,0] op_sel_hi:[1,1]
    v_pk_mul_f32 v[170:171], v[192:193], v[170:171] op_sel:[1,0] op_sel_hi:[1,1]
    v_pk_mul_f32 v[172:173], v[192:193], v[172:173] op_sel:[1,0] op_sel_hi:[1,1]
    v_pk_mul_f32 v[174:175], v[192:193], v[174:175] op_sel:[1,0] op_sel_hi:[1,1]
    v_cvt_pk_bf16_f32 v168, v168, v169
    v_cvt_pk_bf16_f32 v169, v170, v171
    v_cvt_pk_bf16_f32 v170, v172, v173
    v_cvt_pk_bf16_f32 v171, v174, v175
    buffer_store_dwordx4 v[168:171], v5, s[12:15], s49 offen offset:1024 sc1
    v_rcp_f32 v197, v196
    s_nop 0
    v_pk_mul_f32 v[176:177], v[196:197], v[176:177] op_sel:[1,0] op_sel_hi:[1,1]
    v_pk_mul_f32 v[178:179], v[196:197], v[178:179] op_sel:[1,0] op_sel_hi:[1,1]
    v_pk_mul_f32 v[180:181], v[196:197], v[180:181] op_sel:[1,0] op_sel_hi:[1,1]
    v_pk_mul_f32 v[182:183], v[196:197], v[182:183] op_sel:[1,0] op_sel_hi:[1,1]
    v_cvt_pk_bf16_f32 v176, v176, v177
    v_cvt_pk_bf16_f32 v177, v178, v179
    v_cvt_pk_bf16_f32 v178, v180, v181
    v_cvt_pk_bf16_f32 v179, v182, v183
    buffer_store_dwordx4 v[176:179], v5, s[12:15], s51 offen offset:0 sc1
    v_pk_mul_f32 v[184:185], v[196:197], v[184:185] op_sel:[1,0] op_sel_hi:[1,1]
    v_pk_mul_f32 v[186:187], v[196:197], v[186:187] op_sel:[1,0] op_sel_hi:[1,1]
    v_pk_mul_f32 v[188:189], v[196:197], v[188:189] op_sel:[1,0] op_sel_hi:[1,1]
    v_pk_mul_f32 v[190:191], v[196:197], v[190:191] op_sel:[1,0] op_sel_hi:[1,1]
    v_cvt_pk_bf16_f32 v184, v184, v185
    v_cvt_pk_bf16_f32 v185, v186, v187
    v_cvt_pk_bf16_f32 v186, v188, v189
    v_cvt_pk_bf16_f32 v187, v190, v191
    buffer_store_dwordx4 v[184:187], v5, s[12:15], s51 offen offset:1024 sc1
    s_branch c_attn_done
.p2align 6
h_first_tail:
    s_waitcnt vmcnt(0)
    s_sub_u32 s50, s50, 8000
    s_load_dword s10, s[46:47], 0
    s_waitcnt lgkmcnt(0)
    s_sub_u32 s51, s10, s50
    s_and_b32 s3, s10, 1
    s_cselect_b32 s51, s51, -1
    s_cmp_ge_i32 s51, 0
    s_cbranch_scc1 h_first_non_ok
    s_load_dword s10, s[46:47], 128
    s_waitcnt lgkmcnt(0)
    s_sub_u32 s51, s10, s50
    s_and_b32 s3, s10, 1
    s_cselect_b32 s51, s51, -1
    s_cmp_ge_i32 s51, 0
    s_cbranch_scc1 h_first_non_ok
    s_load_dword s10, s[46:47], 64
    s_waitcnt lgkmcnt(0)
    s_sub_u32 s51, s10, s50
    s_and_b32 s3, s10, 1
    s_cselect_b32 s51, s51, -1
    s_cmp_ge_i32 s51, 0
    s_cbranch_scc1 h_first_non_ok
    s_load_dword s10, s[46:47], 192
    s_waitcnt lgkmcnt(0)
    s_sub_u32 s51, s10, s50
    s_and_b32 s3, s10, 1
    s_cselect_b32 s51, s51, -1
    s_cmp_ge_i32 s51, 0
    s_cbranch_scc1 h_first_non_ok
    s_mov_b32 s58, 0
    s_and_b32 s57, s2, 0xc0
h_first_non:
    s_load_dword s10, s[46:47], s57 glc
    s_waitcnt lgkmcnt(0)
    s_sub_u32 s51, s10, s50
    s_and_b32 s3, s10, 1
    s_cselect_b32 s51, s51, -1
    s_cmp_ge_i32 s51, 0
    s_cbranch_scc1 h_first_non_ok
    s_add_u32 s58, s58, 1
    s_cmp_gt_u32 s58, 100
    s_cselect_b32 s50, s10, s50
    s_cmp_lt_u32 s58, 0x100000
    s_cbranch_scc1 h_first_non
    s_mov_b32 s10, 1
h_first_non_ok:
    v_mov_b32 v12, s10
    ds_write_b32 v10, v12 offset:4
    v_lshlrev_b32 v13, 7, v1
    s_lshl_b32 s50, s2, 13
    s_mov_b32 s28, s36
    s_mov_b32 s29, s37
    s_mov_b32 s30, 2097152
    s_mov_b32 s31, 0x00020000
    buffer_load_dword v14, v13, s[28:31], s50 offen
    s_mov_b32 s9, 0
h_qkvA:
    s_mul_i32 s98, s9, 786432
    s_add_u32 s98, s98, 65273856
    s_lshl_b32 s99, s11, 10
    s_add_u32 s98, s98, s99
    s_add_u32 s96, s4, s98
    s_addc_u32 s97, s5, 0
    s_mov_b32 s98, s10
    s_mov_b32 s99, s10
    v_and_b32 v1, 63, v0
    v_lshlrev_b32 v5, 4, v1
    v_and_b32 v20, 15, v1
    v_lshrrev_b32 v11, 4, v1
    v_min_u32 v11, 2, v11
    v_lshlrev_b32 v21, 3, v20
    v_lshl_add_u32 v12, v11, 7, v21
    v_add_u32 v12, 155648, v12
    v_lshl_add_u32 v11, v11, 16, v21
    v_mov_b32 v10, 159496
    s_add_u32 s3, s9, 1
    v_mov_b32 v13, s3
    s_and_b32 s3, s6, 14
    s_lshl_b32 s3, s3, 2
    s_sub_u32 s3, s3, 1
    s_max_i32 s3, s3, 0
    s_lshl_b32 s3, s3, 16
    s_lshl_b32 s48, s9, 22
    s_add_u32 s3, s3, s48
    s_add_u32 s20, s4, s3
    s_addc_u32 s21, s5, 0
    s_mov_b32 s22, 65536
    s_mov_b32 s23, 0x00020000
    s_cmp_lt_u32 s6, 2
    s_cselect_b32 s22, 0, s22
    s_cselect_b32 s3, 0, 512
    s_add_u32 s96, s96, s3
    s_addc_u32 s97, s97, 0
    v_bfe_u32 v21, v1, 4, 1
    v_lshl_add_u32 v6, v21, 5, v20
    v_lshlrev_b32 v6, 4, v6
    v_lshrrev_b32 v21, 5, v1
    v_lshl_add_u32 v6, v21, 10, v6
    v_add_u32 v6, 256, v6
    v_mov_b32 v16, v5
    s_cmp_eq_u32 s9, 0
    s_cbranch_scc1 h_qkvA_noend
    s_barrier
    s_cmp_lt_u32 s9, 2
    s_cbranch_scc1 c4_11
    ds_write_b128 v16, v[64:67] offset:0
    ds_write_b128 v16, v[68:71] offset:1024
    ds_write_b128 v16, v[72:75] offset:2048
    ds_write_b128 v16, v[76:79] offset:3072
    ds_write_b128 v16, v[80:83] offset:4096
    ds_write_b128 v16, v[84:87] offset:5120
    ds_write_b128 v16, v[88:91] offset:6144
    ds_write_b128 v16, v[92:95] offset:7168
    ds_write_b128 v16, v[96:99] offset:8192
    ds_write_b128 v16, v[100:103] offset:9216
    ds_write_b128 v16, v[104:107] offset:10240
    ds_write_b128 v16, v[108:111] offset:11264
    ds_write_b128 v16, v[112:115] offset:12288
    ds_write_b128 v16, v[116:119] offset:13312
    ds_write_b128 v16, v[120:123] offset:14336
    ds_write_b128 v16, v[124:127] offset:15360
    ds_write_b128 v16, v[128:131] offset:16384
    ds_write_b128 v16, v[132:135] offset:17408
    ds_write_b128 v16, v[136:139] offset:18432
    ds_write_b128 v16, v[140:143] offset:19456
    ds_write_b128 v16, v[144:147] offset:20480
    ds_write_b128 v16, v[148:151] offset:21504
    ds_write_b128 v16, v[152:155] offset:22528
    ds_write_b128 v16, v[156:159] offset:23552
    s_waitcnt lgkmcnt(0)
c4_11:
    s_barrier
h_qkvA_noend:
    s_mov_b32 s3, 0x100000
poll_12:
    s_load_dwordx8 s[80:87], s[96:97], 0 glc
    s_load_dwordx8 s[88:95], s[96:97], 128 glc
    s_sub_u32 s3, s3, 1
    s_cbranch_scc1 poll_12_ok
    s_waitcnt lgkmcnt(0)
    s_xor_b64 s[100:101], s[80:81], s[98:99]
    s_xor_b64 s[80:81], s[82:83], s[98:99]
    s_or_b64 s[100:101], s[100:101], s[80:81]
    s_xor_b64 s[80:81], s[84:85], s[98:99]
    s_or_b64 s[100:101], s[100:101], s[80:81]
    s_xor_b64 s[80:81], s[86:87], s[98:99]
    s_or_b64 s[100:101], s[100:101], s[80:81]
    s_xor_b64 s[80:81], s[88:89], s[98:99]
    s_or_b64 s[100:101], s[100:101], s[80:81]
    s_xor_b64 s[80:81], s[90:91], s[98:99]
    s_or_b64 s[100:101], s[100:101], s[80:81]
    s_xor_b64 s[80:81], s[92:93], s[98:99]
    s_or_b64 s[100:101], s[100:101], s[80:81]
    s_xor_b64 s[80:81], s[94:95], s[98:99]
    s_or_b64 s[100:101], s[100:101], s[80:81]
    s_cbranch_scc1 poll_12
poll_12_ok:
    s_waitcnt lgkmcnt(0)
    ds_write_b32 v10, v13
    s_mov_b32 m0, 147456
    s_mov_b32 s48, 0
    buffer_load_dwordx4 v6, s[20:23], s48 offen sc1 lds
    s_mov_b32 m0, 148480
    s_mov_b32 s48, 2048
    buffer_load_dwordx4 v6, s[20:23], s48 offen sc1 lds
    s_mov_b32 m0, 149504
    s_mov_b32 s48, 4096
    buffer_load_dwordx4 v6, s[20:23], s48 offen sc1 lds
    s_mov_b32 m0, 150528
    s_mov_b32 s48, 6144
    buffer_load_dwordx4 v6, s[20:23], s48 offen sc1 lds
    s_mov_b32 m0, 151552
    s_mov_b32 s48, 8192
    buffer_load_dwordx4 v6, s[20:23], s48 offen sc1 lds
    s_mov_b32 m0, 152576
    s_mov_b32 s48, 10240
    buffer_load_dwordx4 v6, s[20:23], s48 offen sc1 lds
    s_mov_b32 m0, 153600
    s_mov_b32 s48, 12288
    buffer_load_dwordx4 v6, s[20:23], s48 offen sc1 lds
    s_mov_b32 m0, 154624
    s_mov_b32 s48, 14336
    buffer_load_dwordx4 v6, s[20:23], s48 offen sc1 lds
    s_lshl_b32 s56, s7, 12
    s_and_b32 s57, s6, 1
    s_lshl_b32 s57, s57, 7
    s_add_u32 s56, s56, s57
    s_add_u32 s56, s56, 63963136
    v_lshlrev_b32 v15, 7, v1
    s_lshr_b32 s59, s2, 3
    s_mul_i32 s59, s59, 3
    s_lshr_b32 s59, s59, 5
    s_lshl_b32 s3, s9, 4
    s_add_u32 s59, s59, s3
    s_waitcnt vmcnt(4)
    s_barrier
    s_cmp_ge_u32 s9, 2
    s_cbranch_scc1 c4_13
    ds_read_b128 v[64:67], v16 offset:0
    ds_read_b128 v[68:71], v16 offset:1024
    ds_read_b128 v[72:75], v16 offset:2048
    ds_read_b128 v[76:79], v16 offset:3072
    ds_read_b128 v[80:83], v16 offset:4096
    ds_read_b128 v[84:87], v16 offset:5120
    ds_read_b128 v[88:91], v16 offset:6144
    ds_read_b128 v[92:95], v16 offset:7168
    ds_read_b128 v[96:99], v16 offset:8192
    ds_read_b128 v[100:103], v16 offset:9216
    ds_read_b128 v[104:107], v16 offset:10240
    ds_read_b128 v[108:111], v16 offset:11264
    ds_read_b128 v[112:115], v16 offset:12288
    ds_read_b128 v[116:119], v16 offset:13312
    ds_read_b128 v[120:123], v16 offset:14336
    ds_read_b128 v[124:127], v16 offset:15360
    ds_read_b128 v[128:131], v16 offset:16384
    ds_read_b128 v[132:135], v16 offset:17408
    ds_read_b128 v[136:139], v16 offset:18432
    ds_read_b128 v[140:143], v16 offset:19456
    ds_read_b128 v[144:147], v16 offset:20480
    ds_read_b128 v[148:151], v16 offset:21504
    ds_read_b128 v[152:155], v16 offset:22528
    ds_read_b128 v[156:159], v16 offset:23552
    s_waitcnt lgkmcnt(0)
c4_13:
    s_waitcnt vmcnt(0)
    s_barrier
    s_mov_b32 m0, 147456
    s_mov_b32 s48, 16384
    buffer_load_dwordx4 v6, s[20:23], s48 offen sc1 lds
    s_mov_b32 m0, 148480
    s_mov_b32 s48, 18432
    buffer_load_dwordx4 v6, s[20:23], s48 offen sc1 lds
    s_mov_b32 m0, 149504
    s_mov_b32 s48, 20480
    buffer_load_dwordx4 v6, s[20:23], s48 offen sc1 lds
    s_mov_b32 m0, 150528
    s_mov_b32 s48, 22528
    buffer_load_dwordx4 v6, s[20:23], s48 offen sc1 lds
    s_waitcnt vmcnt(0)
    s_waitcnt vmcnt(0)
    s_barrier
    s_mov_b32 m0, 151552
    s_mov_b32 s48, 24576
    buffer_load_dwordx4 v6, s[20:23], s48 offen sc1 lds
    s_mov_b32 m0, 152576
    s_mov_b32 s48, 26624
    buffer_load_dwordx4 v6, s[20:23], s48 offen sc1 lds
    s_mov_b32 m0, 153600
    s_mov_b32 s48, 28672
    buffer_load_dwordx4 v6, s[20:23], s48 offen sc1 lds
    s_mov_b32 m0, 154624
    s_mov_b32 s48, 30720
    buffer_load_dwordx4 v6, s[20:23], s48 offen sc1 lds
    s_cmp_ge_u32 s9, 2
    s_cbranch_scc1 cs_15
    buffer_load_dwordx2 v[32:33], v11, s[12:15], s56 offen offset:0 sc1
    buffer_load_dwordx2 v[34:35], v11, s[12:15], s56 offen offset:256 sc1
    buffer_load_dwordx2 v[36:37], v11, s[12:15], s56 offen offset:512 sc1
    buffer_load_dwordx2 v[38:39], v11, s[12:15], s56 offen offset:768 sc1
    buffer_load_dwordx2 v[40:41], v11, s[12:15], s56 offen offset:1024 sc1
    buffer_load_dwordx2 v[42:43], v11, s[12:15], s56 offen offset:1280 sc1
    buffer_load_dwordx2 v[44:45], v11, s[12:15], s56 offen offset:1536 sc1
    buffer_load_dwordx2 v[46:47], v11, s[12:15], s56 offen offset:1792 sc1
    buffer_load_dwordx2 v[48:49], v11, s[12:15], s56 offen offset:2048 sc1
    buffer_load_dwordx2 v[50:51], v11, s[12:15], s56 offen offset:2304 sc1
    buffer_load_dwordx2 v[52:53], v11, s[12:15], s56 offen offset:2560 sc1
    buffer_load_dwordx2 v[54:55], v11, s[12:15], s56 offen offset:2816 sc1
cs_15:
    s_waitcnt vmcnt(0)
    s_waitcnt vmcnt(12)
    s_barrier
    s_mov_b32 m0, 147456
    s_mov_b32 s48, 32768
    buffer_load_dwordx4 v6, s[20:23], s48 offen sc1 lds
    s_mov_b32 m0, 148480
    s_mov_b32 s48, 34816
    buffer_load_dwordx4 v6, s[20:23], s48 offen sc1 lds
    s_mov_b32 m0, 149504
    s_mov_b32 s48, 36864
    buffer_load_dwordx4 v6, s[20:23], s48 offen sc1 lds
    s_mov_b32 m0, 150528
    s_mov_b32 s48, 38912
    buffer_load_dwordx4 v6, s[20:23], s48 offen sc1 lds
    s_cmp_ge_u32 s9, 2
    s_cbranch_scc1 cs_16
    buffer_load_dwordx2 v[56:57], v11, s[12:15], s56 offen offset:3072 sc1
    buffer_load_dwordx2 v[58:59], v11, s[12:15], s56 offen offset:3328 sc1
    buffer_load_dwordx2 v[60:61], v11, s[12:15], s56 offen offset:3584 sc1
    buffer_load_dwordx2 v[62:63], v11, s[12:15], s56 offen offset:3840 sc1
cs_16:
    s_waitcnt vmcnt(0)
    s_waitcnt vmcnt(4)
    s_barrier
    s_mov_b32 m0, 151552
    s_mov_b32 s48, 40960
    buffer_load_dwordx4 v6, s[20:23], s48 offen sc1 lds
    s_mov_b32 m0, 152576
    s_mov_b32 s48, 43008
    buffer_load_dwordx4 v6, s[20:23], s48 offen sc1 lds
    s_mov_b32 m0, 153600
    s_mov_b32 s48, 45056
    buffer_load_dwordx4 v6, s[20:23], s48 offen sc1 lds
    s_mov_b32 m0, 154624
    s_mov_b32 s48, 47104
    buffer_load_dwordx4 v6, s[20:23], s48 offen sc1 lds
    s_cmp_ge_u32 s9, 2
    s_cbranch_scc1 cs_17
    s_waitcnt vmcnt(4)
    v_add_f32 v32, v32, v48
    v_add_f32 v33, v33, v49
    v_add_f32 v34, v34, v50
    v_add_f32 v35, v35, v51
    v_add_f32 v36, v36, v52
    v_add_f32 v37, v37, v53
    v_add_f32 v38, v38, v54
    v_add_f32 v39, v39, v55
    v_add_f32 v40, v40, v56
    v_add_f32 v41, v41, v57
    v_add_f32 v42, v42, v58
    v_add_f32 v43, v43, v59
cs_17:
    s_waitcnt vmcnt(0)
    s_waitcnt vmcnt(0)
    s_barrier
    s_mov_b32 m0, 147456
    s_mov_b32 s48, 49152
    buffer_load_dwordx4 v6, s[20:23], s48 offen sc1 lds
    s_mov_b32 m0, 148480
    s_mov_b32 s48, 51200
    buffer_load_dwordx4 v6, s[20:23], s48 offen sc1 lds
    s_mov_b32 m0, 149504
    s_mov_b32 s48, 53248
    buffer_load_dwordx4 v6, s[20:23], s48 offen sc1 lds
    s_mov_b32 m0, 150528
    s_mov_b32 s48, 55296
    buffer_load_dwordx4 v6, s[20:23], s48 offen sc1 lds
    s_cmp_ge_u32 s9, 2
    s_cbranch_scc1 cs_18
    v_add_f32 v44, v44, v60
    v_add_f32 v45, v45, v61
    v_add_f32 v46, v46, v62
    v_add_f32 v47, v47, v63
    v_add_f32 v32, v32, v40
    v_add_f32 v33, v33, v41
    v_add_f32 v34, v34, v42
    v_add_f32 v35, v35, v43
    v_add_f32 v36, v36, v44
    v_add_f32 v37, v37, v45
    v_add_f32 v38, v38, v46
    v_add_f32 v39, v39, v47
cs_18:
    s_waitcnt vmcnt(0)
    s_waitcnt vmcnt(0)
    s_barrier
    s_mov_b32 m0, 151552
    s_mov_b32 s48, 57344
    buffer_load_dwordx4 v6, s[20:23], s48 offen sc1 lds
    s_mov_b32 m0, 152576
    s_mov_b32 s48, 59392
    buffer_load_dwordx4 v6, s[20:23], s48 offen sc1 lds
    s_mov_b32 m0, 153600
    s_mov_b32 s48, 61440
    buffer_load_dwordx4 v6, s[20:23], s48 offen sc1 lds
    s_mov_b32 m0, 154624
    s_mov_b32 s48, 63488
    buffer_load_dwordx4 v6, s[20:23], s48 offen sc1 lds
    s_cmp_ge_u32 s9, 2
    s_cbranch_scc1 cs_19
    v_add_f32 v32, v32, v36
    v_add_f32 v33, v33, v37
    v_add_f32 v34, v34, v38
    v_add_f32 v35, v35, v39
    v_add_f32 v32, v32, v34
    v_add_f32 v33, v33, v35
    ds_write_b64 v12, v[32:33]
    s_waitcnt lgkmcnt(0)
cs_19:
    s_waitcnt vmcnt(0)
    s_waitcnt vmcnt(0)
    s_barrier
    s_barrier
    s_barrier
    s_branch h_wo
h_qkvB:
    s_mul_i32 s98, s9, 786432
    s_add_u32 s98, s98, 65273856
    s_lshl_b32 s99, s11, 10
    s_add_u32 s98, s98, s99
    s_add_u32 s96, s4, s98
    s_addc_u32 s97, s5, 0
    s_mov_b32 s98, s10
    s_mov_b32 s99, s10
    v_and_b32 v1, 63, v0
    v_lshlrev_b32 v5, 4, v1
    v_and_b32 v20, 15, v1
    v_lshrrev_b32 v11, 4, v1
    v_min_u32 v11, 2, v11
    v_lshlrev_b32 v21, 3, v20
    v_lshl_add_u32 v12, v11, 7, v21
    v_add_u32 v12, 156032, v12
    v_lshl_add_u32 v11, v11, 16, v21
    v_mov_b32 v10, 159496
    s_add_u32 s3, s9, 1
    v_mov_b32 v13, s3
    v_mov_b32 v16, v5
    s_barrier
    s_cmp_lt_u32 s9, 2
    s_cbranch_scc1 c4_22
    ds_write_b128 v16, v[160:163] offset:0
    ds_write_b128 v16, v[164:167] offset:1024
    ds_write_b128 v16, v[168:171] offset:2048
    ds_write_b128 v16, v[172:175] offset:3072
    ds_write_b128 v16, v[176:179] offset:4096
    ds_write_b128 v16, v[180:183] offset:5120
    ds_write_b128 v16, v[184:187] offset:6144
    ds_write_b128 v16, v[188:191] offset:7168
    ds_write_b128 v16, v[192:195] offset:8192
    ds_write_b128 v16, v[196:199] offset:9216
    ds_write_b128 v16, v[200:203] offset:10240
    ds_write_b128 v16, v[204:207] offset:11264
    ds_write_b128 v16, v[208:211] offset:12288
    ds_write_b128 v16, v[212:215] offset:13312
    ds_write_b128 v16, v[216:219] offset:14336
    ds_write_b128 v16, v[220:223] offset:15360
    ds_write_b128 v16, a[0:3] offset:16384
    ds_write_b128 v16, a[4:7] offset:17408
    ds_write_b128 v16, a[8:11] offset:18432
    ds_write_b128 v16, a[12:15] offset:19456
    ds_write_b128 v16, a[16:19] offset:20480
    ds_write_b128 v16, a[20:23] offset:21504
    ds_write_b128 v16, a[24:27] offset:22528
    ds_write_b128 v16, a[28:31] offset:23552
    s_waitcnt lgkmcnt(0)
c4_22:
    s_barrier
    s_mov_b32 s3, 0x100000
poll_23:
    s_load_dwordx8 s[88:95], s[96:97], 0 glc
    s_sub_u32 s3, s3, 1
    s_cbranch_scc1 poll_23_ok
    s_waitcnt lgkmcnt(0)
    s_xor_b64 s[100:101], s[88:89], s[98:99]
    s_xor_b64 s[88:89], s[90:91], s[98:99]
    s_or_b64 s[100:101], s[100:101], s[88:89]
    s_xor_b64 s[88:89], s[92:93], s[98:99]
    s_or_b64 s[100:101], s[100:101], s[88:89]
    s_xor_b64 s[88:89], s[94:95], s[98:99]
    s_or_b64 s[100:101], s[100:101], s[88:89]
    s_cbranch_scc1 poll_23
poll_23_ok:
    s_waitcnt lgkmcnt(0)
    ds_write_b32 v10, v13
    s_lshl_b32 s56, s7, 12
    s_and_b32 s57, s6, 1
    s_lshl_b32 s57, s57, 7
    s_add_u32 s56, s56, s57
    s_add_u32 s56, s56, 64159744
    s_barrier
    s_cmp_ge_u32 s9, 2
    s_cbranch_scc1 c4_24
    ds_read_b128 v[160:163], v16 offset:0
    ds_read_b128 v[164:167], v16 offset:1024
    ds_read_b128 v[168:171], v16 offset:2048
    ds_read_b128 v[172:175], v16 offset:3072
    ds_read_b128 v[176:179], v16 offset:4096
    ds_read_b128 v[180:183], v16 offset:5120
    ds_read_b128 v[184:187], v16 offset:6144
    ds_read_b128 v[188:191], v16 offset:7168
    ds_read_b128 v[192:195], v16 offset:8192
    ds_read_b128 v[196:199], v16 offset:9216
    ds_read_b128 v[200:203], v16 offset:10240
    ds_read_b128 v[204:207], v16 offset:11264
    ds_read_b128 v[208:211], v16 offset:12288
    ds_read_b128 v[212:215], v16 offset:13312
    ds_read_b128 v[216:219], v16 offset:14336
    ds_read_b128 v[220:223], v16 offset:15360
    ds_read_b128 a[0:3], v16 offset:16384
    ds_read_b128 a[4:7], v16 offset:17408
    ds_read_b128 a[8:11], v16 offset:18432
    ds_read_b128 a[12:15], v16 offset:19456
    ds_read_b128 a[16:19], v16 offset:20480
    ds_read_b128 a[20:23], v16 offset:21504
    ds_read_b128 a[24:27], v16 offset:22528
    ds_read_b128 a[28:31], v16 offset:23552
    s_waitcnt lgkmcnt(0)
c4_24:
    s_barrier
    s_barrier
    s_cmp_ge_u32 s9, 2
    s_cbranch_scc1 cs_26
    buffer_load_dwordx2 v[32:33], v11, s[12:15], s56 offen offset:0 sc1
    buffer_load_dwordx2 v[34:35], v11, s[12:15], s56 offen offset:256 sc1
    buffer_load_dwordx2 v[36:37], v11, s[12:15], s56 offen offset:512 sc1
    buffer_load_dwordx2 v[38:39], v11, s[12:15], s56 offen offset:768 sc1
    buffer_load_dwordx2 v[40:41], v11, s[12:15], s56 offen offset:1024 sc1
    buffer_load_dwordx2 v[42:43], v11, s[12:15], s56 offen offset:1280 sc1
    buffer_load_dwordx2 v[44:45], v11, s[12:15], s56 offen offset:1536 sc1
    buffer_load_dwordx2 v[46:47], v11, s[12:15], s56 offen offset:1792 sc1
    buffer_load_dwordx2 v[48:49], v11, s[12:15], s56 offen offset:2048 sc1
    buffer_load_dwordx2 v[50:51], v11, s[12:15], s56 offen offset:2304 sc1
    buffer_load_dwordx2 v[52:53], v11, s[12:15], s56 offen offset:2560 sc1
    buffer_load_dwordx2 v[54:55], v11, s[12:15], s56 offen offset:2816 sc1
cs_26:
    s_barrier
    s_cmp_ge_u32 s9, 2
    s_cbranch_scc1 cs_27
    buffer_load_dwordx2 v[56:57], v11, s[12:15], s56 offen offset:3072 sc1
    buffer_load_dwordx2 v[58:59], v11, s[12:15], s56 offen offset:3328 sc1
    buffer_load_dwordx2 v[60:61], v11, s[12:15], s56 offen offset:3584 sc1
    buffer_load_dwordx2 v[62:63], v11, s[12:15], s56 offen offset:3840 sc1
cs_27:
    s_barrier
    s_cmp_ge_u32 s9, 2
    s_cbranch_scc1 cs_28
    s_waitcnt vmcnt(0)
    v_add_f32 v32, v32, v48
    v_add_f32 v33, v33, v49
    v_add_f32 v34, v34, v50
    v_add_f32 v35, v35, v51
    v_add_f32 v36, v36, v52
    v_add_f32 v37, v37, v53
    v_add_f32 v38, v38, v54
    v_add_f32 v39, v39, v55
    v_add_f32 v40, v40, v56
    v_add_f32 v41, v41, v57
    v_add_f32 v42, v42, v58
    v_add_f32 v43, v43, v59
cs_28:
    s_barrier
    s_cmp_ge_u32 s9, 2
    s_cbranch_scc1 cs_29
    v_add_f32 v44, v44, v60
    v_add_f32 v45, v45, v61
    v_add_f32 v46, v46, v62
    v_add_f32 v47, v47, v63
    v_add_f32 v32, v32, v40
    v_add_f32 v33, v33, v41
    v_add_f32 v34, v34, v42
    v_add_f32 v35, v35, v43
    v_add_f32 v36, v36, v44
    v_add_f32 v37, v37, v45
    v_add_f32 v38, v38, v46
    v_add_f32 v39, v39, v47
cs_29:
    s_barrier
    s_cmp_ge_u32 s9, 2
    s_cbranch_scc1 cs_30
    v_add_f32 v32, v32, v36
    v_add_f32 v33, v33, v37
    v_add_f32 v34, v34, v38
    v_add_f32 v35, v35, v39
    v_add_f32 v32, v32, v34
    v_add_f32 v33, v33, v35
    ds_write_b64 v12, v[32:33]
    s_waitcnt lgkmcnt(0)
cs_30:
    s_barrier
    s_barrier
    s_branch s_attn
.p2align 6
l_first_tail:
    s_mov_b32 s28, s40
    s_mov_b32 s29, s41
    s_mov_b32 s30, 6291456
    s_mov_b32 s31, 0x00020000
    v_lshlrev_b32 v14, 6, v20
    v_lshrrev_b32 v22, 5, v1
    v_bfe_u32 v23, v1, 1, 1
    v_xor_b32 v22, v22, v23
    v_lshl_add_u32 v14, v22, 5, v14
    v_and_b32 v22, 1, v1
    v_lshl_add_u32 v14, v22, 4, v14
    v_bfe_u32 v23, v1, 2, 1
    v_mul_u32_u24 v23, 196608, v23
    v_add_u32 v14, v14, v23
    v_lshlrev_b32 v22, 4, v22
    v_mov_b32 v23, 0x3f80
    v_lshlrev_b32 v23, v22, v23
    v_bfe_u32 v22, v1, 1, 3
    v_cmp_eq_u32 vcc, 0, v22
    s_nop 1
    v_cndmask_b32 v24, 0, v23, vcc
    v_cmp_eq_u32 vcc, 1, v22
    s_nop 1
    v_cndmask_b32 v25, 0, v23, vcc
    v_cmp_eq_u32 vcc, 2, v22
    s_nop 1
    v_cndmask_b32 v26, 0, v23, vcc
    v_cmp_eq_u32 vcc, 3, v22
    s_nop 1
    v_cndmask_b32 v27, 0, v23, vcc
    v_lshlrev_b32 v15, 5, v21
    v_and_b32 v22, 16, v1
    v_add_u32 v15, v15, v22
    v_lshlrev_b32 v16, 14, v1
    s_mov_b32 s9, 0
    s_lshr_b32 s55, s63, 4
    s_and_b32 s56, s63, 15
    s_lshl_b32 s57, s56, 4
    s_lshr_b32 s58, s62, 1
    s_add_u32 s57, s57, s58
    s_mul_i32 s57, s57, 3
    s_add_u32 s57, s57, s55
    s_lshl_b32 s57, s57, 13
    s_and_b32 s58, s62, 1
    s_lshl_b32 s58, s58, 12
    s_add_u32 s57, s57, s58
    s_add_u32 s57, s57, 50331648
    s_lshl_b32 s54, s61, 8
    s_add_u32 s54, s54, 63963136
    s_lshl_b32 s56, s56, 10
    s_lshl_b32 s55, s55, 7
    s_add_u32 s55, s55, s56
    s_lshl_b32 s56, s62, 2
    s_add_u32 s55, s55, s56
    s_add_u32 s55, s55, 64487424
    s_waitcnt vmcnt(7)
    buffer_store_dwordx4 v[160:163], v14, s[12:15], s57 offen offset:0 sc1
    v_mfma_f32_16x16x32_bf16 v[28:31], v[24:27], v[160:163], 0
    s_waitcnt vmcnt(7)
    buffer_store_dwordx4 v[164:167], v14, s[12:15], s57 offen offset:1024 sc1
    v_mfma_f32_16x16x32_bf16 v[28:31], v[24:27], v[164:167], v[28:31]
    s_waitcnt vmcnt(7)
    buffer_store_dwordx4 v[168:171], v14, s[12:15], s57 offen offset:512 sc1
    v_mfma_f32_16x16x32_bf16 v[28:31], v[24:27], v[168:171], v[28:31]
    s_waitcnt vmcnt(7)
    buffer_store_dwordx4 v[172:175], v14, s[12:15], s57 offen offset:1536 sc1
    v_mfma_f32_16x16x32_bf16 v[28:31], v[24:27], v[172:175], v[28:31]
    s_waitcnt vmcnt(7)
    buffer_store_dwordx4 v[176:179], v14, s[12:15], s57 offen offset:2048 sc1
    v_mfma_f32_16x16x32_bf16 v[28:31], v[24:27], v[176:179], v[28:31]
    s_waitcnt vmcnt(7)
    buffer_store_dwordx4 v[180:183], v14, s[12:15], s57 offen offset:3072 sc1
    v_mfma_f32_16x16x32_bf16 v[28:31], v[24:27], v[180:183], v[28:31]
    s_waitcnt vmcnt(7)
    buffer_store_dwordx4 v[184:187], v14, s[12:15], s57 offen offset:2560 sc1
    v_mfma_f32_16x16x32_bf16 v[28:31], v[24:27], v[184:187], v[28:31]
    s_waitcnt vmcnt(7)
    buffer_store_dwordx4 v[188:191], v14, s[12:15], s57 offen offset:3584 sc1
    v_mfma_f32_16x16x32_bf16 v[28:31], v[24:27], v[188:191], v[28:31]
    s_nop 7
    v_add_f32_dpp v28, v28, v28 row_ror:8 row_mask:0xf bank_mask:0xf
    v_add_f32_dpp v29, v29, v29 row_ror:8 row_mask:0xf bank_mask:0xf
    v_add_f32_dpp v30, v30, v30 row_ror:8 row_mask:0xf bank_mask:0xf
    v_add_f32_dpp v31, v31, v31 row_ror:8 row_mask:0xf bank_mask:0xf
    s_mov_b64 exec, 0x00ff00ff
    buffer_store_dwordx4 v[28:31], v15, s[12:15], s54 offen sc1
    s_mov_b64 exec, -1
    s_add_u32 s57, s57, 6291456
    s_add_u32 s54, s54, 196608
    v_mov_b32 v8, 159492
non_33:
    ds_read_b32 v9, v8
    s_waitcnt lgkmcnt(0)
    v_readfirstlane_b32 s10, v9
    s_cmp_eq_u32 s10, 0
    s_cbranch_scc1 non_33
    s_mov_b64 exec, 0xffff
    s_waitcnt vmcnt(0)
    buffer_store_dword v9, v16, s[12:15], s55 offen offset:0 sc1
    s_mov_b64 exec, -1
    s_add_u32 s53, s52, 0
    buffer_load_dwordx4 v[192:195], v12, s[28:31], s53 offen nt
    s_add_u32 s53, s52, 49152
    buffer_load_dwordx4 v[196:199], v12, s[28:31], s53 offen nt
    s_add_u32 s53, s52, 98304
    buffer_load_dwordx4 v[200:203], v12, s[28:31], s53 offen nt
    s_add_u32 s53, s52, 147456
    buffer_load_dwordx4 v[204:207], v12, s[28:31], s53 offen nt
    s_add_u32 s53, s52, 196608
    buffer_load_dwordx4 v[208:211], v12, s[28:31], s53 offen nt
    s_add_u32 s53, s52, 245760
    buffer_load_dwordx4 v[212:215], v12, s[28:31], s53 offen nt
    s_add_u32 s53, s52, 294912
    buffer_load_dwordx4 v[216:219], v12, s[28:31], s53 offen nt
    s_add_u32 s53, s52, 344064
    buffer_load_dwordx4 v[220:223], v12, s[28:31], s53 offen nt
    s_mov_b32 s58, s52
    s_lshr_b32 s60, s2, 3
    s_mul_i32 s60, s60, 3
    s_lshr_b32 s60, s60, 5
    s_add_u32 s60, s60, 1
    s_branch l_qkv2
l_qkv:
    s_mov_b32 s60, 0
l_qkv2:
    v_and_b32 v1, 63, v0
    v_lshlrev_b32 v5, 4, v1
    s_sub_u32 s51, s8, 5
    s_lshl_b32 s48, s51, 13
    s_and_b32 s53, s9, 1
    s_lshl_b32 s52, s53, 4
    s_add_u32 s49, s7, s52
    s_lshl_b32 s49, s49, 1
    s_and_b32 s52, s6, 1
    s_add_u32 s49, s49, s52
    s_mul_i32 s49, s49, 196608
    s_add_u32 s49, s49, s48
    s_add_u32 s49, s49, 50331648
    v_mov_b32 v13, 159496
    s_mov_b32 s50, 0
    v_lshrrev_b32 v10, 2, v1
    v_and_b32 v11, 3, v1
    v_lshlrev_b32 v10, 8, v10
    v_lshl_add_u32 v10, v11, 4, v10
    v_lshlrev_b32 v7, 5, v11
    v_lshlrev_b32 v11, 2, v1
    v_add_u32 v11, 155648, v11
    s_lshr_b32 s59, s11, 2
    s_lshl_b32 s59, s59, 12
    s_and_b32 s3, s11, 3
    s_lshl_b32 s3, s3, 6
    s_add_u32 s59, s59, s3
    s_lshl_b32 s3, s9, 18
    s_add_u32 s59, s59, s3
    s_add_u32 s59, s59, 62914560
    s_lshl_b32 s56, s9, 15
    s_add_u32 s56, s56, 64749568
    v_mov_b32 v41, s10
    v_mov_b32 v43, s10
    v_mov_b32 v45, s10
    v_mov_b32 v47, s10
    v_and_b32 v6, 0xff, v5
    s_lshl_b32 s3, s7, 7
    v_lshrrev_b32 v20, 3, v1
    v_lshlrev_b32 v21, 11, v20
    v_and_b32 v22, 2, v20
    v_lshrrev_b32 v23, 2, v20
    v_or_b32 v22, v22, v23
    v_bfe_u32 v23, v1, 1, 2
    v_xor_b32 v22, v22, v23
    v_lshl_add_u32 v21, v22, 5, v21
    v_and_b32 v22, 1, v1
    v_lshl_add_u32 v21, v22, 4, v21
    v_add_u32 v17, s3, v21
    s_lshl_b32 s3, s51, 13
    s_add_u32 s3, s3, 24576
    v_add_u32 v3, s3, v5
    s_cmp_lg_u32 s9, 0
    s_cbranch_scc1 l_qkv_tiled
    s_lshl_b32 s53, s8, 7
    s_lshl_b32 s52, s11, 10
    s_add_u32 s53, s53, s52
    s_add_u32 s53, s53, 64486784
    s_add_u32 s96, s4, s53
    s_addc_u32 s97, s5, 0
    s_mov_b32 s98, s10
    s_mov_b32 s99, s10
    s_mov_b32 s3, 0x100000
poll_34:
    s_load_dwordx16 s[80:95], s[96:97], 0 glc
    s_sub_u32 s3, s3, 1
    s_cbranch_scc1 poll_34_ok
    s_waitcnt lgkmcnt(0)
    s_xor_b64 s[100:101], s[80:81], s[98:99]
    s_xor_b64 s[80:81], s[82:83], s[98:99]
    s_or_b64 s[100:101], s[100:101], s[80:81]
    s_xor_b64 s[80:81], s[84:85], s[98:99]
    s_or_b64 s[100:101], s[100:101], s[80:81]
    s_xor_b64 s[80:81], s[86:87], s[98:99]
    s_or_b64 s[100:101], s[100:101], s[80:81]
    s_xor_b64 s[80:81], s[88:89], s[98:99]
    s_or_b64 s[100:101], s[100:101], s[80:81]
    s_xor_b64 s[80:81], s[90:91], s[98:99]
    s_or_b64 s[100:101], s[100:101], s[80:81]
    s_xor_b64 s[80:81], s[92:93], s[98:99]
    s_or_b64 s[100:101], s[100:101], s[80:81]
    s_xor_b64 s[80:81], s[94:95], s[98:99]
    s_or_b64 s[100:101], s[100:101], s[80:81]
    s_cbranch_scc1 poll_34
poll_34_ok:
    s_waitcnt lgkmcnt(0)
    s_mov_b32 m0, s48
    s_add_u32 s50, s50, 1
    buffer_load_dwordx4 v5, s[12:15], s49 offen offset:0 sc1 lds
    buffer_load_dwordx4 v5, s[12:15], s49 offen offset:1024 sc1 lds
    buffer_load_dwordx4 v5, s[12:15], s49 offen offset:2048 sc1 lds
    buffer_load_dwordx4 v5, s[12:15], s49 offen offset:3072 sc1 lds
    s_add_u32 s49, s49, 4096
    s_bitcmp1_b32 s50, 0
    s_cselect_b32 s3, 0, 16384
    s_add_u32 s48, s48, s3
    s_add_u32 s49, s49, s3
    s_cmp_eq_u32 s50, 12
    s_cselect_b32 s3, 4294819840, 0
    s_add_u32 s48, s48, 4096
    s_add_u32 s48, s48, s3
    s_mov_b32 m0, s48
    s_add_u32 s50, s50, 1
    buffer_load_dwordx4 v5, s[12:15], s49 offen offset:0 sc1 lds
    buffer_load_dwordx4 v5, s[12:15], s49 offen offset:1024 sc1 lds
    buffer_load_dwordx4 v5, s[12:15], s49 offen offset:2048 sc1 lds
    buffer_load_dwordx4 v5, s[12:15], s49 offen offset:3072 sc1 lds
    s_add_u32 s49, s49, 4096
    s_bitcmp1_b32 s50, 0
    s_cselect_b32 s3, 0, 16384
    s_add_u32 s48, s48, s3
    s_add_u32 s49, s49, s3
    s_cmp_eq_u32 s50, 12
    s_cselect_b32 s3, 4294819840, 0
    s_add_u32 s48, s48, 4096
    s_add_u32 s48, s48, s3
    s_mov_b32 m0, s48
    s_add_u32 s50, s50, 1
    buffer_load_dwordx4 v5, s[12:15], s49 offen offset:0 sc1 lds
    buffer_load_dwordx4 v5, s[12:15], s49 offen offset:1024 sc1 lds
    buffer_load_dwordx4 v5, s[12:15], s49 offen offset:2048 sc1 lds
    buffer_load_dwordx4 v5, s[12:15], s49 offen offset:3072 sc1 lds
    s_add_u32 s49, s49, 4096
    s_bitcmp1_b32 s50, 0
    s_cselect_b32 s3, 0, 16384
    s_add_u32 s48, s48, s3
    s_add_u32 s49, s49, s3
    s_cmp_eq_u32 s50, 12
    s_cselect_b32 s3, 4294819840, 0
    s_add_u32 s48, s48, 4096
    s_add_u32 s48, s48, s3
    s_mov_b32 m0, s48
    s_add_u32 s50, s50, 1
    buffer_load_dwordx4 v5, s[12:15], s49 offen offset:0 sc1 lds
    buffer_load_dwordx4 v5, s[12:15], s49 offen offset:1024 sc1 lds
    buffer_load_dwordx4 v5, s[12:15], s49 offen offset:2048 sc1 lds
    buffer_load_dwordx4 v5, s[12:15], s49 offen offset:3072 sc1 lds
    s_add_u32 s49, s49, 4096
    s_bitcmp1_b32 s50, 0
    s_cselect_b32 s3, 0, 16384
    s_add_u32 s48, s48, s3
    s_add_u32 s49, s49, s3
    s_cmp_eq_u32 s50, 12
    s_cselect_b32 s3, 4294819840, 0
    s_add_u32 s48, s48, 4096
    s_add_u32 s48, s48, s3
    s_waitcnt vmcnt(16)
    buffer_store_dwordx4 v[192:195], v14, s[12:15], s57 offen offset:0 sc1
    v_mfma_f32_16x16x32_bf16 v[28:31], v[24:27], v[192:195], 0
    buffer_store_dwordx4 v[196:199], v14, s[12:15], s57 offen offset:1024 sc1
    v_mfma_f32_16x16x32_bf16 v[28:31], v[24:27], v[196:199], v[28:31]
    buffer_store_dwordx4 v[200:203], v14, s[12:15], s57 offen offset:512 sc1
    v_mfma_f32_16x16x32_bf16 v[28:31], v[24:27], v[200:203], v[28:31]
    buffer_store_dwordx4 v[204:207], v14, s[12:15], s57 offen offset:1536 sc1
    v_mfma_f32_16x16x32_bf16 v[28:31], v[24:27], v[204:207], v[28:31]
    buffer_store_dwordx4 v[208:211], v14, s[12:15], s57 offen offset:2048 sc1
    v_mfma_f32_16x16x32_bf16 v[28:31], v[24:27], v[208:211], v[28:31]
    buffer_store_dwordx4 v[212:215], v14, s[12:15], s57 offen offset:3072 sc1
    v_mfma_f32_16x16x32_bf16 v[28:31], v[24:27], v[212:215], v[28:31]
    buffer_store_dwordx4 v[216:219], v14, s[12:15], s57 offen offset:2560 sc1
    v_mfma_f32_16x16x32_bf16 v[28:31], v[24:27], v[216:219], v[28:31]
    buffer_store_dwordx4 v[220:223], v14, s[12:15], s57 offen offset:3584 sc1
    v_mfma_f32_16x16x32_bf16 v[28:31], v[24:27], v[220:223], v[28:31]
    s_waitcnt vmcnt(16)
    s_barrier
    s_branch l_qkv_gone
    s_branch l_qkv_fill
l_qkv_tiled:
    s_barrier
    s_cmp_lt_u32 s9, 2
    s_cbranch_scc1 l_qkv_nocache
    s_bitcmp1_b32 s9, 0
    s_cbranch_scc1 l_qkv_c_b
    ds_write_b128 v3, v[64:67] offset:0
    ds_write_b128 v3, v[68:71] offset:1024
    ds_write_b128 v3, v[72:75] offset:2048
    ds_write_b128 v3, v[76:79] offset:3072
    ds_write_b128 v3, v[80:83] offset:4096
    ds_write_b128 v3, v[84:87] offset:5120
    ds_write_b128 v3, v[88:91] offset:6144
    ds_write_b128 v3, v[92:95] offset:7168
    ds_write_b128 v3, v[96:99] offset:24576
    ds_write_b128 v3, v[100:103] offset:25600
    ds_write_b128 v3, v[104:107] offset:26624
    ds_write_b128 v3, v[108:111] offset:27648
    ds_write_b128 v3, v[112:115] offset:28672
    ds_write_b128 v3, v[116:119] offset:29696
    ds_write_b128 v3, v[120:123] offset:30720
    ds_write_b128 v3, v[124:127] offset:31744
    ds_write_b128 v3, v[128:131] offset:49152
    ds_write_b128 v3, v[132:135] offset:50176
    ds_write_b128 v3, v[136:139] offset:51200
    ds_write_b128 v3, v[140:143] offset:52224
    ds_write_b128 v3, v[144:147] offset:53248
    ds_write_b128 v3, v[148:151] offset:54272
    ds_write_b128 v3, v[152:155] offset:55296
    ds_write_b128 v3, v[156:159] offset:56320
    s_branch l_qkv_c_w
l_qkv_c_b:
    ds_write_b128 v3, v[160:163] offset:0
    ds_write_b128 v3, v[164:167] offset:1024
    ds_write_b128 v3, v[168:171] offset:2048
    ds_write_b128 v3, v[172:175] offset:3072
    ds_write_b128 v3, v[176:179] offset:4096
    ds_write_b128 v3, v[180:183] offset:5120
    ds_write_b128 v3, v[184:187] offset:6144
    ds_write_b128 v3, v[188:191] offset:7168
    ds_write_b128 v3, v[192:195] offset:24576
    ds_write_b128 v3, v[196:199] offset:25600
    ds_write_b128 v3, v[200:203] offset:26624
    ds_write_b128 v3, v[204:207] offset:27648
    ds_write_b128 v3, v[208:211] offset:28672
    ds_write_b128 v3, v[212:215] offset:29696
    ds_write_b128 v3, v[216:219] offset:30720
    ds_write_b128 v3, v[220:223] offset:31744
    ds_write_b128 v3, a[0:3] offset:49152
    ds_write_b128 v3, a[4:7] offset:50176
    ds_write_b128 v3, a[8:11] offset:51200
    ds_write_b128 v3, a[12:15] offset:52224
    ds_write_b128 v3, a[16:19] offset:53248
    ds_write_b128 v3, a[20:23] offset:54272
    ds_write_b128 v3, a[24:27] offset:55296
    ds_write_b128 v3, a[28:31] offset:56320
l_qkv_c_w:
    s_waitcnt lgkmcnt(0)
    s_mov_b32 s50, 8
    s_add_u32 s49, s49, 98304
    s_add_u32 s48, s48, 98304
    s_barrier
    s_mov_b32 m0, s48
    s_add_u32 s50, s50, 1
    buffer_load_dwordx4 v5, s[12:15], s49 offen offset:0 sc1 lds
    buffer_load_dwordx4 v5, s[12:15], s49 offen offset:1024 sc1 lds
    buffer_load_dwordx4 v5, s[12:15], s49 offen offset:2048 sc1 lds
    buffer_load_dwordx4 v5, s[12:15], s49 offen offset:3072 sc1 lds
    s_add_u32 s49, s49, 4096
    s_bitcmp1_b32 s50, 0
    s_cselect_b32 s3, 0, 16384
    s_add_u32 s48, s48, s3
    s_add_u32 s49, s49, s3
    s_cmp_eq_u32 s50, 12
    s_cselect_b32 s3, 4294819840, 0
    s_add_u32 s48, s48, 4096
    s_add_u32 s48, s48, s3
    s_mov_b32 m0, s48
    s_add_u32 s50, s50, 1
    buffer_load_dwordx4 v5, s[12:15], s49 offen offset:0 sc1 lds
    buffer_load_dwordx4 v5, s[12:15], s49 offen offset:1024 sc1 lds
    buffer_load_dwordx4 v5, s[12:15], s49 offen offset:2048 sc1 lds
    buffer_load_dwordx4 v5, s[12:15], s49 offen offset:3072 sc1 lds
    s_add_u32 s49, s49, 4096
    s_bitcmp1_b32 s50, 0
    s_cselect_b32 s3, 0, 16384
    s_add_u32 s48, s48, s3
    s_add_u32 s49, s49, s3
    s_cmp_eq_u32 s50, 12
    s_cselect_b32 s3, 4294819840, 0
    s_add_u32 s48, s48, 4096
    s_add_u32 s48, s48, s3
    s_mov_b32 m0, s48
    s_add_u32 s50, s50, 1
    buffer_load_dwordx4 v5, s[12:15], s49 offen offset:0 sc1 lds
    buffer_load_dwordx4 v5, s[12:15], s49 offen offset:1024 sc1 lds
    buffer_load_dwordx4 v5, s[12:15], s49 offen offset:2048 sc1 lds
    buffer_load_dwordx4 v5, s[12:15], s49 offen offset:3072 sc1 lds
    s_add_u32 s49, s49, 4096
    s_bitcmp1_b32 s50, 0
    s_cselect_b32 s3, 0, 16384
    s_add_u32 s48, s48, s3
    s_add_u32 s49, s49, s3
    s_cmp_eq_u32 s50, 12
    s_cselect_b32 s3, 4294819840, 0
    s_add_u32 s48, s48, 4096
    s_add_u32 s48, s48, s3
    s_mov_b32 m0, s48
    s_add_u32 s50, s50, 1
    buffer_load_dwordx4 v5, s[12:15], s49 offen offset:0 sc1 lds
    buffer_load_dwordx4 v5, s[12:15], s49 offen offset:1024 sc1 lds
    buffer_load_dwordx4 v5, s[12:15], s49 offen offset:2048 sc1 lds
    buffer_load_dwordx4 v5, s[12:15], s49 offen offset:3072 sc1 lds
    s_add_u32 s49, s49, 4096
    s_bitcmp1_b32 s50, 0
    s_cselect_b32 s3, 0, 16384
    s_add_u32 s48, s48, s3
    s_add_u32 s49, s49, s3
    s_cmp_eq_u32 s50, 12
    s_cselect_b32 s3, 4294819840, 0
    s_add_u32 s48, s48, 4096
    s_add_u32 s48, s48, s3
    s_barrier
    s_branch l_qkv_gone
l_qkv_nocache:
    s_barrier
l_qkv_fill:
    s_mov_b32 m0, s48
    s_add_u32 s50, s50, 1
    buffer_load_dwordx4 v5, s[12:15], s49 offen offset:0 sc1 lds
    buffer_load_dwordx4 v5, s[12:15], s49 offen offset:1024 sc1 lds
    buffer_load_dwordx4 v5, s[12:15], s49 offen offset:2048 sc1 lds
    buffer_load_dwordx4 v5, s[12:15], s49 offen offset:3072 sc1 lds
    s_add_u32 s49, s49, 4096
    s_bitcmp1_b32 s50, 0
    s_cselect_b32 s3, 0, 16384
    s_add_u32 s48, s48, s3
    s_add_u32 s49, s49, s3
    s_cmp_eq_u32 s50, 12
    s_cselect_b32 s3, 4294819840, 0
    s_add_u32 s48, s48, 4096
    s_add_u32 s48, s48, s3
l_qkv_fill1:
    s_mov_b32 m0, s48
    s_add_u32 s50, s50, 1
    buffer_load_dwordx4 v5, s[12:15], s49 offen offset:0 sc1 lds
    buffer_load_dwordx4 v5, s[12:15], s49 offen offset:1024 sc1 lds
    buffer_load_dwordx4 v5, s[12:15], s49 offen offset:2048 sc1 lds
    buffer_load_dwordx4 v5, s[12:15], s49 offen offset:3072 sc1 lds
    s_add_u32 s49, s49, 4096
    s_bitcmp1_b32 s50, 0
    s_cselect_b32 s3, 0, 16384
    s_add_u32 s48, s48, s3
    s_add_u32 s49, s49, s3
    s_cmp_eq_u32 s50, 12
    s_cselect_b32 s3, 4294819840, 0
    s_add_u32 s48, s48, 4096
    s_add_u32 s48, s48, s3
l_qkv_fill2:
    s_add_u32 s52, s9, 1
    s_mov_b32 m0, s48
    s_add_u32 s50, s50, 1
    buffer_load_dwordx4 v5, s[12:15], s49 offen offset:0 sc1 lds
    s_waitcnt vmcnt(10)
    buffer_load_dwordx4 v5, s[12:15], s49 offen offset:1024 sc1 lds
    s_waitcnt vmcnt(10)
    buffer_load_dwordx4 v5, s[12:15], s49 offen offset:2048 sc1 lds
    s_waitcnt vmcnt(10)
    buffer_load_dwordx4 v5, s[12:15], s49 offen offset:3072 sc1 lds
    s_waitcnt vmcnt(10)
    s_add_u32 s49, s49, 4096
    s_bitcmp1_b32 s50, 0
    s_cselect_b32 s3, 0, 16384
    s_add_u32 s48, s48, s3
    s_add_u32 s49, s49, s3
    s_cmp_eq_u32 s50, 12
    s_cselect_b32 s3, 4294819840, 0
    s_add_u32 s48, s48, 4096
    s_add_u32 s48, s48, s3
l_qkv_pre:
    s_mov_b32 m0, s48
    s_add_u32 s50, s50, 1
    buffer_load_dwordx4 v5, s[12:15], s49 offen offset:0 sc1 lds
    s_waitcnt vmcnt(10)
    buffer_load_dwordx4 v5, s[12:15], s49 offen offset:1024 sc1 lds
    s_waitcnt vmcnt(10)
    buffer_load_dwordx4 v5, s[12:15], s49 offen offset:2048 sc1 lds
    s_waitcnt vmcnt(10)
    buffer_load_dwordx4 v5, s[12:15], s49 offen offset:3072 sc1 lds
    s_waitcnt vmcnt(10)
    s_add_u32 s49, s49, 4096
    s_bitcmp1_b32 s50, 0
    s_cselect_b32 s3, 0, 16384
    s_add_u32 s48, s48, s3
    s_add_u32 s49, s49, s3
    s_cmp_eq_u32 s50, 12
    s_cselect_b32 s3, 4294819840, 0
    s_add_u32 s48, s48, 4096
    s_add_u32 s48, s48, s3
    ds_read_b32 v8, v13
    s_cmp_ge_u32 s50, 12
    s_cbranch_scc1 l_qkv_go
    s_waitcnt lgkmcnt(0)
    v_readfirstlane_b32 s3, v8
    s_cmp_lg_u32 s3, s52
    s_cbranch_scc1 l_qkv_pre
    s_cmp_ge_u32 s50, 5
    s_cbranch_scc1 l_qkv_go
    s_waitcnt vmcnt(8)
l_qkv_go:
    s_waitcnt lgkmcnt(0)
    s_barrier
l_qkv_gone:
    s_bitcmp0_b32 s50, 0
    s_cbranch_scc1 l_qkv_even
    s_mov_b32 m0, s48
    s_add_u32 s50, s50, 1
    buffer_load_dwordx4 v5, s[12:15], s49 offen offset:0 sc1 lds
    buffer_load_dwordx4 v5, s[12:15], s49 offen offset:1024 sc1 lds
    buffer_load_dwordx4 v5, s[12:15], s49 offen offset:2048 sc1 lds
    buffer_load_dwordx4 v5, s[12:15], s49 offen offset:3072 sc1 lds
    s_add_u32 s49, s49, 4096
    s_bitcmp1_b32 s50, 0
    s_cselect_b32 s3, 0, 16384
    s_add_u32 s48, s48, s3
    s_add_u32 s49, s49, s3
    s_cmp_eq_u32 s50, 12
    s_cselect_b32 s3, 4294819840, 0
    s_add_u32 s48, s48, 4096
    s_add_u32 s48, s48, s3
l_qkv_even:
    s_cmp_gt_u32 s50, 11
    s_cbranch_scc1 stg_35
    s_mov_b32 m0, s48
    s_add_u32 s50, s50, 1
    buffer_load_dwordx4 v5, s[12:15], s49 offen offset:0 sc1 lds
    buffer_load_dwordx4 v5, s[12:15], s49 offen offset:1024 sc1 lds
    buffer_load_dwordx4 v5, s[12:15], s49 offen offset:2048 sc1 lds
    buffer_load_dwordx4 v5, s[12:15], s49 offen offset:3072 sc1 lds
    s_add_u32 s49, s49, 4096
    s_bitcmp1_b32 s50, 0
    s_cselect_b32 s3, 0, 16384
    s_add_u32 s48, s48, s3
    s_add_u32 s49, s49, s3
    s_cmp_eq_u32 s50, 12
    s_cselect_b32 s3, 4294819840, 0
    s_add_u32 s48, s48, 4096
    s_add_u32 s48, s48, s3
    s_cmp_ge_u32 s9, 2
    s_cbranch_scc1 stg_35
stg_35:
    s_cmp_lg_u32 s51, 0
    s_cbranch_scc1 role_36
    buffer_load_dwordx4 v[32:35], v10, s[12:15], s59 offen sc1
role_36:
    s_lshr_b32 s3, s9, 1
    s_andn2_b32 s3, s50, s3
    s_bitcmp0_b32 s3, 0
    s_cbranch_scc1 str_37
    s_waitcnt vmcnt(1)
    s_mov_b32 m0, s48
    s_add_u32 s50, s50, 1
    buffer_load_dwordx4 v5, s[12:15], s49 offen offset:0 sc1 lds
    buffer_load_dwordx4 v5, s[12:15], s49 offen offset:1024 sc1 lds
    buffer_load_dwordx4 v5, s[12:15], s49 offen offset:2048 sc1 lds
    buffer_load_dwordx4 v5, s[12:15], s49 offen offset:3072 sc1 lds
    s_add_u32 s49, s49, 4096
    s_bitcmp1_b32 s50, 0
    s_cselect_b32 s3, 0, 16384
    s_add_u32 s48, s48, s3
    s_add_u32 s49, s49, s3
    s_cmp_eq_u32 s50, 12
    s_cselect_b32 s3, 4294819840, 0
    s_add_u32 s48, s48, 4096
    s_add_u32 s48, s48, s3
str_37:
    s_waitcnt vmcnt(8)
    s_barrier
    s_waitcnt vmcnt(0)
l_qkv_b0:
    s_cmp_gt_u32 s50, 13
    s_cbranch_scc1 stg_38
    s_mov_b32 m0, s48
    s_add_u32 s50, s50, 1
    buffer_load_dwordx4 v5, s[12:15], s49 offen offset:0 sc1 lds
    buffer_load_dwordx4 v5, s[12:15], s49 offen offset:1024 sc1 lds
    buffer_load_dwordx4 v5, s[12:15], s49 offen offset:2048 sc1 lds
    buffer_load_dwordx4 v5, s[12:15], s49 offen offset:3072 sc1 lds
    s_add_u32 s49, s49, 4096
    s_bitcmp1_b32 s50, 0
    s_cselect_b32 s3, 0, 16384
    s_add_u32 s48, s48, s3
    s_add_u32 s49, s49, s3
    s_cmp_eq_u32 s50, 12
    s_cselect_b32 s3, 4294819840, 0
    s_add_u32 s48, s48, 4096
    s_add_u32 s48, s48, s3
    s_cmp_ge_u32 s9, 2
    s_cbranch_scc1 stg_38
stg_38:
    s_cmp_eq_u32 s60, 0
    s_cbranch_scc1 ub_39
    v_add_f32_dpp v28, v28, v28 row_ror:8 row_mask:0xf bank_mask:0xf
    v_add_f32_dpp v29, v29, v29 row_ror:8 row_mask:0xf bank_mask:0xf
    v_add_f32_dpp v30, v30, v30 row_ror:8 row_mask:0xf bank_mask:0xf
    v_add_f32_dpp v31, v31, v31 row_ror:8 row_mask:0xf bank_mask:0xf
    s_mov_b64 exec, 0x00ff00ff
    buffer_store_dwordx4 v[28:31], v15, s[12:15], s54 offen sc1
    s_mov_b64 exec, -1
ub_39:
    s_cmp_ge_u32 s9, 2
    s_cbranch_scc1 wc_40
    s_bitcmp1_b32 s9, 0
    s_cbranch_scc1 wc_40_b
    ds_read_b128 v[64:67], v3 offset:0
    ds_read_b128 v[68:71], v3 offset:1024
    ds_read_b128 v[72:75], v3 offset:2048
    ds_read_b128 v[76:79], v3 offset:3072
    ds_read_b128 v[80:83], v3 offset:4096
    ds_read_b128 v[84:87], v3 offset:5120
    ds_read_b128 v[88:91], v3 offset:6144
    ds_read_b128 v[92:95], v3 offset:7168
    s_branch wc_40_w
wc_40_b:
    ds_read_b128 v[160:163], v3 offset:0
    ds_read_b128 v[164:167], v3 offset:1024
    ds_read_b128 v[168:171], v3 offset:2048
    ds_read_b128 v[172:175], v3 offset:3072
    ds_read_b128 v[176:179], v3 offset:4096
    ds_read_b128 v[180:183], v3 offset:5120
    ds_read_b128 v[184:187], v3 offset:6144
    ds_read_b128 v[188:191], v3 offset:7168
wc_40_w:
    s_waitcnt lgkmcnt(0)
wc_40:
    s_cmp_lg_u32 s51, 0
    s_cbranch_scc1 role_41
    v_add_f32_dpp v32, v32, v32 row_ror:4 row_mask:0xf bank_mask:0xf
    v_add_f32_dpp v33, v33, v33 row_ror:4 row_mask:0xf bank_mask:0xf
    v_add_f32_dpp v34, v34, v34 row_ror:4 row_mask:0xf bank_mask:0xf
    v_add_f32_dpp v35, v35, v35 row_ror:4 row_mask:0xf bank_mask:0xf
    v_add_f32_dpp v32, v32, v32 row_ror:8 row_mask:0xf bank_mask:0xf
    v_add_f32_dpp v33, v33, v33 row_ror:8 row_mask:0xf bank_mask:0xf
    v_add_f32_dpp v34, v34, v34 row_ror:8 row_mask:0xf bank_mask:0xf
    v_add_f32_dpp v35, v35, v35 row_ror:8 row_mask:0xf bank_mask:0xf
    v_mov_b32 v36, v32
    v_mov_b32 v37, v33
    v_mov_b32 v38, v34
    v_mov_b32 v39, v35
    v_permlane16_swap_b32 v32, v36
    v_permlane16_swap_b32 v33, v37
    v_permlane16_swap_b32 v34, v38
    v_permlane16_swap_b32 v35, v39
    v_add_f32 v32, v32, v36
    v_add_f32 v33, v33, v37
    v_add_f32 v34, v34, v38
    v_add_f32 v35, v35, v39
    v_mov_b32 v36, v32
    v_mov_b32 v37, v33
    v_mov_b32 v38, v34
    v_mov_b32 v39, v35
    v_permlane32_swap_b32 v32, v36
    v_permlane32_swap_b32 v33, v37
    v_permlane32_swap_b32 v34, v38
    v_permlane32_swap_b32 v35, v39
    v_add_f32 v40, v32, v36
    v_add_f32 v42, v33, v37
    v_add_f32 v44, v34, v38
    v_add_f32 v46, v35, v39
role_41:
    s_lshr_b32 s3, s9, 1
    s_andn2_b32 s3, s50, s3
    s_bitcmp0_b32 s3, 0
    s_cbranch_scc1 str_42
    s_waitcnt vmcnt(1)
    s_mov_b32 m0, s48
    s_add_u32 s50, s50, 1
    buffer_load_dwordx4 v5, s[12:15], s49 offen offset:0 sc1 lds
    buffer_load_dwordx4 v5, s[12:15], s49 offen offset:1024 sc1 lds
    buffer_load_dwordx4 v5, s[12:15], s49 offen offset:2048 sc1 lds
    buffer_load_dwordx4 v5, s[12:15], s49 offen offset:3072 sc1 lds
    s_add_u32 s49, s49, 4096
    s_bitcmp1_b32 s50, 0
    s_cselect_b32 s3, 0, 16384
    s_add_u32 s48, s48, s3
    s_add_u32 s49, s49, s3
    s_cmp_eq_u32 s50, 12
    s_cselect_b32 s3, 4294819840, 0
    s_add_u32 s48, s48, 4096
    s_add_u32 s48, s48, s3
str_42:
    s_waitcnt vmcnt(8)
    s_barrier
    s_cmp_gt_u32 s50, 15
    s_cbranch_scc1 stg_43
    s_mov_b32 m0, s48
    s_add_u32 s50, s50, 1
    buffer_load_dwordx4 v5, s[12:15], s49 offen offset:0 sc1 lds
    buffer_load_dwordx4 v5, s[12:15], s49 offen offset:1024 sc1 lds
    buffer_load_dwordx4 v5, s[12:15], s49 offen offset:2048 sc1 lds
    buffer_load_dwordx4 v5, s[12:15], s49 offen offset:3072 sc1 lds
    s_add_u32 s49, s49, 4096
    s_bitcmp1_b32 s50, 0
    s_cselect_b32 s3, 0, 16384
    s_add_u32 s48, s48, s3
    s_add_u32 s49, s49, s3
    s_cmp_eq_u32 s50, 12
    s_cselect_b32 s3, 4294819840, 0
    s_add_u32 s48, s48, 4096
    s_add_u32 s48, s48, s3
    s_cmp_ge_u32 s9, 2
    s_cbranch_scc1 stg_43
stg_43:
    s_cmp_lg_u32 s51, 0
    s_cbranch_scc1 role_44
    v_mul_f32 v40, 0x3a800000, v40
    v_mul_f32 v44, 0x3a800000, v44
    v_mul_f32 v42, 0x3a800000, v42
    v_mul_f32 v46, 0x3a800000, v46
    v_fma_f32 v42, -v40, v40, v42
    v_fma_f32 v46, -v44, v44, v46
    v_max_f32 v42, 0, v42
    v_max_f32 v46, 0, v46
    v_add_f32 v42, 0x3727c5ac, v42
    v_add_f32 v46, 0x3727c5ac, v46
    v_rsq_f32 v42, v42
    v_rsq_f32 v46, v46
    s_lshl_b32 s3, s11, 7
    s_add_u32 s3, s3, s56
    s_mov_b64 exec, 0xf
    buffer_store_dwordx4 v[40:43], v7, s[12:15], s3 offen offset:0 sc1
    buffer_store_dwordx4 v[44:47], v7, s[12:15], s3 offen offset:16 sc1
    s_mov_b64 exec, -1
role_44:
    s_lshr_b32 s3, s9, 1
    s_andn2_b32 s3, s50, s3
    s_bitcmp0_b32 s3, 0
    s_cbranch_scc1 str_45
    s_waitcnt vmcnt(1)
    s_mov_b32 m0, s48
    s_add_u32 s50, s50, 1
    buffer_load_dwordx4 v5, s[12:15], s49 offen offset:0 sc1 lds
    buffer_load_dwordx4 v5, s[12:15], s49 offen offset:1024 sc1 lds
    buffer_load_dwordx4 v5, s[12:15], s49 offen offset:2048 sc1 lds
    buffer_load_dwordx4 v5, s[12:15], s49 offen offset:3072 sc1 lds
    s_add_u32 s49, s49, 4096
    s_bitcmp1_b32 s50, 0
    s_cselect_b32 s3, 0, 16384
    s_add_u32 s48, s48, s3
    s_add_u32 s49, s49, s3
    s_cmp_eq_u32 s50, 12
    s_cselect_b32 s3, 4294819840, 0
    s_add_u32 s48, s48, 4096
    s_add_u32 s48, s48, s3
str_45:
    s_waitcnt vmcnt(8)
    s_barrier
    s_cmp_gt_u32 s50, 15
    s_cbranch_scc1 stg_46
    s_mov_b32 m0, s48
    s_add_u32 s50, s50, 1
    buffer_load_dwordx4 v5, s[12:15], s49 offen offset:0 sc1 lds
    buffer_load_dwordx4 v5, s[12:15], s49 offen offset:1024 sc1 lds
    buffer_load_dwordx4 v5, s[12:15], s49 offen offset:2048 sc1 lds
    buffer_load_dwordx4 v5, s[12:15], s49 offen offset:3072 sc1 lds
    s_add_u32 s49, s49, 4096
    s_bitcmp1_b32 s50, 0
    s_cselect_b32 s3, 0, 16384
    s_add_u32 s48, s48, s3
    s_add_u32 s49, s49, s3
    s_cmp_eq_u32 s50, 12
    s_cselect_b32 s3, 4294819840, 0
    s_add_u32 s48, s48, 4096
    s_add_u32 s48, s48, s3
    s_cmp_ge_u32 s9, 2
    s_cbranch_scc1 stg_46
stg_46:
    s_cmp_eq_u32 s60, 0
    s_cbranch_scc1 ub_47
    s_waitcnt vmcnt(0)
    s_mov_b64 exec, 0xffff
    buffer_store_dword v9, v16, s[12:15], s55 offen offset:384 sc1
    s_mov_b64 exec, -1
ub_47:
    s_cmp_ge_u32 s9, 2
    s_cbranch_scc1 wc_48
    s_bitcmp1_b32 s9, 0
    s_cbranch_scc1 wc_48_b
    ds_read_b128 v[96:99], v3 offset:24576
    ds_read_b128 v[100:103], v3 offset:25600
    ds_read_b128 v[104:107], v3 offset:26624
    ds_read_b128 v[108:111], v3 offset:27648
    ds_read_b128 v[112:115], v3 offset:28672
    ds_read_b128 v[116:119], v3 offset:29696
    ds_read_b128 v[120:123], v3 offset:30720
    ds_read_b128 v[124:127], v3 offset:31744
    s_branch wc_48_w
wc_48_b:
    ds_read_b128 v[192:195], v3 offset:24576
    ds_read_b128 v[196:199], v3 offset:25600
    ds_read_b128 v[200:203], v3 offset:26624
    ds_read_b128 v[204:207], v3 offset:27648
    ds_read_b128 v[208:211], v3 offset:28672
    ds_read_b128 v[212:215], v3 offset:29696
    ds_read_b128 v[216:219], v3 offset:30720
    ds_read_b128 v[220:223], v3 offset:31744
wc_48_w:
    s_waitcnt lgkmcnt(0)
wc_48:
    s_lshr_b32 s3, s9, 1
    s_andn2_b32 s3, s50, s3
    s_bitcmp0_b32 s3, 0
    s_cbranch_scc1 str_49
    s_waitcnt vmcnt(1)
    s_mov_b32 m0, s48
    s_add_u32 s50, s50, 1
    buffer_load_dwordx4 v5, s[12:15], s49 offen offset:0 sc1 lds
    buffer_load_dwordx4 v5, s[12:15], s49 offen offset:1024 sc1 lds
    buffer_load_dwordx4 v5, s[12:15], s49 offen offset:2048 sc1 lds
    buffer_load_dwordx4 v5, s[12:15], s49 offen offset:3072 sc1 lds
    s_add_u32 s49, s49, 4096
    s_bitcmp1_b32 s50, 0
    s_cselect_b32 s3, 0, 16384
    s_add_u32 s48, s48, s3
    s_add_u32 s49, s49, s3
    s_cmp_eq_u32 s50, 12
    s_cselect_b32 s3, 4294819840, 0
    s_add_u32 s48, s48, 4096
    s_add_u32 s48, s48, s3
str_49:
    s_waitcnt vmcnt(8)
    s_barrier
    s_cmp_gt_u32 s50, 15
    s_cbranch_scc1 stg_50
    s_mov_b32 m0, s48
    s_add_u32 s50, s50, 1
    buffer_load_dwordx4 v5, s[12:15], s49 offen offset:0 sc1 lds
    buffer_load_dwordx4 v5, s[12:15], s49 offen offset:1024 sc1 lds
    buffer_load_dwordx4 v5, s[12:15], s49 offen offset:2048 sc1 lds
    buffer_load_dwordx4 v5, s[12:15], s49 offen offset:3072 sc1 lds
    s_add_u32 s49, s49, 4096
    s_bitcmp1_b32 s50, 0
    s_cselect_b32 s3, 0, 16384
    s_add_u32 s48, s48, s3
    s_add_u32 s49, s49, s3
    s_cmp_eq_u32 s50, 12
    s_cselect_b32 s3, 4294819840, 0
    s_add_u32 s48, s48, 4096
    s_add_u32 s48, s48, s3
    s_cmp_ge_u32 s9, 2
    s_cbranch_scc1 stg_50
stg_50:
    s_cmp_ge_u32 s9, 2
    s_cbranch_scc1 wc_51
    s_bitcmp1_b32 s9, 0
    s_cbranch_scc1 wc_51_b
    ds_read_b128 v[128:131], v3 offset:49152
    ds_read_b128 v[132:135], v3 offset:50176
    ds_read_b128 v[136:139], v3 offset:51200
    ds_read_b128 v[140:143], v3 offset:52224
    ds_read_b128 v[144:147], v3 offset:53248
    ds_read_b128 v[148:151], v3 offset:54272
    ds_read_b128 v[152:155], v3 offset:55296
    ds_read_b128 v[156:159], v3 offset:56320
    s_branch wc_51_w
wc_51_b:
    ds_read_b128 a[0:3], v3 offset:49152
    ds_read_b128 a[4:7], v3 offset:50176
    ds_read_b128 a[8:11], v3 offset:51200
    ds_read_b128 a[12:15], v3 offset:52224
    ds_read_b128 a[16:19], v3 offset:53248
    ds_read_b128 a[20:23], v3 offset:54272
    ds_read_b128 a[24:27], v3 offset:55296
    ds_read_b128 a[28:31], v3 offset:56320
wc_51_w:
    s_waitcnt lgkmcnt(0)
wc_51:
    s_cmp_lg_u32 s51, 1
    s_cbranch_scc1 role_52
    s_and_b32 s52, s11, 0xe0
    s_lshl_b32 s52, s52, 7
    s_add_u32 s52, s52, s56
    s_lshr_b32 s3, s6, 1
    s_min_u32 s3, s3, 1
    s_andn2_b32 s3, s3, s9
    s_lshl_b32 s3, s3, 8
    s_sub_u32 s53, s52, s3
    buffer_load_dwordx4 v[32:35], v5, s[12:15], s52 offen offset:0 sc1
    buffer_load_dwordx4 v[36:39], v5, s[12:15], s52 offen offset:1024 sc1
    buffer_load_dwordx4 v[40:43], v5, s[12:15], s52 offen offset:2048 sc1
    buffer_load_dwordx4 v[44:47], v5, s[12:15], s52 offen offset:3072 sc1
    buffer_load_dwordx4 v[48:51], v6, s[12:15], s53 offen sc1
role_52:
    s_lshr_b32 s3, s9, 1
    s_andn2_b32 s3, s50, s3
    s_bitcmp0_b32 s3, 0
    s_cbranch_scc1 str_53
    s_waitcnt vmcnt(1)
    s_mov_b32 m0, s48
    s_add_u32 s50, s50, 1
    buffer_load_dwordx4 v5, s[12:15], s49 offen offset:0 sc1 lds
    buffer_load_dwordx4 v5, s[12:15], s49 offen offset:1024 sc1 lds
    buffer_load_dwordx4 v5, s[12:15], s49 offen offset:2048 sc1 lds
    buffer_load_dwordx4 v5, s[12:15], s49 offen offset:3072 sc1 lds
    s_add_u32 s49, s49, 4096
    s_bitcmp1_b32 s50, 0
    s_cselect_b32 s3, 0, 16384
    s_add_u32 s48, s48, s3
    s_add_u32 s49, s49, s3
    s_cmp_eq_u32 s50, 12
    s_cselect_b32 s3, 4294819840, 0
    s_add_u32 s48, s48, 4096
    s_add_u32 s48, s48, s3
str_53:
    s_waitcnt vmcnt(8)
    s_barrier
    s_waitcnt vmcnt(0)
    s_cmp_gt_u32 s50, 15
    s_cbranch_scc1 stg_54
    s_mov_b32 m0, s48
    s_add_u32 s50, s50, 1
    buffer_load_dwordx4 v5, s[12:15], s49 offen offset:0 sc1 lds
    buffer_load_dwordx4 v5, s[12:15], s49 offen offset:1024 sc1 lds
    buffer_load_dwordx4 v5, s[12:15], s49 offen offset:2048 sc1 lds
    buffer_load_dwordx4 v5, s[12:15], s49 offen offset:3072 sc1 lds
    s_add_u32 s49, s49, 4096
    s_bitcmp1_b32 s50, 0
    s_cselect_b32 s3, 0, 16384
    s_add_u32 s48, s48, s3
    s_add_u32 s49, s49, s3
    s_cmp_eq_u32 s50, 12
    s_cselect_b32 s3, 4294819840, 0
    s_add_u32 s48, s48, 4096
    s_add_u32 s48, s48, s3
    s_cmp_ge_u32 s9, 2
    s_cbranch_scc1 stg_54
stg_54:
    s_cmp_lg_u32 s51, 1
    s_cbranch_scc1 role_55
    s_mov_b32 s3, 0x100000
l_st_chk:
    v_cmp_ne_u32 s[64:65], s10, v33
    v_cmp_ne_u32 vcc, s10, v35
    s_or_b64 s[64:65], s[64:65], vcc
    v_cmp_ne_u32 vcc, s10, v37
    s_or_b64 s[64:65], s[64:65], vcc
    v_cmp_ne_u32 vcc, s10, v39
    s_or_b64 s[64:65], s[64:65], vcc
    v_cmp_ne_u32 vcc, s10, v41
    s_or_b64 s[64:65], s[64:65], vcc
    v_cmp_ne_u32 vcc, s10, v43
    s_or_b64 s[64:65], s[64:65], vcc
    v_cmp_ne_u32 vcc, s10, v45
    s_or_b64 s[64:65], s[64:65], vcc
    v_cmp_ne_u32 vcc, s10, v47
    s_or_b64 s[64:65], s[64:65], vcc
    v_cmp_ne_u32 vcc, s10, v49
    s_or_b64 s[64:65], s[64:65], vcc
    v_cmp_ne_u32 vcc, s10, v51
    s_or_b64 s[64:65], s[64:65], vcc
    s_cbranch_scc0 l_st_ok
    s_sub_u32 s3, s3, 1
    s_cbranch_scc0 l_st_again
l_st_ok:
    ds_write_b32 v11, v32 offset:1280
    ds_write_b32 v11, v34 offset:2816
    ds_write_b32 v11, v36 offset:1536
    ds_write_b32 v11, v38 offset:3072
    ds_write_b32 v11, v40 offset:1792
    ds_write_b32 v11, v42 offset:3328
    ds_write_b32 v11, v44 offset:2048
    ds_write_b32 v11, v46 offset:3584
    s_mov_b64 exec, 0xffff
    ds_write_b32 v11, v48 offset:1216
    ds_write_b32 v11, v50 offset:2752
    s_mov_b64 exec, -1
    s_waitcnt lgkmcnt(0)
role_55:
    s_lshr_b32 s3, s9, 1
    s_andn2_b32 s3, s50, s3
    s_bitcmp0_b32 s3, 0
    s_cbranch_scc1 str_56
    s_waitcnt vmcnt(1)
    s_mov_b32 m0, s48
    s_add_u32 s50, s50, 1
    buffer_load_dwordx4 v5, s[12:15], s49 offen offset:0 sc1 lds
    buffer_load_dwordx4 v5, s[12:15], s49 offen offset:1024 sc1 lds
    buffer_load_dwordx4 v5, s[12:15], s49 offen offset:2048 sc1 lds
    buffer_load_dwordx4 v5, s[12:15], s49 offen offset:3072 sc1 lds
    s_add_u32 s49, s49, 4096
    s_bitcmp1_b32 s50, 0
    s_cselect_b32 s3, 0, 16384
    s_add_u32 s48, s48, s3
    s_add_u32 s49, s49, s3
    s_cmp_eq_u32 s50, 12
    s_cselect_b32 s3, 4294819840, 0
    s_add_u32 s48, s48, 4096
    s_add_u32 s48, s48, s3
str_56:
    s_add_u32 s61, s51, 48
    s_bitcmp1_b32 s9, 0
    s_cbranch_scc1 wo_57
    s_mov_b32 s24, s36
    s_mov_b32 s25, s37
    s_mov_b32 s26, 2097152
    s_mov_b32 s27, 0x00020000
    s_and_b32 s3, s7, 7
    s_cmp_eq_u32 s3, 3
    s_cbranch_scc0 wo_57
    s_cmp_eq_u32 s9, 0
    s_cbranch_scc1 wo_57
wop_58:
    s_lshl_b32 m0, s61, 10
    s_lshr_b32 s3, s61, 1
    s_xor_b32 s3, s3, s61
    s_and_b32 s3, s3, 1
    s_mul_i32 s3, s3, 3
    s_xor_b32 s3, s3, s61
    s_lshl_b32 s3, s3, 14
    buffer_load_dwordx4 v17, s[24:27], s3 offen lds
    s_add_u32 s61, s61, 3
    s_waitcnt vmcnt(4)
    s_cmp_lt_u32 s61, 66
    s_cbranch_scc1 wop_58
wo_57:
    s_waitcnt vmcnt(8)
    s_barrier
    s_bitcmp1_b32 s9, 0
    s_cbranch_scc1 wo_59
    s_mov_b32 s24, s36
    s_mov_b32 s25, s37
    s_mov_b32 s26, 2097152
    s_mov_b32 s27, 0x00020000
    s_and_b32 s3, s7, 7
    s_cmp_eq_u32 s3, 3
    s_cbranch_scc0 wo_59
    s_cmp_eq_u32 s9, 0
    s_cbranch_scc1 wo_59
wop_60:
    s_lshl_b32 m0, s61, 10
    s_lshr_b32 s3, s61, 1
    s_xor_b32 s3, s3, s61
    s_and_b32 s3, s3, 1
    s_mul_i32 s3, s3, 3
    s_xor_b32 s3, s3, s61
    s_lshl_b32 s3, s3, 14
    buffer_load_dwordx4 v17, s[24:27], s3 offen lds
    s_add_u32 s61, s61, 3
    s_waitcnt vmcnt(4)
    s_cmp_lt_u32 s61, 84
    s_cbranch_scc1 wop_60
wo_59:
    s_waitcnt vmcnt(0)
    s_barrier
    s_bitcmp1_b32 s9, 0
    s_cbranch_scc1 wo_61
    s_mov_b32 s24, s36
    s_mov_b32 s25, s37
    s_mov_b32 s26, 2097152
    s_mov_b32 s27, 0x00020000
    s_and_b32 s3, s7, 7
    s_cmp_eq_u32 s3, 3
    s_cselect_b32 s62, 27, 48
    s_cselect_b32 s63, 12, 24
    s_add_u32 s62, s62, s61
    s_sub_u32 s62, s62, s51
    s_add_u32 s63, s63, s62
wop_62:
    s_lshl_b32 m0, s61, 10
    s_lshr_b32 s3, s61, 1
    s_xor_b32 s3, s3, s61
    s_and_b32 s3, s3, 1
    s_mul_i32 s3, s3, 3
    s_xor_b32 s3, s3, s61
    s_lshl_b32 s3, s3, 14
    buffer_load_dwordx4 v17, s[24:27], s3 offen lds
    s_add_u32 s61, s61, 3
    s_waitcnt vmcnt(7)
    s_cmp_lt_u32 s61, s62
    s_cbranch_scc1 wop_62
wo_61:
    s_barrier
    s_bitcmp1_b32 s9, 0
    s_cbranch_scc1 s_attn
    s_mov_b32 s24, s36
    s_mov_b32 s25, s37
    s_mov_b32 s26, 2097152
    s_mov_b32 s27, 0x00020000
wop_63:
    s_lshl_b32 m0, s61, 10
    s_lshr_b32 s3, s61, 1
    s_xor_b32 s3, s3, s61
    s_and_b32 s3, s3, 1
    s_mul_i32 s3, s3, 3
    s_xor_b32 s3, s3, s61
    s_lshl_b32 s3, s3, 14
    buffer_load_dwordx4 v17, s[24:27], s3 offen lds
    s_add_u32 s61, s61, 3
    s_waitcnt vmcnt(7)
    s_cmp_lt_u32 s61, s63
    s_cbranch_scc1 wop_63
    s_barrier
wop_64:
    s_lshl_b32 m0, s61, 10
    s_lshr_b32 s3, s61, 1
    s_xor_b32 s3, s3, s61
    s_and_b32 s3, s3, 1
    s_mul_i32 s3, s3, 3
    s_xor_b32 s3, s3, s61
    s_lshl_b32 s3, s3, 14
    buffer_load_dwordx4 v17, s[24:27], s3 offen lds
    s_add_u32 s61, s61, 3
    s_waitcnt vmcnt(7)
    s_cmp_lt_u32 s61, 128
    s_cbranch_scc1 wop_64
    s_mov_b32 s61, s51
wop_65:
    s_lshl_b32 m0, s61, 10
    s_lshr_b32 s3, s61, 1
    s_xor_b32 s3, s3, s61
    s_and_b32 s3, s3, 1
    s_mul_i32 s3, s3, 3
    s_xor_b32 s3, s3, s61
    s_lshl_b32 s3, s3, 14
    buffer_load_dwordx4 v17, s[24:27], s3 offen lds
    s_add_u32 s61, s61, 3
    s_waitcnt vmcnt(7)
    s_cmp_lt_u32 s61, 48
    s_cbranch_scc1 wop_65
    s_branch l_wo
l_st_again:
    buffer_load_dwordx4 v[32:35], v5, s[12:15], s52 offen offset:0 sc1
    buffer_load_dwordx4 v[36:39], v5, s[12:15], s52 offen offset:1024 sc1
    buffer_load_dwordx4 v[40:43], v5, s[12:15], s52 offen offset:2048 sc1
    buffer_load_dwordx4 v[44:47], v5, s[12:15], s52 offen offset:3072 sc1
    buffer_load_dwordx4 v[48:51], v6, s[12:15], s53 offen sc1
    s_waitcnt vmcnt(0)
    s_branch l_st_chk
.p2align 6
h_wo:
l_wo:
    s_mul_i32 s98, s9, 786432
    s_add_u32 s98, s98, 65798144
    s_lshl_b32 s99, s11, 10
    s_add_u32 s98, s98, s99
    s_add_u32 s96, s4, s98
    s_addc_u32 s97, s5, 0
    s_mov_b32 s98, s10
    s_mov_b32 s99, s10
    s_sub_u32 s59, s8, 4
    s_lshl_b32 s60, s59, 7
    s_add_u32 s96, s96, s60
    s_addc_u32 s97, s97, 0
    s_lshl_b32 s60, s9, 2
    s_add_u32 s60, s60, 159504
    v_mov_b32 v10, s60
    s_lshl_b32 s60, 1, s59
    v_mov_b32 v11, s60
    v_lshlrev_b32 v13, 4, v11
    s_mov_b64 exec, 1
    s_waitcnt vmcnt(0)
    ds_or_b32 v10, v13
    s_mov_b32 s3, 0x100000
poll_66:
    s_load_dwordx8 s[88:95], s[96:97], 0 glc
    s_sub_u32 s3, s3, 1
    s_cbranch_scc1 poll_66_ok
    s_waitcnt lgkmcnt(0)
    s_xor_b64 s[100:101], s[88:89], s[98:99]
    s_xor_b64 s[88:89], s[90:91], s[98:99]
    s_or_b64 s[100:101], s[100:101], s[88:89]
    s_xor_b64 s[88:89], s[92:93], s[98:99]
    s_or_b64 s[100:101], s[100:101], s[88:89]
    s_xor_b64 s[88:89], s[94:95], s[98:99]
    s_or_b64 s[100:101], s[100:101], s[88:89]
    s_cbranch_scc1 poll_66
poll_66_ok:
    s_waitcnt lgkmcnt(0)
    ds_or_b32 v10, v11
    s_mov_b64 exec, -1
    s_setprio 0
    s_waitcnt lgkmcnt(0)
    s_cmp_eq_u32 s8, 4
    s_cbranch_scc1 l_wo_end
    s_cmp_lg_u32 s9, 0
    s_cbranch_scc1 l_wo_end
    s_lshl_b32 s53, s8, 7
    s_lshl_b32 s52, s11, 10
    s_add_u32 s53, s53, s52
    s_add_u32 s53, s53, 64487168
    s_add_u32 s96, s4, s53
    s_addc_u32 s97, s5, 0
    s_mov_b32 s98, s10
    s_mov_b32 s99, s10
    s_mov_b32 s3, 0x100000
poll_67:
    s_load_dwordx16 s[80:95], s[96:97], 0 glc
    s_sub_u32 s3, s3, 1
    s_cbranch_scc1 poll_67_ok
    s_waitcnt lgkmcnt(0)
    s_xor_b64 s[100:101], s[80:81], s[98:99]
    s_xor_b64 s[80:81], s[82:83], s[98:99]
    s_or_b64 s[100:101], s[100:101], s[80:81]
    s_xor_b64 s[80:81], s[84:85], s[98:99]
    s_or_b64 s[100:101], s[100:101], s[80:81]
    s_xor_b64 s[80:81], s[86:87], s[98:99]
    s_or_b64 s[100:101], s[100:101], s[80:81]
    s_xor_b64 s[80:81], s[88:89], s[98:99]
    s_or_b64 s[100:101], s[100:101], s[80:81]
    s_xor_b64 s[80:81], s[90:91], s[98:99]
    s_or_b64 s[100:101], s[100:101], s[80:81]
    s_xor_b64 s[80:81], s[92:93], s[98:99]
    s_or_b64 s[100:101], s[100:101], s[80:81]
    s_xor_b64 s[80:81], s[94:95], s[98:99]
    s_or_b64 s[100:101], s[100:101], s[80:81]
    s_cbranch_scc1 poll_67
poll_67_ok:
    s_waitcnt lgkmcnt(0)
l_wo_end:
    s_add_u32 s9, s9, 1
    s_cmp_lg_u32 s9, 4
    s_cbranch_scc1 l_wo_next
    s_branch k_exit
l_wo_next:
    s_cmp_lg_u32 s8, 4
    s_cbranch_scc1 l_qkv
    s_cmp_eq_u32 s9, 2
    s_cbranch_scc1 h_qkvA
    s_branch h_qkvB
.p2align 6
s_attn:
    s_sub_u32 s48, s8, 4
    s_lshl_b32 s3, s7, 7
    v_lshrrev_b32 v20, 3, v1
    v_lshlrev_b32 v21, 11, v20
    v_and_b32 v22, 2, v20
    v_lshrrev_b32 v23, 2, v20
    v_or_b32 v22, v22, v23
    v_bfe_u32 v23, v1, 1, 2
    v_xor_b32 v22, v22, v23
    v_lshl_add_u32 v21, v22, 5, v21
    v_and_b32 v22, 1, v1
    v_lshl_add_u32 v21, v22, 4, v21
    v_add_u32 v7, s3, v21
    s_mov_b32 s24, s42
    s_mov_b32 s25, s43
    s_mov_b32 s26, 2097152
    s_mov_b32 s27, 0x00020000
    s_lshr_b32 s49, s9, 1
    s_lshl_b32 s49, s49, 23
    s_lshl_b32 s52, s7, 19
    s_add_u32 s49, s49, s52
    s_and_b32 s52, s6, 1
    s_lshl_b32 s52, s52, 18
    s_add_u32 s49, s49, s52
    s_add_u32 s49, s49, 33554432
    s_lshr_b32 s61, s6, 1
    s_mul_i32 s54, s9, 786432
    s_add_u32 s54, s54, 66322432
    s_lshl_b32 s55, s11, 10
    s_add_u32 s54, s54, s55
    s_add_u32 s52, s4, s54
    s_addc_u32 s53, s5, 0
    s_mov_b32 s54, s10
    s_mov_b32 s55, s10
    s_lshl_b32 s51, s48, 11
    s_add_u32 s49, s49, s51
    s_add_u32 s51, s51, 81920
    s_mov_b32 s60, s48
    s_setprio 3
    s_barrier
    s_lshl_b32 s58, 1, s61
    s_mov_b32 s57, 0
    s_add_u32 s62, s61, 1
    s_and_b32 s62, s62, 7
    s_lshl_b32 s50, s62, 15
    s_add_u32 s50, s50, s49
    s_lshr_b32 s63, s62, 1
    s_lshl_b32 s63, s63, 7
    s_and_b32 s62, s62, 1
    s_lshl_b32 s62, s62, 4
    s_add_u32 s62, s62, s63
    s_mov_b32 s58, 0x100000
need_68:
    s_load_dwordx4 s[64:67], s[52:53], s62 glc
    s_sub_u32 s58, s58, 1
    s_cbranch_scc1 need_68_ok
    s_waitcnt lgkmcnt(0)
need_68_t:
    s_cmp_ge_u32 s48, 2
    s_cselect_b32 s63, s65, s64
    s_cmp_lg_u32 s63, s10
    s_cbranch_scc1 need_68
need_68_ok:
    s_waitcnt lgkmcnt(0)
    s_add_u32 m0, s51, 32768
    s_nop 0
    buffer_load_dwordx4 v5, s[12:15], s50 offen offset:0 sc1 lds
    buffer_load_dwordx4 v5, s[12:15], s50 offen offset:1024 sc1 lds
    s_add_u32 s50, s50, 8192
    s_add_u32 m0, s51, 40960
    s_nop 0
    buffer_load_dwordx4 v5, s[12:15], s50 offen offset:0 sc1 lds
    buffer_load_dwordx4 v5, s[12:15], s50 offen offset:1024 sc1 lds
    s_add_u32 s50, s50, 8192
    s_waitcnt vmcnt(0)
    s_barrier
    s_branch need_69_t
need_69:
    s_load_dwordx4 s[64:67], s[52:53], s62 glc
    s_sub_u32 s58, s58, 1
    s_cbranch_scc1 need_69_ok
    s_waitcnt lgkmcnt(0)
need_69_t:
    s_cmp_ge_u32 s48, 2
    s_cselect_b32 s63, s67, s66
    s_cmp_lg_u32 s63, s10
    s_cbranch_scc1 need_69
need_69_ok:
    s_waitcnt lgkmcnt(0)
    s_add_u32 m0, s51, 49152
    s_nop 0
    buffer_load_dwordx4 v5, s[12:15], s50 offen offset:0 sc1 lds
    buffer_load_dwordx4 v5, s[12:15], s50 offen offset:1024 sc1 lds
    s_add_u32 s50, s50, 8192
    s_add_u32 m0, s51, 57344
    s_nop 0
    buffer_load_dwordx4 v5, s[12:15], s50 offen offset:0 sc1 lds
    buffer_load_dwordx4 v5, s[12:15], s50 offen offset:1024 sc1 lds
    s_add_u32 s50, s50, 8192
    s_add_u32 s62, s61, 2
    s_and_b32 s62, s62, 7
    s_lshl_b32 s50, s62, 15
    s_add_u32 s50, s50, s49
    s_lshr_b32 s63, s62, 1
    s_lshl_b32 s63, s63, 7
    s_and_b32 s62, s62, 1
    s_lshl_b32 s62, s62, 4
    s_add_u32 s62, s62, s63
    s_mov_b32 s58, 0x100000
need_70:
    s_load_dwordx4 s[64:67], s[52:53], s62 glc
    s_sub_u32 s58, s58, 1
    s_cbranch_scc1 need_70_ok
    s_waitcnt lgkmcnt(0)
need_70_t:
    s_cmp_ge_u32 s48, 2
    s_cselect_b32 s63, s65, s64
    s_cmp_lg_u32 s63, s10
    s_cbranch_scc1 need_70
need_70_ok:
    s_waitcnt lgkmcnt(0)
    s_add_u32 m0, s51, 0
    s_nop 0
    buffer_load_dwordx4 v5, s[12:15], s50 offen offset:0 sc1 lds
    buffer_load_dwordx4 v5, s[12:15], s50 offen offset:1024 sc1 lds
    s_add_u32 s50, s50, 8192
    s_add_u32 m0, s51, 8192
    s_nop 0
    buffer_load_dwordx4 v5, s[12:15], s50 offen offset:0 sc1 lds
    buffer_load_dwordx4 v5, s[12:15], s50 offen offset:1024 sc1 lds
    s_add_u32 s50, s50, 8192
    s_waitcnt vmcnt(4)
    s_barrier
    s_branch need_71_t
need_71:
    s_load_dwordx4 s[64:67], s[52:53], s62 glc
    s_sub_u32 s58, s58, 1
    s_cbranch_scc1 need_71_ok
    s_waitcnt lgkmcnt(0)
need_71_t:
    s_cmp_ge_u32 s48, 2
    s_cselect_b32 s63, s67, s66
    s_cmp_lg_u32 s63, s10
    s_cbranch_scc1 need_71
need_71_ok:
    s_waitcnt lgkmcnt(0)
    s_add_u32 m0, s51, 16384
    s_nop 0
    buffer_load_dwordx4 v5, s[12:15], s50 offen offset:0 sc1 lds
    buffer_load_dwordx4 v5, s[12:15], s50 offen offset:1024 sc1 lds
    s_add_u32 s50, s50, 8192
    s_add_u32 m0, s51, 24576
    s_nop 0
    buffer_load_dwordx4 v5, s[12:15], s50 offen offset:0 sc1 lds
    buffer_load_dwordx4 v5, s[12:15], s50 offen offset:1024 sc1 lds
    s_add_u32 s50, s50, 8192
    s_waitcnt vmcnt(4)
    s_barrier
    s_add_u32 s62, s61, 3
    s_and_b32 s62, s62, 7
    s_lshl_b32 s50, s62, 15
    s_add_u32 s50, s50, s49
    s_lshr_b32 s63, s62, 1
    s_lshl_b32 s63, s63, 7
    s_and_b32 s62, s62, 1
    s_lshl_b32 s62, s62, 4
    s_add_u32 s62, s62, s63
    s_mov_b32 s58, 0x100000
need_72:
    s_load_dwordx4 s[64:67], s[52:53], s62 glc
    s_sub_u32 s58, s58, 1
    s_cbranch_scc1 need_72_ok
    s_waitcnt lgkmcnt(0)
need_72_t:
    s_cmp_ge_u32 s48, 2
    s_cselect_b32 s63, s65, s64
    s_cmp_lg_u32 s63, s10
    s_cbranch_scc1 need_72
need_72_ok:
    s_waitcnt lgkmcnt(0)
    s_add_u32 m0, s51, 32768
    s_nop 0
    buffer_load_dwordx4 v5, s[12:15], s50 offen offset:0 sc1 lds
    buffer_load_dwordx4 v5, s[12:15], s50 offen offset:1024 sc1 lds
    s_add_u32 s50, s50, 8192
    s_add_u32 m0, s51, 40960
    s_nop 0
    buffer_load_dwordx4 v5, s[12:15], s50 offen offset:0 sc1 lds
    buffer_load_dwordx4 v5, s[12:15], s50 offen offset:1024 sc1 lds
    s_add_u32 s50, s50, 8192
    s_lshl_b32 m0, s60, 10
    s_lshl_b32 s3, s60, 14
    buffer_load_dwordx4 v7, s[24:27], s3 offen lds
    s_add_u32 s60, s60, 4
    s_lshl_b32 m0, s60, 10
    s_lshl_b32 s3, s60, 14
    buffer_load_dwordx4 v7, s[24:27], s3 offen lds
    s_add_u32 s60, s60, 4
    s_waitcnt vmcnt(6)
    s_barrier
    s_branch need_73_t
need_73:
    s_load_dwordx4 s[64:67], s[52:53], s62 glc
    s_sub_u32 s58, s58, 1
    s_cbranch_scc1 need_73_ok
    s_waitcnt lgkmcnt(0)
need_73_t:
    s_cmp_ge_u32 s48, 2
    s_cselect_b32 s63, s67, s66
    s_cmp_lg_u32 s63, s10
    s_cbranch_scc1 need_73
need_73_ok:
    s_waitcnt lgkmcnt(0)
    s_add_u32 m0, s51, 49152
    s_nop 0
    buffer_load_dwordx4 v5, s[12:15], s50 offen offset:0 sc1 lds
    buffer_load_dwordx4 v5, s[12:15], s50 offen offset:1024 sc1 lds
    s_add_u32 s50, s50, 8192
    s_add_u32 m0, s51, 57344
    s_nop 0
    buffer_load_dwordx4 v5, s[12:15], s50 offen offset:0 sc1 lds
    buffer_load_dwordx4 v5, s[12:15], s50 offen offset:1024 sc1 lds
    s_add_u32 s50, s50, 8192
    s_lshl_b32 m0, s60, 10
    s_lshl_b32 s3, s60, 14
    buffer_load_dwordx4 v7, s[24:27], s3 offen lds
    s_add_u32 s60, s60, 4
    s_lshl_b32 m0, s60, 10
    s_lshl_b32 s3, s60, 14
    buffer_load_dwordx4 v7, s[24:27], s3 offen lds
    s_add_u32 s60, s60, 4
    s_waitcnt vmcnt(8)
    s_barrier
    s_add_u32 s62, s61, 4
    s_and_b32 s62, s62, 7
    s_lshl_b32 s50, s62, 15
    s_add_u32 s50, s50, s49
    s_lshr_b32 s63, s62, 1
    s_lshl_b32 s63, s63, 7
    s_and_b32 s62, s62, 1
    s_lshl_b32 s62, s62, 4
    s_add_u32 s62, s62, s63
    s_mov_b32 s58, 0x100000
need_74:
    s_load_dwordx4 s[64:67], s[52:53], s62 glc
    s_sub_u32 s58, s58, 1
    s_cbranch_scc1 need_74_ok
    s_waitcnt lgkmcnt(0)
need_74_t:
    s_cmp_ge_u32 s48, 2
    s_cselect_b32 s63, s65, s64
    s_cmp_lg_u32 s63, s10
    s_cbranch_scc1 need_74
need_74_ok:
    s_waitcnt lgkmcnt(0)
    s_add_u32 m0, s51, 0
    s_nop 0
    buffer_load_dwordx4 v5, s[12:15], s50 offen offset:0 sc1 lds
    buffer_load_dwordx4 v5, s[12:15], s50 offen offset:1024 sc1 lds
    s_add_u32 s50, s50, 8192
    s_add_u32 m0, s51, 8192
    s_nop 0
    buffer_load_dwordx4 v5, s[12:15], s50 offen offset:0 sc1 lds
    buffer_load_dwordx4 v5, s[12:15], s50 offen offset:1024 sc1 lds
    s_add_u32 s50, s50, 8192
    s_lshl_b32 m0, s60, 10
    s_lshl_b32 s3, s60, 14
    buffer_load_dwordx4 v7, s[24:27], s3 offen lds
    s_add_u32 s60, s60, 4
    s_lshl_b32 m0, s60, 10
    s_lshl_b32 s3, s60, 14
    buffer_load_dwordx4 v7, s[24:27], s3 offen lds
    s_add_u32 s60, s60, 4
    s_waitcnt vmcnt(8)
    s_barrier
    s_branch need_75_t
need_75:
    s_load_dwordx4 s[64:67], s[52:53], s62 glc
    s_sub_u32 s58, s58, 1
    s_cbranch_scc1 need_75_ok
    s_waitcnt lgkmcnt(0)
need_75_t:
    s_cmp_ge_u32 s48, 2
    s_cselect_b32 s63, s67, s66
    s_cmp_lg_u32 s63, s10
    s_cbranch_scc1 need_75
need_75_ok:
    s_waitcnt lgkmcnt(0)
    s_add_u32 m0, s51, 16384
    s_nop 0
    buffer_load_dwordx4 v5, s[12:15], s50 offen offset:0 sc1 lds
    buffer_load_dwordx4 v5, s[12:15], s50 offen offset:1024 sc1 lds
    s_add_u32 s50, s50, 8192
    s_add_u32 m0, s51, 24576
    s_nop 0
    buffer_load_dwordx4 v5, s[12:15], s50 offen offset:0 sc1 lds
    buffer_load_dwordx4 v5, s[12:15], s50 offen offset:1024 sc1 lds
    s_add_u32 s50, s50, 8192
    s_lshl_b32 m0, s60, 10
    s_lshl_b32 s3, s60, 14
    buffer_load_dwordx4 v7, s[24:27], s3 offen lds
    s_add_u32 s60, s60, 4
    s_lshl_b32 m0, s60, 10
    s_lshl_b32 s3, s60, 14
    buffer_load_dwordx4 v7, s[24:27], s3 offen lds
    s_add_u32 s60, s60, 4
    s_waitcnt vmcnt(8)
    s_barrier
    s_add_u32 s62, s61, 5
    s_and_b32 s62, s62, 7
    s_lshl_b32 s50, s62, 15
    s_add_u32 s50, s50, s49
    s_lshr_b32 s63, s62, 1
    s_lshl_b32 s63, s63, 7
    s_and_b32 s62, s62, 1
    s_lshl_b32 s62, s62, 4
    s_add_u32 s62, s62, s63
    s_mov_b32 s58, 0x100000
need_76:
    s_load_dwordx4 s[64:67], s[52:53], s62 glc
    s_sub_u32 s58, s58, 1
    s_cbranch_scc1 need_76_ok
    s_waitcnt lgkmcnt(0)
need_76_t:
    s_cmp_ge_u32 s48, 2
    s_cselect_b32 s63, s65, s64
    s_cmp_lg_u32 s63, s10
    s_cbranch_scc1 need_76
need_76_ok:
    s_waitcnt lgkmcnt(0)
    s_add_u32 m0, s51, 32768
    s_nop 0
    buffer_load_dwordx4 v5, s[12:15], s50 offen offset:0 sc1 lds
    buffer_load_dwordx4 v5, s[12:15], s50 offen offset:1024 sc1 lds
    s_add_u32 s50, s50, 8192
    s_add_u32 m0, s51, 40960
    s_nop 0
    buffer_load_dwordx4 v5, s[12:15], s50 offen offset:0 sc1 lds
    buffer_load_dwordx4 v5, s[12:15], s50 offen offset:1024 sc1 lds
    s_add_u32 s50, s50, 8192
    s_lshl_b32 m0, s60, 10
    s_lshl_b32 s3, s60, 14
    buffer_load_dwordx4 v7, s[24:27], s3 offen lds
    s_add_u32 s60, s60, 4
    s_lshl_b32 m0, s60, 10
    s_lshl_b32 s3, s60, 14
    buffer_load_dwordx4 v7, s[24:27], s3 offen lds
    s_add_u32 s60, s60, 4
    s_waitcnt vmcnt(8)
    s_barrier
    s_branch need_77_t
need_77:
    s_load_dwordx4 s[64:67], s[52:53], s62 glc
    s_sub_u32 s58, s58, 1
    s_cbranch_scc1 need_77_ok
    s_waitcnt lgkmcnt(0)
need_77_t:
    s_cmp_ge_u32 s48, 2
    s_cselect_b32 s63, s67, s66
    s_cmp_lg_u32 s63, s10
    s_cbranch_scc1 need_77
need_77_ok:
    s_waitcnt lgkmcnt(0)
    s_add_u32 m0, s51, 49152
    s_nop 0
    buffer_load_dwordx4 v5, s[12:15], s50 offen offset:0 sc1 lds
    buffer_load_dwordx4 v5, s[12:15], s50 offen offset:1024 sc1 lds
    s_add_u32 s50, s50, 8192
    s_add_u32 m0, s51, 57344
    s_nop 0
    buffer_load_dwordx4 v5, s[12:15], s50 offen offset:0 sc1 lds
    buffer_load_dwordx4 v5, s[12:15], s50 offen offset:1024 sc1 lds
    s_add_u32 s50, s50, 8192
    s_lshl_b32 m0, s60, 10
    s_lshl_b32 s3, s60, 14
    buffer_load_dwordx4 v7, s[24:27], s3 offen lds
    s_add_u32 s60, s60, 4
    s_lshl_b32 m0, s60, 10
    s_lshl_b32 s3, s60, 14
    buffer_load_dwordx4 v7, s[24:27], s3 offen lds
    s_add_u32 s60, s60, 4
    s_waitcnt vmcnt(8)
    s_barrier
    s_add_u32 s62, s61, 6
    s_and_b32 s62, s62, 7
    s_lshl_b32 s50, s62, 15
    s_add_u32 s50, s50, s49
    s_lshr_b32 s63, s62, 1
    s_lshl_b32 s63, s63, 7
    s_and_b32 s62, s62, 1
    s_lshl_b32 s62, s62, 4
    s_add_u32 s62, s62, s63
    s_mov_b32 s58, 0x100000
need_78:
    s_load_dwordx4 s[64:67], s[52:53], s62 glc
    s_sub_u32 s58, s58, 1
    s_cbranch_scc1 need_78_ok
    s_waitcnt lgkmcnt(0)
need_78_t:
    s_cmp_ge_u32 s48, 2
    s_cselect_b32 s63, s65, s64
    s_cmp_lg_u32 s63, s10
    s_cbranch_scc1 need_78
need_78_ok:
    s_waitcnt lgkmcnt(0)
    s_add_u32 m0, s51, 0
    s_nop 0
    buffer_load_dwordx4 v5, s[12:15], s50 offen offset:0 sc1 lds
    buffer_load_dwordx4 v5, s[12:15], s50 offen offset:1024 sc1 lds
    s_add_u32 s50, s50, 8192
    s_add_u32 m0, s51, 8192
    s_nop 0
    buffer_load_dwordx4 v5, s[12:15], s50 offen offset:0 sc1 lds
    buffer_load_dwordx4 v5, s[12:15], s50 offen offset:1024 sc1 lds
    s_add_u32 s50, s50, 8192
    s_lshl_b32 m0, s60, 10
    s_lshl_b32 s3, s60, 14
    buffer_load_dwordx4 v7, s[24:27], s3 offen lds
    s_add_u32 s60, s60, 4
    s_lshl_b32 m0, s60, 10
    s_lshl_b32 s3, s60, 14
    buffer_load_dwordx4 v7, s[24:27], s3 offen lds
    s_add_u32 s60, s60, 4
    s_waitcnt vmcnt(8)
    s_barrier
    s_branch need_79_t
need_79:
    s_load_dwordx4 s[64:67], s[52:53], s62 glc
    s_sub_u32 s58, s58, 1
    s_cbranch_scc1 need_79_ok
    s_waitcnt lgkmcnt(0)
need_79_t:
    s_cmp_ge_u32 s48, 2
    s_cselect_b32 s63, s67, s66
    s_cmp_lg_u32 s63, s10
    s_cbranch_scc1 need_79
need_79_ok:
    s_waitcnt lgkmcnt(0)
    s_add_u32 m0, s51, 16384
    s_nop 0
    buffer_load_dwordx4 v5, s[12:15], s50 offen offset:0 sc1 lds
    buffer_load_dwordx4 v5, s[12:15], s50 offen offset:1024 sc1 lds
    s_add_u32 s50, s50, 8192
    s_add_u32 m0, s51, 24576
    s_nop 0
    buffer_load_dwordx4 v5, s[12:15], s50 offen offset:0 sc1 lds
    buffer_load_dwordx4 v5, s[12:15], s50 offen offset:1024 sc1 lds
    s_add_u32 s50, s50, 8192
    s_lshl_b32 m0, s60, 10
    s_lshl_b32 s3, s60, 14
    buffer_load_dwordx4 v7, s[24:27], s3 offen lds
    s_add_u32 s60, s60, 4
    s_lshl_b32 m0, s60, 10
    s_lshl_b32 s3, s60, 14
    buffer_load_dwordx4 v7, s[24:27], s3 offen lds
    s_add_u32 s60, s60, 4
    s_waitcnt vmcnt(8)
    s_barrier
    s_add_u32 s62, s61, 7
    s_and_b32 s62, s62, 7
    s_lshl_b32 s50, s62, 15
    s_add_u32 s50, s50, s49
    s_lshr_b32 s63, s62, 1
    s_lshl_b32 s63, s63, 7
    s_and_b32 s62, s62, 1
    s_lshl_b32 s62, s62, 4
    s_add_u32 s62, s62, s63
    s_mov_b32 s58, 0x100000
need_80:
    s_load_dwordx4 s[64:67], s[52:53], s62 glc
    s_sub_u32 s58, s58, 1
    s_cbranch_scc1 need_80_ok
    s_waitcnt lgkmcnt(0)
need_80_t:
    s_cmp_ge_u32 s48, 2
    s_cselect_b32 s63, s65, s64
    s_cmp_lg_u32 s63, s10
    s_cbranch_scc1 need_80
need_80_ok:
    s_waitcnt lgkmcnt(0)
    s_add_u32 m0, s51, 32768
    s_nop 0
    buffer_load_dwordx4 v5, s[12:15], s50 offen offset:0 sc1 lds
    buffer_load_dwordx4 v5, s[12:15], s50 offen offset:1024 sc1 lds
    s_add_u32 s50, s50, 8192
    s_add_u32 m0, s51, 40960
    s_nop 0
    buffer_load_dwordx4 v5, s[12:15], s50 offen offset:0 sc1 lds
    buffer_load_dwordx4 v5, s[12:15], s50 offen offset:1024 sc1 lds
    s_add_u32 s50, s50, 8192
    s_lshl_b32 m0, s60, 10
    s_lshl_b32 s3, s60, 14
    buffer_load_dwordx4 v7, s[24:27], s3 offen lds
    s_add_u32 s60, s60, 4
    s_lshl_b32 m0, s60, 10
    s_lshl_b32 s3, s60, 14
    buffer_load_dwordx4 v7, s[24:27], s3 offen lds
    s_add_u32 s60, s60, 4
    s_waitcnt vmcnt(8)
    s_barrier
    s_branch need_81_t
need_81:
    s_load_dwordx4 s[64:67], s[52:53], s62 glc
    s_sub_u32 s58, s58, 1
    s_cbranch_scc1 need_81_ok
    s_waitcnt lgkmcnt(0)
need_81_t:
    s_cmp_ge_u32 s48, 2
    s_cselect_b32 s63, s67, s66
    s_cmp_lg_u32 s63, s10
    s_cbranch_scc1 need_81
need_81_ok:
    s_waitcnt lgkmcnt(0)
    s_add_u32 m0, s51, 49152
    s_nop 0
    buffer_load_dwordx4 v5, s[12:15], s50 offen offset:0 sc1 lds
    buffer_load_dwordx4 v5, s[12:15], s50 offen offset:1024 sc1 lds
    s_add_u32 s50, s50, 8192
    s_add_u32 m0, s51, 57344
    s_nop 0
    buffer_load_dwordx4 v5, s[12:15], s50 offen offset:0 sc1 lds
    buffer_load_dwordx4 v5, s[12:15], s50 offen offset:1024 sc1 lds
    s_add_u32 s50, s50, 8192
    s_lshl_b32 m0, s60, 10
    s_lshl_b32 s3, s60, 14
    buffer_load_dwordx4 v7, s[24:27], s3 offen lds
    s_add_u32 s60, s60, 4
    s_lshl_b32 m0, s60, 10
    s_lshl_b32 s3, s60, 14
    buffer_load_dwordx4 v7, s[24:27], s3 offen lds
    s_add_u32 s60, s60, 4
    s_waitcnt vmcnt(8)
    s_barrier
    s_lshl_b32 m0, s60, 10
    s_lshl_b32 s3, s60, 14
    buffer_load_dwordx4 v7, s[24:27], s3 offen lds
    s_add_u32 s60, s60, 4
    s_lshl_b32 m0, s60, 10
    s_lshl_b32 s3, s60, 14
    buffer_load_dwordx4 v7, s[24:27], s3 offen lds
    s_add_u32 s60, s60, 4
    s_lshl_b32 m0, s60, 10
    s_lshl_b32 s3, s60, 14
    buffer_load_dwordx4 v7, s[24:27], s3 offen lds
    s_add_u32 s60, s60, 4
    s_lshl_b32 m0, s60, 10
    s_lshl_b32 s3, s60, 14
    buffer_load_dwordx4 v7, s[24:27], s3 offen lds
    s_add_u32 s60, s60, 4
    s_waitcnt vmcnt(6)
    s_barrier
    s_lshl_b32 m0, s60, 10
    s_lshl_b32 s3, s60, 14
    buffer_load_dwordx4 v7, s[24:27], s3 offen lds
    s_add_u32 s60, s60, 4
    s_lshl_b32 m0, s60, 10
    s_lshl_b32 s3, s60, 14
    buffer_load_dwordx4 v7, s[24:27], s3 offen lds
    s_add_u32 s60, s60, 4
    s_lshl_b32 m0, s60, 10
    s_lshl_b32 s3, s60, 14
    buffer_load_dwordx4 v7, s[24:27], s3 offen lds
    s_add_u32 s60, s60, 4
    s_lshl_b32 m0, s60, 10
    s_lshl_b32 s3, s60, 14
    buffer_load_dwordx4 v7, s[24:27], s3 offen lds
    s_add_u32 s60, s60, 4
    s_barrier
    s_lshl_b32 m0, s60, 10
    s_lshl_b32 s3, s60, 14
    buffer_load_dwordx4 v7, s[24:27], s3 offen lds
    s_add_u32 s60, s60, 4
    s_lshl_b32 m0, s60, 10
    s_lshl_b32 s3, s60, 14
    buffer_load_dwordx4 v7, s[24:27], s3 offen lds
    s_add_u32 s60, s60, 4
    s_lshl_b32 m0, s60, 10
    s_lshl_b32 s3, s60, 14
    buffer_load_dwordx4 v7, s[24:27], s3 offen lds
    s_add_u32 s60, s60, 4
    s_lshl_b32 m0, s60, 10
    s_lshl_b32 s3, s60, 14
    buffer_load_dwordx4 v7, s[24:27], s3 offen lds
    s_add_u32 s60, s60, 4
    s_cmp_eq_u32 s8, 4
    s_cbranch_scc1 h_wo
    s_branch l_wo
.p2align 6
c_attn_slow:
    s_waitcnt lgkmcnt(0)
    s_lshr_b32 s56, s9, 1
    s_lshl_b32 s56, s56, 23
    s_lshl_b32 s55, s7, 19
    s_add_u32 s56, s56, s55
    s_and_b32 s55, s6, 1
    s_lshl_b32 s55, s55, 18
    s_add_u32 s56, s56, s55
    s_add_u32 s56, s56, 33554432
    v_mov_b32 v28, 0xff800000
    v_mov_b32 v30, 0xff800000
    s_mov_b32 s57, 0
c_attn_slow1:
    s_lshr_b32 s55, s57, 2
    s_lshl_b32 s55, s55, 14
    s_and_b32 s58, s57, 3
    s_lshl_b32 s58, s58, 11
    s_add_u32 s55, s55, s58
    s_add_u32 s55, s55, s56
    buffer_load_dwordx4 v[128:131], v5, s[12:15], s55 offen offset:0 sc1
    buffer_load_dwordx4 v[132:135], v5, s[12:15], s55 offen offset:1024 sc1
    s_waitcnt vmcnt(0)
    v_mfma_f32_32x32x16_bf16 v[64:79], v[128:131], v[8:11], 0
    v_mfma_f32_32x32x16_bf16 v[80:95], v[128:131], v[16:19], 0
    v_mfma_f32_32x32x16_bf16 v[64:79], v[132:135], v[12:15], v[64:79]
    v_mfma_f32_32x32x16_bf16 v[80:95], v[132:135], v[20:23], v[80:95]
    s_nop 10
    v_max3_f32 v28, v28, v64, v65
    v_max3_f32 v28, v28, v66, v67
    v_max3_f32 v28, v28, v68, v69
    v_max3_f32 v28, v28, v70, v71
    v_max3_f32 v28, v28, v72, v73
    v_max3_f32 v28, v28, v74, v75
    v_max3_f32 v28, v28, v76, v77
    v_max3_f32 v28, v28, v78, v79
    v_max3_f32 v30, v30, v80, v81
    v_max3_f32 v30, v30, v82, v83
    v_max3_f32 v30, v30, v84, v85
    v_max3_f32 v30, v30, v86, v87
    v_max3_f32 v30, v30, v88, v89
    v_max3_f32 v30, v30, v90, v91
    v_max3_f32 v30, v30, v92, v93
    v_max3_f32 v30, v30, v94, v95
    s_add_u32 s57, s57, 1
    s_cmp_lt_u32 s57, 64
    s_cbranch_scc1 c_attn_slow1
    v_mov_b32 v29, v28
    s_nop 1
    v_permlane32_swap_b32 v28, v29
    v_max_f32 v28, v28, v29
    v_sub_f32 v96, 0, v28
    v_sub_f32 v97, 0, v28
    v_sub_f32 v98, 0, v28
    v_sub_f32 v99, 0, v28
    v_sub_f32 v100, 0, v28
    v_sub_f32 v101, 0, v28
    v_sub_f32 v102, 0, v28
    v_sub_f32 v103, 0, v28
    v_sub_f32 v104, 0, v28
    v_sub_f32 v105, 0, v28
    v_sub_f32 v106, 0, v28
    v_sub_f32 v107, 0, v28
    v_sub_f32 v108, 0, v28
    v_sub_f32 v109, 0, v28
    v_sub_f32 v110, 0, v28
    v_sub_f32 v111, 0, v28
    v_mov_b32 v160, 0
    v_mov_b32 v161, 0
    v_mov_b32 v162, 0
    v_mov_b32 v163, 0
    v_mov_b32 v164, 0
    v_mov_b32 v165, 0
    v_mov_b32 v166, 0
    v_mov_b32 v167, 0
    v_mov_b32 v168, 0
    v_mov_b32 v169, 0
    v_mov_b32 v170, 0
    v_mov_b32 v171, 0
    v_mov_b32 v172, 0
    v_mov_b32 v173, 0
    v_mov_b32 v174, 0
    v_mov_b32 v175, 0
    v_mov_b32 v192, 0
    v_mov_b32 v193, 0
    v_mov_b32 v194, 0
    v_mov_b32 v195, 0
    v_mov_b32 v31, v30
    s_nop 1
    v_permlane32_swap_b32 v30, v31
    v_max_f32 v30, v30, v31
    v_sub_f32 v112, 0, v30
    v_sub_f32 v113, 0, v30
    v_sub_f32 v114, 0, v30
    v_sub_f32 v115, 0, v30
    v_sub_f32 v116, 0, v30
    v_sub_f32 v117, 0, v30
    v_sub_f32 v118, 0, v30
    v_sub_f32 v119, 0, v30
    v_sub_f32 v120, 0, v30
    v_sub_f32 v121, 0, v30
    v_sub_f32 v122, 0, v30
    v_sub_f32 v123, 0, v30
    v_sub_f32 v124, 0, v30
    v_sub_f32 v125, 0, v30
    v_sub_f32 v126, 0, v30
    v_sub_f32 v127, 0, v30
    v_mov_b32 v176, 0
    v_mov_b32 v177, 0
    v_mov_b32 v178, 0
    v_mov_b32 v179, 0
    v_mov_b32 v180, 0
    v_mov_b32 v181, 0
    v_mov_b32 v182, 0
    v_mov_b32 v183, 0
    v_mov_b32 v184, 0
    v_mov_b32 v185, 0
    v_mov_b32 v186, 0
    v_mov_b32 v187, 0
    v_mov_b32 v188, 0
    v_mov_b32 v189, 0
    v_mov_b32 v190, 0
    v_mov_b32 v191, 0
    v_mov_b32 v196, 0
    v_mov_b32 v197, 0
    v_mov_b32 v198, 0
    v_mov_b32 v199, 0
    s_mov_b32 s57, 0
c_attn_slow2:
    s_lshr_b32 s55, s57, 2
    s_lshl_b32 s55, s55, 14
    s_and_b32 s58, s57, 3
    s_lshl_b32 s58, s58, 11
    s_add_u32 s55, s55, s58
    s_add_u32 s55, s55, s56
    buffer_load_dwordx4 v[128:131], v5, s[12:15], s55 offen offset:0 sc1
    buffer_load_dwordx4 v[132:135], v5, s[12:15], s55 offen offset:1024 sc1
    s_add_u32 s55, s55, 8192
    buffer_load_dwordx4 v[144:147], v5, s[12:15], s55 offen offset:0 sc1
    buffer_load_dwordx4 v[148:151], v5, s[12:15], s55 offen offset:1024 sc1
    s_waitcnt vmcnt(0)
    v_mfma_f32_32x32x16_bf16 v[64:79], v[128:131], v[8:11], v[96:111]
    v_mfma_f32_32x32x16_bf16 v[80:95], v[128:131], v[16:19], v[112:127]
    v_mfma_f32_32x32x16_bf16 v[64:79], v[132:135], v[12:15], v[64:79]
    v_mfma_f32_32x32x16_bf16 v[80:95], v[132:135], v[20:23], v[80:95]
    s_nop 10
    v_exp_f32 v64, v64
    v_exp_f32 v65, v65
    v_exp_f32 v66, v66
    v_exp_f32 v67, v67
    v_exp_f32 v68, v68
    v_exp_f32 v69, v69
    v_exp_f32 v70, v70
    v_exp_f32 v71, v71
    v_exp_f32 v72, v72
    v_exp_f32 v73, v73
    v_exp_f32 v74, v74
    v_exp_f32 v75, v75
    v_exp_f32 v76, v76
    v_exp_f32 v77, v77
    v_exp_f32 v78, v78
    v_exp_f32 v79, v79
    v_exp_f32 v80, v80
    v_exp_f32 v81, v81
    v_exp_f32 v82, v82
    v_exp_f32 v83, v83
    v_exp_f32 v84, v84
    v_exp_f32 v85, v85
    v_exp_f32 v86, v86
    v_exp_f32 v87, v87
    v_exp_f32 v88, v88
    v_exp_f32 v89, v89
    v_exp_f32 v90, v90
    v_exp_f32 v91, v91
    v_exp_f32 v92, v92
    v_exp_f32 v93, v93
    v_exp_f32 v94, v94
    v_exp_f32 v95, v95
    v_smfmac_f32_32x32x32_bf16 v[160:175], v[144:147], v[64:71], v204
    v_smfmac_f32_16x16x64_bf16 v[192:195], v[200:203], v[64:71], v204
    v_smfmac_f32_32x32x32_bf16 v[160:175], v[148:151], v[72:79], v204
    v_smfmac_f32_16x16x64_bf16 v[192:195], v[200:203], v[72:79], v204
    v_smfmac_f32_32x32x32_bf16 v[176:191], v[144:147], v[80:87], v204
    v_smfmac_f32_16x16x64_bf16 v[196:199], v[200:203], v[80:87], v204
    v_smfmac_f32_32x32x32_bf16 v[176:191], v[148:151], v[88:95], v204
    v_smfmac_f32_16x16x64_bf16 v[196:199], v[200:203], v[88:95], v204
    s_add_u32 s57, s57, 1
    s_cmp_lt_u32 s57, 64
    s_nop 15
    s_cbranch_scc1 c_attn_slow2
    s_branch c_attn_fin
    s_endpgm
k_end:
.section .rodata,"a"
.p2align 6
.amdhsa_kernel interleave_layers__sliding_local_dilated__softmax_full_mha__prompt_kernel
  .amdhsa_next_free_vgpr 256
  .amdhsa_next_free_sgpr 102
  .amdhsa_accum_offset 224
  .amdhsa_group_segment_fixed_size 0
  .amdhsa_kernarg_size 72
  .amdhsa_user_sgpr_count 2
  .amdhsa_user_sgpr_kernarg_segment_ptr 1
  .amdhsa_system_sgpr_workgroup_id_x 1
.end_amdhsa_kernel
```
